```python
import torch

def _softmax(x, axis=-1):
    return torch.softmax(x, dim=axis)
def _gelu(x):
    return torch.nn.functional.gelu(x, approximate="tanh")
def _silu(x):
    return torch.nn.functional.silu(x)
def _sigmoid(x):
    return torch.sigmoid(x)
def _layernorm(x, axis=-1, eps=1e-5):
    m = x.mean(dim=axis, keepdim=True)
    v = x.var(dim=axis, keepdim=True, unbiased=False)
    return (x - m) / torch.sqrt(v + eps)
def _scatter_add(tgt, idx, src, axis=0):
    return tgt.clone().index_add_(axis, idx, src)
def _segment_sum(src, seg, n):
    out = torch.zeros((n,) + src.shape[1:], dtype=src.dtype)
    return out.index_add_(0, seg, src)
def _pad(x, pw):
    flat = tuple(v for pair in reversed(pw) for v in pair)
    return torch.nn.functional.pad(x, flat)

kernel_name = 'recurrent_scan__mha_block_cached__geglu_ffn__prompt'

def setup_inputs():

    _w = (lambda a: (lambda t: t.to(torch.bfloat16) if t.is_floating_point() else t)(torch.as_tensor(a)))
    def _A_setup():
        B, Sq, D = 1, 2048, 1024
        H, Sk, Dh = 32, 2048, 128
        return {
            "x": _w((lambda *s: torch.randn(*s, dtype=torch.bfloat16) * 0.05)(B, Sq, D)),
            "k_cache": _w((lambda *s: torch.randn(*s, dtype=torch.bfloat16) * 0.8)(B, H, Sk, Dh)),
            "v_cache": _w((lambda *s: torch.randn(*s, dtype=torch.bfloat16) * 0.2)(B, H, Sk, Dh)),
            "wq": _w((lambda *s: torch.randn(*s, dtype=torch.bfloat16) * 0.8)(D, H * Dh) * (D ** -0.5)),
            "wo": _w((lambda *s: torch.randn(*s, dtype=torch.bfloat16) * 0.2)(H * Dh, D) * ((H * Dh) ** -0.5)),
        }
    _A_in = _A_setup()

    def _B_setup():
        B, S, D, F = 1, 2048, 1024, 3584
        return {
            "x": _w((lambda *s: torch.randn(*s, dtype=torch.bfloat16) * 0.05)(B, S, D)),
            "w_gate": _w((lambda *s: torch.randn(*s, dtype=torch.bfloat16) * 0.1)(D, F)),
            "w_up": _w((lambda *s: torch.randn(*s, dtype=torch.bfloat16) * 0.1)(D, F)),
            "w_down": _w((lambda *s: torch.randn(*s, dtype=torch.bfloat16) * 0.1)(F, D)),
        }
    _B_in = _B_setup()

    return {
        "A_x": _A_in["x"],
        "A_k_cache": _A_in["k_cache"],
        "A_v_cache": _A_in["v_cache"],
        "A_wq": _A_in["wq"],
        "A_wo": _A_in["wo"],
        "B_x": _B_in["x"],
        "B_w_gate": _B_in["w_gate"],
        "B_w_up": _B_in["w_up"],
        "B_w_down": _B_in["w_down"],
    }

def reference(A_x, A_k_cache, A_v_cache, A_wq, A_wo, B_x, B_w_gate, B_w_up, B_w_down):
    def _A_ref(x, k_cache, v_cache, wq, wo):
        B, Sq, D = x.shape
        H, Dh = 32, 128
        q = (lambda x, *d: x.permute(*d))((x @ wq).reshape(B, Sq, H, Dh), 0, 2, 1, 3)
        scores = torch.einsum("bhqd,bhkd->bhqk", q, k_cache) * (Dh ** -0.5)
        p = _softmax(scores, axis=-1)
        o = torch.einsum("bhqk,bhkd->bhqd", p, v_cache)
        return (lambda x, *d: x.permute(*d))(o, 0, 2, 1, 3).reshape(B, Sq, H * Dh) @ wo

    def _B_ref(x, w_gate, w_up, w_down):
        return (_gelu(x @ w_gate) * (x @ w_up)) @ w_down

    x = A_x
    xn = _layernorm(x, axis=-1)
    s = _A_ref(xn, A_k_cache, A_v_cache, A_wq, A_wo)
    g = _silu(_B_ref(xn, B_w_gate, B_w_up, B_w_down))
    return x + s * g
```

```asm
; @launch grid=(256,1,1) block=(256,1,1) lds=163840
.amdgcn_target "amdgcn-amd-amdhsa--gfx950"
.text
.globl recurrent_scan__mha_block_cached__geglu_ffn__prompt_kernel
.p2align 12
.type recurrent_scan__mha_block_cached__geglu_ffn__prompt_kernel,@function
recurrent_scan__mha_block_cached__geglu_ffn__prompt_kernel:
 s_cmp_ge_u32 s2,256
 s_cbranch_scc1 L_end
 s_load_dwordx16 s[64:79],s[0:1],0
 s_load_dwordx8 s[80:87],s[0:1],64
 v_lshrrev_b32 v2,6,v0
 v_and_b32 v1,63,v0
 v_readfirstlane_b32 s48,v2
 s_lshl_b32 s3,s2,2
 s_lshr_b32 s3,0x5366350,s3
 s_and_b32 s3,s3,7
 s_xor_b32 s49,s2,s3
 v_lshlrev_b32 v4,4,v1
 s_lshl_b32 s60,s2,14
 s_lshl_b32 s3,s48,9
 s_add_u32 s60,s60,s3
 v_mul_u32_u24 v204,0x802,v1
 v_and_b32 v204,0x3870,v204
 s_mov_b32 s38,4194304
 s_mov_b32 s39,0x00020000
 s_mov_b32 s10,268435456
 s_mov_b32 s11,0x00020000
 s_getpc_b64 s[4:5]
L_pc:
 v_lshlrev_b32 v2,6,v0
 s_mov_b32 s6,L_codeend-L_pc-4
 global_load_dword a255,v2,s[4:5]
 s_bfe_u32 s3,s2,0x30003
 s_add_u32 s3,s3,1
 s_lshl_b32 s3,s3,14
 v_add_u32 v2,s3,v2
 v_min_u32 v2,s6,v2
 v_and_b32 v206,31,v1
 v_lshlrev_b32 v206,7,v206
 s_lshr_b32 s3,s60,19
 s_lshl_b32 s3,s3,12
 s_add_u32 s3,s3,83918848
 v_add_u32 v206,s3,v206
 v_mov_b32 v207,0
 s_and_b32 s3,s60,509440
 s_cselect_b32 s63,0x40000000,0
 s_waitcnt lgkmcnt(0)
 s_mov_b32 s8,s86
 s_and_b32 s9,s87,0xffff
 buffer_store_dword v207,v206,s[8:11],s63 offen sc0 sc1
 s_mov_b32 s36,s64
 s_and_b32 s37,s65,0xffff
 buffer_load_dwordx4 v[32:35],v204,s[36:39],s60 offen offset:0
 buffer_load_dwordx4 v[36:39],v204,s[36:39],s60 offen offset:128
 buffer_load_dwordx4 v[40:43],v204,s[36:39],s60 offen offset:256
 buffer_load_dwordx4 v[44:47],v204,s[36:39],s60 offen offset:384
 global_load_dword a255,v2,s[4:5]
 s_cmp_lt_u32 s48,2
 s_cselect_b32 s4,s76,s78
 s_cselect_b32 s5,s77,s79
 s_mov_b32 s12,s4
 s_and_b32 s13,s5,0xffff
 s_mov_b32 s14,7340032
 s_mov_b32 s15,0x00020000
 s_and_b32 s3,s49,7
 s_lshl_b32 s3,s3,2
 s_bfe_u32 s4,s49,0x20003
 s_lshr_b32 s3,0x75316420,s3
 s_and_b32 s3,s3,7
 s_lshl2_add_u32 s61,s3,s4
 s_lshr_b32 s62,s49,5
 s_and_b32 s3,s61,3
 s_lshl_b32 s3,s3,3
 s_add_u32 s3,s3,s62
 s_lshl_b32 s3,s3,1
 s_and_b32 s4,s48,1
 s_add_u32 s4,s4,s3
 v_lshrrev_b32 v2,3,v1
 v_lshlrev_b32 v2,6,v2
 v_add_u32 v2,s4,v2
 v_mul_u32_u24 v2,7168,v2
 s_lshr_b32 s4,s61,2
 s_mul_i32 s4,s4,896
 v_add_u32 v2,s4,v2
 v_and_b32 v3,7,v1
 v_min_u32 v3,6,v3
 v_lshl_add_u32 v2,v3,7,v2
 s_mov_b32 s44,s84
 s_and_b32 s45,s85,0xffff
 s_mov_b32 s46,256
 s_mov_b32 s47,0x00020000
 s_mov_b32 s88,0x00100001
 s_mov_b32 s89,0x10000100
 s_lshl_b64 s[90:91],s[88:89],1
 s_lshl_b64 s[96:97],s[88:89],2
 s_lshl_b64 s[98:99],s[88:89],3
 v_mov_b32 v88,0x3f803f80
 v_mov_b32 v89,0x3f803f80
 v_mov_b32 v90,0x3f803f80
 v_mov_b32 v91,0x3f803f80
 v_and_b32 v202,7,v1
 v_lshrrev_b32 v203,3,v1
 v_lshlrev_b32 v203,8,v203
 v_lshl_add_u32 v203,v202,4,v203
 v_lshlrev_b32 v202,6,v202
 v_and_b32 v200,8,v1
 v_lshl_add_u32 v200,v200,2,v202
 v_lshl_add_u32 v200,s48,3,v200
 s_mov_b32 vcc_lo,0x00f0000f
 s_mov_b32 vcc_hi,0xf0000f00
 v_add_u32 v201,4,v200
 v_cndmask_b32 v200,v200,v201,vcc
 s_and_b32 s4,s60,0xfffe0000
 s_bfe_u32 s3,s60,0x2000f
 s_lshl_b32 s3,s3,11
 s_add_u32 s4,s4,s3
 s_bfe_u32 s3,s60,0x4000b
 s_lshl_b32 s3,s3,4
 s_add_u32 s4,s4,s3
 s_lshl_b32 s3,s48,15
 s_add_u32 s4,s4,s3
 s_add_u32 s5,s4,8192
 s_add_u32 s6,s4,16384
 s_add_u32 s7,s4,24576
 v_mov_b32 v205,4
 s_add_u32 s3,s63,s49
 s_waitcnt vmcnt(5)
 buffer_store_byte v205,off,s[44:47],s3 sc0 sc1
 s_waitcnt vmcnt(5)
 v_mfma_f32_16x16x32_bf16 v[84:87],v[32:35],v[32:35],0
 v_mfma_f32_16x16x32_bf16 v[80:83],v[88:91],v[32:35],0
 s_waitcnt vmcnt(4)
 v_mfma_f32_16x16x32_bf16 v[84:87],v[36:39],v[36:39],v[84:87]
 v_mfma_f32_16x16x32_bf16 v[80:83],v[88:91],v[36:39],v[80:83]
 s_waitcnt vmcnt(3)
 v_mfma_f32_16x16x32_bf16 v[84:87],v[40:43],v[40:43],v[84:87]
 v_mfma_f32_16x16x32_bf16 v[80:83],v[88:91],v[40:43],v[80:83]
 s_waitcnt vmcnt(2)
 v_mfma_f32_16x16x32_bf16 v[84:87],v[44:47],v[44:47],v[84:87]
 v_mfma_f32_16x16x32_bf16 v[80:83],v[88:91],v[44:47],v[80:83]
 v_lshlrev_b32 v48,16,v32
 v_and_b32 v49,0xffff0000,v32
 v_lshlrev_b32 v50,16,v33
 v_and_b32 v51,0xffff0000,v33
 v_lshlrev_b32 v52,16,v34
 v_and_b32 v53,0xffff0000,v34
 v_lshlrev_b32 v54,16,v35
 v_and_b32 v55,0xffff0000,v35
 v_cndmask_b32 v80,v80,v84,s[88:89]
 v_cndmask_b32 v80,v80,v85,s[90:91]
 v_cndmask_b32 v80,v80,v86,s[96:97]
 v_cndmask_b32 v80,v80,v87,s[98:99]
 ds_write_b32 v200,v80
 s_mov_b32 s3,0
 s_bfm_b64 exec,32,0
 buffer_load_dword v31,v2,s[12:15],s3 offen
 s_mov_b64 exec,-1
 v_lshlrev_b32 v56,16,v36
 v_and_b32 v57,0xffff0000,v36
 v_lshlrev_b32 v58,16,v37
 v_and_b32 v59,0xffff0000,v37
 v_lshlrev_b32 v60,16,v38
 v_and_b32 v61,0xffff0000,v38
 v_lshlrev_b32 v62,16,v39
 v_and_b32 v63,0xffff0000,v39
 s_waitcnt lgkmcnt(0)
 s_barrier
 ds_read_b128 v[96:99],v202 offset:0
 ds_read_b128 v[100:103],v202 offset:16
 ds_read_b128 v[104:107],v202 offset:32
 ds_read_b128 v[108:111],v202 offset:48
 v_lshlrev_b32 v64,16,v40
 v_and_b32 v65,0xffff0000,v40
 v_lshlrev_b32 v66,16,v41
 v_and_b32 v67,0xffff0000,v41
 v_lshlrev_b32 v68,16,v42
 v_and_b32 v69,0xffff0000,v42
 v_lshlrev_b32 v70,16,v43
 v_and_b32 v71,0xffff0000,v43
 v_lshlrev_b32 v72,16,v44
 v_and_b32 v73,0xffff0000,v44
 v_lshlrev_b32 v74,16,v45
 v_and_b32 v75,0xffff0000,v45
 v_lshlrev_b32 v76,16,v46
 v_and_b32 v77,0xffff0000,v46
 v_lshlrev_b32 v78,16,v47
 v_and_b32 v79,0xffff0000,v47
 s_waitcnt lgkmcnt(2)
 v_pk_add_f32 v[96:97],v[96:97],v[100:101]
 v_pk_add_f32 v[98:99],v[98:99],v[102:103]
 s_waitcnt lgkmcnt(0)
 v_pk_add_f32 v[104:105],v[104:105],v[108:109]
 v_pk_add_f32 v[106:107],v[106:107],v[110:111]
 v_pk_add_f32 v[96:97],v[96:97],v[104:105]
 v_pk_add_f32 v[98:99],v[98:99],v[106:107]
 v_pk_add_f32 v[96:97],v[96:97],v[98:99]
 v_mul_f32 v112,0xba800000,v96
 v_mul_f32 v116,0x3a800000,v97
 v_cvt_pk_bf16_f32 v114,v112,v112
 v_and_b32 v114,0xffff0000,v114
 v_pk_add_f32 v[48:49],v[48:49],v[114:115] op_sel_hi:[1,0]
 v_fma_f32 v116,-v112,v112,v116
 v_pk_add_f32 v[50:51],v[50:51],v[114:115] op_sel_hi:[1,0]
 v_max_f32 v116,0,v116
 v_pk_add_f32 v[52:53],v[52:53],v[114:115] op_sel_hi:[1,0]
 v_cvt_pk_bf16_f32 v116,v116,v116
 v_pk_add_f32 v[54:55],v[54:55],v[114:115] op_sel_hi:[1,0]
 v_and_b32 v116,0xffff0000,v116
 v_pk_add_f32 v[56:57],v[56:57],v[114:115] op_sel_hi:[1,0]
 v_add_f32 v116,0x3727c5ac,v116
 v_pk_add_f32 v[58:59],v[58:59],v[114:115] op_sel_hi:[1,0]
 v_cvt_pk_bf16_f32 v116,v116,v116
 v_pk_add_f32 v[60:61],v[60:61],v[114:115] op_sel_hi:[1,0]
 v_and_b32 v116,0xffff0000,v116
 v_pk_add_f32 v[62:63],v[62:63],v[114:115] op_sel_hi:[1,0]
 v_sqrt_f32 v116,v116
 v_pk_add_f32 v[64:65],v[64:65],v[114:115] op_sel_hi:[1,0]
 v_cvt_pk_bf16_f32 v116,v116,v116
 v_pk_add_f32 v[66:67],v[66:67],v[114:115] op_sel_hi:[1,0]
 v_and_b32 v116,0xffff0000,v116
 v_pk_add_f32 v[68:69],v[68:69],v[114:115] op_sel_hi:[1,0]
 v_rcp_f32 v118,v116
 v_pk_add_f32 v[70:71],v[70:71],v[114:115] op_sel_hi:[1,0]
 v_pk_add_f32 v[72:73],v[72:73],v[114:115] op_sel_hi:[1,0]
 v_pk_add_f32 v[74:75],v[74:75],v[114:115] op_sel_hi:[1,0]
 v_pk_add_f32 v[76:77],v[76:77],v[114:115] op_sel_hi:[1,0]
 v_pk_add_f32 v[78:79],v[78:79],v[114:115] op_sel_hi:[1,0]
 v_cvt_pk_bf16_f32 v32,v48,v49
 v_cvt_pk_bf16_f32 v33,v50,v51
 v_cvt_pk_bf16_f32 v34,v52,v53
 v_cvt_pk_bf16_f32 v35,v54,v55
 v_lshlrev_b32 v48,16,v32
 v_and_b32 v49,0xffff0000,v32
 v_lshlrev_b32 v50,16,v33
 v_and_b32 v51,0xffff0000,v33
 v_lshlrev_b32 v52,16,v34
 v_and_b32 v53,0xffff0000,v34
 v_lshlrev_b32 v54,16,v35
 v_and_b32 v55,0xffff0000,v35
 v_pk_mul_f32 v[48:49],v[48:49],v[118:119] op_sel_hi:[1,0]
 v_pk_mul_f32 v[50:51],v[50:51],v[118:119] op_sel_hi:[1,0]
 v_pk_mul_f32 v[52:53],v[52:53],v[118:119] op_sel_hi:[1,0]
 v_pk_mul_f32 v[54:55],v[54:55],v[118:119] op_sel_hi:[1,0]
 v_cvt_pk_bf16_f32 v32,v48,v49
 v_cvt_pk_bf16_f32 v33,v50,v51
 v_cvt_pk_bf16_f32 v34,v52,v53
 v_cvt_pk_bf16_f32 v35,v54,v55
 buffer_store_dwordx4 v[32:35],v203,s[8:11],s4 offen sc0 sc1
 v_cvt_pk_bf16_f32 v36,v56,v57
 v_cvt_pk_bf16_f32 v37,v58,v59
 v_cvt_pk_bf16_f32 v38,v60,v61
 v_cvt_pk_bf16_f32 v39,v62,v63
 v_lshlrev_b32 v56,16,v36
 v_and_b32 v57,0xffff0000,v36
 v_lshlrev_b32 v58,16,v37
 v_and_b32 v59,0xffff0000,v37
 v_lshlrev_b32 v60,16,v38
 v_and_b32 v61,0xffff0000,v38
 v_lshlrev_b32 v62,16,v39
 v_and_b32 v63,0xffff0000,v39
 v_pk_mul_f32 v[56:57],v[56:57],v[118:119] op_sel_hi:[1,0]
 v_pk_mul_f32 v[58:59],v[58:59],v[118:119] op_sel_hi:[1,0]
 v_pk_mul_f32 v[60:61],v[60:61],v[118:119] op_sel_hi:[1,0]
 v_pk_mul_f32 v[62:63],v[62:63],v[118:119] op_sel_hi:[1,0]
 v_cvt_pk_bf16_f32 v36,v56,v57
 v_cvt_pk_bf16_f32 v37,v58,v59
 v_cvt_pk_bf16_f32 v38,v60,v61
 v_cvt_pk_bf16_f32 v39,v62,v63
 buffer_store_dwordx4 v[36:39],v203,s[8:11],s5 offen sc0 sc1
 v_cvt_pk_bf16_f32 v40,v64,v65
 v_cvt_pk_bf16_f32 v41,v66,v67
 v_cvt_pk_bf16_f32 v42,v68,v69
 v_cvt_pk_bf16_f32 v43,v70,v71
 v_lshlrev_b32 v64,16,v40
 v_and_b32 v65,0xffff0000,v40
 v_lshlrev_b32 v66,16,v41
 v_and_b32 v67,0xffff0000,v41
 v_lshlrev_b32 v68,16,v42
 v_and_b32 v69,0xffff0000,v42
 v_lshlrev_b32 v70,16,v43
 v_and_b32 v71,0xffff0000,v43
 v_pk_mul_f32 v[64:65],v[64:65],v[118:119] op_sel_hi:[1,0]
 v_pk_mul_f32 v[66:67],v[66:67],v[118:119] op_sel_hi:[1,0]
 v_pk_mul_f32 v[68:69],v[68:69],v[118:119] op_sel_hi:[1,0]
 v_pk_mul_f32 v[70:71],v[70:71],v[118:119] op_sel_hi:[1,0]
 v_cvt_pk_bf16_f32 v40,v64,v65
 v_cvt_pk_bf16_f32 v41,v66,v67
 v_cvt_pk_bf16_f32 v42,v68,v69
 v_cvt_pk_bf16_f32 v43,v70,v71
 buffer_store_dwordx4 v[40:43],v203,s[8:11],s6 offen sc0 sc1
 v_cvt_pk_bf16_f32 v44,v72,v73
 v_cvt_pk_bf16_f32 v45,v74,v75
 v_cvt_pk_bf16_f32 v46,v76,v77
 v_cvt_pk_bf16_f32 v47,v78,v79
 v_lshlrev_b32 v72,16,v44
 v_and_b32 v73,0xffff0000,v44
 v_lshlrev_b32 v74,16,v45
 v_and_b32 v75,0xffff0000,v45
 v_lshlrev_b32 v76,16,v46
 v_and_b32 v77,0xffff0000,v46
 v_lshlrev_b32 v78,16,v47
 v_and_b32 v79,0xffff0000,v47
 v_pk_mul_f32 v[72:73],v[72:73],v[118:119] op_sel_hi:[1,0]
 v_pk_mul_f32 v[74:75],v[74:75],v[118:119] op_sel_hi:[1,0]
 v_pk_mul_f32 v[76:77],v[76:77],v[118:119] op_sel_hi:[1,0]
 v_pk_mul_f32 v[78:79],v[78:79],v[118:119] op_sel_hi:[1,0]
 v_cvt_pk_bf16_f32 v44,v72,v73
 v_cvt_pk_bf16_f32 v45,v74,v75
 v_cvt_pk_bf16_f32 v46,v76,v77
 v_cvt_pk_bf16_f32 v47,v78,v79
 buffer_store_dwordx4 v[44:47],v203,s[8:11],s7 offen sc0 sc1
 s_lshl_b32 s4,s62,5
 buffer_load_ubyte v202,off,s[44:47],s4 sc0 sc1
 s_mov_b32 s50,1317011456
 v_add_u32 v5,4096,v4
 s_mov_b32 s16,s70
 s_and_b32 s17,s71,0xffff
 s_mov_b32 s18,8388608
 s_mov_b32 s19,0x00020000
 s_mov_b32 s20,s66
 s_and_b32 s21,s67,0xffff
 s_mov_b32 s22,16777216
 s_mov_b32 s23,0x00020000
 s_mov_b32 s24,s68
 s_and_b32 s25,s69,0xffff
 s_mov_b32 s26,16777216
 s_mov_b32 s27,0x00020000
 s_mov_b32 s28,s80
 s_and_b32 s29,s81,0xffff
 s_mov_b32 s30,7340032
 s_mov_b32 s31,0x00020000
 s_mov_b32 s32,s72
 s_and_b32 s33,s73,0xffff
 s_mov_b32 s34,8388608
 s_mov_b32 s35,0x00020000
 s_mov_b32 s40,s82
 s_and_b32 s41,s83,0xffff
 s_mov_b32 s42,4194304
 s_mov_b32 s43,0x00020000
 s_mov_b32 s0,0
 s_mov_b32 s1,64
L_late:
 s_and_b32 s3,s49,7
 s_lshl_b32 s3,s3,2
 s_bfe_u32 s4,s49,0x20003
 s_lshr_b32 s3,0x75316420,s3
 s_and_b32 s3,s3,7
 s_lshl2_add_u32 s61,s3,s4
 s_lshr_b32 s62,s49,5
 s_mul_i32 s52,s48,7168
 s_add_u32 s52,s52,17536
 s_mul_i32 s51,s48,4384
 s_lshl_b32 s3,s62,2
 s_add_u32 s3,s3,s48
 s_lshl_b32 s57,s3,17
 s_mov_b32 s58,0
 s_and_b32 s3,s48,1
 s_mul_i32 s3,s3,229376
 s_mul_i32 s4,s61,224
 s_add_u32 s3,s3,s4
 s_and_b32 s5,s61,1
 s_lshl_b32 s5,s5,1
 v_add_u32 v2,0,v1
 v_mul_u32_u24 v3,4682,v2
 v_lshrrev_b32 v3,16,v3
 v_mul_u32_u24 v24,14,v3
 v_sub_u32 v2,v2,v24
 v_and_b32 v8,12,v2
 v_and_b32 v24,1,v2
 v_lshl_or_b32 v8,v24,1,v8
 v_bfe_u32 v24,v2,1,1
 v_or_b32 v8,v8,v24
 v_min_u32 v8,13,v8
 v_add_u32 v8,s5,v8
 v_subrev_u32 v24,14,v8
 v_min_u32 v8,v8,v24
 v_lshrrev_b32 v24,1,v3
 v_and_b32 v24,4,v24
 v_xor_b32 v3,v3,v24
 v_mul_u32_u24 v3,7168,v3
 v_lshl_add_u32 v8,v8,4,v3
 s_sub_u32 s4,s3,0
 v_add_u32 v8,s4,v8
 v_add_u32 v2,64,v1
 v_mul_u32_u24 v3,4682,v2
 v_lshrrev_b32 v3,16,v3
 v_mul_u32_u24 v24,14,v3
 v_sub_u32 v2,v2,v24
 v_and_b32 v9,12,v2
 v_and_b32 v24,1,v2
 v_lshl_or_b32 v9,v24,1,v9
 v_bfe_u32 v24,v2,1,1
 v_or_b32 v9,v9,v24
 v_min_u32 v9,13,v9
 v_add_u32 v9,s5,v9
 v_subrev_u32 v24,14,v9
 v_min_u32 v9,v9,v24
 v_lshrrev_b32 v24,1,v3
 v_and_b32 v24,4,v24
 v_xor_b32 v3,v3,v24
 v_mul_u32_u24 v3,7168,v3
 v_lshl_add_u32 v9,v9,4,v3
 s_sub_u32 s4,s3,1024
 v_add_u32 v9,s4,v9
 v_add_u32 v2,128,v1
 v_mul_u32_u24 v3,4682,v2
 v_lshrrev_b32 v3,16,v3
 v_mul_u32_u24 v24,14,v3
 v_sub_u32 v2,v2,v24
 v_and_b32 v10,12,v2
 v_and_b32 v24,1,v2
 v_lshl_or_b32 v10,v24,1,v10
 v_bfe_u32 v24,v2,1,1
 v_or_b32 v10,v10,v24
 v_min_u32 v10,13,v10
 v_add_u32 v10,s5,v10
 v_subrev_u32 v24,14,v10
 v_min_u32 v10,v10,v24
 v_lshrrev_b32 v24,1,v3
 v_and_b32 v24,4,v24
 v_xor_b32 v3,v3,v24
 v_mul_u32_u24 v3,7168,v3
 v_lshl_add_u32 v10,v10,4,v3
 s_sub_u32 s4,s3,2048
 v_add_u32 v10,s4,v10
 v_add_u32 v2,192,v1
 v_mul_u32_u24 v3,4682,v2
 v_lshrrev_b32 v3,16,v3
 v_mul_u32_u24 v24,14,v3
 v_sub_u32 v2,v2,v24
 v_and_b32 v11,12,v2
 v_and_b32 v24,1,v2
 v_lshl_or_b32 v11,v24,1,v11
 v_bfe_u32 v24,v2,1,1
 v_or_b32 v11,v11,v24
 v_min_u32 v11,13,v11
 v_add_u32 v11,s5,v11
 v_subrev_u32 v24,14,v11
 v_min_u32 v11,v11,v24
 v_lshrrev_b32 v24,1,v3
 v_and_b32 v24,4,v24
 v_xor_b32 v3,v3,v24
 v_mul_u32_u24 v3,7168,v3
 v_lshl_add_u32 v11,v11,4,v3
 s_sub_u32 s4,s3,3072
 v_add_u32 v11,s4,v11
 v_add_u32 v2,256,v1
 v_mul_u32_u24 v3,4682,v2
 v_lshrrev_b32 v3,16,v3
 v_mul_u32_u24 v24,14,v3
 v_sub_u32 v2,v2,v24
 v_and_b32 v12,12,v2
 v_and_b32 v24,1,v2
 v_lshl_or_b32 v12,v24,1,v12
 v_bfe_u32 v24,v2,1,1
 v_or_b32 v12,v12,v24
 v_min_u32 v12,13,v12
 v_add_u32 v12,s5,v12
 v_subrev_u32 v24,14,v12
 v_min_u32 v12,v12,v24
 v_lshrrev_b32 v24,1,v3
 v_and_b32 v24,4,v24
 v_xor_b32 v3,v3,v24
 v_mul_u32_u24 v3,7168,v3
 v_lshl_add_u32 v12,v12,4,v3
 s_sub_u32 s4,s3,0
 v_add_u32 v12,s4,v12
 v_add_u32 v2,320,v1
 v_mul_u32_u24 v3,4682,v2
 v_lshrrev_b32 v3,16,v3
 v_mul_u32_u24 v24,14,v3
 v_sub_u32 v2,v2,v24
 v_and_b32 v13,12,v2
 v_and_b32 v24,1,v2
 v_lshl_or_b32 v13,v24,1,v13
 v_bfe_u32 v24,v2,1,1
 v_or_b32 v13,v13,v24
 v_min_u32 v13,13,v13
 v_add_u32 v13,s5,v13
 v_subrev_u32 v24,14,v13
 v_min_u32 v13,v13,v24
 v_lshrrev_b32 v24,1,v3
 v_and_b32 v24,4,v24
 v_xor_b32 v3,v3,v24
 v_mul_u32_u24 v3,7168,v3
 v_lshl_add_u32 v13,v13,4,v3
 s_sub_u32 s4,s3,1024
 v_add_u32 v13,s4,v13
 v_add_u32 v2,384,v1
 v_mul_u32_u24 v3,4682,v2
 v_lshrrev_b32 v3,16,v3
 v_mul_u32_u24 v24,14,v3
 v_sub_u32 v2,v2,v24
 v_and_b32 v14,12,v2
 v_and_b32 v24,1,v2
 v_lshl_or_b32 v14,v24,1,v14
 v_bfe_u32 v24,v2,1,1
 v_or_b32 v14,v14,v24
 v_min_u32 v14,13,v14
 v_add_u32 v14,s5,v14
 v_subrev_u32 v24,14,v14
 v_min_u32 v14,v14,v24
 v_lshrrev_b32 v24,1,v3
 v_and_b32 v24,4,v24
 v_xor_b32 v3,v3,v24
 v_mul_u32_u24 v3,7168,v3
 v_lshl_add_u32 v14,v14,4,v3
 s_sub_u32 s4,s3,2048
 v_add_u32 v14,s4,v14
 s_add_u32 m0,s52,0
 s_nop 0
 buffer_load_dwordx4 v8,s[12:15],s58 offen offset:0 lds
 buffer_load_dwordx4 v9,s[12:15],s58 offen offset:1024 lds
 buffer_load_dwordx4 v10,s[12:15],s58 offen offset:2048 lds
 buffer_load_dwordx4 v11,s[12:15],s58 offen offset:3072 lds
 s_add_u32 m0,s52,4096
 s_nop 0
 buffer_load_dwordx4 v12,s[12:15],s58 offen offset:0 lds
 buffer_load_dwordx4 v13,s[12:15],s58 offen offset:1024 lds
 buffer_load_dwordx4 v14,s[12:15],s58 offen offset:2048 lds
 s_add_u32 s58,s58,458752
 v_mov_b32 v7,0xc0135761
 s_lshl_b32 s4,s62,5
 s_lshl_b32 s6,s49,7
 s_add_u32 s6,s6,83918848
 s_lshl_b32 s3,s48,28
 s_add_u32 s6,s6,s3
 s_waitcnt vmcnt(7)
 s_barrier
L_lnp1:
 v_readfirstlane_b32 s3,v202
 s_sub_u32 s1,s1,1
 s_cbranch_scc1 L_lnp3
 s_bitcmp1_b32 s3,2
 s_cbranch_scc1 L_lnp2
 buffer_load_ubyte v202,off,s[44:47],s4 sc0 sc1
 s_waitcnt vmcnt(0)
 s_branch L_lnp1
L_lnp2:
 buffer_store_dword v7,off,s[8:11],s6 sc0 sc1
L_lnp3:
 s_max_i32 s1,s1,0
 s_add_u32 m0,s52,28672
 s_nop 0
 buffer_load_dwordx4 v8,s[12:15],s58 offen offset:0 lds
 buffer_load_dwordx4 v9,s[12:15],s58 offen offset:1024 lds
 buffer_load_dwordx4 v10,s[12:15],s58 offen offset:2048 lds
 buffer_load_dwordx4 v11,s[12:15],s58 offen offset:3072 lds
 s_add_u32 m0,s52,32768
 s_nop 0
 buffer_load_dwordx4 v12,s[12:15],s58 offen offset:0 lds
 buffer_load_dwordx4 v13,s[12:15],s58 offen offset:1024 lds
 buffer_load_dwordx4 v14,s[12:15],s58 offen offset:2048 lds
 s_add_u32 s58,s58,458752
 v_lshrrev_b32 v24,4,v1
 v_bfe_u32 v25,v1,2,2
 v_and_b32 v26,3,v1
 v_and_b32 v27,1,v24
 v_lshl_add_u32 v2,v24,3,v25
 v_lshl_add_u32 v3,v27,2,v2
 v_xor_b32 v2,4,v3
 v_mul_u32_u24 v3,224,v3
 v_lshl_add_u32 v3,v26,3,v3
 v_add_u32 v15,17536,v3
 v_add_u32 v17,74880,v3
 v_add_u32 v19,132224,v3
 v_mul_u32_u24 v2,224,v2
 v_lshl_add_u32 v2,v26,3,v2
 v_add_u32 v16,17536,v2
 v_add_u32 v18,74880,v2
 v_add_u32 v20,132224,v2
 v_mul_u32_u24 v2,4384,v27
 v_mul_u32_u24 v3,1088,v25
 v_add_u32 v2,v2,v3
 v_lshrrev_b32 v3,1,v24
 v_lshl_add_u32 v2,v3,9,v2
 v_lshl_add_u32 v21,v26,3,v2
 v_add_u32 v22,52608,v21
 v_add_u32 v23,105216,v21
 v_lshrrev_b32 v2,5,v1
 v_and_b32 v3,31,v1
 v_lshlrev_b32 v2,11,v2
 v_lshl_add_u32 v6,v3,4,v2
 s_mov_b32 s82,0xbdd2d3e8
 s_mov_b32 s83,0x3e0293ee
 s_lshl_b32 s3,s62,2
 s_add_u32 s3,s3,s48
 s_lshl_b32 s77,s3,17
 s_mul_i32 s4,s3,458752
 s_add_u32 s4,s4,4194304
 s_lshr_b32 s5,s61,1
 s_mul_i32 s5,s5,7
 s_and_b32 s6,s61,1
 s_add_u32 s7,s5,3
 s_lshr_b32 s67,s7,1
 s_lshl_b32 s67,s67,13
 s_and_b32 s63,s7,1
 s_lshl_b32 s63,s63,10
 s_add_u32 s67,s67,s63
 s_add_u32 s67,s67,s4
 s_lshl_b32 s7,s6,9
 s_add_u32 s67,s67,s7
 s_add_u32 s68,s67,4096
 s_lshl_b32 s7,s6,2
 s_add_u32 s7,s7,s5
 s_lshr_b32 s64,s7,1
 s_lshl_b32 s64,s64,13
 s_and_b32 s63,s7,1
 s_lshl_b32 s63,s63,10
 s_add_u32 s64,s64,s63
 s_add_u32 s64,s64,s4
 s_add_u32 s7,s7,1
 s_lshr_b32 s65,s7,1
 s_lshl_b32 s65,s65,13
 s_and_b32 s63,s7,1
 s_lshl_b32 s63,s63,10
 s_add_u32 s65,s65,s63
 s_add_u32 s65,s65,s4
 s_add_u32 s7,s7,1
 s_lshr_b32 s66,s7,1
 s_lshl_b32 s66,s66,13
 s_and_b32 s63,s7,1
 s_lshl_b32 s63,s63,10
 s_add_u32 s66,s66,s63
 s_add_u32 s66,s66,s4
 s_add_u32 s7,s7,1
 s_lshl_b32 s4,s3,19
 s_lshl_b32 s5,s61,14
 s_add_u32 s4,s4,s5
 s_add_u32 s69,s4,20971520
 s_lshl_b32 s4,s3,5
 s_add_u32 s4,s4,s61
 s_lshl_b32 s4,s4,2
 s_add_u32 s70,s4,83890176
 s_add_u32 m0,s52,57344
 s_nop 0
 buffer_load_dwordx4 v8,s[12:15],s58 offen offset:0 lds
 buffer_load_dwordx4 v9,s[12:15],s58 offen offset:1024 lds
 buffer_load_dwordx4 v10,s[12:15],s58 offen offset:2048 lds
 buffer_load_dwordx4 v11,s[12:15],s58 offen offset:3072 lds
 s_add_u32 m0,s52,61440
 s_nop 0
 buffer_load_dwordx4 v12,s[12:15],s58 offen offset:0 lds
 buffer_load_dwordx4 v13,s[12:15],s58 offen offset:1024 lds
 buffer_load_dwordx4 v14,s[12:15],s58 offen offset:2048 lds
 s_add_u32 s58,s58,458752
 s_lshr_b32 s4,s48,1
 s_and_b32 s5,s48,1
 s_lshl_b32 s6,s4,18
 s_lshl_b32 s7,s5,16
 s_add_u32 s6,s6,s7
 s_lshl_b32 s7,s61,8
 s_add_u32 s84,s6,s7
 s_lshl_b32 s6,s5,12
 s_lshl_b32 s7,s4,10
 s_add_u32 s85,s6,s7
 s_lshl_b32 s86,s4,9
 s_lshl_b32 s59,s61,19
 s_add_u32 s85,s85,s59
 s_add_u32 s86,s86,s59
 s_mov_b32 s59,0
 s_mul_i32 s53,s48,4160
 s_add_u32 s54,s51,17536
 s_lshl_b32 s55,s53,1
 s_add_u32 s55,s55,70144
 s_lshl_b32 s56,s54,1
 s_add_u32 s56,s56,70144
 s_mov_b32 s88,s49
 s_and_b32 s3,s88,3
 s_and_b32 s4,s88,4
 s_bfe_u32 s5,s88,0x20003
 s_add_u32 s5,s4,s5
 s_lshr_b32 s4,s88,5
 s_lshl_b32 s4,s4,2
 s_add_u32 s4,s4,s48
 s_mul_i32 s6,s4,458752
 s_mul_i32 s7,s3,49152
 s_add_u32 s6,s6,s7
 s_add_u32 s71,s6,4194304
 s_lshl_b32 s6,s4,19
 s_lshl_b32 s7,s3,17
 s_add_u32 s6,s6,s7
 s_add_u32 s72,s6,20971520
 s_mul_i32 s73,s3,786432
 s_lshl_b32 s74,s3,21
 s_lshl_b32 s89,s3,6
 s_lshr_b32 s6,s48,1
 s_lshl_b32 s6,s6,16
 s_and_b32 s7,s48,1
 s_lshl_b32 s7,s7,13
 s_add_u32 s6,s6,s7
 s_lshl_b32 s7,s5,8
 s_add_u32 s87,s6,s7
 s_lshl_b32 s6,s88,17
 s_lshl_b32 s7,s48,14
 s_add_u32 s6,s6,s7
 s_add_u32 s75,s6,41943040
 s_lshl_b32 s6,s88,4
 s_lshl_b32 s7,s48,2
 s_add_u32 s6,s6,s7
 s_add_u32 s76,s6,83898368
 s_lshl_b32 s6,s4,17
 s_lshl_b32 s7,s5,8
 s_add_u32 s6,s6,s7
 s_add_u32 s90,s6,s89
 s_lshl_b32 s6,s4,7
 s_add_u32 s91,s6,83890176
 s_lshr_b32 s4,s90,17
 s_lshl_b32 s4,s4,12
 s_and_b32 s5,s90,0x700
 s_add_u32 s4,s4,s5
 s_add_u32 s96,s73,s4
 s_add_u32 s97,s74,s4
 s_and_b32 s4,s61,4
 s_lshl_b32 s5,s4,14
 s_add_u32 s72,s72,s5
 s_lshl_b32 s5,s4,18
 s_add_u32 s74,s74,s5
 s_add_u32 s98,s75,68608
 s_lshl_b32 s5,s49,5
 s_andn2_b32 s5,s5,127
 s_lshr_b32 s6,s89,4
 s_add_u32 s5,s5,s6
 s_add_u32 s5,s5,83951616
 s_and_b32 s4,s49,0xfc
 s_cmp_eq_u32 s48,0
 s_cselect_b32 s99,s4,0x1000
 s_cselect_b32 s81,s5,0x40000000
 s_and_b32 s3,s61,3
 s_lshl_b32 s3,s3,3
 s_add_u32 s3,s3,s62
 s_lshl_b32 s3,s3,1
 s_and_b32 s4,s48,1
 s_add_u32 s4,s4,s3
 v_lshrrev_b32 v2,3,v1
 v_lshlrev_b32 v2,6,v2
 v_add_u32 v2,s4,v2
 v_mul_u32_u24 v2,7168,v2
 s_lshr_b32 s4,s61,2
 s_mul_i32 s4,s4,896
 v_add_u32 v2,s4,v2
 v_and_b32 v3,7,v1
 v_min_u32 v3,6,v3
 v_lshl_add_u32 v2,v3,7,v2
 s_lshl_b32 s3,s3,1
 s_add_u32 s3,s3,s48
 s_lshl_b32 s3,s3,13
 s_lshr_b32 s4,s61,2
 s_lshl_b32 s4,s4,10
 s_add_u32 s3,s3,s4
 v_and_b32 v3,7,v1
 v_lshlrev_b32 v3,7,v3
 v_lshrrev_b32 v24,3,v1
 v_lshl_add_u32 v3,v24,20,v3
 v_lshrrev_b32 v24,3,v1
 v_lshl_add_u32 v3,v24,24,v3
 v_add_u32 v3,s3,v3
 v_lshrrev_b32 v24,4,v1
 v_lshl_add_u32 v2,v24,24,v2
 v_and_b32 v206,7,v1
 v_lshlrev_b32 v206,7,v206
 s_lshr_b32 s3,s77,7
 s_add_u32 s3,s3,83918848
 v_add_u32 v206,s3,v206
 s_waitcnt vmcnt(14)
 s_barrier
 s_sub_u32 s3,s76,8192
 v_mov_b32 v200,s3
 v_mov_b32 v201,s70
 v_cmp_gt_u32 vcc,2,v1
 s_nop 1
 v_cndmask_b32 v200,v200,v201,vcc
 v_lshl_add_u32 v200,v1,12,v200
 v_mov_b32 v201,0
 s_mov_b64 exec,0x3f
 buffer_store_dword v201,v200,s[8:11],0 offen sc0 sc1
 s_mov_b64 exec,-1
 v_mov_b32 v25,0
 v_mov_b32 v26,0
 v_mov_b32 v27,0
 v_mov_b32 v28,0
 v_mov_b32 v29,0
 v_mov_b32 v30,0
 v_mov_b32 v32,0
 v_mov_b32 v33,0
 v_mov_b32 v34,0
 v_mov_b32 v35,0
 v_mov_b32 v36,0
 v_mov_b32 v37,0
 v_mov_b32 v38,0
 v_mov_b32 v39,0
 v_mov_b32 v40,0
 v_mov_b32 v41,0
 s_getpc_b64 s[6:7]
L_cb1:
 s_mov_b64 exec,0
 s_cmp_eq_u32 s48,0
 s_cbranch_scc1 L_w2
 s_cmp_eq_u32 s48,1
 s_cbranch_scc1 L_w3
 s_cmp_eq_u32 s48,2
 s_cbranch_scc1 L_w4
 s_branch L_w5
L_wret0:
 s_mov_b64 exec,-1
L_lnpoll:
 buffer_load_dword v202,v206,s[8:11],0 offen sc0 sc1
 s_sub_u32 s1,s1,1
 s_cbranch_scc1 L_lnself
 s_waitcnt vmcnt(0)
 v_cmp_eq_u32 vcc,0,v202
 s_nop 0
 s_cbranch_vccnz L_lnpoll
L_lnok:
 buffer_load_dwordx4 a[0:3],v4,s[8:11],s57 offen offset:0 sc1
 buffer_load_dwordx4 a[4:7],v4,s[8:11],s57 offen offset:1024 sc1
 buffer_load_dwordx4 a[8:11],v4,s[8:11],s57 offen offset:2048 sc1
 buffer_load_dwordx4 a[12:15],v4,s[8:11],s57 offen offset:3072 sc1
 buffer_load_dwordx4 a[16:19],v5,s[8:11],s57 offen offset:0 sc1
 buffer_load_dwordx4 a[20:23],v5,s[8:11],s57 offen offset:1024 sc1
 buffer_load_dwordx4 a[24:27],v5,s[8:11],s57 offen offset:2048 sc1
 buffer_load_dwordx4 a[28:31],v5,s[8:11],s57 offen offset:3072 sc1
 s_add_u32 s57,s57,8192
 buffer_load_dwordx4 a[32:35],v4,s[8:11],s57 offen offset:0 sc1
 buffer_load_dwordx4 a[36:39],v4,s[8:11],s57 offen offset:1024 sc1
 buffer_load_dwordx4 a[40:43],v4,s[8:11],s57 offen offset:2048 sc1
 buffer_load_dwordx4 a[44:47],v4,s[8:11],s57 offen offset:3072 sc1
 buffer_load_dwordx4 a[48:51],v5,s[8:11],s57 offen offset:0 sc1
 buffer_load_dwordx4 a[52:55],v5,s[8:11],s57 offen offset:1024 sc1
 buffer_load_dwordx4 a[56:59],v5,s[8:11],s57 offen offset:2048 sc1
 buffer_load_dwordx4 a[60:63],v5,s[8:11],s57 offen offset:3072 sc1
 s_add_u32 s57,s57,8192
 s_mov_b32 s60,0xc0000000
 ds_read_b64_tr_b16 a[128:129],v15 offset:0
 ds_read_b64_tr_b16 a[130:131],v16 offset:0
 ds_read_b64_tr_b16 a[132:133],v15 offset:7168
 ds_read_b64_tr_b16 a[134:135],v16 offset:7168
 ds_read_b64_tr_b16 a[136:137],v15 offset:14336
 ds_read_b64_tr_b16 a[138:139],v16 offset:14336
 ds_read_b64_tr_b16 a[140:141],v15 offset:21504
 ds_read_b64_tr_b16 a[142:143],v16 offset:21504
 ds_read_b64_tr_b16 a[144:145],v15 offset:32
 ds_read_b64_tr_b16 a[146:147],v16 offset:32
 ds_read_b64_tr_b16 a[148:149],v15 offset:7200
 ds_read_b64_tr_b16 a[150:151],v16 offset:7200
 s_waitcnt vmcnt(8)
 s_waitcnt lgkmcnt(4)
 v_mfma_f32_16x16x32_bf16 v[32:35],a[128:131],a[0:3],0
 ds_read_b64_tr_b16 a[152:153],v15 offset:14368
 v_mfma_f32_16x16x32_bf16 v[32:35],a[132:135],a[4:7],v[32:35]
 v_mfma_f32_16x16x32_bf16 v[36:39],a[128:131],a[8:11],0
 ds_read_b64_tr_b16 a[154:155],v16 offset:14368
 v_mfma_f32_16x16x32_bf16 v[36:39],a[132:135],a[12:15],v[36:39]
 v_mfma_f32_16x16x32_bf16 v[40:43],a[128:131],a[16:19],0
 ds_read_b64_tr_b16 a[156:157],v15 offset:21536
 v_mfma_f32_16x16x32_bf16 v[40:43],a[132:135],a[20:23],v[40:43]
 v_mfma_f32_16x16x32_bf16 v[44:47],a[128:131],a[24:27],0
 ds_read_b64_tr_b16 a[158:159],v16 offset:21536
 s_mov_b32 s3,1835008
 v_mfma_f32_16x16x32_bf16 v[44:47],a[132:135],a[28:31],v[44:47]
 buffer_load_dword v31,v2,s[12:15],s3 offen
 v_mfma_f32_16x16x32_bf16 v[48:51],a[136:139],a[0:3],0
 ds_read_b64_tr_b16 a[128:129],v15 offset:64
 v_lshlrev_b32 v25,7,v1
 v_mfma_f32_16x16x32_bf16 v[48:51],a[140:143],a[4:7],v[48:51]
 buffer_load_dwordx4 a[64:67],v4,s[8:11],s57 offen offset:0 sc1
 v_mfma_f32_16x16x32_bf16 v[52:55],a[136:139],a[8:11],0
 ds_read_b64_tr_b16 a[130:131],v16 offset:64
 v_lshrrev_b32 v24,2,v1
 v_mfma_f32_16x16x32_bf16 v[52:55],a[140:143],a[12:15],v[52:55]
 buffer_load_dwordx4 a[68:71],v4,s[8:11],s57 offen offset:1024 sc1
 v_mfma_f32_16x16x32_bf16 v[56:59],a[136:139],a[16:19],0
 ds_read_b64_tr_b16 a[132:133],v15 offset:7232
 v_lshl_add_u32 v25,v24,25,v25
 v_mfma_f32_16x16x32_bf16 v[56:59],a[140:143],a[20:23],v[56:59]
 buffer_load_dwordx4 a[72:75],v4,s[8:11],s57 offen offset:2048 sc1
 v_mfma_f32_16x16x32_bf16 v[60:63],a[136:139],a[24:27],0
 ds_read_b64_tr_b16 a[134:135],v16 offset:7232
 v_mfma_f32_16x16x32_bf16 v[60:63],a[140:143],a[28:31],v[60:63]
 s_waitcnt lgkmcnt(4)
 v_mfma_f32_16x16x32_bf16 v[64:67],a[144:147],a[0:3],0
 ds_read_b64_tr_b16 a[136:137],v15 offset:14400
 v_mfma_f32_16x16x32_bf16 v[64:67],a[148:151],a[4:7],v[64:67]
 buffer_load_dwordx4 a[76:79],v4,s[8:11],s57 offen offset:3072 sc1
 v_mfma_f32_16x16x32_bf16 v[68:71],a[144:147],a[8:11],0
 ds_read_b64_tr_b16 a[138:139],v16 offset:14400
 v_mfma_f32_16x16x32_bf16 v[68:71],a[148:151],a[12:15],v[68:71]
 buffer_load_dwordx4 a[80:83],v5,s[8:11],s57 offen offset:0 sc1
 v_mfma_f32_16x16x32_bf16 v[72:75],a[144:147],a[16:19],0
 ds_read_b64_tr_b16 a[140:141],v15 offset:21568
 v_mfma_f32_16x16x32_bf16 v[72:75],a[148:151],a[20:23],v[72:75]
 buffer_load_dwordx4 a[84:87],v5,s[8:11],s57 offen offset:1024 sc1
 v_mfma_f32_16x16x32_bf16 v[76:79],a[144:147],a[24:27],0
 ds_read_b64_tr_b16 a[142:143],v16 offset:21568
 v_mfma_f32_16x16x32_bf16 v[76:79],a[148:151],a[28:31],v[76:79]
 s_lshl_b32 s4,s62,2
 s_add_u32 s4,s4,s48
 s_lshl_b32 s4,s4,9
 v_mfma_f32_16x16x32_bf16 v[80:83],a[152:155],a[0:3],0
 ds_read_b64_tr_b16 a[144:145],v15 offset:96
 v_mfma_f32_16x16x32_bf16 v[80:83],a[156:159],a[4:7],v[80:83]
 s_lshl_b32 s5,s61,19
 s_add_u32 s4,s4,s5
 v_mfma_f32_16x16x32_bf16 v[84:87],a[152:155],a[8:11],0
 ds_read_b64_tr_b16 a[146:147],v16 offset:96
 v_add_u32 v25,s4,v25
 v_mfma_f32_16x16x32_bf16 v[84:87],a[156:159],a[12:15],v[84:87]
 v_mfma_f32_16x16x32_bf16 v[88:91],a[152:155],a[16:19],0
 ds_read_b64_tr_b16 a[148:149],v15 offset:7264
 v_mfma_f32_16x16x32_bf16 v[88:91],a[156:159],a[20:23],v[88:91]
 v_mfma_f32_16x16x32_bf16 v[92:95],a[152:155],a[24:27],0
 ds_read_b64_tr_b16 a[150:151],v16 offset:7264
 v_mfma_f32_16x16x32_bf16 v[92:95],a[156:159],a[28:31],v[92:95]
 s_waitcnt lgkmcnt(4)
 v_mfma_f32_16x16x32_bf16 v[96:99],a[128:131],a[0:3],0
 ds_read_b64_tr_b16 a[152:153],v15 offset:14432
 v_mfma_f32_16x16x32_bf16 v[96:99],a[132:135],a[4:7],v[96:99]
 v_mfma_f32_16x16x32_bf16 v[100:103],a[128:131],a[8:11],0
 ds_read_b64_tr_b16 a[154:155],v16 offset:14432
 v_mfma_f32_16x16x32_bf16 v[100:103],a[132:135],a[12:15],v[100:103]
 v_mfma_f32_16x16x32_bf16 v[104:107],a[128:131],a[16:19],0
 ds_read_b64_tr_b16 a[156:157],v15 offset:21600
 v_mfma_f32_16x16x32_bf16 v[104:107],a[132:135],a[20:23],v[104:107]
 v_mfma_f32_16x16x32_bf16 v[108:111],a[128:131],a[24:27],0
 ds_read_b64_tr_b16 a[158:159],v16 offset:21600
 v_mfma_f32_16x16x32_bf16 v[108:111],a[132:135],a[28:31],v[108:111]
 v_mfma_f32_16x16x32_bf16 v[112:115],a[136:139],a[0:3],0
 ds_read_b64_tr_b16 a[128:129],v15 offset:128
 v_bfe_i32 v30,v1,0,1
 v_mfma_f32_16x16x32_bf16 v[112:115],a[140:143],a[4:7],v[112:115]
 v_and_b32 v30,0xaaaaaaaa,v30
 v_mfma_f32_16x16x32_bf16 v[116:119],a[136:139],a[8:11],0
 ds_read_b64_tr_b16 a[130:131],v16 offset:128
 v_or_b32 v30,0x44444444,v30
 v_mfma_f32_16x16x32_bf16 v[116:119],a[140:143],a[12:15],v[116:119]
 v_mfma_f32_16x16x32_bf16 v[120:123],a[136:139],a[16:19],0
 ds_read_b64_tr_b16 a[132:133],v15 offset:7296
 v_mfma_f32_16x16x32_bf16 v[120:123],a[140:143],a[20:23],v[120:123]
 v_mfma_f32_16x16x32_bf16 v[124:127],a[136:139],a[24:27],0
 ds_read_b64_tr_b16 a[134:135],v16 offset:7296
 v_mfma_f32_16x16x32_bf16 v[124:127],a[140:143],a[28:31],v[124:127]
 s_waitcnt lgkmcnt(4)
 v_mfma_f32_16x16x32_bf16 v[128:131],a[144:147],a[0:3],0
 ds_read_b64_tr_b16 a[136:137],v15 offset:14464
 v_mfma_f32_16x16x32_bf16 v[128:131],a[148:151],a[4:7],v[128:131]
 v_mfma_f32_16x16x32_bf16 v[132:135],a[144:147],a[8:11],0
 ds_read_b64_tr_b16 a[138:139],v16 offset:14464
 v_min_u32 v28,2,v1
 v_mfma_f32_16x16x32_bf16 v[132:135],a[148:151],a[12:15],v[132:135]
 s_lshr_b32 s4,s49,3
 s_lshl2_add_u32 s4,s4,s48
 s_lshl_b32 s4,s4,7
 v_mfma_f32_16x16x32_bf16 v[136:139],a[144:147],a[16:19],0
 ds_read_b64_tr_b16 a[140:141],v15 offset:21632
 v_lshl_add_u32 v28,v28,14,s4
 v_mfma_f32_16x16x32_bf16 v[136:139],a[148:151],a[20:23],v[136:139]
 v_mfma_f32_16x16x32_bf16 v[140:143],a[144:147],a[24:27],0
 ds_read_b64_tr_b16 a[142:143],v16 offset:21632
 v_mfma_f32_16x16x32_bf16 v[140:143],a[148:151],a[28:31],v[140:143]
 v_mfma_f32_16x16x32_bf16 v[144:147],a[152:155],a[0:3],0
 ds_read_b64_tr_b16 a[144:145],v15 offset:160
 v_mfma_f32_16x16x32_bf16 v[144:147],a[156:159],a[4:7],v[144:147]
 v_mfma_f32_16x16x32_bf16 v[148:151],a[152:155],a[8:11],0
 ds_read_b64_tr_b16 a[146:147],v16 offset:160
 v_mfma_f32_16x16x32_bf16 v[148:151],a[156:159],a[12:15],v[148:151]
 v_mfma_f32_16x16x32_bf16 v[152:155],a[152:155],a[16:19],0
 ds_read_b64_tr_b16 a[148:149],v15 offset:7328
 v_mfma_f32_16x16x32_bf16 v[152:155],a[156:159],a[20:23],v[152:155]
 v_mfma_f32_16x16x32_bf16 v[156:159],a[152:155],a[24:27],0
 ds_read_b64_tr_b16 a[150:151],v16 offset:7328
 v_mfma_f32_16x16x32_bf16 v[156:159],a[156:159],a[28:31],v[156:159]
 s_waitcnt lgkmcnt(4)
 v_mfma_f32_16x16x32_bf16 v[160:163],a[128:131],a[0:3],0
 ds_read_b64_tr_b16 a[152:153],v15 offset:14496
 v_mfma_f32_16x16x32_bf16 v[160:163],a[132:135],a[4:7],v[160:163]
 v_mfma_f32_16x16x32_bf16 v[164:167],a[128:131],a[8:11],0
 ds_read_b64_tr_b16 a[154:155],v16 offset:14496
 v_mfma_f32_16x16x32_bf16 v[164:167],a[132:135],a[12:15],v[164:167]
 v_mfma_f32_16x16x32_bf16 v[168:171],a[128:131],a[16:19],0
 ds_read_b64_tr_b16 a[156:157],v15 offset:21664
 v_mfma_f32_16x16x32_bf16 v[168:171],a[132:135],a[20:23],v[168:171]
 v_mfma_f32_16x16x32_bf16 v[172:175],a[128:131],a[24:27],0
 ds_read_b64_tr_b16 a[158:159],v16 offset:21664
 v_mfma_f32_16x16x32_bf16 v[172:175],a[132:135],a[28:31],v[172:175]
 v_mfma_f32_16x16x32_bf16 v[176:179],a[136:139],a[0:3],0
 ds_read_b64_tr_b16 a[128:129],v15 offset:192
 v_mfma_f32_16x16x32_bf16 v[176:179],a[140:143],a[4:7],v[176:179]
 v_mfma_f32_16x16x32_bf16 v[180:183],a[136:139],a[8:11],0
 ds_read_b64_tr_b16 a[130:131],v16 offset:192
 v_mfma_f32_16x16x32_bf16 v[180:183],a[140:143],a[12:15],v[180:183]
 v_mfma_f32_16x16x32_bf16 v[184:187],a[136:139],a[16:19],0
 ds_read_b64_tr_b16 a[132:133],v15 offset:7360
 v_mfma_f32_16x16x32_bf16 v[184:187],a[140:143],a[20:23],v[184:187]
 v_mfma_f32_16x16x32_bf16 v[188:191],a[136:139],a[24:27],0
 ds_read_b64_tr_b16 a[134:135],v16 offset:7360
 v_mfma_f32_16x16x32_bf16 v[188:191],a[140:143],a[28:31],v[188:191]
 s_waitcnt lgkmcnt(4)
 v_mfma_f32_16x16x32_bf16 v[192:195],a[144:147],a[0:3],0
 ds_read_b64_tr_b16 a[136:137],v15 offset:14528
 v_mfma_f32_16x16x32_bf16 v[192:195],a[148:151],a[4:7],v[192:195]
 v_mfma_f32_16x16x32_bf16 v[196:199],a[144:147],a[8:11],0
 ds_read_b64_tr_b16 a[138:139],v16 offset:14528
 v_mfma_f32_16x16x32_bf16 v[196:199],a[148:151],a[12:15],v[196:199]
 v_mfma_f32_16x16x32_bf16 v[200:203],a[144:147],a[16:19],0
 ds_read_b64_tr_b16 a[140:141],v15 offset:21696
 v_mfma_f32_16x16x32_bf16 v[200:203],a[148:151],a[20:23],v[200:203]
 v_mfma_f32_16x16x32_bf16 v[204:207],a[144:147],a[24:27],0
 ds_read_b64_tr_b16 a[142:143],v16 offset:21696
 v_mfma_f32_16x16x32_bf16 v[204:207],a[148:151],a[28:31],v[204:207]
 s_barrier
 v_mfma_f32_16x16x32_bf16 v[208:211],a[152:155],a[0:3],0
 ds_read_b64_tr_b16 a[144:145],v15 offset:28672
 v_mfma_f32_16x16x32_bf16 v[208:211],a[156:159],a[4:7],v[208:211]
 v_mfma_f32_16x16x32_bf16 v[212:215],a[152:155],a[8:11],0
 ds_read_b64_tr_b16 a[146:147],v16 offset:28672
 v_mfma_f32_16x16x32_bf16 v[212:215],a[156:159],a[12:15],v[212:215]
 v_mfma_f32_16x16x32_bf16 v[216:219],a[152:155],a[16:19],0
 ds_read_b64_tr_b16 a[148:149],v15 offset:35840
 v_mfma_f32_16x16x32_bf16 v[216:219],a[156:159],a[20:23],v[216:219]
 v_mfma_f32_16x16x32_bf16 v[220:223],a[152:155],a[24:27],0
 ds_read_b64_tr_b16 a[150:151],v16 offset:35840
 v_mfma_f32_16x16x32_bf16 v[220:223],a[156:159],a[28:31],v[220:223]
 s_waitcnt lgkmcnt(4)
 v_mfma_f32_16x16x32_bf16 v[224:227],a[128:131],a[0:3],0
 ds_read_b64_tr_b16 a[152:153],v15 offset:43008
 v_mfma_f32_16x16x32_bf16 v[224:227],a[132:135],a[4:7],v[224:227]
 v_mfma_f32_16x16x32_bf16 v[228:231],a[128:131],a[8:11],0
 ds_read_b64_tr_b16 a[154:155],v16 offset:43008
 v_mfma_f32_16x16x32_bf16 v[228:231],a[132:135],a[12:15],v[228:231]
 v_mfma_f32_16x16x32_bf16 v[232:235],a[128:131],a[16:19],0
 ds_read_b64_tr_b16 a[156:157],v15 offset:50176
 v_mfma_f32_16x16x32_bf16 v[232:235],a[132:135],a[20:23],v[232:235]
 buffer_load_dwordx4 a[88:91],v5,s[8:11],s57 offen offset:2048 sc1
 v_mfma_f32_16x16x32_bf16 v[236:239],a[128:131],a[24:27],0
 ds_read_b64_tr_b16 a[158:159],v16 offset:50176
 v_mfma_f32_16x16x32_bf16 v[236:239],a[132:135],a[28:31],v[236:239]
 buffer_load_dwordx4 a[92:95],v5,s[8:11],s57 offen offset:3072 sc1
 v_mfma_f32_16x16x32_bf16 v[240:243],a[136:139],a[0:3],0
 ds_read_b64_tr_b16 a[128:129],v15 offset:28704
 s_add_u32 m0,s52,86016
 v_mfma_f32_16x16x32_bf16 v[240:243],a[140:143],a[4:7],v[240:243]
 buffer_load_dwordx4 v8,s[12:15],s58 offen offset:0 lds
 v_mfma_f32_16x16x32_bf16 v[244:247],a[136:139],a[8:11],0
 ds_read_b64_tr_b16 a[130:131],v16 offset:28704
 v_mfma_f32_16x16x32_bf16 v[244:247],a[140:143],a[12:15],v[244:247]
 v_mfma_f32_16x16x32_bf16 v[248:251],a[136:139],a[16:19],0
 ds_read_b64_tr_b16 a[132:133],v15 offset:35872
 v_mfma_f32_16x16x32_bf16 v[248:251],a[140:143],a[20:23],v[248:251]
 v_mfma_f32_16x16x32_bf16 v[252:255],a[136:139],a[24:27],0
 ds_read_b64_tr_b16 a[134:135],v16 offset:35872
 v_mfma_f32_16x16x32_bf16 v[252:255],a[140:143],a[28:31],v[252:255]
 s_waitcnt vmcnt(10)
 s_waitcnt lgkmcnt(4)
 v_mfma_f32_16x16x32_bf16 v[32:35],a[144:147],a[32:35],v[32:35]
 ds_read_b64_tr_b16 a[136:137],v15 offset:43040
 v_mfma_f32_16x16x32_bf16 v[32:35],a[148:151],a[36:39],v[32:35]
 buffer_load_dwordx4 v9,s[12:15],s58 offen offset:1024 lds
 v_mfma_f32_16x16x32_bf16 v[36:39],a[144:147],a[40:43],v[36:39]
 ds_read_b64_tr_b16 a[138:139],v16 offset:43040
 v_mfma_f32_16x16x32_bf16 v[36:39],a[148:151],a[44:47],v[36:39]
 buffer_load_dwordx4 v10,s[12:15],s58 offen offset:2048 lds
 v_mfma_f32_16x16x32_bf16 v[40:43],a[144:147],a[48:51],v[40:43]
 ds_read_b64_tr_b16 a[140:141],v15 offset:50208
 v_mfma_f32_16x16x32_bf16 v[40:43],a[148:151],a[52:55],v[40:43]
 v_mfma_f32_16x16x32_bf16 v[44:47],a[144:147],a[56:59],v[44:47]
 ds_read_b64_tr_b16 a[142:143],v16 offset:50208
 v_mfma_f32_16x16x32_bf16 v[44:47],a[148:151],a[60:63],v[44:47]
 v_mfma_f32_16x16x32_bf16 v[48:51],a[152:155],a[32:35],v[48:51]
 ds_read_b64_tr_b16 a[144:145],v15 offset:28736
 v_mfma_f32_16x16x32_bf16 v[48:51],a[156:159],a[36:39],v[48:51]
 buffer_load_dwordx4 v11,s[12:15],s58 offen offset:3072 lds
 v_mfma_f32_16x16x32_bf16 v[52:55],a[152:155],a[40:43],v[52:55]
 ds_read_b64_tr_b16 a[146:147],v16 offset:28736
 v_mfma_f32_16x16x32_bf16 v[52:55],a[156:159],a[44:47],v[52:55]
 v_mfma_f32_16x16x32_bf16 v[56:59],a[152:155],a[48:51],v[56:59]
 ds_read_b64_tr_b16 a[148:149],v15 offset:35904
 s_add_u32 m0,s52,90112
 v_mfma_f32_16x16x32_bf16 v[56:59],a[156:159],a[52:55],v[56:59]
 buffer_load_dwordx4 v12,s[12:15],s58 offen offset:0 lds
 v_mfma_f32_16x16x32_bf16 v[60:63],a[152:155],a[56:59],v[60:63]
 ds_read_b64_tr_b16 a[150:151],v16 offset:35904
 v_mfma_f32_16x16x32_bf16 v[60:63],a[156:159],a[60:63],v[60:63]
 s_waitcnt lgkmcnt(4)
 v_mfma_f32_16x16x32_bf16 v[64:67],a[128:131],a[32:35],v[64:67]
 ds_read_b64_tr_b16 a[152:153],v15 offset:43072
 v_mfma_f32_16x16x32_bf16 v[64:67],a[132:135],a[36:39],v[64:67]
 buffer_load_dwordx4 v13,s[12:15],s58 offen offset:1024 lds
 v_mfma_f32_16x16x32_bf16 v[68:71],a[128:131],a[40:43],v[68:71]
 ds_read_b64_tr_b16 a[154:155],v16 offset:43072
 v_mfma_f32_16x16x32_bf16 v[68:71],a[132:135],a[44:47],v[68:71]
 v_mfma_f32_16x16x32_bf16 v[72:75],a[128:131],a[48:51],v[72:75]
 ds_read_b64_tr_b16 a[156:157],v15 offset:50240
 v_mfma_f32_16x16x32_bf16 v[72:75],a[132:135],a[52:55],v[72:75]
 v_mfma_f32_16x16x32_bf16 v[76:79],a[128:131],a[56:59],v[76:79]
 ds_read_b64_tr_b16 a[158:159],v16 offset:50240
 v_mfma_f32_16x16x32_bf16 v[76:79],a[132:135],a[60:63],v[76:79]
 v_mfma_f32_16x16x32_bf16 v[80:83],a[136:139],a[32:35],v[80:83]
 ds_read_b64_tr_b16 a[128:129],v15 offset:28768
 v_mfma_f32_16x16x32_bf16 v[80:83],a[140:143],a[36:39],v[80:83]
 v_mfma_f32_16x16x32_bf16 v[84:87],a[136:139],a[40:43],v[84:87]
 ds_read_b64_tr_b16 a[130:131],v16 offset:28768
 v_mfma_f32_16x16x32_bf16 v[84:87],a[140:143],a[44:47],v[84:87]
 buffer_load_dwordx4 v14,s[12:15],s58 offen offset:2048 lds
 v_mfma_f32_16x16x32_bf16 v[88:91],a[136:139],a[48:51],v[88:91]
 ds_read_b64_tr_b16 a[132:133],v15 offset:35936
 v_mfma_f32_16x16x32_bf16 v[88:91],a[140:143],a[52:55],v[88:91]
 v_mfma_f32_16x16x32_bf16 v[92:95],a[136:139],a[56:59],v[92:95]
 ds_read_b64_tr_b16 a[134:135],v16 offset:35936
 v_mfma_f32_16x16x32_bf16 v[92:95],a[140:143],a[60:63],v[92:95]
 s_waitcnt lgkmcnt(4)
 v_mfma_f32_16x16x32_bf16 v[96:99],a[144:147],a[32:35],v[96:99]
 ds_read_b64_tr_b16 a[136:137],v15 offset:43104
 s_add_u32 s57,s57,8192
 v_mfma_f32_16x16x32_bf16 v[96:99],a[148:151],a[36:39],v[96:99]
 buffer_load_dwordx4 a[96:99],v4,s[8:11],s57 offen offset:0 sc1
 v_mfma_f32_16x16x32_bf16 v[100:103],a[144:147],a[40:43],v[100:103]
 ds_read_b64_tr_b16 a[138:139],v16 offset:43104
 v_mfma_f32_16x16x32_bf16 v[100:103],a[148:151],a[44:47],v[100:103]
 v_mfma_f32_16x16x32_bf16 v[104:107],a[144:147],a[48:51],v[104:107]
 ds_read_b64_tr_b16 a[140:141],v15 offset:50272
 v_mfma_f32_16x16x32_bf16 v[104:107],a[148:151],a[52:55],v[104:107]
 buffer_load_dwordx4 a[100:103],v4,s[8:11],s57 offen offset:1024 sc1
 v_mfma_f32_16x16x32_bf16 v[108:111],a[144:147],a[56:59],v[108:111]
 ds_read_b64_tr_b16 a[142:143],v16 offset:50272
 v_mfma_f32_16x16x32_bf16 v[108:111],a[148:151],a[60:63],v[108:111]
 v_mfma_f32_16x16x32_bf16 v[112:115],a[152:155],a[32:35],v[112:115]
 ds_read_b64_tr_b16 a[144:145],v15 offset:28800
 v_mfma_f32_16x16x32_bf16 v[112:115],a[156:159],a[36:39],v[112:115]
 buffer_load_dwordx4 a[104:107],v4,s[8:11],s57 offen offset:2048 sc1
 v_mfma_f32_16x16x32_bf16 v[116:119],a[152:155],a[40:43],v[116:119]
 ds_read_b64_tr_b16 a[146:147],v16 offset:28800
 v_mfma_f32_16x16x32_bf16 v[116:119],a[156:159],a[44:47],v[116:119]
 v_mfma_f32_16x16x32_bf16 v[120:123],a[152:155],a[48:51],v[120:123]
 ds_read_b64_tr_b16 a[148:149],v15 offset:35968
 v_mfma_f32_16x16x32_bf16 v[120:123],a[156:159],a[52:55],v[120:123]
 v_mfma_f32_16x16x32_bf16 v[124:127],a[152:155],a[56:59],v[124:127]
 ds_read_b64_tr_b16 a[150:151],v16 offset:35968
 v_mfma_f32_16x16x32_bf16 v[124:127],a[156:159],a[60:63],v[124:127]
 s_waitcnt lgkmcnt(4)
 v_mfma_f32_16x16x32_bf16 v[128:131],a[128:131],a[32:35],v[128:131]
 ds_read_b64_tr_b16 a[152:153],v15 offset:43136
 v_mfma_f32_16x16x32_bf16 v[128:131],a[132:135],a[36:39],v[128:131]
 buffer_load_dwordx4 a[108:111],v4,s[8:11],s57 offen offset:3072 sc1
 v_mfma_f32_16x16x32_bf16 v[132:135],a[128:131],a[40:43],v[132:135]
 ds_read_b64_tr_b16 a[154:155],v16 offset:43136
 v_mfma_f32_16x16x32_bf16 v[132:135],a[132:135],a[44:47],v[132:135]
 buffer_load_dwordx4 a[112:115],v5,s[8:11],s57 offen offset:0 sc1
 v_mfma_f32_16x16x32_bf16 v[136:139],a[128:131],a[48:51],v[136:139]
 ds_read_b64_tr_b16 a[156:157],v15 offset:50304
 v_mfma_f32_16x16x32_bf16 v[136:139],a[132:135],a[52:55],v[136:139]
 v_mfma_f32_16x16x32_bf16 v[140:143],a[128:131],a[56:59],v[140:143]
 ds_read_b64_tr_b16 a[158:159],v16 offset:50304
 v_mfma_f32_16x16x32_bf16 v[140:143],a[132:135],a[60:63],v[140:143]
 buffer_load_dwordx4 a[116:119],v5,s[8:11],s57 offen offset:1024 sc1
 v_mfma_f32_16x16x32_bf16 v[144:147],a[136:139],a[32:35],v[144:147]
 ds_read_b64_tr_b16 a[128:129],v15 offset:28832
 v_mfma_f32_16x16x32_bf16 v[144:147],a[140:143],a[36:39],v[144:147]
 v_mfma_f32_16x16x32_bf16 v[148:151],a[136:139],a[40:43],v[148:151]
 ds_read_b64_tr_b16 a[130:131],v16 offset:28832
 v_mfma_f32_16x16x32_bf16 v[148:151],a[140:143],a[44:47],v[148:151]
 v_mfma_f32_16x16x32_bf16 v[152:155],a[136:139],a[48:51],v[152:155]
 ds_read_b64_tr_b16 a[132:133],v15 offset:36000
 v_mfma_f32_16x16x32_bf16 v[152:155],a[140:143],a[52:55],v[152:155]
 buffer_load_dwordx4 a[120:123],v5,s[8:11],s57 offen offset:2048 sc1
 v_mfma_f32_16x16x32_bf16 v[156:159],a[136:139],a[56:59],v[156:159]
 ds_read_b64_tr_b16 a[134:135],v16 offset:36000
 v_mfma_f32_16x16x32_bf16 v[156:159],a[140:143],a[60:63],v[156:159]
 s_waitcnt lgkmcnt(4)
 v_mfma_f32_16x16x32_bf16 v[160:163],a[144:147],a[32:35],v[160:163]
 ds_read_b64_tr_b16 a[136:137],v15 offset:43168
 v_mfma_f32_16x16x32_bf16 v[160:163],a[148:151],a[36:39],v[160:163]
 buffer_load_dwordx4 a[124:127],v5,s[8:11],s57 offen offset:3072 sc1
 v_mfma_f32_16x16x32_bf16 v[164:167],a[144:147],a[40:43],v[164:167]
 ds_read_b64_tr_b16 a[138:139],v16 offset:43168
 v_mfma_f32_16x16x32_bf16 v[164:167],a[148:151],a[44:47],v[164:167]
 v_mfma_f32_16x16x32_bf16 v[168:171],a[144:147],a[48:51],v[168:171]
 ds_read_b64_tr_b16 a[140:141],v15 offset:50336
 v_mfma_f32_16x16x32_bf16 v[168:171],a[148:151],a[52:55],v[168:171]
 s_add_u32 s58,s58,458752
 v_mfma_f32_16x16x32_bf16 v[172:175],a[144:147],a[56:59],v[172:175]
 ds_read_b64_tr_b16 a[142:143],v16 offset:50336
 s_add_u32 m0,s52,114688
 v_mfma_f32_16x16x32_bf16 v[172:175],a[148:151],a[60:63],v[172:175]
 buffer_load_dwordx4 v8,s[12:15],s58 offen offset:0 lds
 v_mfma_f32_16x16x32_bf16 v[176:179],a[152:155],a[32:35],v[176:179]
 ds_read_b64_tr_b16 a[144:145],v15 offset:28864
 v_mfma_f32_16x16x32_bf16 v[176:179],a[156:159],a[36:39],v[176:179]
 v_mfma_f32_16x16x32_bf16 v[180:183],a[152:155],a[40:43],v[180:183]
 ds_read_b64_tr_b16 a[146:147],v16 offset:28864
 v_mfma_f32_16x16x32_bf16 v[180:183],a[156:159],a[44:47],v[180:183]
 v_mfma_f32_16x16x32_bf16 v[184:187],a[152:155],a[48:51],v[184:187]
 ds_read_b64_tr_b16 a[148:149],v15 offset:36032
 v_mfma_f32_16x16x32_bf16 v[184:187],a[156:159],a[52:55],v[184:187]
 buffer_load_dwordx4 v9,s[12:15],s58 offen offset:1024 lds
 v_mfma_f32_16x16x32_bf16 v[188:191],a[152:155],a[56:59],v[188:191]
 ds_read_b64_tr_b16 a[150:151],v16 offset:36032
 v_mfma_f32_16x16x32_bf16 v[188:191],a[156:159],a[60:63],v[188:191]
 s_waitcnt lgkmcnt(4)
 v_mfma_f32_16x16x32_bf16 v[192:195],a[128:131],a[32:35],v[192:195]
 ds_read_b64_tr_b16 a[152:153],v15 offset:43200
 s_mov_b32 s3,2752512
 v_mfma_f32_16x16x32_bf16 v[192:195],a[132:135],a[36:39],v[192:195]
 buffer_load_dword v31,v2,s[12:15],s3 offen
 v_mfma_f32_16x16x32_bf16 v[196:199],a[128:131],a[40:43],v[196:199]
 ds_read_b64_tr_b16 a[154:155],v16 offset:43200
 v_mfma_f32_16x16x32_bf16 v[196:199],a[132:135],a[44:47],v[196:199]
 v_mfma_f32_16x16x32_bf16 v[200:203],a[128:131],a[48:51],v[200:203]
 ds_read_b64_tr_b16 a[156:157],v15 offset:50368
 v_mfma_f32_16x16x32_bf16 v[200:203],a[132:135],a[52:55],v[200:203]
 v_mfma_f32_16x16x32_bf16 v[204:207],a[128:131],a[56:59],v[204:207]
 ds_read_b64_tr_b16 a[158:159],v16 offset:50368
 v_mfma_f32_16x16x32_bf16 v[204:207],a[132:135],a[60:63],v[204:207]
 s_barrier
 v_mfma_f32_16x16x32_bf16 v[208:211],a[136:139],a[32:35],v[208:211]
 ds_read_b64_tr_b16 a[128:129],v17 offset:0
 v_mfma_f32_16x16x32_bf16 v[208:211],a[140:143],a[36:39],v[208:211]
 buffer_load_dwordx4 v10,s[12:15],s58 offen offset:2048 lds
 v_mfma_f32_16x16x32_bf16 v[212:215],a[136:139],a[40:43],v[212:215]
 ds_read_b64_tr_b16 a[130:131],v18 offset:0
 s_getpc_b64 s[6:7]
L_cb2:
 v_mfma_f32_16x16x32_bf16 v[212:215],a[140:143],a[44:47],v[212:215]
 global_load_dword v31,v28,s[6:7]
 v_mfma_f32_16x16x32_bf16 v[216:219],a[136:139],a[48:51],v[216:219]
 ds_read_b64_tr_b16 a[132:133],v17 offset:7168
 v_mfma_f32_16x16x32_bf16 v[216:219],a[140:143],a[52:55],v[216:219]
 buffer_load_dwordx4 v11,s[12:15],s58 offen offset:3072 lds
 v_mfma_f32_16x16x32_bf16 v[220:223],a[136:139],a[56:59],v[220:223]
 ds_read_b64_tr_b16 a[134:135],v18 offset:7168
 v_mfma_f32_16x16x32_bf16 v[220:223],a[140:143],a[60:63],v[220:223]
 s_waitcnt lgkmcnt(4)
 v_mfma_f32_16x16x32_bf16 v[224:227],a[144:147],a[32:35],v[224:227]
 ds_read_b64_tr_b16 a[136:137],v17 offset:14336
 s_add_u32 m0,s52,118784
 v_mfma_f32_16x16x32_bf16 v[224:227],a[148:151],a[36:39],v[224:227]
 buffer_load_dwordx4 v12,s[12:15],s58 offen offset:0 lds
 v_mfma_f32_16x16x32_bf16 v[228:231],a[144:147],a[40:43],v[228:231]
 ds_read_b64_tr_b16 a[138:139],v18 offset:14336
 v_mfma_f32_16x16x32_bf16 v[228:231],a[148:151],a[44:47],v[228:231]
 v_mfma_f32_16x16x32_bf16 v[232:235],a[144:147],a[48:51],v[232:235]
 ds_read_b64_tr_b16 a[140:141],v17 offset:21504
 v_mfma_f32_16x16x32_bf16 v[232:235],a[148:151],a[52:55],v[232:235]
 buffer_load_dwordx4 v13,s[12:15],s58 offen offset:1024 lds
 v_mfma_f32_16x16x32_bf16 v[236:239],a[144:147],a[56:59],v[236:239]
 ds_read_b64_tr_b16 a[142:143],v18 offset:21504
 v_mfma_f32_16x16x32_bf16 v[236:239],a[148:151],a[60:63],v[236:239]
 v_mfma_f32_16x16x32_bf16 v[240:243],a[152:155],a[32:35],v[240:243]
 ds_read_b64_tr_b16 a[144:145],v17 offset:32
 v_mfma_f32_16x16x32_bf16 v[240:243],a[156:159],a[36:39],v[240:243]
 buffer_load_dwordx4 v14,s[12:15],s58 offen offset:2048 lds
 v_mfma_f32_16x16x32_bf16 v[244:247],a[152:155],a[40:43],v[244:247]
 ds_read_b64_tr_b16 a[146:147],v18 offset:32
 v_mfma_f32_16x16x32_bf16 v[244:247],a[156:159],a[44:47],v[244:247]
 v_mfma_f32_16x16x32_bf16 v[248:251],a[152:155],a[48:51],v[248:251]
 ds_read_b64_tr_b16 a[148:149],v17 offset:7200
 v_mfma_f32_16x16x32_bf16 v[248:251],a[156:159],a[52:55],v[248:251]
 v_mfma_f32_16x16x32_bf16 v[252:255],a[152:155],a[56:59],v[252:255]
 ds_read_b64_tr_b16 a[150:151],v18 offset:7200
 v_mfma_f32_16x16x32_bf16 v[252:255],a[156:159],a[60:63],v[252:255]
 s_waitcnt vmcnt(24)
 s_waitcnt lgkmcnt(4)
 v_mfma_f32_16x16x32_bf16 v[32:35],a[128:131],a[64:67],v[32:35]
 ds_read_b64_tr_b16 a[152:153],v17 offset:14368
 s_add_u32 s57,s57,8192
 v_mfma_f32_16x16x32_bf16 v[32:35],a[132:135],a[68:71],v[32:35]
 buffer_load_dwordx4 a[0:3],v4,s[8:11],s57 offen offset:0 sc1
 v_mfma_f32_16x16x32_bf16 v[36:39],a[128:131],a[72:75],v[36:39]
 ds_read_b64_tr_b16 a[154:155],v18 offset:14368
 v_mfma_f32_16x16x32_bf16 v[36:39],a[132:135],a[76:79],v[36:39]
 v_mfma_f32_16x16x32_bf16 v[40:43],a[128:131],a[80:83],v[40:43]
 ds_read_b64_tr_b16 a[156:157],v17 offset:21536
 v_mfma_f32_16x16x32_bf16 v[40:43],a[132:135],a[84:87],v[40:43]
 v_mfma_f32_16x16x32_bf16 v[44:47],a[128:131],a[88:91],v[44:47]
 ds_read_b64_tr_b16 a[158:159],v18 offset:21536
 v_mfma_f32_16x16x32_bf16 v[44:47],a[132:135],a[92:95],v[44:47]
 v_mfma_f32_16x16x32_bf16 v[48:51],a[136:139],a[64:67],v[48:51]
 ds_read_b64_tr_b16 a[128:129],v17 offset:64
 v_mfma_f32_16x16x32_bf16 v[48:51],a[140:143],a[68:71],v[48:51]
 v_mfma_f32_16x16x32_bf16 v[52:55],a[136:139],a[72:75],v[52:55]
 ds_read_b64_tr_b16 a[130:131],v18 offset:64
 v_mfma_f32_16x16x32_bf16 v[52:55],a[140:143],a[76:79],v[52:55]
L_w2:
 s_cbranch_execz L_w6
 v_mfma_f32_16x16x32_bf16 v[56:59],a[136:139],a[80:83],v[56:59]
 ds_read_b64_tr_b16 a[132:133],v17 offset:7232
 v_mfma_f32_16x16x32_bf16 v[56:59],a[140:143],a[84:87],v[56:59]
 v_mfma_f32_16x16x32_bf16 v[60:63],a[136:139],a[88:91],v[60:63]
 ds_read_b64_tr_b16 a[134:135],v18 offset:7232
 v_mfma_f32_16x16x32_bf16 v[60:63],a[140:143],a[92:95],v[60:63]
 s_waitcnt lgkmcnt(4)
 v_mfma_f32_16x16x32_bf16 v[64:67],a[144:147],a[64:67],v[64:67]
 ds_read_b64_tr_b16 a[136:137],v17 offset:14400
 v_mfma_f32_16x16x32_bf16 v[64:67],a[148:151],a[68:71],v[64:67]
 v_mfma_f32_16x16x32_bf16 v[68:71],a[144:147],a[72:75],v[68:71]
 ds_read_b64_tr_b16 a[138:139],v18 offset:14400
 v_mfma_f32_16x16x32_bf16 v[68:71],a[148:151],a[76:79],v[68:71]
 v_mfma_f32_16x16x32_bf16 v[72:75],a[144:147],a[80:83],v[72:75]
 ds_read_b64_tr_b16 a[140:141],v17 offset:21568
 v_mfma_f32_16x16x32_bf16 v[72:75],a[148:151],a[84:87],v[72:75]
 v_mfma_f32_16x16x32_bf16 v[76:79],a[144:147],a[88:91],v[76:79]
 ds_read_b64_tr_b16 a[142:143],v18 offset:21568
 v_mfma_f32_16x16x32_bf16 v[76:79],a[148:151],a[92:95],v[76:79]
 v_mfma_f32_16x16x32_bf16 v[80:83],a[152:155],a[64:67],v[80:83]
 ds_read_b64_tr_b16 a[144:145],v17 offset:96
 v_mfma_f32_16x16x32_bf16 v[80:83],a[156:159],a[68:71],v[80:83]
 v_mfma_f32_16x16x32_bf16 v[84:87],a[152:155],a[72:75],v[84:87]
 ds_read_b64_tr_b16 a[146:147],v18 offset:96
 v_mfma_f32_16x16x32_bf16 v[84:87],a[156:159],a[76:79],v[84:87]
 v_mfma_f32_16x16x32_bf16 v[88:91],a[152:155],a[80:83],v[88:91]
 ds_read_b64_tr_b16 a[148:149],v17 offset:7264
 v_mfma_f32_16x16x32_bf16 v[88:91],a[156:159],a[84:87],v[88:91]
 v_mfma_f32_16x16x32_bf16 v[92:95],a[152:155],a[88:91],v[92:95]
 ds_read_b64_tr_b16 a[150:151],v18 offset:7264
 v_mfma_f32_16x16x32_bf16 v[92:95],a[156:159],a[92:95],v[92:95]
 s_waitcnt lgkmcnt(4)
 v_mfma_f32_16x16x32_bf16 v[96:99],a[128:131],a[64:67],v[96:99]
 ds_read_b64_tr_b16 a[152:153],v17 offset:14432
 v_mfma_f32_16x16x32_bf16 v[96:99],a[132:135],a[68:71],v[96:99]
 v_mfma_f32_16x16x32_bf16 v[100:103],a[128:131],a[72:75],v[100:103]
 ds_read_b64_tr_b16 a[154:155],v18 offset:14432
 v_mfma_f32_16x16x32_bf16 v[100:103],a[132:135],a[76:79],v[100:103]
 v_mfma_f32_16x16x32_bf16 v[104:107],a[128:131],a[80:83],v[104:107]
 ds_read_b64_tr_b16 a[156:157],v17 offset:21600
 v_mfma_f32_16x16x32_bf16 v[104:107],a[132:135],a[84:87],v[104:107]
 v_mfma_f32_16x16x32_bf16 v[108:111],a[128:131],a[88:91],v[108:111]
 ds_read_b64_tr_b16 a[158:159],v18 offset:21600
 v_mfma_f32_16x16x32_bf16 v[108:111],a[132:135],a[92:95],v[108:111]
 v_mfma_f32_16x16x32_bf16 v[112:115],a[136:139],a[64:67],v[112:115]
 ds_read_b64_tr_b16 a[128:129],v17 offset:128
 v_mfma_f32_16x16x32_bf16 v[112:115],a[140:143],a[68:71],v[112:115]
 v_mfma_f32_16x16x32_bf16 v[116:119],a[136:139],a[72:75],v[116:119]
 ds_read_b64_tr_b16 a[130:131],v18 offset:128
 v_mfma_f32_16x16x32_bf16 v[116:119],a[140:143],a[76:79],v[116:119]
 v_mfma_f32_16x16x32_bf16 v[120:123],a[136:139],a[80:83],v[120:123]
 ds_read_b64_tr_b16 a[132:133],v17 offset:7296
 v_mfma_f32_16x16x32_bf16 v[120:123],a[140:143],a[84:87],v[120:123]
 v_mfma_f32_16x16x32_bf16 v[124:127],a[136:139],a[88:91],v[124:127]
 ds_read_b64_tr_b16 a[134:135],v18 offset:7296
 v_mfma_f32_16x16x32_bf16 v[124:127],a[140:143],a[92:95],v[124:127]
 s_waitcnt lgkmcnt(4)
 v_mfma_f32_16x16x32_bf16 v[128:131],a[144:147],a[64:67],v[128:131]
 ds_read_b64_tr_b16 a[136:137],v17 offset:14464
 v_mfma_f32_16x16x32_bf16 v[128:131],a[148:151],a[68:71],v[128:131]
 v_mfma_f32_16x16x32_bf16 v[132:135],a[144:147],a[72:75],v[132:135]
 ds_read_b64_tr_b16 a[138:139],v18 offset:14464
 v_mfma_f32_16x16x32_bf16 v[132:135],a[148:151],a[76:79],v[132:135]
 v_mfma_f32_16x16x32_bf16 v[136:139],a[144:147],a[80:83],v[136:139]
 ds_read_b64_tr_b16 a[140:141],v17 offset:21632
 v_mfma_f32_16x16x32_bf16 v[136:139],a[148:151],a[84:87],v[136:139]
 v_mfma_f32_16x16x32_bf16 v[140:143],a[144:147],a[88:91],v[140:143]
 ds_read_b64_tr_b16 a[142:143],v18 offset:21632
 v_mfma_f32_16x16x32_bf16 v[140:143],a[148:151],a[92:95],v[140:143]
 v_mfma_f32_16x16x32_bf16 v[144:147],a[152:155],a[64:67],v[144:147]
 ds_read_b64_tr_b16 a[144:145],v17 offset:160
 v_mfma_f32_16x16x32_bf16 v[144:147],a[156:159],a[68:71],v[144:147]
 v_mfma_f32_16x16x32_bf16 v[148:151],a[152:155],a[72:75],v[148:151]
 ds_read_b64_tr_b16 a[146:147],v18 offset:160
 v_mfma_f32_16x16x32_bf16 v[148:151],a[156:159],a[76:79],v[148:151]
 v_mfma_f32_16x16x32_bf16 v[152:155],a[152:155],a[80:83],v[152:155]
 ds_read_b64_tr_b16 a[148:149],v17 offset:7328
 v_mfma_f32_16x16x32_bf16 v[152:155],a[156:159],a[84:87],v[152:155]
 v_mfma_f32_16x16x32_bf16 v[156:159],a[152:155],a[88:91],v[156:159]
 ds_read_b64_tr_b16 a[150:151],v18 offset:7328
 v_mfma_f32_16x16x32_bf16 v[156:159],a[156:159],a[92:95],v[156:159]
 s_waitcnt lgkmcnt(4)
 v_mfma_f32_16x16x32_bf16 v[160:163],a[128:131],a[64:67],v[160:163]
 ds_read_b64_tr_b16 a[152:153],v17 offset:14496
 v_mfma_f32_16x16x32_bf16 v[160:163],a[132:135],a[68:71],v[160:163]
 buffer_load_dwordx4 a[4:7],v4,s[8:11],s57 offen offset:1024 sc1
 v_mfma_f32_16x16x32_bf16 v[164:167],a[128:131],a[72:75],v[164:167]
 ds_read_b64_tr_b16 a[154:155],v18 offset:14496
 v_mfma_f32_16x16x32_bf16 v[164:167],a[132:135],a[76:79],v[164:167]
 buffer_load_dwordx4 a[8:11],v4,s[8:11],s57 offen offset:2048 sc1
 v_mfma_f32_16x16x32_bf16 v[168:171],a[128:131],a[80:83],v[168:171]
 ds_read_b64_tr_b16 a[156:157],v17 offset:21664
 v_mfma_f32_16x16x32_bf16 v[168:171],a[132:135],a[84:87],v[168:171]
 buffer_load_dwordx4 a[12:15],v4,s[8:11],s57 offen offset:3072 sc1
 v_mfma_f32_16x16x32_bf16 v[172:175],a[128:131],a[88:91],v[172:175]
 ds_read_b64_tr_b16 a[158:159],v18 offset:21664
 v_mfma_f32_16x16x32_bf16 v[172:175],a[132:135],a[92:95],v[172:175]
 v_mfma_f32_16x16x32_bf16 v[176:179],a[136:139],a[64:67],v[176:179]
 ds_read_b64_tr_b16 a[128:129],v17 offset:192
 v_mfma_f32_16x16x32_bf16 v[176:179],a[140:143],a[68:71],v[176:179]
 v_mfma_f32_16x16x32_bf16 v[180:183],a[136:139],a[72:75],v[180:183]
 ds_read_b64_tr_b16 a[130:131],v18 offset:192
 v_mfma_f32_16x16x32_bf16 v[180:183],a[140:143],a[76:79],v[180:183]
 v_mfma_f32_16x16x32_bf16 v[184:187],a[136:139],a[80:83],v[184:187]
 ds_read_b64_tr_b16 a[132:133],v17 offset:7360
 v_mfma_f32_16x16x32_bf16 v[184:187],a[140:143],a[84:87],v[184:187]
 v_mfma_f32_16x16x32_bf16 v[188:191],a[136:139],a[88:91],v[188:191]
 ds_read_b64_tr_b16 a[134:135],v18 offset:7360
 v_mfma_f32_16x16x32_bf16 v[188:191],a[140:143],a[92:95],v[188:191]
 s_waitcnt lgkmcnt(4)
 v_mfma_f32_16x16x32_bf16 v[192:195],a[144:147],a[64:67],v[192:195]
 ds_read_b64_tr_b16 a[136:137],v17 offset:14528
 v_mfma_f32_16x16x32_bf16 v[192:195],a[148:151],a[68:71],v[192:195]
 buffer_load_dwordx4 a[16:19],v5,s[8:11],s57 offen offset:0 sc1
 v_mfma_f32_16x16x32_bf16 v[196:199],a[144:147],a[72:75],v[196:199]
 ds_read_b64_tr_b16 a[138:139],v18 offset:14528
 v_mfma_f32_16x16x32_bf16 v[196:199],a[148:151],a[76:79],v[196:199]
 buffer_load_dwordx4 a[20:23],v5,s[8:11],s57 offen offset:1024 sc1
 v_mfma_f32_16x16x32_bf16 v[200:203],a[144:147],a[80:83],v[200:203]
 ds_read_b64_tr_b16 a[140:141],v17 offset:21696
 v_mfma_f32_16x16x32_bf16 v[200:203],a[148:151],a[84:87],v[200:203]
 v_mfma_f32_16x16x32_bf16 v[204:207],a[144:147],a[88:91],v[204:207]
 ds_read_b64_tr_b16 a[142:143],v18 offset:21696
 v_mfma_f32_16x16x32_bf16 v[204:207],a[148:151],a[92:95],v[204:207]
 s_waitcnt vmcnt(23)
 s_barrier
 v_mfma_f32_16x16x32_bf16 v[208:211],a[152:155],a[64:67],v[208:211]
 ds_read_b64_tr_b16 a[144:145],v17 offset:28672
 v_mfma_f32_16x16x32_bf16 v[208:211],a[156:159],a[68:71],v[208:211]
 buffer_load_dwordx4 a[24:27],v5,s[8:11],s57 offen offset:2048 sc1
 v_mfma_f32_16x16x32_bf16 v[212:215],a[152:155],a[72:75],v[212:215]
 ds_read_b64_tr_b16 a[146:147],v18 offset:28672
 v_mfma_f32_16x16x32_bf16 v[212:215],a[156:159],a[76:79],v[212:215]
 v_mfma_f32_16x16x32_bf16 v[216:219],a[152:155],a[80:83],v[216:219]
 ds_read_b64_tr_b16 a[148:149],v17 offset:35840
 v_mfma_f32_16x16x32_bf16 v[216:219],a[156:159],a[84:87],v[216:219]
 buffer_load_dwordx4 a[28:31],v5,s[8:11],s57 offen offset:3072 sc1
 v_mfma_f32_16x16x32_bf16 v[220:223],a[152:155],a[88:91],v[220:223]
 ds_read_b64_tr_b16 a[150:151],v18 offset:35840
 v_mfma_f32_16x16x32_bf16 v[220:223],a[156:159],a[92:95],v[220:223]
 s_add_u32 s58,s58,458752
 s_waitcnt lgkmcnt(4)
 v_mfma_f32_16x16x32_bf16 v[224:227],a[128:131],a[64:67],v[224:227]
 ds_read_b64_tr_b16 a[152:153],v17 offset:43008
 s_add_u32 m0,s52,0
 v_mfma_f32_16x16x32_bf16 v[224:227],a[132:135],a[68:71],v[224:227]
 buffer_load_dwordx4 v8,s[12:15],s58 offen offset:0 lds
 v_mfma_f32_16x16x32_bf16 v[228:231],a[128:131],a[72:75],v[228:231]
 ds_read_b64_tr_b16 a[154:155],v18 offset:43008
 v_mfma_f32_16x16x32_bf16 v[228:231],a[132:135],a[76:79],v[228:231]
 v_mfma_f32_16x16x32_bf16 v[232:235],a[128:131],a[80:83],v[232:235]
 ds_read_b64_tr_b16 a[156:157],v17 offset:50176
 v_mfma_f32_16x16x32_bf16 v[232:235],a[132:135],a[84:87],v[232:235]
 v_mfma_f32_16x16x32_bf16 v[236:239],a[128:131],a[88:91],v[236:239]
 ds_read_b64_tr_b16 a[158:159],v18 offset:50176
 v_mfma_f32_16x16x32_bf16 v[236:239],a[132:135],a[92:95],v[236:239]
 buffer_load_dwordx4 v9,s[12:15],s58 offen offset:1024 lds
 v_mfma_f32_16x16x32_bf16 v[240:243],a[136:139],a[64:67],v[240:243]
 ds_read_b64_tr_b16 a[128:129],v17 offset:28704
 v_mfma_f32_16x16x32_bf16 v[240:243],a[140:143],a[68:71],v[240:243]
 v_mfma_f32_16x16x32_bf16 v[244:247],a[136:139],a[72:75],v[244:247]
 ds_read_b64_tr_b16 a[130:131],v18 offset:28704
 v_mfma_f32_16x16x32_bf16 v[244:247],a[140:143],a[76:79],v[244:247]
 v_mfma_f32_16x16x32_bf16 v[248:251],a[136:139],a[80:83],v[248:251]
 ds_read_b64_tr_b16 a[132:133],v17 offset:35872
 v_mfma_f32_16x16x32_bf16 v[248:251],a[140:143],a[84:87],v[248:251]
 buffer_load_dwordx4 v10,s[12:15],s58 offen offset:2048 lds
 v_mfma_f32_16x16x32_bf16 v[252:255],a[136:139],a[88:91],v[252:255]
 ds_read_b64_tr_b16 a[134:135],v18 offset:35872
 v_mfma_f32_16x16x32_bf16 v[252:255],a[140:143],a[92:95],v[252:255]
 s_waitcnt vmcnt(20)
 s_waitcnt lgkmcnt(4)
 v_mfma_f32_16x16x32_bf16 v[32:35],a[144:147],a[96:99],v[32:35]
 ds_read_b64_tr_b16 a[136:137],v17 offset:43040
 v_mfma_f32_16x16x32_bf16 v[32:35],a[148:151],a[100:103],v[32:35]
 buffer_load_dwordx4 v11,s[12:15],s58 offen offset:3072 lds
 v_mfma_f32_16x16x32_bf16 v[36:39],a[144:147],a[104:107],v[36:39]
 ds_read_b64_tr_b16 a[138:139],v18 offset:43040
 v_mfma_f32_16x16x32_bf16 v[36:39],a[148:151],a[108:111],v[36:39]
 v_mfma_f32_16x16x32_bf16 v[40:43],a[144:147],a[112:115],v[40:43]
 ds_read_b64_tr_b16 a[140:141],v17 offset:50208
 v_mfma_f32_16x16x32_bf16 v[40:43],a[148:151],a[116:119],v[40:43]
 v_mfma_f32_16x16x32_bf16 v[44:47],a[144:147],a[120:123],v[44:47]
 ds_read_b64_tr_b16 a[142:143],v18 offset:50208
 s_add_u32 m0,s52,4096
 v_mfma_f32_16x16x32_bf16 v[44:47],a[148:151],a[124:127],v[44:47]
 buffer_load_dwordx4 v12,s[12:15],s58 offen offset:0 lds
 v_mfma_f32_16x16x32_bf16 v[48:51],a[152:155],a[96:99],v[48:51]
 ds_read_b64_tr_b16 a[144:145],v17 offset:28736
 v_mfma_f32_16x16x32_bf16 v[48:51],a[156:159],a[100:103],v[48:51]
 v_mfma_f32_16x16x32_bf16 v[52:55],a[152:155],a[104:107],v[52:55]
 ds_read_b64_tr_b16 a[146:147],v18 offset:28736
 v_mfma_f32_16x16x32_bf16 v[52:55],a[156:159],a[108:111],v[52:55]
 v_mfma_f32_16x16x32_bf16 v[56:59],a[152:155],a[112:115],v[56:59]
 ds_read_b64_tr_b16 a[148:149],v17 offset:35904
 v_mfma_f32_16x16x32_bf16 v[56:59],a[156:159],a[116:119],v[56:59]
 buffer_load_dwordx4 v13,s[12:15],s58 offen offset:1024 lds
 v_mfma_f32_16x16x32_bf16 v[60:63],a[152:155],a[120:123],v[60:63]
 ds_read_b64_tr_b16 a[150:151],v18 offset:35904
 v_mfma_f32_16x16x32_bf16 v[60:63],a[156:159],a[124:127],v[60:63]
 s_waitcnt lgkmcnt(4)
 v_mfma_f32_16x16x32_bf16 v[64:67],a[128:131],a[96:99],v[64:67]
 ds_read_b64_tr_b16 a[152:153],v17 offset:43072
 v_mfma_f32_16x16x32_bf16 v[64:67],a[132:135],a[100:103],v[64:67]
 buffer_load_dwordx4 v14,s[12:15],s58 offen offset:2048 lds
 v_mfma_f32_16x16x32_bf16 v[68:71],a[128:131],a[104:107],v[68:71]
 ds_read_b64_tr_b16 a[154:155],v18 offset:43072
 v_mfma_f32_16x16x32_bf16 v[68:71],a[132:135],a[108:111],v[68:71]
 v_mfma_f32_16x16x32_bf16 v[72:75],a[128:131],a[112:115],v[72:75]
 ds_read_b64_tr_b16 a[156:157],v17 offset:50240
 s_add_u32 s57,s57,8192
 v_mfma_f32_16x16x32_bf16 v[72:75],a[132:135],a[116:119],v[72:75]
 buffer_load_dwordx4 a[32:35],v4,s[8:11],s57 offen offset:0 sc1
 v_mfma_f32_16x16x32_bf16 v[76:79],a[128:131],a[120:123],v[76:79]
 ds_read_b64_tr_b16 a[158:159],v18 offset:50240
 v_mfma_f32_16x16x32_bf16 v[76:79],a[132:135],a[124:127],v[76:79]
 v_mfma_f32_16x16x32_bf16 v[80:83],a[136:139],a[96:99],v[80:83]
 ds_read_b64_tr_b16 a[128:129],v17 offset:28768
 v_mfma_f32_16x16x32_bf16 v[80:83],a[140:143],a[100:103],v[80:83]
 v_mfma_f32_16x16x32_bf16 v[84:87],a[136:139],a[104:107],v[84:87]
 ds_read_b64_tr_b16 a[130:131],v18 offset:28768
 v_mfma_f32_16x16x32_bf16 v[84:87],a[140:143],a[108:111],v[84:87]
 buffer_load_dwordx4 a[36:39],v4,s[8:11],s57 offen offset:1024 sc1
 v_mfma_f32_16x16x32_bf16 v[88:91],a[136:139],a[112:115],v[88:91]
 ds_read_b64_tr_b16 a[132:133],v17 offset:35936
 v_mfma_f32_16x16x32_bf16 v[88:91],a[140:143],a[116:119],v[88:91]
 v_mfma_f32_16x16x32_bf16 v[92:95],a[136:139],a[120:123],v[92:95]
 ds_read_b64_tr_b16 a[134:135],v18 offset:35936
 v_mfma_f32_16x16x32_bf16 v[92:95],a[140:143],a[124:127],v[92:95]
 s_waitcnt lgkmcnt(4)
 v_mfma_f32_16x16x32_bf16 v[96:99],a[144:147],a[96:99],v[96:99]
 ds_read_b64_tr_b16 a[136:137],v17 offset:43104
 v_mfma_f32_16x16x32_bf16 v[96:99],a[148:151],a[100:103],v[96:99]
 buffer_load_dwordx4 a[40:43],v4,s[8:11],s57 offen offset:2048 sc1
 v_mfma_f32_16x16x32_bf16 v[100:103],a[144:147],a[104:107],v[100:103]
 ds_read_b64_tr_b16 a[138:139],v18 offset:43104
 v_mfma_f32_16x16x32_bf16 v[100:103],a[148:151],a[108:111],v[100:103]
 buffer_load_dwordx4 a[44:47],v4,s[8:11],s57 offen offset:3072 sc1
 v_mfma_f32_16x16x32_bf16 v[104:107],a[144:147],a[112:115],v[104:107]
 ds_read_b64_tr_b16 a[140:141],v17 offset:50272
 v_mfma_f32_16x16x32_bf16 v[104:107],a[148:151],a[116:119],v[104:107]
 v_mfma_f32_16x16x32_bf16 v[108:111],a[144:147],a[120:123],v[108:111]
 ds_read_b64_tr_b16 a[142:143],v18 offset:50272
 s_mov_b32 s3,3670016
 v_mfma_f32_16x16x32_bf16 v[108:111],a[148:151],a[124:127],v[108:111]
 buffer_load_dword v31,v2,s[12:15],s3 offen
 v_mfma_f32_16x16x32_bf16 v[112:115],a[152:155],a[96:99],v[112:115]
 ds_read_b64_tr_b16 a[144:145],v17 offset:28800
 v_mfma_f32_16x16x32_bf16 v[112:115],a[156:159],a[100:103],v[112:115]
 v_mfma_f32_16x16x32_bf16 v[116:119],a[152:155],a[104:107],v[116:119]
 ds_read_b64_tr_b16 a[146:147],v18 offset:28800
 v_mfma_f32_16x16x32_bf16 v[116:119],a[156:159],a[108:111],v[116:119]
 v_mfma_f32_16x16x32_bf16 v[120:123],a[152:155],a[112:115],v[120:123]
 ds_read_b64_tr_b16 a[148:149],v17 offset:35968
 v_mfma_f32_16x16x32_bf16 v[120:123],a[156:159],a[116:119],v[120:123]
 buffer_load_dwordx4 a[48:51],v5,s[8:11],s57 offen offset:0 sc1
 v_mfma_f32_16x16x32_bf16 v[124:127],a[152:155],a[120:123],v[124:127]
 ds_read_b64_tr_b16 a[150:151],v18 offset:35968
 v_mfma_f32_16x16x32_bf16 v[124:127],a[156:159],a[124:127],v[124:127]
 s_waitcnt lgkmcnt(4)
 v_mfma_f32_16x16x32_bf16 v[128:131],a[128:131],a[96:99],v[128:131]
 ds_read_b64_tr_b16 a[152:153],v17 offset:43136
 v_mfma_f32_16x16x32_bf16 v[128:131],a[132:135],a[100:103],v[128:131]
 buffer_load_dwordx4 a[52:55],v5,s[8:11],s57 offen offset:1024 sc1
 v_mfma_f32_16x16x32_bf16 v[132:135],a[128:131],a[104:107],v[132:135]
 ds_read_b64_tr_b16 a[154:155],v18 offset:43136
 v_mfma_f32_16x16x32_bf16 v[132:135],a[132:135],a[108:111],v[132:135]
 v_mfma_f32_16x16x32_bf16 v[136:139],a[128:131],a[112:115],v[136:139]
 ds_read_b64_tr_b16 a[156:157],v17 offset:50304
 v_mfma_f32_16x16x32_bf16 v[136:139],a[132:135],a[116:119],v[136:139]
 v_mfma_f32_16x16x32_bf16 v[140:143],a[128:131],a[120:123],v[140:143]
 ds_read_b64_tr_b16 a[158:159],v18 offset:50304
 v_mfma_f32_16x16x32_bf16 v[140:143],a[132:135],a[124:127],v[140:143]
 buffer_load_dwordx4 a[56:59],v5,s[8:11],s57 offen offset:2048 sc1
 v_mfma_f32_16x16x32_bf16 v[144:147],a[136:139],a[96:99],v[144:147]
 ds_read_b64_tr_b16 a[128:129],v17 offset:28832
 v_mfma_f32_16x16x32_bf16 v[144:147],a[140:143],a[100:103],v[144:147]
 v_mfma_f32_16x16x32_bf16 v[148:151],a[136:139],a[104:107],v[148:151]
 ds_read_b64_tr_b16 a[130:131],v18 offset:28832
 v_mfma_f32_16x16x32_bf16 v[148:151],a[140:143],a[108:111],v[148:151]
 buffer_load_dwordx4 a[60:63],v5,s[8:11],s57 offen offset:3072 sc1
 v_mfma_f32_16x16x32_bf16 v[152:155],a[136:139],a[112:115],v[152:155]
 ds_read_b64_tr_b16 a[132:133],v17 offset:36000
 v_mfma_f32_16x16x32_bf16 v[152:155],a[140:143],a[116:119],v[152:155]
 v_mfma_f32_16x16x32_bf16 v[156:159],a[136:139],a[120:123],v[156:159]
 ds_read_b64_tr_b16 a[134:135],v18 offset:36000
 v_mfma_f32_16x16x32_bf16 v[156:159],a[140:143],a[124:127],v[156:159]
 s_add_u32 s58,s58,458752
 s_waitcnt lgkmcnt(4)
 v_mfma_f32_16x16x32_bf16 v[160:163],a[144:147],a[96:99],v[160:163]
 ds_read_b64_tr_b16 a[136:137],v17 offset:43168
 s_add_u32 m0,s52,28672
 v_mfma_f32_16x16x32_bf16 v[160:163],a[148:151],a[100:103],v[160:163]
 buffer_load_dwordx4 v8,s[12:15],s58 offen offset:0 lds
 v_mfma_f32_16x16x32_bf16 v[164:167],a[144:147],a[104:107],v[164:167]
 ds_read_b64_tr_b16 a[138:139],v18 offset:43168
 v_mfma_f32_16x16x32_bf16 v[164:167],a[148:151],a[108:111],v[164:167]
 v_mfma_f32_16x16x32_bf16 v[168:171],a[144:147],a[112:115],v[168:171]
 ds_read_b64_tr_b16 a[140:141],v17 offset:50336
 v_mfma_f32_16x16x32_bf16 v[168:171],a[148:151],a[116:119],v[168:171]
 v_mfma_f32_16x16x32_bf16 v[172:175],a[144:147],a[120:123],v[172:175]
 ds_read_b64_tr_b16 a[142:143],v18 offset:50336
 v_mfma_f32_16x16x32_bf16 v[172:175],a[148:151],a[124:127],v[172:175]
 buffer_load_dwordx4 v9,s[12:15],s58 offen offset:1024 lds
 v_mfma_f32_16x16x32_bf16 v[176:179],a[152:155],a[96:99],v[176:179]
 ds_read_b64_tr_b16 a[144:145],v17 offset:28864
 v_mfma_f32_16x16x32_bf16 v[176:179],a[156:159],a[100:103],v[176:179]
 v_mfma_f32_16x16x32_bf16 v[180:183],a[152:155],a[104:107],v[180:183]
 ds_read_b64_tr_b16 a[146:147],v18 offset:28864
 v_mfma_f32_16x16x32_bf16 v[180:183],a[156:159],a[108:111],v[180:183]
 v_mfma_f32_16x16x32_bf16 v[184:187],a[152:155],a[112:115],v[184:187]
 ds_read_b64_tr_b16 a[148:149],v17 offset:36032
 v_mfma_f32_16x16x32_bf16 v[184:187],a[156:159],a[116:119],v[184:187]
 v_mfma_f32_16x16x32_bf16 v[188:191],a[152:155],a[120:123],v[188:191]
 ds_read_b64_tr_b16 a[150:151],v18 offset:36032
 v_mfma_f32_16x16x32_bf16 v[188:191],a[156:159],a[124:127],v[188:191]
 s_waitcnt lgkmcnt(4)
 v_mfma_f32_16x16x32_bf16 v[192:195],a[128:131],a[96:99],v[192:195]
 ds_read_b64_tr_b16 a[152:153],v17 offset:43200
 v_mfma_f32_16x16x32_bf16 v[192:195],a[132:135],a[100:103],v[192:195]
 v_mfma_f32_16x16x32_bf16 v[196:199],a[128:131],a[104:107],v[196:199]
 ds_read_b64_tr_b16 a[154:155],v18 offset:43200
 v_mfma_f32_16x16x32_bf16 v[196:199],a[132:135],a[108:111],v[196:199]
 v_mfma_f32_16x16x32_bf16 v[200:203],a[128:131],a[112:115],v[200:203]
 ds_read_b64_tr_b16 a[156:157],v17 offset:50368
 v_mfma_f32_16x16x32_bf16 v[200:203],a[132:135],a[116:119],v[200:203]
 v_mfma_f32_16x16x32_bf16 v[204:207],a[128:131],a[120:123],v[204:207]
 ds_read_b64_tr_b16 a[158:159],v18 offset:50368
 v_mfma_f32_16x16x32_bf16 v[204:207],a[132:135],a[124:127],v[204:207]
 s_waitcnt vmcnt(26)
 s_barrier
 v_mfma_f32_16x16x32_bf16 v[208:211],a[136:139],a[96:99],v[208:211]
 ds_read_b64_tr_b16 a[128:129],v19 offset:0
 v_mfma_f32_16x16x32_bf16 v[208:211],a[140:143],a[100:103],v[208:211]
 v_mfma_f32_16x16x32_bf16 v[212:215],a[136:139],a[104:107],v[212:215]
 ds_read_b64_tr_b16 a[130:131],v20 offset:0
 v_mfma_f32_16x16x32_bf16 v[212:215],a[140:143],a[108:111],v[212:215]
 v_mfma_f32_16x16x32_bf16 v[216:219],a[136:139],a[112:115],v[216:219]
 ds_read_b64_tr_b16 a[132:133],v19 offset:7168
 v_mfma_f32_16x16x32_bf16 v[216:219],a[140:143],a[116:119],v[216:219]
 v_mfma_f32_16x16x32_bf16 v[220:223],a[136:139],a[120:123],v[220:223]
 ds_read_b64_tr_b16 a[134:135],v20 offset:7168
 v_mfma_f32_16x16x32_bf16 v[220:223],a[140:143],a[124:127],v[220:223]
 s_waitcnt lgkmcnt(4)
 v_mfma_f32_16x16x32_bf16 v[224:227],a[144:147],a[96:99],v[224:227]
 ds_read_b64_tr_b16 a[136:137],v19 offset:14336
 v_mfma_f32_16x16x32_bf16 v[224:227],a[148:151],a[100:103],v[224:227]
 v_mfma_f32_16x16x32_bf16 v[228:231],a[144:147],a[104:107],v[228:231]
 ds_read_b64_tr_b16 a[138:139],v20 offset:14336
 v_mfma_f32_16x16x32_bf16 v[228:231],a[148:151],a[108:111],v[228:231]
 v_mfma_f32_16x16x32_bf16 v[232:235],a[144:147],a[112:115],v[232:235]
 ds_read_b64_tr_b16 a[140:141],v19 offset:21504
 v_mfma_f32_16x16x32_bf16 v[232:235],a[148:151],a[116:119],v[232:235]
 v_mfma_f32_16x16x32_bf16 v[236:239],a[144:147],a[120:123],v[236:239]
 ds_read_b64_tr_b16 a[142:143],v20 offset:21504
 v_mfma_f32_16x16x32_bf16 v[236:239],a[148:151],a[124:127],v[236:239]
 v_mfma_f32_16x16x32_bf16 v[240:243],a[152:155],a[96:99],v[240:243]
 ds_read_b64_tr_b16 a[144:145],v19 offset:32
 v_mfma_f32_16x16x32_bf16 v[240:243],a[156:159],a[100:103],v[240:243]
 v_mfma_f32_16x16x32_bf16 v[244:247],a[152:155],a[104:107],v[244:247]
 ds_read_b64_tr_b16 a[146:147],v20 offset:32
 v_mfma_f32_16x16x32_bf16 v[244:247],a[156:159],a[108:111],v[244:247]
 v_mfma_f32_16x16x32_bf16 v[248:251],a[152:155],a[112:115],v[248:251]
 ds_read_b64_tr_b16 a[148:149],v19 offset:7200
 v_mfma_f32_16x16x32_bf16 v[248:251],a[156:159],a[116:119],v[248:251]
 v_mfma_f32_16x16x32_bf16 v[252:255],a[152:155],a[120:123],v[252:255]
 ds_read_b64_tr_b16 a[150:151],v20 offset:7200
 v_mfma_f32_16x16x32_bf16 v[252:255],a[156:159],a[124:127],v[252:255]
 s_waitcnt vmcnt(18)
 s_waitcnt lgkmcnt(4)
 v_mfma_f32_16x16x32_bf16 v[32:35],a[128:131],a[0:3],v[32:35]
 ds_read_b64_tr_b16 a[152:153],v19 offset:14368
 v_mfma_f32_16x16x32_bf16 v[32:35],a[132:135],a[4:7],v[32:35]
 v_mfma_f32_16x16x32_bf16 v[36:39],a[128:131],a[8:11],v[36:39]
 ds_read_b64_tr_b16 a[154:155],v20 offset:14368
 v_mfma_f32_16x16x32_bf16 v[36:39],a[132:135],a[12:15],v[36:39]
 v_mfma_f32_16x16x32_bf16 v[40:43],a[128:131],a[16:19],v[40:43]
 ds_read_b64_tr_b16 a[156:157],v19 offset:21536
 v_mfma_f32_16x16x32_bf16 v[40:43],a[132:135],a[20:23],v[40:43]
 v_mfma_f32_16x16x32_bf16 v[44:47],a[128:131],a[24:27],v[44:47]
 ds_read_b64_tr_b16 a[158:159],v20 offset:21536
 v_mfma_f32_16x16x32_bf16 v[44:47],a[132:135],a[28:31],v[44:47]
 v_mfma_f32_16x16x32_bf16 v[48:51],a[136:139],a[0:3],v[48:51]
 ds_read_b64_tr_b16 a[128:129],v19 offset:64
 v_mfma_f32_16x16x32_bf16 v[48:51],a[140:143],a[4:7],v[48:51]
 v_mfma_f32_16x16x32_bf16 v[52:55],a[136:139],a[8:11],v[52:55]
 ds_read_b64_tr_b16 a[130:131],v20 offset:64
 v_mfma_f32_16x16x32_bf16 v[52:55],a[140:143],a[12:15],v[52:55]
 v_mfma_f32_16x16x32_bf16 v[56:59],a[136:139],a[16:19],v[56:59]
 ds_read_b64_tr_b16 a[132:133],v19 offset:7232
 v_mfma_f32_16x16x32_bf16 v[56:59],a[140:143],a[20:23],v[56:59]
 v_mfma_f32_16x16x32_bf16 v[60:63],a[136:139],a[24:27],v[60:63]
 ds_read_b64_tr_b16 a[134:135],v20 offset:7232
 v_mfma_f32_16x16x32_bf16 v[60:63],a[140:143],a[28:31],v[60:63]
 s_waitcnt lgkmcnt(4)
 v_mfma_f32_16x16x32_bf16 v[64:67],a[144:147],a[0:3],v[64:67]
 ds_read_b64_tr_b16 a[136:137],v19 offset:14400
 v_mfma_f32_16x16x32_bf16 v[64:67],a[148:151],a[4:7],v[64:67]
 v_mfma_f32_16x16x32_bf16 v[68:71],a[144:147],a[8:11],v[68:71]
 ds_read_b64_tr_b16 a[138:139],v20 offset:14400
 v_mfma_f32_16x16x32_bf16 v[68:71],a[148:151],a[12:15],v[68:71]
 v_mfma_f32_16x16x32_bf16 v[72:75],a[144:147],a[16:19],v[72:75]
 ds_read_b64_tr_b16 a[140:141],v19 offset:21568
 v_mfma_f32_16x16x32_bf16 v[72:75],a[148:151],a[20:23],v[72:75]
 buffer_load_dwordx4 v10,s[12:15],s58 offen offset:2048 lds
 v_mfma_f32_16x16x32_bf16 v[76:79],a[144:147],a[24:27],v[76:79]
 ds_read_b64_tr_b16 a[142:143],v20 offset:21568
 v_mfma_f32_16x16x32_bf16 v[76:79],a[148:151],a[28:31],v[76:79]
 buffer_load_dwordx4 v11,s[12:15],s58 offen offset:3072 lds
 v_mfma_f32_16x16x32_bf16 v[80:83],a[152:155],a[0:3],v[80:83]
 ds_read_b64_tr_b16 a[144:145],v19 offset:96
 v_mfma_f32_16x16x32_bf16 v[80:83],a[156:159],a[4:7],v[80:83]
 v_mfma_f32_16x16x32_bf16 v[84:87],a[152:155],a[8:11],v[84:87]
 ds_read_b64_tr_b16 a[146:147],v20 offset:96
 s_add_u32 m0,s52,32768
 v_mfma_f32_16x16x32_bf16 v[84:87],a[156:159],a[12:15],v[84:87]
 buffer_load_dwordx4 v12,s[12:15],s58 offen offset:0 lds
 v_mfma_f32_16x16x32_bf16 v[88:91],a[152:155],a[16:19],v[88:91]
 ds_read_b64_tr_b16 a[148:149],v19 offset:7264
 v_mfma_f32_16x16x32_bf16 v[88:91],a[156:159],a[20:23],v[88:91]
 v_mfma_f32_16x16x32_bf16 v[92:95],a[152:155],a[24:27],v[92:95]
 ds_read_b64_tr_b16 a[150:151],v20 offset:7264
 v_mfma_f32_16x16x32_bf16 v[92:95],a[156:159],a[28:31],v[92:95]
 s_waitcnt lgkmcnt(4)
 v_mfma_f32_16x16x32_bf16 v[96:99],a[128:131],a[0:3],v[96:99]
 ds_read_b64_tr_b16 a[152:153],v19 offset:14432
 v_mfma_f32_16x16x32_bf16 v[96:99],a[132:135],a[4:7],v[96:99]
 buffer_load_dwordx4 v13,s[12:15],s58 offen offset:1024 lds
 v_mfma_f32_16x16x32_bf16 v[100:103],a[128:131],a[8:11],v[100:103]
 ds_read_b64_tr_b16 a[154:155],v20 offset:14432
 v_mfma_f32_16x16x32_bf16 v[100:103],a[132:135],a[12:15],v[100:103]
 buffer_load_dwordx4 v14,s[12:15],s58 offen offset:2048 lds
 v_mfma_f32_16x16x32_bf16 v[104:107],a[128:131],a[16:19],v[104:107]
 ds_read_b64_tr_b16 a[156:157],v19 offset:21600
 v_mfma_f32_16x16x32_bf16 v[104:107],a[132:135],a[20:23],v[104:107]
 v_mfma_f32_16x16x32_bf16 v[108:111],a[128:131],a[24:27],v[108:111]
 ds_read_b64_tr_b16 a[158:159],v20 offset:21600
 v_mfma_f32_16x16x32_bf16 v[108:111],a[132:135],a[28:31],v[108:111]
 v_mfma_f32_16x16x32_bf16 v[112:115],a[136:139],a[0:3],v[112:115]
 ds_read_b64_tr_b16 a[128:129],v19 offset:128
 s_add_u32 s57,s57,8192
 v_mfma_f32_16x16x32_bf16 v[112:115],a[140:143],a[4:7],v[112:115]
 buffer_load_dwordx4 a[64:67],v4,s[8:11],s57 offen offset:0 sc1
 v_mfma_f32_16x16x32_bf16 v[116:119],a[136:139],a[8:11],v[116:119]
 ds_read_b64_tr_b16 a[130:131],v20 offset:128
 v_mfma_f32_16x16x32_bf16 v[116:119],a[140:143],a[12:15],v[116:119]
 v_mfma_f32_16x16x32_bf16 v[120:123],a[136:139],a[16:19],v[120:123]
 ds_read_b64_tr_b16 a[132:133],v19 offset:7296
 v_mfma_f32_16x16x32_bf16 v[120:123],a[140:143],a[20:23],v[120:123]
 buffer_load_dwordx4 a[68:71],v4,s[8:11],s57 offen offset:1024 sc1
 v_mfma_f32_16x16x32_bf16 v[124:127],a[136:139],a[24:27],v[124:127]
 ds_read_b64_tr_b16 a[134:135],v20 offset:7296
 v_mfma_f32_16x16x32_bf16 v[124:127],a[140:143],a[28:31],v[124:127]
 s_waitcnt lgkmcnt(4)
 v_mfma_f32_16x16x32_bf16 v[128:131],a[144:147],a[0:3],v[128:131]
 ds_read_b64_tr_b16 a[136:137],v19 offset:14464
 v_mfma_f32_16x16x32_bf16 v[128:131],a[148:151],a[4:7],v[128:131]
 v_mfma_f32_16x16x32_bf16 v[132:135],a[144:147],a[8:11],v[132:135]
 ds_read_b64_tr_b16 a[138:139],v20 offset:14464
 v_mfma_f32_16x16x32_bf16 v[132:135],a[148:151],a[12:15],v[132:135]
 buffer_load_dwordx4 a[72:75],v4,s[8:11],s57 offen offset:2048 sc1
 v_mfma_f32_16x16x32_bf16 v[136:139],a[144:147],a[16:19],v[136:139]
 ds_read_b64_tr_b16 a[140:141],v19 offset:21632
 v_mfma_f32_16x16x32_bf16 v[136:139],a[148:151],a[20:23],v[136:139]
 v_mfma_f32_16x16x32_bf16 v[140:143],a[144:147],a[24:27],v[140:143]
 ds_read_b64_tr_b16 a[142:143],v20 offset:21632
 v_mfma_f32_16x16x32_bf16 v[140:143],a[148:151],a[28:31],v[140:143]
 buffer_load_dwordx4 a[76:79],v4,s[8:11],s57 offen offset:3072 sc1
 v_mfma_f32_16x16x32_bf16 v[144:147],a[152:155],a[0:3],v[144:147]
 ds_read_b64_tr_b16 a[144:145],v19 offset:160
 v_mfma_f32_16x16x32_bf16 v[144:147],a[156:159],a[4:7],v[144:147]
 v_mfma_f32_16x16x32_bf16 v[148:151],a[152:155],a[8:11],v[148:151]
 ds_read_b64_tr_b16 a[146:147],v20 offset:160
 v_mfma_f32_16x16x32_bf16 v[148:151],a[156:159],a[12:15],v[148:151]
 buffer_load_dwordx4 a[80:83],v5,s[8:11],s57 offen offset:0 sc1
 v_mfma_f32_16x16x32_bf16 v[152:155],a[152:155],a[16:19],v[152:155]
 ds_read_b64_tr_b16 a[148:149],v19 offset:7328
 v_mfma_f32_16x16x32_bf16 v[152:155],a[156:159],a[20:23],v[152:155]
 v_mfma_f32_16x16x32_bf16 v[156:159],a[152:155],a[24:27],v[156:159]
 ds_read_b64_tr_b16 a[150:151],v20 offset:7328
 v_mfma_f32_16x16x32_bf16 v[156:159],a[156:159],a[28:31],v[156:159]
 s_waitcnt lgkmcnt(4)
 v_mfma_f32_16x16x32_bf16 v[160:163],a[128:131],a[0:3],v[160:163]
 ds_read_b64_tr_b16 a[152:153],v19 offset:14496
 v_mfma_f32_16x16x32_bf16 v[160:163],a[132:135],a[4:7],v[160:163]
 buffer_load_dwordx4 a[84:87],v5,s[8:11],s57 offen offset:1024 sc1
 v_mfma_f32_16x16x32_bf16 v[164:167],a[128:131],a[8:11],v[164:167]
 ds_read_b64_tr_b16 a[154:155],v20 offset:14496
 v_mfma_f32_16x16x32_bf16 v[164:167],a[132:135],a[12:15],v[164:167]
 v_mfma_f32_16x16x32_bf16 v[168:171],a[128:131],a[16:19],v[168:171]
 ds_read_b64_tr_b16 a[156:157],v19 offset:21664
 v_mfma_f32_16x16x32_bf16 v[168:171],a[132:135],a[20:23],v[168:171]
 buffer_load_dwordx4 a[88:91],v5,s[8:11],s57 offen offset:2048 sc1
 v_mfma_f32_16x16x32_bf16 v[172:175],a[128:131],a[24:27],v[172:175]
 ds_read_b64_tr_b16 a[158:159],v20 offset:21664
 v_mfma_f32_16x16x32_bf16 v[172:175],a[132:135],a[28:31],v[172:175]
 v_mfma_f32_16x16x32_bf16 v[176:179],a[136:139],a[0:3],v[176:179]
 ds_read_b64_tr_b16 a[128:129],v19 offset:192
 v_mfma_f32_16x16x32_bf16 v[176:179],a[140:143],a[4:7],v[176:179]
 buffer_load_dwordx4 a[92:95],v5,s[8:11],s57 offen offset:3072 sc1
 v_mfma_f32_16x16x32_bf16 v[180:183],a[136:139],a[8:11],v[180:183]
 ds_read_b64_tr_b16 a[130:131],v20 offset:192
 v_mfma_f32_16x16x32_bf16 v[180:183],a[140:143],a[12:15],v[180:183]
 v_mfma_f32_16x16x32_bf16 v[184:187],a[136:139],a[16:19],v[184:187]
 ds_read_b64_tr_b16 a[132:133],v19 offset:7360
 v_mfma_f32_16x16x32_bf16 v[184:187],a[140:143],a[20:23],v[184:187]
 v_mfma_f32_16x16x32_bf16 v[188:191],a[136:139],a[24:27],v[188:191]
 ds_read_b64_tr_b16 a[134:135],v20 offset:7360
 v_mfma_f32_16x16x32_bf16 v[188:191],a[140:143],a[28:31],v[188:191]
 s_add_u32 s58,s58,458752
 s_waitcnt lgkmcnt(4)
 v_mfma_f32_16x16x32_bf16 v[192:195],a[144:147],a[0:3],v[192:195]
 ds_read_b64_tr_b16 a[136:137],v19 offset:14528
 s_add_u32 m0,s52,57344
 v_mfma_f32_16x16x32_bf16 v[192:195],a[148:151],a[4:7],v[192:195]
 buffer_load_dwordx4 v8,s[12:15],s58 offen offset:0 lds
 v_mfma_f32_16x16x32_bf16 v[196:199],a[144:147],a[8:11],v[196:199]
 ds_read_b64_tr_b16 a[138:139],v20 offset:14528
 v_mfma_f32_16x16x32_bf16 v[196:199],a[148:151],a[12:15],v[196:199]
 v_mfma_f32_16x16x32_bf16 v[200:203],a[144:147],a[16:19],v[200:203]
 ds_read_b64_tr_b16 a[140:141],v19 offset:21696
 v_mfma_f32_16x16x32_bf16 v[200:203],a[148:151],a[20:23],v[200:203]
 buffer_load_dwordx4 v9,s[12:15],s58 offen offset:1024 lds
 v_mfma_f32_16x16x32_bf16 v[204:207],a[144:147],a[24:27],v[204:207]
L_w3:
 s_cbranch_execz L_w7
 ds_read_b64_tr_b16 a[142:143],v20 offset:21696
 v_mfma_f32_16x16x32_bf16 v[204:207],a[148:151],a[28:31],v[204:207]
 s_waitcnt vmcnt(26)
 s_barrier
 v_mfma_f32_16x16x32_bf16 v[208:211],a[152:155],a[0:3],v[208:211]
 ds_read_b64_tr_b16 a[144:145],v15 offset:0
 v_mfma_f32_16x16x32_bf16 v[208:211],a[156:159],a[4:7],v[208:211]
 buffer_load_dwordx4 v10,s[12:15],s58 offen offset:2048 lds
 v_mfma_f32_16x16x32_bf16 v[212:215],a[152:155],a[8:11],v[212:215]
 ds_read_b64_tr_b16 a[146:147],v16 offset:0
 v_mfma_f32_16x16x32_bf16 v[212:215],a[156:159],a[12:15],v[212:215]
 v_mfma_f32_16x16x32_bf16 v[216:219],a[152:155],a[16:19],v[216:219]
 ds_read_b64_tr_b16 a[148:149],v15 offset:7168
 v_mfma_f32_16x16x32_bf16 v[216:219],a[156:159],a[20:23],v[216:219]
 v_mfma_f32_16x16x32_bf16 v[220:223],a[152:155],a[24:27],v[220:223]
 ds_read_b64_tr_b16 a[150:151],v16 offset:7168
 v_mfma_f32_16x16x32_bf16 v[220:223],a[156:159],a[28:31],v[220:223]
 s_waitcnt lgkmcnt(4)
 v_mfma_f32_16x16x32_bf16 v[224:227],a[128:131],a[0:3],v[224:227]
 ds_read_b64_tr_b16 a[152:153],v15 offset:14336
 v_mfma_f32_16x16x32_bf16 v[224:227],a[132:135],a[4:7],v[224:227]
 buffer_load_dwordx4 v11,s[12:15],s58 offen offset:3072 lds
 v_mfma_f32_16x16x32_bf16 v[228:231],a[128:131],a[8:11],v[228:231]
 ds_read_b64_tr_b16 a[154:155],v16 offset:14336
 s_add_u32 m0,s52,61440
 v_mfma_f32_16x16x32_bf16 v[228:231],a[132:135],a[12:15],v[228:231]
 buffer_load_dwordx4 v12,s[12:15],s58 offen offset:0 lds
 v_mfma_f32_16x16x32_bf16 v[232:235],a[128:131],a[16:19],v[232:235]
 ds_read_b64_tr_b16 a[156:157],v15 offset:21504
 v_mfma_f32_16x16x32_bf16 v[232:235],a[132:135],a[20:23],v[232:235]
 v_mfma_f32_16x16x32_bf16 v[236:239],a[128:131],a[24:27],v[236:239]
 ds_read_b64_tr_b16 a[158:159],v16 offset:21504
 v_mfma_f32_16x16x32_bf16 v[236:239],a[132:135],a[28:31],v[236:239]
 buffer_load_dwordx4 v13,s[12:15],s58 offen offset:1024 lds
 v_mfma_f32_16x16x32_bf16 v[240:243],a[136:139],a[0:3],v[240:243]
 ds_read_b64_tr_b16 a[128:129],v15 offset:32
 v_mfma_f32_16x16x32_bf16 v[240:243],a[140:143],a[4:7],v[240:243]
 v_mfma_f32_16x16x32_bf16 v[244:247],a[136:139],a[8:11],v[244:247]
 ds_read_b64_tr_b16 a[130:131],v16 offset:32
 v_mfma_f32_16x16x32_bf16 v[244:247],a[140:143],a[12:15],v[244:247]
 v_mfma_f32_16x16x32_bf16 v[248:251],a[136:139],a[16:19],v[248:251]
 ds_read_b64_tr_b16 a[132:133],v15 offset:7200
 v_mfma_f32_16x16x32_bf16 v[248:251],a[140:143],a[20:23],v[248:251]
 buffer_load_dwordx4 v14,s[12:15],s58 offen offset:2048 lds
 v_mfma_f32_16x16x32_bf16 v[252:255],a[136:139],a[24:27],v[252:255]
 ds_read_b64_tr_b16 a[134:135],v16 offset:7200
 v_mfma_f32_16x16x32_bf16 v[252:255],a[140:143],a[28:31],v[252:255]
 s_waitcnt vmcnt(22)
 s_waitcnt lgkmcnt(4)
 v_mfma_f32_16x16x32_bf16 v[32:35],a[144:147],a[32:35],v[32:35]
 ds_read_b64_tr_b16 a[136:137],v15 offset:14368
 s_add_u32 s57,s57,8192
 v_mfma_f32_16x16x32_bf16 v[32:35],a[148:151],a[36:39],v[32:35]
 buffer_load_dwordx4 a[96:99],v4,s[8:11],s57 offen offset:0 sc1
 v_mfma_f32_16x16x32_bf16 v[36:39],a[144:147],a[40:43],v[36:39]
 ds_read_b64_tr_b16 a[138:139],v16 offset:14368
 s_mov_b32 s3,4587520
 v_mfma_f32_16x16x32_bf16 v[36:39],a[148:151],a[44:47],v[36:39]
 buffer_load_dword v31,v2,s[12:15],s3 offen
 v_mfma_f32_16x16x32_bf16 v[40:43],a[144:147],a[48:51],v[40:43]
 ds_read_b64_tr_b16 a[140:141],v15 offset:21536
 s_mov_b32 s3,0
 v_mfma_f32_16x16x32_bf16 v[40:43],a[148:151],a[52:55],v[40:43]
 buffer_load_dword v31,v25,s[20:23],s3 offen
 v_mfma_f32_16x16x32_bf16 v[44:47],a[144:147],a[56:59],v[44:47]
 ds_read_b64_tr_b16 a[142:143],v16 offset:21536
 s_mov_b32 s3,0
 v_mfma_f32_16x16x32_bf16 v[44:47],a[148:151],a[60:63],v[44:47]
 buffer_load_dword v31,v25,s[24:27],s3 offen
 v_mfma_f32_16x16x32_bf16 v[48:51],a[152:155],a[32:35],v[48:51]
 ds_read_b64_tr_b16 a[144:145],v15 offset:64
 s_getpc_b64 s[6:7]
L_cb3:
 v_mfma_f32_16x16x32_bf16 v[48:51],a[156:159],a[36:39],v[48:51]
 global_load_dword v31,v28,s[6:7]
 v_mfma_f32_16x16x32_bf16 v[52:55],a[152:155],a[40:43],v[52:55]
 ds_read_b64_tr_b16 a[146:147],v16 offset:64
 v_mfma_f32_16x16x32_bf16 v[52:55],a[156:159],a[44:47],v[52:55]
 v_mfma_f32_16x16x32_bf16 v[56:59],a[152:155],a[48:51],v[56:59]
 ds_read_b64_tr_b16 a[148:149],v15 offset:7232
 v_mfma_f32_16x16x32_bf16 v[56:59],a[156:159],a[52:55],v[56:59]
 v_mfma_f32_16x16x32_bf16 v[60:63],a[152:155],a[56:59],v[60:63]
 ds_read_b64_tr_b16 a[150:151],v16 offset:7232
 v_mfma_f32_16x16x32_bf16 v[60:63],a[156:159],a[60:63],v[60:63]
 s_waitcnt lgkmcnt(4)
 v_mfma_f32_16x16x32_bf16 v[64:67],a[128:131],a[32:35],v[64:67]
 ds_read_b64_tr_b16 a[152:153],v15 offset:14400
 v_mfma_f32_16x16x32_bf16 v[64:67],a[132:135],a[36:39],v[64:67]
 buffer_load_dwordx4 a[100:103],v4,s[8:11],s57 offen offset:1024 sc1
 v_mfma_f32_16x16x32_bf16 v[68:71],a[128:131],a[40:43],v[68:71]
 ds_read_b64_tr_b16 a[154:155],v16 offset:14400
 v_mfma_f32_16x16x32_bf16 v[68:71],a[132:135],a[44:47],v[68:71]
 buffer_load_dwordx4 a[104:107],v4,s[8:11],s57 offen offset:2048 sc1
 v_mfma_f32_16x16x32_bf16 v[72:75],a[128:131],a[48:51],v[72:75]
 ds_read_b64_tr_b16 a[156:157],v15 offset:21568
 v_mfma_f32_16x16x32_bf16 v[72:75],a[132:135],a[52:55],v[72:75]
 v_mfma_f32_16x16x32_bf16 v[76:79],a[128:131],a[56:59],v[76:79]
 ds_read_b64_tr_b16 a[158:159],v16 offset:21568
 v_mfma_f32_16x16x32_bf16 v[76:79],a[132:135],a[60:63],v[76:79]
 v_mfma_f32_16x16x32_bf16 v[80:83],a[136:139],a[32:35],v[80:83]
 ds_read_b64_tr_b16 a[128:129],v15 offset:96
 v_mfma_f32_16x16x32_bf16 v[80:83],a[140:143],a[36:39],v[80:83]
 buffer_load_dwordx4 a[108:111],v4,s[8:11],s57 offen offset:3072 sc1
 v_mfma_f32_16x16x32_bf16 v[84:87],a[136:139],a[40:43],v[84:87]
 ds_read_b64_tr_b16 a[130:131],v16 offset:96
 v_mfma_f32_16x16x32_bf16 v[84:87],a[140:143],a[44:47],v[84:87]
 v_mfma_f32_16x16x32_bf16 v[88:91],a[136:139],a[48:51],v[88:91]
 ds_read_b64_tr_b16 a[132:133],v15 offset:7264
 v_mfma_f32_16x16x32_bf16 v[88:91],a[140:143],a[52:55],v[88:91]
 buffer_load_dwordx4 a[112:115],v5,s[8:11],s57 offen offset:0 sc1
 v_mfma_f32_16x16x32_bf16 v[92:95],a[136:139],a[56:59],v[92:95]
 ds_read_b64_tr_b16 a[134:135],v16 offset:7264
 v_mfma_f32_16x16x32_bf16 v[92:95],a[140:143],a[60:63],v[92:95]
 s_waitcnt lgkmcnt(4)
 v_mfma_f32_16x16x32_bf16 v[96:99],a[144:147],a[32:35],v[96:99]
 ds_read_b64_tr_b16 a[136:137],v15 offset:14432
 v_mfma_f32_16x16x32_bf16 v[96:99],a[148:151],a[36:39],v[96:99]
 v_mfma_f32_16x16x32_bf16 v[100:103],a[144:147],a[40:43],v[100:103]
 ds_read_b64_tr_b16 a[138:139],v16 offset:14432
 v_mfma_f32_16x16x32_bf16 v[100:103],a[148:151],a[44:47],v[100:103]
 v_mfma_f32_16x16x32_bf16 v[104:107],a[144:147],a[48:51],v[104:107]
 ds_read_b64_tr_b16 a[140:141],v15 offset:21600
 v_mfma_f32_16x16x32_bf16 v[104:107],a[148:151],a[52:55],v[104:107]
 v_mfma_f32_16x16x32_bf16 v[108:111],a[144:147],a[56:59],v[108:111]
 ds_read_b64_tr_b16 a[142:143],v16 offset:21600
 v_mfma_f32_16x16x32_bf16 v[108:111],a[148:151],a[60:63],v[108:111]
 v_mfma_f32_16x16x32_bf16 v[112:115],a[152:155],a[32:35],v[112:115]
 ds_read_b64_tr_b16 a[144:145],v15 offset:128
 v_mfma_f32_16x16x32_bf16 v[112:115],a[156:159],a[36:39],v[112:115]
 v_mfma_f32_16x16x32_bf16 v[116:119],a[152:155],a[40:43],v[116:119]
 ds_read_b64_tr_b16 a[146:147],v16 offset:128
 v_mfma_f32_16x16x32_bf16 v[116:119],a[156:159],a[44:47],v[116:119]
 v_mfma_f32_16x16x32_bf16 v[120:123],a[152:155],a[48:51],v[120:123]
 ds_read_b64_tr_b16 a[148:149],v15 offset:7296
 v_mfma_f32_16x16x32_bf16 v[120:123],a[156:159],a[52:55],v[120:123]
 v_mfma_f32_16x16x32_bf16 v[124:127],a[152:155],a[56:59],v[124:127]
 ds_read_b64_tr_b16 a[150:151],v16 offset:7296
 v_mfma_f32_16x16x32_bf16 v[124:127],a[156:159],a[60:63],v[124:127]
 s_waitcnt lgkmcnt(4)
 v_mfma_f32_16x16x32_bf16 v[128:131],a[128:131],a[32:35],v[128:131]
 ds_read_b64_tr_b16 a[152:153],v15 offset:14464
 v_mfma_f32_16x16x32_bf16 v[128:131],a[132:135],a[36:39],v[128:131]
 v_mfma_f32_16x16x32_bf16 v[132:135],a[128:131],a[40:43],v[132:135]
 ds_read_b64_tr_b16 a[154:155],v16 offset:14464
 v_mfma_f32_16x16x32_bf16 v[132:135],a[132:135],a[44:47],v[132:135]
 v_mfma_f32_16x16x32_bf16 v[136:139],a[128:131],a[48:51],v[136:139]
 ds_read_b64_tr_b16 a[156:157],v15 offset:21632
 v_mfma_f32_16x16x32_bf16 v[136:139],a[132:135],a[52:55],v[136:139]
 v_mfma_f32_16x16x32_bf16 v[140:143],a[128:131],a[56:59],v[140:143]
 ds_read_b64_tr_b16 a[158:159],v16 offset:21632
 v_mfma_f32_16x16x32_bf16 v[140:143],a[132:135],a[60:63],v[140:143]
 v_mfma_f32_16x16x32_bf16 v[144:147],a[136:139],a[32:35],v[144:147]
 ds_read_b64_tr_b16 a[128:129],v15 offset:160
 v_mfma_f32_16x16x32_bf16 v[144:147],a[140:143],a[36:39],v[144:147]
 v_mfma_f32_16x16x32_bf16 v[148:151],a[136:139],a[40:43],v[148:151]
 ds_read_b64_tr_b16 a[130:131],v16 offset:160
 v_mfma_f32_16x16x32_bf16 v[148:151],a[140:143],a[44:47],v[148:151]
 v_mfma_f32_16x16x32_bf16 v[152:155],a[136:139],a[48:51],v[152:155]
 ds_read_b64_tr_b16 a[132:133],v15 offset:7328
 v_mfma_f32_16x16x32_bf16 v[152:155],a[140:143],a[52:55],v[152:155]
 v_mfma_f32_16x16x32_bf16 v[156:159],a[136:139],a[56:59],v[156:159]
 ds_read_b64_tr_b16 a[134:135],v16 offset:7328
 v_mfma_f32_16x16x32_bf16 v[156:159],a[140:143],a[60:63],v[156:159]
 s_waitcnt lgkmcnt(4)
 v_mfma_f32_16x16x32_bf16 v[160:163],a[144:147],a[32:35],v[160:163]
 ds_read_b64_tr_b16 a[136:137],v15 offset:14496
 v_mfma_f32_16x16x32_bf16 v[160:163],a[148:151],a[36:39],v[160:163]
 v_mfma_f32_16x16x32_bf16 v[164:167],a[144:147],a[40:43],v[164:167]
 ds_read_b64_tr_b16 a[138:139],v16 offset:14496
 v_mfma_f32_16x16x32_bf16 v[164:167],a[148:151],a[44:47],v[164:167]
 v_mfma_f32_16x16x32_bf16 v[168:171],a[144:147],a[48:51],v[168:171]
 ds_read_b64_tr_b16 a[140:141],v15 offset:21664
 v_mfma_f32_16x16x32_bf16 v[168:171],a[148:151],a[52:55],v[168:171]
 v_mfma_f32_16x16x32_bf16 v[172:175],a[144:147],a[56:59],v[172:175]
 ds_read_b64_tr_b16 a[142:143],v16 offset:21664
 v_mfma_f32_16x16x32_bf16 v[172:175],a[148:151],a[60:63],v[172:175]
 v_mfma_f32_16x16x32_bf16 v[176:179],a[152:155],a[32:35],v[176:179]
 ds_read_b64_tr_b16 a[144:145],v15 offset:192
 v_mfma_f32_16x16x32_bf16 v[176:179],a[156:159],a[36:39],v[176:179]
 v_mfma_f32_16x16x32_bf16 v[180:183],a[152:155],a[40:43],v[180:183]
 ds_read_b64_tr_b16 a[146:147],v16 offset:192
 v_mfma_f32_16x16x32_bf16 v[180:183],a[156:159],a[44:47],v[180:183]
 v_mfma_f32_16x16x32_bf16 v[184:187],a[152:155],a[48:51],v[184:187]
 ds_read_b64_tr_b16 a[148:149],v15 offset:7360
 v_mfma_f32_16x16x32_bf16 v[184:187],a[156:159],a[52:55],v[184:187]
 v_mfma_f32_16x16x32_bf16 v[188:191],a[152:155],a[56:59],v[188:191]
 ds_read_b64_tr_b16 a[150:151],v16 offset:7360
 v_mfma_f32_16x16x32_bf16 v[188:191],a[156:159],a[60:63],v[188:191]
 s_waitcnt lgkmcnt(4)
 v_mfma_f32_16x16x32_bf16 v[192:195],a[128:131],a[32:35],v[192:195]
 ds_read_b64_tr_b16 a[152:153],v15 offset:14528
 v_mfma_f32_16x16x32_bf16 v[192:195],a[132:135],a[36:39],v[192:195]
 v_mfma_f32_16x16x32_bf16 v[196:199],a[128:131],a[40:43],v[196:199]
 ds_read_b64_tr_b16 a[154:155],v16 offset:14528
 v_mfma_f32_16x16x32_bf16 v[196:199],a[132:135],a[44:47],v[196:199]
 v_mfma_f32_16x16x32_bf16 v[200:203],a[128:131],a[48:51],v[200:203]
 ds_read_b64_tr_b16 a[156:157],v15 offset:21696
 v_mfma_f32_16x16x32_bf16 v[200:203],a[132:135],a[52:55],v[200:203]
 v_mfma_f32_16x16x32_bf16 v[204:207],a[128:131],a[56:59],v[204:207]
 ds_read_b64_tr_b16 a[158:159],v16 offset:21696
 v_mfma_f32_16x16x32_bf16 v[204:207],a[132:135],a[60:63],v[204:207]
 s_waitcnt vmcnt(24)
 s_barrier
 v_mfma_f32_16x16x32_bf16 v[208:211],a[136:139],a[32:35],v[208:211]
 ds_read_b64_tr_b16 a[128:129],v15 offset:28672
 v_mfma_f32_16x16x32_bf16 v[208:211],a[140:143],a[36:39],v[208:211]
 v_mfma_f32_16x16x32_bf16 v[212:215],a[136:139],a[40:43],v[212:215]
 ds_read_b64_tr_b16 a[130:131],v16 offset:28672
 v_mfma_f32_16x16x32_bf16 v[212:215],a[140:143],a[44:47],v[212:215]
 v_mfma_f32_16x16x32_bf16 v[216:219],a[136:139],a[48:51],v[216:219]
 ds_read_b64_tr_b16 a[132:133],v15 offset:35840
 v_mfma_f32_16x16x32_bf16 v[216:219],a[140:143],a[52:55],v[216:219]
 v_mfma_f32_16x16x32_bf16 v[220:223],a[136:139],a[56:59],v[220:223]
 ds_read_b64_tr_b16 a[134:135],v16 offset:35840
 v_mfma_f32_16x16x32_bf16 v[220:223],a[140:143],a[60:63],v[220:223]
 s_waitcnt lgkmcnt(4)
 v_mfma_f32_16x16x32_bf16 v[224:227],a[144:147],a[32:35],v[224:227]
 ds_read_b64_tr_b16 a[136:137],v15 offset:43008
 v_mfma_f32_16x16x32_bf16 v[224:227],a[148:151],a[36:39],v[224:227]
 buffer_load_dwordx4 a[116:119],v5,s[8:11],s57 offen offset:1024 sc1
 v_mfma_f32_16x16x32_bf16 v[228:231],a[144:147],a[40:43],v[228:231]
 ds_read_b64_tr_b16 a[138:139],v16 offset:43008
 v_mfma_f32_16x16x32_bf16 v[228:231],a[148:151],a[44:47],v[228:231]
 buffer_load_dwordx4 a[120:123],v5,s[8:11],s57 offen offset:2048 sc1
 v_mfma_f32_16x16x32_bf16 v[232:235],a[144:147],a[48:51],v[232:235]
 ds_read_b64_tr_b16 a[140:141],v15 offset:50176
 s_add_u32 s58,s58,458752
 v_mfma_f32_16x16x32_bf16 v[232:235],a[148:151],a[52:55],v[232:235]
 buffer_load_dwordx4 a[124:127],v5,s[8:11],s57 offen offset:3072 sc1
 v_mfma_f32_16x16x32_bf16 v[236:239],a[144:147],a[56:59],v[236:239]
 ds_read_b64_tr_b16 a[142:143],v16 offset:50176
 s_add_u32 m0,s52,86016
 v_mfma_f32_16x16x32_bf16 v[236:239],a[148:151],a[60:63],v[236:239]
 buffer_load_dwordx4 v8,s[12:15],s58 offen offset:0 lds
 v_mfma_f32_16x16x32_bf16 v[240:243],a[152:155],a[32:35],v[240:243]
 ds_read_b64_tr_b16 a[144:145],v15 offset:28704
 v_mfma_f32_16x16x32_bf16 v[240:243],a[156:159],a[36:39],v[240:243]
 v_mfma_f32_16x16x32_bf16 v[244:247],a[152:155],a[40:43],v[244:247]
 ds_read_b64_tr_b16 a[146:147],v16 offset:28704
 v_mfma_f32_16x16x32_bf16 v[244:247],a[156:159],a[44:47],v[244:247]
 v_mfma_f32_16x16x32_bf16 v[248:251],a[152:155],a[48:51],v[248:251]
 ds_read_b64_tr_b16 a[148:149],v15 offset:35872
 v_mfma_f32_16x16x32_bf16 v[248:251],a[156:159],a[52:55],v[248:251]
 v_mfma_f32_16x16x32_bf16 v[252:255],a[152:155],a[56:59],v[252:255]
 ds_read_b64_tr_b16 a[150:151],v16 offset:35872
 v_mfma_f32_16x16x32_bf16 v[252:255],a[156:159],a[60:63],v[252:255]
 s_waitcnt vmcnt(20)
 s_waitcnt lgkmcnt(4)
 v_mfma_f32_16x16x32_bf16 v[32:35],a[128:131],a[64:67],v[32:35]
 ds_read_b64_tr_b16 a[152:153],v15 offset:43040
 v_mfma_f32_16x16x32_bf16 v[32:35],a[132:135],a[68:71],v[32:35]
 buffer_load_dwordx4 v9,s[12:15],s58 offen offset:1024 lds
 v_mfma_f32_16x16x32_bf16 v[36:39],a[128:131],a[72:75],v[36:39]
 ds_read_b64_tr_b16 a[154:155],v16 offset:43040
 v_mfma_f32_16x16x32_bf16 v[36:39],a[132:135],a[76:79],v[36:39]
 buffer_load_dwordx4 v10,s[12:15],s58 offen offset:2048 lds
 v_mfma_f32_16x16x32_bf16 v[40:43],a[128:131],a[80:83],v[40:43]
 ds_read_b64_tr_b16 a[156:157],v15 offset:50208
 v_mfma_f32_16x16x32_bf16 v[40:43],a[132:135],a[84:87],v[40:43]
 v_mfma_f32_16x16x32_bf16 v[44:47],a[128:131],a[88:91],v[44:47]
 ds_read_b64_tr_b16 a[158:159],v16 offset:50208
 v_mfma_f32_16x16x32_bf16 v[44:47],a[132:135],a[92:95],v[44:47]
 buffer_load_dwordx4 v11,s[12:15],s58 offen offset:3072 lds
 v_mfma_f32_16x16x32_bf16 v[48:51],a[136:139],a[64:67],v[48:51]
 ds_read_b64_tr_b16 a[128:129],v15 offset:28736
 v_mfma_f32_16x16x32_bf16 v[48:51],a[140:143],a[68:71],v[48:51]
 v_mfma_f32_16x16x32_bf16 v[52:55],a[136:139],a[72:75],v[52:55]
 ds_read_b64_tr_b16 a[130:131],v16 offset:28736
 v_mfma_f32_16x16x32_bf16 v[52:55],a[140:143],a[76:79],v[52:55]
 v_mfma_f32_16x16x32_bf16 v[56:59],a[136:139],a[80:83],v[56:59]
 ds_read_b64_tr_b16 a[132:133],v15 offset:35904
 s_add_u32 m0,s52,90112
 v_mfma_f32_16x16x32_bf16 v[56:59],a[140:143],a[84:87],v[56:59]
 buffer_load_dwordx4 v12,s[12:15],s58 offen offset:0 lds
 v_mfma_f32_16x16x32_bf16 v[60:63],a[136:139],a[88:91],v[60:63]
 ds_read_b64_tr_b16 a[134:135],v16 offset:35904
 v_mfma_f32_16x16x32_bf16 v[60:63],a[140:143],a[92:95],v[60:63]
 s_waitcnt lgkmcnt(4)
 v_mfma_f32_16x16x32_bf16 v[64:67],a[144:147],a[64:67],v[64:67]
 ds_read_b64_tr_b16 a[136:137],v15 offset:43072
 v_mfma_f32_16x16x32_bf16 v[64:67],a[148:151],a[68:71],v[64:67]
 v_mfma_f32_16x16x32_bf16 v[68:71],a[144:147],a[72:75],v[68:71]
 ds_read_b64_tr_b16 a[138:139],v16 offset:43072
 v_mfma_f32_16x16x32_bf16 v[68:71],a[148:151],a[76:79],v[68:71]
 v_mfma_f32_16x16x32_bf16 v[72:75],a[144:147],a[80:83],v[72:75]
 ds_read_b64_tr_b16 a[140:141],v15 offset:50240
 v_mfma_f32_16x16x32_bf16 v[72:75],a[148:151],a[84:87],v[72:75]
 v_mfma_f32_16x16x32_bf16 v[76:79],a[144:147],a[88:91],v[76:79]
 ds_read_b64_tr_b16 a[142:143],v16 offset:50240
 v_mfma_f32_16x16x32_bf16 v[76:79],a[148:151],a[92:95],v[76:79]
 buffer_load_dwordx4 v13,s[12:15],s58 offen offset:1024 lds
 v_mfma_f32_16x16x32_bf16 v[80:83],a[152:155],a[64:67],v[80:83]
 ds_read_b64_tr_b16 a[144:145],v15 offset:28768
 v_mfma_f32_16x16x32_bf16 v[80:83],a[156:159],a[68:71],v[80:83]
 v_mfma_f32_16x16x32_bf16 v[84:87],a[152:155],a[72:75],v[84:87]
 ds_read_b64_tr_b16 a[146:147],v16 offset:28768
 v_mfma_f32_16x16x32_bf16 v[84:87],a[156:159],a[76:79],v[84:87]
 v_mfma_f32_16x16x32_bf16 v[88:91],a[152:155],a[80:83],v[88:91]
 ds_read_b64_tr_b16 a[148:149],v15 offset:35936
 v_mfma_f32_16x16x32_bf16 v[88:91],a[156:159],a[84:87],v[88:91]
 buffer_load_dwordx4 v14,s[12:15],s58 offen offset:2048 lds
 v_mfma_f32_16x16x32_bf16 v[92:95],a[152:155],a[88:91],v[92:95]
 ds_read_b64_tr_b16 a[150:151],v16 offset:35936
 v_mfma_f32_16x16x32_bf16 v[92:95],a[156:159],a[92:95],v[92:95]
 s_waitcnt lgkmcnt(4)
 v_mfma_f32_16x16x32_bf16 v[96:99],a[128:131],a[64:67],v[96:99]
 ds_read_b64_tr_b16 a[152:153],v15 offset:43104
 s_add_u32 s57,s57,8192
 v_mfma_f32_16x16x32_bf16 v[96:99],a[132:135],a[68:71],v[96:99]
 buffer_load_dwordx4 a[0:3],v4,s[8:11],s57 offen offset:0 sc1
 v_mfma_f32_16x16x32_bf16 v[100:103],a[128:131],a[72:75],v[100:103]
 ds_read_b64_tr_b16 a[154:155],v16 offset:43104
 v_mfma_f32_16x16x32_bf16 v[100:103],a[132:135],a[76:79],v[100:103]
 v_mfma_f32_16x16x32_bf16 v[104:107],a[128:131],a[80:83],v[104:107]
 ds_read_b64_tr_b16 a[156:157],v15 offset:50272
 v_mfma_f32_16x16x32_bf16 v[104:107],a[132:135],a[84:87],v[104:107]
 buffer_load_dwordx4 a[4:7],v4,s[8:11],s57 offen offset:1024 sc1
 v_mfma_f32_16x16x32_bf16 v[108:111],a[128:131],a[88:91],v[108:111]
 ds_read_b64_tr_b16 a[158:159],v16 offset:50272
 v_mfma_f32_16x16x32_bf16 v[108:111],a[132:135],a[92:95],v[108:111]
 v_mfma_f32_16x16x32_bf16 v[112:115],a[136:139],a[64:67],v[112:115]
 ds_read_b64_tr_b16 a[128:129],v15 offset:28800
 v_mfma_f32_16x16x32_bf16 v[112:115],a[140:143],a[68:71],v[112:115]
 v_mfma_f32_16x16x32_bf16 v[116:119],a[136:139],a[72:75],v[116:119]
 ds_read_b64_tr_b16 a[130:131],v16 offset:28800
 v_mfma_f32_16x16x32_bf16 v[116:119],a[140:143],a[76:79],v[116:119]
 buffer_load_dwordx4 a[8:11],v4,s[8:11],s57 offen offset:2048 sc1
 v_mfma_f32_16x16x32_bf16 v[120:123],a[136:139],a[80:83],v[120:123]
 ds_read_b64_tr_b16 a[132:133],v15 offset:35968
 v_mfma_f32_16x16x32_bf16 v[120:123],a[140:143],a[84:87],v[120:123]
 v_mfma_f32_16x16x32_bf16 v[124:127],a[136:139],a[88:91],v[124:127]
 ds_read_b64_tr_b16 a[134:135],v16 offset:35968
 v_mfma_f32_16x16x32_bf16 v[124:127],a[140:143],a[92:95],v[124:127]
 s_waitcnt lgkmcnt(4)
 v_mfma_f32_16x16x32_bf16 v[128:131],a[144:147],a[64:67],v[128:131]
 ds_read_b64_tr_b16 a[136:137],v15 offset:43136
 v_mfma_f32_16x16x32_bf16 v[128:131],a[148:151],a[68:71],v[128:131]
 buffer_load_dwordx4 a[12:15],v4,s[8:11],s57 offen offset:3072 sc1
 v_mfma_f32_16x16x32_bf16 v[132:135],a[144:147],a[72:75],v[132:135]
 ds_read_b64_tr_b16 a[138:139],v16 offset:43136
 v_mfma_f32_16x16x32_bf16 v[132:135],a[148:151],a[76:79],v[132:135]
 buffer_load_dwordx4 a[16:19],v5,s[8:11],s57 offen offset:0 sc1
 v_mfma_f32_16x16x32_bf16 v[136:139],a[144:147],a[80:83],v[136:139]
 ds_read_b64_tr_b16 a[140:141],v15 offset:50304
 v_mfma_f32_16x16x32_bf16 v[136:139],a[148:151],a[84:87],v[136:139]
 v_mfma_f32_16x16x32_bf16 v[140:143],a[144:147],a[88:91],v[140:143]
 ds_read_b64_tr_b16 a[142:143],v16 offset:50304
 v_mfma_f32_16x16x32_bf16 v[140:143],a[148:151],a[92:95],v[140:143]
 v_mfma_f32_16x16x32_bf16 v[144:147],a[152:155],a[64:67],v[144:147]
 ds_read_b64_tr_b16 a[144:145],v15 offset:28832
 v_mfma_f32_16x16x32_bf16 v[144:147],a[156:159],a[68:71],v[144:147]
 buffer_load_dwordx4 a[20:23],v5,s[8:11],s57 offen offset:1024 sc1
 v_mfma_f32_16x16x32_bf16 v[148:151],a[152:155],a[72:75],v[148:151]
 ds_read_b64_tr_b16 a[146:147],v16 offset:28832
 v_mfma_f32_16x16x32_bf16 v[148:151],a[156:159],a[76:79],v[148:151]
 v_mfma_f32_16x16x32_bf16 v[152:155],a[152:155],a[80:83],v[152:155]
 ds_read_b64_tr_b16 a[148:149],v15 offset:36000
 v_mfma_f32_16x16x32_bf16 v[152:155],a[156:159],a[84:87],v[152:155]
 buffer_load_dwordx4 a[24:27],v5,s[8:11],s57 offen offset:2048 sc1
 v_mfma_f32_16x16x32_bf16 v[156:159],a[152:155],a[88:91],v[156:159]
 ds_read_b64_tr_b16 a[150:151],v16 offset:36000
 v_mfma_f32_16x16x32_bf16 v[156:159],a[156:159],a[92:95],v[156:159]
 s_waitcnt lgkmcnt(4)
 v_mfma_f32_16x16x32_bf16 v[160:163],a[128:131],a[64:67],v[160:163]
 ds_read_b64_tr_b16 a[152:153],v15 offset:43168
 v_mfma_f32_16x16x32_bf16 v[160:163],a[132:135],a[68:71],v[160:163]
 v_mfma_f32_16x16x32_bf16 v[164:167],a[128:131],a[72:75],v[164:167]
 ds_read_b64_tr_b16 a[154:155],v16 offset:43168
 v_mfma_f32_16x16x32_bf16 v[164:167],a[132:135],a[76:79],v[164:167]
 buffer_load_dwordx4 a[28:31],v5,s[8:11],s57 offen offset:3072 sc1
 v_mfma_f32_16x16x32_bf16 v[168:171],a[128:131],a[80:83],v[168:171]
 ds_read_b64_tr_b16 a[156:157],v15 offset:50336
 v_mfma_f32_16x16x32_bf16 v[168:171],a[132:135],a[84:87],v[168:171]
 v_mfma_f32_16x16x32_bf16 v[172:175],a[128:131],a[88:91],v[172:175]
 ds_read_b64_tr_b16 a[158:159],v16 offset:50336
 s_mov_b32 s3,5505024
 v_mfma_f32_16x16x32_bf16 v[172:175],a[132:135],a[92:95],v[172:175]
 buffer_load_dword v31,v2,s[12:15],s3 offen
 v_mfma_f32_16x16x32_bf16 v[176:179],a[136:139],a[64:67],v[176:179]
 ds_read_b64_tr_b16 a[128:129],v15 offset:28864
 s_mov_b32 s3,6291456
 v_mfma_f32_16x16x32_bf16 v[176:179],a[140:143],a[68:71],v[176:179]
 buffer_load_dword v31,v3,s[16:19],s3 offen
 v_mfma_f32_16x16x32_bf16 v[180:183],a[136:139],a[72:75],v[180:183]
 ds_read_b64_tr_b16 a[130:131],v16 offset:28864
 s_mov_b32 s3,7340032
 v_mfma_f32_16x16x32_bf16 v[180:183],a[140:143],a[76:79],v[180:183]
 buffer_load_dword v31,v3,s[16:19],s3 offen
 v_mfma_f32_16x16x32_bf16 v[184:187],a[136:139],a[80:83],v[184:187]
 ds_read_b64_tr_b16 a[132:133],v15 offset:36032
 s_mov_b32 s3,16384
 v_mfma_f32_16x16x32_bf16 v[184:187],a[140:143],a[84:87],v[184:187]
 buffer_load_dword v31,v25,s[20:23],s3 offen
 v_mfma_f32_16x16x32_bf16 v[188:191],a[136:139],a[88:91],v[188:191]
 ds_read_b64_tr_b16 a[134:135],v16 offset:36032
 v_mfma_f32_16x16x32_bf16 v[188:191],a[140:143],a[92:95],v[188:191]
 s_waitcnt lgkmcnt(4)
 v_mfma_f32_16x16x32_bf16 v[192:195],a[144:147],a[64:67],v[192:195]
 ds_read_b64_tr_b16 a[136:137],v15 offset:43200
 s_mov_b32 s3,16384
 v_mfma_f32_16x16x32_bf16 v[192:195],a[148:151],a[68:71],v[192:195]
 buffer_load_dword v31,v25,s[24:27],s3 offen
 v_mfma_f32_16x16x32_bf16 v[196:199],a[144:147],a[72:75],v[196:199]
 ds_read_b64_tr_b16 a[138:139],v16 offset:43200
 v_mfma_f32_16x16x32_bf16 v[196:199],a[148:151],a[76:79],v[196:199]
 v_mfma_f32_16x16x32_bf16 v[200:203],a[144:147],a[80:83],v[200:203]
 ds_read_b64_tr_b16 a[140:141],v15 offset:50368
 v_mfma_f32_16x16x32_bf16 v[200:203],a[148:151],a[84:87],v[200:203]
 v_mfma_f32_16x16x32_bf16 v[204:207],a[144:147],a[88:91],v[204:207]
 ds_read_b64_tr_b16 a[142:143],v16 offset:50368
 s_add_u32 s58,s58,458752
 v_mfma_f32_16x16x32_bf16 v[204:207],a[148:151],a[92:95],v[204:207]
 s_waitcnt vmcnt(32)
 s_barrier
 v_mfma_f32_16x16x32_bf16 v[208:211],a[152:155],a[64:67],v[208:211]
 ds_read_b64_tr_b16 a[144:145],v17 offset:0
 s_add_u32 m0,s52,114688
 v_mfma_f32_16x16x32_bf16 v[208:211],a[156:159],a[68:71],v[208:211]
 buffer_load_dwordx4 v8,s[12:15],s58 offen offset:0 lds
 v_mfma_f32_16x16x32_bf16 v[212:215],a[152:155],a[72:75],v[212:215]
 ds_read_b64_tr_b16 a[146:147],v18 offset:0
 v_mfma_f32_16x16x32_bf16 v[212:215],a[156:159],a[76:79],v[212:215]
 buffer_load_dwordx4 v9,s[12:15],s58 offen offset:1024 lds
 v_mfma_f32_16x16x32_bf16 v[216:219],a[152:155],a[80:83],v[216:219]
 ds_read_b64_tr_b16 a[148:149],v17 offset:7168
 v_mfma_f32_16x16x32_bf16 v[216:219],a[156:159],a[84:87],v[216:219]
 v_mfma_f32_16x16x32_bf16 v[220:223],a[152:155],a[88:91],v[220:223]
 ds_read_b64_tr_b16 a[150:151],v18 offset:7168
 v_mfma_f32_16x16x32_bf16 v[220:223],a[156:159],a[92:95],v[220:223]
 s_waitcnt lgkmcnt(4)
 v_mfma_f32_16x16x32_bf16 v[224:227],a[128:131],a[64:67],v[224:227]
 ds_read_b64_tr_b16 a[152:153],v17 offset:14336
 v_mfma_f32_16x16x32_bf16 v[224:227],a[132:135],a[68:71],v[224:227]
 v_mfma_f32_16x16x32_bf16 v[228:231],a[128:131],a[72:75],v[228:231]
 ds_read_b64_tr_b16 a[154:155],v18 offset:14336
 v_mfma_f32_16x16x32_bf16 v[228:231],a[132:135],a[76:79],v[228:231]
 v_mfma_f32_16x16x32_bf16 v[232:235],a[128:131],a[80:83],v[232:235]
 ds_read_b64_tr_b16 a[156:157],v17 offset:21504
 v_mfma_f32_16x16x32_bf16 v[232:235],a[132:135],a[84:87],v[232:235]
 v_mfma_f32_16x16x32_bf16 v[236:239],a[128:131],a[88:91],v[236:239]
 ds_read_b64_tr_b16 a[158:159],v18 offset:21504
 v_mfma_f32_16x16x32_bf16 v[236:239],a[132:135],a[92:95],v[236:239]
 v_mfma_f32_16x16x32_bf16 v[240:243],a[136:139],a[64:67],v[240:243]
 ds_read_b64_tr_b16 a[128:129],v17 offset:32
 v_mfma_f32_16x16x32_bf16 v[240:243],a[140:143],a[68:71],v[240:243]
 v_mfma_f32_16x16x32_bf16 v[244:247],a[136:139],a[72:75],v[244:247]
 ds_read_b64_tr_b16 a[130:131],v18 offset:32
 v_mfma_f32_16x16x32_bf16 v[244:247],a[140:143],a[76:79],v[244:247]
 v_mfma_f32_16x16x32_bf16 v[248:251],a[136:139],a[80:83],v[248:251]
 ds_read_b64_tr_b16 a[132:133],v17 offset:7200
 v_mfma_f32_16x16x32_bf16 v[248:251],a[140:143],a[84:87],v[248:251]
 v_mfma_f32_16x16x32_bf16 v[252:255],a[136:139],a[88:91],v[252:255]
 ds_read_b64_tr_b16 a[134:135],v18 offset:7200
 v_mfma_f32_16x16x32_bf16 v[252:255],a[140:143],a[92:95],v[252:255]
 s_waitcnt vmcnt(22)
 s_waitcnt lgkmcnt(4)
 v_mfma_f32_16x16x32_bf16 v[32:35],a[144:147],a[96:99],v[32:35]
 ds_read_b64_tr_b16 a[136:137],v17 offset:14368
 v_mfma_f32_16x16x32_bf16 v[32:35],a[148:151],a[100:103],v[32:35]
 v_mfma_f32_16x16x32_bf16 v[36:39],a[144:147],a[104:107],v[36:39]
 ds_read_b64_tr_b16 a[138:139],v18 offset:14368
 v_mfma_f32_16x16x32_bf16 v[36:39],a[148:151],a[108:111],v[36:39]
 v_mfma_f32_16x16x32_bf16 v[40:43],a[144:147],a[112:115],v[40:43]
 ds_read_b64_tr_b16 a[140:141],v17 offset:21536
 v_mfma_f32_16x16x32_bf16 v[40:43],a[148:151],a[116:119],v[40:43]
 v_mfma_f32_16x16x32_bf16 v[44:47],a[144:147],a[120:123],v[44:47]
 ds_read_b64_tr_b16 a[142:143],v18 offset:21536
 v_mfma_f32_16x16x32_bf16 v[44:47],a[148:151],a[124:127],v[44:47]
 v_mfma_f32_16x16x32_bf16 v[48:51],a[152:155],a[96:99],v[48:51]
 ds_read_b64_tr_b16 a[144:145],v17 offset:64
 v_mfma_f32_16x16x32_bf16 v[48:51],a[156:159],a[100:103],v[48:51]
 v_mfma_f32_16x16x32_bf16 v[52:55],a[152:155],a[104:107],v[52:55]
 ds_read_b64_tr_b16 a[146:147],v18 offset:64
 v_mfma_f32_16x16x32_bf16 v[52:55],a[156:159],a[108:111],v[52:55]
 v_mfma_f32_16x16x32_bf16 v[56:59],a[152:155],a[112:115],v[56:59]
 ds_read_b64_tr_b16 a[148:149],v17 offset:7232
 v_mfma_f32_16x16x32_bf16 v[56:59],a[156:159],a[116:119],v[56:59]
 v_mfma_f32_16x16x32_bf16 v[60:63],a[152:155],a[120:123],v[60:63]
 ds_read_b64_tr_b16 a[150:151],v18 offset:7232
 v_mfma_f32_16x16x32_bf16 v[60:63],a[156:159],a[124:127],v[60:63]
 s_waitcnt lgkmcnt(4)
 v_mfma_f32_16x16x32_bf16 v[64:67],a[128:131],a[96:99],v[64:67]
 ds_read_b64_tr_b16 a[152:153],v17 offset:14400
 v_mfma_f32_16x16x32_bf16 v[64:67],a[132:135],a[100:103],v[64:67]
 v_mfma_f32_16x16x32_bf16 v[68:71],a[128:131],a[104:107],v[68:71]
 ds_read_b64_tr_b16 a[154:155],v18 offset:14400
 v_mfma_f32_16x16x32_bf16 v[68:71],a[132:135],a[108:111],v[68:71]
 v_mfma_f32_16x16x32_bf16 v[72:75],a[128:131],a[112:115],v[72:75]
 ds_read_b64_tr_b16 a[156:157],v17 offset:21568
 v_mfma_f32_16x16x32_bf16 v[72:75],a[132:135],a[116:119],v[72:75]
 v_mfma_f32_16x16x32_bf16 v[76:79],a[128:131],a[120:123],v[76:79]
 ds_read_b64_tr_b16 a[158:159],v18 offset:21568
 v_mfma_f32_16x16x32_bf16 v[76:79],a[132:135],a[124:127],v[76:79]
 v_mfma_f32_16x16x32_bf16 v[80:83],a[136:139],a[96:99],v[80:83]
 ds_read_b64_tr_b16 a[128:129],v17 offset:96
 v_mfma_f32_16x16x32_bf16 v[80:83],a[140:143],a[100:103],v[80:83]
 v_mfma_f32_16x16x32_bf16 v[84:87],a[136:139],a[104:107],v[84:87]
 ds_read_b64_tr_b16 a[130:131],v18 offset:96
 v_mfma_f32_16x16x32_bf16 v[84:87],a[140:143],a[108:111],v[84:87]
 v_mfma_f32_16x16x32_bf16 v[88:91],a[136:139],a[112:115],v[88:91]
 ds_read_b64_tr_b16 a[132:133],v17 offset:7264
 v_mfma_f32_16x16x32_bf16 v[88:91],a[140:143],a[116:119],v[88:91]
 v_mfma_f32_16x16x32_bf16 v[92:95],a[136:139],a[120:123],v[92:95]
 ds_read_b64_tr_b16 a[134:135],v18 offset:7264
 v_mfma_f32_16x16x32_bf16 v[92:95],a[140:143],a[124:127],v[92:95]
 s_waitcnt lgkmcnt(4)
 v_mfma_f32_16x16x32_bf16 v[96:99],a[144:147],a[96:99],v[96:99]
 ds_read_b64_tr_b16 a[136:137],v17 offset:14432
 v_mfma_f32_16x16x32_bf16 v[96:99],a[148:151],a[100:103],v[96:99]
 v_mfma_f32_16x16x32_bf16 v[100:103],a[144:147],a[104:107],v[100:103]
 ds_read_b64_tr_b16 a[138:139],v18 offset:14432
 v_mfma_f32_16x16x32_bf16 v[100:103],a[148:151],a[108:111],v[100:103]
 v_mfma_f32_16x16x32_bf16 v[104:107],a[144:147],a[112:115],v[104:107]
 ds_read_b64_tr_b16 a[140:141],v17 offset:21600
 v_mfma_f32_16x16x32_bf16 v[104:107],a[148:151],a[116:119],v[104:107]
 v_mfma_f32_16x16x32_bf16 v[108:111],a[144:147],a[120:123],v[108:111]
 ds_read_b64_tr_b16 a[142:143],v18 offset:21600
 v_mfma_f32_16x16x32_bf16 v[108:111],a[148:151],a[124:127],v[108:111]
 v_mfma_f32_16x16x32_bf16 v[112:115],a[152:155],a[96:99],v[112:115]
 ds_read_b64_tr_b16 a[144:145],v17 offset:128
 v_mfma_f32_16x16x32_bf16 v[112:115],a[156:159],a[100:103],v[112:115]
 v_mfma_f32_16x16x32_bf16 v[116:119],a[152:155],a[104:107],v[116:119]
 ds_read_b64_tr_b16 a[146:147],v18 offset:128
 v_mfma_f32_16x16x32_bf16 v[116:119],a[156:159],a[108:111],v[116:119]
 buffer_load_dwordx4 v10,s[12:15],s58 offen offset:2048 lds
 v_mfma_f32_16x16x32_bf16 v[120:123],a[152:155],a[112:115],v[120:123]
 ds_read_b64_tr_b16 a[148:149],v17 offset:7296
 v_mfma_f32_16x16x32_bf16 v[120:123],a[156:159],a[116:119],v[120:123]
L_w4:
 s_cbranch_execz L_w8
 buffer_load_dwordx4 v11,s[12:15],s58 offen offset:3072 lds
 v_mfma_f32_16x16x32_bf16 v[124:127],a[152:155],a[120:123],v[124:127]
 ds_read_b64_tr_b16 a[150:151],v18 offset:7296
 v_mfma_f32_16x16x32_bf16 v[124:127],a[156:159],a[124:127],v[124:127]
 s_waitcnt lgkmcnt(4)
 v_mfma_f32_16x16x32_bf16 v[128:131],a[128:131],a[96:99],v[128:131]
 ds_read_b64_tr_b16 a[152:153],v17 offset:14464
 s_add_u32 m0,s52,118784
 v_mfma_f32_16x16x32_bf16 v[128:131],a[132:135],a[100:103],v[128:131]
 buffer_load_dwordx4 v12,s[12:15],s58 offen offset:0 lds
 v_mfma_f32_16x16x32_bf16 v[132:135],a[128:131],a[104:107],v[132:135]
 ds_read_b64_tr_b16 a[154:155],v18 offset:14464
 v_mfma_f32_16x16x32_bf16 v[132:135],a[132:135],a[108:111],v[132:135]
 v_mfma_f32_16x16x32_bf16 v[136:139],a[128:131],a[112:115],v[136:139]
 ds_read_b64_tr_b16 a[156:157],v17 offset:21632
 v_mfma_f32_16x16x32_bf16 v[136:139],a[132:135],a[116:119],v[136:139]
 v_mfma_f32_16x16x32_bf16 v[140:143],a[128:131],a[120:123],v[140:143]
 ds_read_b64_tr_b16 a[158:159],v18 offset:21632
 v_mfma_f32_16x16x32_bf16 v[140:143],a[132:135],a[124:127],v[140:143]
 buffer_load_dwordx4 v13,s[12:15],s58 offen offset:1024 lds
 v_mfma_f32_16x16x32_bf16 v[144:147],a[136:139],a[96:99],v[144:147]
 ds_read_b64_tr_b16 a[128:129],v17 offset:160
 v_mfma_f32_16x16x32_bf16 v[144:147],a[140:143],a[100:103],v[144:147]
 v_mfma_f32_16x16x32_bf16 v[148:151],a[136:139],a[104:107],v[148:151]
 ds_read_b64_tr_b16 a[130:131],v18 offset:160
 v_mfma_f32_16x16x32_bf16 v[148:151],a[140:143],a[108:111],v[148:151]
 buffer_load_dwordx4 v14,s[12:15],s58 offen offset:2048 lds
 v_mfma_f32_16x16x32_bf16 v[152:155],a[136:139],a[112:115],v[152:155]
 ds_read_b64_tr_b16 a[132:133],v17 offset:7328
 v_mfma_f32_16x16x32_bf16 v[152:155],a[140:143],a[116:119],v[152:155]
 v_mfma_f32_16x16x32_bf16 v[156:159],a[136:139],a[120:123],v[156:159]
 ds_read_b64_tr_b16 a[134:135],v18 offset:7328
 v_mfma_f32_16x16x32_bf16 v[156:159],a[140:143],a[124:127],v[156:159]
 s_waitcnt lgkmcnt(4)
 v_mfma_f32_16x16x32_bf16 v[160:163],a[144:147],a[96:99],v[160:163]
 ds_read_b64_tr_b16 a[136:137],v17 offset:14496
 s_add_u32 s57,s57,8192
 v_mfma_f32_16x16x32_bf16 v[160:163],a[148:151],a[100:103],v[160:163]
 buffer_load_dwordx4 a[32:35],v4,s[8:11],s57 offen offset:0 sc1
 v_mfma_f32_16x16x32_bf16 v[164:167],a[144:147],a[104:107],v[164:167]
 ds_read_b64_tr_b16 a[138:139],v18 offset:14496
 v_mfma_f32_16x16x32_bf16 v[164:167],a[148:151],a[108:111],v[164:167]
 v_mfma_f32_16x16x32_bf16 v[168:171],a[144:147],a[112:115],v[168:171]
 ds_read_b64_tr_b16 a[140:141],v17 offset:21664
 v_mfma_f32_16x16x32_bf16 v[168:171],a[148:151],a[116:119],v[168:171]
 buffer_load_dwordx4 a[36:39],v4,s[8:11],s57 offen offset:1024 sc1
 v_mfma_f32_16x16x32_bf16 v[172:175],a[144:147],a[120:123],v[172:175]
 ds_read_b64_tr_b16 a[142:143],v18 offset:21664
 v_mfma_f32_16x16x32_bf16 v[172:175],a[148:151],a[124:127],v[172:175]
 v_mfma_f32_16x16x32_bf16 v[176:179],a[152:155],a[96:99],v[176:179]
 ds_read_b64_tr_b16 a[144:145],v17 offset:192
 v_mfma_f32_16x16x32_bf16 v[176:179],a[156:159],a[100:103],v[176:179]
 buffer_load_dwordx4 a[40:43],v4,s[8:11],s57 offen offset:2048 sc1
 v_mfma_f32_16x16x32_bf16 v[180:183],a[152:155],a[104:107],v[180:183]
 ds_read_b64_tr_b16 a[146:147],v18 offset:192
 v_mfma_f32_16x16x32_bf16 v[180:183],a[156:159],a[108:111],v[180:183]
 v_mfma_f32_16x16x32_bf16 v[184:187],a[152:155],a[112:115],v[184:187]
 ds_read_b64_tr_b16 a[148:149],v17 offset:7360
 v_mfma_f32_16x16x32_bf16 v[184:187],a[156:159],a[116:119],v[184:187]
 buffer_load_dwordx4 a[44:47],v4,s[8:11],s57 offen offset:3072 sc1
 v_mfma_f32_16x16x32_bf16 v[188:191],a[152:155],a[120:123],v[188:191]
 ds_read_b64_tr_b16 a[150:151],v18 offset:7360
 v_mfma_f32_16x16x32_bf16 v[188:191],a[156:159],a[124:127],v[188:191]
 s_waitcnt lgkmcnt(4)
 v_mfma_f32_16x16x32_bf16 v[192:195],a[128:131],a[96:99],v[192:195]
 ds_read_b64_tr_b16 a[152:153],v17 offset:14528
 v_mfma_f32_16x16x32_bf16 v[192:195],a[132:135],a[100:103],v[192:195]
 v_mfma_f32_16x16x32_bf16 v[196:199],a[128:131],a[104:107],v[196:199]
 ds_read_b64_tr_b16 a[154:155],v18 offset:14528
 v_mfma_f32_16x16x32_bf16 v[196:199],a[132:135],a[108:111],v[196:199]
 buffer_load_dwordx4 a[48:51],v5,s[8:11],s57 offen offset:0 sc1
 v_mfma_f32_16x16x32_bf16 v[200:203],a[128:131],a[112:115],v[200:203]
 ds_read_b64_tr_b16 a[156:157],v17 offset:21696
 v_mfma_f32_16x16x32_bf16 v[200:203],a[132:135],a[116:119],v[200:203]
 v_mfma_f32_16x16x32_bf16 v[204:207],a[128:131],a[120:123],v[204:207]
 ds_read_b64_tr_b16 a[158:159],v18 offset:21696
 v_mfma_f32_16x16x32_bf16 v[204:207],a[132:135],a[124:127],v[204:207]
 s_waitcnt vmcnt(25)
 s_barrier
 v_mfma_f32_16x16x32_bf16 v[208:211],a[136:139],a[96:99],v[208:211]
 ds_read_b64_tr_b16 a[128:129],v17 offset:28672
 v_mfma_f32_16x16x32_bf16 v[208:211],a[140:143],a[100:103],v[208:211]
 buffer_load_dwordx4 a[52:55],v5,s[8:11],s57 offen offset:1024 sc1
 v_mfma_f32_16x16x32_bf16 v[212:215],a[136:139],a[104:107],v[212:215]
 ds_read_b64_tr_b16 a[130:131],v18 offset:28672
 v_mfma_f32_16x16x32_bf16 v[212:215],a[140:143],a[108:111],v[212:215]
 v_mfma_f32_16x16x32_bf16 v[216:219],a[136:139],a[112:115],v[216:219]
 ds_read_b64_tr_b16 a[132:133],v17 offset:35840
 v_mfma_f32_16x16x32_bf16 v[216:219],a[140:143],a[116:119],v[216:219]
 buffer_load_dwordx4 a[56:59],v5,s[8:11],s57 offen offset:2048 sc1
 v_mfma_f32_16x16x32_bf16 v[220:223],a[136:139],a[120:123],v[220:223]
 ds_read_b64_tr_b16 a[134:135],v18 offset:35840
 v_mfma_f32_16x16x32_bf16 v[220:223],a[140:143],a[124:127],v[220:223]
 s_waitcnt lgkmcnt(4)
 v_mfma_f32_16x16x32_bf16 v[224:227],a[144:147],a[96:99],v[224:227]
 ds_read_b64_tr_b16 a[136:137],v17 offset:43008
 v_mfma_f32_16x16x32_bf16 v[224:227],a[148:151],a[100:103],v[224:227]
 buffer_load_dwordx4 a[60:63],v5,s[8:11],s57 offen offset:3072 sc1
 v_mfma_f32_16x16x32_bf16 v[228:231],a[144:147],a[104:107],v[228:231]
 ds_read_b64_tr_b16 a[138:139],v18 offset:43008
 v_mfma_f32_16x16x32_bf16 v[228:231],a[148:151],a[108:111],v[228:231]
 v_mfma_f32_16x16x32_bf16 v[232:235],a[144:147],a[112:115],v[232:235]
 ds_read_b64_tr_b16 a[140:141],v17 offset:50176
 v_mfma_f32_16x16x32_bf16 v[232:235],a[148:151],a[116:119],v[232:235]
 s_add_u32 s58,s58,458752
 v_mfma_f32_16x16x32_bf16 v[236:239],a[144:147],a[120:123],v[236:239]
 ds_read_b64_tr_b16 a[142:143],v18 offset:50176
 s_add_u32 m0,s52,0
 v_mfma_f32_16x16x32_bf16 v[236:239],a[148:151],a[124:127],v[236:239]
 buffer_load_dwordx4 v8,s[12:15],s58 offen offset:0 lds
 v_mfma_f32_16x16x32_bf16 v[240:243],a[152:155],a[96:99],v[240:243]
 ds_read_b64_tr_b16 a[144:145],v17 offset:28704
 v_mfma_f32_16x16x32_bf16 v[240:243],a[156:159],a[100:103],v[240:243]
 v_mfma_f32_16x16x32_bf16 v[244:247],a[152:155],a[104:107],v[244:247]
 ds_read_b64_tr_b16 a[146:147],v18 offset:28704
 v_mfma_f32_16x16x32_bf16 v[244:247],a[156:159],a[108:111],v[244:247]
 v_mfma_f32_16x16x32_bf16 v[248:251],a[152:155],a[112:115],v[248:251]
 ds_read_b64_tr_b16 a[148:149],v17 offset:35872
 v_mfma_f32_16x16x32_bf16 v[248:251],a[156:159],a[116:119],v[248:251]
 buffer_load_dwordx4 v9,s[12:15],s58 offen offset:1024 lds
 v_mfma_f32_16x16x32_bf16 v[252:255],a[152:155],a[120:123],v[252:255]
 ds_read_b64_tr_b16 a[150:151],v18 offset:35872
 v_mfma_f32_16x16x32_bf16 v[252:255],a[156:159],a[124:127],v[252:255]
 s_waitcnt vmcnt(22)
 s_waitcnt lgkmcnt(4)
 v_mfma_f32_16x16x32_bf16 v[32:35],a[128:131],a[0:3],v[32:35]
 ds_read_b64_tr_b16 a[152:153],v17 offset:43040
 v_mfma_f32_16x16x32_bf16 v[32:35],a[132:135],a[4:7],v[32:35]
 buffer_load_dwordx4 v10,s[12:15],s58 offen offset:2048 lds
 v_mfma_f32_16x16x32_bf16 v[36:39],a[128:131],a[8:11],v[36:39]
 ds_read_b64_tr_b16 a[154:155],v18 offset:43040
 v_mfma_f32_16x16x32_bf16 v[36:39],a[132:135],a[12:15],v[36:39]
 v_mfma_f32_16x16x32_bf16 v[40:43],a[128:131],a[16:19],v[40:43]
 ds_read_b64_tr_b16 a[156:157],v17 offset:50208
 v_mfma_f32_16x16x32_bf16 v[40:43],a[132:135],a[20:23],v[40:43]
 buffer_load_dwordx4 v11,s[12:15],s58 offen offset:3072 lds
 v_mfma_f32_16x16x32_bf16 v[44:47],a[128:131],a[24:27],v[44:47]
 ds_read_b64_tr_b16 a[158:159],v18 offset:50208
 v_mfma_f32_16x16x32_bf16 v[44:47],a[132:135],a[28:31],v[44:47]
 v_mfma_f32_16x16x32_bf16 v[48:51],a[136:139],a[0:3],v[48:51]
 ds_read_b64_tr_b16 a[128:129],v17 offset:28736
 v_mfma_f32_16x16x32_bf16 v[48:51],a[140:143],a[4:7],v[48:51]
 v_mfma_f32_16x16x32_bf16 v[52:55],a[136:139],a[8:11],v[52:55]
 ds_read_b64_tr_b16 a[130:131],v18 offset:28736
 s_add_u32 m0,s52,4096
 v_mfma_f32_16x16x32_bf16 v[52:55],a[140:143],a[12:15],v[52:55]
 buffer_load_dwordx4 v12,s[12:15],s58 offen offset:0 lds
 v_mfma_f32_16x16x32_bf16 v[56:59],a[136:139],a[16:19],v[56:59]
 ds_read_b64_tr_b16 a[132:133],v17 offset:35904
 v_mfma_f32_16x16x32_bf16 v[56:59],a[140:143],a[20:23],v[56:59]
 v_mfma_f32_16x16x32_bf16 v[60:63],a[136:139],a[24:27],v[60:63]
 ds_read_b64_tr_b16 a[134:135],v18 offset:35904
 v_mfma_f32_16x16x32_bf16 v[60:63],a[140:143],a[28:31],v[60:63]
 s_waitcnt lgkmcnt(4)
 v_mfma_f32_16x16x32_bf16 v[64:67],a[144:147],a[0:3],v[64:67]
 ds_read_b64_tr_b16 a[136:137],v17 offset:43072
 v_mfma_f32_16x16x32_bf16 v[64:67],a[148:151],a[4:7],v[64:67]
 buffer_load_dwordx4 v13,s[12:15],s58 offen offset:1024 lds
 v_mfma_f32_16x16x32_bf16 v[68:71],a[144:147],a[8:11],v[68:71]
 ds_read_b64_tr_b16 a[138:139],v18 offset:43072
 v_mfma_f32_16x16x32_bf16 v[68:71],a[148:151],a[12:15],v[68:71]
 v_mfma_f32_16x16x32_bf16 v[72:75],a[144:147],a[16:19],v[72:75]
 ds_read_b64_tr_b16 a[140:141],v17 offset:50240
 v_mfma_f32_16x16x32_bf16 v[72:75],a[148:151],a[20:23],v[72:75]
 buffer_load_dwordx4 v14,s[12:15],s58 offen offset:2048 lds
 v_mfma_f32_16x16x32_bf16 v[76:79],a[144:147],a[24:27],v[76:79]
 ds_read_b64_tr_b16 a[142:143],v18 offset:50240
 v_mfma_f32_16x16x32_bf16 v[76:79],a[148:151],a[28:31],v[76:79]
 v_mfma_f32_16x16x32_bf16 v[80:83],a[152:155],a[0:3],v[80:83]
 ds_read_b64_tr_b16 a[144:145],v17 offset:28768
 s_add_u32 s57,s57,8192
 v_mfma_f32_16x16x32_bf16 v[80:83],a[156:159],a[4:7],v[80:83]
 buffer_load_dwordx4 a[64:67],v4,s[8:11],s57 offen offset:0 sc1
 v_mfma_f32_16x16x32_bf16 v[84:87],a[152:155],a[8:11],v[84:87]
 ds_read_b64_tr_b16 a[146:147],v18 offset:28768
 v_mfma_f32_16x16x32_bf16 v[84:87],a[156:159],a[12:15],v[84:87]
 v_mfma_f32_16x16x32_bf16 v[88:91],a[152:155],a[16:19],v[88:91]
 ds_read_b64_tr_b16 a[148:149],v17 offset:35936
 v_mfma_f32_16x16x32_bf16 v[88:91],a[156:159],a[20:23],v[88:91]
 buffer_load_dwordx4 a[68:71],v4,s[8:11],s57 offen offset:1024 sc1
 v_mfma_f32_16x16x32_bf16 v[92:95],a[152:155],a[24:27],v[92:95]
 ds_read_b64_tr_b16 a[150:151],v18 offset:35936
 v_mfma_f32_16x16x32_bf16 v[92:95],a[156:159],a[28:31],v[92:95]
 s_waitcnt lgkmcnt(4)
 v_mfma_f32_16x16x32_bf16 v[96:99],a[128:131],a[0:3],v[96:99]
 ds_read_b64_tr_b16 a[152:153],v17 offset:43104
 s_mov_b32 s3,6422528
 v_mfma_f32_16x16x32_bf16 v[96:99],a[132:135],a[4:7],v[96:99]
 buffer_load_dword v31,v2,s[12:15],s3 offen
 v_mfma_f32_16x16x32_bf16 v[100:103],a[128:131],a[8:11],v[100:103]
 ds_read_b64_tr_b16 a[154:155],v18 offset:43104
 s_mov_b32 s3,0
 v_mfma_f32_16x16x32_bf16 v[100:103],a[132:135],a[12:15],v[100:103]
 buffer_load_dword v31,v3,s[16:19],s3 offen
 v_mfma_f32_16x16x32_bf16 v[104:107],a[128:131],a[16:19],v[104:107]
 ds_read_b64_tr_b16 a[156:157],v17 offset:50272
 s_mov_b32 s3,1048576
 v_mfma_f32_16x16x32_bf16 v[104:107],a[132:135],a[20:23],v[104:107]
 buffer_load_dword v31,v3,s[16:19],s3 offen
 v_mfma_f32_16x16x32_bf16 v[108:111],a[128:131],a[24:27],v[108:111]
 ds_read_b64_tr_b16 a[158:159],v18 offset:50272
 s_mov_b32 s3,32768
 v_mfma_f32_16x16x32_bf16 v[108:111],a[132:135],a[28:31],v[108:111]
 buffer_load_dword v31,v25,s[20:23],s3 offen
 v_mfma_f32_16x16x32_bf16 v[112:115],a[136:139],a[0:3],v[112:115]
 ds_read_b64_tr_b16 a[128:129],v17 offset:28800
 s_mov_b32 s3,32768
 v_mfma_f32_16x16x32_bf16 v[112:115],a[140:143],a[4:7],v[112:115]
 buffer_load_dword v31,v25,s[24:27],s3 offen
 v_mfma_f32_16x16x32_bf16 v[116:119],a[136:139],a[8:11],v[116:119]
 ds_read_b64_tr_b16 a[130:131],v18 offset:28800
 s_getpc_b64 s[6:7]
L_cb4:
 v_mfma_f32_16x16x32_bf16 v[116:119],a[140:143],a[12:15],v[116:119]
 global_load_dword v31,v28,s[6:7]
 v_mfma_f32_16x16x32_bf16 v[120:123],a[136:139],a[16:19],v[120:123]
 ds_read_b64_tr_b16 a[132:133],v17 offset:35968
 v_mfma_f32_16x16x32_bf16 v[120:123],a[140:143],a[20:23],v[120:123]
 v_mfma_f32_16x16x32_bf16 v[124:127],a[136:139],a[24:27],v[124:127]
 ds_read_b64_tr_b16 a[134:135],v18 offset:35968
 v_mfma_f32_16x16x32_bf16 v[124:127],a[140:143],a[28:31],v[124:127]
 s_waitcnt lgkmcnt(4)
 v_mfma_f32_16x16x32_bf16 v[128:131],a[144:147],a[0:3],v[128:131]
 ds_read_b64_tr_b16 a[136:137],v17 offset:43136
 v_mfma_f32_16x16x32_bf16 v[128:131],a[148:151],a[4:7],v[128:131]
 buffer_load_dwordx4 a[72:75],v4,s[8:11],s57 offen offset:2048 sc1
 v_mfma_f32_16x16x32_bf16 v[132:135],a[144:147],a[8:11],v[132:135]
 ds_read_b64_tr_b16 a[138:139],v18 offset:43136
 v_mfma_f32_16x16x32_bf16 v[132:135],a[148:151],a[12:15],v[132:135]
 buffer_load_dwordx4 a[76:79],v4,s[8:11],s57 offen offset:3072 sc1
 v_mfma_f32_16x16x32_bf16 v[136:139],a[144:147],a[16:19],v[136:139]
 ds_read_b64_tr_b16 a[140:141],v17 offset:50304
 v_mfma_f32_16x16x32_bf16 v[136:139],a[148:151],a[20:23],v[136:139]
 v_mfma_f32_16x16x32_bf16 v[140:143],a[144:147],a[24:27],v[140:143]
 ds_read_b64_tr_b16 a[142:143],v18 offset:50304
 v_mfma_f32_16x16x32_bf16 v[140:143],a[148:151],a[28:31],v[140:143]
 v_mfma_f32_16x16x32_bf16 v[144:147],a[152:155],a[0:3],v[144:147]
 ds_read_b64_tr_b16 a[144:145],v17 offset:28832
 v_mfma_f32_16x16x32_bf16 v[144:147],a[156:159],a[4:7],v[144:147]
 v_mfma_f32_16x16x32_bf16 v[148:151],a[152:155],a[8:11],v[148:151]
 ds_read_b64_tr_b16 a[146:147],v18 offset:28832
 v_mfma_f32_16x16x32_bf16 v[148:151],a[156:159],a[12:15],v[148:151]
 v_mfma_f32_16x16x32_bf16 v[152:155],a[152:155],a[16:19],v[152:155]
 ds_read_b64_tr_b16 a[148:149],v17 offset:36000
 v_mfma_f32_16x16x32_bf16 v[152:155],a[156:159],a[20:23],v[152:155]
 v_mfma_f32_16x16x32_bf16 v[156:159],a[152:155],a[24:27],v[156:159]
 ds_read_b64_tr_b16 a[150:151],v18 offset:36000
 v_mfma_f32_16x16x32_bf16 v[156:159],a[156:159],a[28:31],v[156:159]
 s_waitcnt lgkmcnt(4)
 v_mfma_f32_16x16x32_bf16 v[160:163],a[128:131],a[0:3],v[160:163]
 ds_read_b64_tr_b16 a[152:153],v17 offset:43168
 v_mfma_f32_16x16x32_bf16 v[160:163],a[132:135],a[4:7],v[160:163]
 v_mfma_f32_16x16x32_bf16 v[164:167],a[128:131],a[8:11],v[164:167]
 ds_read_b64_tr_b16 a[154:155],v18 offset:43168
 v_mfma_f32_16x16x32_bf16 v[164:167],a[132:135],a[12:15],v[164:167]
 v_mfma_f32_16x16x32_bf16 v[168:171],a[128:131],a[16:19],v[168:171]
 ds_read_b64_tr_b16 a[156:157],v17 offset:50336
 v_mfma_f32_16x16x32_bf16 v[168:171],a[132:135],a[20:23],v[168:171]
 v_mfma_f32_16x16x32_bf16 v[172:175],a[128:131],a[24:27],v[172:175]
 ds_read_b64_tr_b16 a[158:159],v18 offset:50336
 v_mfma_f32_16x16x32_bf16 v[172:175],a[132:135],a[28:31],v[172:175]
 v_mfma_f32_16x16x32_bf16 v[176:179],a[136:139],a[0:3],v[176:179]
 ds_read_b64_tr_b16 a[128:129],v17 offset:28864
 v_mfma_f32_16x16x32_bf16 v[176:179],a[140:143],a[4:7],v[176:179]
 v_mfma_f32_16x16x32_bf16 v[180:183],a[136:139],a[8:11],v[180:183]
 ds_read_b64_tr_b16 a[130:131],v18 offset:28864
 v_mfma_f32_16x16x32_bf16 v[180:183],a[140:143],a[12:15],v[180:183]
 v_mfma_f32_16x16x32_bf16 v[184:187],a[136:139],a[16:19],v[184:187]
 ds_read_b64_tr_b16 a[132:133],v17 offset:36032
 v_mfma_f32_16x16x32_bf16 v[184:187],a[140:143],a[20:23],v[184:187]
 v_mfma_f32_16x16x32_bf16 v[188:191],a[136:139],a[24:27],v[188:191]
 ds_read_b64_tr_b16 a[134:135],v18 offset:36032
 v_mfma_f32_16x16x32_bf16 v[188:191],a[140:143],a[28:31],v[188:191]
 s_waitcnt lgkmcnt(4)
 v_mfma_f32_16x16x32_bf16 v[192:195],a[144:147],a[0:3],v[192:195]
 ds_read_b64_tr_b16 a[136:137],v17 offset:43200
 v_mfma_f32_16x16x32_bf16 v[192:195],a[148:151],a[4:7],v[192:195]
 v_mfma_f32_16x16x32_bf16 v[196:199],a[144:147],a[8:11],v[196:199]
 ds_read_b64_tr_b16 a[138:139],v18 offset:43200
 v_mfma_f32_16x16x32_bf16 v[196:199],a[148:151],a[12:15],v[196:199]
 v_mfma_f32_16x16x32_bf16 v[200:203],a[144:147],a[16:19],v[200:203]
 ds_read_b64_tr_b16 a[140:141],v17 offset:50368
 v_mfma_f32_16x16x32_bf16 v[200:203],a[148:151],a[20:23],v[200:203]
 v_mfma_f32_16x16x32_bf16 v[204:207],a[144:147],a[24:27],v[204:207]
 ds_read_b64_tr_b16 a[142:143],v18 offset:50368
 v_mfma_f32_16x16x32_bf16 v[204:207],a[148:151],a[28:31],v[204:207]
 s_waitcnt vmcnt(25)
 s_barrier
 v_mfma_f32_16x16x32_bf16 v[208:211],a[152:155],a[0:3],v[208:211]
 ds_read_b64_tr_b16 a[144:145],v19 offset:0
 v_mfma_f32_16x16x32_bf16 v[208:211],a[156:159],a[4:7],v[208:211]
 v_mfma_f32_16x16x32_bf16 v[212:215],a[152:155],a[8:11],v[212:215]
 ds_read_b64_tr_b16 a[146:147],v20 offset:0
 v_mfma_f32_16x16x32_bf16 v[212:215],a[156:159],a[12:15],v[212:215]
 v_mfma_f32_16x16x32_bf16 v[216:219],a[152:155],a[16:19],v[216:219]
 ds_read_b64_tr_b16 a[148:149],v19 offset:7168
 v_mfma_f32_16x16x32_bf16 v[216:219],a[156:159],a[20:23],v[216:219]
 v_mfma_f32_16x16x32_bf16 v[220:223],a[152:155],a[24:27],v[220:223]
 ds_read_b64_tr_b16 a[150:151],v20 offset:7168
 v_mfma_f32_16x16x32_bf16 v[220:223],a[156:159],a[28:31],v[220:223]
 s_waitcnt lgkmcnt(4)
 v_mfma_f32_16x16x32_bf16 v[224:227],a[128:131],a[0:3],v[224:227]
 ds_read_b64_tr_b16 a[152:153],v19 offset:14336
 v_mfma_f32_16x16x32_bf16 v[224:227],a[132:135],a[4:7],v[224:227]
 v_mfma_f32_16x16x32_bf16 v[228:231],a[128:131],a[8:11],v[228:231]
 ds_read_b64_tr_b16 a[154:155],v20 offset:14336
 v_mfma_f32_16x16x32_bf16 v[228:231],a[132:135],a[12:15],v[228:231]
 v_mfma_f32_16x16x32_bf16 v[232:235],a[128:131],a[16:19],v[232:235]
 ds_read_b64_tr_b16 a[156:157],v19 offset:21504
 v_mfma_f32_16x16x32_bf16 v[232:235],a[132:135],a[20:23],v[232:235]
 v_mfma_f32_16x16x32_bf16 v[236:239],a[128:131],a[24:27],v[236:239]
 ds_read_b64_tr_b16 a[158:159],v20 offset:21504
 v_mfma_f32_16x16x32_bf16 v[236:239],a[132:135],a[28:31],v[236:239]
 v_mfma_f32_16x16x32_bf16 v[240:243],a[136:139],a[0:3],v[240:243]
 ds_read_b64_tr_b16 a[128:129],v19 offset:32
 v_mfma_f32_16x16x32_bf16 v[240:243],a[140:143],a[4:7],v[240:243]
 v_mfma_f32_16x16x32_bf16 v[244:247],a[136:139],a[8:11],v[244:247]
 ds_read_b64_tr_b16 a[130:131],v20 offset:32
 v_mfma_f32_16x16x32_bf16 v[244:247],a[140:143],a[12:15],v[244:247]
 v_mfma_f32_16x16x32_bf16 v[248:251],a[136:139],a[16:19],v[248:251]
 ds_read_b64_tr_b16 a[132:133],v19 offset:7200
 v_mfma_f32_16x16x32_bf16 v[248:251],a[140:143],a[20:23],v[248:251]
 v_mfma_f32_16x16x32_bf16 v[252:255],a[136:139],a[24:27],v[252:255]
 ds_read_b64_tr_b16 a[134:135],v20 offset:7200
 v_mfma_f32_16x16x32_bf16 v[252:255],a[140:143],a[28:31],v[252:255]
 s_waitcnt vmcnt(17)
 s_waitcnt lgkmcnt(4)
 v_mfma_f32_16x16x32_bf16 v[32:35],a[144:147],a[32:35],v[32:35]
 ds_read_b64_tr_b16 a[136:137],v19 offset:14368
 v_mfma_f32_16x16x32_bf16 v[32:35],a[148:151],a[36:39],v[32:35]
 v_mfma_f32_16x16x32_bf16 v[36:39],a[144:147],a[40:43],v[36:39]
 ds_read_b64_tr_b16 a[138:139],v20 offset:14368
 v_mfma_f32_16x16x32_bf16 v[36:39],a[148:151],a[44:47],v[36:39]
 v_mfma_f32_16x16x32_bf16 v[40:43],a[144:147],a[48:51],v[40:43]
 ds_read_b64_tr_b16 a[140:141],v19 offset:21536
 v_mfma_f32_16x16x32_bf16 v[40:43],a[148:151],a[52:55],v[40:43]
 buffer_load_dwordx4 a[80:83],v5,s[8:11],s57 offen offset:0 sc1
 v_mfma_f32_16x16x32_bf16 v[44:47],a[144:147],a[56:59],v[44:47]
 ds_read_b64_tr_b16 a[142:143],v20 offset:21536
 v_mfma_f32_16x16x32_bf16 v[44:47],a[148:151],a[60:63],v[44:47]
 buffer_load_dwordx4 a[84:87],v5,s[8:11],s57 offen offset:1024 sc1
 v_mfma_f32_16x16x32_bf16 v[48:51],a[152:155],a[32:35],v[48:51]
 ds_read_b64_tr_b16 a[144:145],v19 offset:64
 v_mfma_f32_16x16x32_bf16 v[48:51],a[156:159],a[36:39],v[48:51]
 buffer_load_dwordx4 a[88:91],v5,s[8:11],s57 offen offset:2048 sc1
 v_mfma_f32_16x16x32_bf16 v[52:55],a[152:155],a[40:43],v[52:55]
 ds_read_b64_tr_b16 a[146:147],v20 offset:64
 v_mfma_f32_16x16x32_bf16 v[52:55],a[156:159],a[44:47],v[52:55]
 v_mfma_f32_16x16x32_bf16 v[56:59],a[152:155],a[48:51],v[56:59]
 ds_read_b64_tr_b16 a[148:149],v19 offset:7232
 v_mfma_f32_16x16x32_bf16 v[56:59],a[156:159],a[52:55],v[56:59]
 v_mfma_f32_16x16x32_bf16 v[60:63],a[152:155],a[56:59],v[60:63]
 ds_read_b64_tr_b16 a[150:151],v20 offset:7232
 v_mfma_f32_16x16x32_bf16 v[60:63],a[156:159],a[60:63],v[60:63]
 s_waitcnt lgkmcnt(4)
 v_mfma_f32_16x16x32_bf16 v[64:67],a[128:131],a[32:35],v[64:67]
 ds_read_b64_tr_b16 a[152:153],v19 offset:14400
 s_add_u32 s58,s58,458752
 v_mfma_f32_16x16x32_bf16 v[64:67],a[132:135],a[36:39],v[64:67]
 buffer_load_dwordx4 a[92:95],v5,s[8:11],s57 offen offset:3072 sc1
 v_mfma_f32_16x16x32_bf16 v[68:71],a[128:131],a[40:43],v[68:71]
 ds_read_b64_tr_b16 a[154:155],v20 offset:14400
 s_add_u32 m0,s52,28672
 v_mfma_f32_16x16x32_bf16 v[68:71],a[132:135],a[44:47],v[68:71]
 buffer_load_dwordx4 v8,s[12:15],s58 offen offset:0 lds
 v_mfma_f32_16x16x32_bf16 v[72:75],a[128:131],a[48:51],v[72:75]
 ds_read_b64_tr_b16 a[156:157],v19 offset:21568
 v_mfma_f32_16x16x32_bf16 v[72:75],a[132:135],a[52:55],v[72:75]
 v_mfma_f32_16x16x32_bf16 v[76:79],a[128:131],a[56:59],v[76:79]
 ds_read_b64_tr_b16 a[158:159],v20 offset:21568
 v_mfma_f32_16x16x32_bf16 v[76:79],a[132:135],a[60:63],v[76:79]
 buffer_load_dwordx4 v9,s[12:15],s58 offen offset:1024 lds
 v_mfma_f32_16x16x32_bf16 v[80:83],a[136:139],a[32:35],v[80:83]
 ds_read_b64_tr_b16 a[128:129],v19 offset:96
 v_mfma_f32_16x16x32_bf16 v[80:83],a[140:143],a[36:39],v[80:83]
 v_mfma_f32_16x16x32_bf16 v[84:87],a[136:139],a[40:43],v[84:87]
 ds_read_b64_tr_b16 a[130:131],v20 offset:96
 v_mfma_f32_16x16x32_bf16 v[84:87],a[140:143],a[44:47],v[84:87]
 v_mfma_f32_16x16x32_bf16 v[88:91],a[136:139],a[48:51],v[88:91]
 ds_read_b64_tr_b16 a[132:133],v19 offset:7264
 v_mfma_f32_16x16x32_bf16 v[88:91],a[140:143],a[52:55],v[88:91]
 v_mfma_f32_16x16x32_bf16 v[92:95],a[136:139],a[56:59],v[92:95]
 ds_read_b64_tr_b16 a[134:135],v20 offset:7264
 v_mfma_f32_16x16x32_bf16 v[92:95],a[140:143],a[60:63],v[92:95]
 s_waitcnt lgkmcnt(4)
 v_mfma_f32_16x16x32_bf16 v[96:99],a[144:147],a[32:35],v[96:99]
 ds_read_b64_tr_b16 a[136:137],v19 offset:14432
 v_mfma_f32_16x16x32_bf16 v[96:99],a[148:151],a[36:39],v[96:99]
 buffer_load_dwordx4 v10,s[12:15],s58 offen offset:2048 lds
 v_mfma_f32_16x16x32_bf16 v[100:103],a[144:147],a[40:43],v[100:103]
 ds_read_b64_tr_b16 a[138:139],v20 offset:14432
 v_mfma_f32_16x16x32_bf16 v[100:103],a[148:151],a[44:47],v[100:103]
 buffer_load_dwordx4 v11,s[12:15],s58 offen offset:3072 lds
 v_mfma_f32_16x16x32_bf16 v[104:107],a[144:147],a[48:51],v[104:107]
 ds_read_b64_tr_b16 a[140:141],v19 offset:21600
 v_mfma_f32_16x16x32_bf16 v[104:107],a[148:151],a[52:55],v[104:107]
 v_mfma_f32_16x16x32_bf16 v[108:111],a[144:147],a[56:59],v[108:111]
 ds_read_b64_tr_b16 a[142:143],v20 offset:21600
 v_mfma_f32_16x16x32_bf16 v[108:111],a[148:151],a[60:63],v[108:111]
 v_mfma_f32_16x16x32_bf16 v[112:115],a[152:155],a[32:35],v[112:115]
 ds_read_b64_tr_b16 a[144:145],v19 offset:128
 v_mfma_f32_16x16x32_bf16 v[112:115],a[156:159],a[36:39],v[112:115]
 v_mfma_f32_16x16x32_bf16 v[116:119],a[152:155],a[40:43],v[116:119]
 ds_read_b64_tr_b16 a[146:147],v20 offset:128
 s_add_u32 m0,s52,32768
 v_mfma_f32_16x16x32_bf16 v[116:119],a[156:159],a[44:47],v[116:119]
 buffer_load_dwordx4 v12,s[12:15],s58 offen offset:0 lds
 v_mfma_f32_16x16x32_bf16 v[120:123],a[152:155],a[48:51],v[120:123]
 ds_read_b64_tr_b16 a[148:149],v19 offset:7296
 v_mfma_f32_16x16x32_bf16 v[120:123],a[156:159],a[52:55],v[120:123]
 v_mfma_f32_16x16x32_bf16 v[124:127],a[152:155],a[56:59],v[124:127]
 ds_read_b64_tr_b16 a[150:151],v20 offset:7296
 v_mfma_f32_16x16x32_bf16 v[124:127],a[156:159],a[60:63],v[124:127]
 s_waitcnt lgkmcnt(4)
 v_mfma_f32_16x16x32_bf16 v[128:131],a[128:131],a[32:35],v[128:131]
 ds_read_b64_tr_b16 a[152:153],v19 offset:14464
 v_mfma_f32_16x16x32_bf16 v[128:131],a[132:135],a[36:39],v[128:131]
 buffer_load_dwordx4 v13,s[12:15],s58 offen offset:1024 lds
 v_mfma_f32_16x16x32_bf16 v[132:135],a[128:131],a[40:43],v[132:135]
 ds_read_b64_tr_b16 a[154:155],v20 offset:14464
 v_mfma_f32_16x16x32_bf16 v[132:135],a[132:135],a[44:47],v[132:135]
 v_mfma_f32_16x16x32_bf16 v[136:139],a[128:131],a[48:51],v[136:139]
 ds_read_b64_tr_b16 a[156:157],v19 offset:21632
 v_mfma_f32_16x16x32_bf16 v[136:139],a[132:135],a[52:55],v[136:139]
 buffer_load_dwordx4 v14,s[12:15],s58 offen offset:2048 lds
 v_mfma_f32_16x16x32_bf16 v[140:143],a[128:131],a[56:59],v[140:143]
 ds_read_b64_tr_b16 a[158:159],v20 offset:21632
 v_mfma_f32_16x16x32_bf16 v[140:143],a[132:135],a[60:63],v[140:143]
 v_mfma_f32_16x16x32_bf16 v[144:147],a[136:139],a[32:35],v[144:147]
 ds_read_b64_tr_b16 a[128:129],v19 offset:160
 s_add_u32 s57,s57,8192
 v_mfma_f32_16x16x32_bf16 v[144:147],a[140:143],a[36:39],v[144:147]
 buffer_load_dwordx4 a[96:99],v4,s[8:11],s57 offen offset:0 sc1
 v_mfma_f32_16x16x32_bf16 v[148:151],a[136:139],a[40:43],v[148:151]
 ds_read_b64_tr_b16 a[130:131],v20 offset:160
 v_mfma_f32_16x16x32_bf16 v[148:151],a[140:143],a[44:47],v[148:151]
 v_mfma_f32_16x16x32_bf16 v[152:155],a[136:139],a[48:51],v[152:155]
 ds_read_b64_tr_b16 a[132:133],v19 offset:7328
 v_mfma_f32_16x16x32_bf16 v[152:155],a[140:143],a[52:55],v[152:155]
 v_mfma_f32_16x16x32_bf16 v[156:159],a[136:139],a[56:59],v[156:159]
 ds_read_b64_tr_b16 a[134:135],v20 offset:7328
 v_mfma_f32_16x16x32_bf16 v[156:159],a[140:143],a[60:63],v[156:159]
 s_waitcnt lgkmcnt(4)
 v_mfma_f32_16x16x32_bf16 v[160:163],a[144:147],a[32:35],v[160:163]
 ds_read_b64_tr_b16 a[136:137],v19 offset:14496
 v_mfma_f32_16x16x32_bf16 v[160:163],a[148:151],a[36:39],v[160:163]
 buffer_load_dwordx4 a[100:103],v4,s[8:11],s57 offen offset:1024 sc1
 v_mfma_f32_16x16x32_bf16 v[164:167],a[144:147],a[40:43],v[164:167]
 ds_read_b64_tr_b16 a[138:139],v20 offset:14496
 v_mfma_f32_16x16x32_bf16 v[164:167],a[148:151],a[44:47],v[164:167]
 buffer_load_dwordx4 a[104:107],v4,s[8:11],s57 offen offset:2048 sc1
 v_mfma_f32_16x16x32_bf16 v[168:171],a[144:147],a[48:51],v[168:171]
 ds_read_b64_tr_b16 a[140:141],v19 offset:21664
 v_mfma_f32_16x16x32_bf16 v[168:171],a[148:151],a[52:55],v[168:171]
 v_mfma_f32_16x16x32_bf16 v[172:175],a[144:147],a[56:59],v[172:175]
 ds_read_b64_tr_b16 a[142:143],v20 offset:21664
 v_mfma_f32_16x16x32_bf16 v[172:175],a[148:151],a[60:63],v[172:175]
 buffer_load_dwordx4 a[108:111],v4,s[8:11],s57 offen offset:3072 sc1
 v_mfma_f32_16x16x32_bf16 v[176:179],a[152:155],a[32:35],v[176:179]
 ds_read_b64_tr_b16 a[144:145],v19 offset:192
 v_mfma_f32_16x16x32_bf16 v[176:179],a[156:159],a[36:39],v[176:179]
 v_mfma_f32_16x16x32_bf16 v[180:183],a[152:155],a[40:43],v[180:183]
 ds_read_b64_tr_b16 a[146:147],v20 offset:192
 v_mfma_f32_16x16x32_bf16 v[180:183],a[156:159],a[44:47],v[180:183]
 v_mfma_f32_16x16x32_bf16 v[184:187],a[152:155],a[48:51],v[184:187]
 ds_read_b64_tr_b16 a[148:149],v19 offset:7360
 v_mfma_f32_16x16x32_bf16 v[184:187],a[156:159],a[52:55],v[184:187]
 buffer_load_dwordx4 a[112:115],v5,s[8:11],s57 offen offset:0 sc1
 v_mfma_f32_16x16x32_bf16 v[188:191],a[152:155],a[56:59],v[188:191]
 ds_read_b64_tr_b16 a[150:151],v20 offset:7360
 v_mfma_f32_16x16x32_bf16 v[188:191],a[156:159],a[60:63],v[188:191]
 s_waitcnt lgkmcnt(4)
 v_mfma_f32_16x16x32_bf16 v[192:195],a[128:131],a[32:35],v[192:195]
 ds_read_b64_tr_b16 a[152:153],v19 offset:14528
 v_mfma_f32_16x16x32_bf16 v[192:195],a[132:135],a[36:39],v[192:195]
 buffer_load_dwordx4 a[116:119],v5,s[8:11],s57 offen offset:1024 sc1
 v_mfma_f32_16x16x32_bf16 v[196:199],a[128:131],a[40:43],v[196:199]
 ds_read_b64_tr_b16 a[154:155],v20 offset:14528
 v_mfma_f32_16x16x32_bf16 v[196:199],a[132:135],a[44:47],v[196:199]
 v_mfma_f32_16x16x32_bf16 v[200:203],a[128:131],a[48:51],v[200:203]
 ds_read_b64_tr_b16 a[156:157],v19 offset:21696
 v_mfma_f32_16x16x32_bf16 v[200:203],a[132:135],a[52:55],v[200:203]
 v_mfma_f32_16x16x32_bf16 v[204:207],a[128:131],a[56:59],v[204:207]
 ds_read_b64_tr_b16 a[158:159],v20 offset:21696
 v_mfma_f32_16x16x32_bf16 v[204:207],a[132:135],a[60:63],v[204:207]
 s_waitcnt vmcnt(27)
 s_barrier
 v_mfma_f32_16x16x32_bf16 v[208:211],a[136:139],a[32:35],v[208:211]
 ds_read_b64_tr_b16 a[128:129],v15 offset:0
 v_mfma_f32_16x16x32_bf16 v[208:211],a[140:143],a[36:39],v[208:211]
 buffer_load_dwordx4 a[120:123],v5,s[8:11],s57 offen offset:2048 sc1
 v_mfma_f32_16x16x32_bf16 v[212:215],a[136:139],a[40:43],v[212:215]
 ds_read_b64_tr_b16 a[130:131],v16 offset:0
 v_mfma_f32_16x16x32_bf16 v[212:215],a[140:143],a[44:47],v[212:215]
 buffer_load_dwordx4 a[124:127],v5,s[8:11],s57 offen offset:3072 sc1
 v_mfma_f32_16x16x32_bf16 v[216:219],a[136:139],a[48:51],v[216:219]
 ds_read_b64_tr_b16 a[132:133],v15 offset:7168
 v_mfma_f32_16x16x32_bf16 v[216:219],a[140:143],a[52:55],v[216:219]
 v_mfma_f32_16x16x32_bf16 v[220:223],a[136:139],a[56:59],v[220:223]
 ds_read_b64_tr_b16 a[134:135],v16 offset:7168
 v_mfma_f32_16x16x32_bf16 v[220:223],a[140:143],a[60:63],v[220:223]
 s_add_u32 s58,s58,458752
 s_waitcnt lgkmcnt(4)
 v_mfma_f32_16x16x32_bf16 v[224:227],a[144:147],a[32:35],v[224:227]
 ds_read_b64_tr_b16 a[136:137],v15 offset:14336
 s_add_u32 m0,s52,57344
 v_mfma_f32_16x16x32_bf16 v[224:227],a[148:151],a[36:39],v[224:227]
 buffer_load_dwordx4 v8,s[12:15],s58 offen offset:0 lds
 v_mfma_f32_16x16x32_bf16 v[228:231],a[144:147],a[40:43],v[228:231]
 ds_read_b64_tr_b16 a[138:139],v16 offset:14336
 v_mfma_f32_16x16x32_bf16 v[228:231],a[148:151],a[44:47],v[228:231]
 v_mfma_f32_16x16x32_bf16 v[232:235],a[144:147],a[48:51],v[232:235]
 ds_read_b64_tr_b16 a[140:141],v15 offset:21504
 v_mfma_f32_16x16x32_bf16 v[232:235],a[148:151],a[52:55],v[232:235]
 v_mfma_f32_16x16x32_bf16 v[236:239],a[144:147],a[56:59],v[236:239]
 ds_read_b64_tr_b16 a[142:143],v16 offset:21504
 v_mfma_f32_16x16x32_bf16 v[236:239],a[148:151],a[60:63],v[236:239]
 buffer_load_dwordx4 v9,s[12:15],s58 offen offset:1024 lds
 v_mfma_f32_16x16x32_bf16 v[240:243],a[152:155],a[32:35],v[240:243]
 ds_read_b64_tr_b16 a[144:145],v15 offset:32
 s_mov_b32 s3,2097152
 v_mfma_f32_16x16x32_bf16 v[240:243],a[156:159],a[36:39],v[240:243]
 buffer_load_dword v31,v3,s[16:19],s3 offen
 v_mfma_f32_16x16x32_bf16 v[244:247],a[152:155],a[40:43],v[244:247]
 ds_read_b64_tr_b16 a[146:147],v16 offset:32
 s_mov_b32 s3,3145728
 v_mfma_f32_16x16x32_bf16 v[244:247],a[156:159],a[44:47],v[244:247]
L_w5:
 s_cbranch_execz L_w9
 buffer_load_dword v31,v3,s[16:19],s3 offen
 v_mfma_f32_16x16x32_bf16 v[248:251],a[152:155],a[48:51],v[248:251]
 ds_read_b64_tr_b16 a[148:149],v15 offset:7200
 s_mov_b32 s3,49152
 v_mfma_f32_16x16x32_bf16 v[248:251],a[156:159],a[52:55],v[248:251]
 buffer_load_dword v31,v25,s[20:23],s3 offen
 v_mfma_f32_16x16x32_bf16 v[252:255],a[152:155],a[56:59],v[252:255]
 ds_read_b64_tr_b16 a[150:151],v16 offset:7200
 v_mfma_f32_16x16x32_bf16 v[252:255],a[156:159],a[60:63],v[252:255]
 s_waitcnt vmcnt(20)
 s_waitcnt lgkmcnt(4)
 v_mfma_f32_16x16x32_bf16 v[32:35],a[128:131],a[64:67],v[32:35]
 ds_read_b64_tr_b16 a[152:153],v15 offset:14368
 s_mov_b32 s3,49152
 v_mfma_f32_16x16x32_bf16 v[32:35],a[132:135],a[68:71],v[32:35]
 buffer_load_dword v31,v25,s[24:27],s3 offen
 v_mfma_f32_16x16x32_bf16 v[36:39],a[128:131],a[72:75],v[36:39]
 ds_read_b64_tr_b16 a[154:155],v16 offset:14368
 s_getpc_b64 s[6:7]
L_cb5:
 v_mfma_f32_16x16x32_bf16 v[36:39],a[132:135],a[76:79],v[36:39]
 global_load_dword v31,v28,s[6:7]
 v_mfma_f32_16x16x32_bf16 v[40:43],a[128:131],a[80:83],v[40:43]
 ds_read_b64_tr_b16 a[156:157],v15 offset:21536
 v_mfma_f32_16x16x32_bf16 v[40:43],a[132:135],a[84:87],v[40:43]
 v_mfma_f32_16x16x32_bf16 v[44:47],a[128:131],a[88:91],v[44:47]
 ds_read_b64_tr_b16 a[158:159],v16 offset:21536
 v_mfma_f32_16x16x32_bf16 v[44:47],a[132:135],a[92:95],v[44:47]
 buffer_load_dwordx4 v10,s[12:15],s58 offen offset:2048 lds
 v_mfma_f32_16x16x32_bf16 v[48:51],a[136:139],a[64:67],v[48:51]
 ds_read_b64_tr_b16 a[128:129],v15 offset:64
 v_mfma_f32_16x16x32_bf16 v[48:51],a[140:143],a[68:71],v[48:51]
 v_mfma_f32_16x16x32_bf16 v[52:55],a[136:139],a[72:75],v[52:55]
 ds_read_b64_tr_b16 a[130:131],v16 offset:64
 v_mfma_f32_16x16x32_bf16 v[52:55],a[140:143],a[76:79],v[52:55]
 v_mfma_f32_16x16x32_bf16 v[56:59],a[136:139],a[80:83],v[56:59]
 ds_read_b64_tr_b16 a[132:133],v15 offset:7232
 v_mfma_f32_16x16x32_bf16 v[56:59],a[140:143],a[84:87],v[56:59]
 buffer_load_dwordx4 v11,s[12:15],s58 offen offset:3072 lds
 v_mfma_f32_16x16x32_bf16 v[60:63],a[136:139],a[88:91],v[60:63]
 ds_read_b64_tr_b16 a[134:135],v16 offset:7232
 v_mfma_f32_16x16x32_bf16 v[60:63],a[140:143],a[92:95],v[60:63]
 s_waitcnt lgkmcnt(4)
 v_mfma_f32_16x16x32_bf16 v[64:67],a[144:147],a[64:67],v[64:67]
 ds_read_b64_tr_b16 a[136:137],v15 offset:14400
 s_add_u32 m0,s52,61440
 v_mfma_f32_16x16x32_bf16 v[64:67],a[148:151],a[68:71],v[64:67]
 buffer_load_dwordx4 v12,s[12:15],s58 offen offset:0 lds
 v_mfma_f32_16x16x32_bf16 v[68:71],a[144:147],a[72:75],v[68:71]
 ds_read_b64_tr_b16 a[138:139],v16 offset:14400
 v_mfma_f32_16x16x32_bf16 v[68:71],a[148:151],a[76:79],v[68:71]
 v_mfma_f32_16x16x32_bf16 v[72:75],a[144:147],a[80:83],v[72:75]
 ds_read_b64_tr_b16 a[140:141],v15 offset:21568
 v_mfma_f32_16x16x32_bf16 v[72:75],a[148:151],a[84:87],v[72:75]
 buffer_load_dwordx4 v13,s[12:15],s58 offen offset:1024 lds
 v_mfma_f32_16x16x32_bf16 v[76:79],a[144:147],a[88:91],v[76:79]
 ds_read_b64_tr_b16 a[142:143],v16 offset:21568
 v_mfma_f32_16x16x32_bf16 v[76:79],a[148:151],a[92:95],v[76:79]
 v_mfma_f32_16x16x32_bf16 v[80:83],a[152:155],a[64:67],v[80:83]
 ds_read_b64_tr_b16 a[144:145],v15 offset:96
 v_mfma_f32_16x16x32_bf16 v[80:83],a[156:159],a[68:71],v[80:83]
 v_mfma_f32_16x16x32_bf16 v[84:87],a[152:155],a[72:75],v[84:87]
 ds_read_b64_tr_b16 a[146:147],v16 offset:96
 v_mfma_f32_16x16x32_bf16 v[84:87],a[156:159],a[76:79],v[84:87]
 v_mfma_f32_16x16x32_bf16 v[88:91],a[152:155],a[80:83],v[88:91]
 ds_read_b64_tr_b16 a[148:149],v15 offset:7264
 v_mfma_f32_16x16x32_bf16 v[88:91],a[156:159],a[84:87],v[88:91]
 v_mfma_f32_16x16x32_bf16 v[92:95],a[152:155],a[88:91],v[92:95]
 ds_read_b64_tr_b16 a[150:151],v16 offset:7264
 v_mfma_f32_16x16x32_bf16 v[92:95],a[156:159],a[92:95],v[92:95]
 s_waitcnt lgkmcnt(4)
 v_mfma_f32_16x16x32_bf16 v[96:99],a[128:131],a[64:67],v[96:99]
 ds_read_b64_tr_b16 a[152:153],v15 offset:14432
 v_mfma_f32_16x16x32_bf16 v[96:99],a[132:135],a[68:71],v[96:99]
 v_mfma_f32_16x16x32_bf16 v[100:103],a[128:131],a[72:75],v[100:103]
 ds_read_b64_tr_b16 a[154:155],v16 offset:14432
 v_mfma_f32_16x16x32_bf16 v[100:103],a[132:135],a[76:79],v[100:103]
 v_mfma_f32_16x16x32_bf16 v[104:107],a[128:131],a[80:83],v[104:107]
 ds_read_b64_tr_b16 a[156:157],v15 offset:21600
 v_mfma_f32_16x16x32_bf16 v[104:107],a[132:135],a[84:87],v[104:107]
 v_mfma_f32_16x16x32_bf16 v[108:111],a[128:131],a[88:91],v[108:111]
 ds_read_b64_tr_b16 a[158:159],v16 offset:21600
 v_mfma_f32_16x16x32_bf16 v[108:111],a[132:135],a[92:95],v[108:111]
 v_mfma_f32_16x16x32_bf16 v[112:115],a[136:139],a[64:67],v[112:115]
 ds_read_b64_tr_b16 a[128:129],v15 offset:128
 v_mfma_f32_16x16x32_bf16 v[112:115],a[140:143],a[68:71],v[112:115]
 v_mfma_f32_16x16x32_bf16 v[116:119],a[136:139],a[72:75],v[116:119]
 ds_read_b64_tr_b16 a[130:131],v16 offset:128
 v_mfma_f32_16x16x32_bf16 v[116:119],a[140:143],a[76:79],v[116:119]
 v_mfma_f32_16x16x32_bf16 v[120:123],a[136:139],a[80:83],v[120:123]
 ds_read_b64_tr_b16 a[132:133],v15 offset:7296
 v_mfma_f32_16x16x32_bf16 v[120:123],a[140:143],a[84:87],v[120:123]
 v_mfma_f32_16x16x32_bf16 v[124:127],a[136:139],a[88:91],v[124:127]
 ds_read_b64_tr_b16 a[134:135],v16 offset:7296
 v_mfma_f32_16x16x32_bf16 v[124:127],a[140:143],a[92:95],v[124:127]
 s_waitcnt lgkmcnt(4)
 v_mfma_f32_16x16x32_bf16 v[128:131],a[144:147],a[64:67],v[128:131]
 ds_read_b64_tr_b16 a[136:137],v15 offset:14464
 v_mfma_f32_16x16x32_bf16 v[128:131],a[148:151],a[68:71],v[128:131]
 v_mfma_f32_16x16x32_bf16 v[132:135],a[144:147],a[72:75],v[132:135]
 ds_read_b64_tr_b16 a[138:139],v16 offset:14464
 v_mfma_f32_16x16x32_bf16 v[132:135],a[148:151],a[76:79],v[132:135]
 v_mfma_f32_16x16x32_bf16 v[136:139],a[144:147],a[80:83],v[136:139]
 ds_read_b64_tr_b16 a[140:141],v15 offset:21632
 v_mfma_f32_16x16x32_bf16 v[136:139],a[148:151],a[84:87],v[136:139]
 v_mfma_f32_16x16x32_bf16 v[140:143],a[144:147],a[88:91],v[140:143]
 ds_read_b64_tr_b16 a[142:143],v16 offset:21632
 v_mfma_f32_16x16x32_bf16 v[140:143],a[148:151],a[92:95],v[140:143]
 v_mfma_f32_16x16x32_bf16 v[144:147],a[152:155],a[64:67],v[144:147]
 ds_read_b64_tr_b16 a[144:145],v15 offset:160
 v_mfma_f32_16x16x32_bf16 v[144:147],a[156:159],a[68:71],v[144:147]
 v_mfma_f32_16x16x32_bf16 v[148:151],a[152:155],a[72:75],v[148:151]
 ds_read_b64_tr_b16 a[146:147],v16 offset:160
 v_mfma_f32_16x16x32_bf16 v[148:151],a[156:159],a[76:79],v[148:151]
 v_mfma_f32_16x16x32_bf16 v[152:155],a[152:155],a[80:83],v[152:155]
 ds_read_b64_tr_b16 a[148:149],v15 offset:7328
 v_mfma_f32_16x16x32_bf16 v[152:155],a[156:159],a[84:87],v[152:155]
 v_mfma_f32_16x16x32_bf16 v[156:159],a[152:155],a[88:91],v[156:159]
 ds_read_b64_tr_b16 a[150:151],v16 offset:7328
 v_mfma_f32_16x16x32_bf16 v[156:159],a[156:159],a[92:95],v[156:159]
 s_waitcnt lgkmcnt(4)
 v_mfma_f32_16x16x32_bf16 v[160:163],a[128:131],a[64:67],v[160:163]
 ds_read_b64_tr_b16 a[152:153],v15 offset:14496
 v_mfma_f32_16x16x32_bf16 v[160:163],a[132:135],a[68:71],v[160:163]
 v_mfma_f32_16x16x32_bf16 v[164:167],a[128:131],a[72:75],v[164:167]
 ds_read_b64_tr_b16 a[154:155],v16 offset:14496
 v_mfma_f32_16x16x32_bf16 v[164:167],a[132:135],a[76:79],v[164:167]
 v_mfma_f32_16x16x32_bf16 v[168:171],a[128:131],a[80:83],v[168:171]
 ds_read_b64_tr_b16 a[156:157],v15 offset:21664
 v_mfma_f32_16x16x32_bf16 v[168:171],a[132:135],a[84:87],v[168:171]
 v_mfma_f32_16x16x32_bf16 v[172:175],a[128:131],a[88:91],v[172:175]
 ds_read_b64_tr_b16 a[158:159],v16 offset:21664
 v_mfma_f32_16x16x32_bf16 v[172:175],a[132:135],a[92:95],v[172:175]
 v_mfma_f32_16x16x32_bf16 v[176:179],a[136:139],a[64:67],v[176:179]
 ds_read_b64_tr_b16 a[128:129],v15 offset:192
 v_mfma_f32_16x16x32_bf16 v[176:179],a[140:143],a[68:71],v[176:179]
 v_mfma_f32_16x16x32_bf16 v[180:183],a[136:139],a[72:75],v[180:183]
 ds_read_b64_tr_b16 a[130:131],v16 offset:192
 v_mfma_f32_16x16x32_bf16 v[180:183],a[140:143],a[76:79],v[180:183]
 v_mfma_f32_16x16x32_bf16 v[184:187],a[136:139],a[80:83],v[184:187]
 ds_read_b64_tr_b16 a[132:133],v15 offset:7360
 v_mfma_f32_16x16x32_bf16 v[184:187],a[140:143],a[84:87],v[184:187]
 v_mfma_f32_16x16x32_bf16 v[188:191],a[136:139],a[88:91],v[188:191]
 ds_read_b64_tr_b16 a[134:135],v16 offset:7360
 v_mfma_f32_16x16x32_bf16 v[188:191],a[140:143],a[92:95],v[188:191]
 s_waitcnt lgkmcnt(4)
 v_mfma_f32_16x16x32_bf16 v[192:195],a[144:147],a[64:67],v[192:195]
 ds_read_b64_tr_b16 a[136:137],v15 offset:14528
 v_mfma_f32_16x16x32_bf16 v[192:195],a[148:151],a[68:71],v[192:195]
 v_mfma_f32_16x16x32_bf16 v[196:199],a[144:147],a[72:75],v[196:199]
 ds_read_b64_tr_b16 a[138:139],v16 offset:14528
 v_mfma_f32_16x16x32_bf16 v[196:199],a[148:151],a[76:79],v[196:199]
 buffer_load_dwordx4 v14,s[12:15],s58 offen offset:2048 lds
 v_mfma_f32_16x16x32_bf16 v[200:203],a[144:147],a[80:83],v[200:203]
 ds_read_b64_tr_b16 a[140:141],v15 offset:21696
 v_mfma_f32_16x16x32_bf16 v[200:203],a[148:151],a[84:87],v[200:203]
 v_mfma_f32_16x16x32_bf16 v[204:207],a[144:147],a[88:91],v[204:207]
 ds_read_b64_tr_b16 a[142:143],v16 offset:21696
 v_mfma_f32_16x16x32_bf16 v[204:207],a[148:151],a[92:95],v[204:207]
 s_waitcnt vmcnt(20)
 s_barrier
 v_mfma_f32_16x16x32_bf16 v[208:211],a[152:155],a[64:67],v[208:211]
 ds_read_b64_tr_b16 a[144:145],v15 offset:28672
 s_add_u32 s57,s57,8192
 v_mfma_f32_16x16x32_bf16 v[208:211],a[156:159],a[68:71],v[208:211]
 buffer_load_dwordx4 a[0:3],v4,s[8:11],s57 offen offset:0 sc1
 v_mfma_f32_16x16x32_bf16 v[212:215],a[152:155],a[72:75],v[212:215]
 ds_read_b64_tr_b16 a[146:147],v16 offset:28672
 v_mfma_f32_16x16x32_bf16 v[212:215],a[156:159],a[76:79],v[212:215]
 buffer_load_dwordx4 a[4:7],v4,s[8:11],s57 offen offset:1024 sc1
 v_mfma_f32_16x16x32_bf16 v[216:219],a[152:155],a[80:83],v[216:219]
 ds_read_b64_tr_b16 a[148:149],v15 offset:35840
 v_mfma_f32_16x16x32_bf16 v[216:219],a[156:159],a[84:87],v[216:219]
 v_mfma_f32_16x16x32_bf16 v[220:223],a[152:155],a[88:91],v[220:223]
 ds_read_b64_tr_b16 a[150:151],v16 offset:35840
 v_mfma_f32_16x16x32_bf16 v[220:223],a[156:159],a[92:95],v[220:223]
 s_waitcnt lgkmcnt(4)
 v_mfma_f32_16x16x32_bf16 v[224:227],a[128:131],a[64:67],v[224:227]
 ds_read_b64_tr_b16 a[152:153],v15 offset:43008
 v_mfma_f32_16x16x32_bf16 v[224:227],a[132:135],a[68:71],v[224:227]
 buffer_load_dwordx4 a[8:11],v4,s[8:11],s57 offen offset:2048 sc1
 v_mfma_f32_16x16x32_bf16 v[228:231],a[128:131],a[72:75],v[228:231]
 ds_read_b64_tr_b16 a[154:155],v16 offset:43008
 v_mfma_f32_16x16x32_bf16 v[228:231],a[132:135],a[76:79],v[228:231]
 v_mfma_f32_16x16x32_bf16 v[232:235],a[128:131],a[80:83],v[232:235]
 ds_read_b64_tr_b16 a[156:157],v15 offset:50176
 v_mfma_f32_16x16x32_bf16 v[232:235],a[132:135],a[84:87],v[232:235]
 v_mfma_f32_16x16x32_bf16 v[236:239],a[128:131],a[88:91],v[236:239]
 ds_read_b64_tr_b16 a[158:159],v16 offset:50176
 v_mfma_f32_16x16x32_bf16 v[236:239],a[132:135],a[92:95],v[236:239]
 v_mfma_f32_16x16x32_bf16 v[240:243],a[136:139],a[64:67],v[240:243]
 ds_read_b64_tr_b16 a[128:129],v15 offset:28704
 v_mfma_f32_16x16x32_bf16 v[240:243],a[140:143],a[68:71],v[240:243]
 buffer_load_dwordx4 a[12:15],v4,s[8:11],s57 offen offset:3072 sc1
 v_mfma_f32_16x16x32_bf16 v[244:247],a[136:139],a[72:75],v[244:247]
 ds_read_b64_tr_b16 a[130:131],v16 offset:28704
 v_mfma_f32_16x16x32_bf16 v[244:247],a[140:143],a[76:79],v[244:247]
 v_mfma_f32_16x16x32_bf16 v[248:251],a[136:139],a[80:83],v[248:251]
 ds_read_b64_tr_b16 a[132:133],v15 offset:35872
 v_mfma_f32_16x16x32_bf16 v[248:251],a[140:143],a[84:87],v[248:251]
 buffer_load_dwordx4 a[16:19],v5,s[8:11],s57 offen offset:0 sc1
 v_mfma_f32_16x16x32_bf16 v[252:255],a[136:139],a[88:91],v[252:255]
 ds_read_b64_tr_b16 a[134:135],v16 offset:35872
 v_mfma_f32_16x16x32_bf16 v[252:255],a[140:143],a[92:95],v[252:255]
 s_waitcnt vmcnt(17)
 s_waitcnt lgkmcnt(4)
 v_mfma_f32_16x16x32_bf16 v[32:35],a[144:147],a[96:99],v[32:35]
 ds_read_b64_tr_b16 a[136:137],v15 offset:43040
 v_mfma_f32_16x16x32_bf16 v[32:35],a[148:151],a[100:103],v[32:35]
 buffer_load_dwordx4 a[20:23],v5,s[8:11],s57 offen offset:1024 sc1
 v_mfma_f32_16x16x32_bf16 v[36:39],a[144:147],a[104:107],v[36:39]
 ds_read_b64_tr_b16 a[138:139],v16 offset:43040
 v_mfma_f32_16x16x32_bf16 v[36:39],a[148:151],a[108:111],v[36:39]
 v_mfma_f32_16x16x32_bf16 v[40:43],a[144:147],a[112:115],v[40:43]
 ds_read_b64_tr_b16 a[140:141],v15 offset:50208
 v_mfma_f32_16x16x32_bf16 v[40:43],a[148:151],a[116:119],v[40:43]
 v_mfma_f32_16x16x32_bf16 v[44:47],a[144:147],a[120:123],v[44:47]
 ds_read_b64_tr_b16 a[142:143],v16 offset:50208
 v_mfma_f32_16x16x32_bf16 v[44:47],a[148:151],a[124:127],v[44:47]
 buffer_load_dwordx4 a[24:27],v5,s[8:11],s57 offen offset:2048 sc1
 v_mfma_f32_16x16x32_bf16 v[48:51],a[152:155],a[96:99],v[48:51]
 ds_read_b64_tr_b16 a[144:145],v15 offset:28736
 v_mfma_f32_16x16x32_bf16 v[48:51],a[156:159],a[100:103],v[48:51]
 v_mfma_f32_16x16x32_bf16 v[52:55],a[152:155],a[104:107],v[52:55]
 ds_read_b64_tr_b16 a[146:147],v16 offset:28736
 v_mfma_f32_16x16x32_bf16 v[52:55],a[156:159],a[108:111],v[52:55]
 buffer_load_dwordx4 a[28:31],v5,s[8:11],s57 offen offset:3072 sc1
 v_mfma_f32_16x16x32_bf16 v[56:59],a[152:155],a[112:115],v[56:59]
 ds_read_b64_tr_b16 a[148:149],v15 offset:35904
 v_mfma_f32_16x16x32_bf16 v[56:59],a[156:159],a[116:119],v[56:59]
 v_mfma_f32_16x16x32_bf16 v[60:63],a[152:155],a[120:123],v[60:63]
 ds_read_b64_tr_b16 a[150:151],v16 offset:35904
 v_mfma_f32_16x16x32_bf16 v[60:63],a[156:159],a[124:127],v[60:63]
 s_add_u32 s58,s58,458752
 s_waitcnt lgkmcnt(4)
 v_mfma_f32_16x16x32_bf16 v[64:67],a[128:131],a[96:99],v[64:67]
 ds_read_b64_tr_b16 a[152:153],v15 offset:43072
 s_add_u32 m0,s52,86016
 v_mfma_f32_16x16x32_bf16 v[64:67],a[132:135],a[100:103],v[64:67]
 buffer_load_dwordx4 v8,s[12:15],s58 offen offset:0 lds
 v_mfma_f32_16x16x32_bf16 v[68:71],a[128:131],a[104:107],v[68:71]
 ds_read_b64_tr_b16 a[154:155],v16 offset:43072
 v_mfma_f32_16x16x32_bf16 v[68:71],a[132:135],a[108:111],v[68:71]
 v_mfma_f32_16x16x32_bf16 v[72:75],a[128:131],a[112:115],v[72:75]
 ds_read_b64_tr_b16 a[156:157],v15 offset:50240
 v_mfma_f32_16x16x32_bf16 v[72:75],a[132:135],a[116:119],v[72:75]
 buffer_load_dwordx4 v9,s[12:15],s58 offen offset:1024 lds
 v_mfma_f32_16x16x32_bf16 v[76:79],a[128:131],a[120:123],v[76:79]
 ds_read_b64_tr_b16 a[158:159],v16 offset:50240
 v_mfma_f32_16x16x32_bf16 v[76:79],a[132:135],a[124:127],v[76:79]
 v_mfma_f32_16x16x32_bf16 v[80:83],a[136:139],a[96:99],v[80:83]
 ds_read_b64_tr_b16 a[128:129],v15 offset:28768
 v_mfma_f32_16x16x32_bf16 v[80:83],a[140:143],a[100:103],v[80:83]
 buffer_load_dwordx4 v10,s[12:15],s58 offen offset:2048 lds
 v_mfma_f32_16x16x32_bf16 v[84:87],a[136:139],a[104:107],v[84:87]
 ds_read_b64_tr_b16 a[130:131],v16 offset:28768
 v_mfma_f32_16x16x32_bf16 v[84:87],a[140:143],a[108:111],v[84:87]
 v_mfma_f32_16x16x32_bf16 v[88:91],a[136:139],a[112:115],v[88:91]
 ds_read_b64_tr_b16 a[132:133],v15 offset:35936
 v_mfma_f32_16x16x32_bf16 v[88:91],a[140:143],a[116:119],v[88:91]
 v_mfma_f32_16x16x32_bf16 v[92:95],a[136:139],a[120:123],v[92:95]
 ds_read_b64_tr_b16 a[134:135],v16 offset:35936
 v_mfma_f32_16x16x32_bf16 v[92:95],a[140:143],a[124:127],v[92:95]
 s_waitcnt lgkmcnt(4)
 v_mfma_f32_16x16x32_bf16 v[96:99],a[144:147],a[96:99],v[96:99]
 ds_read_b64_tr_b16 a[136:137],v15 offset:43104
 v_mfma_f32_16x16x32_bf16 v[96:99],a[148:151],a[100:103],v[96:99]
 buffer_load_dwordx4 v11,s[12:15],s58 offen offset:3072 lds
 v_mfma_f32_16x16x32_bf16 v[100:103],a[144:147],a[104:107],v[100:103]
 ds_read_b64_tr_b16 a[138:139],v16 offset:43104
 v_mfma_f32_16x16x32_bf16 v[100:103],a[148:151],a[108:111],v[100:103]
 v_mfma_f32_16x16x32_bf16 v[104:107],a[144:147],a[112:115],v[104:107]
 ds_read_b64_tr_b16 a[140:141],v15 offset:50272
 s_add_u32 m0,s52,90112
 v_mfma_f32_16x16x32_bf16 v[104:107],a[148:151],a[116:119],v[104:107]
 buffer_load_dwordx4 v12,s[12:15],s58 offen offset:0 lds
 v_mfma_f32_16x16x32_bf16 v[108:111],a[144:147],a[120:123],v[108:111]
 ds_read_b64_tr_b16 a[142:143],v16 offset:50272
 v_mfma_f32_16x16x32_bf16 v[108:111],a[148:151],a[124:127],v[108:111]
 v_mfma_f32_16x16x32_bf16 v[112:115],a[152:155],a[96:99],v[112:115]
 ds_read_b64_tr_b16 a[144:145],v15 offset:28800
 v_mfma_f32_16x16x32_bf16 v[112:115],a[156:159],a[100:103],v[112:115]
 buffer_load_dwordx4 v13,s[12:15],s58 offen offset:1024 lds
 v_mfma_f32_16x16x32_bf16 v[116:119],a[152:155],a[104:107],v[116:119]
 ds_read_b64_tr_b16 a[146:147],v16 offset:28800
 v_mfma_f32_16x16x32_bf16 v[116:119],a[156:159],a[108:111],v[116:119]
 v_mfma_f32_16x16x32_bf16 v[120:123],a[152:155],a[112:115],v[120:123]
 ds_read_b64_tr_b16 a[148:149],v15 offset:35968
 v_mfma_f32_16x16x32_bf16 v[120:123],a[156:159],a[116:119],v[120:123]
 buffer_load_dwordx4 v14,s[12:15],s58 offen offset:2048 lds
 v_mfma_f32_16x16x32_bf16 v[124:127],a[152:155],a[120:123],v[124:127]
 ds_read_b64_tr_b16 a[150:151],v16 offset:35968
 v_mfma_f32_16x16x32_bf16 v[124:127],a[156:159],a[124:127],v[124:127]
 s_waitcnt lgkmcnt(4)
 v_mfma_f32_16x16x32_bf16 v[128:131],a[128:131],a[96:99],v[128:131]
 ds_read_b64_tr_b16 a[152:153],v15 offset:43136
 v_mfma_f32_16x16x32_bf16 v[128:131],a[132:135],a[100:103],v[128:131]
 s_add_u32 s58,s58,458752
 v_mfma_f32_16x16x32_bf16 v[132:135],a[128:131],a[104:107],v[132:135]
 ds_read_b64_tr_b16 a[154:155],v16 offset:43136
 s_add_u32 m0,s52,114688
 v_mfma_f32_16x16x32_bf16 v[132:135],a[132:135],a[108:111],v[132:135]
 buffer_load_dwordx4 v8,s[12:15],s58 offen offset:0 lds
 v_mfma_f32_16x16x32_bf16 v[136:139],a[128:131],a[112:115],v[136:139]
 ds_read_b64_tr_b16 a[156:157],v15 offset:50304
 v_mfma_f32_16x16x32_bf16 v[136:139],a[132:135],a[116:119],v[136:139]
 v_mfma_f32_16x16x32_bf16 v[140:143],a[128:131],a[120:123],v[140:143]
 ds_read_b64_tr_b16 a[158:159],v16 offset:50304
 v_mfma_f32_16x16x32_bf16 v[140:143],a[132:135],a[124:127],v[140:143]
 buffer_load_dwordx4 v9,s[12:15],s58 offen offset:1024 lds
 v_mfma_f32_16x16x32_bf16 v[144:147],a[136:139],a[96:99],v[144:147]
 ds_read_b64_tr_b16 a[128:129],v15 offset:28832
 v_mfma_f32_16x16x32_bf16 v[144:147],a[140:143],a[100:103],v[144:147]
 v_mfma_f32_16x16x32_bf16 v[148:151],a[136:139],a[104:107],v[148:151]
 ds_read_b64_tr_b16 a[130:131],v16 offset:28832
 v_mfma_f32_16x16x32_bf16 v[148:151],a[140:143],a[108:111],v[148:151]
 buffer_load_dwordx4 v10,s[12:15],s58 offen offset:2048 lds
 v_mfma_f32_16x16x32_bf16 v[152:155],a[136:139],a[112:115],v[152:155]
 ds_read_b64_tr_b16 a[132:133],v15 offset:36000
 v_mfma_f32_16x16x32_bf16 v[152:155],a[140:143],a[116:119],v[152:155]
 v_mfma_f32_16x16x32_bf16 v[156:159],a[136:139],a[120:123],v[156:159]
 ds_read_b64_tr_b16 a[134:135],v16 offset:36000
 v_mfma_f32_16x16x32_bf16 v[156:159],a[140:143],a[124:127],v[156:159]
 s_waitcnt lgkmcnt(4)
 v_mfma_f32_16x16x32_bf16 v[160:163],a[144:147],a[96:99],v[160:163]
 ds_read_b64_tr_b16 a[136:137],v15 offset:43168
 s_mov_b32 s3,4194304
 v_mfma_f32_16x16x32_bf16 v[160:163],a[148:151],a[100:103],v[160:163]
 buffer_load_dword v31,v3,s[16:19],s3 offen
 v_mfma_f32_16x16x32_bf16 v[164:167],a[144:147],a[104:107],v[164:167]
 ds_read_b64_tr_b16 a[138:139],v16 offset:43168
 s_mov_b32 s3,5242880
 v_mfma_f32_16x16x32_bf16 v[164:167],a[148:151],a[108:111],v[164:167]
 buffer_load_dword v31,v3,s[16:19],s3 offen
 v_mfma_f32_16x16x32_bf16 v[168:171],a[144:147],a[112:115],v[168:171]
 ds_read_b64_tr_b16 a[140:141],v15 offset:50336
 v_mfma_f32_16x16x32_bf16 v[168:171],a[148:151],a[116:119],v[168:171]
 v_mfma_f32_16x16x32_bf16 v[172:175],a[144:147],a[120:123],v[172:175]
 ds_read_b64_tr_b16 a[142:143],v16 offset:50336
 v_mov_b32 v3,v28
 v_mfma_f32_16x16x32_bf16 v[172:175],a[148:151],a[124:127],v[172:175]
 v_mfma_f32_16x16x32_bf16 v[176:179],a[152:155],a[96:99],v[176:179]
 ds_read_b64_tr_b16 a[144:145],v15 offset:28864
 v_mfma_f32_16x16x32_bf16 v[176:179],a[156:159],a[100:103],v[176:179]
 buffer_load_dwordx4 v11,s[12:15],s58 offen offset:3072 lds
 v_mfma_f32_16x16x32_bf16 v[180:183],a[152:155],a[104:107],v[180:183]
 ds_read_b64_tr_b16 a[146:147],v16 offset:28864
 v_mfma_f32_16x16x32_bf16 v[180:183],a[156:159],a[108:111],v[180:183]
 v_mfma_f32_16x16x32_bf16 v[184:187],a[152:155],a[112:115],v[184:187]
 ds_read_b64_tr_b16 a[148:149],v15 offset:36032
 s_add_u32 m0,s52,118784
 v_mfma_f32_16x16x32_bf16 v[184:187],a[156:159],a[116:119],v[184:187]
 buffer_load_dwordx4 v12,s[12:15],s58 offen offset:0 lds
 v_mfma_f32_16x16x32_bf16 v[188:191],a[152:155],a[120:123],v[188:191]
 ds_read_b64_tr_b16 a[150:151],v16 offset:36032
 v_mfma_f32_16x16x32_bf16 v[188:191],a[156:159],a[124:127],v[188:191]
 s_waitcnt lgkmcnt(4)
 v_mfma_f32_16x16x32_bf16 v[192:195],a[128:131],a[96:99],v[192:195]
 ds_read_b64_tr_b16 a[152:153],v15 offset:43200
 v_mfma_f32_16x16x32_bf16 v[192:195],a[132:135],a[100:103],v[192:195]
 v_mfma_f32_16x16x32_bf16 v[196:199],a[128:131],a[104:107],v[196:199]
 ds_read_b64_tr_b16 a[154:155],v16 offset:43200
 v_mfma_f32_16x16x32_bf16 v[196:199],a[132:135],a[108:111],v[196:199]
 buffer_load_dwordx4 v13,s[12:15],s58 offen offset:1024 lds
 v_mfma_f32_16x16x32_bf16 v[200:203],a[128:131],a[112:115],v[200:203]
 ds_read_b64_tr_b16 a[156:157],v15 offset:50368
 v_mfma_f32_16x16x32_bf16 v[200:203],a[132:135],a[116:119],v[200:203]
 v_mfma_f32_16x16x32_bf16 v[204:207],a[128:131],a[120:123],v[204:207]
 ds_read_b64_tr_b16 a[158:159],v16 offset:50368
 v_mfma_f32_16x16x32_bf16 v[204:207],a[132:135],a[124:127],v[204:207]
 s_waitcnt vmcnt(23)
 s_barrier
 v_mfma_f32_16x16x32_bf16 v[208:211],a[136:139],a[96:99],v[208:211]
 ds_read_b64_tr_b16 a[128:129],v17 offset:0
 v_mfma_f32_16x16x32_bf16 v[208:211],a[140:143],a[100:103],v[208:211]
 buffer_load_dwordx4 v14,s[12:15],s58 offen offset:2048 lds
 v_mfma_f32_16x16x32_bf16 v[212:215],a[136:139],a[104:107],v[212:215]
 ds_read_b64_tr_b16 a[130:131],v18 offset:0
 s_add_u32 s57,s57,8192
 v_mfma_f32_16x16x32_bf16 v[212:215],a[140:143],a[108:111],v[212:215]
 buffer_load_dwordx4 a[160:163],v4,s[8:11],s57 offen offset:0 sc1
 v_mfma_f32_16x16x32_bf16 v[216:219],a[136:139],a[112:115],v[216:219]
 ds_read_b64_tr_b16 a[132:133],v17 offset:7168
 v_mfma_f32_16x16x32_bf16 v[216:219],a[140:143],a[116:119],v[216:219]
 v_mfma_f32_16x16x32_bf16 v[220:223],a[136:139],a[120:123],v[220:223]
 ds_read_b64_tr_b16 a[134:135],v18 offset:7168
 v_mfma_f32_16x16x32_bf16 v[220:223],a[140:143],a[124:127],v[220:223]
 s_waitcnt lgkmcnt(4)
 v_mfma_f32_16x16x32_bf16 v[224:227],a[144:147],a[96:99],v[224:227]
 ds_read_b64_tr_b16 a[136:137],v17 offset:14336
 v_mfma_f32_16x16x32_bf16 v[224:227],a[148:151],a[100:103],v[224:227]
 buffer_load_dwordx4 a[164:167],v4,s[8:11],s57 offen offset:1024 sc1
 v_mfma_f32_16x16x32_bf16 v[228:231],a[144:147],a[104:107],v[228:231]
 ds_read_b64_tr_b16 a[138:139],v18 offset:14336
 v_mfma_f32_16x16x32_bf16 v[228:231],a[148:151],a[108:111],v[228:231]
 v_mfma_f32_16x16x32_bf16 v[232:235],a[144:147],a[112:115],v[232:235]
 ds_read_b64_tr_b16 a[140:141],v17 offset:21504
 v_mfma_f32_16x16x32_bf16 v[232:235],a[148:151],a[116:119],v[232:235]
 v_mfma_f32_16x16x32_bf16 v[236:239],a[144:147],a[120:123],v[236:239]
 ds_read_b64_tr_b16 a[142:143],v18 offset:21504
 v_mfma_f32_16x16x32_bf16 v[236:239],a[148:151],a[124:127],v[236:239]
 v_mfma_f32_16x16x32_bf16 v[240:243],a[152:155],a[96:99],v[240:243]
 ds_read_b64_tr_b16 a[144:145],v17 offset:32
 v_mfma_f32_16x16x32_bf16 v[240:243],a[156:159],a[100:103],v[240:243]
 v_mfma_f32_16x16x32_bf16 v[244:247],a[152:155],a[104:107],v[244:247]
 ds_read_b64_tr_b16 a[146:147],v18 offset:32
 v_mfma_f32_16x16x32_bf16 v[244:247],a[156:159],a[108:111],v[244:247]
 v_mfma_f32_16x16x32_bf16 v[248:251],a[152:155],a[112:115],v[248:251]
 ds_read_b64_tr_b16 a[148:149],v17 offset:7200
 v_mfma_f32_16x16x32_bf16 v[248:251],a[156:159],a[116:119],v[248:251]
 v_mfma_f32_16x16x32_bf16 v[252:255],a[152:155],a[120:123],v[252:255]
 ds_read_b64_tr_b16 a[150:151],v18 offset:7200
 v_mfma_f32_16x16x32_bf16 v[252:255],a[156:159],a[124:127],v[252:255]
 s_waitcnt vmcnt(18)
 s_waitcnt lgkmcnt(4)
 v_mfma_f32_16x16x32_bf16 v[32:35],a[128:131],a[0:3],v[32:35]
 ds_read_b64_tr_b16 a[152:153],v17 offset:14368
 v_mfma_f32_16x16x32_bf16 v[32:35],a[132:135],a[4:7],v[32:35]
 v_mfma_f32_16x16x32_bf16 v[36:39],a[128:131],a[8:11],v[36:39]
 ds_read_b64_tr_b16 a[154:155],v18 offset:14368
 v_mfma_f32_16x16x32_bf16 v[36:39],a[132:135],a[12:15],v[36:39]
 v_mfma_f32_16x16x32_bf16 v[40:43],a[128:131],a[16:19],v[40:43]
 ds_read_b64_tr_b16 a[156:157],v17 offset:21536
 v_mfma_f32_16x16x32_bf16 v[40:43],a[132:135],a[20:23],v[40:43]
 v_mfma_f32_16x16x32_bf16 v[44:47],a[128:131],a[24:27],v[44:47]
 ds_read_b64_tr_b16 a[158:159],v18 offset:21536
 v_mfma_f32_16x16x32_bf16 v[44:47],a[132:135],a[28:31],v[44:47]
 v_mfma_f32_16x16x32_bf16 v[48:51],a[136:139],a[0:3],v[48:51]
 ds_read_b64_tr_b16 a[128:129],v17 offset:64
 v_mfma_f32_16x16x32_bf16 v[48:51],a[140:143],a[4:7],v[48:51]
 v_mfma_f32_16x16x32_bf16 v[52:55],a[136:139],a[8:11],v[52:55]
 ds_read_b64_tr_b16 a[130:131],v18 offset:64
 v_mfma_f32_16x16x32_bf16 v[52:55],a[140:143],a[12:15],v[52:55]
 v_mfma_f32_16x16x32_bf16 v[56:59],a[136:139],a[16:19],v[56:59]
 ds_read_b64_tr_b16 a[132:133],v17 offset:7232
 v_mfma_f32_16x16x32_bf16 v[56:59],a[140:143],a[20:23],v[56:59]
 v_mfma_f32_16x16x32_bf16 v[60:63],a[136:139],a[24:27],v[60:63]
 ds_read_b64_tr_b16 a[134:135],v18 offset:7232
 v_mfma_f32_16x16x32_bf16 v[60:63],a[140:143],a[28:31],v[60:63]
 s_waitcnt lgkmcnt(4)
 v_mfma_f32_16x16x32_bf16 v[64:67],a[144:147],a[0:3],v[64:67]
 ds_read_b64_tr_b16 a[136:137],v17 offset:14400
 v_mfma_f32_16x16x32_bf16 v[64:67],a[148:151],a[4:7],v[64:67]
 v_mfma_f32_16x16x32_bf16 v[68:71],a[144:147],a[8:11],v[68:71]
 ds_read_b64_tr_b16 a[138:139],v18 offset:14400
 v_mfma_f32_16x16x32_bf16 v[68:71],a[148:151],a[12:15],v[68:71]
 v_mfma_f32_16x16x32_bf16 v[72:75],a[144:147],a[16:19],v[72:75]
 ds_read_b64_tr_b16 a[140:141],v17 offset:21568
 v_mfma_f32_16x16x32_bf16 v[72:75],a[148:151],a[20:23],v[72:75]
 v_mfma_f32_16x16x32_bf16 v[76:79],a[144:147],a[24:27],v[76:79]
 ds_read_b64_tr_b16 a[142:143],v18 offset:21568
 v_mfma_f32_16x16x32_bf16 v[76:79],a[148:151],a[28:31],v[76:79]
 v_mfma_f32_16x16x32_bf16 v[80:83],a[152:155],a[0:3],v[80:83]
 ds_read_b64_tr_b16 a[144:145],v17 offset:96
 v_mfma_f32_16x16x32_bf16 v[80:83],a[156:159],a[4:7],v[80:83]
 v_mfma_f32_16x16x32_bf16 v[84:87],a[152:155],a[8:11],v[84:87]
 ds_read_b64_tr_b16 a[146:147],v18 offset:96
 v_mfma_f32_16x16x32_bf16 v[84:87],a[156:159],a[12:15],v[84:87]
 v_mfma_f32_16x16x32_bf16 v[88:91],a[152:155],a[16:19],v[88:91]
 ds_read_b64_tr_b16 a[148:149],v17 offset:7264
 v_mfma_f32_16x16x32_bf16 v[88:91],a[156:159],a[20:23],v[88:91]
 v_mfma_f32_16x16x32_bf16 v[92:95],a[152:155],a[24:27],v[92:95]
 ds_read_b64_tr_b16 a[150:151],v18 offset:7264
 v_mfma_f32_16x16x32_bf16 v[92:95],a[156:159],a[28:31],v[92:95]
 s_waitcnt lgkmcnt(4)
 v_mfma_f32_16x16x32_bf16 v[96:99],a[128:131],a[0:3],v[96:99]
 ds_read_b64_tr_b16 a[152:153],v17 offset:14432
 v_mfma_f32_16x16x32_bf16 v[96:99],a[132:135],a[4:7],v[96:99]
 buffer_load_dwordx4 a[168:171],v4,s[8:11],s57 offen offset:2048 sc1
 v_mfma_f32_16x16x32_bf16 v[100:103],a[128:131],a[8:11],v[100:103]
 ds_read_b64_tr_b16 a[154:155],v18 offset:14432
 v_mfma_f32_16x16x32_bf16 v[100:103],a[132:135],a[12:15],v[100:103]
 buffer_load_dwordx4 a[172:175],v4,s[8:11],s57 offen offset:3072 sc1
 v_mfma_f32_16x16x32_bf16 v[104:107],a[128:131],a[16:19],v[104:107]
 ds_read_b64_tr_b16 a[156:157],v17 offset:21600
 v_mfma_f32_16x16x32_bf16 v[104:107],a[132:135],a[20:23],v[104:107]
 buffer_load_dwordx4 a[176:179],v5,s[8:11],s57 offen offset:0 sc1
 v_mfma_f32_16x16x32_bf16 v[108:111],a[128:131],a[24:27],v[108:111]
 ds_read_b64_tr_b16 a[158:159],v18 offset:21600
 v_mfma_f32_16x16x32_bf16 v[108:111],a[132:135],a[28:31],v[108:111]
 buffer_load_dwordx4 a[180:183],v5,s[8:11],s57 offen offset:1024 sc1
 v_mfma_f32_16x16x32_bf16 v[112:115],a[136:139],a[0:3],v[112:115]
 ds_read_b64_tr_b16 a[128:129],v17 offset:128
 v_mfma_f32_16x16x32_bf16 v[112:115],a[140:143],a[4:7],v[112:115]
 buffer_load_dwordx4 a[184:187],v5,s[8:11],s57 offen offset:2048 sc1
 v_mfma_f32_16x16x32_bf16 v[116:119],a[136:139],a[8:11],v[116:119]
 ds_read_b64_tr_b16 a[130:131],v18 offset:128
 s_add_u32 s58,s58,458752
 v_mfma_f32_16x16x32_bf16 v[116:119],a[140:143],a[12:15],v[116:119]
 buffer_load_dwordx4 a[188:191],v5,s[8:11],s57 offen offset:3072 sc1
 v_mfma_f32_16x16x32_bf16 v[120:123],a[136:139],a[16:19],v[120:123]
 ds_read_b64_tr_b16 a[132:133],v17 offset:7296
 s_add_u32 m0,s52,0
 v_mfma_f32_16x16x32_bf16 v[120:123],a[140:143],a[20:23],v[120:123]
 buffer_load_dwordx4 v8,s[12:15],s58 offen offset:0 lds
 v_mfma_f32_16x16x32_bf16 v[124:127],a[136:139],a[24:27],v[124:127]
 ds_read_b64_tr_b16 a[134:135],v18 offset:7296
 v_mfma_f32_16x16x32_bf16 v[124:127],a[140:143],a[28:31],v[124:127]
 s_waitcnt lgkmcnt(4)
 v_mfma_f32_16x16x32_bf16 v[128:131],a[144:147],a[0:3],v[128:131]
 ds_read_b64_tr_b16 a[136:137],v17 offset:14464
 v_mfma_f32_16x16x32_bf16 v[128:131],a[148:151],a[4:7],v[128:131]
 buffer_load_dwordx4 v9,s[12:15],s58 offen offset:1024 lds
 v_mfma_f32_16x16x32_bf16 v[132:135],a[144:147],a[8:11],v[132:135]
 ds_read_b64_tr_b16 a[138:139],v18 offset:14464
 v_mfma_f32_16x16x32_bf16 v[132:135],a[148:151],a[12:15],v[132:135]
 buffer_load_dwordx4 v10,s[12:15],s58 offen offset:2048 lds
 v_mfma_f32_16x16x32_bf16 v[136:139],a[144:147],a[16:19],v[136:139]
 ds_read_b64_tr_b16 a[140:141],v17 offset:21632
 v_mfma_f32_16x16x32_bf16 v[136:139],a[148:151],a[20:23],v[136:139]
 buffer_load_dwordx4 v11,s[12:15],s58 offen offset:3072 lds
 v_mfma_f32_16x16x32_bf16 v[140:143],a[144:147],a[24:27],v[140:143]
 ds_read_b64_tr_b16 a[142:143],v18 offset:21632
 s_add_u32 m0,s52,4096
 v_mfma_f32_16x16x32_bf16 v[140:143],a[148:151],a[28:31],v[140:143]
 buffer_load_dwordx4 v12,s[12:15],s58 offen offset:0 lds
 v_mfma_f32_16x16x32_bf16 v[144:147],a[152:155],a[0:3],v[144:147]
 ds_read_b64_tr_b16 a[144:145],v17 offset:160
 v_mfma_f32_16x16x32_bf16 v[144:147],a[156:159],a[4:7],v[144:147]
 buffer_load_dwordx4 v13,s[12:15],s58 offen offset:1024 lds
 v_mfma_f32_16x16x32_bf16 v[148:151],a[152:155],a[8:11],v[148:151]
 ds_read_b64_tr_b16 a[146:147],v18 offset:160
 v_mfma_f32_16x16x32_bf16 v[148:151],a[156:159],a[12:15],v[148:151]
 buffer_load_dwordx4 v14,s[12:15],s58 offen offset:2048 lds
 v_mfma_f32_16x16x32_bf16 v[152:155],a[152:155],a[16:19],v[152:155]
 ds_read_b64_tr_b16 a[148:149],v17 offset:7328
L_w6:
 s_cbranch_execz L_w10
 s_add_u32 s57,s57,8192
 v_mfma_f32_16x16x32_bf16 v[152:155],a[156:159],a[20:23],v[152:155]
 buffer_load_dwordx4 a[192:195],v4,s[8:11],s57 offen offset:0 sc1
 v_mfma_f32_16x16x32_bf16 v[156:159],a[152:155],a[24:27],v[156:159]
 ds_read_b64_tr_b16 a[150:151],v18 offset:7328
 v_and_b32 v8,12,v1
 v_mfma_f32_16x16x32_bf16 v[156:159],a[156:159],a[28:31],v[156:159]
 v_and_b32 v2,1,v1
 s_waitcnt lgkmcnt(4)
 v_mfma_f32_16x16x32_bf16 v[160:163],a[128:131],a[0:3],v[160:163]
 ds_read_b64_tr_b16 a[152:153],v17 offset:14496
 v_lshl_or_b32 v8,v2,1,v8
 v_mfma_f32_16x16x32_bf16 v[160:163],a[132:135],a[4:7],v[160:163]
 buffer_load_dwordx4 a[196:199],v4,s[8:11],s57 offen offset:1024 sc1
 v_mfma_f32_16x16x32_bf16 v[164:167],a[128:131],a[8:11],v[164:167]
 ds_read_b64_tr_b16 a[154:155],v18 offset:14496
 v_bfe_u32 v2,v1,1,1
 v_mfma_f32_16x16x32_bf16 v[164:167],a[132:135],a[12:15],v[164:167]
 buffer_load_dwordx4 a[200:203],v4,s[8:11],s57 offen offset:2048 sc1
 v_mfma_f32_16x16x32_bf16 v[168:171],a[128:131],a[16:19],v[168:171]
 ds_read_b64_tr_b16 a[156:157],v17 offset:21664
 v_or_b32 v8,v8,v2
 v_mfma_f32_16x16x32_bf16 v[168:171],a[132:135],a[20:23],v[168:171]
 buffer_load_dwordx4 a[204:207],v4,s[8:11],s57 offen offset:3072 sc1
 v_mfma_f32_16x16x32_bf16 v[172:175],a[128:131],a[24:27],v[172:175]
 ds_read_b64_tr_b16 a[158:159],v18 offset:21664
 v_lshlrev_b32 v8,4,v8
 v_mfma_f32_16x16x32_bf16 v[172:175],a[132:135],a[28:31],v[172:175]
 buffer_load_dwordx4 a[208:211],v5,s[8:11],s57 offen offset:0 sc1
 v_mfma_f32_16x16x32_bf16 v[176:179],a[136:139],a[0:3],v[176:179]
 ds_read_b64_tr_b16 a[128:129],v17 offset:192
 v_lshrrev_b32 v2,5,v1
 v_mfma_f32_16x16x32_bf16 v[176:179],a[140:143],a[4:7],v[176:179]
 buffer_load_dwordx4 a[212:215],v5,s[8:11],s57 offen offset:1024 sc1
 v_mfma_f32_16x16x32_bf16 v[180:183],a[136:139],a[8:11],v[180:183]
 ds_read_b64_tr_b16 a[130:131],v18 offset:192
 v_lshl_add_u32 v8,v2,17,v8
 v_mfma_f32_16x16x32_bf16 v[180:183],a[140:143],a[12:15],v[180:183]
 buffer_load_dwordx4 a[216:219],v5,s[8:11],s57 offen offset:2048 sc1
 v_mfma_f32_16x16x32_bf16 v[184:187],a[136:139],a[16:19],v[184:187]
 ds_read_b64_tr_b16 a[132:133],v17 offset:7360
 v_bfe_u32 v2,v1,4,1
 v_mfma_f32_16x16x32_bf16 v[184:187],a[140:143],a[20:23],v[184:187]
 buffer_load_dwordx4 a[220:223],v5,s[8:11],s57 offen offset:3072 sc1
 v_mfma_f32_16x16x32_bf16 v[188:191],a[136:139],a[24:27],v[188:191]
 ds_read_b64_tr_b16 a[134:135],v18 offset:7360
 v_lshl_add_u32 v8,v2,15,v8
 v_mfma_f32_16x16x32_bf16 v[188:191],a[140:143],a[28:31],v[188:191]
 v_add_u32 v8,s84,v8
 s_waitcnt lgkmcnt(4)
 v_mfma_f32_16x16x32_bf16 v[192:195],a[144:147],a[0:3],v[192:195]
 ds_read_b64_tr_b16 a[136:137],v17 offset:14528
 s_add_u32 s57,s57,8192
 v_mfma_f32_16x16x32_bf16 v[192:195],a[148:151],a[4:7],v[192:195]
 buffer_load_dwordx4 a[224:227],v4,s[8:11],s57 offen offset:0 sc1
 v_mfma_f32_16x16x32_bf16 v[196:199],a[144:147],a[8:11],v[196:199]
 ds_read_b64_tr_b16 a[138:139],v18 offset:14528
 v_add_u32 v9,7104,v8
 v_mfma_f32_16x16x32_bf16 v[196:199],a[148:151],a[12:15],v[196:199]
 buffer_load_dwordx4 a[228:231],v4,s[8:11],s57 offen offset:1024 sc1
 v_mfma_f32_16x16x32_bf16 v[200:203],a[144:147],a[16:19],v[200:203]
 ds_read_b64_tr_b16 a[140:141],v17 offset:21696
 v_add_u32 v10,14208,v8
 v_mfma_f32_16x16x32_bf16 v[200:203],a[148:151],a[20:23],v[200:203]
 buffer_load_dwordx4 a[232:235],v4,s[8:11],s57 offen offset:2048 sc1
 v_mfma_f32_16x16x32_bf16 v[204:207],a[144:147],a[24:27],v[204:207]
 ds_read_b64_tr_b16 a[142:143],v18 offset:21696
 v_add_u32 v11,21312,v8
 v_mfma_f32_16x16x32_bf16 v[204:207],a[148:151],a[28:31],v[204:207]
 s_waitcnt vmcnt(35)
 s_barrier
 v_mfma_f32_16x16x32_bf16 v[208:211],a[152:155],a[0:3],v[208:211]
 ds_read_b64_tr_b16 a[144:145],v17 offset:28672
 v_mfma_f32_16x16x32_bf16 v[208:211],a[156:159],a[4:7],v[208:211]
 buffer_load_dwordx4 a[236:239],v4,s[8:11],s57 offen offset:3072 sc1
 v_mfma_f32_16x16x32_bf16 v[212:215],a[152:155],a[8:11],v[212:215]
 ds_read_b64_tr_b16 a[146:147],v18 offset:28672
 v_mfma_f32_16x16x32_bf16 v[212:215],a[156:159],a[12:15],v[212:215]
 buffer_load_dwordx4 a[240:243],v5,s[8:11],s57 offen offset:0 sc1
 v_mfma_f32_16x16x32_bf16 v[216:219],a[152:155],a[16:19],v[216:219]
 ds_read_b64_tr_b16 a[148:149],v17 offset:35840
 v_mfma_f32_16x16x32_bf16 v[216:219],a[156:159],a[20:23],v[216:219]
 buffer_load_dwordx4 a[244:247],v5,s[8:11],s57 offen offset:1024 sc1
 v_mfma_f32_16x16x32_bf16 v[220:223],a[152:155],a[24:27],v[220:223]
 ds_read_b64_tr_b16 a[150:151],v18 offset:35840
 v_mfma_f32_16x16x32_bf16 v[220:223],a[156:159],a[28:31],v[220:223]
 s_waitcnt lgkmcnt(4)
 v_mfma_f32_16x16x32_bf16 v[224:227],a[128:131],a[0:3],v[224:227]
 ds_read_b64_tr_b16 a[152:153],v17 offset:43008
 v_mfma_f32_16x16x32_bf16 v[224:227],a[132:135],a[4:7],v[224:227]
 buffer_load_dwordx4 a[248:251],v5,s[8:11],s57 offen offset:2048 sc1
 v_mfma_f32_16x16x32_bf16 v[228:231],a[128:131],a[8:11],v[228:231]
 ds_read_b64_tr_b16 a[154:155],v18 offset:43008
 v_mfma_f32_16x16x32_bf16 v[228:231],a[132:135],a[12:15],v[228:231]
 buffer_load_dwordx4 a[252:255],v5,s[8:11],s57 offen offset:3072 sc1
 v_mfma_f32_16x16x32_bf16 v[232:235],a[128:131],a[16:19],v[232:235]
 ds_read_b64_tr_b16 a[156:157],v17 offset:50176
 v_mfma_f32_16x16x32_bf16 v[232:235],a[132:135],a[20:23],v[232:235]
 v_mfma_f32_16x16x32_bf16 v[236:239],a[128:131],a[24:27],v[236:239]
 ds_read_b64_tr_b16 a[158:159],v18 offset:50176
 v_mfma_f32_16x16x32_bf16 v[236:239],a[132:135],a[28:31],v[236:239]
 s_waitcnt vmcnt(31)
 s_barrier
 v_mfma_f32_16x16x32_bf16 v[240:243],a[136:139],a[0:3],v[240:243]
 ds_read_b64_tr_b16 a[128:129],v19 offset:0
 v_mfma_f32_16x16x32_bf16 v[240:243],a[140:143],a[4:7],v[240:243]
 v_mfma_f32_16x16x32_bf16 v[244:247],a[136:139],a[8:11],v[244:247]
 ds_read_b64_tr_b16 a[130:131],v20 offset:0
 v_mfma_f32_16x16x32_bf16 v[244:247],a[140:143],a[12:15],v[244:247]
 v_mfma_f32_16x16x32_bf16 v[248:251],a[136:139],a[16:19],v[248:251]
 ds_read_b64_tr_b16 a[132:133],v19 offset:7168
 v_mfma_f32_16x16x32_bf16 v[248:251],a[140:143],a[20:23],v[248:251]
 v_mfma_f32_16x16x32_bf16 v[252:255],a[136:139],a[24:27],v[252:255]
 ds_read_b64_tr_b16 a[134:135],v20 offset:7168
 v_mfma_f32_16x16x32_bf16 v[252:255],a[140:143],a[28:31],v[252:255]
 s_waitcnt vmcnt(23)
 s_waitcnt lgkmcnt(4)
 v_mfma_f32_16x16x32_bf16 v[32:35],a[144:147],a[160:163],v[32:35]
 ds_read_b64_tr_b16 a[136:137],v19 offset:14336
 v_mfma_f32_16x16x32_bf16 v[32:35],a[148:151],a[164:167],v[32:35]
 v_mfma_f32_16x16x32_bf16 v[36:39],a[144:147],a[168:171],v[36:39]
 ds_read_b64_tr_b16 a[138:139],v20 offset:14336
 v_mfma_f32_16x16x32_bf16 v[36:39],a[148:151],a[172:175],v[36:39]
 v_mfma_f32_16x16x32_bf16 v[40:43],a[144:147],a[176:179],v[40:43]
 ds_read_b64_tr_b16 a[140:141],v19 offset:21504
 v_mfma_f32_16x16x32_bf16 v[40:43],a[148:151],a[180:183],v[40:43]
 v_mfma_f32_16x16x32_bf16 v[44:47],a[144:147],a[184:187],v[44:47]
 ds_read_b64_tr_b16 a[142:143],v20 offset:21504
 v_mfma_f32_16x16x32_bf16 v[44:47],a[148:151],a[188:191],v[44:47]
 s_waitcnt vmcnt(16)
 s_barrier
 v_mfma_f32_16x16x32_bf16 v[48:51],a[152:155],a[160:163],v[48:51]
 ds_read_b64_tr_b16 a[144:145],v15 offset:0
 v_mfma_f32_16x16x32_bf16 v[48:51],a[156:159],a[164:167],v[48:51]
 v_mfma_f32_16x16x32_bf16 v[52:55],a[152:155],a[168:171],v[52:55]
 ds_read_b64_tr_b16 a[146:147],v16 offset:0
 v_mfma_f32_16x16x32_bf16 v[52:55],a[156:159],a[172:175],v[52:55]
 v_mfma_f32_16x16x32_bf16 v[56:59],a[152:155],a[176:179],v[56:59]
 ds_read_b64_tr_b16 a[148:149],v15 offset:7168
 v_mfma_f32_16x16x32_bf16 v[56:59],a[156:159],a[180:183],v[56:59]
 v_mfma_f32_16x16x32_bf16 v[60:63],a[152:155],a[184:187],v[60:63]
 ds_read_b64_tr_b16 a[150:151],v16 offset:7168
 v_mfma_f32_16x16x32_bf16 v[60:63],a[156:159],a[188:191],v[60:63]
 s_waitcnt vmcnt(8)
 s_waitcnt lgkmcnt(4)
 v_mfma_f32_16x16x32_bf16 v[32:35],a[128:131],a[192:195],v[32:35]
 ds_read_b64_tr_b16 a[152:153],v15 offset:14336
 v_mfma_f32_16x16x32_bf16 v[32:35],a[132:135],a[196:199],v[32:35]
 v_mfma_f32_16x16x32_bf16 v[36:39],a[128:131],a[200:203],v[36:39]
 ds_read_b64_tr_b16 a[154:155],v16 offset:14336
 v_mfma_f32_16x16x32_bf16 v[36:39],a[132:135],a[204:207],v[36:39]
 v_mfma_f32_16x16x32_bf16 v[40:43],a[128:131],a[208:211],v[40:43]
 ds_read_b64_tr_b16 a[156:157],v15 offset:21504
 v_mfma_f32_16x16x32_bf16 v[40:43],a[132:135],a[212:215],v[40:43]
 v_mfma_f32_16x16x32_bf16 v[44:47],a[128:131],a[216:219],v[44:47]
 ds_read_b64_tr_b16 a[158:159],v16 offset:21504
 v_mfma_f32_16x16x32_bf16 v[44:47],a[132:135],a[220:223],v[44:47]
 v_mfma_f32_16x16x32_bf16 v[48:51],a[136:139],a[192:195],v[48:51]
 ds_read_b64_tr_b16 a[128:129],v17 offset:28704
 v_mfma_f32_16x16x32_bf16 v[48:51],a[140:143],a[196:199],v[48:51]
 v_mfma_f32_16x16x32_bf16 v[52:55],a[136:139],a[200:203],v[52:55]
 ds_read_b64_tr_b16 a[130:131],v18 offset:28704
 v_mfma_f32_16x16x32_bf16 v[52:55],a[140:143],a[204:207],v[52:55]
 v_mfma_f32_16x16x32_bf16 v[56:59],a[136:139],a[208:211],v[56:59]
 ds_read_b64_tr_b16 a[132:133],v17 offset:35872
 v_mfma_f32_16x16x32_bf16 v[56:59],a[140:143],a[212:215],v[56:59]
 v_mfma_f32_16x16x32_bf16 v[60:63],a[136:139],a[216:219],v[60:63]
 ds_read_b64_tr_b16 a[134:135],v18 offset:35872
 v_mfma_f32_16x16x32_bf16 v[60:63],a[140:143],a[220:223],v[60:63]
 s_waitcnt vmcnt(0)
 s_waitcnt lgkmcnt(4)
 v_mfma_f32_16x16x32_bf16 v[32:35],a[144:147],a[224:227],v[32:35]
 ds_read_b64_tr_b16 a[136:137],v17 offset:43040
 v_mfma_f32_16x16x32_bf16 v[32:35],a[148:151],a[228:231],v[32:35]
 v_mfma_f32_16x16x32_bf16 v[36:39],a[144:147],a[232:235],v[36:39]
 ds_read_b64_tr_b16 a[138:139],v18 offset:43040
 v_mfma_f32_16x16x32_bf16 v[36:39],a[148:151],a[236:239],v[36:39]
 v_mfma_f32_16x16x32_bf16 v[40:43],a[144:147],a[240:243],v[40:43]
 ds_read_b64_tr_b16 a[140:141],v17 offset:50208
 v_mfma_f32_16x16x32_bf16 v[40:43],a[148:151],a[244:247],v[40:43]
 v_mfma_f32_16x16x32_bf16 v[44:47],a[144:147],a[248:251],v[44:47]
 ds_read_b64_tr_b16 a[142:143],v18 offset:50208
 v_mfma_f32_16x16x32_bf16 v[44:47],a[148:151],a[252:255],v[44:47]
 s_mov_b32 s63,6815744
 v_mfma_f32_16x16x32_bf16 v[48:51],a[152:155],a[224:227],v[48:51]
 ds_read_b64_tr_b16 a[144:145],v19 offset:32
 s_add_u32 m0,s51,0
 v_mfma_f32_16x16x32_bf16 v[48:51],a[156:159],a[228:231],v[48:51]
 buffer_load_dwordx4 v8,s[16:19],s63 offen offset:0 lds
 v_mfma_f32_16x16x32_bf16 v[52:55],a[152:155],a[232:235],v[52:55]
 ds_read_b64_tr_b16 a[146:147],v20 offset:32
 v_mfma_f32_16x16x32_bf16 v[52:55],a[156:159],a[236:239],v[52:55]
 buffer_load_dwordx4 v9,s[16:19],s63 offen offset:1088 lds
 v_mfma_f32_16x16x32_bf16 v[56:59],a[152:155],a[240:243],v[56:59]
 ds_read_b64_tr_b16 a[148:149],v19 offset:7200
 v_mfma_f32_16x16x32_bf16 v[56:59],a[156:159],a[244:247],v[56:59]
 buffer_load_dwordx4 v10,s[16:19],s63 offen offset:2176 lds
 v_mfma_f32_16x16x32_bf16 v[60:63],a[152:155],a[248:251],v[60:63]
 ds_read_b64_tr_b16 a[150:151],v20 offset:7200
 v_mfma_f32_16x16x32_bf16 v[60:63],a[156:159],a[252:255],v[60:63]
 s_waitcnt lgkmcnt(4)
 v_mfma_f32_16x16x32_bf16 v[64:67],a[128:131],a[160:163],v[64:67]
 ds_read_b64_tr_b16 a[152:153],v19 offset:14368
 v_mfma_f32_16x16x32_bf16 v[64:67],a[132:135],a[164:167],v[64:67]
 buffer_load_dwordx4 v11,s[16:19],s63 offen offset:3264 lds
 v_mfma_f32_16x16x32_bf16 v[68:71],a[128:131],a[168:171],v[68:71]
 ds_read_b64_tr_b16 a[154:155],v20 offset:14368
 v_mfma_f32_16x16x32_bf16 v[68:71],a[132:135],a[172:175],v[68:71]
 v_mul_f32 v24,v32,v32
 v_mul_f32 v25,v33,v33
 v_mfma_f32_16x16x32_bf16 v[72:75],a[128:131],a[176:179],v[72:75]
 ds_read_b64_tr_b16 a[156:157],v19 offset:21536
 v_mul_f32 v26,v34,v34
 v_mfma_f32_16x16x32_bf16 v[72:75],a[132:135],a[180:183],v[72:75]
 v_mul_f32 v27,v35,v35
 v_mul_f32 v48,v32,v48
 v_mfma_f32_16x16x32_bf16 v[76:79],a[128:131],a[184:187],v[76:79]
 ds_read_b64_tr_b16 a[158:159],v20 offset:21536
 v_mul_f32 v49,v33,v49
 v_mfma_f32_16x16x32_bf16 v[76:79],a[132:135],a[188:191],v[76:79]
 v_mul_f32 v50,v34,v50
 v_mul_f32 v51,v35,v51
 v_mfma_f32_16x16x32_bf16 v[80:83],a[136:139],a[160:163],v[80:83]
 ds_read_b64_tr_b16 a[128:129],v15 offset:32
 v_fma_f32 v24,v24,s82,v7
 v_mfma_f32_16x16x32_bf16 v[80:83],a[140:143],a[164:167],v[80:83]
 v_fma_f32 v25,v25,s82,v7
 v_fma_f32 v26,v26,s82,v7
 v_mfma_f32_16x16x32_bf16 v[84:87],a[136:139],a[168:171],v[84:87]
 ds_read_b64_tr_b16 a[130:131],v16 offset:32
 v_fma_f32 v27,v27,s82,v7
 v_mfma_f32_16x16x32_bf16 v[84:87],a[140:143],a[172:175],v[84:87]
 v_mul_f32 v32,v24,v32
 v_mul_f32 v33,v25,v33
 v_mfma_f32_16x16x32_bf16 v[88:91],a[136:139],a[176:179],v[88:91]
 ds_read_b64_tr_b16 a[132:133],v15 offset:7200
 v_mul_f32 v34,v26,v34
 v_mfma_f32_16x16x32_bf16 v[88:91],a[140:143],a[180:183],v[88:91]
 v_mul_f32 v35,v27,v35
 v_mul_f32 v28,v36,v36
 v_mfma_f32_16x16x32_bf16 v[92:95],a[136:139],a[184:187],v[92:95]
 ds_read_b64_tr_b16 a[134:135],v16 offset:7200
 v_mul_f32 v29,v37,v37
 v_mfma_f32_16x16x32_bf16 v[92:95],a[140:143],a[188:191],v[92:95]
 v_mul_f32 v24,v38,v38
 s_waitcnt lgkmcnt(4)
 v_mfma_f32_16x16x32_bf16 v[64:67],a[144:147],a[192:195],v[64:67]
 ds_read_b64_tr_b16 a[136:137],v15 offset:14368
 v_mul_f32 v25,v39,v39
 v_mfma_f32_16x16x32_bf16 v[64:67],a[148:151],a[196:199],v[64:67]
 v_exp_f32 v32,v32
 v_mfma_f32_16x16x32_bf16 v[68:71],a[144:147],a[200:203],v[68:71]
 ds_read_b64_tr_b16 a[138:139],v16 offset:14368
 v_add_f32 v32,1.0,v32
 v_mfma_f32_16x16x32_bf16 v[68:71],a[148:151],a[204:207],v[68:71]
 v_exp_f32 v33,v33
 v_mfma_f32_16x16x32_bf16 v[72:75],a[144:147],a[208:211],v[72:75]
 ds_read_b64_tr_b16 a[140:141],v15 offset:21536
 v_add_f32 v33,1.0,v33
 v_mfma_f32_16x16x32_bf16 v[72:75],a[148:151],a[212:215],v[72:75]
 v_exp_f32 v34,v34
 v_mfma_f32_16x16x32_bf16 v[76:79],a[144:147],a[216:219],v[76:79]
 ds_read_b64_tr_b16 a[142:143],v16 offset:21536
 v_add_f32 v34,1.0,v34
 v_mfma_f32_16x16x32_bf16 v[76:79],a[148:151],a[220:223],v[76:79]
 v_exp_f32 v35,v35
 v_mfma_f32_16x16x32_bf16 v[80:83],a[152:155],a[192:195],v[80:83]
 ds_read_b64_tr_b16 a[144:145],v17 offset:28736
 v_add_f32 v35,1.0,v35
 v_mfma_f32_16x16x32_bf16 v[80:83],a[156:159],a[196:199],v[80:83]
 v_rcp_f32 v32,v32
 v_mfma_f32_16x16x32_bf16 v[84:87],a[152:155],a[200:203],v[84:87]
 ds_read_b64_tr_b16 a[146:147],v18 offset:28736
 v_mul_f32 v48,v48,v32
 v_mfma_f32_16x16x32_bf16 v[84:87],a[156:159],a[204:207],v[84:87]
 v_rcp_f32 v33,v33
 v_mfma_f32_16x16x32_bf16 v[88:91],a[152:155],a[208:211],v[88:91]
 ds_read_b64_tr_b16 a[148:149],v17 offset:35904
 v_mul_f32 v49,v49,v33
 v_mfma_f32_16x16x32_bf16 v[88:91],a[156:159],a[212:215],v[88:91]
 v_rcp_f32 v34,v34
 v_mfma_f32_16x16x32_bf16 v[92:95],a[152:155],a[216:219],v[92:95]
 ds_read_b64_tr_b16 a[150:151],v18 offset:35904
 v_mul_f32 v50,v50,v34
 v_mfma_f32_16x16x32_bf16 v[92:95],a[156:159],a[220:223],v[92:95]
 s_add_u32 s63,s63,524288
 s_waitcnt lgkmcnt(4)
 v_mfma_f32_16x16x32_bf16 v[64:67],a[128:131],a[224:227],v[64:67]
 ds_read_b64_tr_b16 a[152:153],v17 offset:43072
 s_add_u32 m0,s51,52608
 v_mfma_f32_16x16x32_bf16 v[64:67],a[132:135],a[228:231],v[64:67]
 buffer_load_dwordx4 v8,s[16:19],s63 offen offset:0 lds
 v_mfma_f32_16x16x32_bf16 v[68:71],a[128:131],a[232:235],v[68:71]
 ds_read_b64_tr_b16 a[154:155],v18 offset:43072
 v_cvt_pk_bf16_f32 v32,v48,v49
 v_mfma_f32_16x16x32_bf16 v[68:71],a[132:135],a[236:239],v[68:71]
 buffer_load_dwordx4 v9,s[16:19],s63 offen offset:1088 lds
 v_mfma_f32_16x16x32_bf16 v[72:75],a[128:131],a[240:243],v[72:75]
 ds_read_b64_tr_b16 a[156:157],v17 offset:50240
 v_mul_f32 v52,v36,v52
 v_mfma_f32_16x16x32_bf16 v[72:75],a[132:135],a[244:247],v[72:75]
 buffer_load_dwordx4 v10,s[16:19],s63 offen offset:2176 lds
 v_mfma_f32_16x16x32_bf16 v[76:79],a[128:131],a[248:251],v[76:79]
 ds_read_b64_tr_b16 a[158:159],v18 offset:50240
 v_mul_f32 v53,v37,v53
 v_mfma_f32_16x16x32_bf16 v[76:79],a[132:135],a[252:255],v[76:79]
 buffer_load_dwordx4 v11,s[16:19],s63 offen offset:3264 lds
 v_mfma_f32_16x16x32_bf16 v[80:83],a[136:139],a[224:227],v[80:83]
 ds_read_b64_tr_b16 a[128:129],v19 offset:64
 v_mul_f32 v54,v38,v54
 v_mfma_f32_16x16x32_bf16 v[80:83],a[140:143],a[228:231],v[80:83]
 v_rcp_f32 v35,v35
 v_mfma_f32_16x16x32_bf16 v[84:87],a[136:139],a[232:235],v[84:87]
 ds_read_b64_tr_b16 a[130:131],v20 offset:64
 v_mul_f32 v51,v51,v35
 v_mfma_f32_16x16x32_bf16 v[84:87],a[140:143],a[236:239],v[84:87]
 v_cvt_pk_bf16_f32 v33,v50,v51
 v_mul_f32 v55,v39,v55
 v_mfma_f32_16x16x32_bf16 v[88:91],a[136:139],a[240:243],v[88:91]
 ds_read_b64_tr_b16 a[132:133],v19 offset:7232
 v_fma_f32 v28,v28,s82,v7
 v_mfma_f32_16x16x32_bf16 v[88:91],a[140:143],a[244:247],v[88:91]
 v_fma_f32 v29,v29,s82,v7
 v_fma_f32 v24,v24,s82,v7
 v_mfma_f32_16x16x32_bf16 v[92:95],a[136:139],a[248:251],v[92:95]
 ds_read_b64_tr_b16 a[134:135],v20 offset:7232
 v_fma_f32 v25,v25,s82,v7
 v_mfma_f32_16x16x32_bf16 v[92:95],a[140:143],a[252:255],v[92:95]
 v_mul_f32 v36,v28,v36
 s_waitcnt lgkmcnt(4)
 v_mfma_f32_16x16x32_bf16 v[96:99],a[144:147],a[160:163],v[96:99]
 ds_read_b64_tr_b16 a[136:137],v19 offset:14400
 v_mul_f32 v37,v29,v37
 v_mfma_f32_16x16x32_bf16 v[96:99],a[148:151],a[164:167],v[96:99]
 v_mul_f32 v38,v24,v38
 v_mul_f32 v39,v25,v39
 v_mfma_f32_16x16x32_bf16 v[100:103],a[144:147],a[168:171],v[100:103]
 ds_read_b64_tr_b16 a[138:139],v20 offset:14400
 v_mul_f32 v26,v40,v40
 v_mfma_f32_16x16x32_bf16 v[100:103],a[148:151],a[172:175],v[100:103]
 v_exp_f32 v36,v36
 v_mfma_f32_16x16x32_bf16 v[104:107],a[144:147],a[176:179],v[104:107]
 ds_read_b64_tr_b16 a[140:141],v19 offset:21568
 v_add_f32 v36,1.0,v36
 v_mfma_f32_16x16x32_bf16 v[104:107],a[148:151],a[180:183],v[104:107]
 v_exp_f32 v37,v37
 v_mfma_f32_16x16x32_bf16 v[108:111],a[144:147],a[184:187],v[108:111]
 ds_read_b64_tr_b16 a[142:143],v20 offset:21568
 v_add_f32 v37,1.0,v37
 v_mfma_f32_16x16x32_bf16 v[108:111],a[148:151],a[188:191],v[108:111]
 v_exp_f32 v38,v38
 v_mfma_f32_16x16x32_bf16 v[112:115],a[152:155],a[160:163],v[112:115]
 ds_read_b64_tr_b16 a[144:145],v15 offset:64
 v_add_f32 v38,1.0,v38
 v_mfma_f32_16x16x32_bf16 v[112:115],a[156:159],a[164:167],v[112:115]
 v_exp_f32 v39,v39
 v_mfma_f32_16x16x32_bf16 v[116:119],a[152:155],a[168:171],v[116:119]
 ds_read_b64_tr_b16 a[146:147],v16 offset:64
 v_add_f32 v39,1.0,v39
 v_mfma_f32_16x16x32_bf16 v[116:119],a[156:159],a[172:175],v[116:119]
 v_rcp_f32 v36,v36
 v_mfma_f32_16x16x32_bf16 v[120:123],a[152:155],a[176:179],v[120:123]
 ds_read_b64_tr_b16 a[148:149],v15 offset:7232
 v_mul_f32 v52,v52,v36
 v_mfma_f32_16x16x32_bf16 v[120:123],a[156:159],a[180:183],v[120:123]
 v_rcp_f32 v37,v37
 v_mfma_f32_16x16x32_bf16 v[124:127],a[152:155],a[184:187],v[124:127]
 ds_read_b64_tr_b16 a[150:151],v16 offset:7232
 v_mul_f32 v53,v53,v37
 v_mfma_f32_16x16x32_bf16 v[124:127],a[156:159],a[188:191],v[124:127]
 v_cvt_pk_bf16_f32 v36,v52,v53
 s_waitcnt lgkmcnt(4)
 v_mfma_f32_16x16x32_bf16 v[96:99],a[128:131],a[192:195],v[96:99]
 ds_read_b64_tr_b16 a[152:153],v15 offset:14400
 v_mul_f32 v27,v41,v41
 v_mfma_f32_16x16x32_bf16 v[96:99],a[132:135],a[196:199],v[96:99]
 v_rcp_f32 v38,v38
 v_mfma_f32_16x16x32_bf16 v[100:103],a[128:131],a[200:203],v[100:103]
 ds_read_b64_tr_b16 a[154:155],v16 offset:14400
 v_mul_f32 v54,v54,v38
 v_mfma_f32_16x16x32_bf16 v[100:103],a[132:135],a[204:207],v[100:103]
 v_rcp_f32 v39,v39
 v_mfma_f32_16x16x32_bf16 v[104:107],a[128:131],a[208:211],v[104:107]
 ds_read_b64_tr_b16 a[156:157],v15 offset:21568
 v_mul_f32 v55,v55,v39
 v_mfma_f32_16x16x32_bf16 v[104:107],a[132:135],a[212:215],v[104:107]
 v_cvt_pk_bf16_f32 v37,v54,v55
 v_mul_f32 v28,v42,v42
 v_mfma_f32_16x16x32_bf16 v[108:111],a[128:131],a[216:219],v[108:111]
 ds_read_b64_tr_b16 a[158:159],v16 offset:21568
 v_mul_f32 v29,v43,v43
 v_mfma_f32_16x16x32_bf16 v[108:111],a[132:135],a[220:223],v[108:111]
 v_mul_f32 v56,v40,v56
 v_mul_f32 v57,v41,v57
 v_mfma_f32_16x16x32_bf16 v[112:115],a[136:139],a[192:195],v[112:115]
 ds_read_b64_tr_b16 a[128:129],v17 offset:28768
 v_mul_f32 v58,v42,v58
 v_mfma_f32_16x16x32_bf16 v[112:115],a[140:143],a[196:199],v[112:115]
 v_mul_f32 v59,v43,v59
 v_fma_f32 v26,v26,s82,v7
 v_mfma_f32_16x16x32_bf16 v[116:119],a[136:139],a[200:203],v[116:119]
 ds_read_b64_tr_b16 a[130:131],v18 offset:28768
 v_fma_f32 v27,v27,s82,v7
 v_mfma_f32_16x16x32_bf16 v[116:119],a[140:143],a[204:207],v[116:119]
 v_fma_f32 v28,v28,s82,v7
 v_fma_f32 v29,v29,s82,v7
 v_mfma_f32_16x16x32_bf16 v[120:123],a[136:139],a[208:211],v[120:123]
 ds_read_b64_tr_b16 a[132:133],v17 offset:35936
 v_mul_f32 v40,v26,v40
 v_mfma_f32_16x16x32_bf16 v[120:123],a[140:143],a[212:215],v[120:123]
 v_mul_f32 v41,v27,v41
 v_mul_f32 v42,v28,v42
 v_mfma_f32_16x16x32_bf16 v[124:127],a[136:139],a[216:219],v[124:127]
 ds_read_b64_tr_b16 a[134:135],v18 offset:35936
 v_mul_f32 v43,v29,v43
 v_mfma_f32_16x16x32_bf16 v[124:127],a[140:143],a[220:223],v[124:127]
 v_mul_f32 v24,v44,v44
 s_waitcnt lgkmcnt(4)
 v_mfma_f32_16x16x32_bf16 v[96:99],a[144:147],a[224:227],v[96:99]
 ds_read_b64_tr_b16 a[136:137],v17 offset:43104
 v_mul_f32 v25,v45,v45
 v_mfma_f32_16x16x32_bf16 v[96:99],a[148:151],a[228:231],v[96:99]
 v_exp_f32 v40,v40
 v_mfma_f32_16x16x32_bf16 v[100:103],a[144:147],a[232:235],v[100:103]
 ds_read_b64_tr_b16 a[138:139],v18 offset:43104
 v_add_f32 v40,1.0,v40
 v_mfma_f32_16x16x32_bf16 v[100:103],a[148:151],a[236:239],v[100:103]
 v_exp_f32 v41,v41
 v_mfma_f32_16x16x32_bf16 v[104:107],a[144:147],a[240:243],v[104:107]
 ds_read_b64_tr_b16 a[140:141],v17 offset:50272
 v_add_f32 v41,1.0,v41
 v_mfma_f32_16x16x32_bf16 v[104:107],a[148:151],a[244:247],v[104:107]
 v_exp_f32 v42,v42
 v_mfma_f32_16x16x32_bf16 v[108:111],a[144:147],a[248:251],v[108:111]
 ds_read_b64_tr_b16 a[142:143],v18 offset:50272
 v_add_f32 v42,1.0,v42
 v_mfma_f32_16x16x32_bf16 v[108:111],a[148:151],a[252:255],v[108:111]
 v_exp_f32 v43,v43
 v_mfma_f32_16x16x32_bf16 v[112:115],a[152:155],a[224:227],v[112:115]
 ds_read_b64_tr_b16 a[144:145],v19 offset:96
 v_add_f32 v43,1.0,v43
 v_mfma_f32_16x16x32_bf16 v[112:115],a[156:159],a[228:231],v[112:115]
 v_rcp_f32 v40,v40
 v_mfma_f32_16x16x32_bf16 v[116:119],a[152:155],a[232:235],v[116:119]
 ds_read_b64_tr_b16 a[146:147],v20 offset:96
 v_mul_f32 v56,v56,v40
 v_mfma_f32_16x16x32_bf16 v[116:119],a[156:159],a[236:239],v[116:119]
 v_rcp_f32 v41,v41
 v_mfma_f32_16x16x32_bf16 v[120:123],a[152:155],a[240:243],v[120:123]
 ds_read_b64_tr_b16 a[148:149],v19 offset:7264
 v_mul_f32 v57,v57,v41
 v_mfma_f32_16x16x32_bf16 v[120:123],a[156:159],a[244:247],v[120:123]
 v_rcp_f32 v42,v42
 v_mfma_f32_16x16x32_bf16 v[124:127],a[152:155],a[248:251],v[124:127]
 ds_read_b64_tr_b16 a[150:151],v20 offset:7264
 v_mul_f32 v58,v58,v42
 v_mfma_f32_16x16x32_bf16 v[124:127],a[156:159],a[252:255],v[124:127]
 s_add_u32 s63,s63,524288
 s_waitcnt lgkmcnt(4)
 v_mfma_f32_16x16x32_bf16 v[128:131],a[128:131],a[160:163],v[128:131]
 ds_read_b64_tr_b16 a[152:153],v19 offset:14432
 s_add_u32 m0,s51,70144
 v_mfma_f32_16x16x32_bf16 v[128:131],a[132:135],a[164:167],v[128:131]
 buffer_load_dwordx4 v8,s[16:19],s63 offen offset:0 lds
 v_mfma_f32_16x16x32_bf16 v[132:135],a[128:131],a[168:171],v[132:135]
 ds_read_b64_tr_b16 a[154:155],v20 offset:14432
 v_cvt_pk_bf16_f32 v40,v56,v57
 v_mfma_f32_16x16x32_bf16 v[132:135],a[132:135],a[172:175],v[132:135]
 buffer_load_dwordx4 v9,s[16:19],s63 offen offset:1088 lds
 v_mfma_f32_16x16x32_bf16 v[136:139],a[128:131],a[176:179],v[136:139]
 ds_read_b64_tr_b16 a[156:157],v19 offset:21600
 v_mul_f32 v26,v46,v46
 v_mfma_f32_16x16x32_bf16 v[136:139],a[132:135],a[180:183],v[136:139]
 buffer_load_dwordx4 v10,s[16:19],s63 offen offset:2176 lds
 v_mfma_f32_16x16x32_bf16 v[140:143],a[128:131],a[184:187],v[140:143]
 ds_read_b64_tr_b16 a[158:159],v20 offset:21600
 v_mul_f32 v27,v47,v47
 v_mfma_f32_16x16x32_bf16 v[140:143],a[132:135],a[188:191],v[140:143]
 buffer_load_dwordx4 v11,s[16:19],s63 offen offset:3264 lds
 v_mfma_f32_16x16x32_bf16 v[144:147],a[136:139],a[160:163],v[144:147]
 ds_read_b64_tr_b16 a[128:129],v15 offset:96
 v_mul_f32 v60,v44,v60
 v_mfma_f32_16x16x32_bf16 v[144:147],a[140:143],a[164:167],v[144:147]
 v_rcp_f32 v43,v43
 v_mfma_f32_16x16x32_bf16 v[148:151],a[136:139],a[168:171],v[148:151]
 ds_read_b64_tr_b16 a[130:131],v16 offset:96
 v_mul_f32 v59,v59,v43
 v_mfma_f32_16x16x32_bf16 v[148:151],a[140:143],a[172:175],v[148:151]
 v_cvt_pk_bf16_f32 v41,v58,v59
 v_mul_f32 v61,v45,v61
 v_mfma_f32_16x16x32_bf16 v[152:155],a[136:139],a[176:179],v[152:155]
 ds_read_b64_tr_b16 a[132:133],v15 offset:7264
 v_mul_f32 v62,v46,v62
 v_mfma_f32_16x16x32_bf16 v[152:155],a[140:143],a[180:183],v[152:155]
 v_mul_f32 v63,v47,v63
 v_fma_f32 v24,v24,s82,v7
 v_mfma_f32_16x16x32_bf16 v[156:159],a[136:139],a[184:187],v[156:159]
 ds_read_b64_tr_b16 a[134:135],v16 offset:7264
 v_fma_f32 v25,v25,s82,v7
 v_mfma_f32_16x16x32_bf16 v[156:159],a[140:143],a[188:191],v[156:159]
 v_fma_f32 v26,v26,s82,v7
 s_waitcnt lgkmcnt(4)
 v_mfma_f32_16x16x32_bf16 v[128:131],a[144:147],a[192:195],v[128:131]
 ds_read_b64_tr_b16 a[136:137],v15 offset:14432
 v_fma_f32 v27,v27,s82,v7
 v_mfma_f32_16x16x32_bf16 v[128:131],a[148:151],a[196:199],v[128:131]
 v_mul_f32 v44,v24,v44
 v_mul_f32 v45,v25,v45
 v_mfma_f32_16x16x32_bf16 v[132:135],a[144:147],a[200:203],v[132:135]
 ds_read_b64_tr_b16 a[138:139],v16 offset:14432
 v_mul_f32 v46,v26,v46
 v_mfma_f32_16x16x32_bf16 v[132:135],a[148:151],a[204:207],v[132:135]
 v_mul_f32 v47,v27,v47
 v_mul_f32 v28,v64,v64
 v_mfma_f32_16x16x32_bf16 v[136:139],a[144:147],a[208:211],v[136:139]
 ds_read_b64_tr_b16 a[140:141],v15 offset:21600
 v_mul_f32 v29,v65,v65
 v_mfma_f32_16x16x32_bf16 v[136:139],a[148:151],a[212:215],v[136:139]
 v_exp_f32 v44,v44
 v_mfma_f32_16x16x32_bf16 v[140:143],a[144:147],a[216:219],v[140:143]
 ds_read_b64_tr_b16 a[142:143],v16 offset:21600
 v_add_f32 v44,1.0,v44
 v_mfma_f32_16x16x32_bf16 v[140:143],a[148:151],a[220:223],v[140:143]
 v_exp_f32 v45,v45
 v_mfma_f32_16x16x32_bf16 v[144:147],a[152:155],a[192:195],v[144:147]
 ds_read_b64_tr_b16 a[144:145],v17 offset:28800
 v_add_f32 v45,1.0,v45
 v_mfma_f32_16x16x32_bf16 v[144:147],a[156:159],a[196:199],v[144:147]
 v_exp_f32 v46,v46
 v_mfma_f32_16x16x32_bf16 v[148:151],a[152:155],a[200:203],v[148:151]
 ds_read_b64_tr_b16 a[146:147],v18 offset:28800
 v_add_f32 v46,1.0,v46
 v_mfma_f32_16x16x32_bf16 v[148:151],a[156:159],a[204:207],v[148:151]
 v_exp_f32 v47,v47
 v_mfma_f32_16x16x32_bf16 v[152:155],a[152:155],a[208:211],v[152:155]
 ds_read_b64_tr_b16 a[148:149],v17 offset:35968
 v_add_f32 v47,1.0,v47
 v_mfma_f32_16x16x32_bf16 v[152:155],a[156:159],a[212:215],v[152:155]
 v_rcp_f32 v44,v44
 v_mfma_f32_16x16x32_bf16 v[156:159],a[152:155],a[216:219],v[156:159]
 ds_read_b64_tr_b16 a[150:151],v18 offset:35968
 v_mul_f32 v60,v60,v44
 v_mfma_f32_16x16x32_bf16 v[156:159],a[156:159],a[220:223],v[156:159]
 v_mul_f32 v24,v66,v66
 s_waitcnt lgkmcnt(4)
 v_mfma_f32_16x16x32_bf16 v[128:131],a[128:131],a[224:227],v[128:131]
 ds_read_b64_tr_b16 a[152:153],v17 offset:43136
 v_mul_f32 v25,v67,v67
 v_mfma_f32_16x16x32_bf16 v[128:131],a[132:135],a[228:231],v[128:131]
 v_rcp_f32 v45,v45
 v_mfma_f32_16x16x32_bf16 v[132:135],a[128:131],a[232:235],v[132:135]
 ds_read_b64_tr_b16 a[154:155],v18 offset:43136
 v_mul_f32 v61,v61,v45
 v_mfma_f32_16x16x32_bf16 v[132:135],a[132:135],a[236:239],v[132:135]
 v_rcp_f32 v46,v46
 v_mfma_f32_16x16x32_bf16 v[136:139],a[128:131],a[240:243],v[136:139]
 ds_read_b64_tr_b16 a[156:157],v17 offset:50304
 v_mul_f32 v62,v62,v46
 v_mfma_f32_16x16x32_bf16 v[136:139],a[132:135],a[244:247],v[136:139]
 v_rcp_f32 v47,v47
 v_mfma_f32_16x16x32_bf16 v[140:143],a[128:131],a[248:251],v[140:143]
 ds_read_b64_tr_b16 a[158:159],v18 offset:50304
 v_mul_f32 v63,v63,v47
 v_mfma_f32_16x16x32_bf16 v[140:143],a[132:135],a[252:255],v[140:143]
 v_cvt_pk_bf16_f32 v44,v60,v61
 v_cvt_pk_bf16_f32 v45,v62,v63
 v_mfma_f32_16x16x32_bf16 v[144:147],a[136:139],a[224:227],v[144:147]
 ds_read_b64_tr_b16 a[128:129],v19 offset:128
 v_mul_f32 v80,v64,v80
 v_mfma_f32_16x16x32_bf16 v[144:147],a[140:143],a[228:231],v[144:147]
 v_mul_f32 v81,v65,v81
 v_mul_f32 v82,v66,v82
 v_mfma_f32_16x16x32_bf16 v[148:151],a[136:139],a[232:235],v[148:151]
 ds_read_b64_tr_b16 a[130:131],v20 offset:128
 v_mul_f32 v83,v67,v83
 v_mfma_f32_16x16x32_bf16 v[148:151],a[140:143],a[236:239],v[148:151]
 v_fma_f32 v28,v28,s82,v7
 v_fma_f32 v29,v29,s82,v7
 v_mfma_f32_16x16x32_bf16 v[152:155],a[136:139],a[240:243],v[152:155]
 ds_read_b64_tr_b16 a[132:133],v19 offset:7296
 v_fma_f32 v24,v24,s82,v7
 v_mfma_f32_16x16x32_bf16 v[152:155],a[140:143],a[244:247],v[152:155]
 v_fma_f32 v25,v25,s82,v7
 v_mul_f32 v64,v28,v64
 v_mfma_f32_16x16x32_bf16 v[156:159],a[136:139],a[248:251],v[156:159]
 ds_read_b64_tr_b16 a[134:135],v20 offset:7296
 v_mul_f32 v65,v29,v65
 v_mfma_f32_16x16x32_bf16 v[156:159],a[140:143],a[252:255],v[156:159]
L_w7:
 s_cbranch_execz L_w11
 v_mul_f32 v66,v24,v66
 s_waitcnt lgkmcnt(4)
 v_mfma_f32_16x16x32_bf16 v[160:163],a[144:147],a[160:163],v[160:163]
 ds_read_b64_tr_b16 a[136:137],v19 offset:14464
 v_mul_f32 v67,v25,v67
 v_mfma_f32_16x16x32_bf16 v[160:163],a[148:151],a[164:167],v[160:163]
 v_exp_f32 v64,v64
 v_mfma_f32_16x16x32_bf16 v[164:167],a[144:147],a[168:171],v[164:167]
 ds_read_b64_tr_b16 a[138:139],v20 offset:14464
 v_add_f32 v64,1.0,v64
 v_mfma_f32_16x16x32_bf16 v[164:167],a[148:151],a[172:175],v[164:167]
 v_exp_f32 v65,v65
 v_mfma_f32_16x16x32_bf16 v[168:171],a[144:147],a[176:179],v[168:171]
 ds_read_b64_tr_b16 a[140:141],v19 offset:21632
 v_add_f32 v65,1.0,v65
 v_mfma_f32_16x16x32_bf16 v[168:171],a[148:151],a[180:183],v[168:171]
 v_exp_f32 v66,v66
 v_mfma_f32_16x16x32_bf16 v[172:175],a[144:147],a[184:187],v[172:175]
 ds_read_b64_tr_b16 a[142:143],v20 offset:21632
 v_add_f32 v66,1.0,v66
 v_mfma_f32_16x16x32_bf16 v[172:175],a[148:151],a[188:191],v[172:175]
 v_exp_f32 v67,v67
 v_mfma_f32_16x16x32_bf16 v[176:179],a[152:155],a[160:163],v[176:179]
 ds_read_b64_tr_b16 a[144:145],v15 offset:128
 v_add_f32 v67,1.0,v67
 v_mfma_f32_16x16x32_bf16 v[176:179],a[156:159],a[164:167],v[176:179]
 v_rcp_f32 v64,v64
 v_mfma_f32_16x16x32_bf16 v[180:183],a[152:155],a[168:171],v[180:183]
 ds_read_b64_tr_b16 a[146:147],v16 offset:128
 v_mul_f32 v80,v80,v64
 v_mfma_f32_16x16x32_bf16 v[180:183],a[156:159],a[172:175],v[180:183]
 v_rcp_f32 v65,v65
 v_mfma_f32_16x16x32_bf16 v[184:187],a[152:155],a[176:179],v[184:187]
 ds_read_b64_tr_b16 a[148:149],v15 offset:7296
 v_mul_f32 v81,v81,v65
 v_mfma_f32_16x16x32_bf16 v[184:187],a[156:159],a[180:183],v[184:187]
 v_rcp_f32 v66,v66
 v_mfma_f32_16x16x32_bf16 v[188:191],a[152:155],a[184:187],v[188:191]
 ds_read_b64_tr_b16 a[150:151],v16 offset:7296
 v_mul_f32 v82,v82,v66
 v_mfma_f32_16x16x32_bf16 v[188:191],a[156:159],a[188:191],v[188:191]
 v_cvt_pk_bf16_f32 v34,v80,v81
 s_waitcnt lgkmcnt(4)
 v_mfma_f32_16x16x32_bf16 v[160:163],a[128:131],a[192:195],v[160:163]
 ds_read_b64_tr_b16 a[152:153],v15 offset:14464
 v_mul_f32 v26,v68,v68
 v_mfma_f32_16x16x32_bf16 v[160:163],a[132:135],a[196:199],v[160:163]
 v_rcp_f32 v67,v67
 v_mfma_f32_16x16x32_bf16 v[164:167],a[128:131],a[200:203],v[164:167]
 ds_read_b64_tr_b16 a[154:155],v16 offset:14464
 v_mul_f32 v83,v83,v67
 v_mfma_f32_16x16x32_bf16 v[164:167],a[132:135],a[204:207],v[164:167]
 v_cvt_pk_bf16_f32 v35,v82,v83
 v_mul_f32 v27,v69,v69
 v_mfma_f32_16x16x32_bf16 v[168:171],a[128:131],a[208:211],v[168:171]
 ds_read_b64_tr_b16 a[156:157],v15 offset:21632
 v_mul_f32 v28,v70,v70
 v_mfma_f32_16x16x32_bf16 v[168:171],a[132:135],a[212:215],v[168:171]
 buffer_store_dwordx4 v[32:35],v4,s[8:11],s64 offen offset:0 sc0 sc1
 v_mfma_f32_16x16x32_bf16 v[172:175],a[128:131],a[216:219],v[172:175]
 ds_read_b64_tr_b16 a[158:159],v16 offset:21632
 v_mul_f32 v29,v71,v71
 v_mfma_f32_16x16x32_bf16 v[172:175],a[132:135],a[220:223],v[172:175]
 v_mul_f32 v84,v68,v84
 v_mul_f32 v85,v69,v85
 v_mfma_f32_16x16x32_bf16 v[176:179],a[136:139],a[192:195],v[176:179]
 ds_read_b64_tr_b16 a[128:129],v17 offset:28832
 v_mul_f32 v86,v70,v86
 v_mfma_f32_16x16x32_bf16 v[176:179],a[140:143],a[196:199],v[176:179]
 v_mul_f32 v87,v71,v87
 v_fma_f32 v26,v26,s82,v7
 v_mfma_f32_16x16x32_bf16 v[180:183],a[136:139],a[200:203],v[180:183]
 ds_read_b64_tr_b16 a[130:131],v18 offset:28832
 v_fma_f32 v27,v27,s82,v7
 v_mfma_f32_16x16x32_bf16 v[180:183],a[140:143],a[204:207],v[180:183]
 v_fma_f32 v28,v28,s82,v7
 v_fma_f32 v29,v29,s82,v7
 v_mfma_f32_16x16x32_bf16 v[184:187],a[136:139],a[208:211],v[184:187]
 ds_read_b64_tr_b16 a[132:133],v17 offset:36000
 v_mul_f32 v68,v26,v68
 v_mfma_f32_16x16x32_bf16 v[184:187],a[140:143],a[212:215],v[184:187]
 v_mul_f32 v69,v27,v69
 v_mul_f32 v70,v28,v70
 v_mfma_f32_16x16x32_bf16 v[188:191],a[136:139],a[216:219],v[188:191]
 ds_read_b64_tr_b16 a[134:135],v18 offset:36000
 v_mul_f32 v71,v29,v71
 v_mfma_f32_16x16x32_bf16 v[188:191],a[140:143],a[220:223],v[188:191]
 v_mul_f32 v24,v72,v72
 s_waitcnt lgkmcnt(4)
 v_mfma_f32_16x16x32_bf16 v[160:163],a[144:147],a[224:227],v[160:163]
 ds_read_b64_tr_b16 a[136:137],v17 offset:43168
 v_mul_f32 v25,v73,v73
 v_mfma_f32_16x16x32_bf16 v[160:163],a[148:151],a[228:231],v[160:163]
 v_exp_f32 v68,v68
 v_mfma_f32_16x16x32_bf16 v[164:167],a[144:147],a[232:235],v[164:167]
 ds_read_b64_tr_b16 a[138:139],v18 offset:43168
 v_add_f32 v68,1.0,v68
 v_mfma_f32_16x16x32_bf16 v[164:167],a[148:151],a[236:239],v[164:167]
 v_exp_f32 v69,v69
 v_mfma_f32_16x16x32_bf16 v[168:171],a[144:147],a[240:243],v[168:171]
 ds_read_b64_tr_b16 a[140:141],v17 offset:50336
 v_add_f32 v69,1.0,v69
 v_mfma_f32_16x16x32_bf16 v[168:171],a[148:151],a[244:247],v[168:171]
 v_exp_f32 v70,v70
 v_mfma_f32_16x16x32_bf16 v[172:175],a[144:147],a[248:251],v[172:175]
 ds_read_b64_tr_b16 a[142:143],v18 offset:50336
 v_add_f32 v70,1.0,v70
 v_mfma_f32_16x16x32_bf16 v[172:175],a[148:151],a[252:255],v[172:175]
 v_exp_f32 v71,v71
 v_mfma_f32_16x16x32_bf16 v[176:179],a[152:155],a[224:227],v[176:179]
 ds_read_b64_tr_b16 a[144:145],v19 offset:160
 v_add_f32 v71,1.0,v71
 v_mfma_f32_16x16x32_bf16 v[176:179],a[156:159],a[228:231],v[176:179]
 v_rcp_f32 v68,v68
 v_mfma_f32_16x16x32_bf16 v[180:183],a[152:155],a[232:235],v[180:183]
 ds_read_b64_tr_b16 a[146:147],v20 offset:160
 v_mul_f32 v84,v84,v68
 v_mfma_f32_16x16x32_bf16 v[180:183],a[156:159],a[236:239],v[180:183]
 v_rcp_f32 v69,v69
 v_mfma_f32_16x16x32_bf16 v[184:187],a[152:155],a[240:243],v[184:187]
 ds_read_b64_tr_b16 a[148:149],v19 offset:7328
 v_mul_f32 v85,v85,v69
 v_mfma_f32_16x16x32_bf16 v[184:187],a[156:159],a[244:247],v[184:187]
 v_rcp_f32 v70,v70
 v_mfma_f32_16x16x32_bf16 v[188:191],a[152:155],a[248:251],v[188:191]
 ds_read_b64_tr_b16 a[150:151],v20 offset:7328
 v_mul_f32 v86,v86,v70
 v_mfma_f32_16x16x32_bf16 v[188:191],a[156:159],a[252:255],v[188:191]
 v_cvt_pk_bf16_f32 v38,v84,v85
 s_waitcnt lgkmcnt(4)
 v_mfma_f32_16x16x32_bf16 v[192:195],a[128:131],a[160:163],v[192:195]
 ds_read_b64_tr_b16 a[152:153],v19 offset:14496
 v_mul_f32 v26,v74,v74
 v_mfma_f32_16x16x32_bf16 v[192:195],a[132:135],a[164:167],v[192:195]
 v_rcp_f32 v71,v71
 v_mfma_f32_16x16x32_bf16 v[196:199],a[128:131],a[168:171],v[196:199]
 ds_read_b64_tr_b16 a[154:155],v20 offset:14496
 v_mul_f32 v87,v87,v71
 v_mfma_f32_16x16x32_bf16 v[196:199],a[132:135],a[172:175],v[196:199]
 v_cvt_pk_bf16_f32 v39,v86,v87
 v_mul_f32 v27,v75,v75
 v_mfma_f32_16x16x32_bf16 v[200:203],a[128:131],a[176:179],v[200:203]
 ds_read_b64_tr_b16 a[156:157],v19 offset:21664
 v_mul_f32 v88,v72,v88
 v_mfma_f32_16x16x32_bf16 v[200:203],a[132:135],a[180:183],v[200:203]
 buffer_store_dwordx4 v[36:39],v4,s[8:11],s64 offen offset:2048 sc0 sc1
 v_mfma_f32_16x16x32_bf16 v[204:207],a[128:131],a[184:187],v[204:207]
 ds_read_b64_tr_b16 a[158:159],v20 offset:21664
 v_mul_f32 v89,v73,v89
 v_mfma_f32_16x16x32_bf16 v[204:207],a[132:135],a[188:191],v[204:207]
 v_mul_f32 v90,v74,v90
 v_mul_f32 v91,v75,v91
 v_mfma_f32_16x16x32_bf16 v[208:211],a[136:139],a[160:163],v[208:211]
 ds_read_b64_tr_b16 a[128:129],v15 offset:160
 v_fma_f32 v24,v24,s82,v7
 v_mfma_f32_16x16x32_bf16 v[208:211],a[140:143],a[164:167],v[208:211]
 v_fma_f32 v25,v25,s82,v7
 v_fma_f32 v26,v26,s82,v7
 v_mfma_f32_16x16x32_bf16 v[212:215],a[136:139],a[168:171],v[212:215]
 ds_read_b64_tr_b16 a[130:131],v16 offset:160
 v_fma_f32 v27,v27,s82,v7
 v_mfma_f32_16x16x32_bf16 v[212:215],a[140:143],a[172:175],v[212:215]
 v_mul_f32 v72,v24,v72
 v_mul_f32 v73,v25,v73
 v_mfma_f32_16x16x32_bf16 v[216:219],a[136:139],a[176:179],v[216:219]
 ds_read_b64_tr_b16 a[132:133],v15 offset:7328
 v_mul_f32 v74,v26,v74
 v_mfma_f32_16x16x32_bf16 v[216:219],a[140:143],a[180:183],v[216:219]
 v_mul_f32 v75,v27,v75
 v_mul_f32 v28,v76,v76
 v_mfma_f32_16x16x32_bf16 v[220:223],a[136:139],a[184:187],v[220:223]
 ds_read_b64_tr_b16 a[134:135],v16 offset:7328
 v_mul_f32 v29,v77,v77
 v_mfma_f32_16x16x32_bf16 v[220:223],a[140:143],a[188:191],v[220:223]
 v_mul_f32 v24,v78,v78
 s_waitcnt lgkmcnt(4)
 v_mfma_f32_16x16x32_bf16 v[192:195],a[144:147],a[192:195],v[192:195]
 ds_read_b64_tr_b16 a[136:137],v15 offset:14496
 v_mul_f32 v25,v79,v79
 v_mfma_f32_16x16x32_bf16 v[192:195],a[148:151],a[196:199],v[192:195]
 v_exp_f32 v72,v72
 v_mfma_f32_16x16x32_bf16 v[196:199],a[144:147],a[200:203],v[196:199]
 ds_read_b64_tr_b16 a[138:139],v16 offset:14496
 v_add_f32 v72,1.0,v72
 v_mfma_f32_16x16x32_bf16 v[196:199],a[148:151],a[204:207],v[196:199]
 v_exp_f32 v73,v73
 v_mfma_f32_16x16x32_bf16 v[200:203],a[144:147],a[208:211],v[200:203]
 ds_read_b64_tr_b16 a[140:141],v15 offset:21664
 v_add_f32 v73,1.0,v73
 v_mfma_f32_16x16x32_bf16 v[200:203],a[148:151],a[212:215],v[200:203]
 v_exp_f32 v74,v74
 v_mfma_f32_16x16x32_bf16 v[204:207],a[144:147],a[216:219],v[204:207]
 ds_read_b64_tr_b16 a[142:143],v16 offset:21664
 v_add_f32 v74,1.0,v74
 v_mfma_f32_16x16x32_bf16 v[204:207],a[148:151],a[220:223],v[204:207]
 v_exp_f32 v75,v75
 v_mfma_f32_16x16x32_bf16 v[208:211],a[152:155],a[192:195],v[208:211]
 ds_read_b64_tr_b16 a[144:145],v17 offset:28864
 v_add_f32 v75,1.0,v75
 v_mfma_f32_16x16x32_bf16 v[208:211],a[156:159],a[196:199],v[208:211]
 v_rcp_f32 v72,v72
 v_mfma_f32_16x16x32_bf16 v[212:215],a[152:155],a[200:203],v[212:215]
 ds_read_b64_tr_b16 a[146:147],v18 offset:28864
 v_mul_f32 v88,v88,v72
 v_mfma_f32_16x16x32_bf16 v[212:215],a[156:159],a[204:207],v[212:215]
 v_rcp_f32 v73,v73
 v_mfma_f32_16x16x32_bf16 v[216:219],a[152:155],a[208:211],v[216:219]
 ds_read_b64_tr_b16 a[148:149],v17 offset:36032
 v_mul_f32 v89,v89,v73
 v_mfma_f32_16x16x32_bf16 v[216:219],a[156:159],a[212:215],v[216:219]
 v_rcp_f32 v74,v74
 v_mfma_f32_16x16x32_bf16 v[220:223],a[152:155],a[216:219],v[220:223]
 ds_read_b64_tr_b16 a[150:151],v18 offset:36032
 v_mul_f32 v90,v90,v74
 v_mfma_f32_16x16x32_bf16 v[220:223],a[156:159],a[220:223],v[220:223]
 v_cvt_pk_bf16_f32 v42,v88,v89
 s_waitcnt lgkmcnt(4)
 v_mfma_f32_16x16x32_bf16 v[192:195],a[128:131],a[224:227],v[192:195]
 ds_read_b64_tr_b16 a[152:153],v17 offset:43200
 v_mul_f32 v92,v76,v92
 v_mfma_f32_16x16x32_bf16 v[192:195],a[132:135],a[228:231],v[192:195]
 v_rcp_f32 v75,v75
 v_mfma_f32_16x16x32_bf16 v[196:199],a[128:131],a[232:235],v[196:199]
 ds_read_b64_tr_b16 a[154:155],v18 offset:43200
 v_mul_f32 v91,v91,v75
 v_mfma_f32_16x16x32_bf16 v[196:199],a[132:135],a[236:239],v[196:199]
 v_cvt_pk_bf16_f32 v43,v90,v91
 v_mul_f32 v93,v77,v93
 v_mfma_f32_16x16x32_bf16 v[200:203],a[128:131],a[240:243],v[200:203]
 ds_read_b64_tr_b16 a[156:157],v17 offset:50368
 v_mul_f32 v94,v78,v94
 v_mfma_f32_16x16x32_bf16 v[200:203],a[132:135],a[244:247],v[200:203]
 buffer_store_dwordx4 v[40:43],v5,s[8:11],s64 offen offset:0 sc0 sc1
 v_mfma_f32_16x16x32_bf16 v[204:207],a[128:131],a[248:251],v[204:207]
 ds_read_b64_tr_b16 a[158:159],v18 offset:50368
 v_mul_f32 v95,v79,v95
 v_mfma_f32_16x16x32_bf16 v[204:207],a[132:135],a[252:255],v[204:207]
 v_fma_f32 v28,v28,s82,v7
 v_fma_f32 v29,v29,s82,v7
 v_mfma_f32_16x16x32_bf16 v[208:211],a[136:139],a[224:227],v[208:211]
 ds_read_b64_tr_b16 a[128:129],v19 offset:192
 v_fma_f32 v24,v24,s82,v7
 v_mfma_f32_16x16x32_bf16 v[208:211],a[140:143],a[228:231],v[208:211]
 v_fma_f32 v25,v25,s82,v7
 v_mul_f32 v76,v28,v76
 v_mfma_f32_16x16x32_bf16 v[212:215],a[136:139],a[232:235],v[212:215]
 ds_read_b64_tr_b16 a[130:131],v20 offset:192
 v_mul_f32 v77,v29,v77
 v_mfma_f32_16x16x32_bf16 v[212:215],a[140:143],a[236:239],v[212:215]
 v_mul_f32 v78,v24,v78
 v_mul_f32 v79,v25,v79
 v_mfma_f32_16x16x32_bf16 v[216:219],a[136:139],a[240:243],v[216:219]
 ds_read_b64_tr_b16 a[132:133],v19 offset:7360
 v_mul_f32 v26,v96,v96
 v_mfma_f32_16x16x32_bf16 v[216:219],a[140:143],a[244:247],v[216:219]
 v_exp_f32 v76,v76
 v_mfma_f32_16x16x32_bf16 v[220:223],a[136:139],a[248:251],v[220:223]
 ds_read_b64_tr_b16 a[134:135],v20 offset:7360
 v_add_f32 v76,1.0,v76
 v_mfma_f32_16x16x32_bf16 v[220:223],a[140:143],a[252:255],v[220:223]
 v_mul_f32 v27,v97,v97
 s_waitcnt lgkmcnt(4)
 v_mfma_f32_16x16x32_bf16 v[224:227],a[144:147],a[160:163],v[224:227]
 ds_read_b64_tr_b16 a[136:137],v19 offset:14528
 v_mul_f32 v28,v98,v98
 v_mfma_f32_16x16x32_bf16 v[224:227],a[148:151],a[164:167],v[224:227]
 v_exp_f32 v77,v77
 v_mfma_f32_16x16x32_bf16 v[228:231],a[144:147],a[168:171],v[228:231]
 ds_read_b64_tr_b16 a[138:139],v20 offset:14528
 v_add_f32 v77,1.0,v77
 v_mfma_f32_16x16x32_bf16 v[228:231],a[148:151],a[172:175],v[228:231]
 v_exp_f32 v78,v78
 v_mfma_f32_16x16x32_bf16 v[232:235],a[144:147],a[176:179],v[232:235]
 ds_read_b64_tr_b16 a[140:141],v19 offset:21696
 v_add_f32 v78,1.0,v78
 v_mfma_f32_16x16x32_bf16 v[232:235],a[148:151],a[180:183],v[232:235]
 v_exp_f32 v79,v79
 v_mfma_f32_16x16x32_bf16 v[236:239],a[144:147],a[184:187],v[236:239]
 ds_read_b64_tr_b16 a[142:143],v20 offset:21696
 v_add_f32 v79,1.0,v79
 v_mfma_f32_16x16x32_bf16 v[236:239],a[148:151],a[188:191],v[236:239]
 v_rcp_f32 v76,v76
 v_mfma_f32_16x16x32_bf16 v[240:243],a[152:155],a[160:163],v[240:243]
 ds_read_b64_tr_b16 a[144:145],v15 offset:192
 v_mul_f32 v92,v92,v76
 v_mfma_f32_16x16x32_bf16 v[240:243],a[156:159],a[164:167],v[240:243]
 v_rcp_f32 v77,v77
 v_mfma_f32_16x16x32_bf16 v[244:247],a[152:155],a[168:171],v[244:247]
 ds_read_b64_tr_b16 a[146:147],v16 offset:192
 v_mul_f32 v93,v93,v77
 v_mfma_f32_16x16x32_bf16 v[244:247],a[156:159],a[172:175],v[244:247]
 v_rcp_f32 v78,v78
 v_mfma_f32_16x16x32_bf16 v[248:251],a[152:155],a[176:179],v[248:251]
 ds_read_b64_tr_b16 a[148:149],v15 offset:7360
 v_mul_f32 v94,v94,v78
 v_mfma_f32_16x16x32_bf16 v[248:251],a[156:159],a[180:183],v[248:251]
 v_rcp_f32 v79,v79
 v_mfma_f32_16x16x32_bf16 v[252:255],a[152:155],a[184:187],v[252:255]
 ds_read_b64_tr_b16 a[150:151],v16 offset:7360
 v_mul_f32 v95,v95,v79
 v_mfma_f32_16x16x32_bf16 v[252:255],a[156:159],a[188:191],v[252:255]
 v_cvt_pk_bf16_f32 v46,v92,v93
 s_waitcnt lgkmcnt(4)
 v_mfma_f32_16x16x32_bf16 v[224:227],a[128:131],a[192:195],v[224:227]
 ds_read_b64_tr_b16 a[152:153],v15 offset:14528
 v_cvt_pk_bf16_f32 v47,v94,v95
 v_mfma_f32_16x16x32_bf16 v[224:227],a[132:135],a[196:199],v[224:227]
 buffer_store_dwordx4 v[44:47],v5,s[8:11],s64 offen offset:2048 sc0 sc1
 v_mfma_f32_16x16x32_bf16 v[228:231],a[128:131],a[200:203],v[228:231]
 ds_read_b64_tr_b16 a[154:155],v16 offset:14528
 v_mul_f32 v29,v99,v99
 v_mfma_f32_16x16x32_bf16 v[228:231],a[132:135],a[204:207],v[228:231]
 v_mul_f32 v112,v96,v112
 v_mul_f32 v113,v97,v113
 v_mfma_f32_16x16x32_bf16 v[232:235],a[128:131],a[208:211],v[232:235]
 ds_read_b64_tr_b16 a[156:157],v15 offset:21696
 v_mul_f32 v114,v98,v114
 v_mfma_f32_16x16x32_bf16 v[232:235],a[132:135],a[212:215],v[232:235]
 v_mul_f32 v115,v99,v115
 v_fma_f32 v26,v26,s82,v7
 v_mfma_f32_16x16x32_bf16 v[236:239],a[128:131],a[216:219],v[236:239]
 ds_read_b64_tr_b16 a[158:159],v16 offset:21696
 s_mov_b32 s63,0
 v_mfma_f32_16x16x32_bf16 v[236:239],a[132:135],a[220:223],v[236:239]
 s_waitcnt vmcnt(12)
 s_barrier
 v_mfma_f32_16x16x32_bf16 v[240:243],a[136:139],a[192:195],v[240:243]
 ds_read_b64_tr_b16 a[128:129],v21 offset:0
 s_add_u32 m0,s51,87680
 v_mfma_f32_16x16x32_bf16 v[240:243],a[140:143],a[196:199],v[240:243]
 buffer_load_dwordx4 v8,s[16:19],s63 offen offset:0 lds
 v_mfma_f32_16x16x32_bf16 v[244:247],a[136:139],a[200:203],v[244:247]
 ds_read_b64_tr_b16 a[130:131],v21 offset:256
 v_fma_f32 v27,v27,s82,v7
 v_mfma_f32_16x16x32_bf16 v[244:247],a[140:143],a[204:207],v[244:247]
 buffer_load_dwordx4 v9,s[16:19],s63 offen offset:1088 lds
 v_mfma_f32_16x16x32_bf16 v[248:251],a[136:139],a[208:211],v[248:251]
 ds_read_b64_tr_b16 a[132:133],v21 offset:8768
 v_fma_f32 v28,v28,s82,v7
 v_mfma_f32_16x16x32_bf16 v[248:251],a[140:143],a[212:215],v[248:251]
 buffer_load_dwordx4 v10,s[16:19],s63 offen offset:2176 lds
 v_mfma_f32_16x16x32_bf16 v[252:255],a[136:139],a[216:219],v[252:255]
 ds_read_b64_tr_b16 a[134:135],v21 offset:9024
 v_fma_f32 v29,v29,s82,v7
 v_mfma_f32_16x16x32_bf16 v[252:255],a[140:143],a[220:223],v[252:255]
 v_mul_f32 v96,v26,v96
 s_waitcnt lgkmcnt(4)
 v_mfma_f32_16x16x32_bf16 v[224:227],a[144:147],a[224:227],v[224:227]
 ds_read_b64_tr_b16 a[136:137],v21 offset:32
 v_mul_f32 v97,v27,v97
 v_mfma_f32_16x16x32_bf16 v[224:227],a[148:151],a[228:231],v[224:227]
 buffer_load_dwordx4 v11,s[16:19],s63 offen offset:3264 lds
 v_mfma_f32_16x16x32_bf16 v[228:231],a[144:147],a[232:235],v[228:231]
 ds_read_b64_tr_b16 a[138:139],v21 offset:288
 s_mov_b32 s57,s77
 v_mfma_f32_16x16x32_bf16 v[228:231],a[148:151],a[236:239],v[228:231]
 buffer_load_dwordx4 v[32:35],v4,s[8:11],s57 offen offset:0 sc1
 v_mfma_f32_16x16x32_bf16 v[232:235],a[144:147],a[240:243],v[232:235]
 ds_read_b64_tr_b16 a[140:141],v21 offset:8800
 v_mul_f32 v98,v28,v98
 v_mfma_f32_16x16x32_bf16 v[232:235],a[148:151],a[244:247],v[232:235]
 buffer_load_dwordx4 v[36:39],v4,s[8:11],s57 offen offset:1024 sc1
 v_mfma_f32_16x16x32_bf16 v[236:239],a[144:147],a[248:251],v[236:239]
 ds_read_b64_tr_b16 a[142:143],v21 offset:9056
 v_mul_f32 v99,v29,v99
 v_mfma_f32_16x16x32_bf16 v[236:239],a[148:151],a[252:255],v[236:239]
 buffer_load_dwordx4 v[40:43],v4,s[8:11],s57 offen offset:2048 sc1
 v_mfma_f32_16x16x32_bf16 v[240:243],a[152:155],a[224:227],v[240:243]
 ds_read_b64_tr_b16 a[144:145],v21 offset:64
 v_mul_f32 v24,v100,v100
 v_mfma_f32_16x16x32_bf16 v[240:243],a[156:159],a[228:231],v[240:243]
 v_exp_f32 v96,v96
 v_mfma_f32_16x16x32_bf16 v[244:247],a[152:155],a[232:235],v[244:247]
 ds_read_b64_tr_b16 a[146:147],v21 offset:320
 v_add_f32 v96,1.0,v96
 v_mfma_f32_16x16x32_bf16 v[244:247],a[156:159],a[236:239],v[244:247]
 v_exp_f32 v97,v97
 v_mfma_f32_16x16x32_bf16 v[248:251],a[152:155],a[240:243],v[248:251]
 ds_read_b64_tr_b16 a[148:149],v21 offset:8832
 v_add_f32 v97,1.0,v97
 v_mfma_f32_16x16x32_bf16 v[248:251],a[156:159],a[244:247],v[248:251]
 v_exp_f32 v98,v98
 v_mfma_f32_16x16x32_bf16 v[252:255],a[152:155],a[248:251],v[252:255]
 ds_read_b64_tr_b16 a[150:151],v21 offset:9088
 v_add_f32 v98,1.0,v98
 v_mfma_f32_16x16x32_bf16 v[252:255],a[156:159],a[252:255],v[252:255]
 v_mul_f32 v25,v101,v101
 s_waitcnt lgkmcnt(4)
 v_mfma_f32_16x16x32_bf16 a[0:3],a[128:131],a[160:163],0
 ds_read_b64_tr_b16 a[152:153],v21 offset:96
 s_barrier
 v_mfma_f32_16x16x32_bf16 a[0:3],a[132:135],a[164:167],a[0:3]
 v_and_b32 v16,12,v1
 v_and_b32 v2,1,v1
 v_mfma_f32_16x16x32_bf16 a[4:7],a[128:131],a[168:171],0
 ds_read_b64_tr_b16 a[154:155],v21 offset:352
 v_lshl_or_b32 v16,v2,1,v16
 v_mfma_f32_16x16x32_bf16 a[4:7],a[132:135],a[172:175],a[4:7]
 v_bfe_u32 v2,v1,1,1
 v_mul_f32 v26,v102,v102
 v_mfma_f32_16x16x32_bf16 a[8:11],a[128:131],a[176:179],0
 ds_read_b64_tr_b16 a[156:157],v21 offset:8864
 v_or_b32 v16,v16,v2
 v_mfma_f32_16x16x32_bf16 a[8:11],a[132:135],a[180:183],a[8:11]
 v_lshlrev_b32 v16,4,v16
 v_lshrrev_b32 v2,4,v1
 v_mfma_f32_16x16x32_bf16 a[12:15],a[128:131],a[184:187],0
 ds_read_b64_tr_b16 a[158:159],v21 offset:9120
 v_lshl_add_u32 v12,v2,8,v16
 v_mfma_f32_16x16x32_bf16 a[12:15],a[132:135],a[188:191],a[12:15]
 v_add_u32 v12,s85,v12
 v_lshrrev_b32 v2,5,v1
 v_mfma_f32_16x16x32_bf16 a[16:19],a[136:139],a[160:163],0
 ds_read_b64_tr_b16 a[128:129],v21 offset:128
 v_add_u32 v13,1008,v12
 v_mfma_f32_16x16x32_bf16 a[16:19],a[140:143],a[164:167],a[16:19]
 v_add_u32 v14,6112,v12
 v_add_u32 v15,7120,v12
 v_mfma_f32_16x16x32_bf16 a[20:23],a[136:139],a[168:171],0
 ds_read_b64_tr_b16 a[130:131],v21 offset:384
 v_lshl_add_u32 v16,v2,10,v16
 v_mfma_f32_16x16x32_bf16 a[20:23],a[140:143],a[172:175],a[20:23]
 v_xor_b32 v2,s48,v2
 v_mul_f32 v27,v103,v103
 v_mfma_f32_16x16x32_bf16 a[24:27],a[136:139],a[176:179],0
 ds_read_b64_tr_b16 a[132:133],v21 offset:8896
 v_and_b32 v2,1,v2
 v_mfma_f32_16x16x32_bf16 a[24:27],a[140:143],a[180:183],a[24:27]
 v_lshl_add_u32 v16,v2,11,v16
 v_bfe_u32 v2,v1,4,1
 v_mfma_f32_16x16x32_bf16 a[28:31],a[136:139],a[184:187],0
 ds_read_b64_tr_b16 a[134:135],v21 offset:9152
 v_lshl_add_u32 v16,v2,8,v16
 v_mfma_f32_16x16x32_bf16 a[28:31],a[140:143],a[188:191],a[28:31]
 v_add_u32 v16,s86,v16
 s_waitcnt lgkmcnt(4)
 v_mfma_f32_16x16x32_bf16 a[32:35],a[144:147],a[160:163],0
 ds_read_b64_tr_b16 a[136:137],v21 offset:160
 v_add_u32 v17,3008,v16
 v_mfma_f32_16x16x32_bf16 a[32:35],a[148:151],a[164:167],a[32:35]
 v_add_u32 v18,6016,v16
 v_add_u32 v19,9024,v16
 v_mfma_f32_16x16x32_bf16 a[36:39],a[144:147],a[168:171],0
 ds_read_b64_tr_b16 a[138:139],v21 offset:416
 v_mul_f32 v116,v100,v116
 v_mfma_f32_16x16x32_bf16 a[36:39],a[148:151],a[172:175],a[36:39]
 buffer_load_dwordx4 v[44:47],v4,s[8:11],s57 offen offset:3072 sc1
 v_mfma_f32_16x16x32_bf16 a[40:43],a[144:147],a[176:179],0
 ds_read_b64_tr_b16 a[140:141],v21 offset:8928
 v_mul_f32 v117,v101,v117
 v_mfma_f32_16x16x32_bf16 a[40:43],a[148:151],a[180:183],a[40:43]
 v_exp_f32 v99,v99
 v_mfma_f32_16x16x32_bf16 a[44:47],a[144:147],a[184:187],0
 ds_read_b64_tr_b16 a[142:143],v21 offset:9184
 v_add_f32 v99,1.0,v99
 v_mfma_f32_16x16x32_bf16 a[44:47],a[148:151],a[188:191],a[44:47]
 v_rcp_f32 v96,v96
 v_mfma_f32_16x16x32_bf16 a[48:51],a[152:155],a[160:163],0
 ds_read_b64_tr_b16 a[144:145],v21 offset:192
 v_mul_f32 v112,v112,v96
 v_mfma_f32_16x16x32_bf16 a[48:51],a[156:159],a[164:167],a[48:51]
 buffer_load_dwordx4 v[48:51],v5,s[8:11],s57 offen offset:0 sc1
 v_mfma_f32_16x16x32_bf16 a[52:55],a[152:155],a[168:171],0
 ds_read_b64_tr_b16 a[146:147],v21 offset:448
 v_mul_f32 v118,v102,v118
 v_mfma_f32_16x16x32_bf16 a[52:55],a[156:159],a[172:175],a[52:55]
 v_rcp_f32 v97,v97
 v_mfma_f32_16x16x32_bf16 a[56:59],a[152:155],a[176:179],0
 ds_read_b64_tr_b16 a[148:149],v21 offset:8960
 v_mul_f32 v113,v113,v97
 v_mfma_f32_16x16x32_bf16 a[56:59],a[156:159],a[180:183],a[56:59]
 buffer_load_dwordx4 v[52:55],v5,s[8:11],s57 offen offset:1024 sc1
 v_mfma_f32_16x16x32_bf16 a[60:63],a[152:155],a[184:187],0
 ds_read_b64_tr_b16 a[150:151],v21 offset:9216
 v_cvt_pk_bf16_f32 v96,v112,v113
 v_mfma_f32_16x16x32_bf16 a[60:63],a[156:159],a[188:191],a[60:63]
 v_mul_f32 v119,v103,v119
 s_waitcnt lgkmcnt(4)
 v_mfma_f32_16x16x32_bf16 a[64:67],a[128:131],a[160:163],0
 ds_read_b64_tr_b16 a[152:153],v21 offset:224
 v_fma_f32 v24,v24,s82,v7
 v_mfma_f32_16x16x32_bf16 a[64:67],a[132:135],a[164:167],a[64:67]
 buffer_load_dwordx4 v[56:59],v5,s[8:11],s57 offen offset:2048 sc1
 v_mfma_f32_16x16x32_bf16 a[68:71],a[128:131],a[168:171],0
 ds_read_b64_tr_b16 a[154:155],v21 offset:480
 v_fma_f32 v25,v25,s82,v7
 v_mfma_f32_16x16x32_bf16 a[68:71],a[132:135],a[172:175],a[68:71]
 v_rcp_f32 v98,v98
 v_mfma_f32_16x16x32_bf16 a[72:75],a[128:131],a[176:179],0
 ds_read_b64_tr_b16 a[156:157],v21 offset:8992
 v_mul_f32 v114,v114,v98
 v_mfma_f32_16x16x32_bf16 a[72:75],a[132:135],a[180:183],a[72:75]
 v_rcp_f32 v99,v99
 v_mfma_f32_16x16x32_bf16 a[76:79],a[128:131],a[184:187],0
 ds_read_b64_tr_b16 a[158:159],v21 offset:9248
 v_mul_f32 v115,v115,v99
 v_mfma_f32_16x16x32_bf16 a[76:79],a[132:135],a[188:191],a[76:79]
 s_waitcnt vmcnt(19)
 s_barrier
 v_mfma_f32_16x16x32_bf16 a[80:83],a[136:139],a[160:163],0
 ds_read_b64_tr_b16 a[128:129],v22 offset:0
 s_add_u32 s63,s63,524288
 v_mfma_f32_16x16x32_bf16 a[80:83],a[140:143],a[164:167],a[80:83]
 buffer_load_dwordx4 v[60:63],v5,s[8:11],s57 offen offset:3072 sc1
 v_mfma_f32_16x16x32_bf16 a[84:87],a[136:139],a[168:171],0
 ds_read_b64_tr_b16 a[130:131],v22 offset:256
 s_add_u32 m0,s51,105216
 v_mfma_f32_16x16x32_bf16 a[84:87],a[140:143],a[172:175],a[84:87]
 buffer_load_dwordx4 v8,s[16:19],s63 offen offset:0 lds
 v_mfma_f32_16x16x32_bf16 a[88:91],a[136:139],a[176:179],0
 ds_read_b64_tr_b16 a[132:133],v22 offset:8768
 v_cvt_pk_bf16_f32 v97,v114,v115
 v_mfma_f32_16x16x32_bf16 a[88:91],a[140:143],a[180:183],a[88:91]
 v_fma_f32 v26,v26,s82,v7
 v_fma_f32 v27,v27,s82,v7
 v_mfma_f32_16x16x32_bf16 a[92:95],a[136:139],a[184:187],0
 ds_read_b64_tr_b16 a[134:135],v22 offset:9024
 v_mul_f32 v100,v24,v100
 v_mfma_f32_16x16x32_bf16 a[92:95],a[140:143],a[188:191],a[92:95]
 v_mul_f32 v101,v25,v101
 s_waitcnt lgkmcnt(4)
 v_mfma_f32_16x16x32_bf16 a[96:99],a[144:147],a[160:163],0
 ds_read_b64_tr_b16 a[136:137],v22 offset:32
 v_mul_f32 v102,v26,v102
 v_mfma_f32_16x16x32_bf16 a[96:99],a[148:151],a[164:167],a[96:99]
 buffer_load_dwordx4 v9,s[16:19],s63 offen offset:1088 lds
 v_mfma_f32_16x16x32_bf16 a[100:103],a[144:147],a[168:171],0
 ds_read_b64_tr_b16 a[138:139],v22 offset:288
 v_mul_f32 v103,v27,v103
 v_mfma_f32_16x16x32_bf16 a[100:103],a[148:151],a[172:175],a[100:103]
 v_exp_f32 v100,v100
 v_mfma_f32_16x16x32_bf16 a[104:107],a[144:147],a[176:179],0
 ds_read_b64_tr_b16 a[140:141],v22 offset:8800
 v_add_f32 v100,1.0,v100
 v_mfma_f32_16x16x32_bf16 a[104:107],a[148:151],a[180:183],a[104:107]
 buffer_load_dwordx4 v10,s[16:19],s63 offen offset:2176 lds
 v_mfma_f32_16x16x32_bf16 a[108:111],a[144:147],a[184:187],0
 ds_read_b64_tr_b16 a[142:143],v22 offset:9056
 v_mul_f32 v28,v104,v104
 v_mfma_f32_16x16x32_bf16 a[108:111],a[148:151],a[188:191],a[108:111]
 v_exp_f32 v101,v101
 v_mfma_f32_16x16x32_bf16 a[112:115],a[152:155],a[160:163],0
 ds_read_b64_tr_b16 a[144:145],v22 offset:64
 v_add_f32 v101,1.0,v101
 v_mfma_f32_16x16x32_bf16 a[112:115],a[156:159],a[164:167],a[112:115]
 buffer_load_dwordx4 v11,s[16:19],s63 offen offset:3264 lds
 v_mfma_f32_16x16x32_bf16 a[116:119],a[152:155],a[168:171],0
 ds_read_b64_tr_b16 a[146:147],v22 offset:320
 v_mul_f32 v29,v105,v105
 v_mfma_f32_16x16x32_bf16 a[116:119],a[156:159],a[172:175],a[116:119]
 v_exp_f32 v102,v102
 v_mfma_f32_16x16x32_bf16 a[120:123],a[152:155],a[176:179],0
 ds_read_b64_tr_b16 a[148:149],v22 offset:8832
 v_add_f32 v102,1.0,v102
 v_mfma_f32_16x16x32_bf16 a[120:123],a[156:159],a[180:183],a[120:123]
 v_exp_f32 v103,v103
 v_mfma_f32_16x16x32_bf16 a[124:127],a[152:155],a[184:187],0
 ds_read_b64_tr_b16 a[150:151],v22 offset:9088
 v_add_f32 v103,1.0,v103
 v_mfma_f32_16x16x32_bf16 a[124:127],a[156:159],a[188:191],a[124:127]
 v_mul_f32 v24,v106,v106
 s_waitcnt lgkmcnt(4)
 v_mfma_f32_16x16x32_bf16 a[0:3],a[128:131],a[192:195],a[0:3]
 ds_read_b64_tr_b16 a[152:153],v22 offset:96
 s_add_u32 s57,s57,8192
 v_mfma_f32_16x16x32_bf16 a[0:3],a[132:135],a[196:199],a[0:3]
 buffer_load_dwordx4 v[64:67],v4,s[8:11],s57 offen offset:0 sc1
 v_mfma_f32_16x16x32_bf16 a[4:7],a[128:131],a[200:203],a[4:7]
 ds_read_b64_tr_b16 a[154:155],v22 offset:352
 v_mul_f32 v25,v107,v107
 v_mfma_f32_16x16x32_bf16 a[4:7],a[132:135],a[204:207],a[4:7]
 v_rcp_f32 v100,v100
 v_mfma_f32_16x16x32_bf16 a[8:11],a[128:131],a[208:211],a[8:11]
 ds_read_b64_tr_b16 a[156:157],v22 offset:8864
 v_mul_f32 v116,v116,v100
 v_mfma_f32_16x16x32_bf16 a[8:11],a[132:135],a[212:215],a[8:11]
 buffer_load_dwordx4 v[68:71],v4,s[8:11],s57 offen offset:1024 sc1
 v_mfma_f32_16x16x32_bf16 a[12:15],a[128:131],a[216:219],a[12:15]
 ds_read_b64_tr_b16 a[158:159],v22 offset:9120
 v_mul_f32 v120,v104,v120
 v_mfma_f32_16x16x32_bf16 a[12:15],a[132:135],a[220:223],a[12:15]
 v_rcp_f32 v101,v101
 v_mfma_f32_16x16x32_bf16 a[16:19],a[136:139],a[192:195],a[16:19]
 ds_read_b64_tr_b16 a[128:129],v22 offset:128
 v_mul_f32 v117,v117,v101
 v_mfma_f32_16x16x32_bf16 a[16:19],a[140:143],a[196:199],a[16:19]
 buffer_load_dwordx4 v[72:75],v4,s[8:11],s57 offen offset:2048 sc1
 v_mfma_f32_16x16x32_bf16 a[20:23],a[136:139],a[200:203],a[20:23]
 ds_read_b64_tr_b16 a[130:131],v22 offset:384
 v_cvt_pk_bf16_f32 v100,v116,v117
 v_mfma_f32_16x16x32_bf16 a[20:23],a[140:143],a[204:207],a[20:23]
 v_rcp_f32 v102,v102
 v_mfma_f32_16x16x32_bf16 a[24:27],a[136:139],a[208:211],a[24:27]
 ds_read_b64_tr_b16 a[132:133],v22 offset:8896
 v_mul_f32 v118,v118,v102
 v_mfma_f32_16x16x32_bf16 a[24:27],a[140:143],a[212:215],a[24:27]
 v_rcp_f32 v103,v103
 v_mfma_f32_16x16x32_bf16 a[28:31],a[136:139],a[216:219],a[28:31]
 ds_read_b64_tr_b16 a[134:135],v22 offset:9152
 v_mul_f32 v119,v119,v103
 v_mfma_f32_16x16x32_bf16 a[28:31],a[140:143],a[220:223],a[28:31]
 v_cvt_pk_bf16_f32 v101,v118,v119
 s_waitcnt lgkmcnt(4)
 v_mfma_f32_16x16x32_bf16 a[32:35],a[144:147],a[192:195],a[32:35]
 ds_read_b64_tr_b16 a[136:137],v22 offset:160
 v_mul_f32 v121,v105,v121
 v_mfma_f32_16x16x32_bf16 a[32:35],a[148:151],a[196:199],a[32:35]
 buffer_load_dwordx4 v[76:79],v4,s[8:11],s57 offen offset:3072 sc1
 v_mfma_f32_16x16x32_bf16 a[36:39],a[144:147],a[200:203],a[36:39]
 ds_read_b64_tr_b16 a[138:139],v22 offset:416
L_w8:
 s_cbranch_execz L_w12
 v_mul_f32 v122,v106,v122
 v_mfma_f32_16x16x32_bf16 a[36:39],a[148:151],a[204:207],a[36:39]
 v_mul_f32 v123,v107,v123
 v_fma_f32 v28,v28,s82,v7
 v_mfma_f32_16x16x32_bf16 a[40:43],a[144:147],a[208:211],a[40:43]
 ds_read_b64_tr_b16 a[140:141],v22 offset:8928
 v_fma_f32 v29,v29,s82,v7
 v_mfma_f32_16x16x32_bf16 a[40:43],a[148:151],a[212:215],a[40:43]
 buffer_load_dwordx4 v[80:83],v5,s[8:11],s57 offen offset:0 sc1
 v_mfma_f32_16x16x32_bf16 a[44:47],a[144:147],a[216:219],a[44:47]
 ds_read_b64_tr_b16 a[142:143],v22 offset:9184
 v_fma_f32 v24,v24,s82,v7
 v_mfma_f32_16x16x32_bf16 a[44:47],a[148:151],a[220:223],a[44:47]
 v_fma_f32 v25,v25,s82,v7
 v_mul_f32 v104,v28,v104
 v_mfma_f32_16x16x32_bf16 a[48:51],a[152:155],a[192:195],a[48:51]
 ds_read_b64_tr_b16 a[144:145],v22 offset:192
 v_mul_f32 v105,v29,v105
 v_mfma_f32_16x16x32_bf16 a[48:51],a[156:159],a[196:199],a[48:51]
 buffer_load_dwordx4 v[84:87],v5,s[8:11],s57 offen offset:1024 sc1
 v_mfma_f32_16x16x32_bf16 a[52:55],a[152:155],a[200:203],a[52:55]
 ds_read_b64_tr_b16 a[146:147],v22 offset:448
 v_mul_f32 v106,v24,v106
 v_mfma_f32_16x16x32_bf16 a[52:55],a[156:159],a[204:207],a[52:55]
 v_mul_f32 v107,v25,v107
 v_mul_f32 v26,v108,v108
 v_mfma_f32_16x16x32_bf16 a[56:59],a[152:155],a[208:211],a[56:59]
 ds_read_b64_tr_b16 a[148:149],v22 offset:8960
 v_mul_f32 v27,v109,v109
 v_mfma_f32_16x16x32_bf16 a[56:59],a[156:159],a[212:215],a[56:59]
 buffer_load_dwordx4 v[88:91],v5,s[8:11],s57 offen offset:2048 sc1
 v_mfma_f32_16x16x32_bf16 a[60:63],a[152:155],a[216:219],a[60:63]
 ds_read_b64_tr_b16 a[150:151],v22 offset:9216
 v_mul_f32 v28,v110,v110
 v_mfma_f32_16x16x32_bf16 a[60:63],a[156:159],a[220:223],a[60:63]
 v_mul_f32 v29,v111,v111
 s_waitcnt lgkmcnt(4)
 v_mfma_f32_16x16x32_bf16 a[64:67],a[128:131],a[192:195],a[64:67]
 ds_read_b64_tr_b16 a[152:153],v22 offset:224
 v_mul_f32 v124,v108,v124
 v_mfma_f32_16x16x32_bf16 a[64:67],a[132:135],a[196:199],a[64:67]
 v_exp_f32 v104,v104
 v_mfma_f32_16x16x32_bf16 a[68:71],a[128:131],a[200:203],a[68:71]
 ds_read_b64_tr_b16 a[154:155],v22 offset:480
 v_add_f32 v104,1.0,v104
 v_mfma_f32_16x16x32_bf16 a[68:71],a[132:135],a[204:207],a[68:71]
 buffer_load_dwordx4 v[92:95],v5,s[8:11],s57 offen offset:3072 sc1
 v_mfma_f32_16x16x32_bf16 a[72:75],a[128:131],a[208:211],a[72:75]
 ds_read_b64_tr_b16 a[156:157],v22 offset:8992
 v_mul_f32 v125,v109,v125
 v_mfma_f32_16x16x32_bf16 a[72:75],a[132:135],a[212:215],a[72:75]
 v_exp_f32 v105,v105
 v_mfma_f32_16x16x32_bf16 a[76:79],a[128:131],a[216:219],a[76:79]
 ds_read_b64_tr_b16 a[158:159],v22 offset:9248
 s_add_u32 s63,s63,524288
 v_mfma_f32_16x16x32_bf16 a[76:79],a[132:135],a[220:223],a[76:79]
 s_waitcnt vmcnt(28)
 s_barrier
 v_mfma_f32_16x16x32_bf16 a[80:83],a[136:139],a[192:195],a[80:83]
 ds_read_b64_tr_b16 a[128:129],v22 offset:17536
 s_add_u32 m0,s51,122752
 v_mfma_f32_16x16x32_bf16 a[80:83],a[140:143],a[196:199],a[80:83]
 buffer_load_dwordx4 v8,s[16:19],s63 offen offset:0 lds
 v_mfma_f32_16x16x32_bf16 a[84:87],a[136:139],a[200:203],a[84:87]
 ds_read_b64_tr_b16 a[130:131],v22 offset:17792
 v_add_f32 v105,1.0,v105
 v_mfma_f32_16x16x32_bf16 a[84:87],a[140:143],a[204:207],a[84:87]
 v_exp_f32 v106,v106
 v_mfma_f32_16x16x32_bf16 a[88:91],a[136:139],a[208:211],a[88:91]
 ds_read_b64_tr_b16 a[132:133],v22 offset:26304
 v_add_f32 v106,1.0,v106
 v_mfma_f32_16x16x32_bf16 a[88:91],a[140:143],a[212:215],a[88:91]
 buffer_load_dwordx4 v9,s[16:19],s63 offen offset:1088 lds
 v_mfma_f32_16x16x32_bf16 a[92:95],a[136:139],a[216:219],a[92:95]
 ds_read_b64_tr_b16 a[134:135],v22 offset:26560
 v_mul_f32 v126,v110,v126
 v_mfma_f32_16x16x32_bf16 a[92:95],a[140:143],a[220:223],a[92:95]
 v_mul_f32 v127,v111,v127
 s_waitcnt lgkmcnt(4)
 v_mfma_f32_16x16x32_bf16 a[96:99],a[144:147],a[192:195],a[96:99]
 ds_read_b64_tr_b16 a[136:137],v22 offset:17568
 v_fma_f32 v26,v26,s82,v7
 v_mfma_f32_16x16x32_bf16 a[96:99],a[148:151],a[196:199],a[96:99]
 buffer_load_dwordx4 v10,s[16:19],s63 offen offset:2176 lds
 v_mfma_f32_16x16x32_bf16 a[100:103],a[144:147],a[200:203],a[100:103]
 ds_read_b64_tr_b16 a[138:139],v22 offset:17824
 v_fma_f32 v27,v27,s82,v7
 v_mfma_f32_16x16x32_bf16 a[100:103],a[148:151],a[204:207],a[100:103]
 v_exp_f32 v107,v107
 v_mfma_f32_16x16x32_bf16 a[104:107],a[144:147],a[208:211],a[104:107]
 ds_read_b64_tr_b16 a[140:141],v22 offset:26336
 v_add_f32 v107,1.0,v107
 v_mfma_f32_16x16x32_bf16 a[104:107],a[148:151],a[212:215],a[104:107]
 v_rcp_f32 v104,v104
 v_mfma_f32_16x16x32_bf16 a[108:111],a[144:147],a[216:219],a[108:111]
 ds_read_b64_tr_b16 a[142:143],v22 offset:26592
 v_mul_f32 v120,v120,v104
 v_mfma_f32_16x16x32_bf16 a[108:111],a[148:151],a[220:223],a[108:111]
 buffer_load_dwordx4 v11,s[16:19],s63 offen offset:3264 lds
 v_mfma_f32_16x16x32_bf16 a[112:115],a[152:155],a[192:195],a[112:115]
 ds_read_b64_tr_b16 a[144:145],v22 offset:17600
 v_fma_f32 v28,v28,s82,v7
 v_mfma_f32_16x16x32_bf16 a[112:115],a[156:159],a[196:199],a[112:115]
 v_rcp_f32 v105,v105
 v_mfma_f32_16x16x32_bf16 a[116:119],a[152:155],a[200:203],a[116:119]
 ds_read_b64_tr_b16 a[146:147],v22 offset:17856
 v_mul_f32 v121,v121,v105
 v_mfma_f32_16x16x32_bf16 a[116:119],a[156:159],a[204:207],a[116:119]
 v_rcp_f32 v106,v106
 v_mfma_f32_16x16x32_bf16 a[120:123],a[152:155],a[208:211],a[120:123]
 ds_read_b64_tr_b16 a[148:149],v22 offset:26368
 s_add_u32 s57,s57,8192
 v_mfma_f32_16x16x32_bf16 a[120:123],a[156:159],a[212:215],a[120:123]
 buffer_load_dwordx4 a[160:163],v4,s[8:11],s57 offen offset:0 sc1
 v_mfma_f32_16x16x32_bf16 a[124:127],a[152:155],a[216:219],a[124:127]
 ds_read_b64_tr_b16 a[150:151],v22 offset:26624
 v_mul_f32 v122,v122,v106
 v_mfma_f32_16x16x32_bf16 a[124:127],a[156:159],a[220:223],a[124:127]
 v_cvt_pk_bf16_f32 v104,v120,v121
 s_waitcnt lgkmcnt(4)
 v_mfma_f32_16x16x32_bf16 a[0:3],a[128:131],a[224:227],a[0:3]
 ds_read_b64_tr_b16 a[152:153],v22 offset:17632
 v_fma_f32 v29,v29,s82,v7
 v_mfma_f32_16x16x32_bf16 a[0:3],a[132:135],a[228:231],a[0:3]
 buffer_load_dwordx4 a[164:167],v4,s[8:11],s57 offen offset:1024 sc1
 v_mfma_f32_16x16x32_bf16 a[4:7],a[128:131],a[232:235],a[4:7]
 ds_read_b64_tr_b16 a[154:155],v22 offset:17888
 v_mul_f32 v108,v26,v108
 v_mfma_f32_16x16x32_bf16 a[4:7],a[132:135],a[236:239],a[4:7]
 v_rcp_f32 v107,v107
 v_mfma_f32_16x16x32_bf16 a[8:11],a[128:131],a[240:243],a[8:11]
 ds_read_b64_tr_b16 a[156:157],v22 offset:26400
 v_mul_f32 v123,v123,v107
 v_mfma_f32_16x16x32_bf16 a[8:11],a[132:135],a[244:247],a[8:11]
 buffer_load_dwordx4 a[168:171],v4,s[8:11],s57 offen offset:2048 sc1
 v_mfma_f32_16x16x32_bf16 a[12:15],a[128:131],a[248:251],a[12:15]
 ds_read_b64_tr_b16 a[158:159],v22 offset:26656
 v_cvt_pk_bf16_f32 v105,v122,v123
 v_mfma_f32_16x16x32_bf16 a[12:15],a[132:135],a[252:255],a[12:15]
 v_mul_f32 v109,v27,v109
 v_mul_f32 v110,v28,v110
 v_mfma_f32_16x16x32_bf16 a[16:19],a[136:139],a[224:227],a[16:19]
 ds_read_b64_tr_b16 a[128:129],v22 offset:17664
 v_mul_f32 v111,v29,v111
 v_mfma_f32_16x16x32_bf16 a[16:19],a[140:143],a[228:231],a[16:19]
 v_exp_f32 v108,v108
 v_mfma_f32_16x16x32_bf16 a[20:23],a[136:139],a[232:235],a[20:23]
 ds_read_b64_tr_b16 a[130:131],v22 offset:17920
 v_add_f32 v108,1.0,v108
 v_mfma_f32_16x16x32_bf16 a[20:23],a[140:143],a[236:239],a[20:23]
 buffer_load_dwordx4 a[172:175],v4,s[8:11],s57 offen offset:3072 sc1
 v_mfma_f32_16x16x32_bf16 a[24:27],a[136:139],a[240:243],a[24:27]
 ds_read_b64_tr_b16 a[132:133],v22 offset:26432
 v_mul_f32 v24,v128,v128
 v_mfma_f32_16x16x32_bf16 a[24:27],a[140:143],a[244:247],a[24:27]
 v_exp_f32 v109,v109
 v_mfma_f32_16x16x32_bf16 a[28:31],a[136:139],a[248:251],a[28:31]
 ds_read_b64_tr_b16 a[134:135],v22 offset:26688
 v_add_f32 v109,1.0,v109
 v_mfma_f32_16x16x32_bf16 a[28:31],a[140:143],a[252:255],a[28:31]
 v_mul_f32 v25,v129,v129
 s_waitcnt lgkmcnt(4)
 v_mfma_f32_16x16x32_bf16 a[32:35],a[144:147],a[224:227],a[32:35]
 ds_read_b64_tr_b16 a[136:137],v22 offset:17696
 v_mul_f32 v26,v130,v130
 v_mfma_f32_16x16x32_bf16 a[32:35],a[148:151],a[228:231],a[32:35]
 buffer_load_dwordx4 a[176:179],v5,s[8:11],s57 offen offset:0 sc1
 v_mfma_f32_16x16x32_bf16 a[36:39],a[144:147],a[232:235],a[36:39]
 ds_read_b64_tr_b16 a[138:139],v22 offset:17952
 v_mul_f32 v27,v131,v131
 v_mfma_f32_16x16x32_bf16 a[36:39],a[148:151],a[236:239],a[36:39]
 buffer_load_dwordx4 a[180:183],v5,s[8:11],s57 offen offset:1024 sc1
 v_mfma_f32_16x16x32_bf16 a[40:43],a[144:147],a[240:243],a[40:43]
 ds_read_b64_tr_b16 a[140:141],v22 offset:26464
 v_mul_f32 v144,v128,v144
 v_mfma_f32_16x16x32_bf16 a[40:43],a[148:151],a[244:247],a[40:43]
 v_exp_f32 v110,v110
 v_mfma_f32_16x16x32_bf16 a[44:47],a[144:147],a[248:251],a[44:47]
 ds_read_b64_tr_b16 a[142:143],v22 offset:26720
 v_add_f32 v110,1.0,v110
 v_mfma_f32_16x16x32_bf16 a[44:47],a[148:151],a[252:255],a[44:47]
 v_exp_f32 v111,v111
 v_mfma_f32_16x16x32_bf16 a[48:51],a[152:155],a[224:227],a[48:51]
 ds_read_b64_tr_b16 a[144:145],v22 offset:17728
 v_add_f32 v111,1.0,v111
 v_mfma_f32_16x16x32_bf16 a[48:51],a[156:159],a[228:231],a[48:51]
 buffer_load_dwordx4 a[184:187],v5,s[8:11],s57 offen offset:2048 sc1
 v_mfma_f32_16x16x32_bf16 a[52:55],a[152:155],a[232:235],a[52:55]
 ds_read_b64_tr_b16 a[146:147],v22 offset:17984
 v_mul_f32 v145,v129,v145
 v_mfma_f32_16x16x32_bf16 a[52:55],a[156:159],a[236:239],a[52:55]
 v_rcp_f32 v108,v108
 v_mfma_f32_16x16x32_bf16 a[56:59],a[152:155],a[240:243],a[56:59]
 ds_read_b64_tr_b16 a[148:149],v22 offset:26496
 v_mul_f32 v124,v124,v108
 v_mfma_f32_16x16x32_bf16 a[56:59],a[156:159],a[244:247],a[56:59]
 buffer_load_dwordx4 a[188:191],v5,s[8:11],s57 offen offset:3072 sc1
 v_mfma_f32_16x16x32_bf16 a[60:63],a[152:155],a[248:251],a[60:63]
 ds_read_b64_tr_b16 a[150:151],v22 offset:26752
 v_mul_f32 v146,v130,v146
 v_mfma_f32_16x16x32_bf16 a[60:63],a[156:159],a[252:255],a[60:63]
 v_mul_f32 v147,v131,v147
 s_waitcnt lgkmcnt(4)
 v_mfma_f32_16x16x32_bf16 a[64:67],a[128:131],a[224:227],a[64:67]
 ds_read_b64_tr_b16 a[152:153],v22 offset:17760
 v_fma_f32 v24,v24,s82,v7
 v_mfma_f32_16x16x32_bf16 a[64:67],a[132:135],a[228:231],a[64:67]
 s_add_u32 s63,s63,524288
 v_fma_f32 v25,v25,s82,v7
 v_mfma_f32_16x16x32_bf16 a[68:71],a[128:131],a[232:235],a[68:71]
 ds_read_b64_tr_b16 a[154:155],v22 offset:18016
 s_add_u32 m0,s51,140288
 v_mfma_f32_16x16x32_bf16 a[68:71],a[132:135],a[236:239],a[68:71]
 buffer_load_dwordx4 v8,s[16:19],s63 offen offset:0 lds
 v_mfma_f32_16x16x32_bf16 a[72:75],a[128:131],a[240:243],a[72:75]
 ds_read_b64_tr_b16 a[156:157],v22 offset:26528
 v_fma_f32 v26,v26,s82,v7
 v_mfma_f32_16x16x32_bf16 a[72:75],a[132:135],a[244:247],a[72:75]
 v_rcp_f32 v109,v109
 v_mfma_f32_16x16x32_bf16 a[76:79],a[128:131],a[248:251],a[76:79]
 ds_read_b64_tr_b16 a[158:159],v22 offset:26784
 v_mul_f32 v125,v125,v109
 v_mfma_f32_16x16x32_bf16 a[76:79],a[132:135],a[252:255],a[76:79]
 s_waitcnt vmcnt(33)
 s_barrier
 v_mfma_f32_16x16x32_bf16 a[80:83],a[136:139],a[224:227],a[80:83]
 ds_read_b64_tr_b16 a[128:129],v22 offset:35072
 v_cvt_pk_bf16_f32 v108,v124,v125
 v_mfma_f32_16x16x32_bf16 a[80:83],a[140:143],a[228:231],a[80:83]
 buffer_load_dwordx4 v9,s[16:19],s63 offen offset:1088 lds
 v_mfma_f32_16x16x32_bf16 a[84:87],a[136:139],a[232:235],a[84:87]
 ds_read_b64_tr_b16 a[130:131],v22 offset:35328
 v_fma_f32 v27,v27,s82,v7
 v_mfma_f32_16x16x32_bf16 a[84:87],a[140:143],a[236:239],a[84:87]
 v_rcp_f32 v110,v110
 v_mfma_f32_16x16x32_bf16 a[88:91],a[136:139],a[240:243],a[88:91]
 ds_read_b64_tr_b16 a[132:133],v22 offset:43840
 v_mul_f32 v126,v126,v110
 v_mfma_f32_16x16x32_bf16 a[88:91],a[140:143],a[244:247],a[88:91]
 buffer_load_dwordx4 v10,s[16:19],s63 offen offset:2176 lds
 v_mfma_f32_16x16x32_bf16 a[92:95],a[136:139],a[248:251],a[92:95]
 ds_read_b64_tr_b16 a[134:135],v22 offset:44096
 v_mul_f32 v128,v24,v128
 v_mfma_f32_16x16x32_bf16 a[92:95],a[140:143],a[252:255],a[92:95]
 v_mul_f32 v129,v25,v129
 s_waitcnt lgkmcnt(4)
 v_mfma_f32_16x16x32_bf16 a[96:99],a[144:147],a[224:227],a[96:99]
 ds_read_b64_tr_b16 a[136:137],v22 offset:35104
 v_mul_f32 v130,v26,v130
 v_mfma_f32_16x16x32_bf16 a[96:99],a[148:151],a[228:231],a[96:99]
 buffer_load_dwordx4 v11,s[16:19],s63 offen offset:3264 lds
 v_mfma_f32_16x16x32_bf16 a[100:103],a[144:147],a[232:235],a[100:103]
 ds_read_b64_tr_b16 a[138:139],v22 offset:35360
 v_mul_f32 v131,v27,v131
 v_mfma_f32_16x16x32_bf16 a[100:103],a[148:151],a[236:239],a[100:103]
 v_rcp_f32 v111,v111
 v_mfma_f32_16x16x32_bf16 a[104:107],a[144:147],a[240:243],a[104:107]
 ds_read_b64_tr_b16 a[140:141],v22 offset:43872
 v_mul_f32 v127,v127,v111
 v_mfma_f32_16x16x32_bf16 a[104:107],a[148:151],a[244:247],a[104:107]
 v_cvt_pk_bf16_f32 v109,v126,v127
 v_mul_f32 v28,v132,v132
 v_mfma_f32_16x16x32_bf16 a[108:111],a[144:147],a[248:251],a[108:111]
 ds_read_b64_tr_b16 a[142:143],v22 offset:44128
 s_add_u32 s57,s57,8192
 v_mfma_f32_16x16x32_bf16 a[108:111],a[148:151],a[252:255],a[108:111]
 buffer_load_dwordx4 a[192:195],v4,s[8:11],s57 offen offset:0 sc1
 v_mfma_f32_16x16x32_bf16 a[112:115],a[152:155],a[224:227],a[112:115]
 ds_read_b64_tr_b16 a[144:145],v22 offset:35136
 v_mul_f32 v29,v133,v133
 v_mfma_f32_16x16x32_bf16 a[112:115],a[156:159],a[228:231],a[112:115]
 v_exp_f32 v128,v128
 v_mfma_f32_16x16x32_bf16 a[116:119],a[152:155],a[232:235],a[116:119]
 ds_read_b64_tr_b16 a[146:147],v22 offset:35392
 v_add_f32 v128,1.0,v128
 v_mfma_f32_16x16x32_bf16 a[116:119],a[156:159],a[236:239],a[116:119]
 v_exp_f32 v129,v129
 v_mfma_f32_16x16x32_bf16 a[120:123],a[152:155],a[240:243],a[120:123]
 ds_read_b64_tr_b16 a[148:149],v22 offset:43904
 v_add_f32 v129,1.0,v129
 v_mfma_f32_16x16x32_bf16 a[120:123],a[156:159],a[244:247],a[120:123]
 buffer_load_dwordx4 a[196:199],v4,s[8:11],s57 offen offset:1024 sc1
 v_mfma_f32_16x16x32_bf16 a[124:127],a[152:155],a[248:251],a[124:127]
 ds_read_b64_tr_b16 a[150:151],v22 offset:44160
 v_mul_f32 v24,v134,v134
 v_mfma_f32_16x16x32_bf16 a[124:127],a[156:159],a[252:255],a[124:127]
 s_waitcnt vmcnt(30)
 s_waitcnt lgkmcnt(4)
 v_mfma_f32_16x16x32_bf16 a[0:3],a[128:131],v[32:35],a[0:3]
 ds_read_b64_tr_b16 a[152:153],v22 offset:35168
 v_mul_f32 v25,v135,v135
 v_mfma_f32_16x16x32_bf16 a[0:3],a[132:135],v[36:39],a[0:3]
 buffer_load_dwordx4 a[200:203],v4,s[8:11],s57 offen offset:2048 sc1
 v_mfma_f32_16x16x32_bf16 a[4:7],a[128:131],v[40:43],a[4:7]
 ds_read_b64_tr_b16 a[154:155],v22 offset:35424
 v_mul_f32 v148,v132,v148
 v_mfma_f32_16x16x32_bf16 a[4:7],a[132:135],v[44:47],a[4:7]
 v_exp_f32 v130,v130
 v_mfma_f32_16x16x32_bf16 a[8:11],a[128:131],v[48:51],a[8:11]
 ds_read_b64_tr_b16 a[156:157],v22 offset:43936
 v_add_f32 v130,1.0,v130
 v_mfma_f32_16x16x32_bf16 a[8:11],a[132:135],v[52:55],a[8:11]
 buffer_load_dwordx4 a[204:207],v4,s[8:11],s57 offen offset:3072 sc1
 v_mfma_f32_16x16x32_bf16 a[12:15],a[128:131],v[56:59],a[12:15]
 ds_read_b64_tr_b16 a[158:159],v22 offset:44192
 v_mul_f32 v149,v133,v149
 v_mfma_f32_16x16x32_bf16 a[12:15],a[132:135],v[60:63],a[12:15]
 v_exp_f32 v131,v131
 v_mfma_f32_16x16x32_bf16 a[16:19],a[136:139],v[32:35],a[16:19]
 ds_read_b64_tr_b16 a[128:129],v22 offset:35200
 v_add_f32 v131,1.0,v131
 v_mfma_f32_16x16x32_bf16 a[16:19],a[140:143],v[36:39],a[16:19]
 v_rcp_f32 v128,v128
 v_mfma_f32_16x16x32_bf16 a[20:23],a[136:139],v[40:43],a[20:23]
 ds_read_b64_tr_b16 a[130:131],v22 offset:35456
 v_mul_f32 v144,v144,v128
 v_mfma_f32_16x16x32_bf16 a[20:23],a[140:143],v[44:47],a[20:23]
 buffer_load_dwordx4 a[208:211],v5,s[8:11],s57 offen offset:0 sc1
 v_mfma_f32_16x16x32_bf16 a[24:27],a[136:139],v[48:51],a[24:27]
 ds_read_b64_tr_b16 a[132:133],v22 offset:43968
 v_mul_f32 v150,v134,v150
 v_mfma_f32_16x16x32_bf16 a[24:27],a[140:143],v[52:55],a[24:27]
 v_rcp_f32 v129,v129
 v_mfma_f32_16x16x32_bf16 a[28:31],a[136:139],v[56:59],a[28:31]
 ds_read_b64_tr_b16 a[134:135],v22 offset:44224
 v_mul_f32 v145,v145,v129
 v_mfma_f32_16x16x32_bf16 a[28:31],a[140:143],v[60:63],a[28:31]
 v_cvt_pk_bf16_f32 v98,v144,v145
 s_waitcnt lgkmcnt(4)
 v_mfma_f32_16x16x32_bf16 a[32:35],a[144:147],v[32:35],a[32:35]
 ds_read_b64_tr_b16 a[136:137],v22 offset:35232
 v_mul_f32 v151,v135,v151
 v_mfma_f32_16x16x32_bf16 a[32:35],a[148:151],v[36:39],a[32:35]
 buffer_load_dwordx4 a[212:215],v5,s[8:11],s57 offen offset:1024 sc1
 v_mfma_f32_16x16x32_bf16 a[36:39],a[144:147],v[40:43],a[36:39]
 ds_read_b64_tr_b16 a[138:139],v22 offset:35488
 v_fma_f32 v28,v28,s82,v7
 v_mfma_f32_16x16x32_bf16 a[36:39],a[148:151],v[44:47],a[36:39]
 buffer_load_dwordx4 a[216:219],v5,s[8:11],s57 offen offset:2048 sc1
 v_mfma_f32_16x16x32_bf16 a[40:43],a[144:147],v[48:51],a[40:43]
 ds_read_b64_tr_b16 a[140:141],v22 offset:44000
 v_fma_f32 v29,v29,s82,v7
 v_mfma_f32_16x16x32_bf16 a[40:43],a[148:151],v[52:55],a[40:43]
 v_rcp_f32 v130,v130
 v_mfma_f32_16x16x32_bf16 a[44:47],a[144:147],v[56:59],a[44:47]
 ds_read_b64_tr_b16 a[142:143],v22 offset:44256
 v_mul_f32 v146,v146,v130
 v_mfma_f32_16x16x32_bf16 a[44:47],a[148:151],v[60:63],a[44:47]
 v_rcp_f32 v131,v131
 v_mfma_f32_16x16x32_bf16 a[48:51],a[152:155],v[32:35],a[48:51]
 ds_read_b64_tr_b16 a[144:145],v22 offset:35264
 v_mul_f32 v147,v147,v131
 v_mfma_f32_16x16x32_bf16 a[48:51],a[156:159],v[36:39],a[48:51]
 buffer_load_dwordx4 a[220:223],v5,s[8:11],s57 offen offset:3072 sc1
 v_mfma_f32_16x16x32_bf16 a[52:55],a[152:155],v[40:43],a[52:55]
 ds_read_b64_tr_b16 a[146:147],v22 offset:35520
 v_cvt_pk_bf16_f32 v99,v146,v147
 v_mfma_f32_16x16x32_bf16 a[52:55],a[156:159],v[44:47],a[52:55]
 s_add_u32 s63,s63,524288
 v_fma_f32 v24,v24,s82,v7
 v_mfma_f32_16x16x32_bf16 a[56:59],a[152:155],v[48:51],a[56:59]
 ds_read_b64_tr_b16 a[148:149],v22 offset:44032
 s_add_u32 m0,s51,0
 v_mfma_f32_16x16x32_bf16 a[56:59],a[156:159],v[52:55],a[56:59]
 buffer_load_dwordx4 v8,s[16:19],s63 offen offset:0 lds
 v_mfma_f32_16x16x32_bf16 a[60:63],a[152:155],v[56:59],a[60:63]
 ds_read_b64_tr_b16 a[150:151],v22 offset:44288
 v_fma_f32 v25,v25,s82,v7
 v_mfma_f32_16x16x32_bf16 a[60:63],a[156:159],v[60:63],a[60:63]
 v_mul_f32 v132,v28,v132
 s_waitcnt lgkmcnt(4)
 v_mfma_f32_16x16x32_bf16 a[64:67],a[128:131],v[32:35],a[64:67]
 ds_read_b64_tr_b16 a[152:153],v22 offset:35296
 v_mul_f32 v133,v29,v133
 v_mfma_f32_16x16x32_bf16 a[64:67],a[132:135],v[36:39],a[64:67]
 v_mul_f32 v134,v24,v134
 v_mul_f32 v135,v25,v135
 v_mfma_f32_16x16x32_bf16 a[68:71],a[128:131],v[40:43],a[68:71]
 ds_read_b64_tr_b16 a[154:155],v22 offset:35552
 v_mul_f32 v26,v136,v136
 v_mfma_f32_16x16x32_bf16 a[68:71],a[132:135],v[44:47],a[68:71]
 buffer_load_dwordx4 v9,s[16:19],s63 offen offset:1088 lds
 v_mfma_f32_16x16x32_bf16 a[72:75],a[128:131],v[48:51],a[72:75]
 ds_read_b64_tr_b16 a[156:157],v22 offset:44064
 v_mul_f32 v27,v137,v137
 v_mfma_f32_16x16x32_bf16 a[72:75],a[132:135],v[52:55],a[72:75]
 v_exp_f32 v132,v132
 v_mfma_f32_16x16x32_bf16 a[76:79],a[128:131],v[56:59],a[76:79]
 ds_read_b64_tr_b16 a[158:159],v22 offset:44320
 v_add_f32 v132,1.0,v132
 v_mfma_f32_16x16x32_bf16 a[76:79],a[132:135],v[60:63],a[76:79]
 s_waitcnt vmcnt(34)
 s_barrier
 v_mfma_f32_16x16x32_bf16 a[80:83],a[136:139],v[32:35],a[80:83]
 ds_read_b64_tr_b16 a[128:129],v23 offset:0
 v_mul_f32 v28,v138,v138
 v_mfma_f32_16x16x32_bf16 a[80:83],a[140:143],v[36:39],a[80:83]
 buffer_load_dwordx4 v10,s[16:19],s63 offen offset:2176 lds
 v_mfma_f32_16x16x32_bf16 a[84:87],a[136:139],v[40:43],a[84:87]
 ds_read_b64_tr_b16 a[130:131],v23 offset:256
 v_mul_f32 v29,v139,v139
 v_mfma_f32_16x16x32_bf16 a[84:87],a[140:143],v[44:47],a[84:87]
 v_exp_f32 v133,v133
 v_mfma_f32_16x16x32_bf16 a[88:91],a[136:139],v[48:51],a[88:91]
 ds_read_b64_tr_b16 a[132:133],v23 offset:8768
 v_add_f32 v133,1.0,v133
 v_mfma_f32_16x16x32_bf16 a[88:91],a[140:143],v[52:55],a[88:91]
 buffer_load_dwordx4 v11,s[16:19],s63 offen offset:3264 lds
 v_mfma_f32_16x16x32_bf16 a[92:95],a[136:139],v[56:59],a[92:95]
 ds_read_b64_tr_b16 a[134:135],v23 offset:9024
 v_mul_f32 v152,v136,v152
 v_mfma_f32_16x16x32_bf16 a[92:95],a[140:143],v[60:63],a[92:95]
 v_mul_f32 v153,v137,v153
 s_waitcnt lgkmcnt(4)
 v_mfma_f32_16x16x32_bf16 a[96:99],a[144:147],v[32:35],a[96:99]
 ds_read_b64_tr_b16 a[136:137],v23 offset:32
 s_add_u32 s57,s57,8192
 v_mfma_f32_16x16x32_bf16 a[96:99],a[148:151],v[36:39],a[96:99]
 buffer_load_dwordx4 a[224:227],v4,s[8:11],s57 offen offset:0 sc1
 v_mfma_f32_16x16x32_bf16 a[100:103],a[144:147],v[40:43],a[100:103]
 ds_read_b64_tr_b16 a[138:139],v23 offset:288
 v_mul_f32 v154,v138,v154
 v_mfma_f32_16x16x32_bf16 a[100:103],a[148:151],v[44:47],a[100:103]
 v_exp_f32 v134,v134
 v_mfma_f32_16x16x32_bf16 a[104:107],a[144:147],v[48:51],a[104:107]
 ds_read_b64_tr_b16 a[140:141],v23 offset:8800
 v_add_f32 v134,1.0,v134
 v_mfma_f32_16x16x32_bf16 a[104:107],a[148:151],v[52:55],a[104:107]
 v_exp_f32 v135,v135
 v_mfma_f32_16x16x32_bf16 a[108:111],a[144:147],v[56:59],a[108:111]
 ds_read_b64_tr_b16 a[142:143],v23 offset:9056
 v_add_f32 v135,1.0,v135
 v_mfma_f32_16x16x32_bf16 a[108:111],a[148:151],v[60:63],a[108:111]
 buffer_load_dwordx4 a[228:231],v4,s[8:11],s57 offen offset:1024 sc1
 v_mfma_f32_16x16x32_bf16 a[112:115],a[152:155],v[32:35],a[112:115]
 ds_read_b64_tr_b16 a[144:145],v23 offset:64
 v_mul_f32 v155,v139,v155
 v_mfma_f32_16x16x32_bf16 a[112:115],a[156:159],v[36:39],a[112:115]
 v_rcp_f32 v132,v132
 v_mfma_f32_16x16x32_bf16 a[116:119],a[152:155],v[40:43],a[116:119]
 ds_read_b64_tr_b16 a[146:147],v23 offset:320
 v_mul_f32 v148,v148,v132
 v_mfma_f32_16x16x32_bf16 a[116:119],a[156:159],v[44:47],a[116:119]
 v_rcp_f32 v133,v133
 v_mfma_f32_16x16x32_bf16 a[120:123],a[152:155],v[48:51],a[120:123]
 ds_read_b64_tr_b16 a[148:149],v23 offset:8832
 v_mul_f32 v149,v149,v133
 v_mfma_f32_16x16x32_bf16 a[120:123],a[156:159],v[52:55],a[120:123]
 buffer_load_dwordx4 a[232:235],v4,s[8:11],s57 offen offset:2048 sc1
 v_mfma_f32_16x16x32_bf16 a[124:127],a[152:155],v[56:59],a[124:127]
 ds_read_b64_tr_b16 a[150:151],v23 offset:9088
 v_cvt_pk_bf16_f32 v102,v148,v149
 v_mfma_f32_16x16x32_bf16 a[124:127],a[156:159],v[60:63],a[124:127]
 s_waitcnt vmcnt(31)
 s_waitcnt lgkmcnt(4)
 v_mfma_f32_16x16x32_bf16 a[0:3],a[128:131],v[64:67],a[0:3]
 ds_read_b64_tr_b16 a[152:153],v23 offset:96
 v_fma_f32 v26,v26,s82,v7
 v_mfma_f32_16x16x32_bf16 a[0:3],a[132:135],v[68:71],a[0:3]
 buffer_load_dwordx4 a[236:239],v4,s[8:11],s57 offen offset:3072 sc1
 v_mfma_f32_16x16x32_bf16 a[4:7],a[128:131],v[72:75],a[4:7]
 ds_read_b64_tr_b16 a[154:155],v23 offset:352
 v_fma_f32 v27,v27,s82,v7
 v_mfma_f32_16x16x32_bf16 a[4:7],a[132:135],v[76:79],a[4:7]
 v_rcp_f32 v134,v134
 v_mfma_f32_16x16x32_bf16 a[8:11],a[128:131],v[80:83],a[8:11]
 ds_read_b64_tr_b16 a[156:157],v23 offset:8864
 v_mul_f32 v150,v150,v134
 v_mfma_f32_16x16x32_bf16 a[8:11],a[132:135],v[84:87],a[8:11]
 buffer_load_dwordx4 a[240:243],v5,s[8:11],s57 offen offset:0 sc1
 v_mfma_f32_16x16x32_bf16 a[12:15],a[128:131],v[88:91],a[12:15]
 ds_read_b64_tr_b16 a[158:159],v23 offset:9120
 v_fma_f32 v28,v28,s82,v7
 v_mfma_f32_16x16x32_bf16 a[12:15],a[132:135],v[92:95],a[12:15]
 v_rcp_f32 v135,v135
 v_mfma_f32_16x16x32_bf16 a[16:19],a[136:139],v[64:67],a[16:19]
 ds_read_b64_tr_b16 a[128:129],v23 offset:128
 v_mul_f32 v151,v151,v135
 v_mfma_f32_16x16x32_bf16 a[16:19],a[140:143],v[68:71],a[16:19]
 v_cvt_pk_bf16_f32 v103,v150,v151
 v_fma_f32 v29,v29,s82,v7
 v_mfma_f32_16x16x32_bf16 a[20:23],a[136:139],v[72:75],a[20:23]
 ds_read_b64_tr_b16 a[130:131],v23 offset:384
 v_mul_f32 v136,v26,v136
 v_mfma_f32_16x16x32_bf16 a[20:23],a[140:143],v[76:79],a[20:23]
 buffer_load_dwordx4 a[244:247],v5,s[8:11],s57 offen offset:1024 sc1
 v_mfma_f32_16x16x32_bf16 a[24:27],a[136:139],v[80:83],a[24:27]
 ds_read_b64_tr_b16 a[132:133],v23 offset:8896
 v_mul_f32 v137,v27,v137
 v_mfma_f32_16x16x32_bf16 a[24:27],a[140:143],v[84:87],a[24:27]
 v_mul_f32 v138,v28,v138
 v_mul_f32 v139,v29,v139
 v_mfma_f32_16x16x32_bf16 a[28:31],a[136:139],v[88:91],a[28:31]
 ds_read_b64_tr_b16 a[134:135],v23 offset:9152
 v_mul_f32 v24,v140,v140
 v_mfma_f32_16x16x32_bf16 a[28:31],a[140:143],v[92:95],a[28:31]
 v_mul_f32 v25,v141,v141
 s_waitcnt lgkmcnt(4)
 v_mfma_f32_16x16x32_bf16 a[32:35],a[144:147],v[64:67],a[32:35]
 ds_read_b64_tr_b16 a[136:137],v23 offset:160
 v_mul_f32 v26,v142,v142
 v_mfma_f32_16x16x32_bf16 a[32:35],a[148:151],v[68:71],a[32:35]
 buffer_load_dwordx4 a[248:251],v5,s[8:11],s57 offen offset:2048 sc1
 v_mfma_f32_16x16x32_bf16 a[36:39],a[144:147],v[72:75],a[36:39]
 ds_read_b64_tr_b16 a[138:139],v23 offset:416
 v_mul_f32 v27,v143,v143
 v_mfma_f32_16x16x32_bf16 a[36:39],a[148:151],v[76:79],a[36:39]
 buffer_load_dwordx4 a[252:255],v5,s[8:11],s57 offen offset:3072 sc1
 v_mfma_f32_16x16x32_bf16 a[40:43],a[144:147],v[80:83],a[40:43]
 ds_read_b64_tr_b16 a[140:141],v23 offset:8928
 v_mul_f32 v156,v140,v156
 v_mfma_f32_16x16x32_bf16 a[40:43],a[148:151],v[84:87],a[40:43]
 v_exp_f32 v136,v136
 v_mfma_f32_16x16x32_bf16 a[44:47],a[144:147],v[88:91],a[44:47]
 ds_read_b64_tr_b16 a[142:143],v23 offset:9184
 v_add_f32 v136,1.0,v136
 v_mfma_f32_16x16x32_bf16 a[44:47],a[148:151],v[92:95],a[44:47]
 s_add_u32 s63,s63,524288
 v_mul_f32 v157,v141,v157
 v_mfma_f32_16x16x32_bf16 a[48:51],a[152:155],v[64:67],a[48:51]
 ds_read_b64_tr_b16 a[144:145],v23 offset:192
 s_add_u32 m0,s51,35072
 v_mfma_f32_16x16x32_bf16 a[48:51],a[156:159],v[68:71],a[48:51]
 buffer_load_dwordx4 v8,s[16:19],s63 offen offset:0 lds
 v_mfma_f32_16x16x32_bf16 a[52:55],a[152:155],v[72:75],a[52:55]
 ds_read_b64_tr_b16 a[146:147],v23 offset:448
 v_mul_f32 v158,v142,v158
 v_mfma_f32_16x16x32_bf16 a[52:55],a[156:159],v[76:79],a[52:55]
 v_exp_f32 v137,v137
 v_mfma_f32_16x16x32_bf16 a[56:59],a[152:155],v[80:83],a[56:59]
 ds_read_b64_tr_b16 a[148:149],v23 offset:8960
 v_add_f32 v137,1.0,v137
 v_mfma_f32_16x16x32_bf16 a[56:59],a[156:159],v[84:87],a[56:59]
 buffer_load_dwordx4 v9,s[16:19],s63 offen offset:1088 lds
 v_mfma_f32_16x16x32_bf16 a[60:63],a[152:155],v[88:91],a[60:63]
 ds_read_b64_tr_b16 a[150:151],v23 offset:9216
 v_mul_f32 v159,v143,v159
 v_mfma_f32_16x16x32_bf16 a[60:63],a[156:159],v[92:95],a[60:63]
 v_fma_f32 v24,v24,s82,v7
 s_waitcnt lgkmcnt(4)
 v_mfma_f32_16x16x32_bf16 a[64:67],a[128:131],v[64:67],a[64:67]
 ds_read_b64_tr_b16 a[152:153],v23 offset:224
 v_fma_f32 v25,v25,s82,v7
 v_mfma_f32_16x16x32_bf16 a[64:67],a[132:135],v[68:71],a[64:67]
 v_exp_f32 v138,v138
 v_mfma_f32_16x16x32_bf16 a[68:71],a[128:131],v[72:75],a[68:71]
 ds_read_b64_tr_b16 a[154:155],v23 offset:480
 v_add_f32 v138,1.0,v138
 v_mfma_f32_16x16x32_bf16 a[68:71],a[132:135],v[76:79],a[68:71]
 buffer_load_dwordx4 v10,s[16:19],s63 offen offset:2176 lds
 v_mfma_f32_16x16x32_bf16 a[72:75],a[128:131],v[80:83],a[72:75]
 ds_read_b64_tr_b16 a[156:157],v23 offset:8992
 v_fma_f32 v26,v26,s82,v7
 v_mfma_f32_16x16x32_bf16 a[72:75],a[132:135],v[84:87],a[72:75]
 v_exp_f32 v139,v139
 v_mfma_f32_16x16x32_bf16 a[76:79],a[128:131],v[88:91],a[76:79]
 ds_read_b64_tr_b16 a[158:159],v23 offset:9248
 v_add_f32 v139,1.0,v139
 v_mfma_f32_16x16x32_bf16 a[76:79],a[132:135],v[92:95],a[76:79]
 s_waitcnt vmcnt(35)
 s_barrier
 v_mfma_f32_16x16x32_bf16 a[80:83],a[136:139],v[64:67],a[80:83]
 ds_read_b64_tr_b16 a[128:129],v23 offset:17536
 v_fma_f32 v27,v27,s82,v7
 v_mfma_f32_16x16x32_bf16 a[80:83],a[140:143],v[68:71],a[80:83]
 buffer_load_dwordx4 v11,s[16:19],s63 offen offset:3264 lds
 v_mfma_f32_16x16x32_bf16 a[84:87],a[136:139],v[72:75],a[84:87]
 ds_read_b64_tr_b16 a[130:131],v23 offset:17792
 v_mul_f32 v140,v24,v140
 v_mfma_f32_16x16x32_bf16 a[84:87],a[140:143],v[76:79],a[84:87]
 v_rcp_f32 v136,v136
 v_mfma_f32_16x16x32_bf16 a[88:91],a[136:139],v[80:83],a[88:91]
 ds_read_b64_tr_b16 a[132:133],v23 offset:26304
 s_add_u32 s57,s57,8192
 v_mfma_f32_16x16x32_bf16 a[88:91],a[140:143],v[84:87],a[88:91]
 buffer_load_dwordx4 v[32:35],v4,s[8:11],s57 offen offset:0 sc1
 v_mfma_f32_16x16x32_bf16 a[92:95],a[136:139],v[88:91],a[92:95]
 ds_read_b64_tr_b16 a[134:135],v23 offset:26560
 v_mul_f32 v152,v152,v136
 v_mfma_f32_16x16x32_bf16 a[92:95],a[140:143],v[92:95],a[92:95]
 v_mul_f32 v141,v25,v141
 s_waitcnt lgkmcnt(4)
 v_mfma_f32_16x16x32_bf16 a[96:99],a[144:147],v[64:67],a[96:99]
 ds_read_b64_tr_b16 a[136:137],v23 offset:17568
 v_mul_f32 v142,v26,v142
 v_mfma_f32_16x16x32_bf16 a[96:99],a[148:151],v[68:71],a[96:99]
 buffer_load_dwordx4 v[36:39],v4,s[8:11],s57 offen offset:1024 sc1
 v_mfma_f32_16x16x32_bf16 a[100:103],a[144:147],v[72:75],a[100:103]
 ds_read_b64_tr_b16 a[138:139],v23 offset:17824
 v_mul_f32 v143,v27,v143
 v_mfma_f32_16x16x32_bf16 a[100:103],a[148:151],v[76:79],a[100:103]
 v_rcp_f32 v137,v137
 v_mfma_f32_16x16x32_bf16 a[104:107],a[144:147],v[80:83],a[104:107]
 ds_read_b64_tr_b16 a[140:141],v23 offset:26336
L_w9:
 s_cbranch_execz L_w13
 v_mul_f32 v153,v153,v137
 v_mfma_f32_16x16x32_bf16 a[104:107],a[148:151],v[84:87],a[104:107]
 v_rcp_f32 v138,v138
 v_mfma_f32_16x16x32_bf16 a[108:111],a[144:147],v[88:91],a[108:111]
 ds_read_b64_tr_b16 a[142:143],v23 offset:26592
 v_mul_f32 v154,v154,v138
 v_mfma_f32_16x16x32_bf16 a[108:111],a[148:151],v[92:95],a[108:111]
 buffer_load_dwordx4 v[40:43],v4,s[8:11],s57 offen offset:2048 sc1
 v_mfma_f32_16x16x32_bf16 a[112:115],a[152:155],v[64:67],a[112:115]
 ds_read_b64_tr_b16 a[144:145],v23 offset:17600
 v_cvt_pk_bf16_f32 v106,v152,v153
 v_mfma_f32_16x16x32_bf16 a[112:115],a[156:159],v[68:71],a[112:115]
 v_rcp_f32 v139,v139
 v_mfma_f32_16x16x32_bf16 a[116:119],a[152:155],v[72:75],a[116:119]
 ds_read_b64_tr_b16 a[146:147],v23 offset:17856
 v_mul_f32 v155,v155,v139
 v_mfma_f32_16x16x32_bf16 a[116:119],a[156:159],v[76:79],a[116:119]
 v_cvt_pk_bf16_f32 v107,v154,v155
 v_mul_f32 v28,v160,v160
 v_mfma_f32_16x16x32_bf16 a[120:123],a[152:155],v[80:83],a[120:123]
 ds_read_b64_tr_b16 a[148:149],v23 offset:26368
 v_mul_f32 v29,v161,v161
 v_mfma_f32_16x16x32_bf16 a[120:123],a[156:159],v[84:87],a[120:123]
 buffer_load_dwordx4 v[44:47],v4,s[8:11],s57 offen offset:3072 sc1
 v_mfma_f32_16x16x32_bf16 a[124:127],a[152:155],v[88:91],a[124:127]
 ds_read_b64_tr_b16 a[150:151],v23 offset:26624
 v_mul_f32 v24,v162,v162
 v_mfma_f32_16x16x32_bf16 a[124:127],a[156:159],v[92:95],a[124:127]
 s_waitcnt vmcnt(32)
 s_waitcnt lgkmcnt(4)
 v_mfma_f32_16x16x32_bf16 a[0:3],a[128:131],a[160:163],a[0:3]
 ds_read_b64_tr_b16 a[152:153],v23 offset:17632
 v_mul_f32 v25,v163,v163
 v_mfma_f32_16x16x32_bf16 a[0:3],a[132:135],a[164:167],a[0:3]
 buffer_load_dwordx4 v[48:51],v5,s[8:11],s57 offen offset:0 sc1
 v_mfma_f32_16x16x32_bf16 a[4:7],a[128:131],a[168:171],a[4:7]
 ds_read_b64_tr_b16 a[154:155],v23 offset:17888
 v_mul_f32 v176,v160,v176
 v_mfma_f32_16x16x32_bf16 a[4:7],a[132:135],a[172:175],a[4:7]
 v_exp_f32 v140,v140
 v_mfma_f32_16x16x32_bf16 a[8:11],a[128:131],a[176:179],a[8:11]
 ds_read_b64_tr_b16 a[156:157],v23 offset:26400
 v_add_f32 v140,1.0,v140
 v_mfma_f32_16x16x32_bf16 a[8:11],a[132:135],a[180:183],a[8:11]
 buffer_load_dwordx4 v[52:55],v5,s[8:11],s57 offen offset:1024 sc1
 v_mfma_f32_16x16x32_bf16 a[12:15],a[128:131],a[184:187],a[12:15]
 ds_read_b64_tr_b16 a[158:159],v23 offset:26656
 v_mul_f32 v177,v161,v177
 v_mfma_f32_16x16x32_bf16 a[12:15],a[132:135],a[188:191],a[12:15]
 v_exp_f32 v141,v141
 v_mfma_f32_16x16x32_bf16 a[16:19],a[136:139],a[160:163],a[16:19]
 ds_read_b64_tr_b16 a[128:129],v23 offset:17664
 v_add_f32 v141,1.0,v141
 v_mfma_f32_16x16x32_bf16 a[16:19],a[140:143],a[164:167],a[16:19]
 v_exp_f32 v142,v142
 v_mfma_f32_16x16x32_bf16 a[20:23],a[136:139],a[168:171],a[20:23]
 ds_read_b64_tr_b16 a[130:131],v23 offset:17920
 v_add_f32 v142,1.0,v142
 v_mfma_f32_16x16x32_bf16 a[20:23],a[140:143],a[172:175],a[20:23]
 buffer_load_dwordx4 v[56:59],v5,s[8:11],s57 offen offset:2048 sc1
 v_mfma_f32_16x16x32_bf16 a[24:27],a[136:139],a[176:179],a[24:27]
 ds_read_b64_tr_b16 a[132:133],v23 offset:26432
 v_mul_f32 v178,v162,v178
 v_mfma_f32_16x16x32_bf16 a[24:27],a[140:143],a[180:183],a[24:27]
 v_exp_f32 v143,v143
 v_mfma_f32_16x16x32_bf16 a[28:31],a[136:139],a[184:187],a[28:31]
 ds_read_b64_tr_b16 a[134:135],v23 offset:26688
 v_add_f32 v143,1.0,v143
 v_mfma_f32_16x16x32_bf16 a[28:31],a[140:143],a[188:191],a[28:31]
 v_mul_f32 v179,v163,v179
 s_waitcnt lgkmcnt(4)
 v_mfma_f32_16x16x32_bf16 a[32:35],a[144:147],a[160:163],a[32:35]
 ds_read_b64_tr_b16 a[136:137],v23 offset:17696
 s_add_u32 s63,s63,524288
 v_mfma_f32_16x16x32_bf16 a[32:35],a[148:151],a[164:167],a[32:35]
 buffer_load_dwordx4 v[60:63],v5,s[8:11],s57 offen offset:3072 sc1
 v_mfma_f32_16x16x32_bf16 a[36:39],a[144:147],a[168:171],a[36:39]
 ds_read_b64_tr_b16 a[138:139],v23 offset:17952
 s_add_u32 m0,s51,17536
 v_mfma_f32_16x16x32_bf16 a[36:39],a[148:151],a[172:175],a[36:39]
 buffer_load_dwordx4 v8,s[16:19],s63 offen offset:0 lds
 v_mfma_f32_16x16x32_bf16 a[40:43],a[144:147],a[176:179],a[40:43]
 ds_read_b64_tr_b16 a[140:141],v23 offset:26464
 v_fma_f32 v28,v28,s82,v7
 v_mfma_f32_16x16x32_bf16 a[40:43],a[148:151],a[180:183],a[40:43]
 v_rcp_f32 v140,v140
 v_mfma_f32_16x16x32_bf16 a[44:47],a[144:147],a[184:187],a[44:47]
 ds_read_b64_tr_b16 a[142:143],v23 offset:26720
 v_mul_f32 v156,v156,v140
 v_mfma_f32_16x16x32_bf16 a[44:47],a[148:151],a[188:191],a[44:47]
 v_rcp_f32 v141,v141
 v_mfma_f32_16x16x32_bf16 a[48:51],a[152:155],a[160:163],a[48:51]
 ds_read_b64_tr_b16 a[144:145],v23 offset:17728
 v_mul_f32 v157,v157,v141
 v_mfma_f32_16x16x32_bf16 a[48:51],a[156:159],a[164:167],a[48:51]
 buffer_load_dwordx4 v9,s[16:19],s63 offen offset:1088 lds
 v_mfma_f32_16x16x32_bf16 a[52:55],a[152:155],a[168:171],a[52:55]
 ds_read_b64_tr_b16 a[146:147],v23 offset:17984
 v_cvt_pk_bf16_f32 v110,v156,v157
 v_mfma_f32_16x16x32_bf16 a[52:55],a[156:159],a[172:175],a[52:55]
 v_rcp_f32 v142,v142
 v_mfma_f32_16x16x32_bf16 a[56:59],a[152:155],a[176:179],a[56:59]
 ds_read_b64_tr_b16 a[148:149],v23 offset:26496
 v_mul_f32 v158,v158,v142
 v_mfma_f32_16x16x32_bf16 a[56:59],a[156:159],a[180:183],a[56:59]
 buffer_load_dwordx4 v10,s[16:19],s63 offen offset:2176 lds
 v_mfma_f32_16x16x32_bf16 a[60:63],a[152:155],a[184:187],a[60:63]
 ds_read_b64_tr_b16 a[150:151],v23 offset:26752
 v_fma_f32 v29,v29,s82,v7
 v_mfma_f32_16x16x32_bf16 a[60:63],a[156:159],a[188:191],a[60:63]
 v_fma_f32 v24,v24,s82,v7
 s_waitcnt lgkmcnt(4)
 v_mfma_f32_16x16x32_bf16 a[64:67],a[128:131],a[160:163],a[64:67]
 ds_read_b64_tr_b16 a[152:153],v23 offset:17760
 v_fma_f32 v25,v25,s82,v7
 v_mfma_f32_16x16x32_bf16 a[64:67],a[132:135],a[164:167],a[64:67]
 v_rcp_f32 v143,v143
 v_mfma_f32_16x16x32_bf16 a[68:71],a[128:131],a[168:171],a[68:71]
 ds_read_b64_tr_b16 a[154:155],v23 offset:18016
 v_mul_f32 v159,v159,v143
 v_mfma_f32_16x16x32_bf16 a[68:71],a[132:135],a[172:175],a[68:71]
 buffer_load_dwordx4 v11,s[16:19],s63 offen offset:3264 lds
 v_mfma_f32_16x16x32_bf16 a[72:75],a[128:131],a[176:179],a[72:75]
 ds_read_b64_tr_b16 a[156:157],v23 offset:26528
 v_cvt_pk_bf16_f32 v111,v158,v159
 v_mfma_f32_16x16x32_bf16 a[72:75],a[132:135],a[180:183],a[72:75]
 v_mul_f32 v160,v28,v160
 v_mul_f32 v161,v29,v161
 v_mfma_f32_16x16x32_bf16 a[76:79],a[128:131],a[184:187],a[76:79]
 ds_read_b64_tr_b16 a[158:159],v23 offset:26784
 v_mul_f32 v162,v24,v162
 v_mfma_f32_16x16x32_bf16 a[76:79],a[132:135],a[188:191],a[76:79]
 s_waitcnt vmcnt(36)
 s_barrier
 v_mfma_f32_16x16x32_bf16 a[80:83],a[136:139],a[160:163],a[80:83]
 ds_read_b64_tr_b16 a[128:129],v23 offset:35072
 s_add_u32 s57,s57,8192
 v_mfma_f32_16x16x32_bf16 a[80:83],a[140:143],a[164:167],a[80:83]
 buffer_load_dwordx4 v[64:67],v4,s[8:11],s57 offen offset:0 sc1
 v_mfma_f32_16x16x32_bf16 a[84:87],a[136:139],a[168:171],a[84:87]
 ds_read_b64_tr_b16 a[130:131],v23 offset:35328
 v_mul_f32 v163,v25,v163
 v_mfma_f32_16x16x32_bf16 a[84:87],a[140:143],a[172:175],a[84:87]
 v_exp_f32 v160,v160
 v_mfma_f32_16x16x32_bf16 a[88:91],a[136:139],a[176:179],a[88:91]
 ds_read_b64_tr_b16 a[132:133],v23 offset:43840
 v_add_f32 v160,1.0,v160
 v_mfma_f32_16x16x32_bf16 a[88:91],a[140:143],a[180:183],a[88:91]
 buffer_load_dwordx4 v[68:71],v4,s[8:11],s57 offen offset:1024 sc1
 v_mfma_f32_16x16x32_bf16 a[92:95],a[136:139],a[184:187],a[92:95]
 ds_read_b64_tr_b16 a[134:135],v23 offset:44096
 v_mul_f32 v26,v164,v164
 v_mfma_f32_16x16x32_bf16 a[92:95],a[140:143],a[188:191],a[92:95]
 v_mul_f32 v27,v165,v165
 s_waitcnt lgkmcnt(4)
 v_mfma_f32_16x16x32_bf16 a[96:99],a[144:147],a[160:163],a[96:99]
 ds_read_b64_tr_b16 a[136:137],v23 offset:35104
 v_mul_f32 v28,v166,v166
 v_mfma_f32_16x16x32_bf16 a[96:99],a[148:151],a[164:167],a[96:99]
 buffer_load_dwordx4 v[72:75],v4,s[8:11],s57 offen offset:2048 sc1
 v_mfma_f32_16x16x32_bf16 a[100:103],a[144:147],a[168:171],a[100:103]
 ds_read_b64_tr_b16 a[138:139],v23 offset:35360
 v_mul_f32 v29,v167,v167
 v_mfma_f32_16x16x32_bf16 a[100:103],a[148:151],a[172:175],a[100:103]
 v_exp_f32 v161,v161
 v_mfma_f32_16x16x32_bf16 a[104:107],a[144:147],a[176:179],a[104:107]
 ds_read_b64_tr_b16 a[140:141],v23 offset:43872
 v_add_f32 v161,1.0,v161
 v_mfma_f32_16x16x32_bf16 a[104:107],a[148:151],a[180:183],a[104:107]
 v_exp_f32 v162,v162
 v_mfma_f32_16x16x32_bf16 a[108:111],a[144:147],a[184:187],a[108:111]
 ds_read_b64_tr_b16 a[142:143],v23 offset:44128
 v_add_f32 v162,1.0,v162
 v_mfma_f32_16x16x32_bf16 a[108:111],a[148:151],a[188:191],a[108:111]
 buffer_load_dwordx4 v[76:79],v4,s[8:11],s57 offen offset:3072 sc1
 v_mfma_f32_16x16x32_bf16 a[112:115],a[152:155],a[160:163],a[112:115]
 ds_read_b64_tr_b16 a[144:145],v23 offset:35136
 v_mul_f32 v180,v164,v180
 v_mfma_f32_16x16x32_bf16 a[112:115],a[156:159],a[164:167],a[112:115]
 v_exp_f32 v163,v163
 v_mfma_f32_16x16x32_bf16 a[116:119],a[152:155],a[168:171],a[116:119]
 ds_read_b64_tr_b16 a[146:147],v23 offset:35392
 v_add_f32 v163,1.0,v163
 v_mfma_f32_16x16x32_bf16 a[116:119],a[156:159],a[172:175],a[116:119]
 v_rcp_f32 v160,v160
 v_mfma_f32_16x16x32_bf16 a[120:123],a[152:155],a[176:179],a[120:123]
 ds_read_b64_tr_b16 a[148:149],v23 offset:43904
 v_mul_f32 v176,v176,v160
 v_mfma_f32_16x16x32_bf16 a[120:123],a[156:159],a[180:183],a[120:123]
 buffer_load_dwordx4 v[80:83],v5,s[8:11],s57 offen offset:0 sc1
 v_mfma_f32_16x16x32_bf16 a[124:127],a[152:155],a[184:187],a[124:127]
 ds_read_b64_tr_b16 a[150:151],v23 offset:44160
 v_mul_f32 v181,v165,v181
 v_mfma_f32_16x16x32_bf16 a[124:127],a[156:159],a[188:191],a[124:127]
 s_waitcnt vmcnt(33)
 s_waitcnt lgkmcnt(4)
 v_mfma_f32_16x16x32_bf16 a[0:3],a[128:131],a[192:195],a[0:3]
 ds_read_b64_tr_b16 a[152:153],v23 offset:35168
 v_mul_f32 v182,v166,v182
 v_mfma_f32_16x16x32_bf16 a[0:3],a[132:135],a[196:199],a[0:3]
 buffer_load_dwordx4 v[84:87],v5,s[8:11],s57 offen offset:1024 sc1
 v_mfma_f32_16x16x32_bf16 a[4:7],a[128:131],a[200:203],a[4:7]
 ds_read_b64_tr_b16 a[154:155],v23 offset:35424
 v_mul_f32 v183,v167,v183
 v_mfma_f32_16x16x32_bf16 a[4:7],a[132:135],a[204:207],a[4:7]
 v_rcp_f32 v161,v161
 v_mfma_f32_16x16x32_bf16 a[8:11],a[128:131],a[208:211],a[8:11]
 ds_read_b64_tr_b16 a[156:157],v23 offset:43936
 v_mul_f32 v177,v177,v161
 v_mfma_f32_16x16x32_bf16 a[8:11],a[132:135],a[212:215],a[8:11]
 buffer_load_dwordx4 v[88:91],v5,s[8:11],s57 offen offset:2048 sc1
 v_mfma_f32_16x16x32_bf16 a[12:15],a[128:131],a[216:219],a[12:15]
 ds_read_b64_tr_b16 a[158:159],v23 offset:44192
 v_cvt_pk_bf16_f32 v160,v176,v177
 v_mfma_f32_16x16x32_bf16 a[12:15],a[132:135],a[220:223],a[12:15]
 v_rcp_f32 v162,v162
 v_mfma_f32_16x16x32_bf16 a[16:19],a[136:139],a[192:195],a[16:19]
 ds_read_b64_tr_b16 a[128:129],v23 offset:35200
 v_mul_f32 v178,v178,v162
 v_mfma_f32_16x16x32_bf16 a[16:19],a[140:143],a[196:199],a[16:19]
 v_rcp_f32 v163,v163
 v_mfma_f32_16x16x32_bf16 a[20:23],a[136:139],a[200:203],a[20:23]
 ds_read_b64_tr_b16 a[130:131],v23 offset:35456
 v_mul_f32 v179,v179,v163
 v_mfma_f32_16x16x32_bf16 a[20:23],a[140:143],a[204:207],a[20:23]
 buffer_load_dwordx4 v[92:95],v5,s[8:11],s57 offen offset:3072 sc1
 v_mfma_f32_16x16x32_bf16 a[24:27],a[136:139],a[208:211],a[24:27]
 ds_read_b64_tr_b16 a[132:133],v23 offset:43968
 v_cvt_pk_bf16_f32 v161,v178,v179
 v_mfma_f32_16x16x32_bf16 a[24:27],a[140:143],a[212:215],a[24:27]
 v_fma_f32 v26,v26,s82,v7
 v_fma_f32 v27,v27,s82,v7
 v_mfma_f32_16x16x32_bf16 a[28:31],a[136:139],a[216:219],a[28:31]
 ds_read_b64_tr_b16 a[134:135],v23 offset:44224
 v_fma_f32 v28,v28,s82,v7
 v_mfma_f32_16x16x32_bf16 a[28:31],a[140:143],a[220:223],a[28:31]
 s_add_u32 s63,s63,524288
 s_waitcnt lgkmcnt(4)
 v_mfma_f32_16x16x32_bf16 a[32:35],a[144:147],a[192:195],a[32:35]
 ds_read_b64_tr_b16 a[136:137],v23 offset:35232
 s_add_u32 m0,s51,70144
 v_mfma_f32_16x16x32_bf16 a[32:35],a[148:151],a[196:199],a[32:35]
 buffer_load_dwordx4 v8,s[16:19],s63 offen offset:0 lds
 v_mfma_f32_16x16x32_bf16 a[36:39],a[144:147],a[200:203],a[36:39]
 ds_read_b64_tr_b16 a[138:139],v23 offset:35488
 v_fma_f32 v29,v29,s82,v7
 v_mfma_f32_16x16x32_bf16 a[36:39],a[148:151],a[204:207],a[36:39]
 v_mul_f32 v164,v26,v164
 v_mul_f32 v165,v27,v165
 v_mfma_f32_16x16x32_bf16 a[40:43],a[144:147],a[208:211],a[40:43]
 ds_read_b64_tr_b16 a[140:141],v23 offset:44000
 v_mul_f32 v166,v28,v166
 v_mfma_f32_16x16x32_bf16 a[40:43],a[148:151],a[212:215],a[40:43]
 buffer_load_dwordx4 v9,s[16:19],s63 offen offset:1088 lds
 v_mfma_f32_16x16x32_bf16 a[44:47],a[144:147],a[216:219],a[44:47]
 ds_read_b64_tr_b16 a[142:143],v23 offset:44256
 v_mul_f32 v167,v29,v167
 v_mfma_f32_16x16x32_bf16 a[44:47],a[148:151],a[220:223],a[44:47]
 v_exp_f32 v164,v164
 v_mfma_f32_16x16x32_bf16 a[48:51],a[152:155],a[192:195],a[48:51]
 ds_read_b64_tr_b16 a[144:145],v23 offset:35264
 v_add_f32 v164,1.0,v164
 v_mfma_f32_16x16x32_bf16 a[48:51],a[156:159],a[196:199],a[48:51]
 buffer_load_dwordx4 v10,s[16:19],s63 offen offset:2176 lds
 v_mfma_f32_16x16x32_bf16 a[52:55],a[152:155],a[200:203],a[52:55]
 ds_read_b64_tr_b16 a[146:147],v23 offset:35520
 v_mul_f32 v24,v168,v168
 v_mfma_f32_16x16x32_bf16 a[52:55],a[156:159],a[204:207],a[52:55]
 v_exp_f32 v165,v165
 v_mfma_f32_16x16x32_bf16 a[56:59],a[152:155],a[208:211],a[56:59]
 ds_read_b64_tr_b16 a[148:149],v23 offset:44032
 v_add_f32 v165,1.0,v165
 v_mfma_f32_16x16x32_bf16 a[56:59],a[156:159],a[212:215],a[56:59]
 buffer_load_dwordx4 v11,s[16:19],s63 offen offset:3264 lds
 v_mfma_f32_16x16x32_bf16 a[60:63],a[152:155],a[216:219],a[60:63]
 ds_read_b64_tr_b16 a[150:151],v23 offset:44288
 v_mul_f32 v25,v169,v169
 v_mfma_f32_16x16x32_bf16 a[60:63],a[156:159],a[220:223],a[60:63]
 v_mul_f32 v26,v170,v170
 s_waitcnt lgkmcnt(4)
 v_mfma_f32_16x16x32_bf16 a[64:67],a[128:131],a[192:195],a[64:67]
 ds_read_b64_tr_b16 a[152:153],v23 offset:35296
 v_mul_f32 v27,v171,v171
 v_mfma_f32_16x16x32_bf16 a[64:67],a[132:135],a[196:199],a[64:67]
 v_exp_f32 v166,v166
 v_mfma_f32_16x16x32_bf16 a[68:71],a[128:131],a[200:203],a[68:71]
 ds_read_b64_tr_b16 a[154:155],v23 offset:35552
 s_add_u32 s57,s57,8192
 v_mfma_f32_16x16x32_bf16 a[68:71],a[132:135],a[204:207],a[68:71]
 buffer_load_dwordx4 a[160:163],v4,s[8:11],s57 offen offset:0 sc1
 v_mfma_f32_16x16x32_bf16 a[72:75],a[128:131],a[208:211],a[72:75]
 ds_read_b64_tr_b16 a[156:157],v23 offset:44064
 v_add_f32 v166,1.0,v166
 v_mfma_f32_16x16x32_bf16 a[72:75],a[132:135],a[212:215],a[72:75]
 v_exp_f32 v167,v167
 v_mfma_f32_16x16x32_bf16 a[76:79],a[128:131],a[216:219],a[76:79]
 ds_read_b64_tr_b16 a[158:159],v23 offset:44320
 v_add_f32 v167,1.0,v167
 v_mfma_f32_16x16x32_bf16 a[76:79],a[132:135],a[220:223],a[76:79]
 s_waitcnt vmcnt(37)
 s_barrier
 v_mfma_f32_16x16x32_bf16 a[80:83],a[136:139],a[192:195],a[80:83]
 ds_read_b64_tr_b16 a[128:129],v21 offset:0
 v_mul_f32 v184,v168,v184
 v_mfma_f32_16x16x32_bf16 a[80:83],a[140:143],a[196:199],a[80:83]
 buffer_load_dwordx4 a[164:167],v4,s[8:11],s57 offen offset:1024 sc1
 v_mfma_f32_16x16x32_bf16 a[84:87],a[136:139],a[200:203],a[84:87]
 ds_read_b64_tr_b16 a[130:131],v21 offset:256
 v_mul_f32 v185,v169,v185
 v_mfma_f32_16x16x32_bf16 a[84:87],a[140:143],a[204:207],a[84:87]
 v_rcp_f32 v164,v164
 v_mfma_f32_16x16x32_bf16 a[88:91],a[136:139],a[208:211],a[88:91]
 ds_read_b64_tr_b16 a[132:133],v21 offset:8768
 v_mul_f32 v180,v180,v164
 v_mfma_f32_16x16x32_bf16 a[88:91],a[140:143],a[212:215],a[88:91]
 buffer_load_dwordx4 a[168:171],v4,s[8:11],s57 offen offset:2048 sc1
 v_mfma_f32_16x16x32_bf16 a[92:95],a[136:139],a[216:219],a[92:95]
 ds_read_b64_tr_b16 a[134:135],v21 offset:9024
 v_mul_f32 v186,v170,v186
 v_mfma_f32_16x16x32_bf16 a[92:95],a[140:143],a[220:223],a[92:95]
 v_mul_f32 v187,v171,v187
 s_waitcnt lgkmcnt(4)
 v_mfma_f32_16x16x32_bf16 a[96:99],a[144:147],a[192:195],a[96:99]
 ds_read_b64_tr_b16 a[136:137],v21 offset:32
 v_fma_f32 v24,v24,s82,v7
 v_mfma_f32_16x16x32_bf16 a[96:99],a[148:151],a[196:199],a[96:99]
 buffer_load_dwordx4 a[172:175],v4,s[8:11],s57 offen offset:3072 sc1
 v_mfma_f32_16x16x32_bf16 a[100:103],a[144:147],a[200:203],a[100:103]
 ds_read_b64_tr_b16 a[138:139],v21 offset:288
 v_fma_f32 v25,v25,s82,v7
 v_mfma_f32_16x16x32_bf16 a[100:103],a[148:151],a[204:207],a[100:103]
 v_rcp_f32 v165,v165
 v_mfma_f32_16x16x32_bf16 a[104:107],a[144:147],a[208:211],a[104:107]
 ds_read_b64_tr_b16 a[140:141],v21 offset:8800
 v_mul_f32 v181,v181,v165
 v_mfma_f32_16x16x32_bf16 a[104:107],a[148:151],a[212:215],a[104:107]
 v_rcp_f32 v166,v166
 v_mfma_f32_16x16x32_bf16 a[108:111],a[144:147],a[216:219],a[108:111]
 ds_read_b64_tr_b16 a[142:143],v21 offset:9056
 v_mul_f32 v182,v182,v166
 v_mfma_f32_16x16x32_bf16 a[108:111],a[148:151],a[220:223],a[108:111]
 buffer_load_dwordx4 a[176:179],v5,s[8:11],s57 offen offset:0 sc1
 v_mfma_f32_16x16x32_bf16 a[112:115],a[152:155],a[192:195],a[112:115]
 ds_read_b64_tr_b16 a[144:145],v21 offset:64
 v_cvt_pk_bf16_f32 v164,v180,v181
 v_mfma_f32_16x16x32_bf16 a[112:115],a[156:159],a[196:199],a[112:115]
 v_rcp_f32 v167,v167
 v_mfma_f32_16x16x32_bf16 a[116:119],a[152:155],a[200:203],a[116:119]
 ds_read_b64_tr_b16 a[146:147],v21 offset:320
 v_mul_f32 v183,v183,v167
 v_mfma_f32_16x16x32_bf16 a[116:119],a[156:159],a[204:207],a[116:119]
 buffer_load_dwordx4 a[180:183],v5,s[8:11],s57 offen offset:1024 sc1
 v_mfma_f32_16x16x32_bf16 a[120:123],a[152:155],a[208:211],a[120:123]
 ds_read_b64_tr_b16 a[148:149],v21 offset:8832
 v_cvt_pk_bf16_f32 v165,v182,v183
 v_mfma_f32_16x16x32_bf16 a[120:123],a[156:159],a[212:215],a[120:123]
 v_fma_f32 v26,v26,s82,v7
 v_fma_f32 v27,v27,s82,v7
 v_mfma_f32_16x16x32_bf16 a[124:127],a[152:155],a[216:219],a[124:127]
 ds_read_b64_tr_b16 a[150:151],v21 offset:9088
 v_mul_f32 v168,v24,v168
 v_mfma_f32_16x16x32_bf16 a[124:127],a[156:159],a[220:223],a[124:127]
 s_waitcnt vmcnt(34)
 s_waitcnt lgkmcnt(4)
 v_mfma_f32_16x16x32_bf16 a[0:3],a[128:131],a[224:227],a[0:3]
 ds_read_b64_tr_b16 a[152:153],v21 offset:96
 v_mul_f32 v169,v25,v169
 v_mfma_f32_16x16x32_bf16 a[0:3],a[132:135],a[228:231],a[0:3]
 buffer_load_dwordx4 a[184:187],v5,s[8:11],s57 offen offset:2048 sc1
 v_mfma_f32_16x16x32_bf16 a[4:7],a[128:131],a[232:235],a[4:7]
 ds_read_b64_tr_b16 a[154:155],v21 offset:352
 v_mul_f32 v170,v26,v170
 v_mfma_f32_16x16x32_bf16 a[4:7],a[132:135],a[236:239],a[4:7]
 v_mul_f32 v171,v27,v171
 v_mul_f32 v28,v172,v172
 v_mfma_f32_16x16x32_bf16 a[8:11],a[128:131],a[240:243],a[8:11]
 ds_read_b64_tr_b16 a[156:157],v21 offset:8864
 v_mul_f32 v29,v173,v173
 v_mfma_f32_16x16x32_bf16 a[8:11],a[132:135],a[244:247],a[8:11]
 buffer_load_dwordx4 a[188:191],v5,s[8:11],s57 offen offset:3072 sc1
 v_mfma_f32_16x16x32_bf16 a[12:15],a[128:131],a[248:251],a[12:15]
 ds_read_b64_tr_b16 a[158:159],v21 offset:9120
 v_mul_f32 v24,v174,v174
 v_mfma_f32_16x16x32_bf16 a[12:15],a[132:135],a[252:255],a[12:15]
 s_add_u32 s63,s63,524288
 v_mul_f32 v25,v175,v175
 v_mfma_f32_16x16x32_bf16 a[16:19],a[136:139],a[224:227],a[16:19]
 ds_read_b64_tr_b16 a[128:129],v21 offset:128
 s_add_u32 m0,s51,52608
 v_mfma_f32_16x16x32_bf16 a[16:19],a[140:143],a[228:231],a[16:19]
 buffer_load_dwordx4 v8,s[16:19],s63 offen offset:0 lds
 v_mfma_f32_16x16x32_bf16 a[20:23],a[136:139],a[232:235],a[20:23]
 ds_read_b64_tr_b16 a[130:131],v21 offset:384
 v_mul_f32 v188,v172,v188
 v_mfma_f32_16x16x32_bf16 a[20:23],a[140:143],a[236:239],a[20:23]
 v_exp_f32 v168,v168
 v_mfma_f32_16x16x32_bf16 a[24:27],a[136:139],a[240:243],a[24:27]
 ds_read_b64_tr_b16 a[132:133],v21 offset:8896
 v_add_f32 v168,1.0,v168
 v_mfma_f32_16x16x32_bf16 a[24:27],a[140:143],a[244:247],a[24:27]
 v_exp_f32 v169,v169
 v_mfma_f32_16x16x32_bf16 a[28:31],a[136:139],a[248:251],a[28:31]
 ds_read_b64_tr_b16 a[134:135],v21 offset:9152
 v_add_f32 v169,1.0,v169
 v_mfma_f32_16x16x32_bf16 a[28:31],a[140:143],a[252:255],a[28:31]
 v_mul_f32 v189,v173,v189
 s_waitcnt lgkmcnt(4)
 v_mfma_f32_16x16x32_bf16 a[32:35],a[144:147],a[224:227],a[32:35]
 ds_read_b64_tr_b16 a[136:137],v21 offset:160
 v_mul_f32 v190,v174,v190
 v_mfma_f32_16x16x32_bf16 a[32:35],a[148:151],a[228:231],a[32:35]
 buffer_load_dwordx4 v9,s[16:19],s63 offen offset:1088 lds
 v_mfma_f32_16x16x32_bf16 a[36:39],a[144:147],a[232:235],a[36:39]
 ds_read_b64_tr_b16 a[138:139],v21 offset:416
 v_mul_f32 v191,v175,v191
 v_mfma_f32_16x16x32_bf16 a[36:39],a[148:151],a[236:239],a[36:39]
 v_exp_f32 v170,v170
 v_mfma_f32_16x16x32_bf16 a[40:43],a[144:147],a[240:243],a[40:43]
 ds_read_b64_tr_b16 a[140:141],v21 offset:8928
 v_add_f32 v170,1.0,v170
 v_mfma_f32_16x16x32_bf16 a[40:43],a[148:151],a[244:247],a[40:43]
 buffer_load_dwordx4 v10,s[16:19],s63 offen offset:2176 lds
 v_mfma_f32_16x16x32_bf16 a[44:47],a[144:147],a[248:251],a[44:47]
 ds_read_b64_tr_b16 a[142:143],v21 offset:9184
 v_fma_f32 v28,v28,s82,v7
 v_mfma_f32_16x16x32_bf16 a[44:47],a[148:151],a[252:255],a[44:47]
 v_exp_f32 v171,v171
 v_mfma_f32_16x16x32_bf16 a[48:51],a[152:155],a[224:227],a[48:51]
 ds_read_b64_tr_b16 a[144:145],v21 offset:192
 v_add_f32 v171,1.0,v171
 v_mfma_f32_16x16x32_bf16 a[48:51],a[156:159],a[228:231],a[48:51]
 buffer_load_dwordx4 v11,s[16:19],s63 offen offset:3264 lds
 v_mfma_f32_16x16x32_bf16 a[52:55],a[152:155],a[232:235],a[52:55]
 ds_read_b64_tr_b16 a[146:147],v21 offset:448
 v_fma_f32 v29,v29,s82,v7
 v_mfma_f32_16x16x32_bf16 a[52:55],a[156:159],a[236:239],a[52:55]
 v_rcp_f32 v168,v168
 v_mfma_f32_16x16x32_bf16 a[56:59],a[152:155],a[240:243],a[56:59]
 ds_read_b64_tr_b16 a[148:149],v21 offset:8960
 s_add_u32 s57,s57,8192
 v_mfma_f32_16x16x32_bf16 a[56:59],a[156:159],a[244:247],a[56:59]
 buffer_load_dwordx4 a[192:195],v4,s[8:11],s57 offen offset:0 sc1
 v_mfma_f32_16x16x32_bf16 a[60:63],a[152:155],a[248:251],a[60:63]
 ds_read_b64_tr_b16 a[150:151],v21 offset:9216
 v_mul_f32 v184,v184,v168
 v_mfma_f32_16x16x32_bf16 a[60:63],a[156:159],a[252:255],a[60:63]
 v_fma_f32 v24,v24,s82,v7
 s_waitcnt lgkmcnt(4)
 v_mfma_f32_16x16x32_bf16 a[64:67],a[128:131],a[224:227],a[64:67]
 ds_read_b64_tr_b16 a[152:153],v21 offset:224
 v_fma_f32 v25,v25,s82,v7
 v_mfma_f32_16x16x32_bf16 a[64:67],a[132:135],a[228:231],a[64:67]
 v_rcp_f32 v169,v169
 v_mfma_f32_16x16x32_bf16 a[68:71],a[128:131],a[232:235],a[68:71]
 ds_read_b64_tr_b16 a[154:155],v21 offset:480
 v_mul_f32 v185,v185,v169
 v_mfma_f32_16x16x32_bf16 a[68:71],a[132:135],a[236:239],a[68:71]
 buffer_load_dwordx4 a[196:199],v4,s[8:11],s57 offen offset:1024 sc1
 v_mfma_f32_16x16x32_bf16 a[72:75],a[128:131],a[240:243],a[72:75]
 ds_read_b64_tr_b16 a[156:157],v21 offset:8992
 v_cvt_pk_bf16_f32 v168,v184,v185
 v_mfma_f32_16x16x32_bf16 a[72:75],a[132:135],a[244:247],a[72:75]
 v_rcp_f32 v170,v170
 v_mfma_f32_16x16x32_bf16 a[76:79],a[128:131],a[248:251],a[76:79]
 ds_read_b64_tr_b16 a[158:159],v21 offset:9248
 v_mul_f32 v186,v186,v170
 v_mfma_f32_16x16x32_bf16 a[76:79],a[132:135],a[252:255],a[76:79]
 s_waitcnt vmcnt(38)
 s_barrier
 v_mfma_f32_16x16x32_bf16 a[80:83],a[136:139],a[224:227],a[80:83]
 ds_read_b64_tr_b16 a[128:129],v21 offset:35072
 v_mul_f32 v172,v28,v172
 v_mfma_f32_16x16x32_bf16 a[80:83],a[140:143],a[228:231],a[80:83]
 buffer_load_dwordx4 a[200:203],v4,s[8:11],s57 offen offset:2048 sc1
 v_mfma_f32_16x16x32_bf16 a[84:87],a[136:139],a[232:235],a[84:87]
 ds_read_b64_tr_b16 a[130:131],v21 offset:35328
 v_mul_f32 v173,v29,v173
 v_mfma_f32_16x16x32_bf16 a[84:87],a[140:143],a[236:239],a[84:87]
 v_rcp_f32 v171,v171
 v_mfma_f32_16x16x32_bf16 a[88:91],a[136:139],a[240:243],a[88:91]
 ds_read_b64_tr_b16 a[132:133],v21 offset:43840
 v_mul_f32 v187,v187,v171
 v_mfma_f32_16x16x32_bf16 a[88:91],a[140:143],a[244:247],a[88:91]
 buffer_load_dwordx4 a[204:207],v4,s[8:11],s57 offen offset:3072 sc1
 v_mfma_f32_16x16x32_bf16 a[92:95],a[136:139],a[248:251],a[92:95]
 ds_read_b64_tr_b16 a[134:135],v21 offset:44096
 v_cvt_pk_bf16_f32 v169,v186,v187
 v_mfma_f32_16x16x32_bf16 a[92:95],a[140:143],a[252:255],a[92:95]
 v_mul_f32 v174,v24,v174
 s_waitcnt lgkmcnt(4)
 v_mfma_f32_16x16x32_bf16 a[96:99],a[144:147],a[224:227],a[96:99]
 ds_read_b64_tr_b16 a[136:137],v21 offset:35104
 v_mul_f32 v175,v25,v175
 v_mfma_f32_16x16x32_bf16 a[96:99],a[148:151],a[228:231],a[96:99]
 buffer_load_dwordx4 a[208:211],v5,s[8:11],s57 offen offset:0 sc1
 v_mfma_f32_16x16x32_bf16 a[100:103],a[144:147],a[232:235],a[100:103]
 ds_read_b64_tr_b16 a[138:139],v21 offset:35360
 v_mul_f32 v26,v192,v192
 v_mfma_f32_16x16x32_bf16 a[100:103],a[148:151],a[236:239],a[100:103]
 v_exp_f32 v172,v172
 v_mfma_f32_16x16x32_bf16 a[104:107],a[144:147],a[240:243],a[104:107]
 ds_read_b64_tr_b16 a[140:141],v21 offset:43872
 v_add_f32 v172,1.0,v172
 v_mfma_f32_16x16x32_bf16 a[104:107],a[148:151],a[244:247],a[104:107]
 buffer_load_dwordx4 a[212:215],v5,s[8:11],s57 offen offset:1024 sc1
 v_mfma_f32_16x16x32_bf16 a[108:111],a[144:147],a[248:251],a[108:111]
 ds_read_b64_tr_b16 a[142:143],v21 offset:44128
 v_mul_f32 v27,v193,v193
 v_mfma_f32_16x16x32_bf16 a[108:111],a[148:151],a[252:255],a[108:111]
 v_exp_f32 v173,v173
 v_mfma_f32_16x16x32_bf16 a[112:115],a[152:155],a[224:227],a[112:115]
 ds_read_b64_tr_b16 a[144:145],v21 offset:35136
 v_add_f32 v173,1.0,v173
 v_mfma_f32_16x16x32_bf16 a[112:115],a[156:159],a[228:231],a[112:115]
 v_exp_f32 v174,v174
 v_mfma_f32_16x16x32_bf16 a[116:119],a[152:155],a[232:235],a[116:119]
 ds_read_b64_tr_b16 a[146:147],v21 offset:35392
 v_add_f32 v174,1.0,v174
 v_mfma_f32_16x16x32_bf16 a[116:119],a[156:159],a[236:239],a[116:119]
 buffer_load_dwordx4 a[216:219],v5,s[8:11],s57 offen offset:2048 sc1
 v_mfma_f32_16x16x32_bf16 a[120:123],a[152:155],a[240:243],a[120:123]
 ds_read_b64_tr_b16 a[148:149],v21 offset:43904
 v_mul_f32 v28,v194,v194
 v_mfma_f32_16x16x32_bf16 a[120:123],a[156:159],a[244:247],a[120:123]
 v_exp_f32 v175,v175
 v_mfma_f32_16x16x32_bf16 a[124:127],a[152:155],a[248:251],a[124:127]
 ds_read_b64_tr_b16 a[150:151],v21 offset:44160
 v_add_f32 v175,1.0,v175
 v_mfma_f32_16x16x32_bf16 a[124:127],a[156:159],a[252:255],a[124:127]
 s_waitcnt vmcnt(35)
 s_waitcnt lgkmcnt(4)
 v_mfma_f32_16x16x32_bf16 a[0:3],a[128:131],v[32:35],a[0:3]
 ds_read_b64_tr_b16 a[152:153],v21 offset:35168
 s_add_u32 s63,s63,524288
 v_mfma_f32_16x16x32_bf16 a[0:3],a[132:135],v[36:39],a[0:3]
 buffer_load_dwordx4 a[220:223],v5,s[8:11],s57 offen offset:3072 sc1
 v_mfma_f32_16x16x32_bf16 a[4:7],a[128:131],v[40:43],a[4:7]
 ds_read_b64_tr_b16 a[154:155],v21 offset:35424
 s_add_u32 m0,s51,105216
 v_mfma_f32_16x16x32_bf16 a[4:7],a[132:135],v[44:47],a[4:7]
 buffer_load_dwordx4 v8,s[16:19],s63 offen offset:0 lds
 v_mfma_f32_16x16x32_bf16 a[8:11],a[128:131],v[48:51],a[8:11]
 ds_read_b64_tr_b16 a[156:157],v21 offset:43936
 v_mul_f32 v29,v195,v195
 v_mfma_f32_16x16x32_bf16 a[8:11],a[132:135],v[52:55],a[8:11]
 v_rcp_f32 v172,v172
 v_mfma_f32_16x16x32_bf16 a[12:15],a[128:131],v[56:59],a[12:15]
 ds_read_b64_tr_b16 a[158:159],v21 offset:44192
 v_mul_f32 v188,v188,v172
 v_mfma_f32_16x16x32_bf16 a[12:15],a[132:135],v[60:63],a[12:15]
 v_rcp_f32 v173,v173
 v_mfma_f32_16x16x32_bf16 a[16:19],a[136:139],v[32:35],a[16:19]
 ds_read_b64_tr_b16 a[128:129],v21 offset:35200
 v_mul_f32 v189,v189,v173
 v_mfma_f32_16x16x32_bf16 a[16:19],a[140:143],v[36:39],a[16:19]
 buffer_load_dwordx4 v9,s[16:19],s63 offen offset:1088 lds
 v_mfma_f32_16x16x32_bf16 a[20:23],a[136:139],v[40:43],a[20:23]
 ds_read_b64_tr_b16 a[130:131],v21 offset:35456
 v_cvt_pk_bf16_f32 v172,v188,v189
 v_mfma_f32_16x16x32_bf16 a[20:23],a[140:143],v[44:47],a[20:23]
 v_rcp_f32 v174,v174
 v_mfma_f32_16x16x32_bf16 a[24:27],a[136:139],v[48:51],a[24:27]
 ds_read_b64_tr_b16 a[132:133],v21 offset:43968
 v_mul_f32 v190,v190,v174
 v_mfma_f32_16x16x32_bf16 a[24:27],a[140:143],v[52:55],a[24:27]
 v_rcp_f32 v175,v175
 v_mfma_f32_16x16x32_bf16 a[28:31],a[136:139],v[56:59],a[28:31]
 ds_read_b64_tr_b16 a[134:135],v21 offset:44224
 v_mul_f32 v191,v191,v175
 v_mfma_f32_16x16x32_bf16 a[28:31],a[140:143],v[60:63],a[28:31]
 v_cvt_pk_bf16_f32 v173,v190,v191
 s_waitcnt lgkmcnt(4)
 v_mfma_f32_16x16x32_bf16 a[32:35],a[144:147],v[32:35],a[32:35]
 ds_read_b64_tr_b16 a[136:137],v21 offset:35232
 v_mul_f32 v208,v192,v208
 v_mfma_f32_16x16x32_bf16 a[32:35],a[148:151],v[36:39],a[32:35]
 buffer_load_dwordx4 v10,s[16:19],s63 offen offset:2176 lds
 v_mfma_f32_16x16x32_bf16 a[36:39],a[144:147],v[40:43],a[36:39]
 ds_read_b64_tr_b16 a[138:139],v21 offset:35488
 v_mul_f32 v209,v193,v209
 v_mfma_f32_16x16x32_bf16 a[36:39],a[148:151],v[44:47],a[36:39]
 v_mul_f32 v210,v194,v210
 v_mul_f32 v211,v195,v211
 v_mfma_f32_16x16x32_bf16 a[40:43],a[144:147],v[48:51],a[40:43]
 ds_read_b64_tr_b16 a[140:141],v21 offset:44000
 v_fma_f32 v26,v26,s82,v7
 v_mfma_f32_16x16x32_bf16 a[40:43],a[148:151],v[52:55],a[40:43]
 buffer_load_dwordx4 v11,s[16:19],s63 offen offset:3264 lds
 v_mfma_f32_16x16x32_bf16 a[44:47],a[144:147],v[56:59],a[44:47]
 ds_read_b64_tr_b16 a[142:143],v21 offset:44256
 v_fma_f32 v27,v27,s82,v7
 v_mfma_f32_16x16x32_bf16 a[44:47],a[148:151],v[60:63],a[44:47]
 s_add_u32 s63,s63,524288
 v_fma_f32 v28,v28,s82,v7
L_w10:
 s_cbranch_execz L_w14
 v_mfma_f32_16x16x32_bf16 a[48:51],a[152:155],v[32:35],a[48:51]
 ds_read_b64_tr_b16 a[144:145],v21 offset:35264
 s_add_u32 m0,s51,87680
 v_mfma_f32_16x16x32_bf16 a[48:51],a[156:159],v[36:39],a[48:51]
 buffer_load_dwordx4 v8,s[16:19],s63 offen offset:0 lds
 v_mfma_f32_16x16x32_bf16 a[52:55],a[152:155],v[40:43],a[52:55]
 ds_read_b64_tr_b16 a[146:147],v21 offset:35520
 v_fma_f32 v29,v29,s82,v7
 v_mfma_f32_16x16x32_bf16 a[52:55],a[156:159],v[44:47],a[52:55]
 v_mul_f32 v192,v26,v192
 v_mul_f32 v193,v27,v193
 v_mfma_f32_16x16x32_bf16 a[56:59],a[152:155],v[48:51],a[56:59]
 ds_read_b64_tr_b16 a[148:149],v21 offset:44032
 v_mul_f32 v194,v28,v194
 v_mfma_f32_16x16x32_bf16 a[56:59],a[156:159],v[52:55],a[56:59]
 buffer_load_dwordx4 v9,s[16:19],s63 offen offset:1088 lds
 v_mfma_f32_16x16x32_bf16 a[60:63],a[152:155],v[56:59],a[60:63]
 ds_read_b64_tr_b16 a[150:151],v21 offset:44288
 v_mul_f32 v195,v29,v195
 v_mfma_f32_16x16x32_bf16 a[60:63],a[156:159],v[60:63],a[60:63]
 v_mul_f32 v24,v196,v196
 s_waitcnt lgkmcnt(4)
 v_mfma_f32_16x16x32_bf16 a[64:67],a[128:131],v[32:35],a[64:67]
 ds_read_b64_tr_b16 a[152:153],v21 offset:35296
 v_mul_f32 v25,v197,v197
 v_mfma_f32_16x16x32_bf16 a[64:67],a[132:135],v[36:39],a[64:67]
 v_exp_f32 v192,v192
 v_mfma_f32_16x16x32_bf16 a[68:71],a[128:131],v[40:43],a[68:71]
 ds_read_b64_tr_b16 a[154:155],v21 offset:35552
 v_add_f32 v192,1.0,v192
 v_mfma_f32_16x16x32_bf16 a[68:71],a[132:135],v[44:47],a[68:71]
 buffer_load_dwordx4 v10,s[16:19],s63 offen offset:2176 lds
 v_mfma_f32_16x16x32_bf16 a[72:75],a[128:131],v[48:51],a[72:75]
 ds_read_b64_tr_b16 a[156:157],v21 offset:44064
 v_mul_f32 v26,v198,v198
 v_mfma_f32_16x16x32_bf16 a[72:75],a[132:135],v[52:55],a[72:75]
 v_exp_f32 v193,v193
 v_mfma_f32_16x16x32_bf16 a[76:79],a[128:131],v[56:59],a[76:79]
 ds_read_b64_tr_b16 a[158:159],v21 offset:44320
 v_add_f32 v193,1.0,v193
 v_mfma_f32_16x16x32_bf16 a[76:79],a[132:135],v[60:63],a[76:79]
 s_waitcnt vmcnt(39)
 s_barrier
 v_mfma_f32_16x16x32_bf16 a[80:83],a[136:139],v[32:35],a[80:83]
 ds_read_b64_tr_b16 a[128:129],v21 offset:17536
 v_mul_f32 v27,v199,v199
 v_mfma_f32_16x16x32_bf16 a[80:83],a[140:143],v[36:39],a[80:83]
 buffer_load_dwordx4 v11,s[16:19],s63 offen offset:3264 lds
 v_mfma_f32_16x16x32_bf16 a[84:87],a[136:139],v[40:43],a[84:87]
 ds_read_b64_tr_b16 a[130:131],v21 offset:17792
 v_mul_f32 v212,v196,v212
 v_mfma_f32_16x16x32_bf16 a[84:87],a[140:143],v[44:47],a[84:87]
 v_exp_f32 v194,v194
 v_mfma_f32_16x16x32_bf16 a[88:91],a[136:139],v[48:51],a[88:91]
 ds_read_b64_tr_b16 a[132:133],v21 offset:26304
 s_add_u32 s57,s57,8192
 v_mfma_f32_16x16x32_bf16 a[88:91],a[140:143],v[52:55],a[88:91]
 buffer_load_dwordx4 a[224:227],v4,s[8:11],s57 offen offset:0 sc1
 v_mfma_f32_16x16x32_bf16 a[92:95],a[136:139],v[56:59],a[92:95]
 ds_read_b64_tr_b16 a[134:135],v21 offset:26560
 v_add_f32 v194,1.0,v194
 v_mfma_f32_16x16x32_bf16 a[92:95],a[140:143],v[60:63],a[92:95]
 v_mul_f32 v213,v197,v213
 s_waitcnt lgkmcnt(4)
 v_mfma_f32_16x16x32_bf16 a[96:99],a[144:147],v[32:35],a[96:99]
 ds_read_b64_tr_b16 a[136:137],v21 offset:17568
 v_mul_f32 v214,v198,v214
 v_mfma_f32_16x16x32_bf16 a[96:99],a[148:151],v[36:39],a[96:99]
 buffer_load_dwordx4 a[228:231],v4,s[8:11],s57 offen offset:1024 sc1
 v_mfma_f32_16x16x32_bf16 a[100:103],a[144:147],v[40:43],a[100:103]
 ds_read_b64_tr_b16 a[138:139],v21 offset:17824
 v_mul_f32 v215,v199,v215
 v_mfma_f32_16x16x32_bf16 a[100:103],a[148:151],v[44:47],a[100:103]
 v_exp_f32 v195,v195
 v_mfma_f32_16x16x32_bf16 a[104:107],a[144:147],v[48:51],a[104:107]
 ds_read_b64_tr_b16 a[140:141],v21 offset:26336
 v_add_f32 v195,1.0,v195
 v_mfma_f32_16x16x32_bf16 a[104:107],a[148:151],v[52:55],a[104:107]
 buffer_load_dwordx4 a[232:235],v4,s[8:11],s57 offen offset:2048 sc1
 v_mfma_f32_16x16x32_bf16 a[108:111],a[144:147],v[56:59],a[108:111]
 ds_read_b64_tr_b16 a[142:143],v21 offset:26592
 v_fma_f32 v24,v24,s82,v7
 v_mfma_f32_16x16x32_bf16 a[108:111],a[148:151],v[60:63],a[108:111]
 v_rcp_f32 v192,v192
 v_mfma_f32_16x16x32_bf16 a[112:115],a[152:155],v[32:35],a[112:115]
 ds_read_b64_tr_b16 a[144:145],v21 offset:17600
 v_mul_f32 v208,v208,v192
 v_mfma_f32_16x16x32_bf16 a[112:115],a[156:159],v[36:39],a[112:115]
 v_rcp_f32 v193,v193
 v_mfma_f32_16x16x32_bf16 a[116:119],a[152:155],v[40:43],a[116:119]
 ds_read_b64_tr_b16 a[146:147],v21 offset:17856
 v_mul_f32 v209,v209,v193
 v_mfma_f32_16x16x32_bf16 a[116:119],a[156:159],v[44:47],a[116:119]
 buffer_load_dwordx4 a[236:239],v4,s[8:11],s57 offen offset:3072 sc1
 v_mfma_f32_16x16x32_bf16 a[120:123],a[152:155],v[48:51],a[120:123]
 ds_read_b64_tr_b16 a[148:149],v21 offset:26368
 v_cvt_pk_bf16_f32 v162,v208,v209
 v_mfma_f32_16x16x32_bf16 a[120:123],a[156:159],v[52:55],a[120:123]
 v_rcp_f32 v194,v194
 v_mfma_f32_16x16x32_bf16 a[124:127],a[152:155],v[56:59],a[124:127]
 ds_read_b64_tr_b16 a[150:151],v21 offset:26624
 v_mul_f32 v210,v210,v194
 v_mfma_f32_16x16x32_bf16 a[124:127],a[156:159],v[60:63],a[124:127]
 s_waitcnt vmcnt(36)
 s_waitcnt lgkmcnt(4)
 v_mfma_f32_16x16x32_bf16 a[0:3],a[128:131],v[64:67],a[0:3]
 ds_read_b64_tr_b16 a[152:153],v21 offset:17632
 v_fma_f32 v25,v25,s82,v7
 v_mfma_f32_16x16x32_bf16 a[0:3],a[132:135],v[68:71],a[0:3]
 buffer_load_dwordx4 a[240:243],v5,s[8:11],s57 offen offset:0 sc1
 v_mfma_f32_16x16x32_bf16 a[4:7],a[128:131],v[72:75],a[4:7]
 ds_read_b64_tr_b16 a[154:155],v21 offset:17888
 v_fma_f32 v26,v26,s82,v7
 v_mfma_f32_16x16x32_bf16 a[4:7],a[132:135],v[76:79],a[4:7]
 buffer_load_dwordx4 a[244:247],v5,s[8:11],s57 offen offset:1024 sc1
 v_mfma_f32_16x16x32_bf16 a[8:11],a[128:131],v[80:83],a[8:11]
 ds_read_b64_tr_b16 a[156:157],v21 offset:26400
 v_fma_f32 v27,v27,s82,v7
 v_mfma_f32_16x16x32_bf16 a[8:11],a[132:135],v[84:87],a[8:11]
 v_rcp_f32 v195,v195
 v_mfma_f32_16x16x32_bf16 a[12:15],a[128:131],v[88:91],a[12:15]
 ds_read_b64_tr_b16 a[158:159],v21 offset:26656
 v_mul_f32 v211,v211,v195
 v_mfma_f32_16x16x32_bf16 a[12:15],a[132:135],v[92:95],a[12:15]
 v_cvt_pk_bf16_f32 v163,v210,v211
 v_mul_f32 v196,v24,v196
 v_mfma_f32_16x16x32_bf16 a[16:19],a[136:139],v[64:67],a[16:19]
 ds_read_b64_tr_b16 a[128:129],v21 offset:17664
 v_mul_f32 v197,v25,v197
 v_mfma_f32_16x16x32_bf16 a[16:19],a[140:143],v[68:71],a[16:19]
 buffer_load_dwordx4 a[248:251],v5,s[8:11],s57 offen offset:2048 sc1
 v_mfma_f32_16x16x32_bf16 a[20:23],a[136:139],v[72:75],a[20:23]
 ds_read_b64_tr_b16 a[130:131],v21 offset:17920
 v_mul_f32 v198,v26,v198
 v_mfma_f32_16x16x32_bf16 a[20:23],a[140:143],v[76:79],a[20:23]
 v_mul_f32 v199,v27,v199
 v_mul_f32 v28,v200,v200
 v_mfma_f32_16x16x32_bf16 a[24:27],a[136:139],v[80:83],a[24:27]
 ds_read_b64_tr_b16 a[132:133],v21 offset:26432
 v_mul_f32 v29,v201,v201
 v_mfma_f32_16x16x32_bf16 a[24:27],a[140:143],v[84:87],a[24:27]
 buffer_load_dwordx4 a[252:255],v5,s[8:11],s57 offen offset:3072 sc1
 v_mfma_f32_16x16x32_bf16 a[28:31],a[136:139],v[88:91],a[28:31]
 ds_read_b64_tr_b16 a[134:135],v21 offset:26688
 v_mul_f32 v24,v202,v202
 v_mfma_f32_16x16x32_bf16 a[28:31],a[140:143],v[92:95],a[28:31]
 v_mul_f32 v25,v203,v203
 s_waitcnt lgkmcnt(4)
 v_mfma_f32_16x16x32_bf16 a[32:35],a[144:147],v[64:67],a[32:35]
 ds_read_b64_tr_b16 a[136:137],v21 offset:17696
 v_mul_f32 v216,v200,v216
 v_mfma_f32_16x16x32_bf16 a[32:35],a[148:151],v[68:71],a[32:35]
 s_add_u32 s63,s63,524288
 v_mul_f32 v217,v201,v217
 v_mfma_f32_16x16x32_bf16 a[36:39],a[144:147],v[72:75],a[36:39]
 ds_read_b64_tr_b16 a[138:139],v21 offset:17952
 s_add_u32 m0,s51,122752
 v_mfma_f32_16x16x32_bf16 a[36:39],a[148:151],v[76:79],a[36:39]
 buffer_load_dwordx4 v8,s[16:19],s63 offen offset:0 lds
 v_mfma_f32_16x16x32_bf16 a[40:43],a[144:147],v[80:83],a[40:43]
 ds_read_b64_tr_b16 a[140:141],v21 offset:26464
 v_mul_f32 v218,v202,v218
 v_mfma_f32_16x16x32_bf16 a[40:43],a[148:151],v[84:87],a[40:43]
 v_exp_f32 v196,v196
 v_mfma_f32_16x16x32_bf16 a[44:47],a[144:147],v[88:91],a[44:47]
 ds_read_b64_tr_b16 a[142:143],v21 offset:26720
 v_add_f32 v196,1.0,v196
 v_mfma_f32_16x16x32_bf16 a[44:47],a[148:151],v[92:95],a[44:47]
 v_exp_f32 v197,v197
 v_mfma_f32_16x16x32_bf16 a[48:51],a[152:155],v[64:67],a[48:51]
 ds_read_b64_tr_b16 a[144:145],v21 offset:17728
 v_add_f32 v197,1.0,v197
 v_mfma_f32_16x16x32_bf16 a[48:51],a[156:159],v[68:71],a[48:51]
 buffer_load_dwordx4 v9,s[16:19],s63 offen offset:1088 lds
 v_mfma_f32_16x16x32_bf16 a[52:55],a[152:155],v[72:75],a[52:55]
 ds_read_b64_tr_b16 a[146:147],v21 offset:17984
 v_mul_f32 v219,v203,v219
 v_mfma_f32_16x16x32_bf16 a[52:55],a[156:159],v[76:79],a[52:55]
 v_exp_f32 v198,v198
 v_mfma_f32_16x16x32_bf16 a[56:59],a[152:155],v[80:83],a[56:59]
 ds_read_b64_tr_b16 a[148:149],v21 offset:26496
 v_add_f32 v198,1.0,v198
 v_mfma_f32_16x16x32_bf16 a[56:59],a[156:159],v[84:87],a[56:59]
 buffer_load_dwordx4 v10,s[16:19],s63 offen offset:2176 lds
 v_mfma_f32_16x16x32_bf16 a[60:63],a[152:155],v[88:91],a[60:63]
 ds_read_b64_tr_b16 a[150:151],v21 offset:26752
 v_fma_f32 v28,v28,s82,v7
 v_mfma_f32_16x16x32_bf16 a[60:63],a[156:159],v[92:95],a[60:63]
 v_fma_f32 v29,v29,s82,v7
 s_waitcnt lgkmcnt(4)
 v_mfma_f32_16x16x32_bf16 a[64:67],a[128:131],v[64:67],a[64:67]
 ds_read_b64_tr_b16 a[152:153],v21 offset:17760
 v_fma_f32 v24,v24,s82,v7
 v_mfma_f32_16x16x32_bf16 a[64:67],a[132:135],v[68:71],a[64:67]
 buffer_load_dwordx4 v11,s[16:19],s63 offen offset:3264 lds
 v_mfma_f32_16x16x32_bf16 a[68:71],a[128:131],v[72:75],a[68:71]
 ds_read_b64_tr_b16 a[154:155],v21 offset:18016
 v_fma_f32 v25,v25,s82,v7
 v_mfma_f32_16x16x32_bf16 a[68:71],a[132:135],v[76:79],a[68:71]
 v_exp_f32 v199,v199
 v_mfma_f32_16x16x32_bf16 a[72:75],a[128:131],v[80:83],a[72:75]
 ds_read_b64_tr_b16 a[156:157],v21 offset:26528
 v_add_f32 v199,1.0,v199
 v_mfma_f32_16x16x32_bf16 a[72:75],a[132:135],v[84:87],a[72:75]
 v_rcp_f32 v196,v196
 v_mfma_f32_16x16x32_bf16 a[76:79],a[128:131],v[88:91],a[76:79]
 ds_read_b64_tr_b16 a[158:159],v21 offset:26784
 v_mul_f32 v212,v212,v196
 v_mfma_f32_16x16x32_bf16 a[76:79],a[132:135],v[92:95],a[76:79]
 s_waitcnt vmcnt(40)
 s_barrier
 v_mfma_f32_16x16x32_bf16 a[80:83],a[136:139],v[64:67],a[80:83]
 ds_read_b64_tr_b16 a[128:129],v22 offset:17536
 s_add_u32 s57,s57,8192
 v_mfma_f32_16x16x32_bf16 a[80:83],a[140:143],v[68:71],a[80:83]
 buffer_load_dwordx4 v[32:35],v4,s[8:11],s57 offen offset:0 sc1
 v_mfma_f32_16x16x32_bf16 a[84:87],a[136:139],v[72:75],a[84:87]
 ds_read_b64_tr_b16 a[130:131],v22 offset:17792
 v_mul_f32 v200,v28,v200
 v_mfma_f32_16x16x32_bf16 a[84:87],a[140:143],v[76:79],a[84:87]
 v_rcp_f32 v197,v197
 v_mfma_f32_16x16x32_bf16 a[88:91],a[136:139],v[80:83],a[88:91]
 ds_read_b64_tr_b16 a[132:133],v22 offset:26304
 v_mul_f32 v213,v213,v197
 v_mfma_f32_16x16x32_bf16 a[88:91],a[140:143],v[84:87],a[88:91]
 buffer_load_dwordx4 v[36:39],v4,s[8:11],s57 offen offset:1024 sc1
 v_mfma_f32_16x16x32_bf16 a[92:95],a[136:139],v[88:91],a[92:95]
 ds_read_b64_tr_b16 a[134:135],v22 offset:26560
 v_cvt_pk_bf16_f32 v166,v212,v213
 v_mfma_f32_16x16x32_bf16 a[92:95],a[140:143],v[92:95],a[92:95]
 v_mul_f32 v201,v29,v201
 s_waitcnt lgkmcnt(4)
 v_mfma_f32_16x16x32_bf16 a[96:99],a[144:147],v[64:67],a[96:99]
 ds_read_b64_tr_b16 a[136:137],v22 offset:17568
 v_mul_f32 v202,v24,v202
 v_mfma_f32_16x16x32_bf16 a[96:99],a[148:151],v[68:71],a[96:99]
 buffer_load_dwordx4 v[40:43],v4,s[8:11],s57 offen offset:2048 sc1
 v_mfma_f32_16x16x32_bf16 a[100:103],a[144:147],v[72:75],a[100:103]
 ds_read_b64_tr_b16 a[138:139],v22 offset:17824
 v_mul_f32 v203,v25,v203
 v_mfma_f32_16x16x32_bf16 a[100:103],a[148:151],v[76:79],a[100:103]
 v_rcp_f32 v198,v198
 v_mfma_f32_16x16x32_bf16 a[104:107],a[144:147],v[80:83],a[104:107]
 ds_read_b64_tr_b16 a[140:141],v22 offset:26336
 v_mul_f32 v214,v214,v198
 v_mfma_f32_16x16x32_bf16 a[104:107],a[148:151],v[84:87],a[104:107]
 buffer_load_dwordx4 v[44:47],v4,s[8:11],s57 offen offset:3072 sc1
 v_mfma_f32_16x16x32_bf16 a[108:111],a[144:147],v[88:91],a[108:111]
 ds_read_b64_tr_b16 a[142:143],v22 offset:26592
 v_mul_f32 v26,v204,v204
 v_mfma_f32_16x16x32_bf16 a[108:111],a[148:151],v[92:95],a[108:111]
 v_rcp_f32 v199,v199
 v_mfma_f32_16x16x32_bf16 a[112:115],a[152:155],v[64:67],a[112:115]
 ds_read_b64_tr_b16 a[144:145],v22 offset:17600
 v_mul_f32 v215,v215,v199
 v_mfma_f32_16x16x32_bf16 a[112:115],a[156:159],v[68:71],a[112:115]
 v_cvt_pk_bf16_f32 v167,v214,v215
 v_mul_f32 v27,v205,v205
 v_mfma_f32_16x16x32_bf16 a[116:119],a[152:155],v[72:75],a[116:119]
 ds_read_b64_tr_b16 a[146:147],v22 offset:17856
 v_mul_f32 v28,v206,v206
 v_mfma_f32_16x16x32_bf16 a[116:119],a[156:159],v[76:79],a[116:119]
 buffer_load_dwordx4 v[48:51],v5,s[8:11],s57 offen offset:0 sc1
 v_mfma_f32_16x16x32_bf16 a[120:123],a[152:155],v[80:83],a[120:123]
 ds_read_b64_tr_b16 a[148:149],v22 offset:26368
 v_mul_f32 v29,v207,v207
 v_mfma_f32_16x16x32_bf16 a[120:123],a[156:159],v[84:87],a[120:123]
 v_exp_f32 v200,v200
 v_mfma_f32_16x16x32_bf16 a[124:127],a[152:155],v[88:91],a[124:127]
 ds_read_b64_tr_b16 a[150:151],v22 offset:26624
 v_add_f32 v200,1.0,v200
 v_mfma_f32_16x16x32_bf16 a[124:127],a[156:159],v[92:95],a[124:127]
 s_waitcnt vmcnt(37)
 s_waitcnt lgkmcnt(4)
 v_mfma_f32_16x16x32_bf16 a[0:3],a[128:131],a[160:163],a[0:3]
 ds_read_b64_tr_b16 a[152:153],v22 offset:17632
 v_mul_f32 v220,v204,v220
 v_mfma_f32_16x16x32_bf16 a[0:3],a[132:135],a[164:167],a[0:3]
 buffer_load_dwordx4 v[52:55],v5,s[8:11],s57 offen offset:1024 sc1
 v_mfma_f32_16x16x32_bf16 a[4:7],a[128:131],a[168:171],a[4:7]
 ds_read_b64_tr_b16 a[154:155],v22 offset:17888
 v_mul_f32 v221,v205,v221
 v_mfma_f32_16x16x32_bf16 a[4:7],a[132:135],a[172:175],a[4:7]
 buffer_load_dwordx4 v[56:59],v5,s[8:11],s57 offen offset:2048 sc1
 v_mfma_f32_16x16x32_bf16 a[8:11],a[128:131],a[176:179],a[8:11]
 ds_read_b64_tr_b16 a[156:157],v22 offset:26400
 v_mul_f32 v222,v206,v222
 v_mfma_f32_16x16x32_bf16 a[8:11],a[132:135],a[180:183],a[8:11]
 v_exp_f32 v201,v201
 v_mfma_f32_16x16x32_bf16 a[12:15],a[128:131],a[184:187],a[12:15]
 ds_read_b64_tr_b16 a[158:159],v22 offset:26656
 v_add_f32 v201,1.0,v201
 v_mfma_f32_16x16x32_bf16 a[12:15],a[132:135],a[188:191],a[12:15]
 v_exp_f32 v202,v202
 v_mfma_f32_16x16x32_bf16 a[16:19],a[136:139],a[160:163],a[16:19]
 ds_read_b64_tr_b16 a[128:129],v22 offset:17664
 v_add_f32 v202,1.0,v202
 v_mfma_f32_16x16x32_bf16 a[16:19],a[140:143],a[164:167],a[16:19]
 buffer_load_dwordx4 v[60:63],v5,s[8:11],s57 offen offset:3072 sc1
 v_mfma_f32_16x16x32_bf16 a[20:23],a[136:139],a[168:171],a[20:23]
 ds_read_b64_tr_b16 a[130:131],v22 offset:17920
 v_mul_f32 v223,v207,v223
 v_mfma_f32_16x16x32_bf16 a[20:23],a[140:143],a[172:175],a[20:23]
 v_exp_f32 v203,v203
 v_mfma_f32_16x16x32_bf16 a[24:27],a[136:139],a[176:179],a[24:27]
 ds_read_b64_tr_b16 a[132:133],v22 offset:26432
 v_add_f32 v203,1.0,v203
 v_mfma_f32_16x16x32_bf16 a[24:27],a[140:143],a[180:183],a[24:27]
 v_rcp_f32 v200,v200
 v_mfma_f32_16x16x32_bf16 a[28:31],a[136:139],a[184:187],a[28:31]
 ds_read_b64_tr_b16 a[134:135],v22 offset:26688
 v_mul_f32 v216,v216,v200
 v_mfma_f32_16x16x32_bf16 a[28:31],a[140:143],a[188:191],a[28:31]
 s_add_u32 s63,s63,524288
 s_waitcnt lgkmcnt(4)
 v_mfma_f32_16x16x32_bf16 a[32:35],a[144:147],a[160:163],a[32:35]
 ds_read_b64_tr_b16 a[136:137],v22 offset:17696
 s_add_u32 m0,s51,140288
 v_mfma_f32_16x16x32_bf16 a[32:35],a[148:151],a[164:167],a[32:35]
 buffer_load_dwordx4 v8,s[16:19],s63 offen offset:0 lds
 v_mfma_f32_16x16x32_bf16 a[36:39],a[144:147],a[168:171],a[36:39]
 ds_read_b64_tr_b16 a[138:139],v22 offset:17952
 v_fma_f32 v26,v26,s82,v7
 v_mfma_f32_16x16x32_bf16 a[36:39],a[148:151],a[172:175],a[36:39]
 v_rcp_f32 v201,v201
 v_mfma_f32_16x16x32_bf16 a[40:43],a[144:147],a[176:179],a[40:43]
 ds_read_b64_tr_b16 a[140:141],v22 offset:26464
 v_mul_f32 v217,v217,v201
 v_mfma_f32_16x16x32_bf16 a[40:43],a[148:151],a[180:183],a[40:43]
 buffer_load_dwordx4 v9,s[16:19],s63 offen offset:1088 lds
 v_mfma_f32_16x16x32_bf16 a[44:47],a[144:147],a[184:187],a[44:47]
 ds_read_b64_tr_b16 a[142:143],v22 offset:26720
 v_cvt_pk_bf16_f32 v170,v216,v217
 v_mfma_f32_16x16x32_bf16 a[44:47],a[148:151],a[188:191],a[44:47]
 v_rcp_f32 v202,v202
 v_mfma_f32_16x16x32_bf16 a[48:51],a[152:155],a[160:163],a[48:51]
 ds_read_b64_tr_b16 a[144:145],v22 offset:17728
 v_mul_f32 v218,v218,v202
 v_mfma_f32_16x16x32_bf16 a[48:51],a[156:159],a[164:167],a[48:51]
 buffer_load_dwordx4 v10,s[16:19],s63 offen offset:2176 lds
 v_mfma_f32_16x16x32_bf16 a[52:55],a[152:155],a[168:171],a[52:55]
 ds_read_b64_tr_b16 a[146:147],v22 offset:17984
 v_fma_f32 v27,v27,s82,v7
 v_mfma_f32_16x16x32_bf16 a[52:55],a[156:159],a[172:175],a[52:55]
 v_rcp_f32 v203,v203
 v_mfma_f32_16x16x32_bf16 a[56:59],a[152:155],a[176:179],a[56:59]
 ds_read_b64_tr_b16 a[148:149],v22 offset:26496
 v_mul_f32 v219,v219,v203
 v_mfma_f32_16x16x32_bf16 a[56:59],a[156:159],a[180:183],a[56:59]
 buffer_load_dwordx4 v11,s[16:19],s63 offen offset:3264 lds
 v_mfma_f32_16x16x32_bf16 a[60:63],a[152:155],a[184:187],a[60:63]
 ds_read_b64_tr_b16 a[150:151],v22 offset:26752
 v_cvt_pk_bf16_f32 v171,v218,v219
 v_mfma_f32_16x16x32_bf16 a[60:63],a[156:159],a[188:191],a[60:63]
 v_fma_f32 v28,v28,s82,v7
 s_waitcnt lgkmcnt(4)
 v_mfma_f32_16x16x32_bf16 a[64:67],a[128:131],a[160:163],a[64:67]
 ds_read_b64_tr_b16 a[152:153],v22 offset:17760
 v_fma_f32 v29,v29,s82,v7
 v_mfma_f32_16x16x32_bf16 a[64:67],a[132:135],a[164:167],a[64:67]
 v_mul_f32 v204,v26,v204
 v_mul_f32 v205,v27,v205
 v_mfma_f32_16x16x32_bf16 a[68:71],a[128:131],a[168:171],a[68:71]
 ds_read_b64_tr_b16 a[154:155],v22 offset:18016
 s_add_u32 s57,s57,8192
 v_mfma_f32_16x16x32_bf16 a[68:71],a[132:135],a[172:175],a[68:71]
 buffer_load_dwordx4 v[64:67],v4,s[8:11],s57 offen offset:0 sc1
 v_mfma_f32_16x16x32_bf16 a[72:75],a[128:131],a[176:179],a[72:75]
 ds_read_b64_tr_b16 a[156:157],v22 offset:26528
 v_mul_f32 v206,v28,v206
 v_mfma_f32_16x16x32_bf16 a[72:75],a[132:135],a[180:183],a[72:75]
 v_mul_f32 v207,v29,v207
 v_mul_f32 v24,v224,v224
 v_mfma_f32_16x16x32_bf16 a[76:79],a[128:131],a[184:187],a[76:79]
 ds_read_b64_tr_b16 a[158:159],v22 offset:26784
 v_mul_f32 v25,v225,v225
 v_mfma_f32_16x16x32_bf16 a[76:79],a[132:135],a[188:191],a[76:79]
 s_waitcnt vmcnt(41)
 s_barrier
 v_mfma_f32_16x16x32_bf16 a[80:83],a[136:139],a[160:163],a[80:83]
 ds_read_b64_tr_b16 a[128:129],v22 offset:0
 v_mul_f32 v26,v226,v226
 v_mfma_f32_16x16x32_bf16 a[80:83],a[140:143],a[164:167],a[80:83]
 buffer_load_dwordx4 v[68:71],v4,s[8:11],s57 offen offset:1024 sc1
 v_mfma_f32_16x16x32_bf16 a[84:87],a[136:139],a[168:171],a[84:87]
 ds_read_b64_tr_b16 a[130:131],v22 offset:256
 v_mul_f32 v27,v227,v227
 v_mfma_f32_16x16x32_bf16 a[84:87],a[140:143],a[172:175],a[84:87]
 v_exp_f32 v204,v204
 v_mfma_f32_16x16x32_bf16 a[88:91],a[136:139],a[176:179],a[88:91]
 ds_read_b64_tr_b16 a[132:133],v22 offset:8768
 v_add_f32 v204,1.0,v204
 v_mfma_f32_16x16x32_bf16 a[88:91],a[140:143],a[180:183],a[88:91]
 buffer_load_dwordx4 v[72:75],v4,s[8:11],s57 offen offset:2048 sc1
 v_mfma_f32_16x16x32_bf16 a[92:95],a[136:139],a[184:187],a[92:95]
 ds_read_b64_tr_b16 a[134:135],v22 offset:9024
 v_mul_f32 v240,v224,v240
 v_mfma_f32_16x16x32_bf16 a[92:95],a[140:143],a[188:191],a[92:95]
 v_mul_f32 v241,v225,v241
 s_waitcnt lgkmcnt(4)
 v_mfma_f32_16x16x32_bf16 a[96:99],a[144:147],a[160:163],a[96:99]
 ds_read_b64_tr_b16 a[136:137],v22 offset:32
 v_mul_f32 v242,v226,v242
 v_mfma_f32_16x16x32_bf16 a[96:99],a[148:151],a[164:167],a[96:99]
 buffer_load_dwordx4 v[76:79],v4,s[8:11],s57 offen offset:3072 sc1
 v_mfma_f32_16x16x32_bf16 a[100:103],a[144:147],a[168:171],a[100:103]
 ds_read_b64_tr_b16 a[138:139],v22 offset:288
 v_mul_f32 v243,v227,v243
 v_mfma_f32_16x16x32_bf16 a[100:103],a[148:151],a[172:175],a[100:103]
 v_exp_f32 v205,v205
 v_mfma_f32_16x16x32_bf16 a[104:107],a[144:147],a[176:179],a[104:107]
 ds_read_b64_tr_b16 a[140:141],v22 offset:8800
 v_add_f32 v205,1.0,v205
 v_mfma_f32_16x16x32_bf16 a[104:107],a[148:151],a[180:183],a[104:107]
 buffer_load_dwordx4 v[80:83],v5,s[8:11],s57 offen offset:0 sc1
 v_mfma_f32_16x16x32_bf16 a[108:111],a[144:147],a[184:187],a[108:111]
 ds_read_b64_tr_b16 a[142:143],v22 offset:9056
 v_fma_f32 v24,v24,s82,v7
 v_mfma_f32_16x16x32_bf16 a[108:111],a[148:151],a[188:191],a[108:111]
 v_exp_f32 v206,v206
 v_mfma_f32_16x16x32_bf16 a[112:115],a[152:155],a[160:163],a[112:115]
 ds_read_b64_tr_b16 a[144:145],v22 offset:64
 v_add_f32 v206,1.0,v206
 v_mfma_f32_16x16x32_bf16 a[112:115],a[156:159],a[164:167],a[112:115]
 v_exp_f32 v207,v207
 v_mfma_f32_16x16x32_bf16 a[116:119],a[152:155],a[168:171],a[116:119]
 ds_read_b64_tr_b16 a[146:147],v22 offset:320
 v_add_f32 v207,1.0,v207
 v_mfma_f32_16x16x32_bf16 a[116:119],a[156:159],a[172:175],a[116:119]
 buffer_load_dwordx4 v[84:87],v5,s[8:11],s57 offen offset:1024 sc1
 v_mfma_f32_16x16x32_bf16 a[120:123],a[152:155],a[176:179],a[120:123]
 ds_read_b64_tr_b16 a[148:149],v22 offset:8832
 v_fma_f32 v25,v25,s82,v7
 v_mfma_f32_16x16x32_bf16 a[120:123],a[156:159],a[180:183],a[120:123]
 v_rcp_f32 v204,v204
 v_mfma_f32_16x16x32_bf16 a[124:127],a[152:155],a[184:187],a[124:127]
 ds_read_b64_tr_b16 a[150:151],v22 offset:9088
 v_mul_f32 v220,v220,v204
 v_mfma_f32_16x16x32_bf16 a[124:127],a[156:159],a[188:191],a[124:127]
 s_waitcnt vmcnt(38)
 s_waitcnt lgkmcnt(4)
 v_mfma_f32_16x16x32_bf16 a[0:3],a[128:131],a[192:195],a[0:3]
 ds_read_b64_tr_b16 a[152:153],v22 offset:96
 v_fma_f32 v26,v26,s82,v7
 v_mfma_f32_16x16x32_bf16 a[0:3],a[132:135],a[196:199],a[0:3]
 buffer_load_dwordx4 v[88:91],v5,s[8:11],s57 offen offset:2048 sc1
 v_mfma_f32_16x16x32_bf16 a[4:7],a[128:131],a[200:203],a[4:7]
 ds_read_b64_tr_b16 a[154:155],v22 offset:352
 v_fma_f32 v27,v27,s82,v7
 v_mfma_f32_16x16x32_bf16 a[4:7],a[132:135],a[204:207],a[4:7]
 buffer_load_dwordx4 v[92:95],v5,s[8:11],s57 offen offset:3072 sc1
 v_mfma_f32_16x16x32_bf16 a[8:11],a[128:131],a[208:211],a[8:11]
 ds_read_b64_tr_b16 a[156:157],v22 offset:8864
 v_mul_f32 v224,v24,v224
 v_mfma_f32_16x16x32_bf16 a[8:11],a[132:135],a[212:215],a[8:11]
 v_rcp_f32 v205,v205
 v_mfma_f32_16x16x32_bf16 a[12:15],a[128:131],a[216:219],a[12:15]
 ds_read_b64_tr_b16 a[158:159],v22 offset:9120
 v_mul_f32 v221,v221,v205
 v_mfma_f32_16x16x32_bf16 a[12:15],a[132:135],a[220:223],a[12:15]
 v_rcp_f32 v206,v206
 v_mfma_f32_16x16x32_bf16 a[16:19],a[136:139],a[192:195],a[16:19]
 ds_read_b64_tr_b16 a[128:129],v22 offset:128
 s_add_u32 s57,s57,8192
 v_mfma_f32_16x16x32_bf16 a[16:19],a[140:143],a[196:199],a[16:19]
 buffer_load_dwordx4 a[160:163],v4,s[8:11],s57 offen offset:0 sc1
 v_mfma_f32_16x16x32_bf16 a[20:23],a[136:139],a[200:203],a[20:23]
 ds_read_b64_tr_b16 a[130:131],v22 offset:384
 v_mul_f32 v222,v222,v206
 v_mfma_f32_16x16x32_bf16 a[20:23],a[140:143],a[204:207],a[20:23]
 v_rcp_f32 v207,v207
 v_mfma_f32_16x16x32_bf16 a[24:27],a[136:139],a[208:211],a[24:27]
 ds_read_b64_tr_b16 a[132:133],v22 offset:8896
 v_mul_f32 v223,v223,v207
 v_mfma_f32_16x16x32_bf16 a[24:27],a[140:143],a[212:215],a[24:27]
 v_cvt_pk_bf16_f32 v174,v220,v221
 v_cvt_pk_bf16_f32 v175,v222,v223
 v_mfma_f32_16x16x32_bf16 a[28:31],a[136:139],a[216:219],a[28:31]
 ds_read_b64_tr_b16 a[134:135],v22 offset:9152
 v_mul_f32 v225,v25,v225
 v_mfma_f32_16x16x32_bf16 a[28:31],a[140:143],a[220:223],a[28:31]
 v_mul_f32 v226,v26,v226
 s_waitcnt lgkmcnt(4)
 v_mfma_f32_16x16x32_bf16 a[32:35],a[144:147],a[192:195],a[32:35]
 ds_read_b64_tr_b16 a[136:137],v22 offset:160
 v_mul_f32 v227,v27,v227
 v_mfma_f32_16x16x32_bf16 a[32:35],a[148:151],a[196:199],a[32:35]
 buffer_load_dwordx4 a[164:167],v4,s[8:11],s57 offen offset:1024 sc1
 v_mfma_f32_16x16x32_bf16 a[36:39],a[144:147],a[200:203],a[36:39]
 ds_read_b64_tr_b16 a[138:139],v22 offset:416
 v_mul_f32 v28,v228,v228
 v_mfma_f32_16x16x32_bf16 a[36:39],a[148:151],a[204:207],a[36:39]
 v_exp_f32 v224,v224
 v_mfma_f32_16x16x32_bf16 a[40:43],a[144:147],a[208:211],a[40:43]
 ds_read_b64_tr_b16 a[140:141],v22 offset:8928
 v_add_f32 v224,1.0,v224
 v_mfma_f32_16x16x32_bf16 a[40:43],a[148:151],a[212:215],a[40:43]
 buffer_load_dwordx4 a[168:171],v4,s[8:11],s57 offen offset:2048 sc1
 v_mfma_f32_16x16x32_bf16 a[44:47],a[144:147],a[216:219],a[44:47]
 ds_read_b64_tr_b16 a[142:143],v22 offset:9184
 v_mul_f32 v29,v229,v229
 v_mfma_f32_16x16x32_bf16 a[44:47],a[148:151],a[220:223],a[44:47]
 v_exp_f32 v225,v225
 v_mfma_f32_16x16x32_bf16 a[48:51],a[152:155],a[192:195],a[48:51]
 ds_read_b64_tr_b16 a[144:145],v22 offset:192
 v_add_f32 v225,1.0,v225
 v_mfma_f32_16x16x32_bf16 a[48:51],a[156:159],a[196:199],a[48:51]
 buffer_load_dwordx4 a[172:175],v4,s[8:11],s57 offen offset:3072 sc1
 v_mfma_f32_16x16x32_bf16 a[52:55],a[152:155],a[200:203],a[52:55]
 ds_read_b64_tr_b16 a[146:147],v22 offset:448
 v_mul_f32 v24,v230,v230
 v_mfma_f32_16x16x32_bf16 a[52:55],a[156:159],a[204:207],a[52:55]
 v_exp_f32 v226,v226
 v_mfma_f32_16x16x32_bf16 a[56:59],a[152:155],a[208:211],a[56:59]
 ds_read_b64_tr_b16 a[148:149],v22 offset:8960
 v_add_f32 v226,1.0,v226
 v_mfma_f32_16x16x32_bf16 a[56:59],a[156:159],a[212:215],a[56:59]
 buffer_load_dwordx4 a[176:179],v5,s[8:11],s57 offen offset:0 sc1
 v_mfma_f32_16x16x32_bf16 a[60:63],a[152:155],a[216:219],a[60:63]
 ds_read_b64_tr_b16 a[150:151],v22 offset:9216
 v_mul_f32 v25,v231,v231
 v_mfma_f32_16x16x32_bf16 a[60:63],a[156:159],a[220:223],a[60:63]
 v_mul_f32 v244,v228,v244
 s_waitcnt lgkmcnt(4)
 v_mfma_f32_16x16x32_bf16 a[64:67],a[128:131],a[192:195],a[64:67]
 ds_read_b64_tr_b16 a[152:153],v22 offset:224
 v_mul_f32 v245,v229,v245
 v_mfma_f32_16x16x32_bf16 a[64:67],a[132:135],a[196:199],a[64:67]
 v_exp_f32 v227,v227
 v_mfma_f32_16x16x32_bf16 a[68:71],a[128:131],a[200:203],a[68:71]
 ds_read_b64_tr_b16 a[154:155],v22 offset:480
 v_add_f32 v227,1.0,v227
 v_mfma_f32_16x16x32_bf16 a[68:71],a[132:135],a[204:207],a[68:71]
 buffer_load_dwordx4 a[180:183],v5,s[8:11],s57 offen offset:1024 sc1
 v_mfma_f32_16x16x32_bf16 a[72:75],a[128:131],a[208:211],a[72:75]
 ds_read_b64_tr_b16 a[156:157],v22 offset:8992
 v_mul_f32 v246,v230,v246
 v_mfma_f32_16x16x32_bf16 a[72:75],a[132:135],a[212:215],a[72:75]
 v_rcp_f32 v224,v224
 v_mfma_f32_16x16x32_bf16 a[76:79],a[128:131],a[216:219],a[76:79]
 ds_read_b64_tr_b16 a[158:159],v22 offset:9248
 v_mul_f32 v240,v240,v224
 v_mfma_f32_16x16x32_bf16 a[76:79],a[132:135],a[220:223],a[76:79]
 s_waitcnt vmcnt(42)
 s_barrier
 v_mfma_f32_16x16x32_bf16 a[80:83],a[136:139],a[192:195],a[80:83]
 ds_read_b64_tr_b16 a[128:129],v23 offset:0
 v_mul_f32 v247,v231,v247
 v_mfma_f32_16x16x32_bf16 a[80:83],a[140:143],a[196:199],a[80:83]
 buffer_load_dwordx4 a[184:187],v5,s[8:11],s57 offen offset:2048 sc1
 v_mfma_f32_16x16x32_bf16 a[84:87],a[136:139],a[200:203],a[84:87]
 ds_read_b64_tr_b16 a[130:131],v23 offset:256
 v_fma_f32 v28,v28,s82,v7
 v_mfma_f32_16x16x32_bf16 a[84:87],a[140:143],a[204:207],a[84:87]
 buffer_load_dwordx4 a[188:191],v5,s[8:11],s57 offen offset:3072 sc1
 v_mfma_f32_16x16x32_bf16 a[88:91],a[136:139],a[208:211],a[88:91]
 ds_read_b64_tr_b16 a[132:133],v23 offset:8768
 v_fma_f32 v29,v29,s82,v7
 v_mfma_f32_16x16x32_bf16 a[88:91],a[140:143],a[212:215],a[88:91]
 v_rcp_f32 v225,v225
 v_mfma_f32_16x16x32_bf16 a[92:95],a[136:139],a[216:219],a[92:95]
 ds_read_b64_tr_b16 a[134:135],v23 offset:9024
 v_mul_f32 v241,v241,v225
 v_mfma_f32_16x16x32_bf16 a[92:95],a[140:143],a[220:223],a[92:95]
 v_cvt_pk_bf16_f32 v224,v240,v241
 s_waitcnt lgkmcnt(4)
 v_mfma_f32_16x16x32_bf16 a[96:99],a[144:147],a[192:195],a[96:99]
 ds_read_b64_tr_b16 a[136:137],v23 offset:32
 s_add_u32 m0,s53,0
 v_mfma_f32_16x16x32_bf16 a[96:99],a[148:151],a[196:199],a[96:99]
 buffer_load_dwordx4 v12,s[20:23],s59 offen offset:0 lds
 v_mfma_f32_16x16x32_bf16 a[100:103],a[144:147],a[200:203],a[100:103]
 ds_read_b64_tr_b16 a[138:139],v23 offset:288
 v_fma_f32 v24,v24,s82,v7
 v_mfma_f32_16x16x32_bf16 a[100:103],a[148:151],a[204:207],a[100:103]
 v_rcp_f32 v226,v226
 v_mfma_f32_16x16x32_bf16 a[104:107],a[144:147],a[208:211],a[104:107]
 ds_read_b64_tr_b16 a[140:141],v23 offset:8800
 v_mul_f32 v242,v242,v226
 v_mfma_f32_16x16x32_bf16 a[104:107],a[148:151],a[212:215],a[104:107]
 v_rcp_f32 v227,v227
 v_mfma_f32_16x16x32_bf16 a[108:111],a[144:147],a[216:219],a[108:111]
 ds_read_b64_tr_b16 a[142:143],v23 offset:9056
 v_mul_f32 v243,v243,v227
 v_mfma_f32_16x16x32_bf16 a[108:111],a[148:151],a[220:223],a[108:111]
 s_waitcnt vmcnt(41)
 s_barrier
 v_mfma_f32_16x16x32_bf16 a[112:115],a[152:155],a[192:195],a[112:115]
 ds_read_b64_tr_b16 a[144:145],v22 offset:35072
 v_cvt_pk_bf16_f32 v225,v242,v243
 v_mfma_f32_16x16x32_bf16 a[112:115],a[156:159],a[196:199],a[112:115]
 buffer_load_dwordx4 v13,s[20:23],s59 offen offset:1040 lds
 v_mfma_f32_16x16x32_bf16 a[116:119],a[152:155],a[200:203],a[116:119]
 ds_read_b64_tr_b16 a[146:147],v22 offset:35328
 v_fma_f32 v25,v25,s82,v7
 v_mfma_f32_16x16x32_bf16 a[116:119],a[156:159],a[204:207],a[116:119]
L_w11:
 s_cbranch_execz L_w15
 buffer_load_dwordx4 v14,s[20:23],s59 offen offset:2080 lds
 v_mfma_f32_16x16x32_bf16 a[120:123],a[152:155],a[208:211],a[120:123]
 ds_read_b64_tr_b16 a[148:149],v22 offset:43840
 v_mul_f32 v228,v28,v228
 v_mfma_f32_16x16x32_bf16 a[120:123],a[156:159],a[212:215],a[120:123]
 v_mul_f32 v229,v29,v229
 v_mul_f32 v230,v24,v230
 v_mfma_f32_16x16x32_bf16 a[124:127],a[152:155],a[216:219],a[124:127]
 ds_read_b64_tr_b16 a[150:151],v22 offset:44096
 v_mul_f32 v231,v25,v231
 v_mfma_f32_16x16x32_bf16 a[124:127],a[156:159],a[220:223],a[124:127]
 s_waitcnt vmcnt(35)
 s_waitcnt lgkmcnt(4)
 v_mfma_f32_16x16x32_bf16 a[0:3],a[128:131],a[224:227],a[0:3]
 ds_read_b64_tr_b16 a[152:153],v22 offset:35104
 v_mul_f32 v26,v232,v232
 v_mfma_f32_16x16x32_bf16 a[0:3],a[132:135],a[228:231],a[0:3]
 buffer_load_dwordx4 v15,s[20:23],s59 offen offset:3120 lds
 v_mfma_f32_16x16x32_bf16 a[4:7],a[128:131],a[232:235],a[4:7]
 ds_read_b64_tr_b16 a[154:155],v22 offset:35360
 v_mul_f32 v27,v233,v233
 v_mfma_f32_16x16x32_bf16 a[4:7],a[132:135],a[236:239],a[4:7]
 v_exp_f32 v228,v228
 v_mfma_f32_16x16x32_bf16 a[8:11],a[128:131],a[240:243],a[8:11]
 ds_read_b64_tr_b16 a[156:157],v22 offset:43872
 s_add_u32 m0,s54,0
 v_mfma_f32_16x16x32_bf16 a[8:11],a[132:135],a[244:247],a[8:11]
 buffer_load_dwordx4 v16,s[24:27],s59 offen offset:0 lds
 v_mfma_f32_16x16x32_bf16 a[12:15],a[128:131],a[248:251],a[12:15]
 ds_read_b64_tr_b16 a[158:159],v22 offset:44128
 v_add_f32 v228,1.0,v228
 v_mfma_f32_16x16x32_bf16 a[12:15],a[132:135],a[252:255],a[12:15]
 s_waitcnt vmcnt(33)
 s_barrier
 v_mfma_f32_16x16x32_bf16 a[16:19],a[136:139],a[224:227],a[16:19]
 ds_read_b64_tr_b16 a[128:129],v23 offset:17536
 v_mul_f32 v28,v234,v234
 v_mfma_f32_16x16x32_bf16 a[16:19],a[140:143],a[228:231],a[16:19]
 v_exp_f32 v229,v229
 v_mfma_f32_16x16x32_bf16 a[20:23],a[136:139],a[232:235],a[20:23]
 ds_read_b64_tr_b16 a[130:131],v23 offset:17792
 v_add_f32 v229,1.0,v229
 v_mfma_f32_16x16x32_bf16 a[20:23],a[140:143],a[236:239],a[20:23]
 buffer_load_dwordx4 v17,s[24:27],s59 offen offset:1088 lds
 v_mfma_f32_16x16x32_bf16 a[24:27],a[136:139],a[240:243],a[24:27]
 ds_read_b64_tr_b16 a[132:133],v23 offset:26304
 v_mul_f32 v29,v235,v235
 v_mfma_f32_16x16x32_bf16 a[24:27],a[140:143],a[244:247],a[24:27]
 v_exp_f32 v230,v230
 v_mfma_f32_16x16x32_bf16 a[28:31],a[136:139],a[248:251],a[28:31]
 ds_read_b64_tr_b16 a[134:135],v23 offset:26560
 v_add_f32 v230,1.0,v230
 v_mfma_f32_16x16x32_bf16 a[28:31],a[140:143],a[252:255],a[28:31]
 s_waitcnt vmcnt(26)
 s_waitcnt lgkmcnt(4)
 v_mfma_f32_16x16x32_bf16 a[0:3],a[144:147],v[32:35],a[0:3]
 ds_read_b64_tr_b16 a[136:137],v23 offset:17568
 v_mul_f32 v248,v232,v248
 v_mfma_f32_16x16x32_bf16 a[0:3],a[148:151],v[36:39],a[0:3]
 buffer_load_dwordx4 v18,s[24:27],s59 offen offset:2176 lds
 v_mfma_f32_16x16x32_bf16 a[4:7],a[144:147],v[40:43],a[4:7]
 ds_read_b64_tr_b16 a[138:139],v23 offset:17824
 v_mul_f32 v249,v233,v249
 v_mfma_f32_16x16x32_bf16 a[4:7],a[148:151],v[44:47],a[4:7]
 buffer_load_dwordx4 v19,s[24:27],s59 offen offset:3264 lds
 v_mfma_f32_16x16x32_bf16 a[8:11],a[144:147],v[48:51],a[8:11]
 ds_read_b64_tr_b16 a[140:141],v23 offset:26336
 v_mul_f32 v250,v234,v250
 v_mfma_f32_16x16x32_bf16 a[8:11],a[148:151],v[52:55],a[8:11]
 v_exp_f32 v231,v231
 v_mfma_f32_16x16x32_bf16 a[12:15],a[144:147],v[56:59],a[12:15]
 ds_read_b64_tr_b16 a[142:143],v23 offset:26592
 s_add_u32 s59,s59,16384
 v_mfma_f32_16x16x32_bf16 a[12:15],a[148:151],v[60:63],a[12:15]
 s_waitcnt vmcnt(24)
 s_barrier
 v_mfma_f32_16x16x32_bf16 a[16:19],a[152:155],v[32:35],a[16:19]
 ds_read_b64_tr_b16 a[144:145],v23 offset:35072
 s_add_u32 m0,s53,35072
 v_mfma_f32_16x16x32_bf16 a[16:19],a[156:159],v[36:39],a[16:19]
 buffer_load_dwordx4 v12,s[20:23],s59 offen offset:0 lds
 v_mfma_f32_16x16x32_bf16 a[20:23],a[152:155],v[40:43],a[20:23]
 ds_read_b64_tr_b16 a[146:147],v23 offset:35328
 v_add_f32 v231,1.0,v231
 v_mfma_f32_16x16x32_bf16 a[20:23],a[156:159],v[44:47],a[20:23]
 v_rcp_f32 v228,v228
 v_mfma_f32_16x16x32_bf16 a[24:27],a[152:155],v[48:51],a[24:27]
 ds_read_b64_tr_b16 a[148:149],v23 offset:43840
 v_mul_f32 v244,v244,v228
 v_mfma_f32_16x16x32_bf16 a[24:27],a[156:159],v[52:55],a[24:27]
 buffer_load_dwordx4 v13,s[20:23],s59 offen offset:1040 lds
 v_mfma_f32_16x16x32_bf16 a[28:31],a[152:155],v[56:59],a[28:31]
 ds_read_b64_tr_b16 a[150:151],v23 offset:44096
 v_mul_f32 v251,v235,v251
 v_mfma_f32_16x16x32_bf16 a[28:31],a[156:159],v[60:63],a[28:31]
 s_waitcnt vmcnt(18)
 s_waitcnt lgkmcnt(4)
 v_mfma_f32_16x16x32_bf16 a[0:3],a[128:131],v[64:67],a[0:3]
 ds_read_b64_tr_b16 a[152:153],v23 offset:35104
 v_fma_f32 v26,v26,s82,v7
 v_mfma_f32_16x16x32_bf16 a[0:3],a[132:135],v[68:71],a[0:3]
 v_rcp_f32 v229,v229
 v_mfma_f32_16x16x32_bf16 a[4:7],a[128:131],v[72:75],a[4:7]
 ds_read_b64_tr_b16 a[154:155],v23 offset:35360
 v_mul_f32 v245,v245,v229
 v_mfma_f32_16x16x32_bf16 a[4:7],a[132:135],v[76:79],a[4:7]
 buffer_load_dwordx4 v14,s[20:23],s59 offen offset:2080 lds
 v_mfma_f32_16x16x32_bf16 a[8:11],a[128:131],v[80:83],a[8:11]
 ds_read_b64_tr_b16 a[156:157],v23 offset:43872
 v_cvt_pk_bf16_f32 v226,v244,v245
 v_mfma_f32_16x16x32_bf16 a[8:11],a[132:135],v[84:87],a[8:11]
 v_rcp_f32 v230,v230
 v_mfma_f32_16x16x32_bf16 a[12:15],a[128:131],v[88:91],a[12:15]
 ds_read_b64_tr_b16 a[158:159],v23 offset:44128
 v_mul_f32 v246,v246,v230
 v_mfma_f32_16x16x32_bf16 a[12:15],a[132:135],v[92:95],a[12:15]
 buffer_load_dwordx4 v15,s[20:23],s59 offen offset:3120 lds
 v_mfma_f32_16x16x32_bf16 a[16:19],a[136:139],v[64:67],a[16:19]
 ds_read_b64_tr_b16 a[128:129],v23 offset:64
 v_fma_f32 v27,v27,s82,v7
 v_mfma_f32_16x16x32_bf16 a[16:19],a[140:143],v[68:71],a[16:19]
 v_rcp_f32 v231,v231
 v_mfma_f32_16x16x32_bf16 a[20:23],a[136:139],v[72:75],a[20:23]
 ds_read_b64_tr_b16 a[130:131],v23 offset:320
 s_add_u32 m0,s54,35072
 v_mfma_f32_16x16x32_bf16 a[20:23],a[140:143],v[76:79],a[20:23]
 buffer_load_dwordx4 v16,s[24:27],s59 offen offset:0 lds
 v_mfma_f32_16x16x32_bf16 a[24:27],a[136:139],v[80:83],a[24:27]
 ds_read_b64_tr_b16 a[132:133],v23 offset:8832
 v_mul_f32 v247,v247,v231
 v_mfma_f32_16x16x32_bf16 a[24:27],a[140:143],v[84:87],a[24:27]
 v_cvt_pk_bf16_f32 v227,v246,v247
 v_fma_f32 v28,v28,s82,v7
 v_mfma_f32_16x16x32_bf16 a[28:31],a[136:139],v[88:91],a[28:31]
 ds_read_b64_tr_b16 a[134:135],v23 offset:9088
 v_fma_f32 v29,v29,s82,v7
 v_mfma_f32_16x16x32_bf16 a[28:31],a[140:143],v[92:95],a[28:31]
 s_waitcnt vmcnt(13)
 s_waitcnt lgkmcnt(4)
 v_mfma_f32_16x16x32_bf16 a[0:3],a[144:147],a[160:163],a[0:3]
 ds_read_b64_tr_b16 a[136:137],v23 offset:96
 v_mul_f32 v232,v26,v232
 v_mfma_f32_16x16x32_bf16 a[0:3],a[148:151],a[164:167],a[0:3]
 buffer_load_dwordx4 v17,s[24:27],s59 offen offset:1088 lds
 v_mfma_f32_16x16x32_bf16 a[4:7],a[144:147],a[168:171],a[4:7]
 ds_read_b64_tr_b16 a[138:139],v23 offset:352
 v_mul_f32 v233,v27,v233
 v_mfma_f32_16x16x32_bf16 a[4:7],a[148:151],a[172:175],a[4:7]
 v_permlane32_swap_b32 v224,v226
 v_mfma_f32_16x16x32_bf16 a[8:11],a[144:147],a[176:179],a[8:11]
 ds_read_b64_tr_b16 a[140:141],v23 offset:8864
 v_mul_f32 v234,v28,v234
 v_mfma_f32_16x16x32_bf16 a[8:11],a[148:151],a[180:183],a[8:11]
 buffer_load_dwordx4 v18,s[24:27],s59 offen offset:2176 lds
 v_mfma_f32_16x16x32_bf16 a[12:15],a[144:147],a[184:187],a[12:15]
 ds_read_b64_tr_b16 a[142:143],v23 offset:9120
 v_mul_f32 v235,v29,v235
 v_mfma_f32_16x16x32_bf16 a[12:15],a[148:151],a[188:191],a[12:15]
 v_permlane32_swap_b32 v225,v227
 v_mfma_f32_16x16x32_bf16 a[16:19],a[152:155],a[160:163],a[16:19]
 ds_read_b64_tr_b16 a[144:145],v22 offset:35136
 v_mul_f32 v24,v236,v236
 v_mfma_f32_16x16x32_bf16 a[16:19],a[156:159],a[164:167],a[16:19]
 buffer_load_dwordx4 v19,s[24:27],s59 offen offset:3264 lds
 v_mfma_f32_16x16x32_bf16 a[20:23],a[152:155],a[168:171],a[20:23]
 ds_read_b64_tr_b16 a[146:147],v22 offset:35392
 v_mul_f32 v25,v237,v237
 v_mfma_f32_16x16x32_bf16 a[20:23],a[156:159],a[172:175],a[20:23]
 v_exp_f32 v232,v232
 v_mfma_f32_16x16x32_bf16 a[24:27],a[152:155],a[176:179],a[24:27]
 ds_read_b64_tr_b16 a[148:149],v22 offset:43904
 v_add_f32 v232,1.0,v232
 v_mfma_f32_16x16x32_bf16 a[24:27],a[156:159],a[180:183],a[24:27]
 v_exp_f32 v233,v233
 v_mfma_f32_16x16x32_bf16 a[28:31],a[152:155],a[184:187],a[28:31]
 ds_read_b64_tr_b16 a[150:151],v22 offset:44160
 s_add_u32 s59,s59,16384
 v_mfma_f32_16x16x32_bf16 a[28:31],a[156:159],a[188:191],a[28:31]
 s_sub_u32 s53,s55,s53
 s_waitcnt lgkmcnt(4)
 v_mfma_f32_16x16x32_bf16 a[32:35],a[128:131],a[224:227],a[32:35]
 ds_read_b64_tr_b16 a[152:153],v22 offset:35168
 s_add_u32 m0,s53,0
 v_mfma_f32_16x16x32_bf16 a[32:35],a[132:135],a[228:231],a[32:35]
 buffer_load_dwordx4 v12,s[20:23],s59 offen offset:0 lds
 v_mfma_f32_16x16x32_bf16 a[36:39],a[128:131],a[232:235],a[36:39]
 ds_read_b64_tr_b16 a[154:155],v22 offset:35424
 v_add_f32 v233,1.0,v233
 v_mfma_f32_16x16x32_bf16 a[36:39],a[132:135],a[236:239],a[36:39]
 buffer_load_dwordx4 v13,s[20:23],s59 offen offset:1040 lds
 v_mfma_f32_16x16x32_bf16 a[40:43],a[128:131],a[240:243],a[40:43]
 ds_read_b64_tr_b16 a[156:157],v22 offset:43936
 v_mul_f32 v26,v238,v238
 v_mfma_f32_16x16x32_bf16 a[40:43],a[132:135],a[244:247],a[40:43]
 v_exp_f32 v234,v234
 v_mfma_f32_16x16x32_bf16 a[44:47],a[128:131],a[248:251],a[44:47]
 ds_read_b64_tr_b16 a[158:159],v22 offset:44192
 v_add_f32 v234,1.0,v234
 v_mfma_f32_16x16x32_bf16 a[44:47],a[132:135],a[252:255],a[44:47]
 v_exp_f32 v235,v235
 v_mfma_f32_16x16x32_bf16 a[48:51],a[136:139],a[224:227],a[48:51]
 ds_read_b64_tr_b16 a[128:129],v23 offset:17600
 v_add_f32 v235,1.0,v235
 v_mfma_f32_16x16x32_bf16 a[48:51],a[140:143],a[228:231],a[48:51]
 buffer_load_dwordx4 v14,s[20:23],s59 offen offset:2080 lds
 v_mfma_f32_16x16x32_bf16 a[52:55],a[136:139],a[232:235],a[52:55]
 ds_read_b64_tr_b16 a[130:131],v23 offset:17856
 v_mul_f32 v27,v239,v239
 v_mfma_f32_16x16x32_bf16 a[52:55],a[140:143],a[236:239],a[52:55]
 v_rcp_f32 v232,v232
 v_mfma_f32_16x16x32_bf16 a[56:59],a[136:139],a[240:243],a[56:59]
 ds_read_b64_tr_b16 a[132:133],v23 offset:26368
 v_mul_f32 v248,v248,v232
 v_mfma_f32_16x16x32_bf16 a[56:59],a[140:143],a[244:247],a[56:59]
 buffer_load_dwordx4 v15,s[20:23],s59 offen offset:3120 lds
 v_mfma_f32_16x16x32_bf16 a[60:63],a[136:139],a[248:251],a[60:63]
 ds_read_b64_tr_b16 a[134:135],v23 offset:26624
 v_mul_f32 v252,v236,v252
 v_mfma_f32_16x16x32_bf16 a[60:63],a[140:143],a[252:255],a[60:63]
 v_mul_f32 v253,v237,v253
 s_waitcnt lgkmcnt(4)
 v_mfma_f32_16x16x32_bf16 a[32:35],a[144:147],v[32:35],a[32:35]
 ds_read_b64_tr_b16 a[136:137],v23 offset:17632
 v_mul_f32 v254,v238,v254
 v_mfma_f32_16x16x32_bf16 a[32:35],a[148:151],v[36:39],a[32:35]
 v_rcp_f32 v233,v233
 v_mfma_f32_16x16x32_bf16 a[36:39],a[144:147],v[40:43],a[36:39]
 ds_read_b64_tr_b16 a[138:139],v23 offset:17888
 v_mul_f32 v249,v249,v233
 v_mfma_f32_16x16x32_bf16 a[36:39],a[148:151],v[44:47],a[36:39]
 buffer_store_dwordx4 v[96:99],v4,s[8:11],s65 offen offset:0 sc0 sc1
 v_mfma_f32_16x16x32_bf16 a[40:43],a[144:147],v[48:51],a[40:43]
 ds_read_b64_tr_b16 a[140:141],v23 offset:26400
 v_cvt_pk_bf16_f32 v232,v248,v249
 v_mfma_f32_16x16x32_bf16 a[40:43],a[148:151],v[52:55],a[40:43]
 v_rcp_f32 v234,v234
 v_mfma_f32_16x16x32_bf16 a[44:47],a[144:147],v[56:59],a[44:47]
 ds_read_b64_tr_b16 a[142:143],v23 offset:26656
 v_mul_f32 v250,v250,v234
 v_mfma_f32_16x16x32_bf16 a[44:47],a[148:151],v[60:63],a[44:47]
 v_rcp_f32 v235,v235
 v_mfma_f32_16x16x32_bf16 a[48:51],a[152:155],v[32:35],a[48:51]
 ds_read_b64_tr_b16 a[144:145],v23 offset:35136
 v_mul_f32 v251,v251,v235
 v_mfma_f32_16x16x32_bf16 a[48:51],a[156:159],v[36:39],a[48:51]
 v_cvt_pk_bf16_f32 v233,v250,v251
 v_mul_f32 v255,v239,v255
 v_mfma_f32_16x16x32_bf16 a[52:55],a[152:155],v[40:43],a[52:55]
 ds_read_b64_tr_b16 a[146:147],v23 offset:35392
 v_fma_f32 v24,v24,s82,v7
 v_mfma_f32_16x16x32_bf16 a[52:55],a[156:159],v[44:47],a[52:55]
 v_fma_f32 v25,v25,s82,v7
 v_fma_f32 v26,v26,s82,v7
 v_mfma_f32_16x16x32_bf16 a[56:59],a[152:155],v[48:51],a[56:59]
 ds_read_b64_tr_b16 a[148:149],v23 offset:43904
 v_fma_f32 v27,v27,s82,v7
 v_mfma_f32_16x16x32_bf16 a[56:59],a[156:159],v[52:55],a[56:59]
 v_mul_f32 v236,v24,v236
 v_mul_f32 v237,v25,v237
 v_mfma_f32_16x16x32_bf16 a[60:63],a[152:155],v[56:59],a[60:63]
 ds_read_b64_tr_b16 a[150:151],v23 offset:44160
 v_mul_f32 v238,v26,v238
 v_mfma_f32_16x16x32_bf16 a[60:63],a[156:159],v[60:63],a[60:63]
 v_mul_f32 v239,v27,v239
 s_waitcnt lgkmcnt(4)
 v_mfma_f32_16x16x32_bf16 a[32:35],a[128:131],v[64:67],a[32:35]
 ds_read_b64_tr_b16 a[152:153],v23 offset:35168
 v_and_b32 v20,1,v1
 v_mfma_f32_16x16x32_bf16 a[32:35],a[132:135],v[68:71],a[32:35]
 buffer_store_dwordx4 v[100:103],v4,s[8:11],s65 offen offset:2048 sc0 sc1
 v_mfma_f32_16x16x32_bf16 a[36:39],a[128:131],v[72:75],a[36:39]
 ds_read_b64_tr_b16 a[154:155],v23 offset:35424
 v_lshlrev_b32 v20,2,v20
 v_mfma_f32_16x16x32_bf16 a[36:39],a[132:135],v[76:79],a[36:39]
 v_exp_f32 v236,v236
 v_mfma_f32_16x16x32_bf16 a[40:43],a[128:131],v[80:83],a[40:43]
 ds_read_b64_tr_b16 a[156:157],v23 offset:43936
 v_add_f32 v236,1.0,v236
 v_mfma_f32_16x16x32_bf16 a[40:43],a[132:135],v[84:87],a[40:43]
 v_exp_f32 v237,v237
 v_mfma_f32_16x16x32_bf16 a[44:47],a[128:131],v[88:91],a[44:47]
 ds_read_b64_tr_b16 a[158:159],v23 offset:44192
 v_add_f32 v237,1.0,v237
 v_mfma_f32_16x16x32_bf16 a[44:47],a[132:135],v[92:95],a[44:47]
 v_exp_f32 v238,v238
 v_mfma_f32_16x16x32_bf16 a[48:51],a[136:139],v[64:67],a[48:51]
 ds_read_b64_tr_b16 a[128:129],v23 offset:128
 v_add_f32 v238,1.0,v238
 v_mfma_f32_16x16x32_bf16 a[48:51],a[140:143],v[68:71],a[48:51]
 v_exp_f32 v239,v239
 v_mfma_f32_16x16x32_bf16 a[52:55],a[136:139],v[72:75],a[52:55]
 ds_read_b64_tr_b16 a[130:131],v23 offset:384
 v_add_f32 v239,1.0,v239
 v_mfma_f32_16x16x32_bf16 a[52:55],a[140:143],v[76:79],a[52:55]
 v_rcp_f32 v236,v236
 v_mfma_f32_16x16x32_bf16 a[56:59],a[136:139],v[80:83],a[56:59]
 ds_read_b64_tr_b16 a[132:133],v23 offset:8896
 v_mul_f32 v252,v252,v236
 v_mfma_f32_16x16x32_bf16 a[56:59],a[140:143],v[84:87],a[56:59]
 buffer_store_dwordx4 v[104:107],v5,s[8:11],s65 offen offset:0 sc0 sc1
 v_mfma_f32_16x16x32_bf16 a[60:63],a[136:139],v[88:91],a[60:63]
 ds_read_b64_tr_b16 a[134:135],v23 offset:9152
 v_and_b32 v2,8,v1
 v_mfma_f32_16x16x32_bf16 a[60:63],a[140:143],v[92:95],a[60:63]
 v_or_b32 v20,v20,v2
 s_waitcnt lgkmcnt(4)
 v_mfma_f32_16x16x32_bf16 a[32:35],a[144:147],a[160:163],a[32:35]
 ds_read_b64_tr_b16 a[136:137],v23 offset:160
 v_and_b32 v2,2,v1
 v_mfma_f32_16x16x32_bf16 a[32:35],a[148:151],a[164:167],a[32:35]
 v_rcp_f32 v237,v237
 v_mfma_f32_16x16x32_bf16 a[36:39],a[144:147],a[168:171],a[36:39]
 ds_read_b64_tr_b16 a[138:139],v23 offset:416
 v_mul_f32 v253,v253,v237
 v_mfma_f32_16x16x32_bf16 a[36:39],a[148:151],a[172:175],a[36:39]
 v_rcp_f32 v238,v238
 v_mfma_f32_16x16x32_bf16 a[40:43],a[144:147],a[176:179],a[40:43]
 ds_read_b64_tr_b16 a[140:141],v23 offset:8928
 v_mul_f32 v254,v254,v238
 v_mfma_f32_16x16x32_bf16 a[40:43],a[148:151],a[180:183],a[40:43]
 v_rcp_f32 v239,v239
 v_mfma_f32_16x16x32_bf16 a[44:47],a[144:147],a[184:187],a[44:47]
 ds_read_b64_tr_b16 a[142:143],v23 offset:9184
 v_mul_f32 v255,v255,v239
 v_mfma_f32_16x16x32_bf16 a[44:47],a[148:151],a[188:191],a[44:47]
 v_cvt_pk_bf16_f32 v234,v252,v253
 v_cvt_pk_bf16_f32 v235,v254,v255
 v_mfma_f32_16x16x32_bf16 a[48:51],a[152:155],a[160:163],a[48:51]
 ds_read_b64_tr_b16 a[144:145],v22 offset:35200
 v_or_b32 v20,v20,v2
 v_mfma_f32_16x16x32_bf16 a[48:51],a[156:159],a[164:167],a[48:51]
 buffer_store_dwordx4 v[108:111],v5,s[8:11],s65 offen offset:2048 sc0 sc1
 v_mfma_f32_16x16x32_bf16 a[52:55],a[152:155],a[168:171],a[52:55]
 ds_read_b64_tr_b16 a[146:147],v22 offset:35456
 v_lshrrev_b32 v2,1,v1
 v_mfma_f32_16x16x32_bf16 a[52:55],a[156:159],a[172:175],a[52:55]
 v_permlane32_swap_b32 v232,v234
 v_mfma_f32_16x16x32_bf16 a[56:59],a[152:155],a[176:179],a[56:59]
 ds_read_b64_tr_b16 a[148:149],v22 offset:43968
 v_xor_b32 v2,v2,v1
 v_mfma_f32_16x16x32_bf16 a[56:59],a[156:159],a[180:183],a[56:59]
 v_permlane32_swap_b32 v233,v235
 v_mfma_f32_16x16x32_bf16 a[60:63],a[152:155],a[184:187],a[60:63]
 ds_read_b64_tr_b16 a[150:151],v22 offset:44224
 v_bfe_u32 v2,v2,2,1
 v_mfma_f32_16x16x32_bf16 a[60:63],a[156:159],a[188:191],a[60:63]
 v_or_b32 v20,v20,v2
 s_waitcnt lgkmcnt(4)
 v_mfma_f32_16x16x32_bf16 a[64:67],a[128:131],a[224:227],a[64:67]
 ds_read_b64_tr_b16 a[152:153],v22 offset:35232
 v_mul_u32_u24 v20,1040,v20
 v_mfma_f32_16x16x32_bf16 a[64:67],a[132:135],a[228:231],a[64:67]
 v_bfe_u32 v2,v1,4,1
 v_add_u32 v24,17536,v21
 v_mfma_f32_16x16x32_bf16 a[68:71],a[128:131],a[232:235],a[68:71]
 ds_read_b64_tr_b16 a[154:155],v22 offset:35488
 v_lshl_add_u32 v20,v2,5,v20
 v_mfma_f32_16x16x32_bf16 a[68:71],a[132:135],a[236:239],a[68:71]
 v_lshrrev_b32 v2,5,v1
 v_lshlrev_b32 v26,1,v24
 v_mfma_f32_16x16x32_bf16 a[72:75],a[128:131],a[240:243],a[72:75]
 ds_read_b64_tr_b16 a[156:157],v22 offset:44000
 v_lshl_add_u32 v20,v2,4,v20
 v_mfma_f32_16x16x32_bf16 a[72:75],a[132:135],a[244:247],a[72:75]
 v_lshlrev_b32 v25,1,v20
 v_add_u32 v26,70144,v26
 v_mfma_f32_16x16x32_bf16 a[76:79],a[128:131],a[248:251],a[76:79]
 ds_read_b64_tr_b16 a[158:159],v22 offset:44256
 v_add_u32 v25,70144,v25
 v_mfma_f32_16x16x32_bf16 a[76:79],a[132:135],a[252:255],a[76:79]
 v_accvgpr_read_b32 v192,a0
 v_accvgpr_read_b32 v193,a1
 v_mfma_f32_16x16x32_bf16 a[80:83],a[136:139],a[224:227],a[80:83]
 ds_read_b64_tr_b16 a[128:129],v23 offset:17664
 v_accvgpr_read_b32 v194,a2
 v_mfma_f32_16x16x32_bf16 a[80:83],a[140:143],a[228:231],a[80:83]
 v_accvgpr_read_b32 v195,a3
 v_accvgpr_read_b32 v196,a16
 v_mfma_f32_16x16x32_bf16 a[84:87],a[136:139],a[232:235],a[84:87]
 ds_read_b64_tr_b16 a[130:131],v23 offset:17920
 v_accvgpr_read_b32 v197,a17
 v_mfma_f32_16x16x32_bf16 a[84:87],a[140:143],a[236:239],a[84:87]
 v_accvgpr_read_b32 v198,a18
 v_accvgpr_read_b32 v199,a19
 v_mfma_f32_16x16x32_bf16 a[88:91],a[136:139],a[240:243],a[88:91]
 ds_read_b64_tr_b16 a[132:133],v23 offset:26432
 v_mul_f32 v192,s83,v192
 v_mfma_f32_16x16x32_bf16 a[88:91],a[140:143],a[244:247],a[88:91]
 v_mul_f32 v193,s83,v193
 v_mul_f32 v194,s83,v194
 v_mfma_f32_16x16x32_bf16 a[92:95],a[136:139],a[248:251],a[92:95]
 ds_read_b64_tr_b16 a[134:135],v23 offset:26688
 v_mul_f32 v195,s83,v195
 v_mfma_f32_16x16x32_bf16 a[92:95],a[140:143],a[252:255],a[92:95]
 v_mul_f32 v196,s83,v196
 s_waitcnt lgkmcnt(4)
 v_mfma_f32_16x16x32_bf16 a[64:67],a[144:147],v[32:35],a[64:67]
 ds_read_b64_tr_b16 a[136:137],v23 offset:17696
 v_mul_f32 v197,s83,v197
 v_mfma_f32_16x16x32_bf16 a[64:67],a[148:151],v[36:39],a[64:67]
 v_mul_f32 v198,s83,v198
 v_mul_f32 v199,s83,v199
 v_mfma_f32_16x16x32_bf16 a[68:71],a[144:147],v[40:43],a[68:71]
 ds_read_b64_tr_b16 a[138:139],v23 offset:17952
 v_cvt_pk_bf16_f32 v192,v192,v193
 v_mfma_f32_16x16x32_bf16 a[68:71],a[148:151],v[44:47],a[68:71]
 v_cvt_pk_bf16_f32 v193,v194,v195
 v_cvt_pk_bf16_f32 v194,v196,v197
 v_mfma_f32_16x16x32_bf16 a[72:75],a[144:147],v[48:51],a[72:75]
 ds_read_b64_tr_b16 a[140:141],v23 offset:26464
 v_cvt_pk_bf16_f32 v195,v198,v199
 v_mfma_f32_16x16x32_bf16 a[72:75],a[148:151],v[52:55],a[72:75]
 v_permlane16_swap_b32 v192,v194
 v_mfma_f32_16x16x32_bf16 a[76:79],a[144:147],v[56:59],a[76:79]
 ds_read_b64_tr_b16 a[142:143],v23 offset:26720
 v_accvgpr_write_b32 a0,v192
 v_mfma_f32_16x16x32_bf16 a[76:79],a[148:151],v[60:63],a[76:79]
 v_permlane16_swap_b32 v193,v195
 v_mfma_f32_16x16x32_bf16 a[80:83],a[152:155],v[32:35],a[80:83]
 ds_read_b64_tr_b16 a[144:145],v23 offset:35200
 v_accvgpr_write_b32 a1,v193
 v_mfma_f32_16x16x32_bf16 a[80:83],a[156:159],v[36:39],a[80:83]
 v_accvgpr_write_b32 a2,v194
 v_accvgpr_write_b32 a3,v195
 v_mfma_f32_16x16x32_bf16 a[84:87],a[152:155],v[40:43],a[84:87]
 ds_read_b64_tr_b16 a[146:147],v23 offset:35456
 v_accvgpr_read_b32 v200,a4
 v_mfma_f32_16x16x32_bf16 a[84:87],a[156:159],v[44:47],a[84:87]
 v_accvgpr_read_b32 v201,a5
 v_accvgpr_read_b32 v202,a6
 v_mfma_f32_16x16x32_bf16 a[88:91],a[152:155],v[48:51],a[88:91]
 ds_read_b64_tr_b16 a[148:149],v23 offset:43968
 v_accvgpr_read_b32 v203,a7
 v_mfma_f32_16x16x32_bf16 a[88:91],a[156:159],v[52:55],a[88:91]
 v_accvgpr_read_b32 v204,a20
 v_accvgpr_read_b32 v205,a21
 v_mfma_f32_16x16x32_bf16 a[92:95],a[152:155],v[56:59],a[92:95]
 ds_read_b64_tr_b16 a[150:151],v23 offset:44224
 v_accvgpr_read_b32 v206,a22
 v_mfma_f32_16x16x32_bf16 a[92:95],a[156:159],v[60:63],a[92:95]
 v_accvgpr_read_b32 v207,a23
 s_waitcnt lgkmcnt(4)
 v_mfma_f32_16x16x32_bf16 a[64:67],a[128:131],v[64:67],a[64:67]
 ds_read_b64_tr_b16 a[152:153],v23 offset:35232
 v_mul_f32 v200,s83,v200
 v_mfma_f32_16x16x32_bf16 a[64:67],a[132:135],v[68:71],a[64:67]
 v_mul_f32 v201,s83,v201
 v_mul_f32 v202,s83,v202
 v_mfma_f32_16x16x32_bf16 a[68:71],a[128:131],v[72:75],a[68:71]
 ds_read_b64_tr_b16 a[154:155],v23 offset:35488
 v_mul_f32 v203,s83,v203
 v_mfma_f32_16x16x32_bf16 a[68:71],a[132:135],v[76:79],a[68:71]
 buffer_store_dwordx4 v[224:227],v6,s[8:11],s67 offen sc0 sc1
 v_mfma_f32_16x16x32_bf16 a[72:75],a[128:131],v[80:83],a[72:75]
 ds_read_b64_tr_b16 a[156:157],v23 offset:44000
 v_mul_f32 v204,s83,v204
 v_mfma_f32_16x16x32_bf16 a[72:75],a[132:135],v[84:87],a[72:75]
 v_mul_f32 v205,s83,v205
 v_mul_f32 v206,s83,v206
 v_mfma_f32_16x16x32_bf16 a[76:79],a[128:131],v[88:91],a[76:79]
 ds_read_b64_tr_b16 a[158:159],v23 offset:44256
 v_mul_f32 v207,s83,v207
 v_mfma_f32_16x16x32_bf16 a[76:79],a[132:135],v[92:95],a[76:79]
 v_cvt_pk_bf16_f32 v200,v200,v201
 v_cvt_pk_bf16_f32 v201,v202,v203
 v_mfma_f32_16x16x32_bf16 a[80:83],a[136:139],v[64:67],a[80:83]
 ds_read_b64_tr_b16 a[128:129],v23 offset:192
 v_cvt_pk_bf16_f32 v202,v204,v205
 v_mfma_f32_16x16x32_bf16 a[80:83],a[140:143],v[68:71],a[80:83]
 v_cvt_pk_bf16_f32 v203,v206,v207
 v_accvgpr_read_b32 v208,a8
 v_mfma_f32_16x16x32_bf16 a[84:87],a[136:139],v[72:75],a[84:87]
 ds_read_b64_tr_b16 a[130:131],v23 offset:448
 v_accvgpr_read_b32 v209,a9
 v_mfma_f32_16x16x32_bf16 a[84:87],a[140:143],v[76:79],a[84:87]
 v_permlane16_swap_b32 v200,v202
 v_mfma_f32_16x16x32_bf16 a[88:91],a[136:139],v[80:83],a[88:91]
 ds_read_b64_tr_b16 a[132:133],v23 offset:8960
 v_accvgpr_write_b32 a4,v200
 v_mfma_f32_16x16x32_bf16 a[88:91],a[140:143],v[84:87],a[88:91]
 v_permlane16_swap_b32 v201,v203
 v_mfma_f32_16x16x32_bf16 a[92:95],a[136:139],v[88:91],a[92:95]
 ds_read_b64_tr_b16 a[134:135],v23 offset:9216
 v_accvgpr_write_b32 a5,v201
 v_mfma_f32_16x16x32_bf16 a[92:95],a[140:143],v[92:95],a[92:95]
 v_accvgpr_write_b32 a6,v202
 s_waitcnt lgkmcnt(4)
 v_mfma_f32_16x16x32_bf16 a[64:67],a[144:147],a[160:163],a[64:67]
 ds_read_b64_tr_b16 a[136:137],v23 offset:224
 v_accvgpr_write_b32 a7,v203
 v_mfma_f32_16x16x32_bf16 a[64:67],a[148:151],a[164:167],a[64:67]
 buffer_store_dwordx4 v[232:235],v6,s[8:11],s68 offen sc0 sc1
 v_mfma_f32_16x16x32_bf16 a[68:71],a[144:147],a[168:171],a[68:71]
 ds_read_b64_tr_b16 a[138:139],v23 offset:480
 v_accvgpr_read_b32 v210,a10
 v_mfma_f32_16x16x32_bf16 a[68:71],a[148:151],a[172:175],a[68:71]
 v_accvgpr_read_b32 v211,a11
 v_accvgpr_read_b32 v212,a24
 v_mfma_f32_16x16x32_bf16 a[72:75],a[144:147],a[176:179],a[72:75]
 ds_read_b64_tr_b16 a[140:141],v23 offset:8992
 v_accvgpr_read_b32 v213,a25
 v_mfma_f32_16x16x32_bf16 a[72:75],a[148:151],a[180:183],a[72:75]
 v_accvgpr_read_b32 v214,a26
 v_accvgpr_read_b32 v215,a27
 v_mfma_f32_16x16x32_bf16 a[76:79],a[144:147],a[184:187],a[76:79]
 ds_read_b64_tr_b16 a[142:143],v23 offset:9248
 v_mul_f32 v208,s83,v208
 v_mfma_f32_16x16x32_bf16 a[76:79],a[148:151],a[188:191],a[76:79]
 v_mul_f32 v209,s83,v209
 v_mul_f32 v210,s83,v210
 v_mfma_f32_16x16x32_bf16 a[80:83],a[152:155],a[160:163],a[80:83]
 ds_read_b64_tr_b16 a[144:145],v22 offset:35264
 v_mul_f32 v211,s83,v211
 v_mfma_f32_16x16x32_bf16 a[80:83],a[156:159],a[164:167],a[80:83]
 v_mul_f32 v212,s83,v212
 v_mul_f32 v213,s83,v213
 v_mfma_f32_16x16x32_bf16 a[84:87],a[152:155],a[168:171],a[84:87]
 ds_read_b64_tr_b16 a[146:147],v22 offset:35520
 v_mul_f32 v214,s83,v214
 v_mfma_f32_16x16x32_bf16 a[84:87],a[156:159],a[172:175],a[84:87]
 v_mul_f32 v215,s83,v215
 v_cvt_pk_bf16_f32 v208,v208,v209
 v_mfma_f32_16x16x32_bf16 a[88:91],a[152:155],a[176:179],a[88:91]
 ds_read_b64_tr_b16 a[148:149],v22 offset:44032
 v_cvt_pk_bf16_f32 v209,v210,v211
 v_mfma_f32_16x16x32_bf16 a[88:91],a[156:159],a[180:183],a[88:91]
 v_cvt_pk_bf16_f32 v210,v212,v213
 v_cvt_pk_bf16_f32 v211,v214,v215
 v_mfma_f32_16x16x32_bf16 a[92:95],a[152:155],a[184:187],a[92:95]
 ds_read_b64_tr_b16 a[150:151],v22 offset:44288
 v_accvgpr_read_b32 v216,a12
 v_mfma_f32_16x16x32_bf16 a[92:95],a[156:159],a[188:191],a[92:95]
 v_accvgpr_read_b32 v217,a13
 s_waitcnt lgkmcnt(4)
 v_mfma_f32_16x16x32_bf16 a[96:99],a[128:131],a[224:227],a[96:99]
 ds_read_b64_tr_b16 a[152:153],v22 offset:35296
 v_accvgpr_read_b32 v218,a14
 v_mfma_f32_16x16x32_bf16 a[96:99],a[132:135],a[228:231],a[96:99]
 buffer_store_dwordx4 v[160:163],v4,s[8:11],s66 offen offset:0 sc0 sc1
 v_mfma_f32_16x16x32_bf16 a[100:103],a[128:131],a[232:235],a[100:103]
 ds_read_b64_tr_b16 a[154:155],v22 offset:35552
 v_accvgpr_read_b32 v219,a15
 v_mfma_f32_16x16x32_bf16 a[100:103],a[132:135],a[236:239],a[100:103]
 v_permlane16_swap_b32 v208,v210
 v_mfma_f32_16x16x32_bf16 a[104:107],a[128:131],a[240:243],a[104:107]
 ds_read_b64_tr_b16 a[156:157],v22 offset:44064
 v_accvgpr_write_b32 a8,v208
 v_mfma_f32_16x16x32_bf16 a[104:107],a[132:135],a[244:247],a[104:107]
 v_permlane16_swap_b32 v209,v211
 v_mfma_f32_16x16x32_bf16 a[108:111],a[128:131],a[248:251],a[108:111]
 ds_read_b64_tr_b16 a[158:159],v22 offset:44320
 v_accvgpr_write_b32 a9,v209
 v_mfma_f32_16x16x32_bf16 a[108:111],a[132:135],a[252:255],a[108:111]
 v_accvgpr_write_b32 a10,v210
 v_accvgpr_write_b32 a11,v211
 v_mfma_f32_16x16x32_bf16 a[112:115],a[136:139],a[224:227],a[112:115]
 ds_read_b64_tr_b16 a[128:129],v23 offset:17728
 v_accvgpr_read_b32 v220,a28
 v_mfma_f32_16x16x32_bf16 a[112:115],a[140:143],a[228:231],a[112:115]
 v_accvgpr_read_b32 v221,a29
 v_accvgpr_read_b32 v222,a30
 v_mfma_f32_16x16x32_bf16 a[116:119],a[136:139],a[232:235],a[116:119]
 ds_read_b64_tr_b16 a[130:131],v23 offset:17984
 v_accvgpr_read_b32 v223,a31
 v_mfma_f32_16x16x32_bf16 a[116:119],a[140:143],a[236:239],a[116:119]
 v_mul_f32 v216,s83,v216
 v_mul_f32 v217,s83,v217
 v_mfma_f32_16x16x32_bf16 a[120:123],a[136:139],a[240:243],a[120:123]
 ds_read_b64_tr_b16 a[132:133],v23 offset:26496
 v_mul_f32 v218,s83,v218
 v_mfma_f32_16x16x32_bf16 a[120:123],a[140:143],a[244:247],a[120:123]
 buffer_store_dwordx4 v[164:167],v4,s[8:11],s66 offen offset:2048 sc0 sc1
 v_mfma_f32_16x16x32_bf16 a[124:127],a[136:139],a[248:251],a[124:127]
 ds_read_b64_tr_b16 a[134:135],v23 offset:26752
 v_mul_f32 v219,s83,v219
 v_mfma_f32_16x16x32_bf16 a[124:127],a[140:143],a[252:255],a[124:127]
 v_mul_f32 v220,s83,v220
 s_waitcnt lgkmcnt(4)
 v_mfma_f32_16x16x32_bf16 a[96:99],a[144:147],v[32:35],a[96:99]
 ds_read_b64_tr_b16 a[136:137],v23 offset:17760
 v_mul_f32 v221,s83,v221
 v_mfma_f32_16x16x32_bf16 a[96:99],a[148:151],v[36:39],a[96:99]
 v_mul_f32 v222,s83,v222
 v_mul_f32 v223,s83,v223
 v_mfma_f32_16x16x32_bf16 a[100:103],a[144:147],v[40:43],a[100:103]
 ds_read_b64_tr_b16 a[138:139],v23 offset:18016
 v_cvt_pk_bf16_f32 v216,v216,v217
 v_mfma_f32_16x16x32_bf16 a[100:103],a[148:151],v[44:47],a[100:103]
 v_cvt_pk_bf16_f32 v217,v218,v219
L_w12:
 s_cbranch_execz L_wret0
 v_cvt_pk_bf16_f32 v218,v220,v221
 v_mfma_f32_16x16x32_bf16 a[104:107],a[144:147],v[48:51],a[104:107]
 ds_read_b64_tr_b16 a[140:141],v23 offset:26528
 v_cvt_pk_bf16_f32 v219,v222,v223
 v_mfma_f32_16x16x32_bf16 a[104:107],a[148:151],v[52:55],a[104:107]
 v_permlane16_swap_b32 v216,v218
 v_mfma_f32_16x16x32_bf16 a[108:111],a[144:147],v[56:59],a[108:111]
 ds_read_b64_tr_b16 a[142:143],v23 offset:26784
 v_accvgpr_write_b32 a12,v216
 v_mfma_f32_16x16x32_bf16 a[108:111],a[148:151],v[60:63],a[108:111]
 v_permlane16_swap_b32 v217,v219
 v_mfma_f32_16x16x32_bf16 a[112:115],a[152:155],v[32:35],a[112:115]
 ds_read_b64_tr_b16 a[144:145],v23 offset:35264
 v_accvgpr_write_b32 a13,v217
 v_mfma_f32_16x16x32_bf16 a[112:115],a[156:159],v[36:39],a[112:115]
 buffer_store_dwordx4 v[168:171],v5,s[8:11],s66 offen offset:0 sc0 sc1
 v_mfma_f32_16x16x32_bf16 a[116:119],a[152:155],v[40:43],a[116:119]
 ds_read_b64_tr_b16 a[146:147],v23 offset:35520
 v_accvgpr_write_b32 a14,v218
 v_mfma_f32_16x16x32_bf16 a[116:119],a[156:159],v[44:47],a[116:119]
 v_accvgpr_write_b32 a15,v219
 v_accvgpr_read_b32 v192,a32
 v_mfma_f32_16x16x32_bf16 a[120:123],a[152:155],v[48:51],a[120:123]
 ds_read_b64_tr_b16 a[148:149],v23 offset:44032
 v_accvgpr_read_b32 v193,a33
 v_mfma_f32_16x16x32_bf16 a[120:123],a[156:159],v[52:55],a[120:123]
 v_accvgpr_read_b32 v194,a34
 v_accvgpr_read_b32 v195,a35
 v_mfma_f32_16x16x32_bf16 a[124:127],a[152:155],v[56:59],a[124:127]
 ds_read_b64_tr_b16 a[150:151],v23 offset:44288
 v_accvgpr_read_b32 v196,a48
 v_mfma_f32_16x16x32_bf16 a[124:127],a[156:159],v[60:63],a[124:127]
 v_accvgpr_read_b32 v197,a49
 s_waitcnt lgkmcnt(4)
 v_mfma_f32_16x16x32_bf16 a[96:99],a[128:131],v[64:67],a[96:99]
 ds_read_b64_tr_b16 a[152:153],v23 offset:35296
 v_accvgpr_read_b32 v198,a50
 v_mfma_f32_16x16x32_bf16 a[96:99],a[132:135],v[68:71],a[96:99]
 v_accvgpr_read_b32 v199,a51
 v_mul_f32 v192,s83,v192
 v_mfma_f32_16x16x32_bf16 a[100:103],a[128:131],v[72:75],a[100:103]
 ds_read_b64_tr_b16 a[154:155],v23 offset:35552
 v_mul_f32 v193,s83,v193
 v_mfma_f32_16x16x32_bf16 a[100:103],a[132:135],v[76:79],a[100:103]
 v_mul_f32 v194,s83,v194
 v_mul_f32 v195,s83,v195
 v_mfma_f32_16x16x32_bf16 a[104:107],a[128:131],v[80:83],a[104:107]
 ds_read_b64_tr_b16 a[156:157],v23 offset:44064
 v_mul_f32 v196,s83,v196
 v_mfma_f32_16x16x32_bf16 a[104:107],a[132:135],v[84:87],a[104:107]
 buffer_store_dwordx4 v[172:175],v5,s[8:11],s66 offen offset:2048 sc0 sc1
 v_mfma_f32_16x16x32_bf16 a[108:111],a[128:131],v[88:91],a[108:111]
 ds_read_b64_tr_b16 a[158:159],v23 offset:44320
 v_mul_f32 v197,s83,v197
 v_mfma_f32_16x16x32_bf16 a[108:111],a[132:135],v[92:95],a[108:111]
 s_sub_u32 s54,s56,s54
 v_mul_f32 v198,s83,v198
 v_mfma_f32_16x16x32_bf16 a[112:115],a[136:139],v[64:67],a[112:115]
 s_waitcnt vmcnt(26)
 s_barrier
 v_mfma_f32_16x16x32_bf16 a[112:115],a[140:143],v[68:71],a[112:115]
 ds_read_b128 a[128:131],v20 offset:0
 s_add_u32 m0,s54,0
 v_mfma_f32_16x16x32_bf16 a[116:119],a[136:139],v[72:75],a[116:119]
 buffer_load_dwordx4 v16,s[24:27],s59 offen offset:0 lds
 v_mfma_f32_16x16x32_bf16 a[116:119],a[140:143],v[76:79],a[116:119]
 v_mul_f32 v199,s83,v199
 v_cvt_pk_bf16_f32 v192,v192,v193
 v_mfma_f32_16x16x32_bf16 a[120:123],a[136:139],v[80:83],a[120:123]
 buffer_load_dwordx4 v17,s[24:27],s59 offen offset:1088 lds
 v_mfma_f32_16x16x32_bf16 a[120:123],a[140:143],v[84:87],a[120:123]
 ds_read_b128 a[132:135],v20 offset:64
 v_cvt_pk_bf16_f32 v193,v194,v195
 v_mfma_f32_16x16x32_bf16 a[124:127],a[136:139],v[88:91],a[124:127]
 buffer_load_dwordx4 v18,s[24:27],s59 offen offset:2176 lds
 v_mfma_f32_16x16x32_bf16 a[124:127],a[140:143],v[92:95],a[124:127]
 v_cvt_pk_bf16_f32 v194,v196,v197
 s_waitcnt lgkmcnt(2)
 v_mfma_f32_16x16x32_bf16 a[96:99],a[144:147],a[160:163],a[96:99]
 buffer_load_dwordx4 v19,s[24:27],s59 offen offset:3264 lds
 v_mfma_f32_16x16x32_bf16 a[96:99],a[148:151],a[164:167],a[96:99]
 ds_read_b128 a[136:139],v20 offset:128
 v_cvt_pk_bf16_f32 v195,v198,v199
 v_mfma_f32_16x16x32_bf16 a[100:103],a[144:147],a[168:171],a[100:103]
 v_permlane16_swap_b32 v192,v194
 v_mfma_f32_16x16x32_bf16 a[100:103],a[148:151],a[172:175],a[100:103]
 v_permlane16_swap_b32 v193,v195
 v_mfma_f32_16x16x32_bf16 a[104:107],a[144:147],a[176:179],a[104:107]
 v_accvgpr_write_b32 a32,v192
 v_accvgpr_write_b32 a33,v193
 v_mfma_f32_16x16x32_bf16 a[104:107],a[148:151],a[180:183],a[104:107]
 ds_read_b128 a[140:143],v20 offset:192
 v_accvgpr_write_b32 a34,v194
 v_mfma_f32_16x16x32_bf16 a[108:111],a[144:147],a[184:187],a[108:111]
 v_accvgpr_write_b32 a35,v195
 v_accvgpr_read_b32 v200,a36
 v_mfma_f32_16x16x32_bf16 a[108:111],a[148:151],a[188:191],a[108:111]
 s_add_u32 s59,s59,16384
 s_add_u32 m0,s53,35072
 v_mfma_f32_16x16x32_bf16 a[112:115],a[152:155],a[160:163],a[112:115]
 buffer_load_dwordx4 v12,s[20:23],s59 offen offset:0 lds
 v_mfma_f32_16x16x32_bf16 a[112:115],a[156:159],a[164:167],a[112:115]
 ds_read_b128 a[144:147],v20 offset:256
 v_accvgpr_read_b32 v201,a37
 v_mfma_f32_16x16x32_bf16 a[116:119],a[152:155],a[168:171],a[116:119]
 v_accvgpr_read_b32 v202,a38
 v_accvgpr_read_b32 v203,a39
 v_mfma_f32_16x16x32_bf16 a[116:119],a[156:159],a[172:175],a[116:119]
 v_accvgpr_read_b32 v204,a52
 v_accvgpr_read_b32 v205,a53
 v_mfma_f32_16x16x32_bf16 a[120:123],a[152:155],a[176:179],a[120:123]
 v_accvgpr_read_b32 v206,a54
 v_accvgpr_read_b32 v207,a55
 v_mfma_f32_16x16x32_bf16 a[120:123],a[156:159],a[180:183],a[120:123]
 ds_read_b128 a[148:151],v20 offset:320
 v_mul_f32 v200,s83,v200
 v_mfma_f32_16x16x32_bf16 a[124:127],a[152:155],a[184:187],a[124:127]
 v_mul_f32 v201,s83,v201
 v_mul_f32 v202,s83,v202
 v_mfma_f32_16x16x32_bf16 a[124:127],a[156:159],a[188:191],a[124:127]
 v_mul_f32 v203,s83,v203
 v_mul_f32 v204,s83,v204
 v_mul_f32 v205,s83,v205
 v_mul_f32 v206,s83,v206
 v_mul_f32 v207,s83,v207
 v_cvt_pk_bf16_f32 v200,v200,v201
 v_cvt_pk_bf16_f32 v201,v202,v203
 v_cvt_pk_bf16_f32 v202,v204,v205
 v_cvt_pk_bf16_f32 v203,v206,v207
 s_nop 0
 v_permlane16_swap_b32 v200,v202
 v_permlane16_swap_b32 v201,v203
 v_accvgpr_write_b32 a36,v200
 v_accvgpr_write_b32 a37,v201
 v_accvgpr_write_b32 a38,v202
 v_accvgpr_write_b32 a39,v203
 v_accvgpr_read_b32 v208,a40
 v_accvgpr_read_b32 v209,a41
 v_accvgpr_read_b32 v210,a42
 v_accvgpr_read_b32 v211,a43
 v_accvgpr_read_b32 v212,a56
 v_accvgpr_read_b32 v213,a57
 v_accvgpr_read_b32 v214,a58
 v_accvgpr_read_b32 v215,a59
 v_mul_f32 v208,s83,v208
 v_mul_f32 v209,s83,v209
 v_mul_f32 v210,s83,v210
 v_mul_f32 v211,s83,v211
 v_mul_f32 v212,s83,v212
 v_mul_f32 v213,s83,v213
 v_mul_f32 v214,s83,v214
 v_mul_f32 v215,s83,v215
 v_cvt_pk_bf16_f32 v208,v208,v209
 v_cvt_pk_bf16_f32 v209,v210,v211
 v_cvt_pk_bf16_f32 v210,v212,v213
 v_cvt_pk_bf16_f32 v211,v214,v215
 s_nop 0
 v_permlane16_swap_b32 v208,v210
 v_permlane16_swap_b32 v209,v211
 v_accvgpr_write_b32 a40,v208
 v_accvgpr_write_b32 a41,v209
 v_accvgpr_write_b32 a42,v210
 v_accvgpr_write_b32 a43,v211
 v_accvgpr_read_b32 v216,a44
 v_accvgpr_read_b32 v217,a45
 v_accvgpr_read_b32 v218,a46
 v_accvgpr_read_b32 v219,a47
 v_accvgpr_read_b32 v220,a60
 v_accvgpr_read_b32 v221,a61
 v_accvgpr_read_b32 v222,a62
 v_accvgpr_read_b32 v223,a63
 v_mul_f32 v216,s83,v216
 v_mul_f32 v217,s83,v217
 v_mul_f32 v218,s83,v218
 v_mul_f32 v219,s83,v219
 v_mul_f32 v220,s83,v220
 v_mul_f32 v221,s83,v221
 v_mul_f32 v222,s83,v222
 v_mul_f32 v223,s83,v223
 v_cvt_pk_bf16_f32 v216,v216,v217
 v_cvt_pk_bf16_f32 v217,v218,v219
 v_cvt_pk_bf16_f32 v218,v220,v221
 v_cvt_pk_bf16_f32 v219,v222,v223
 s_nop 0
 v_permlane16_swap_b32 v216,v218
 v_permlane16_swap_b32 v217,v219
 v_accvgpr_write_b32 a44,v216
 v_accvgpr_write_b32 a45,v217
 v_accvgpr_write_b32 a46,v218
 v_accvgpr_write_b32 a47,v219
 v_accvgpr_read_b32 v192,a64
 v_accvgpr_read_b32 v193,a65
 v_accvgpr_read_b32 v194,a66
 v_accvgpr_read_b32 v195,a67
 v_accvgpr_read_b32 v196,a80
 v_accvgpr_read_b32 v197,a81
 v_accvgpr_read_b32 v198,a82
 v_accvgpr_read_b32 v199,a83
 v_mul_f32 v192,s83,v192
 v_mul_f32 v193,s83,v193
 v_mul_f32 v194,s83,v194
 v_mul_f32 v195,s83,v195
 v_mul_f32 v196,s83,v196
 v_mul_f32 v197,s83,v197
 v_mul_f32 v198,s83,v198
 v_mul_f32 v199,s83,v199
 v_cvt_pk_bf16_f32 v192,v192,v193
 v_cvt_pk_bf16_f32 v193,v194,v195
 v_cvt_pk_bf16_f32 v194,v196,v197
 v_cvt_pk_bf16_f32 v195,v198,v199
 s_nop 0
 v_permlane16_swap_b32 v192,v194
 v_permlane16_swap_b32 v193,v195
 v_accvgpr_write_b32 a64,v192
 v_accvgpr_write_b32 a65,v193
 v_accvgpr_write_b32 a66,v194
 v_accvgpr_write_b32 a67,v195
 v_accvgpr_read_b32 v200,a68
 v_accvgpr_read_b32 v201,a69
 v_accvgpr_read_b32 v202,a70
 v_accvgpr_read_b32 v203,a71
 v_accvgpr_read_b32 v204,a84
 v_accvgpr_read_b32 v205,a85
 v_accvgpr_read_b32 v206,a86
 v_accvgpr_read_b32 v207,a87
 v_mul_f32 v200,s83,v200
 v_mul_f32 v201,s83,v201
 v_mul_f32 v202,s83,v202
 v_mul_f32 v203,s83,v203
 v_mul_f32 v204,s83,v204
 v_mul_f32 v205,s83,v205
 v_mul_f32 v206,s83,v206
 v_mul_f32 v207,s83,v207
 v_cvt_pk_bf16_f32 v200,v200,v201
 v_cvt_pk_bf16_f32 v201,v202,v203
 v_cvt_pk_bf16_f32 v202,v204,v205
 v_cvt_pk_bf16_f32 v203,v206,v207
 s_nop 0
 v_permlane16_swap_b32 v200,v202
 v_permlane16_swap_b32 v201,v203
 v_accvgpr_write_b32 a68,v200
 v_accvgpr_write_b32 a69,v201
 v_accvgpr_write_b32 a70,v202
 v_accvgpr_write_b32 a71,v203
 v_accvgpr_read_b32 v208,a72
 v_accvgpr_read_b32 v209,a73
 v_accvgpr_read_b32 v210,a74
 v_accvgpr_read_b32 v211,a75
 v_accvgpr_read_b32 v212,a88
 v_accvgpr_read_b32 v213,a89
 v_accvgpr_read_b32 v214,a90
 v_accvgpr_read_b32 v215,a91
 v_mul_f32 v208,s83,v208
 v_mul_f32 v209,s83,v209
 v_mul_f32 v210,s83,v210
 v_mul_f32 v211,s83,v211
 v_mul_f32 v212,s83,v212
 v_mul_f32 v213,s83,v213
 v_mul_f32 v214,s83,v214
 v_mul_f32 v215,s83,v215
 v_cvt_pk_bf16_f32 v208,v208,v209
 v_cvt_pk_bf16_f32 v209,v210,v211
 v_cvt_pk_bf16_f32 v210,v212,v213
 v_cvt_pk_bf16_f32 v211,v214,v215
 s_nop 0
 v_permlane16_swap_b32 v208,v210
 v_permlane16_swap_b32 v209,v211
 v_accvgpr_write_b32 a72,v208
 v_accvgpr_write_b32 a73,v209
 v_accvgpr_write_b32 a74,v210
 v_accvgpr_write_b32 a75,v211
 v_accvgpr_read_b32 v216,a76
 v_accvgpr_read_b32 v217,a77
 v_accvgpr_read_b32 v218,a78
 v_accvgpr_read_b32 v219,a79
 v_accvgpr_read_b32 v220,a92
 v_accvgpr_read_b32 v221,a93
 v_accvgpr_read_b32 v222,a94
 v_accvgpr_read_b32 v223,a95
 v_mul_f32 v216,s83,v216
 v_mul_f32 v217,s83,v217
 v_mul_f32 v218,s83,v218
 v_mul_f32 v219,s83,v219
 v_mul_f32 v220,s83,v220
 v_mul_f32 v221,s83,v221
 v_mul_f32 v222,s83,v222
 v_mul_f32 v223,s83,v223
 v_cvt_pk_bf16_f32 v216,v216,v217
 v_cvt_pk_bf16_f32 v217,v218,v219
 v_cvt_pk_bf16_f32 v218,v220,v221
 v_cvt_pk_bf16_f32 v219,v222,v223
 s_nop 0
 v_permlane16_swap_b32 v216,v218
 v_permlane16_swap_b32 v217,v219
 v_accvgpr_write_b32 a76,v216
 v_accvgpr_write_b32 a77,v217
 v_accvgpr_write_b32 a78,v218
 v_accvgpr_write_b32 a79,v219
 s_waitcnt lgkmcnt(3)
 v_mfma_f32_16x16x32_bf16 v[224:227],a[128:131],a[0:3],0
 ds_read_b128 a[152:155],v20 offset:384
 v_mov_b32 v60,0x3f803f80
 v_mfma_f32_16x16x32_bf16 v[224:227],a[132:135],a[32:35],v[224:227]
 buffer_load_dwordx4 v13,s[20:23],s59 offen offset:1040 lds
 v_mfma_f32_16x16x32_bf16 v[224:227],a[136:139],a[64:67],v[224:227]
 ds_read_b128 a[156:159],v20 offset:448
 v_accvgpr_read_b32 v192,a96
 v_mfma_f32_16x16x32_bf16 v[228:231],a[128:131],a[4:7],0
 v_accvgpr_read_b32 v193,a97
 v_accvgpr_read_b32 v194,a98
 v_mfma_f32_16x16x32_bf16 v[228:231],a[132:135],a[36:39],v[228:231]
 v_accvgpr_read_b32 v195,a99
 v_accvgpr_read_b32 v196,a112
 v_mfma_f32_16x16x32_bf16 v[228:231],a[136:139],a[68:71],v[228:231]
 v_accvgpr_read_b32 v197,a113
 v_accvgpr_read_b32 v198,a114
 v_mfma_f32_16x16x32_bf16 v[232:235],a[128:131],a[8:11],0
 v_accvgpr_read_b32 v199,a115
 v_mul_f32 v192,s83,v192
 v_mfma_f32_16x16x32_bf16 v[232:235],a[132:135],a[40:43],v[232:235]
 v_mul_f32 v193,s83,v193
 v_mul_f32 v194,s83,v194
 v_mfma_f32_16x16x32_bf16 v[232:235],a[136:139],a[72:75],v[232:235]
 v_mul_f32 v195,s83,v195
 v_mul_f32 v196,s83,v196
 v_mfma_f32_16x16x32_bf16 v[236:239],a[128:131],a[12:15],0
 buffer_load_dwordx4 v14,s[20:23],s59 offen offset:2080 lds
 v_mfma_f32_16x16x32_bf16 v[236:239],a[132:135],a[44:47],v[236:239]
 v_mul_f32 v197,s83,v197
 v_mul_f32 v198,s83,v198
 v_mfma_f32_16x16x32_bf16 v[236:239],a[136:139],a[76:79],v[236:239]
 v_mul_f32 v199,s83,v199
 v_cvt_pk_bf16_f32 v192,v192,v193
 s_waitcnt lgkmcnt(1)
 v_mfma_f32_16x16x32_bf16 v[240:243],a[144:147],a[0:3],0
 ds_read_b128 a[128:131],v20 offset:512
 v_cvt_pk_bf16_f32 v193,v194,v195
 v_mfma_f32_16x16x32_bf16 v[240:243],a[148:151],a[32:35],v[240:243]
 v_cvt_pk_bf16_f32 v194,v196,v197
 v_cvt_pk_bf16_f32 v195,v198,v199
 v_mfma_f32_16x16x32_bf16 v[240:243],a[152:155],a[64:67],v[240:243]
 ds_read_b128 a[132:135],v20 offset:576
 v_accvgpr_read_b32 v200,a100
 v_mfma_f32_16x16x32_bf16 v[244:247],a[144:147],a[4:7],0
 v_permlane16_swap_b32 v192,v194
 v_mfma_f32_16x16x32_bf16 v[244:247],a[148:151],a[36:39],v[244:247]
 ds_read_b128 a[136:139],v20 offset:640
 s_waitcnt vmcnt(25)
 s_barrier
 v_mfma_f32_16x16x32_bf16 v[244:247],a[152:155],a[68:71],v[244:247]
 buffer_load_dwordx4 v15,s[20:23],s59 offen offset:3120 lds
 v_mfma_f32_16x16x32_bf16 v[248:251],a[144:147],a[8:11],0
 ds_read_b64_tr_b16 a[160:161],v24 offset:0
 v_accvgpr_write_b32 a96,v192
 v_mfma_f32_16x16x32_bf16 v[248:251],a[148:151],a[40:43],v[248:251]
 v_permlane16_swap_b32 v193,v195
 v_mfma_f32_16x16x32_bf16 v[248:251],a[152:155],a[72:75],v[248:251]
 ds_read_b64_tr_b16 a[162:163],v24 offset:256
 v_accvgpr_write_b32 a97,v193
 v_mfma_f32_16x16x32_bf16 v[252:255],a[144:147],a[12:15],0
 v_accvgpr_write_b32 a98,v194
 v_accvgpr_write_b32 a99,v195
 v_mfma_f32_16x16x32_bf16 v[252:255],a[148:151],a[44:47],v[252:255]
 ds_read_b64_tr_b16 a[164:165],v24 offset:32
 v_accvgpr_read_b32 v201,a101
 v_mfma_f32_16x16x32_bf16 v[252:255],a[152:155],a[76:79],v[252:255]
 v_accvgpr_read_b32 v202,a102
 v_accvgpr_read_b32 v203,a103
 v_accvgpr_read_b32 v204,a116
 v_accvgpr_read_b32 v205,a117
 v_accvgpr_read_b32 v206,a118
 v_accvgpr_read_b32 v207,a119
 v_mul_f32 v200,s83,v200
 v_mul_f32 v201,s83,v201
 v_mul_f32 v202,s83,v202
 v_mul_f32 v203,s83,v203
 v_mul_f32 v204,s83,v204
 v_mul_f32 v205,s83,v205
 v_mul_f32 v206,s83,v206
 v_mul_f32 v207,s83,v207
 v_cvt_pk_bf16_f32 v200,v200,v201
 v_cvt_pk_bf16_f32 v201,v202,v203
 v_cvt_pk_bf16_f32 v202,v204,v205
 v_cvt_pk_bf16_f32 v203,v206,v207
 s_nop 0
 v_permlane16_swap_b32 v200,v202
 v_permlane16_swap_b32 v201,v203
 v_accvgpr_write_b32 a100,v200
 v_accvgpr_write_b32 a101,v201
 v_accvgpr_write_b32 a102,v202
 v_accvgpr_write_b32 a103,v203
 v_accvgpr_read_b32 v208,a104
 v_accvgpr_read_b32 v209,a105
 v_accvgpr_read_b32 v210,a106
 v_accvgpr_read_b32 v211,a107
 v_accvgpr_read_b32 v212,a120
 v_accvgpr_read_b32 v213,a121
 v_accvgpr_read_b32 v214,a122
 v_accvgpr_read_b32 v215,a123
 v_mul_f32 v208,s83,v208
 v_mul_f32 v209,s83,v209
 v_mul_f32 v210,s83,v210
 v_mul_f32 v211,s83,v211
 v_mul_f32 v212,s83,v212
 v_mul_f32 v213,s83,v213
 v_mul_f32 v214,s83,v214
 v_mul_f32 v215,s83,v215
 v_cvt_pk_bf16_f32 v208,v208,v209
 v_cvt_pk_bf16_f32 v209,v210,v211
 v_cvt_pk_bf16_f32 v210,v212,v213
 v_cvt_pk_bf16_f32 v211,v214,v215
 s_nop 0
 v_permlane16_swap_b32 v208,v210
 v_permlane16_swap_b32 v209,v211
 v_accvgpr_write_b32 a104,v208
 v_accvgpr_write_b32 a105,v209
 v_accvgpr_write_b32 a106,v210
 v_accvgpr_write_b32 a107,v211
 v_accvgpr_read_b32 v216,a108
 v_accvgpr_read_b32 v217,a109
 v_accvgpr_read_b32 v218,a110
 v_accvgpr_read_b32 v219,a111
 v_accvgpr_read_b32 v220,a124
 v_accvgpr_read_b32 v221,a125
 v_accvgpr_read_b32 v222,a126
 v_accvgpr_read_b32 v223,a127
 v_mul_f32 v216,s83,v216
 v_mul_f32 v217,s83,v217
 v_mul_f32 v218,s83,v218
 v_mul_f32 v219,s83,v219
 v_mul_f32 v220,s83,v220
 v_mul_f32 v221,s83,v221
 v_mul_f32 v222,s83,v222
 v_mul_f32 v223,s83,v223
 v_cvt_pk_bf16_f32 v216,v216,v217
 v_cvt_pk_bf16_f32 v217,v218,v219
 v_cvt_pk_bf16_f32 v218,v220,v221
 v_cvt_pk_bf16_f32 v219,v222,v223
 s_nop 0
 v_permlane16_swap_b32 v216,v218
 v_permlane16_swap_b32 v217,v219
 v_accvgpr_write_b32 a108,v216
 v_accvgpr_write_b32 a109,v217
 v_accvgpr_write_b32 a110,v218
 v_accvgpr_write_b32 a111,v219
 s_waitcnt lgkmcnt(6)
 v_mfma_f32_16x16x32_bf16 v[224:227],a[140:143],a[96:99],v[224:227]
 ds_read_b128 a[144:147],v20 offset:768
 v_mov_b32 v61,0x3f803f80
 v_mfma_f32_16x16x32_bf16 v[228:231],a[140:143],a[100:103],v[228:231]
 ds_read_b64_tr_b16 a[166:167],v24 offset:288
 v_mov_b32 v62,0x3f803f80
 v_mfma_f32_16x16x32_bf16 v[232:235],a[140:143],a[104:107],v[232:235]
 ds_read_b128 a[148:151],v20 offset:832
 v_mov_b32 v63,0x3f803f80
 v_mfma_f32_16x16x32_bf16 v[236:239],a[140:143],a[108:111],v[236:239]
 ds_read_b64_tr_b16 a[168:169],v24 offset:64
 v_mfma_f32_16x16x32_bf16 v[240:243],a[156:159],a[96:99],v[240:243]
 ds_read_b128 a[140:143],v20 offset:704
 v_max3_f32 v48,v224,v225,v226
 v_mfma_f32_16x16x32_bf16 v[244:247],a[156:159],a[100:103],v[244:247]
 ds_read_b64_tr_b16 a[170:171],v24 offset:320
 v_max_f32 v48,v48,v227
 v_mfma_f32_16x16x32_bf16 v[248:251],a[156:159],a[104:107],v[248:251]
 ds_read_b128 a[152:155],v20 offset:896
 s_add_u32 m0,s54,35072
 v_mfma_f32_16x16x32_bf16 v[252:255],a[156:159],a[108:111],v[252:255]
 buffer_load_dwordx4 v16,s[24:27],s59 offen offset:0 lds
 v_max3_f32 v49,v228,v229,v230
 v_max_f32 v49,v49,v231
 v_max3_f32 v50,v232,v233,v234
 v_max_f32 v50,v50,v235
 v_max3_f32 v51,v236,v237,v238
 v_max_f32 v51,v51,v239
 v_permlane16_swap_b32 v48,v49
 s_nop 0
 v_permlane16_swap_b32 v50,v51
 v_max_f32 v48,v48,v49
 v_max_f32 v50,v50,v51
 s_nop 1
 v_permlane32_swap_b32 v48,v50
 v_max_f32 v48,v48,v50
 v_mov_b32 v50,v48
 s_nop 1
 v_permlane32_swap_b32 v48,v50
 v_mov_b32 v49,v48
 v_mov_b32 v51,v50
 s_nop 0
 v_permlane16_swap_b32 v48,v49
 v_permlane16_swap_b32 v50,v51
 v_sub_f32 v80,0,v48
 v_sub_f32 v81,0,v48
 v_sub_f32 v82,0,v48
 v_sub_f32 v83,0,v48
 v_sub_f32 v84,0,v49
 v_sub_f32 v85,0,v49
 v_sub_f32 v86,0,v49
 v_sub_f32 v87,0,v49
 v_sub_f32 v88,0,v50
 v_sub_f32 v89,0,v50
 v_sub_f32 v90,0,v50
 v_sub_f32 v91,0,v50
 v_sub_f32 v92,0,v51
 v_sub_f32 v93,0,v51
 v_sub_f32 v94,0,v51
 v_sub_f32 v95,0,v51
 s_cmp_eq_u32 s50,-1
 s_cbranch_scc1 L_safe
L_safe_ret:
 s_waitcnt lgkmcnt(2)
 v_mfma_f32_16x16x32_bf16 v[64:67],a[128:131],a[0:3],v[80:83]
 ds_read_b128 a[156:159],v20 offset:960
 v_add_f32 v224,v224,v80
 v_mfma_f32_16x16x32_bf16 v[64:67],a[132:135],a[32:35],v[64:67]
 v_add_f32 v225,v225,v80
 v_add_f32 v226,v226,v80
 v_mfma_f32_16x16x32_bf16 v[64:67],a[136:139],a[64:67],v[64:67]
 v_add_f32 v227,v227,v80
 v_add_f32 v240,v240,v80
 v_mfma_f32_16x16x32_bf16 v[64:67],a[140:143],a[96:99],v[64:67]
 v_mfma_f32_16x16x32_bf16 v[68:71],a[128:131],a[4:7],v[84:87]
 s_nop 6
 v_exp_f32 v64,v64
 v_mfma_f32_16x16x32_bf16 v[68:71],a[132:135],a[36:39],v[68:71]
 ds_read_b64_tr_b16 a[172:173],v24 offset:96
 v_add_f32 v241,v241,v80
 v_mfma_f32_16x16x32_bf16 v[68:71],a[136:139],a[68:71],v[68:71]
 v_exp_f32 v65,v65
 v_mfma_f32_16x16x32_bf16 v[68:71],a[140:143],a[100:103],v[68:71]
 v_exp_f32 v224,v224
 v_exp_f32 v225,v225
 v_exp_f32 v226,v226
 v_exp_f32 v227,v227
 v_cvt_pk_bf16_f32 v96,v224,v225
 v_cvt_pk_bf16_f32 v97,v226,v227
 v_add_f32 v242,v242,v80
 v_add_f32 v243,v243,v80
 v_exp_f32 v240,v240
 v_exp_f32 v241,v241
 v_exp_f32 v242,v242
 v_exp_f32 v243,v243
 v_cvt_pk_bf16_f32 v98,v240,v241
 v_cvt_pk_bf16_f32 v99,v242,v243
 s_nop 1
 v_mfma_f32_16x16x32_bf16 v[128:131],a[160:163],v[96:99],0
 v_exp_f32 v66,v66
 v_add_f32 v228,v228,v84
 v_add_f32 v229,v229,v84
 v_add_f32 v230,v230,v84
 v_add_f32 v231,v231,v84
 v_exp_f32 v228,v228
 v_exp_f32 v229,v229
 v_exp_f32 v230,v230
 v_exp_f32 v231,v231
 v_cvt_pk_bf16_f32 v104,v228,v229
 v_cvt_pk_bf16_f32 v105,v230,v231
 v_add_f32 v244,v244,v84
 v_add_f32 v245,v245,v84
 v_add_f32 v246,v246,v84
 v_add_f32 v247,v247,v84
 v_exp_f32 v244,v244
 v_exp_f32 v245,v245
 v_exp_f32 v246,v246
 v_exp_f32 v247,v247
 v_cvt_pk_bf16_f32 v106,v244,v245
 v_cvt_pk_bf16_f32 v107,v246,v247
 s_nop 1
 v_mfma_f32_16x16x32_bf16 v[132:135],a[160:163],v[104:107],0
 ds_read_b64_tr_b16 a[174:175],v24 offset:352
 v_cvt_pk_bf16_f32 v100,v64,v65
 v_add_f32 v232,v232,v88
 v_add_f32 v233,v233,v88
 v_add_f32 v234,v234,v88
 v_add_f32 v235,v235,v88
 v_exp_f32 v232,v232
 v_exp_f32 v233,v233
 v_exp_f32 v234,v234
 v_exp_f32 v235,v235
 v_cvt_pk_bf16_f32 v112,v232,v233
 v_cvt_pk_bf16_f32 v113,v234,v235
 v_add_f32 v248,v248,v88
 v_add_f32 v249,v249,v88
 v_add_f32 v250,v250,v88
 v_add_f32 v251,v251,v88
 v_exp_f32 v248,v248
 v_exp_f32 v249,v249
 v_exp_f32 v250,v250
 v_exp_f32 v251,v251
 v_cvt_pk_bf16_f32 v114,v248,v249
 v_cvt_pk_bf16_f32 v115,v250,v251
 s_nop 1
 v_mfma_f32_16x16x32_bf16 v[136:139],a[160:163],v[112:115],0
 v_exp_f32 v67,v67
 v_add_f32 v236,v236,v92
 v_add_f32 v237,v237,v92
 v_add_f32 v238,v238,v92
 v_add_f32 v239,v239,v92
 v_exp_f32 v236,v236
 v_exp_f32 v237,v237
 v_exp_f32 v238,v238
 v_exp_f32 v239,v239
 v_cvt_pk_bf16_f32 v120,v236,v237
 v_cvt_pk_bf16_f32 v121,v238,v239
 v_add_f32 v252,v252,v92
 v_add_f32 v253,v253,v92
 v_add_f32 v254,v254,v92
 v_add_f32 v255,v255,v92
 v_exp_f32 v252,v252
 v_exp_f32 v253,v253
 v_exp_f32 v254,v254
 v_exp_f32 v255,v255
 v_cvt_pk_bf16_f32 v122,v252,v253
 v_cvt_pk_bf16_f32 v123,v254,v255
 s_nop 1
 v_mfma_f32_16x16x32_bf16 v[140:143],a[160:163],v[120:123],0
 buffer_load_dwordx4 v17,s[24:27],s59 offen offset:1088 lds
 v_mfma_f32_16x16x32_bf16 v[72:75],a[128:131],a[8:11],v[88:91]
 v_exp_f32 v68,v68
 v_mfma_f32_16x16x32_bf16 v[72:75],a[132:135],a[40:43],v[72:75]
 ds_read_b64_tr_b16 a[160:161],v24 offset:128
 v_cvt_pk_bf16_f32 v101,v66,v67
 v_mfma_f32_16x16x32_bf16 v[72:75],a[136:139],a[72:75],v[72:75]
 v_exp_f32 v69,v69
 v_mfma_f32_16x16x32_bf16 v[72:75],a[140:143],a[104:107],v[72:75]
 v_accvgpr_write_b32 a176,0
 v_accvgpr_write_b32 a177,0
 v_mfma_f32_16x16x32_bf16 v[144:147],a[164:167],v[96:99],0
 v_exp_f32 v70,v70
 v_mfma_f32_16x16x32_bf16 v[148:151],a[164:167],v[104:107],0
 ds_read_b64_tr_b16 a[162:163],v24 offset:384
 v_cvt_pk_bf16_f32 v108,v68,v69
 v_mfma_f32_16x16x32_bf16 v[152:155],a[164:167],v[112:115],0
 v_exp_f32 v71,v71
 v_mfma_f32_16x16x32_bf16 v[156:159],a[164:167],v[120:123],0
 buffer_load_dwordx4 v18,s[24:27],s59 offen offset:2176 lds
 v_mfma_f32_16x16x32_bf16 v[76:79],a[128:131],a[12:15],v[92:95]
 v_exp_f32 v72,v72
 v_mfma_f32_16x16x32_bf16 v[76:79],a[132:135],a[44:47],v[76:79]
 ds_read_b64_tr_b16 a[164:165],v24 offset:160
 v_cvt_pk_bf16_f32 v109,v70,v71
 v_mfma_f32_16x16x32_bf16 v[76:79],a[136:139],a[76:79],v[76:79]
 v_exp_f32 v73,v73
 v_mfma_f32_16x16x32_bf16 v[76:79],a[140:143],a[108:111],v[76:79]
L_w13:
 s_cbranch_execz L_wret0
 ds_read_b128 a[128:131],v20 offset:35072
 s_waitcnt lgkmcnt(4)
 v_mfma_f32_16x16x32_bf16 v[160:163],a[168:171],v[96:99],0
 v_exp_f32 v74,v74
 v_mfma_f32_16x16x32_bf16 v[164:167],a[168:171],v[104:107],0
 ds_read_b64_tr_b16 a[166:167],v24 offset:416
 v_cvt_pk_bf16_f32 v116,v72,v73
 v_mfma_f32_16x16x32_bf16 v[168:171],a[168:171],v[112:115],0
 v_exp_f32 v75,v75
 v_mfma_f32_16x16x32_bf16 v[172:175],a[168:171],v[120:123],0
 buffer_load_dwordx4 v19,s[24:27],s59 offen offset:3264 lds
 v_mfma_f32_16x16x32_bf16 v[64:67],a[144:147],a[0:3],v[80:83]
 v_exp_f32 v76,v76
 v_mfma_f32_16x16x32_bf16 v[64:67],a[148:151],a[32:35],v[64:67]
 ds_read_b64_tr_b16 a[168:169],v24 offset:192
 v_cvt_pk_bf16_f32 v117,v74,v75
 v_mfma_f32_16x16x32_bf16 v[64:67],a[152:155],a[64:67],v[64:67]
 v_exp_f32 v77,v77
 v_mfma_f32_16x16x32_bf16 v[64:67],a[156:159],a[96:99],v[64:67]
 ds_read_b128 a[132:135],v20 offset:35136
 v_accvgpr_write_b32 a180,0
 v_mfma_f32_16x16x32_bf16 v[176:179],a[172:175],v[96:99],0
 v_exp_f32 v78,v78
 v_mfma_f32_16x16x32_bf16 v[180:183],a[172:175],v[104:107],0
 ds_read_b64_tr_b16 a[170:171],v24 offset:448
 v_cvt_pk_bf16_f32 v124,v76,v77
 v_mfma_f32_16x16x32_bf16 v[184:187],a[172:175],v[112:115],0
 v_exp_f32 v79,v79
 v_mfma_f32_16x16x32_bf16 v[188:191],a[172:175],v[120:123],0
 v_accvgpr_write_b32 a181,0
 v_accvgpr_write_b32 a184,0
 v_mfma_f32_16x16x32_bf16 v[68:71],a[144:147],a[4:7],v[84:87]
 v_exp_f32 v64,v64
 v_mfma_f32_16x16x32_bf16 v[68:71],a[148:151],a[36:39],v[68:71]
 ds_read_b64_tr_b16 a[172:173],v24 offset:224
 v_cvt_pk_bf16_f32 v125,v78,v79
 v_mfma_f32_16x16x32_bf16 v[68:71],a[152:155],a[68:71],v[68:71]
 v_exp_f32 v65,v65
 v_mfma_f32_16x16x32_bf16 v[68:71],a[156:159],a[100:103],v[68:71]
 ds_read_b128 a[136:139],v20 offset:35200
 s_waitcnt lgkmcnt(3)
 v_mfma_f32_16x16x32_bf16 v[192:195],a[160:163],v[96:99],0
 v_exp_f32 v66,v66
 v_mfma_f32_16x16x32_bf16 v[196:199],a[160:163],v[104:107],0
 ds_read_b64_tr_b16 a[174:175],v24 offset:480
 v_cvt_pk_bf16_f32 v102,v64,v65
 v_mfma_f32_16x16x32_bf16 v[200:203],a[160:163],v[112:115],0
 v_exp_f32 v67,v67
 v_mfma_f32_16x16x32_bf16 v[204:207],a[160:163],v[120:123],0
 v_accvgpr_write_b32 a185,0
 v_accvgpr_write_b32 a188,0
 v_mfma_f32_16x16x32_bf16 v[72:75],a[144:147],a[8:11],v[88:91]
 v_exp_f32 v68,v68
 v_mfma_f32_16x16x32_bf16 v[72:75],a[148:151],a[40:43],v[72:75]
 ds_read_b64_tr_b16 a[160:161],v24 offset:8768
 v_cvt_pk_bf16_f32 v103,v66,v67
 v_mfma_f32_16x16x32_bf16 v[72:75],a[152:155],a[72:75],v[72:75]
 v_exp_f32 v69,v69
 v_mfma_f32_16x16x32_bf16 v[72:75],a[156:159],a[104:107],v[72:75]
 ds_read_b128 a[140:143],v20 offset:35264
 s_waitcnt vmcnt(12)
 v_mfma_f32_16x16x32_bf16 v[208:211],a[164:167],v[96:99],0
 v_exp_f32 v70,v70
 v_mfma_f32_16x16x32_bf16 v[212:215],a[164:167],v[104:107],0
 ds_read_b64_tr_b16 a[162:163],v24 offset:9024
 v_cvt_pk_bf16_f32 v110,v68,v69
 v_mfma_f32_16x16x32_bf16 v[216:219],a[164:167],v[112:115],0
 v_exp_f32 v71,v71
 v_mfma_f32_16x16x32_bf16 v[220:223],a[164:167],v[120:123],0
 buffer_store_dword v7,off,s[8:11],s70 sc0 sc1
 v_smfmac_f32_16x16x64_bf16 a[176:179],v[60:63],v[96:103],v30
 v_accvgpr_write_b32 a189,0
 v_mfma_f32_16x16x32_bf16 v[76:79],a[144:147],a[12:15],v[92:95]
 v_exp_f32 v72,v72
 v_mfma_f32_16x16x32_bf16 v[76:79],a[148:151],a[44:47],v[76:79]
 ds_read_b64_tr_b16 a[164:165],v24 offset:8800
 v_cvt_pk_bf16_f32 v111,v70,v71
 v_mfma_f32_16x16x32_bf16 v[76:79],a[152:155],a[76:79],v[76:79]
 v_exp_f32 v73,v73
 v_mfma_f32_16x16x32_bf16 v[76:79],a[156:159],a[108:111],v[76:79]
 ds_read_b128 a[144:147],v20 offset:35328
 s_waitcnt lgkmcnt(3)
 v_mfma_f32_16x16x32_bf16 v[224:227],a[168:171],v[96:99],0
 v_exp_f32 v74,v74
 v_mfma_f32_16x16x32_bf16 v[228:231],a[168:171],v[104:107],0
 ds_read_b64_tr_b16 a[166:167],v24 offset:9056
 v_cvt_pk_bf16_f32 v118,v72,v73
 v_mfma_f32_16x16x32_bf16 v[232:235],a[168:171],v[112:115],0
 v_exp_f32 v75,v75
 v_mfma_f32_16x16x32_bf16 v[236:239],a[168:171],v[120:123],0
 v_mul_u32_u24 v3,0x400480,v1
 v_mul_u32_u24 v32,0x801,v1
 v_mfma_f32_16x16x32_bf16 v[64:67],a[128:131],a[0:3],v[80:83]
 v_exp_f32 v76,v76
 v_mfma_f32_16x16x32_bf16 v[64:67],a[132:135],a[32:35],v[64:67]
 ds_read_b64_tr_b16 a[168:169],v24 offset:8832
 v_cvt_pk_bf16_f32 v119,v74,v75
 v_mfma_f32_16x16x32_bf16 v[64:67],a[136:139],a[64:67],v[64:67]
 v_exp_f32 v77,v77
 v_mfma_f32_16x16x32_bf16 v[64:67],a[140:143],a[96:99],v[64:67]
 ds_read_b128 a[148:151],v20 offset:35392
 v_and_b32 v3,0x0f000880,v3
 v_mfma_f32_16x16x32_bf16 v[240:243],a[172:175],v[96:99],0
 v_exp_f32 v78,v78
 v_mfma_f32_16x16x32_bf16 v[244:247],a[172:175],v[104:107],0
 ds_read_b64_tr_b16 a[170:171],v24 offset:9088
 v_cvt_pk_bf16_f32 v126,v76,v77
 v_mfma_f32_16x16x32_bf16 v[248:251],a[172:175],v[112:115],0
 v_exp_f32 v79,v79
 v_mfma_f32_16x16x32_bf16 v[252:255],a[172:175],v[120:123],0
 v_and_b32 v32,0x7830,v32
 s_lshl3_add_u32 s4,s49,7
 v_smfmac_f32_16x16x64_bf16 a[180:183],v[60:63],v[104:111],v30
 v_add_u32 v32,s90,v32
 v_mfma_f32_16x16x32_bf16 v[68:71],a[128:131],a[4:7],v[84:87]
 v_exp_f32 v64,v64
 v_mfma_f32_16x16x32_bf16 v[68:71],a[132:135],a[36:39],v[68:71]
 ds_read_b64_tr_b16 a[172:173],v24 offset:8864
 v_cvt_pk_bf16_f32 v127,v78,v79
 v_mfma_f32_16x16x32_bf16 v[68:71],a[136:139],a[68:71],v[68:71]
 v_exp_f32 v65,v65
 v_mfma_f32_16x16x32_bf16 v[68:71],a[140:143],a[100:103],v[68:71]
 ds_read_b128 a[152:155],v20 offset:35456
 s_waitcnt lgkmcnt(3)
 v_mfma_f32_16x16x32_bf16 v[128:131],a[160:163],v[100:103],v[128:131]
 v_exp_f32 v66,v66
 v_mfma_f32_16x16x32_bf16 v[132:135],a[160:163],v[108:111],v[132:135]
 ds_read_b64_tr_b16 a[174:175],v24 offset:9120
 v_cvt_pk_bf16_f32 v96,v64,v65
 v_mfma_f32_16x16x32_bf16 v[136:139],a[160:163],v[116:119],v[136:139]
 v_exp_f32 v67,v67
 v_mfma_f32_16x16x32_bf16 v[140:143],a[160:163],v[124:127],v[140:143]
 v_lshlrev_b32 v28,s4,1
 v_lshlrev_b32 v29,8,v1
 v_mfma_f32_16x16x32_bf16 v[72:75],a[128:131],a[8:11],v[88:91]
 v_exp_f32 v68,v68
 v_mfma_f32_16x16x32_bf16 v[72:75],a[132:135],a[40:43],v[72:75]
 ds_read_b64_tr_b16 a[160:161],v24 offset:8896
 v_cvt_pk_bf16_f32 v97,v66,v67
 v_mfma_f32_16x16x32_bf16 v[72:75],a[136:139],a[72:75],v[72:75]
 v_exp_f32 v69,v69
 v_mfma_f32_16x16x32_bf16 v[72:75],a[140:143],a[104:107],v[72:75]
 ds_read_b128 a[156:159],v20 offset:35520
 v_mov_b32 v27,0
 v_mfma_f32_16x16x32_bf16 v[144:147],a[164:167],v[100:103],v[144:147]
 v_exp_f32 v70,v70
 v_mfma_f32_16x16x32_bf16 v[148:151],a[164:167],v[108:111],v[148:151]
 ds_read_b64_tr_b16 a[162:163],v24 offset:9152
 v_cvt_pk_bf16_f32 v104,v68,v69
 v_mfma_f32_16x16x32_bf16 v[152:155],a[164:167],v[116:119],v[152:155]
 v_exp_f32 v71,v71
 v_mfma_f32_16x16x32_bf16 v[156:159],a[164:167],v[124:127],v[156:159]
 v_lshlrev_b32 v41,2,v1
 v_accvgpr_write_b32 a16,-1
 v_smfmac_f32_16x16x64_bf16 a[184:187],v[60:63],v[112:119],v30
 v_accvgpr_write_b32 a17,-1
 v_mfma_f32_16x16x32_bf16 v[76:79],a[128:131],a[12:15],v[92:95]
 v_exp_f32 v72,v72
 v_mfma_f32_16x16x32_bf16 v[76:79],a[132:135],a[44:47],v[76:79]
 ds_read_b64_tr_b16 a[164:165],v24 offset:8928
 v_cvt_pk_bf16_f32 v105,v70,v71
 v_mfma_f32_16x16x32_bf16 v[76:79],a[136:139],a[76:79],v[76:79]
 v_exp_f32 v73,v73
 v_mfma_f32_16x16x32_bf16 v[76:79],a[140:143],a[108:111],v[76:79]
 ds_read_b128 a[128:131],v20 offset:35584
 s_waitcnt lgkmcnt(3)
 v_mfma_f32_16x16x32_bf16 v[160:163],a[168:171],v[100:103],v[160:163]
 v_exp_f32 v74,v74
 v_mfma_f32_16x16x32_bf16 v[164:167],a[168:171],v[108:111],v[164:167]
 ds_read_b64_tr_b16 a[166:167],v24 offset:9184
 v_cvt_pk_bf16_f32 v112,v72,v73
 v_mfma_f32_16x16x32_bf16 v[168:171],a[168:171],v[116:119],v[168:171]
 v_exp_f32 v75,v75
 v_mfma_f32_16x16x32_bf16 v[172:175],a[168:171],v[124:127],v[172:175]
 s_add_u32 s59,s59,16384
 v_accvgpr_write_b32 a18,-1
 v_smfmac_f32_16x16x64_bf16 a[188:191],v[60:63],v[120:127],v30
 s_sub_u32 s53,s55,s53
 v_mfma_f32_16x16x32_bf16 v[64:67],a[144:147],a[0:3],v[80:83]
 v_exp_f32 v76,v76
 v_mfma_f32_16x16x32_bf16 v[64:67],a[148:151],a[32:35],v[64:67]
 ds_read_b64_tr_b16 a[168:169],v24 offset:8960
 v_cvt_pk_bf16_f32 v113,v74,v75
 v_mfma_f32_16x16x32_bf16 v[64:67],a[152:155],a[64:67],v[64:67]
 v_exp_f32 v77,v77
 v_mfma_f32_16x16x32_bf16 v[64:67],a[156:159],a[96:99],v[64:67]
 ds_read_b128 a[132:135],v20 offset:35648
 s_add_u32 m0,s53,0
 v_mfma_f32_16x16x32_bf16 v[176:179],a[172:175],v[100:103],v[176:179]
 v_exp_f32 v78,v78
 v_mfma_f32_16x16x32_bf16 v[180:183],a[172:175],v[108:111],v[180:183]
 ds_read_b64_tr_b16 a[170:171],v24 offset:9216
 v_cvt_pk_bf16_f32 v120,v76,v77
 v_mfma_f32_16x16x32_bf16 v[184:187],a[172:175],v[116:119],v[184:187]
 v_exp_f32 v79,v79
 v_mfma_f32_16x16x32_bf16 v[188:191],a[172:175],v[124:127],v[188:191]
 s_barrier
 v_mfma_f32_16x16x32_bf16 v[68:71],a[144:147],a[4:7],v[84:87]
 v_exp_f32 v64,v64
 v_mfma_f32_16x16x32_bf16 v[68:71],a[148:151],a[36:39],v[68:71]
 ds_read_b64_tr_b16 a[172:173],v24 offset:8992
 v_cvt_pk_bf16_f32 v121,v78,v79
 v_mfma_f32_16x16x32_bf16 v[68:71],a[152:155],a[68:71],v[68:71]
 v_exp_f32 v65,v65
 v_mfma_f32_16x16x32_bf16 v[68:71],a[156:159],a[100:103],v[68:71]
 ds_read_b128 a[136:139],v20 offset:35712
 s_waitcnt lgkmcnt(3)
 v_mfma_f32_16x16x32_bf16 v[192:195],a[160:163],v[100:103],v[192:195]
 v_exp_f32 v66,v66
 v_mfma_f32_16x16x32_bf16 v[196:199],a[160:163],v[108:111],v[196:199]
 ds_read_b64_tr_b16 a[174:175],v24 offset:9248
 v_cvt_pk_bf16_f32 v98,v64,v65
 v_mfma_f32_16x16x32_bf16 v[200:203],a[160:163],v[116:119],v[200:203]
 v_exp_f32 v67,v67
 v_mfma_f32_16x16x32_bf16 v[204:207],a[160:163],v[124:127],v[204:207]
 buffer_load_dwordx4 v12,s[20:23],s59 offen offset:0 lds
 v_mfma_f32_16x16x32_bf16 v[72:75],a[144:147],a[8:11],v[88:91]
 v_exp_f32 v68,v68
 v_mfma_f32_16x16x32_bf16 v[72:75],a[148:151],a[40:43],v[72:75]
 ds_read_b64_tr_b16 a[160:161],v24 offset:35072
 v_cvt_pk_bf16_f32 v99,v66,v67
 v_mfma_f32_16x16x32_bf16 v[72:75],a[152:155],a[72:75],v[72:75]
 v_exp_f32 v69,v69
 v_mfma_f32_16x16x32_bf16 v[72:75],a[156:159],a[104:107],v[72:75]
 ds_read_b128 a[140:143],v20 offset:35776
 v_accvgpr_write_b32 a19,-1
 v_mfma_f32_16x16x32_bf16 v[208:211],a[164:167],v[100:103],v[208:211]
 v_exp_f32 v70,v70
 v_mfma_f32_16x16x32_bf16 v[212:215],a[164:167],v[108:111],v[212:215]
 ds_read_b64_tr_b16 a[162:163],v24 offset:35328
 v_cvt_pk_bf16_f32 v106,v68,v69
 v_mfma_f32_16x16x32_bf16 v[216:219],a[164:167],v[116:119],v[216:219]
 v_exp_f32 v71,v71
 v_mfma_f32_16x16x32_bf16 v[220:223],a[164:167],v[124:127],v[220:223]
 buffer_load_dwordx4 v13,s[20:23],s59 offen offset:1040 lds
 v_mfma_f32_16x16x32_bf16 v[76:79],a[144:147],a[12:15],v[92:95]
 v_exp_f32 v72,v72
 v_mfma_f32_16x16x32_bf16 v[76:79],a[148:151],a[44:47],v[76:79]
 ds_read_b64_tr_b16 a[164:165],v24 offset:35104
 v_cvt_pk_bf16_f32 v107,v70,v71
 v_mfma_f32_16x16x32_bf16 v[76:79],a[152:155],a[76:79],v[76:79]
 v_exp_f32 v73,v73
 v_mfma_f32_16x16x32_bf16 v[76:79],a[156:159],a[108:111],v[76:79]
 ds_read_b128 a[144:147],v20 offset:35840
 s_waitcnt lgkmcnt(3)
 v_mfma_f32_16x16x32_bf16 v[224:227],a[168:171],v[100:103],v[224:227]
 v_exp_f32 v74,v74
 v_mfma_f32_16x16x32_bf16 v[228:231],a[168:171],v[108:111],v[228:231]
 ds_read_b64_tr_b16 a[166:167],v24 offset:35360
 v_cvt_pk_bf16_f32 v114,v72,v73
 v_mfma_f32_16x16x32_bf16 v[232:235],a[168:171],v[116:119],v[232:235]
 v_exp_f32 v75,v75
 v_mfma_f32_16x16x32_bf16 v[236:239],a[168:171],v[124:127],v[236:239]
 buffer_load_dwordx4 v14,s[20:23],s59 offen offset:2080 lds
 v_mfma_f32_16x16x32_bf16 v[64:67],a[128:131],a[0:3],v[80:83]
 v_exp_f32 v76,v76
 v_mfma_f32_16x16x32_bf16 v[64:67],a[132:135],a[32:35],v[64:67]
 ds_read_b64_tr_b16 a[168:169],v24 offset:35136
 v_cvt_pk_bf16_f32 v115,v74,v75
 v_mfma_f32_16x16x32_bf16 v[64:67],a[136:139],a[64:67],v[64:67]
 v_exp_f32 v77,v77
 v_mfma_f32_16x16x32_bf16 v[64:67],a[140:143],a[96:99],v[64:67]
 ds_read_b128 a[148:151],v20 offset:35904
 s_mov_b32 s3,0
 v_mfma_f32_16x16x32_bf16 v[240:243],a[172:175],v[100:103],v[240:243]
 v_exp_f32 v78,v78
 v_mfma_f32_16x16x32_bf16 v[244:247],a[172:175],v[108:111],v[244:247]
 ds_read_b64_tr_b16 a[170:171],v24 offset:35392
 v_cvt_pk_bf16_f32 v122,v76,v77
 v_mfma_f32_16x16x32_bf16 v[248:251],a[172:175],v[116:119],v[248:251]
 v_exp_f32 v79,v79
 v_mfma_f32_16x16x32_bf16 v[252:255],a[172:175],v[124:127],v[252:255]
 buffer_load_dwordx4 v15,s[20:23],s59 offen offset:3120 lds
 v_mfma_f32_16x16x32_bf16 v[68:71],a[128:131],a[4:7],v[84:87]
 v_exp_f32 v64,v64
 v_mfma_f32_16x16x32_bf16 v[68:71],a[132:135],a[36:39],v[68:71]
 ds_read_b64_tr_b16 a[172:173],v24 offset:35168
 v_cvt_pk_bf16_f32 v123,v78,v79
 v_mfma_f32_16x16x32_bf16 v[68:71],a[136:139],a[68:71],v[68:71]
 v_exp_f32 v65,v65
 v_mfma_f32_16x16x32_bf16 v[68:71],a[140:143],a[100:103],v[68:71]
 ds_read_b128 a[152:155],v20 offset:35968
 s_waitcnt lgkmcnt(3)
 v_mfma_f32_16x16x32_bf16 v[128:131],a[160:163],v[96:99],v[128:131]
 v_exp_f32 v66,v66
 v_mfma_f32_16x16x32_bf16 v[132:135],a[160:163],v[104:107],v[132:135]
 ds_read_b64_tr_b16 a[174:175],v24 offset:35424
 v_cvt_pk_bf16_f32 v100,v64,v65
 v_mfma_f32_16x16x32_bf16 v[136:139],a[160:163],v[112:115],v[136:139]
 v_exp_f32 v67,v67
 v_mfma_f32_16x16x32_bf16 v[140:143],a[160:163],v[120:123],v[140:143]
 buffer_load_dwordx4 v[44:47],v32,s[36:39],s3 offen
 v_mfma_f32_16x16x32_bf16 v[72:75],a[128:131],a[8:11],v[88:91]
 v_exp_f32 v68,v68
 v_mfma_f32_16x16x32_bf16 v[72:75],a[132:135],a[40:43],v[72:75]
 ds_read_b64_tr_b16 a[160:161],v24 offset:35200
 v_cvt_pk_bf16_f32 v101,v66,v67
 v_mfma_f32_16x16x32_bf16 v[72:75],a[136:139],a[72:75],v[72:75]
 v_exp_f32 v69,v69
 v_mfma_f32_16x16x32_bf16 v[72:75],a[140:143],a[104:107],v[72:75]
 ds_read_b128 a[156:159],v20 offset:36032
 v_sub_u32 v20,v25,v20
 v_mfma_f32_16x16x32_bf16 v[144:147],a[164:167],v[96:99],v[144:147]
 v_exp_f32 v70,v70
 v_mfma_f32_16x16x32_bf16 v[148:151],a[164:167],v[104:107],v[148:151]
 ds_read_b64_tr_b16 a[162:163],v24 offset:35456
 v_cvt_pk_bf16_f32 v108,v68,v69
 v_mfma_f32_16x16x32_bf16 v[152:155],a[164:167],v[112:115],v[152:155]
 v_exp_f32 v71,v71
 v_mfma_f32_16x16x32_bf16 v[156:159],a[164:167],v[120:123],v[156:159]
 buffer_load_dword v31,v3,s[32:35],s97 offen
 v_mfma_f32_16x16x32_bf16 v[76:79],a[128:131],a[12:15],v[92:95]
 v_exp_f32 v72,v72
 v_mfma_f32_16x16x32_bf16 v[76:79],a[132:135],a[44:47],v[76:79]
 ds_read_b64_tr_b16 a[164:165],v24 offset:35232
 v_cvt_pk_bf16_f32 v109,v70,v71
 v_mfma_f32_16x16x32_bf16 v[76:79],a[136:139],a[76:79],v[76:79]
 v_exp_f32 v73,v73
 v_mfma_f32_16x16x32_bf16 v[76:79],a[140:143],a[108:111],v[76:79]
 ds_read_b128 a[128:131],v20 offset:0
 s_waitcnt lgkmcnt(3)
 v_mfma_f32_16x16x32_bf16 v[160:163],a[168:171],v[96:99],v[160:163]
 v_exp_f32 v74,v74
 v_mfma_f32_16x16x32_bf16 v[164:167],a[168:171],v[104:107],v[164:167]
 ds_read_b64_tr_b16 a[166:167],v24 offset:35488
 v_cvt_pk_bf16_f32 v116,v72,v73
 v_mfma_f32_16x16x32_bf16 v[168:171],a[168:171],v[112:115],v[168:171]
 v_exp_f32 v75,v75
 v_mfma_f32_16x16x32_bf16 v[172:175],a[168:171],v[120:123],v[172:175]
 s_add_u32 s97,s97,131072
 v_and_b32 v8,0xff,v12
 v_mfma_f32_16x16x32_bf16 v[64:67],a[144:147],a[0:3],v[80:83]
 v_exp_f32 v76,v76
 v_mfma_f32_16x16x32_bf16 v[64:67],a[148:151],a[32:35],v[64:67]
 ds_read_b64_tr_b16 a[168:169],v24 offset:35264
 v_cvt_pk_bf16_f32 v117,v74,v75
 v_mfma_f32_16x16x32_bf16 v[64:67],a[152:155],a[64:67],v[64:67]
 v_exp_f32 v77,v77
 v_mfma_f32_16x16x32_bf16 v[64:67],a[156:159],a[96:99],v[64:67]
 ds_read_b128 a[132:135],v20 offset:64
 v_xor_b32 v8,s89,v8
 v_mfma_f32_16x16x32_bf16 v[176:179],a[172:175],v[96:99],v[176:179]
 v_exp_f32 v78,v78
 v_mfma_f32_16x16x32_bf16 v[180:183],a[172:175],v[104:107],v[180:183]
 ds_read_b64_tr_b16 a[170:171],v24 offset:35520
 v_cvt_pk_bf16_f32 v124,v76,v77
 v_mfma_f32_16x16x32_bf16 v[184:187],a[172:175],v[112:115],v[184:187]
 v_exp_f32 v79,v79
 v_mfma_f32_16x16x32_bf16 v[188:191],a[172:175],v[120:123],v[188:191]
 buffer_load_dword v31,v3,s[32:35],s97 offen
 v_mfma_f32_16x16x32_bf16 v[68:71],a[144:147],a[4:7],v[84:87]
 v_exp_f32 v64,v64
 v_mfma_f32_16x16x32_bf16 v[68:71],a[148:151],a[36:39],v[68:71]
 ds_read_b64_tr_b16 a[172:173],v24 offset:35296
 v_cvt_pk_bf16_f32 v125,v78,v79
 v_mfma_f32_16x16x32_bf16 v[68:71],a[152:155],a[68:71],v[68:71]
 v_exp_f32 v65,v65
 v_mfma_f32_16x16x32_bf16 v[68:71],a[156:159],a[100:103],v[68:71]
 ds_read_b128 a[136:139],v20 offset:128
 s_waitcnt lgkmcnt(3)
 v_mfma_f32_16x16x32_bf16 v[192:195],a[160:163],v[96:99],v[192:195]
 v_exp_f32 v66,v66
 v_mfma_f32_16x16x32_bf16 v[196:199],a[160:163],v[104:107],v[196:199]
 ds_read_b64_tr_b16 a[174:175],v24 offset:35552
 v_cvt_pk_bf16_f32 v102,v64,v65
 v_mfma_f32_16x16x32_bf16 v[200:203],a[160:163],v[112:115],v[200:203]
 v_exp_f32 v67,v67
 v_mfma_f32_16x16x32_bf16 v[204:207],a[160:163],v[120:123],v[204:207]
 s_add_u32 s97,s97,131072
 v_lshrrev_b32 v2,4,v1
 v_mfma_f32_16x16x32_bf16 v[72:75],a[144:147],a[8:11],v[88:91]
 v_exp_f32 v68,v68
 v_mfma_f32_16x16x32_bf16 v[72:75],a[148:151],a[40:43],v[72:75]
 ds_read_b64_tr_b16 a[160:161],v24 offset:43840
 v_cvt_pk_bf16_f32 v103,v66,v67
 v_mfma_f32_16x16x32_bf16 v[72:75],a[152:155],a[72:75],v[72:75]
 v_exp_f32 v69,v69
 v_mfma_f32_16x16x32_bf16 v[72:75],a[156:159],a[104:107],v[72:75]
 ds_read_b128 a[140:143],v20 offset:192
 s_mov_b32 s3,32768
 v_mfma_f32_16x16x32_bf16 v[208:211],a[164:167],v[96:99],v[208:211]
 v_exp_f32 v70,v70
 v_mfma_f32_16x16x32_bf16 v[212:215],a[164:167],v[104:107],v[212:215]
 ds_read_b64_tr_b16 a[162:163],v24 offset:44096
 v_cvt_pk_bf16_f32 v110,v68,v69
 v_mfma_f32_16x16x32_bf16 v[216:219],a[164:167],v[112:115],v[216:219]
 v_exp_f32 v71,v71
 v_mfma_f32_16x16x32_bf16 v[220:223],a[164:167],v[120:123],v[220:223]
 buffer_load_dword v31,v3,s[28:31],s96 offen
 v_smfmac_f32_16x16x64_bf16 a[176:179],v[60:63],v[96:103],v30
 s_add_u32 s96,s96,131072
 v_mfma_f32_16x16x32_bf16 v[76:79],a[144:147],a[12:15],v[92:95]
 v_exp_f32 v72,v72
 v_mfma_f32_16x16x32_bf16 v[76:79],a[148:151],a[44:47],v[76:79]
 ds_read_b64_tr_b16 a[164:165],v24 offset:43872
 v_cvt_pk_bf16_f32 v111,v70,v71
 v_mfma_f32_16x16x32_bf16 v[76:79],a[152:155],a[76:79],v[76:79]
 v_exp_f32 v73,v73
 v_mfma_f32_16x16x32_bf16 v[76:79],a[156:159],a[108:111],v[76:79]
 ds_read_b128 a[144:147],v20 offset:256
 s_waitcnt lgkmcnt(3)
 v_mfma_f32_16x16x32_bf16 v[224:227],a[168:171],v[96:99],v[224:227]
 v_exp_f32 v74,v74
 v_mfma_f32_16x16x32_bf16 v[228:231],a[168:171],v[104:107],v[228:231]
 ds_read_b64_tr_b16 a[166:167],v24 offset:44128
 v_cvt_pk_bf16_f32 v118,v72,v73
 v_mfma_f32_16x16x32_bf16 v[232:235],a[168:171],v[112:115],v[232:235]
 v_exp_f32 v75,v75
 v_mfma_f32_16x16x32_bf16 v[236:239],a[168:171],v[120:123],v[236:239]
 buffer_load_dwordx4 v[48:51],v32,s[36:39],s3 offen
 v_mfma_f32_16x16x32_bf16 v[64:67],a[128:131],a[0:3],v[80:83]
 v_exp_f32 v76,v76
 v_mfma_f32_16x16x32_bf16 v[64:67],a[132:135],a[32:35],v[64:67]
 ds_read_b64_tr_b16 a[168:169],v24 offset:43904
 v_cvt_pk_bf16_f32 v119,v74,v75
 v_mfma_f32_16x16x32_bf16 v[64:67],a[136:139],a[64:67],v[64:67]
 v_exp_f32 v77,v77
 v_mfma_f32_16x16x32_bf16 v[64:67],a[140:143],a[96:99],v[64:67]
 ds_read_b128 a[148:151],v20 offset:320
 s_mov_b32 s3,65536
 v_mfma_f32_16x16x32_bf16 v[240:243],a[172:175],v[96:99],v[240:243]
 v_exp_f32 v78,v78
 v_mfma_f32_16x16x32_bf16 v[244:247],a[172:175],v[104:107],v[244:247]
 ds_read_b64_tr_b16 a[170:171],v24 offset:44160
 v_cvt_pk_bf16_f32 v126,v76,v77
 v_mfma_f32_16x16x32_bf16 v[248:251],a[172:175],v[112:115],v[248:251]
 v_exp_f32 v79,v79
 v_mfma_f32_16x16x32_bf16 v[252:255],a[172:175],v[120:123],v[252:255]
 buffer_load_dword v31,v3,s[32:35],s97 offen
 v_smfmac_f32_16x16x64_bf16 a[180:183],v[60:63],v[104:111],v30
 s_add_u32 s97,s97,131072
 v_mfma_f32_16x16x32_bf16 v[68:71],a[128:131],a[4:7],v[84:87]
 v_exp_f32 v64,v64
 v_mfma_f32_16x16x32_bf16 v[68:71],a[132:135],a[36:39],v[68:71]
 ds_read_b64_tr_b16 a[172:173],v24 offset:43936
 v_cvt_pk_bf16_f32 v127,v78,v79
 v_mfma_f32_16x16x32_bf16 v[68:71],a[136:139],a[68:71],v[68:71]
 v_exp_f32 v65,v65
 v_mfma_f32_16x16x32_bf16 v[68:71],a[140:143],a[100:103],v[68:71]
 ds_read_b128 a[152:155],v20 offset:384
 s_waitcnt lgkmcnt(3)
 v_mfma_f32_16x16x32_bf16 v[128:131],a[160:163],v[100:103],v[128:131]
 v_exp_f32 v66,v66
 v_mfma_f32_16x16x32_bf16 v[132:135],a[160:163],v[108:111],v[132:135]
 ds_read_b64_tr_b16 a[174:175],v24 offset:44192
 v_cvt_pk_bf16_f32 v96,v64,v65
 v_mfma_f32_16x16x32_bf16 v[136:139],a[160:163],v[116:119],v[136:139]
 v_exp_f32 v67,v67
 v_mfma_f32_16x16x32_bf16 v[140:143],a[160:163],v[124:127],v[140:143]
 buffer_load_dwordx4 v[52:55],v32,s[36:39],s3 offen
 v_mfma_f32_16x16x32_bf16 v[72:75],a[128:131],a[8:11],v[88:91]
 v_exp_f32 v68,v68
 v_mfma_f32_16x16x32_bf16 v[72:75],a[132:135],a[40:43],v[72:75]
 ds_read_b64_tr_b16 a[160:161],v24 offset:43968
 v_cvt_pk_bf16_f32 v97,v66,v67
 v_mfma_f32_16x16x32_bf16 v[72:75],a[136:139],a[72:75],v[72:75]
 v_exp_f32 v69,v69
 v_mfma_f32_16x16x32_bf16 v[72:75],a[140:143],a[104:107],v[72:75]
 ds_read_b128 a[156:159],v20 offset:448
 s_mov_b32 s3,98304
 v_mfma_f32_16x16x32_bf16 v[144:147],a[164:167],v[100:103],v[144:147]
 v_exp_f32 v70,v70
 v_mfma_f32_16x16x32_bf16 v[148:151],a[164:167],v[108:111],v[148:151]
 ds_read_b64_tr_b16 a[162:163],v24 offset:44224
 v_cvt_pk_bf16_f32 v104,v68,v69
 v_mfma_f32_16x16x32_bf16 v[152:155],a[164:167],v[116:119],v[152:155]
 v_exp_f32 v71,v71
 v_mfma_f32_16x16x32_bf16 v[156:159],a[164:167],v[124:127],v[156:159]
 buffer_load_dwordx4 v[56:59],v32,s[36:39],s3 offen
 v_smfmac_f32_16x16x64_bf16 a[184:187],v[60:63],v[112:119],v30
 v_lshl_add_u32 v8,v2,14,v8
 v_mfma_f32_16x16x32_bf16 v[76:79],a[128:131],a[12:15],v[92:95]
 v_exp_f32 v72,v72
 v_mfma_f32_16x16x32_bf16 v[76:79],a[132:135],a[44:47],v[76:79]
 ds_read_b64_tr_b16 a[164:165],v24 offset:44000
 v_cvt_pk_bf16_f32 v105,v70,v71
 v_mfma_f32_16x16x32_bf16 v[76:79],a[136:139],a[76:79],v[76:79]
 v_exp_f32 v73,v73
 v_mfma_f32_16x16x32_bf16 v[76:79],a[140:143],a[108:111],v[76:79]
 ds_read_b128 a[128:131],v20 offset:512
 s_waitcnt lgkmcnt(3)
 v_mfma_f32_16x16x32_bf16 v[160:163],a[168:171],v[100:103],v[160:163]
 v_exp_f32 v74,v74
 v_mfma_f32_16x16x32_bf16 v[164:167],a[168:171],v[108:111],v[164:167]
 ds_read_b64_tr_b16 a[166:167],v24 offset:44256
 v_cvt_pk_bf16_f32 v112,v72,v73
 v_mfma_f32_16x16x32_bf16 v[168:171],a[168:171],v[116:119],v[168:171]
 v_exp_f32 v75,v75
 v_mfma_f32_16x16x32_bf16 v[172:175],a[168:171],v[124:127],v[172:175]
 buffer_atomic_or v28,v29,s[44:47],s99 offen sc1
 v_smfmac_f32_16x16x64_bf16 a[188:191],v[60:63],v[120:127],v30
 v_add_u32 v8,s87,v8
 v_mfma_f32_16x16x32_bf16 v[64:67],a[144:147],a[0:3],v[80:83]
 v_exp_f32 v76,v76
 v_mfma_f32_16x16x32_bf16 v[64:67],a[148:151],a[32:35],v[64:67]
 ds_read_b64_tr_b16 a[168:169],v24 offset:44032
 v_cvt_pk_bf16_f32 v113,v74,v75
 v_mfma_f32_16x16x32_bf16 v[64:67],a[152:155],a[64:67],v[64:67]
 v_exp_f32 v77,v77
 v_mfma_f32_16x16x32_bf16 v[64:67],a[156:159],a[96:99],v[64:67]
 ds_read_b128 a[132:135],v20 offset:576
 v_add_u32 v9,960,v8
 v_mfma_f32_16x16x32_bf16 v[176:179],a[172:175],v[100:103],v[176:179]
 v_exp_f32 v78,v78
 v_mfma_f32_16x16x32_bf16 v[180:183],a[172:175],v[108:111],v[180:183]
 ds_read_b64_tr_b16 a[170:171],v24 offset:44288
 v_cvt_pk_bf16_f32 v120,v76,v77
 v_mfma_f32_16x16x32_bf16 v[184:187],a[172:175],v[116:119],v[184:187]
 v_exp_f32 v79,v79
 v_mfma_f32_16x16x32_bf16 v[188:191],a[172:175],v[124:127],v[188:191]
 s_waitcnt vmcnt(18)
 s_barrier
 v_mfma_f32_16x16x32_bf16 v[68:71],a[144:147],a[4:7],v[84:87]
 v_exp_f32 v64,v64
 v_mfma_f32_16x16x32_bf16 v[68:71],a[148:151],a[36:39],v[68:71]
 ds_read_b64_tr_b16 a[172:173],v24 offset:44064
 v_cvt_pk_bf16_f32 v121,v78,v79
 v_mfma_f32_16x16x32_bf16 v[68:71],a[152:155],a[68:71],v[68:71]
 v_exp_f32 v65,v65
 v_mfma_f32_16x16x32_bf16 v[68:71],a[156:159],a[100:103],v[68:71]
 ds_read_b128 a[136:139],v20 offset:640
 s_waitcnt lgkmcnt(3)
 v_mfma_f32_16x16x32_bf16 v[192:195],a[160:163],v[100:103],v[192:195]
 v_exp_f32 v66,v66
 v_mfma_f32_16x16x32_bf16 v[196:199],a[160:163],v[108:111],v[196:199]
 ds_read_b64_tr_b16 a[174:175],v24 offset:44320
 v_cvt_pk_bf16_f32 v98,v64,v65
 v_mfma_f32_16x16x32_bf16 v[200:203],a[160:163],v[116:119],v[200:203]
 v_exp_f32 v67,v67
 v_mfma_f32_16x16x32_bf16 v[204:207],a[160:163],v[124:127],v[204:207]
 v_sub_u32 v24,v26,v24
 s_sub_u32 s54,s56,s54
 s_mov_b64 exec,0
 s_cmp_eq_u32 s48,0
 s_cbranch_scc1 L_w16
 s_cmp_eq_u32 s48,1
 s_cbranch_scc1 L_w17
 s_cmp_eq_u32 s48,2
 s_cbranch_scc1 L_w19
 s_branch L_w20
L_wret1:
 s_mov_b64 exec,-1
 v_mfma_f32_16x16x32_bf16 v[72:75],a[144:147],a[8:11],v[88:91]
 v_exp_f32 v68,v68
 v_mfma_f32_16x16x32_bf16 v[72:75],a[148:151],a[40:43],v[72:75]
 ds_read_b64_tr_b16 a[160:161],v24 offset:0
 v_cvt_pk_bf16_f32 v99,v66,v67
 v_mfma_f32_16x16x32_bf16 v[72:75],a[152:155],a[72:75],v[72:75]
 v_exp_f32 v69,v69
 v_mfma_f32_16x16x32_bf16 v[72:75],a[156:159],a[104:107],v[72:75]
 ds_read_b128 a[140:143],v20 offset:704
 s_add_u32 m0,s54,0
 v_mfma_f32_16x16x32_bf16 v[208:211],a[164:167],v[100:103],v[208:211]
 v_exp_f32 v70,v70
 v_mfma_f32_16x16x32_bf16 v[212:215],a[164:167],v[108:111],v[212:215]
 ds_read_b64_tr_b16 a[162:163],v24 offset:256
 v_cvt_pk_bf16_f32 v106,v68,v69
 v_mfma_f32_16x16x32_bf16 v[216:219],a[164:167],v[116:119],v[216:219]
 v_exp_f32 v71,v71
 v_mfma_f32_16x16x32_bf16 v[220:223],a[164:167],v[124:127],v[220:223]
 buffer_load_dwordx4 v16,s[24:27],s59 offen offset:0 lds
 v_mfma_f32_16x16x32_bf16 v[76:79],a[144:147],a[12:15],v[92:95]
 v_exp_f32 v72,v72
 v_mfma_f32_16x16x32_bf16 v[76:79],a[148:151],a[44:47],v[76:79]
 ds_read_b64_tr_b16 a[164:165],v24 offset:32
 v_cvt_pk_bf16_f32 v107,v70,v71
 v_mfma_f32_16x16x32_bf16 v[76:79],a[152:155],a[76:79],v[76:79]
 v_exp_f32 v73,v73
 v_mfma_f32_16x16x32_bf16 v[76:79],a[156:159],a[108:111],v[76:79]
 ds_read_b128 a[144:147],v20 offset:768
 s_waitcnt lgkmcnt(3)
 v_mfma_f32_16x16x32_bf16 v[224:227],a[168:171],v[100:103],v[224:227]
 v_exp_f32 v74,v74
 v_mfma_f32_16x16x32_bf16 v[228:231],a[168:171],v[108:111],v[228:231]
 ds_read_b64_tr_b16 a[166:167],v24 offset:288
 v_cvt_pk_bf16_f32 v114,v72,v73
 v_mfma_f32_16x16x32_bf16 v[232:235],a[168:171],v[116:119],v[232:235]
 v_exp_f32 v75,v75
 v_mfma_f32_16x16x32_bf16 v[236:239],a[168:171],v[124:127],v[236:239]
 buffer_load_dwordx4 v17,s[24:27],s59 offen offset:1088 lds
 v_mfma_f32_16x16x32_bf16 v[64:67],a[128:131],a[0:3],v[80:83]
 v_exp_f32 v76,v76
 v_mfma_f32_16x16x32_bf16 v[64:67],a[132:135],a[32:35],v[64:67]
 ds_read_b64_tr_b16 a[168:169],v24 offset:64
 v_cvt_pk_bf16_f32 v115,v74,v75
 v_mfma_f32_16x16x32_bf16 v[64:67],a[136:139],a[64:67],v[64:67]
 v_exp_f32 v77,v77
 v_mfma_f32_16x16x32_bf16 v[64:67],a[140:143],a[96:99],v[64:67]
 ds_read_b128 a[148:151],v20 offset:832
 v_add_u32 v10,1920,v8
 v_add_u32 v11,2880,v8
 v_and_b32 v34,31,v1
L_w14:
 s_cbranch_execz L_wret0
 v_lshlrev_b32 v34,2,v34
 v_add_u32 v34,s91,v34
 s_lshr_b32 s4,s49,3
 s_lshl2_add_u32 s4,s4,s48
 s_lshl_b32 s4,s4,7
 v_min_u32 v2,2,v1
 v_lshl_add_u32 v2,v2,14,s4
 s_getpc_b64 s[6:7]
L_pc2:
 s_add_u32 s6,s6,L_rare-L_pc2-49152
 s_addc_u32 s7,s7,0
 s_lshl_b32 s66,s89,14
 s_and_b32 s67,s97,0x1ffff
 s_add_u32 s66,s66,s67
 s_add_u32 s66,s66,3145728
 v_mfma_f32_16x16x32_bf16 v[240:243],a[172:175],v[100:103],v[240:243]
 v_exp_f32 v78,v78
 v_mfma_f32_16x16x32_bf16 v[244:247],a[172:175],v[108:111],v[244:247]
 ds_read_b64_tr_b16 a[170:171],v24 offset:320
 v_cvt_pk_bf16_f32 v122,v76,v77
 v_mfma_f32_16x16x32_bf16 v[248:251],a[172:175],v[116:119],v[248:251]
 v_exp_f32 v79,v79
 v_mfma_f32_16x16x32_bf16 v[252:255],a[172:175],v[124:127],v[252:255]
L_aloop:
 v_mfma_f32_16x16x32_bf16 v[68:71],a[128:131],a[4:7],v[84:87]
 v_exp_f32 v64,v64
 v_mfma_f32_16x16x32_bf16 v[68:71],a[132:135],a[36:39],v[68:71]
 ds_read_b64_tr_b16 a[172:173],v24 offset:96
 v_cvt_pk_bf16_f32 v123,v78,v79
 v_mfma_f32_16x16x32_bf16 v[68:71],a[136:139],a[68:71],v[68:71]
 v_exp_f32 v65,v65
 v_mfma_f32_16x16x32_bf16 v[68:71],a[140:143],a[100:103],v[68:71]
 ds_read_b128 a[152:155],v20 offset:896
 s_waitcnt lgkmcnt(3)
 v_mfma_f32_16x16x32_bf16 v[128:131],a[160:163],v[96:99],v[128:131]
 v_exp_f32 v66,v66
 v_mfma_f32_16x16x32_bf16 v[132:135],a[160:163],v[104:107],v[132:135]
 ds_read_b64_tr_b16 a[174:175],v24 offset:352
 v_cvt_pk_bf16_f32 v100,v64,v65
 v_mfma_f32_16x16x32_bf16 v[136:139],a[160:163],v[112:115],v[136:139]
 v_exp_f32 v67,v67
 v_mfma_f32_16x16x32_bf16 v[140:143],a[160:163],v[120:123],v[140:143]
 buffer_store_dword v27,off,s[8:11],s81 sc0 sc1
 v_mfma_f32_16x16x32_bf16 v[72:75],a[128:131],a[8:11],v[88:91]
 v_exp_f32 v68,v68
 v_mfma_f32_16x16x32_bf16 v[72:75],a[132:135],a[40:43],v[72:75]
 ds_read_b64_tr_b16 a[160:161],v24 offset:128
 v_cvt_pk_bf16_f32 v101,v66,v67
 v_mfma_f32_16x16x32_bf16 v[72:75],a[136:139],a[72:75],v[72:75]
 v_exp_f32 v69,v69
 v_mfma_f32_16x16x32_bf16 v[72:75],a[140:143],a[104:107],v[72:75]
 ds_read_b128 a[156:159],v20 offset:960
 v_add_u32 v27,1,v27
 v_mfma_f32_16x16x32_bf16 v[144:147],a[164:167],v[96:99],v[144:147]
 v_exp_f32 v70,v70
 v_mfma_f32_16x16x32_bf16 v[148:151],a[164:167],v[104:107],v[148:151]
 ds_read_b64_tr_b16 a[162:163],v24 offset:384
 v_cvt_pk_bf16_f32 v108,v68,v69
 v_mfma_f32_16x16x32_bf16 v[152:155],a[164:167],v[112:115],v[152:155]
 v_exp_f32 v71,v71
 v_mfma_f32_16x16x32_bf16 v[156:159],a[164:167],v[120:123],v[156:159]
 buffer_load_dwordx4 v18,s[24:27],s59 offen offset:2176 lds
 v_mfma_f32_16x16x32_bf16 v[76:79],a[128:131],a[12:15],v[92:95]
 v_exp_f32 v72,v72
 v_mfma_f32_16x16x32_bf16 v[76:79],a[132:135],a[44:47],v[76:79]
 ds_read_b64_tr_b16 a[164:165],v24 offset:160
 v_cvt_pk_bf16_f32 v109,v70,v71
 v_mfma_f32_16x16x32_bf16 v[76:79],a[136:139],a[76:79],v[76:79]
 v_exp_f32 v73,v73
 v_mfma_f32_16x16x32_bf16 v[76:79],a[140:143],a[108:111],v[76:79]
 ds_read_b128 a[128:131],v20 offset:35072
 s_waitcnt lgkmcnt(3)
 v_mfma_f32_16x16x32_bf16 v[160:163],a[168:171],v[96:99],v[160:163]
 v_exp_f32 v74,v74
 v_mfma_f32_16x16x32_bf16 v[164:167],a[168:171],v[104:107],v[164:167]
 ds_read_b64_tr_b16 a[166:167],v24 offset:416
 v_cvt_pk_bf16_f32 v116,v72,v73
 v_mfma_f32_16x16x32_bf16 v[168:171],a[168:171],v[112:115],v[168:171]
 v_exp_f32 v75,v75
 v_mfma_f32_16x16x32_bf16 v[172:175],a[168:171],v[120:123],v[172:175]
 buffer_load_dwordx4 v19,s[24:27],s59 offen offset:3264 lds
 v_mfma_f32_16x16x32_bf16 v[64:67],a[144:147],a[0:3],v[80:83]
 v_exp_f32 v76,v76
 v_mfma_f32_16x16x32_bf16 v[64:67],a[148:151],a[32:35],v[64:67]
 ds_read_b64_tr_b16 a[168:169],v24 offset:192
 v_cvt_pk_bf16_f32 v117,v74,v75
 v_mfma_f32_16x16x32_bf16 v[64:67],a[152:155],a[64:67],v[64:67]
 v_exp_f32 v77,v77
 v_mfma_f32_16x16x32_bf16 v[64:67],a[156:159],a[96:99],v[64:67]
 ds_read_b128 a[132:135],v20 offset:35136
 v_mfma_f32_16x16x32_bf16 v[176:179],a[172:175],v[96:99],v[176:179]
 v_exp_f32 v78,v78
 v_mfma_f32_16x16x32_bf16 v[180:183],a[172:175],v[104:107],v[180:183]
 ds_read_b64_tr_b16 a[170:171],v24 offset:448
 v_cvt_pk_bf16_f32 v124,v76,v77
 v_mfma_f32_16x16x32_bf16 v[184:187],a[172:175],v[112:115],v[184:187]
 v_exp_f32 v79,v79
 v_mfma_f32_16x16x32_bf16 v[188:191],a[172:175],v[120:123],v[188:191]
 s_add_u32 s59,s59,16384
 s_add_u32 m0,s53,35072
 v_mfma_f32_16x16x32_bf16 v[68:71],a[144:147],a[4:7],v[84:87]
 v_exp_f32 v64,v64
 v_mfma_f32_16x16x32_bf16 v[68:71],a[148:151],a[36:39],v[68:71]
 ds_read_b64_tr_b16 a[172:173],v24 offset:224
 v_cvt_pk_bf16_f32 v125,v78,v79
 v_mfma_f32_16x16x32_bf16 v[68:71],a[152:155],a[68:71],v[68:71]
 v_exp_f32 v65,v65
 v_mfma_f32_16x16x32_bf16 v[68:71],a[156:159],a[100:103],v[68:71]
 ds_read_b128 a[136:139],v20 offset:35200
 s_waitcnt lgkmcnt(3)
 v_mfma_f32_16x16x32_bf16 v[192:195],a[160:163],v[96:99],v[192:195]
 v_exp_f32 v66,v66
 v_mfma_f32_16x16x32_bf16 v[196:199],a[160:163],v[104:107],v[196:199]
 ds_read_b64_tr_b16 a[174:175],v24 offset:480
 v_cvt_pk_bf16_f32 v102,v64,v65
 v_mfma_f32_16x16x32_bf16 v[200:203],a[160:163],v[112:115],v[200:203]
 v_exp_f32 v67,v67
 v_mfma_f32_16x16x32_bf16 v[204:207],a[160:163],v[120:123],v[204:207]
 buffer_load_dwordx4 v12,s[20:23],s59 offen offset:0 lds
 v_mfma_f32_16x16x32_bf16 v[72:75],a[144:147],a[8:11],v[88:91]
 v_exp_f32 v68,v68
 v_mfma_f32_16x16x32_bf16 v[72:75],a[148:151],a[40:43],v[72:75]
 ds_read_b64_tr_b16 a[160:161],v24 offset:8768
 v_cvt_pk_bf16_f32 v103,v66,v67
 v_mfma_f32_16x16x32_bf16 v[72:75],a[152:155],a[72:75],v[72:75]
 v_exp_f32 v69,v69
 v_mfma_f32_16x16x32_bf16 v[72:75],a[156:159],a[104:107],v[72:75]
 ds_read_b128 a[140:143],v20 offset:35264
 v_mfma_f32_16x16x32_bf16 v[208:211],a[164:167],v[96:99],v[208:211]
 v_exp_f32 v70,v70
 v_mfma_f32_16x16x32_bf16 v[212:215],a[164:167],v[104:107],v[212:215]
 ds_read_b64_tr_b16 a[162:163],v24 offset:9024
 v_cvt_pk_bf16_f32 v110,v68,v69
 v_mfma_f32_16x16x32_bf16 v[216:219],a[164:167],v[112:115],v[216:219]
 v_exp_f32 v71,v71
 v_mfma_f32_16x16x32_bf16 v[220:223],a[164:167],v[120:123],v[220:223]
 buffer_load_dwordx4 v13,s[20:23],s59 offen offset:1040 lds
 v_smfmac_f32_16x16x64_bf16 a[176:179],v[60:63],v[96:103],v30
 v_mfma_f32_16x16x32_bf16 v[76:79],a[144:147],a[12:15],v[92:95]
 v_exp_f32 v72,v72
 v_mfma_f32_16x16x32_bf16 v[76:79],a[148:151],a[44:47],v[76:79]
 ds_read_b64_tr_b16 a[164:165],v24 offset:8800
 v_cvt_pk_bf16_f32 v111,v70,v71
 v_mfma_f32_16x16x32_bf16 v[76:79],a[152:155],a[76:79],v[76:79]
 v_exp_f32 v73,v73
 v_mfma_f32_16x16x32_bf16 v[76:79],a[156:159],a[108:111],v[76:79]
 ds_read_b128 a[144:147],v20 offset:35328
 s_waitcnt lgkmcnt(3)
 v_mfma_f32_16x16x32_bf16 v[224:227],a[168:171],v[96:99],v[224:227]
 v_exp_f32 v74,v74
 v_mfma_f32_16x16x32_bf16 v[228:231],a[168:171],v[104:107],v[228:231]
 ds_read_b64_tr_b16 a[166:167],v24 offset:9056
 v_cvt_pk_bf16_f32 v118,v72,v73
 v_mfma_f32_16x16x32_bf16 v[232:235],a[168:171],v[112:115],v[232:235]
 v_exp_f32 v75,v75
 v_mfma_f32_16x16x32_bf16 v[236:239],a[168:171],v[120:123],v[236:239]
 buffer_load_dwordx4 v14,s[20:23],s59 offen offset:2080 lds
 v_mfma_f32_16x16x32_bf16 v[64:67],a[128:131],a[0:3],v[80:83]
 v_exp_f32 v76,v76
 v_mfma_f32_16x16x32_bf16 v[64:67],a[132:135],a[32:35],v[64:67]
 ds_read_b64_tr_b16 a[168:169],v24 offset:8832
 v_cvt_pk_bf16_f32 v119,v74,v75
 v_mfma_f32_16x16x32_bf16 v[64:67],a[136:139],a[64:67],v[64:67]
 v_exp_f32 v77,v77
 v_mfma_f32_16x16x32_bf16 v[64:67],a[140:143],a[96:99],v[64:67]
 ds_read_b128 a[148:151],v20 offset:35392
 v_mfma_f32_16x16x32_bf16 v[240:243],a[172:175],v[96:99],v[240:243]
 v_exp_f32 v78,v78
 v_mfma_f32_16x16x32_bf16 v[244:247],a[172:175],v[104:107],v[244:247]
 ds_read_b64_tr_b16 a[170:171],v24 offset:9088
 v_cvt_pk_bf16_f32 v126,v76,v77
 v_mfma_f32_16x16x32_bf16 v[248:251],a[172:175],v[112:115],v[248:251]
 v_exp_f32 v79,v79
 v_mfma_f32_16x16x32_bf16 v[252:255],a[172:175],v[120:123],v[252:255]
 buffer_load_dwordx4 v15,s[20:23],s59 offen offset:3120 lds
 v_smfmac_f32_16x16x64_bf16 a[180:183],v[60:63],v[104:111],v30
 v_mfma_f32_16x16x32_bf16 v[68:71],a[128:131],a[4:7],v[84:87]
 v_exp_f32 v64,v64
 v_mfma_f32_16x16x32_bf16 v[68:71],a[132:135],a[36:39],v[68:71]
 ds_read_b64_tr_b16 a[172:173],v24 offset:8864
 v_cvt_pk_bf16_f32 v127,v78,v79
 v_mfma_f32_16x16x32_bf16 v[68:71],a[136:139],a[68:71],v[68:71]
 v_exp_f32 v65,v65
 v_mfma_f32_16x16x32_bf16 v[68:71],a[140:143],a[100:103],v[68:71]
 ds_read_b128 a[152:155],v20 offset:35456
 s_waitcnt lgkmcnt(3)
 v_mfma_f32_16x16x32_bf16 v[128:131],a[160:163],v[100:103],v[128:131]
 v_exp_f32 v66,v66
 v_mfma_f32_16x16x32_bf16 v[132:135],a[160:163],v[108:111],v[132:135]
 ds_read_b64_tr_b16 a[174:175],v24 offset:9120
 v_cvt_pk_bf16_f32 v96,v64,v65
 v_mfma_f32_16x16x32_bf16 v[136:139],a[160:163],v[116:119],v[136:139]
 v_exp_f32 v67,v67
 v_mfma_f32_16x16x32_bf16 v[140:143],a[160:163],v[124:127],v[140:143]
 buffer_store_dword v27,off,s[8:11],s81 sc0 sc1
 v_mfma_f32_16x16x32_bf16 v[72:75],a[128:131],a[8:11],v[88:91]
 v_exp_f32 v68,v68
 v_mfma_f32_16x16x32_bf16 v[72:75],a[132:135],a[40:43],v[72:75]
 ds_read_b64_tr_b16 a[160:161],v24 offset:8896
 v_cvt_pk_bf16_f32 v97,v66,v67
 v_mfma_f32_16x16x32_bf16 v[72:75],a[136:139],a[72:75],v[72:75]
 v_exp_f32 v69,v69
 v_mfma_f32_16x16x32_bf16 v[72:75],a[140:143],a[104:107],v[72:75]
 ds_read_b128 a[156:159],v20 offset:35520
 v_add_u32 v27,1,v27
 v_mfma_f32_16x16x32_bf16 v[144:147],a[164:167],v[100:103],v[144:147]
 v_exp_f32 v70,v70
 v_mfma_f32_16x16x32_bf16 v[148:151],a[164:167],v[108:111],v[148:151]
 ds_read_b64_tr_b16 a[162:163],v24 offset:9152
 v_cvt_pk_bf16_f32 v104,v68,v69
 v_mfma_f32_16x16x32_bf16 v[152:155],a[164:167],v[116:119],v[152:155]
 v_exp_f32 v71,v71
 v_mfma_f32_16x16x32_bf16 v[156:159],a[164:167],v[124:127],v[156:159]
 buffer_store_dwordx4 a[16:19],v4,s[8:11],s98 offen sc0 sc1
 v_smfmac_f32_16x16x64_bf16 a[184:187],v[60:63],v[112:119],v30
 s_add_u32 s98,s98,1024
 v_mfma_f32_16x16x32_bf16 v[76:79],a[128:131],a[12:15],v[92:95]
 v_exp_f32 v72,v72
 v_mfma_f32_16x16x32_bf16 v[76:79],a[132:135],a[44:47],v[76:79]
 ds_read_b64_tr_b16 a[164:165],v24 offset:8928
 v_cvt_pk_bf16_f32 v105,v70,v71
 v_mfma_f32_16x16x32_bf16 v[76:79],a[136:139],a[76:79],v[76:79]
 v_exp_f32 v73,v73
 v_mfma_f32_16x16x32_bf16 v[76:79],a[140:143],a[108:111],v[76:79]
 ds_read_b128 a[128:131],v20 offset:35584
 s_waitcnt lgkmcnt(3)
 v_mfma_f32_16x16x32_bf16 v[160:163],a[168:171],v[100:103],v[160:163]
 v_exp_f32 v74,v74
 v_mfma_f32_16x16x32_bf16 v[164:167],a[168:171],v[108:111],v[164:167]
 ds_read_b64_tr_b16 a[166:167],v24 offset:9184
 v_cvt_pk_bf16_f32 v112,v72,v73
 v_mfma_f32_16x16x32_bf16 v[168:171],a[168:171],v[116:119],v[168:171]
 v_exp_f32 v75,v75
 v_mfma_f32_16x16x32_bf16 v[172:175],a[168:171],v[124:127],v[172:175]
 buffer_load_dword v40,v41,s[44:47],s60 offen sc0 sc1
 v_smfmac_f32_16x16x64_bf16 a[188:191],v[60:63],v[120:127],v30
 v_mfma_f32_16x16x32_bf16 v[64:67],a[144:147],a[0:3],v[80:83]
 v_exp_f32 v76,v76
 v_mfma_f32_16x16x32_bf16 v[64:67],a[148:151],a[32:35],v[64:67]
 ds_read_b64_tr_b16 a[168:169],v24 offset:8960
 v_cvt_pk_bf16_f32 v113,v74,v75
 v_mfma_f32_16x16x32_bf16 v[64:67],a[152:155],a[64:67],v[64:67]
 v_exp_f32 v77,v77
 v_mfma_f32_16x16x32_bf16 v[64:67],a[156:159],a[96:99],v[64:67]
 ds_read_b128 a[132:135],v20 offset:35648
 s_add_u32 m0,s54,35072
 v_mfma_f32_16x16x32_bf16 v[176:179],a[172:175],v[100:103],v[176:179]
 v_exp_f32 v78,v78
 v_mfma_f32_16x16x32_bf16 v[180:183],a[172:175],v[108:111],v[180:183]
 ds_read_b64_tr_b16 a[170:171],v24 offset:9216
 v_cvt_pk_bf16_f32 v120,v76,v77
 v_mfma_f32_16x16x32_bf16 v[184:187],a[172:175],v[116:119],v[184:187]
 v_exp_f32 v79,v79
 v_mfma_f32_16x16x32_bf16 v[188:191],a[172:175],v[124:127],v[188:191]
 s_waitcnt vmcnt(14)
 s_barrier
 v_mfma_f32_16x16x32_bf16 v[68:71],a[144:147],a[4:7],v[84:87]
 v_exp_f32 v64,v64
 v_mfma_f32_16x16x32_bf16 v[68:71],a[148:151],a[36:39],v[68:71]
 ds_read_b64_tr_b16 a[172:173],v24 offset:8992
 v_cvt_pk_bf16_f32 v121,v78,v79
 v_mfma_f32_16x16x32_bf16 v[68:71],a[152:155],a[68:71],v[68:71]
 v_exp_f32 v65,v65
 v_mfma_f32_16x16x32_bf16 v[68:71],a[156:159],a[100:103],v[68:71]
 ds_read_b128 a[136:139],v20 offset:35712
 s_waitcnt lgkmcnt(3)
 v_mfma_f32_16x16x32_bf16 v[192:195],a[160:163],v[100:103],v[192:195]
 v_exp_f32 v66,v66
 v_mfma_f32_16x16x32_bf16 v[196:199],a[160:163],v[108:111],v[196:199]
 ds_read_b64_tr_b16 a[174:175],v24 offset:9248
 v_cvt_pk_bf16_f32 v98,v64,v65
 v_mfma_f32_16x16x32_bf16 v[200:203],a[160:163],v[116:119],v[200:203]
 v_exp_f32 v67,v67
 v_mfma_f32_16x16x32_bf16 v[204:207],a[160:163],v[124:127],v[204:207]
 buffer_load_dwordx4 v16,s[24:27],s59 offen offset:0 lds
 v_mfma_f32_16x16x32_bf16 v[72:75],a[144:147],a[8:11],v[88:91]
 v_exp_f32 v68,v68
 v_mfma_f32_16x16x32_bf16 v[72:75],a[148:151],a[40:43],v[72:75]
 ds_read_b64_tr_b16 a[160:161],v24 offset:35072
 v_cvt_pk_bf16_f32 v99,v66,v67
 v_mfma_f32_16x16x32_bf16 v[72:75],a[152:155],a[72:75],v[72:75]
 v_exp_f32 v69,v69
 v_mfma_f32_16x16x32_bf16 v[72:75],a[156:159],a[104:107],v[72:75]
 ds_read_b128 a[140:143],v20 offset:35776
 v_mfma_f32_16x16x32_bf16 v[208:211],a[164:167],v[100:103],v[208:211]
 v_exp_f32 v70,v70
 v_mfma_f32_16x16x32_bf16 v[212:215],a[164:167],v[108:111],v[212:215]
 ds_read_b64_tr_b16 a[162:163],v24 offset:35328
 v_cvt_pk_bf16_f32 v106,v68,v69
 v_mfma_f32_16x16x32_bf16 v[216:219],a[164:167],v[116:119],v[216:219]
 v_exp_f32 v71,v71
 v_mfma_f32_16x16x32_bf16 v[220:223],a[164:167],v[124:127],v[220:223]
 global_load_dword v31,v2,s[6:7]
 v_mfma_f32_16x16x32_bf16 v[76:79],a[144:147],a[12:15],v[92:95]
 v_exp_f32 v72,v72
 v_mfma_f32_16x16x32_bf16 v[76:79],a[148:151],a[44:47],v[76:79]
 ds_read_b64_tr_b16 a[164:165],v24 offset:35104
 v_cvt_pk_bf16_f32 v107,v70,v71
 v_mfma_f32_16x16x32_bf16 v[76:79],a[152:155],a[76:79],v[76:79]
 v_exp_f32 v73,v73
 v_mfma_f32_16x16x32_bf16 v[76:79],a[156:159],a[108:111],v[76:79]
 ds_read_b128 a[144:147],v20 offset:35840
 s_waitcnt lgkmcnt(3)
 v_mfma_f32_16x16x32_bf16 v[224:227],a[168:171],v[100:103],v[224:227]
 v_exp_f32 v74,v74
 v_mfma_f32_16x16x32_bf16 v[228:231],a[168:171],v[108:111],v[228:231]
 ds_read_b64_tr_b16 a[166:167],v24 offset:35360
 v_cvt_pk_bf16_f32 v114,v72,v73
 v_mfma_f32_16x16x32_bf16 v[232:235],a[168:171],v[116:119],v[232:235]
 v_exp_f32 v75,v75
 v_mfma_f32_16x16x32_bf16 v[236:239],a[168:171],v[124:127],v[236:239]
 buffer_load_dwordx4 v17,s[24:27],s59 offen offset:1088 lds
 v_mfma_f32_16x16x32_bf16 v[64:67],a[128:131],a[0:3],v[80:83]
 v_exp_f32 v76,v76
 v_mfma_f32_16x16x32_bf16 v[64:67],a[132:135],a[32:35],v[64:67]
 ds_read_b64_tr_b16 a[168:169],v24 offset:35136
 v_cvt_pk_bf16_f32 v115,v74,v75
 v_mfma_f32_16x16x32_bf16 v[64:67],a[136:139],a[64:67],v[64:67]
 v_exp_f32 v77,v77
 v_mfma_f32_16x16x32_bf16 v[64:67],a[140:143],a[96:99],v[64:67]
 ds_read_b128 a[148:151],v20 offset:35904
 s_cmp_eq_u32 s60,0x70000000
 s_cselect_b32 s96,s66,s96
 v_mfma_f32_16x16x32_bf16 v[240:243],a[172:175],v[100:103],v[240:243]
 v_exp_f32 v78,v78
 v_mfma_f32_16x16x32_bf16 v[244:247],a[172:175],v[108:111],v[244:247]
 ds_read_b64_tr_b16 a[170:171],v24 offset:35392
 v_cvt_pk_bf16_f32 v122,v76,v77
 v_mfma_f32_16x16x32_bf16 v[248:251],a[172:175],v[116:119],v[248:251]
 v_exp_f32 v79,v79
 v_mfma_f32_16x16x32_bf16 v[252:255],a[172:175],v[124:127],v[252:255]
 buffer_load_dwordx4 v18,s[24:27],s59 offen offset:2176 lds
 v_mfma_f32_16x16x32_bf16 v[68:71],a[128:131],a[4:7],v[84:87]
 v_exp_f32 v64,v64
 v_mfma_f32_16x16x32_bf16 v[68:71],a[132:135],a[36:39],v[68:71]
 ds_read_b64_tr_b16 a[172:173],v24 offset:35168
 v_cvt_pk_bf16_f32 v123,v78,v79
 v_mfma_f32_16x16x32_bf16 v[68:71],a[136:139],a[68:71],v[68:71]
 v_exp_f32 v65,v65
 v_mfma_f32_16x16x32_bf16 v[68:71],a[140:143],a[100:103],v[68:71]
 ds_read_b128 a[152:155],v20 offset:35968
 s_waitcnt lgkmcnt(3)
 v_mfma_f32_16x16x32_bf16 v[128:131],a[160:163],v[96:99],v[128:131]
 v_exp_f32 v66,v66
 v_mfma_f32_16x16x32_bf16 v[132:135],a[160:163],v[104:107],v[132:135]
 ds_read_b64_tr_b16 a[174:175],v24 offset:35424
 v_cvt_pk_bf16_f32 v100,v64,v65
 v_mfma_f32_16x16x32_bf16 v[136:139],a[160:163],v[112:115],v[136:139]
 v_exp_f32 v67,v67
 v_mfma_f32_16x16x32_bf16 v[140:143],a[160:163],v[120:123],v[140:143]
 buffer_load_dwordx4 v19,s[24:27],s59 offen offset:3264 lds
 v_mfma_f32_16x16x32_bf16 v[72:75],a[128:131],a[8:11],v[88:91]
 v_exp_f32 v68,v68
 v_mfma_f32_16x16x32_bf16 v[72:75],a[132:135],a[40:43],v[72:75]
 ds_read_b64_tr_b16 a[160:161],v24 offset:35200
 v_cvt_pk_bf16_f32 v101,v66,v67
 v_mfma_f32_16x16x32_bf16 v[72:75],a[136:139],a[72:75],v[72:75]
 v_exp_f32 v69,v69
 v_mfma_f32_16x16x32_bf16 v[72:75],a[140:143],a[104:107],v[72:75]
 ds_read_b128 a[156:159],v20 offset:36032
 v_sub_u32 v20,v25,v20
 v_mfma_f32_16x16x32_bf16 v[144:147],a[164:167],v[96:99],v[144:147]
 v_exp_f32 v70,v70
 v_mfma_f32_16x16x32_bf16 v[148:151],a[164:167],v[104:107],v[148:151]
 ds_read_b64_tr_b16 a[162:163],v24 offset:35456
 v_cvt_pk_bf16_f32 v108,v68,v69
 v_mfma_f32_16x16x32_bf16 v[152:155],a[164:167],v[112:115],v[152:155]
 v_exp_f32 v71,v71
 v_mfma_f32_16x16x32_bf16 v[156:159],a[164:167],v[120:123],v[156:159]
 buffer_store_dword v27,off,s[8:11],s81 sc0 sc1
 v_mfma_f32_16x16x32_bf16 v[76:79],a[128:131],a[12:15],v[92:95]
 v_exp_f32 v72,v72
 v_mfma_f32_16x16x32_bf16 v[76:79],a[132:135],a[44:47],v[76:79]
 ds_read_b64_tr_b16 a[164:165],v24 offset:35232
 v_cvt_pk_bf16_f32 v109,v70,v71
 v_mfma_f32_16x16x32_bf16 v[76:79],a[136:139],a[76:79],v[76:79]
 v_exp_f32 v73,v73
 v_mfma_f32_16x16x32_bf16 v[76:79],a[140:143],a[108:111],v[76:79]
 ds_read_b128 a[128:131],v20 offset:0
 s_waitcnt lgkmcnt(3)
 v_mfma_f32_16x16x32_bf16 v[160:163],a[168:171],v[96:99],v[160:163]
 v_exp_f32 v74,v74
 v_mfma_f32_16x16x32_bf16 v[164:167],a[168:171],v[104:107],v[164:167]
 ds_read_b64_tr_b16 a[166:167],v24 offset:35488
 v_cvt_pk_bf16_f32 v116,v72,v73
 v_mfma_f32_16x16x32_bf16 v[168:171],a[168:171],v[112:115],v[168:171]
 v_exp_f32 v75,v75
 v_mfma_f32_16x16x32_bf16 v[172:175],a[168:171],v[120:123],v[172:175]
 s_add_u32 s59,s59,16384
 s_sub_u32 s53,s55,s53
 v_mfma_f32_16x16x32_bf16 v[64:67],a[144:147],a[0:3],v[80:83]
 v_exp_f32 v76,v76
 v_mfma_f32_16x16x32_bf16 v[64:67],a[148:151],a[32:35],v[64:67]
 ds_read_b64_tr_b16 a[168:169],v24 offset:35264
 v_cvt_pk_bf16_f32 v117,v74,v75
 v_mfma_f32_16x16x32_bf16 v[64:67],a[152:155],a[64:67],v[64:67]
 v_exp_f32 v77,v77
 v_mfma_f32_16x16x32_bf16 v[64:67],a[156:159],a[96:99],v[64:67]
 ds_read_b128 a[132:135],v20 offset:64
 s_add_u32 m0,s53,0
 v_mfma_f32_16x16x32_bf16 v[176:179],a[172:175],v[96:99],v[176:179]
 v_exp_f32 v78,v78
 v_mfma_f32_16x16x32_bf16 v[180:183],a[172:175],v[104:107],v[180:183]
 ds_read_b64_tr_b16 a[170:171],v24 offset:35520
 v_cvt_pk_bf16_f32 v124,v76,v77
 v_mfma_f32_16x16x32_bf16 v[184:187],a[172:175],v[112:115],v[184:187]
 v_exp_f32 v79,v79
 v_mfma_f32_16x16x32_bf16 v[188:191],a[172:175],v[120:123],v[188:191]
 buffer_load_dwordx4 v12,s[20:23],s59 offen offset:0 lds
 v_mfma_f32_16x16x32_bf16 v[68:71],a[144:147],a[4:7],v[84:87]
 v_exp_f32 v64,v64
 v_mfma_f32_16x16x32_bf16 v[68:71],a[148:151],a[36:39],v[68:71]
 ds_read_b64_tr_b16 a[172:173],v24 offset:35296
 v_cvt_pk_bf16_f32 v125,v78,v79
 v_mfma_f32_16x16x32_bf16 v[68:71],a[152:155],a[68:71],v[68:71]
 v_exp_f32 v65,v65
 v_mfma_f32_16x16x32_bf16 v[68:71],a[156:159],a[100:103],v[68:71]
 ds_read_b128 a[136:139],v20 offset:128
 s_waitcnt lgkmcnt(3)
 v_mfma_f32_16x16x32_bf16 v[192:195],a[160:163],v[96:99],v[192:195]
 v_exp_f32 v66,v66
 v_mfma_f32_16x16x32_bf16 v[196:199],a[160:163],v[104:107],v[196:199]
 ds_read_b64_tr_b16 a[174:175],v24 offset:35552
 v_cvt_pk_bf16_f32 v102,v64,v65
 v_mfma_f32_16x16x32_bf16 v[200:203],a[160:163],v[112:115],v[200:203]
 v_exp_f32 v67,v67
 v_mfma_f32_16x16x32_bf16 v[204:207],a[160:163],v[120:123],v[204:207]
 buffer_load_dwordx4 v13,s[20:23],s59 offen offset:1040 lds
 v_mfma_f32_16x16x32_bf16 v[72:75],a[144:147],a[8:11],v[88:91]
 v_exp_f32 v68,v68
 v_mfma_f32_16x16x32_bf16 v[72:75],a[148:151],a[40:43],v[72:75]
 ds_read_b64_tr_b16 a[160:161],v24 offset:43840
 v_cvt_pk_bf16_f32 v103,v66,v67
 v_mfma_f32_16x16x32_bf16 v[72:75],a[152:155],a[72:75],v[72:75]
 v_exp_f32 v69,v69
 v_mfma_f32_16x16x32_bf16 v[72:75],a[156:159],a[104:107],v[72:75]
 ds_read_b128 a[140:143],v20 offset:192
 v_add_u32 v27,1,v27
 v_mfma_f32_16x16x32_bf16 v[208:211],a[164:167],v[96:99],v[208:211]
 v_exp_f32 v70,v70
 v_mfma_f32_16x16x32_bf16 v[212:215],a[164:167],v[104:107],v[212:215]
 ds_read_b64_tr_b16 a[162:163],v24 offset:44096
 v_cvt_pk_bf16_f32 v110,v68,v69
 v_mfma_f32_16x16x32_bf16 v[216:219],a[164:167],v[112:115],v[216:219]
 v_exp_f32 v71,v71
 v_mfma_f32_16x16x32_bf16 v[220:223],a[164:167],v[120:123],v[220:223]
 buffer_load_dword v31,v3,s[28:31],s96 offen
 v_smfmac_f32_16x16x64_bf16 a[176:179],v[60:63],v[96:103],v30
 s_add_u32 s96,s96,131072
 v_mfma_f32_16x16x32_bf16 v[76:79],a[144:147],a[12:15],v[92:95]
 v_exp_f32 v72,v72
 v_mfma_f32_16x16x32_bf16 v[76:79],a[148:151],a[44:47],v[76:79]
 ds_read_b64_tr_b16 a[164:165],v24 offset:43872
 v_cvt_pk_bf16_f32 v111,v70,v71
 v_mfma_f32_16x16x32_bf16 v[76:79],a[152:155],a[76:79],v[76:79]
 v_exp_f32 v73,v73
 v_mfma_f32_16x16x32_bf16 v[76:79],a[156:159],a[108:111],v[76:79]
 ds_read_b128 a[144:147],v20 offset:256
 s_waitcnt lgkmcnt(3)
 v_mfma_f32_16x16x32_bf16 v[224:227],a[168:171],v[96:99],v[224:227]
 v_exp_f32 v74,v74
 v_mfma_f32_16x16x32_bf16 v[228:231],a[168:171],v[104:107],v[228:231]
 ds_read_b64_tr_b16 a[166:167],v24 offset:44128
 v_cvt_pk_bf16_f32 v118,v72,v73
 v_mfma_f32_16x16x32_bf16 v[232:235],a[168:171],v[112:115],v[232:235]
 v_exp_f32 v75,v75
 v_mfma_f32_16x16x32_bf16 v[236:239],a[168:171],v[120:123],v[236:239]
 buffer_load_dwordx4 v14,s[20:23],s59 offen offset:2080 lds
 v_mfma_f32_16x16x32_bf16 v[64:67],a[128:131],a[0:3],v[80:83]
 v_exp_f32 v76,v76
 v_mfma_f32_16x16x32_bf16 v[64:67],a[132:135],a[32:35],v[64:67]
 ds_read_b64_tr_b16 a[168:169],v24 offset:43904
 v_cvt_pk_bf16_f32 v119,v74,v75
 v_mfma_f32_16x16x32_bf16 v[64:67],a[136:139],a[64:67],v[64:67]
 v_exp_f32 v77,v77
 v_mfma_f32_16x16x32_bf16 v[64:67],a[140:143],a[96:99],v[64:67]
 ds_read_b128 a[148:151],v20 offset:320
 v_mfma_f32_16x16x32_bf16 v[240:243],a[172:175],v[96:99],v[240:243]
 v_exp_f32 v78,v78
 v_mfma_f32_16x16x32_bf16 v[244:247],a[172:175],v[104:107],v[244:247]
 ds_read_b64_tr_b16 a[170:171],v24 offset:44160
 v_cvt_pk_bf16_f32 v126,v76,v77
 v_mfma_f32_16x16x32_bf16 v[248:251],a[172:175],v[112:115],v[248:251]
 v_exp_f32 v79,v79
 v_mfma_f32_16x16x32_bf16 v[252:255],a[172:175],v[120:123],v[252:255]
 buffer_load_dword v31,v3,s[32:35],s97 offen
 v_smfmac_f32_16x16x64_bf16 a[180:183],v[60:63],v[104:111],v30
 s_add_u32 s97,s97,131072
 v_mfma_f32_16x16x32_bf16 v[68:71],a[128:131],a[4:7],v[84:87]
 v_exp_f32 v64,v64
 v_mfma_f32_16x16x32_bf16 v[68:71],a[132:135],a[36:39],v[68:71]
 ds_read_b64_tr_b16 a[172:173],v24 offset:43936
 v_cvt_pk_bf16_f32 v127,v78,v79
 v_mfma_f32_16x16x32_bf16 v[68:71],a[136:139],a[68:71],v[68:71]
 v_exp_f32 v65,v65
 v_mfma_f32_16x16x32_bf16 v[68:71],a[140:143],a[100:103],v[68:71]
 ds_read_b128 a[152:155],v20 offset:384
 s_waitcnt lgkmcnt(3)
 v_mfma_f32_16x16x32_bf16 v[128:131],a[160:163],v[100:103],v[128:131]
 v_exp_f32 v66,v66
 v_mfma_f32_16x16x32_bf16 v[132:135],a[160:163],v[108:111],v[132:135]
 ds_read_b64_tr_b16 a[174:175],v24 offset:44192
 v_cvt_pk_bf16_f32 v96,v64,v65
 v_mfma_f32_16x16x32_bf16 v[136:139],a[160:163],v[116:119],v[136:139]
 v_exp_f32 v67,v67
 v_mfma_f32_16x16x32_bf16 v[140:143],a[160:163],v[124:127],v[140:143]
 buffer_load_dwordx4 v15,s[20:23],s59 offen offset:3120 lds
 v_mfma_f32_16x16x32_bf16 v[72:75],a[128:131],a[8:11],v[88:91]
 v_exp_f32 v68,v68
 v_mfma_f32_16x16x32_bf16 v[72:75],a[132:135],a[40:43],v[72:75]
 ds_read_b64_tr_b16 a[160:161],v24 offset:43968
 v_cvt_pk_bf16_f32 v97,v66,v67
 v_mfma_f32_16x16x32_bf16 v[72:75],a[136:139],a[72:75],v[72:75]
 v_exp_f32 v69,v69
 v_mfma_f32_16x16x32_bf16 v[72:75],a[140:143],a[104:107],v[72:75]
 ds_read_b128 a[156:159],v20 offset:448
 s_waitcnt vmcnt(12)
 v_mfma_f32_16x16x32_bf16 v[144:147],a[164:167],v[100:103],v[144:147]
 v_exp_f32 v70,v70
 v_mfma_f32_16x16x32_bf16 v[148:151],a[164:167],v[108:111],v[148:151]
 ds_read_b64_tr_b16 a[162:163],v24 offset:44224
 v_cvt_pk_bf16_f32 v104,v68,v69
 v_mfma_f32_16x16x32_bf16 v[152:155],a[164:167],v[116:119],v[152:155]
 v_exp_f32 v71,v71
 v_mfma_f32_16x16x32_bf16 v[156:159],a[164:167],v[124:127],v[156:159]
 buffer_load_dword v35,v34,s[8:11],s60 offen sc0 sc1
 v_smfmac_f32_16x16x64_bf16 a[184:187],v[60:63],v[112:119],v30
 v_mfma_f32_16x16x32_bf16 v[76:79],a[128:131],a[12:15],v[92:95]
 v_exp_f32 v72,v72
 v_mfma_f32_16x16x32_bf16 v[76:79],a[132:135],a[44:47],v[76:79]
 ds_read_b64_tr_b16 a[164:165],v24 offset:44000
 v_cvt_pk_bf16_f32 v105,v70,v71
 v_mfma_f32_16x16x32_bf16 v[76:79],a[136:139],a[76:79],v[76:79]
 v_exp_f32 v73,v73
 v_mfma_f32_16x16x32_bf16 v[76:79],a[140:143],a[108:111],v[76:79]
 ds_read_b128 a[128:131],v20 offset:512
 s_waitcnt lgkmcnt(3)
 v_mfma_f32_16x16x32_bf16 v[160:163],a[168:171],v[100:103],v[160:163]
 v_exp_f32 v74,v74
 v_mfma_f32_16x16x32_bf16 v[164:167],a[168:171],v[108:111],v[164:167]
 ds_read_b64_tr_b16 a[166:167],v24 offset:44256
 v_cvt_pk_bf16_f32 v112,v72,v73
 v_mfma_f32_16x16x32_bf16 v[168:171],a[168:171],v[116:119],v[168:171]
 v_exp_f32 v75,v75
 v_mfma_f32_16x16x32_bf16 v[172:175],a[168:171],v[124:127],v[172:175]
 buffer_store_dword v27,off,s[8:11],s81 sc0 sc1
 v_smfmac_f32_16x16x64_bf16 a[188:191],v[60:63],v[120:127],v30
 v_mfma_f32_16x16x32_bf16 v[64:67],a[144:147],a[0:3],v[80:83]
 v_exp_f32 v76,v76
 v_mfma_f32_16x16x32_bf16 v[64:67],a[148:151],a[32:35],v[64:67]
 ds_read_b64_tr_b16 a[168:169],v24 offset:44032
 v_cvt_pk_bf16_f32 v113,v74,v75
 v_mfma_f32_16x16x32_bf16 v[64:67],a[152:155],a[64:67],v[64:67]
 v_exp_f32 v77,v77
 v_mfma_f32_16x16x32_bf16 v[64:67],a[156:159],a[96:99],v[64:67]
 ds_read_b128 a[132:135],v20 offset:576
 v_add_u32 v27,1,v27
 v_mfma_f32_16x16x32_bf16 v[176:179],a[172:175],v[100:103],v[176:179]
 v_exp_f32 v78,v78
 v_mfma_f32_16x16x32_bf16 v[180:183],a[172:175],v[108:111],v[180:183]
 ds_read_b64_tr_b16 a[170:171],v24 offset:44288
 v_cvt_pk_bf16_f32 v120,v76,v77
 v_mfma_f32_16x16x32_bf16 v[184:187],a[172:175],v[116:119],v[184:187]
 v_exp_f32 v79,v79
 v_mfma_f32_16x16x32_bf16 v[188:191],a[172:175],v[124:127],v[188:191]
 s_barrier
 v_mfma_f32_16x16x32_bf16 v[68:71],a[144:147],a[4:7],v[84:87]
 v_exp_f32 v64,v64
 v_mfma_f32_16x16x32_bf16 v[68:71],a[148:151],a[36:39],v[68:71]
 ds_read_b64_tr_b16 a[172:173],v24 offset:44064
 v_cvt_pk_bf16_f32 v121,v78,v79
 v_mfma_f32_16x16x32_bf16 v[68:71],a[152:155],a[68:71],v[68:71]
 v_exp_f32 v65,v65
 v_mfma_f32_16x16x32_bf16 v[68:71],a[156:159],a[100:103],v[68:71]
 ds_read_b128 a[136:139],v20 offset:640
 s_waitcnt lgkmcnt(3)
 v_mfma_f32_16x16x32_bf16 v[192:195],a[160:163],v[100:103],v[192:195]
 v_exp_f32 v66,v66
 v_mfma_f32_16x16x32_bf16 v[196:199],a[160:163],v[108:111],v[196:199]
 ds_read_b64_tr_b16 a[174:175],v24 offset:44320
 v_cvt_pk_bf16_f32 v98,v64,v65
 v_mfma_f32_16x16x32_bf16 v[200:203],a[160:163],v[116:119],v[200:203]
 v_exp_f32 v67,v67
 v_mfma_f32_16x16x32_bf16 v[204:207],a[160:163],v[124:127],v[204:207]
 v_sub_u32 v24,v26,v24
 s_sub_u32 s54,s56,s54
 v_mfma_f32_16x16x32_bf16 v[72:75],a[144:147],a[8:11],v[88:91]
 v_exp_f32 v68,v68
 v_mfma_f32_16x16x32_bf16 v[72:75],a[148:151],a[40:43],v[72:75]
 ds_read_b64_tr_b16 a[160:161],v24 offset:0
 v_cvt_pk_bf16_f32 v99,v66,v67
 v_mfma_f32_16x16x32_bf16 v[72:75],a[152:155],a[72:75],v[72:75]
 v_exp_f32 v69,v69
L_w15:
 s_cbranch_execz L_wret0
 v_mfma_f32_16x16x32_bf16 v[72:75],a[156:159],a[104:107],v[72:75]
 ds_read_b128 a[140:143],v20 offset:704
 s_add_u32 m0,s54,0
 v_mfma_f32_16x16x32_bf16 v[208:211],a[164:167],v[100:103],v[208:211]
 v_exp_f32 v70,v70
 v_mfma_f32_16x16x32_bf16 v[212:215],a[164:167],v[108:111],v[212:215]
 ds_read_b64_tr_b16 a[162:163],v24 offset:256
 v_cvt_pk_bf16_f32 v106,v68,v69
 v_mfma_f32_16x16x32_bf16 v[216:219],a[164:167],v[116:119],v[216:219]
 v_exp_f32 v71,v71
 v_mfma_f32_16x16x32_bf16 v[220:223],a[164:167],v[124:127],v[220:223]
 buffer_load_dwordx4 v16,s[24:27],s59 offen offset:0 lds
 v_mfma_f32_16x16x32_bf16 v[76:79],a[144:147],a[12:15],v[92:95]
 v_exp_f32 v72,v72
 v_mfma_f32_16x16x32_bf16 v[76:79],a[148:151],a[44:47],v[76:79]
 ds_read_b64_tr_b16 a[164:165],v24 offset:32
 v_cvt_pk_bf16_f32 v107,v70,v71
 v_mfma_f32_16x16x32_bf16 v[76:79],a[152:155],a[76:79],v[76:79]
 v_exp_f32 v73,v73
 v_mfma_f32_16x16x32_bf16 v[76:79],a[156:159],a[108:111],v[76:79]
 ds_read_b128 a[144:147],v20 offset:768
 s_waitcnt lgkmcnt(3)
 v_mfma_f32_16x16x32_bf16 v[224:227],a[168:171],v[100:103],v[224:227]
 v_exp_f32 v74,v74
 v_mfma_f32_16x16x32_bf16 v[228:231],a[168:171],v[108:111],v[228:231]
 ds_read_b64_tr_b16 a[166:167],v24 offset:288
 v_cvt_pk_bf16_f32 v114,v72,v73
 v_mfma_f32_16x16x32_bf16 v[232:235],a[168:171],v[116:119],v[232:235]
 v_exp_f32 v75,v75
 v_mfma_f32_16x16x32_bf16 v[236:239],a[168:171],v[124:127],v[236:239]
 buffer_load_dwordx4 v17,s[24:27],s59 offen offset:1088 lds
 v_mfma_f32_16x16x32_bf16 v[64:67],a[128:131],a[0:3],v[80:83]
 v_exp_f32 v76,v76
 v_mfma_f32_16x16x32_bf16 v[64:67],a[132:135],a[32:35],v[64:67]
 ds_read_b64_tr_b16 a[168:169],v24 offset:64
 v_cvt_pk_bf16_f32 v115,v74,v75
 v_mfma_f32_16x16x32_bf16 v[64:67],a[136:139],a[64:67],v[64:67]
 v_exp_f32 v77,v77
 v_mfma_f32_16x16x32_bf16 v[64:67],a[140:143],a[96:99],v[64:67]
 ds_read_b128 a[148:151],v20 offset:832
 v_mfma_f32_16x16x32_bf16 v[240:243],a[172:175],v[100:103],v[240:243]
 v_exp_f32 v78,v78
 v_mfma_f32_16x16x32_bf16 v[244:247],a[172:175],v[108:111],v[244:247]
 ds_read_b64_tr_b16 a[170:171],v24 offset:320
 v_cvt_pk_bf16_f32 v122,v76,v77
 v_mfma_f32_16x16x32_bf16 v[248:251],a[172:175],v[116:119],v[248:251]
 v_exp_f32 v79,v79
 v_mfma_f32_16x16x32_bf16 v[252:255],a[172:175],v[124:127],v[252:255]
 s_sub_u32 s60,s60,0x10000000
 s_cbranch_scc0 L_aloop
 v_mfma_f32_16x16x32_bf16 v[68:71],a[128:131],a[4:7],v[84:87]
 v_exp_f32 v64,v64
 v_mfma_f32_16x16x32_bf16 v[68:71],a[132:135],a[36:39],v[68:71]
 ds_read_b64_tr_b16 a[172:173],v24 offset:96
 v_cvt_pk_bf16_f32 v123,v78,v79
 v_mfma_f32_16x16x32_bf16 v[68:71],a[136:139],a[68:71],v[68:71]
 v_exp_f32 v65,v65
 v_mfma_f32_16x16x32_bf16 v[68:71],a[140:143],a[100:103],v[68:71]
 ds_read_b128 a[152:155],v20 offset:896
 s_waitcnt lgkmcnt(3)
 v_mfma_f32_16x16x32_bf16 v[128:131],a[160:163],v[96:99],v[128:131]
 v_exp_f32 v66,v66
 v_mfma_f32_16x16x32_bf16 v[132:135],a[160:163],v[104:107],v[132:135]
 ds_read_b64_tr_b16 a[174:175],v24 offset:352
 v_cvt_pk_bf16_f32 v100,v64,v65
 v_mfma_f32_16x16x32_bf16 v[136:139],a[160:163],v[112:115],v[136:139]
 v_exp_f32 v67,v67
 v_mfma_f32_16x16x32_bf16 v[140:143],a[160:163],v[120:123],v[140:143]
 buffer_store_dword v27,off,s[8:11],s81 sc0 sc1
 v_mfma_f32_16x16x32_bf16 v[72:75],a[128:131],a[8:11],v[88:91]
 v_exp_f32 v68,v68
 v_mfma_f32_16x16x32_bf16 v[72:75],a[132:135],a[40:43],v[72:75]
 ds_read_b64_tr_b16 a[160:161],v24 offset:128
 v_cvt_pk_bf16_f32 v101,v66,v67
 v_mfma_f32_16x16x32_bf16 v[72:75],a[136:139],a[72:75],v[72:75]
 v_exp_f32 v69,v69
 v_mfma_f32_16x16x32_bf16 v[72:75],a[140:143],a[104:107],v[72:75]
 ds_read_b128 a[156:159],v20 offset:960
 v_and_b32 v28,12,v41
 v_mfma_f32_16x16x32_bf16 v[144:147],a[164:167],v[96:99],v[144:147]
 v_exp_f32 v70,v70
 v_mfma_f32_16x16x32_bf16 v[148:151],a[164:167],v[104:107],v[148:151]
 ds_read_b64_tr_b16 a[162:163],v24 offset:384
 v_cvt_pk_bf16_f32 v108,v68,v69
 v_mfma_f32_16x16x32_bf16 v[152:155],a[164:167],v[112:115],v[152:155]
 v_exp_f32 v71,v71
 v_mfma_f32_16x16x32_bf16 v[156:159],a[164:167],v[120:123],v[156:159]
 buffer_load_dwordx4 v18,s[24:27],s59 offen offset:2176 lds
 v_mfma_f32_16x16x32_bf16 v[76:79],a[128:131],a[12:15],v[92:95]
 v_exp_f32 v72,v72
 v_mfma_f32_16x16x32_bf16 v[76:79],a[132:135],a[44:47],v[76:79]
 ds_read_b64_tr_b16 a[164:165],v24 offset:160
 v_cvt_pk_bf16_f32 v109,v70,v71
 v_mfma_f32_16x16x32_bf16 v[76:79],a[136:139],a[76:79],v[76:79]
 v_exp_f32 v73,v73
 v_mfma_f32_16x16x32_bf16 v[76:79],a[140:143],a[108:111],v[76:79]
 ds_read_b128 a[128:131],v20 offset:35072
 s_waitcnt lgkmcnt(3)
 v_mfma_f32_16x16x32_bf16 v[160:163],a[168:171],v[96:99],v[160:163]
 v_exp_f32 v74,v74
 v_mfma_f32_16x16x32_bf16 v[164:167],a[168:171],v[104:107],v[164:167]
 ds_read_b64_tr_b16 a[166:167],v24 offset:416
 v_cvt_pk_bf16_f32 v116,v72,v73
 v_mfma_f32_16x16x32_bf16 v[168:171],a[168:171],v[112:115],v[168:171]
 v_exp_f32 v75,v75
 v_mfma_f32_16x16x32_bf16 v[172:175],a[168:171],v[120:123],v[172:175]
 buffer_load_dwordx4 v19,s[24:27],s59 offen offset:3264 lds
 v_mfma_f32_16x16x32_bf16 v[64:67],a[144:147],a[0:3],v[80:83]
 v_exp_f32 v76,v76
 v_mfma_f32_16x16x32_bf16 v[64:67],a[148:151],a[32:35],v[64:67]
 ds_read_b64_tr_b16 a[168:169],v24 offset:192
 v_cvt_pk_bf16_f32 v117,v74,v75
 v_mfma_f32_16x16x32_bf16 v[64:67],a[152:155],a[64:67],v[64:67]
 v_exp_f32 v77,v77
 v_mfma_f32_16x16x32_bf16 v[64:67],a[156:159],a[96:99],v[64:67]
 ds_read_b128 a[132:135],v20 offset:35136
 s_add_u32 s59,s59,16384
 s_mov_b32 s58,s73
 s_add_u32 m0,s51,140288
 v_mfma_f32_16x16x32_bf16 v[176:179],a[172:175],v[96:99],v[176:179]
 v_exp_f32 v78,v78
 v_mfma_f32_16x16x32_bf16 v[180:183],a[172:175],v[104:107],v[180:183]
 ds_read_b64_tr_b16 a[170:171],v24 offset:448
 v_cvt_pk_bf16_f32 v124,v76,v77
 v_mfma_f32_16x16x32_bf16 v[184:187],a[172:175],v[112:115],v[184:187]
 v_exp_f32 v79,v79
 v_mfma_f32_16x16x32_bf16 v[188:191],a[172:175],v[120:123],v[188:191]
 buffer_load_dwordx4 v8,s[28:31],s58 offen offset:0 lds
 v_mfma_f32_16x16x32_bf16 v[68:71],a[144:147],a[4:7],v[84:87]
 v_exp_f32 v64,v64
 v_mfma_f32_16x16x32_bf16 v[68:71],a[148:151],a[36:39],v[68:71]
 ds_read_b64_tr_b16 a[172:173],v24 offset:224
 v_cvt_pk_bf16_f32 v125,v78,v79
 v_mfma_f32_16x16x32_bf16 v[68:71],a[152:155],a[68:71],v[68:71]
 v_exp_f32 v65,v65
 v_mfma_f32_16x16x32_bf16 v[68:71],a[156:159],a[100:103],v[68:71]
 ds_read_b128 a[136:139],v20 offset:35200
 s_waitcnt lgkmcnt(3)
 v_mfma_f32_16x16x32_bf16 v[192:195],a[160:163],v[96:99],v[192:195]
 v_exp_f32 v66,v66
 v_mfma_f32_16x16x32_bf16 v[196:199],a[160:163],v[104:107],v[196:199]
 ds_read_b64_tr_b16 a[174:175],v24 offset:480
 v_cvt_pk_bf16_f32 v102,v64,v65
 v_mfma_f32_16x16x32_bf16 v[200:203],a[160:163],v[112:115],v[200:203]
 v_exp_f32 v67,v67
 v_mfma_f32_16x16x32_bf16 v[204:207],a[160:163],v[120:123],v[204:207]
 buffer_load_dwordx4 v9,s[28:31],s58 offen offset:1088 lds
 v_mfma_f32_16x16x32_bf16 v[72:75],a[144:147],a[8:11],v[88:91]
 v_exp_f32 v68,v68
 v_mfma_f32_16x16x32_bf16 v[72:75],a[148:151],a[40:43],v[72:75]
 ds_read_b64_tr_b16 a[160:161],v24 offset:8768
 v_cvt_pk_bf16_f32 v103,v66,v67
 v_mfma_f32_16x16x32_bf16 v[72:75],a[152:155],a[72:75],v[72:75]
 v_exp_f32 v69,v69
 v_mfma_f32_16x16x32_bf16 v[72:75],a[156:159],a[104:107],v[72:75]
 ds_read_b128 a[140:143],v20 offset:35264
 v_xor_b32 v28,s81,v28
 v_mfma_f32_16x16x32_bf16 v[208:211],a[164:167],v[96:99],v[208:211]
 v_exp_f32 v70,v70
 v_mfma_f32_16x16x32_bf16 v[212:215],a[164:167],v[104:107],v[212:215]
 ds_read_b64_tr_b16 a[162:163],v24 offset:9024
 v_cvt_pk_bf16_f32 v110,v68,v69
 v_mfma_f32_16x16x32_bf16 v[216:219],a[164:167],v[112:115],v[216:219]
 v_exp_f32 v71,v71
 v_mfma_f32_16x16x32_bf16 v[220:223],a[164:167],v[120:123],v[220:223]
 buffer_load_dwordx4 v10,s[28:31],s58 offen offset:2176 lds
 v_smfmac_f32_16x16x64_bf16 a[176:179],v[60:63],v[96:103],v30
 v_lshlrev_b32 v6,1,v28
 v_mfma_f32_16x16x32_bf16 v[76:79],a[144:147],a[12:15],v[92:95]
 v_exp_f32 v72,v72
 v_mfma_f32_16x16x32_bf16 v[76:79],a[148:151],a[44:47],v[76:79]
 ds_read_b64_tr_b16 a[164:165],v24 offset:8800
 v_cvt_pk_bf16_f32 v111,v70,v71
 v_mfma_f32_16x16x32_bf16 v[76:79],a[152:155],a[76:79],v[76:79]
 v_exp_f32 v73,v73
 v_mfma_f32_16x16x32_bf16 v[76:79],a[156:159],a[108:111],v[76:79]
 ds_read_b128 a[144:147],v20 offset:35328
 s_waitcnt lgkmcnt(3)
 v_mfma_f32_16x16x32_bf16 v[224:227],a[168:171],v[96:99],v[224:227]
 v_exp_f32 v74,v74
 v_mfma_f32_16x16x32_bf16 v[228:231],a[168:171],v[104:107],v[228:231]
 ds_read_b64_tr_b16 a[166:167],v24 offset:9056
 v_cvt_pk_bf16_f32 v118,v72,v73
 v_mfma_f32_16x16x32_bf16 v[232:235],a[168:171],v[112:115],v[232:235]
 v_exp_f32 v75,v75
 v_mfma_f32_16x16x32_bf16 v[236:239],a[168:171],v[120:123],v[236:239]
 buffer_load_dword v28,v28,s[8:11],0 offen sc0 sc1
 v_mfma_f32_16x16x32_bf16 v[64:67],a[128:131],a[0:3],v[80:83]
 v_exp_f32 v76,v76
 v_mfma_f32_16x16x32_bf16 v[64:67],a[132:135],a[32:35],v[64:67]
 ds_read_b64_tr_b16 a[168:169],v24 offset:8832
 v_cvt_pk_bf16_f32 v119,v74,v75
 v_mfma_f32_16x16x32_bf16 v[64:67],a[136:139],a[64:67],v[64:67]
 v_exp_f32 v77,v77
 v_mfma_f32_16x16x32_bf16 v[64:67],a[140:143],a[96:99],v[64:67]
 ds_read_b128 a[148:151],v20 offset:35392
 s_mov_b32 s84,0x02020200
 v_mfma_f32_16x16x32_bf16 v[240:243],a[172:175],v[96:99],v[240:243]
 v_exp_f32 v78,v78
 v_mfma_f32_16x16x32_bf16 v[244:247],a[172:175],v[104:107],v[244:247]
 ds_read_b64_tr_b16 a[170:171],v24 offset:9088
 v_cvt_pk_bf16_f32 v126,v76,v77
 v_mfma_f32_16x16x32_bf16 v[248:251],a[172:175],v[112:115],v[248:251]
 v_exp_f32 v79,v79
 v_mfma_f32_16x16x32_bf16 v[252:255],a[172:175],v[120:123],v[252:255]
 buffer_load_dword v43,off,s[44:47],s99 sc0 sc1
 v_smfmac_f32_16x16x64_bf16 a[180:183],v[60:63],v[104:111],v30
 buffer_load_dwordx4 v11,s[28:31],s58 offen offset:3264 lds
 v_mfma_f32_16x16x32_bf16 v[68:71],a[128:131],a[4:7],v[84:87]
 v_exp_f32 v64,v64
 v_mfma_f32_16x16x32_bf16 v[68:71],a[132:135],a[36:39],v[68:71]
 ds_read_b64_tr_b16 a[172:173],v24 offset:8864
 v_cvt_pk_bf16_f32 v127,v78,v79
 v_mfma_f32_16x16x32_bf16 v[68:71],a[136:139],a[68:71],v[68:71]
 v_exp_f32 v65,v65
 v_mfma_f32_16x16x32_bf16 v[68:71],a[140:143],a[100:103],v[68:71]
 ds_read_b128 a[152:155],v20 offset:35456
 s_waitcnt lgkmcnt(3)
 v_mfma_f32_16x16x32_bf16 v[128:131],a[160:163],v[100:103],v[128:131]
 v_exp_f32 v66,v66
 v_mfma_f32_16x16x32_bf16 v[132:135],a[160:163],v[108:111],v[132:135]
 ds_read_b64_tr_b16 a[174:175],v24 offset:9120
 v_cvt_pk_bf16_f32 v96,v64,v65
 v_mfma_f32_16x16x32_bf16 v[136:139],a[160:163],v[116:119],v[136:139]
 v_exp_f32 v67,v67
 v_mfma_f32_16x16x32_bf16 v[140:143],a[160:163],v[124:127],v[140:143]
 v_lshlrev_b32 v6,v6,s84
 v_mfma_f32_16x16x32_bf16 v[72:75],a[128:131],a[8:11],v[88:91]
 v_exp_f32 v68,v68
 s_waitcnt vmcnt(12)
 v_mfma_f32_16x16x32_bf16 v[72:75],a[132:135],a[40:43],v[72:75]
 ds_read_b64_tr_b16 a[160:161],v24 offset:8896
 v_cvt_pk_bf16_f32 v97,v66,v67
 v_mfma_f32_16x16x32_bf16 v[72:75],a[136:139],a[72:75],v[72:75]
 v_exp_f32 v69,v69
 v_mfma_f32_16x16x32_bf16 v[72:75],a[140:143],a[104:107],v[72:75]
 ds_read_b128 a[156:159],v20 offset:35520
 s_add_u32 m0,s53,35072
 v_mfma_f32_16x16x32_bf16 v[144:147],a[164:167],v[100:103],v[144:147]
 v_exp_f32 v70,v70
 v_mfma_f32_16x16x32_bf16 v[148:151],a[164:167],v[108:111],v[148:151]
 ds_read_b64_tr_b16 a[162:163],v24 offset:9152
 v_cvt_pk_bf16_f32 v104,v68,v69
 v_mfma_f32_16x16x32_bf16 v[152:155],a[164:167],v[116:119],v[152:155]
 v_exp_f32 v71,v71
 v_mfma_f32_16x16x32_bf16 v[156:159],a[164:167],v[124:127],v[156:159]
 buffer_load_dwordx4 v12,s[20:23],s59 offen offset:0 lds
 v_smfmac_f32_16x16x64_bf16 a[184:187],v[60:63],v[112:119],v30
 v_or_b32 v40,0x7f7f7f7f,v40
 v_mfma_f32_16x16x32_bf16 v[76:79],a[128:131],a[12:15],v[92:95]
 v_exp_f32 v72,v72
 v_mfma_f32_16x16x32_bf16 v[76:79],a[132:135],a[44:47],v[76:79]
 ds_read_b64_tr_b16 a[164:165],v24 offset:8928
 v_cvt_pk_bf16_f32 v105,v70,v71
 v_mfma_f32_16x16x32_bf16 v[76:79],a[136:139],a[76:79],v[76:79]
 v_exp_f32 v73,v73
 v_mfma_f32_16x16x32_bf16 v[76:79],a[140:143],a[108:111],v[76:79]
 ds_read_b128 a[128:131],v20 offset:35584
 s_waitcnt lgkmcnt(3)
 v_mfma_f32_16x16x32_bf16 v[160:163],a[168:171],v[100:103],v[160:163]
 v_exp_f32 v74,v74
 v_mfma_f32_16x16x32_bf16 v[164:167],a[168:171],v[108:111],v[164:167]
 ds_read_b64_tr_b16 a[166:167],v24 offset:9184
 v_cvt_pk_bf16_f32 v112,v72,v73
 v_mfma_f32_16x16x32_bf16 v[168:171],a[168:171],v[116:119],v[168:171]
 v_exp_f32 v75,v75
 v_mfma_f32_16x16x32_bf16 v[172:175],a[168:171],v[124:127],v[172:175]
 buffer_load_dwordx4 v13,s[20:23],s59 offen offset:1040 lds
 v_smfmac_f32_16x16x64_bf16 a[188:191],v[60:63],v[120:127],v30
 v_add_u32 v40,1,v40
 v_mfma_f32_16x16x32_bf16 v[64:67],a[144:147],a[0:3],v[80:83]
 v_exp_f32 v76,v76
 v_mfma_f32_16x16x32_bf16 v[64:67],a[148:151],a[32:35],v[64:67]
 ds_read_b64_tr_b16 a[168:169],v24 offset:8960
 v_cvt_pk_bf16_f32 v113,v74,v75
 v_mfma_f32_16x16x32_bf16 v[64:67],a[152:155],a[64:67],v[64:67]
 v_exp_f32 v77,v77
 v_mfma_f32_16x16x32_bf16 v[64:67],a[156:159],a[96:99],v[64:67]
 ds_read_b128 a[132:135],v20 offset:35648
 v_cmp_eq_u32 vcc,0,v40
 v_mfma_f32_16x16x32_bf16 v[176:179],a[172:175],v[100:103],v[176:179]
 v_exp_f32 v78,v78
 v_mfma_f32_16x16x32_bf16 v[180:183],a[172:175],v[108:111],v[180:183]
 ds_read_b64_tr_b16 a[170:171],v24 offset:9216
 v_cvt_pk_bf16_f32 v120,v76,v77
 v_mfma_f32_16x16x32_bf16 v[184:187],a[172:175],v[116:119],v[184:187]
 v_exp_f32 v79,v79
 v_mfma_f32_16x16x32_bf16 v[188:191],a[172:175],v[124:127],v[188:191]
 s_barrier
 v_mfma_f32_16x16x32_bf16 v[68:71],a[144:147],a[4:7],v[84:87]
 v_exp_f32 v64,v64
 v_mfma_f32_16x16x32_bf16 v[68:71],a[148:151],a[36:39],v[68:71]
 ds_read_b64_tr_b16 a[172:173],v24 offset:8992
 v_cvt_pk_bf16_f32 v121,v78,v79
 v_mfma_f32_16x16x32_bf16 v[68:71],a[152:155],a[68:71],v[68:71]
 v_exp_f32 v65,v65
 v_mfma_f32_16x16x32_bf16 v[68:71],a[156:159],a[100:103],v[68:71]
 ds_read_b128 a[136:139],v20 offset:35712
 s_waitcnt lgkmcnt(3)
 v_mfma_f32_16x16x32_bf16 v[192:195],a[160:163],v[100:103],v[192:195]
 v_exp_f32 v66,v66
 v_mfma_f32_16x16x32_bf16 v[196:199],a[160:163],v[108:111],v[196:199]
 ds_read_b64_tr_b16 a[174:175],v24 offset:9248
 v_cvt_pk_bf16_f32 v98,v64,v65
 v_mfma_f32_16x16x32_bf16 v[200:203],a[160:163],v[116:119],v[200:203]
 v_exp_f32 v67,v67
 v_mfma_f32_16x16x32_bf16 v[204:207],a[160:163],v[124:127],v[204:207]
 v_cndmask_b32 v39,0,v35,vcc
 v_sub_u32_dpp v6,v6,v6 quad_perm:[0,0,0,0] row_mask:0xf bank_mask:0xf
 v_mfma_f32_16x16x32_bf16 v[72:75],a[144:147],a[8:11],v[88:91]
 v_exp_f32 v68,v68
 v_mfma_f32_16x16x32_bf16 v[72:75],a[148:151],a[40:43],v[72:75]
 ds_read_b64_tr_b16 a[160:161],v24 offset:35072
 v_cvt_pk_bf16_f32 v99,v66,v67
 v_mfma_f32_16x16x32_bf16 v[72:75],a[152:155],a[72:75],v[72:75]
 v_exp_f32 v69,v69
 v_mfma_f32_16x16x32_bf16 v[72:75],a[156:159],a[104:107],v[72:75]
 ds_read_b128 a[140:143],v20 offset:35776
 v_cmp_ge_u32 s[78:79],s0,v39
 v_mfma_f32_16x16x32_bf16 v[208:211],a[164:167],v[100:103],v[208:211]
 v_exp_f32 v70,v70
 v_mfma_f32_16x16x32_bf16 v[212:215],a[164:167],v[108:111],v[212:215]
 ds_read_b64_tr_b16 a[162:163],v24 offset:35328
 v_cvt_pk_bf16_f32 v106,v68,v69
 v_mfma_f32_16x16x32_bf16 v[216:219],a[164:167],v[116:119],v[216:219]
 v_exp_f32 v71,v71
 v_mfma_f32_16x16x32_bf16 v[220:223],a[164:167],v[124:127],v[220:223]
 buffer_load_dwordx4 v14,s[20:23],s59 offen offset:2080 lds
 v_mfma_f32_16x16x32_bf16 v[76:79],a[144:147],a[12:15],v[92:95]
 v_exp_f32 v72,v72
 v_mfma_f32_16x16x32_bf16 v[76:79],a[148:151],a[44:47],v[76:79]
 ds_read_b64_tr_b16 a[164:165],v24 offset:35104
 v_cvt_pk_bf16_f32 v107,v70,v71
 v_mfma_f32_16x16x32_bf16 v[76:79],a[152:155],a[76:79],v[76:79]
 v_exp_f32 v73,v73
 v_mfma_f32_16x16x32_bf16 v[76:79],a[156:159],a[108:111],v[76:79]
 ds_read_b128 a[144:147],v20 offset:35840
 s_waitcnt lgkmcnt(3)
 v_mfma_f32_16x16x32_bf16 v[224:227],a[168:171],v[100:103],v[224:227]
 v_exp_f32 v74,v74
 v_mfma_f32_16x16x32_bf16 v[228:231],a[168:171],v[108:111],v[228:231]
 ds_read_b64_tr_b16 a[166:167],v24 offset:35360
 v_cvt_pk_bf16_f32 v114,v72,v73
 v_mfma_f32_16x16x32_bf16 v[232:235],a[168:171],v[116:119],v[232:235]
 v_exp_f32 v75,v75
 v_mfma_f32_16x16x32_bf16 v[236:239],a[168:171],v[124:127],v[236:239]
 buffer_load_dwordx4 v15,s[20:23],s59 offen offset:3120 lds
 v_mfma_f32_16x16x32_bf16 v[64:67],a[128:131],a[0:3],v[80:83]
 v_exp_f32 v76,v76
 v_mfma_f32_16x16x32_bf16 v[64:67],a[132:135],a[32:35],v[64:67]
 ds_read_b64_tr_b16 a[168:169],v24 offset:35136
 v_cvt_pk_bf16_f32 v115,v74,v75
 v_mfma_f32_16x16x32_bf16 v[64:67],a[136:139],a[64:67],v[64:67]
 v_exp_f32 v77,v77
 v_mfma_f32_16x16x32_bf16 v[64:67],a[140:143],a[96:99],v[64:67]
 ds_read_b128 a[148:151],v20 offset:35904
 s_add_u32 m0,s54,35072
 s_cmp_lg_u64 s[78:79],0
 s_cselect_b32 s80,2,0
 s_cmp_lg_u32 s80,0
 s_cselect_b32 s71,0,s71
 v_mfma_f32_16x16x32_bf16 v[240:243],a[172:175],v[100:103],v[240:243]
 v_exp_f32 v78,v78
 v_mfma_f32_16x16x32_bf16 v[244:247],a[172:175],v[108:111],v[244:247]
 ds_read_b64_tr_b16 a[170:171],v24 offset:35392
 v_cvt_pk_bf16_f32 v122,v76,v77
 v_mfma_f32_16x16x32_bf16 v[248:251],a[172:175],v[116:119],v[248:251]
 v_exp_f32 v79,v79
 v_mfma_f32_16x16x32_bf16 v[252:255],a[172:175],v[124:127],v[252:255]
 buffer_load_dwordx4 v16,s[24:27],s59 offen offset:0 lds
 v_mfma_f32_16x16x32_bf16 v[68:71],a[128:131],a[4:7],v[84:87]
 v_exp_f32 v64,v64
 v_mfma_f32_16x16x32_bf16 v[68:71],a[132:135],a[36:39],v[68:71]
 ds_read_b64_tr_b16 a[172:173],v24 offset:35168
 v_cvt_pk_bf16_f32 v123,v78,v79
 v_mfma_f32_16x16x32_bf16 v[68:71],a[136:139],a[68:71],v[68:71]
 v_exp_f32 v65,v65
 v_mfma_f32_16x16x32_bf16 v[68:71],a[140:143],a[100:103],v[68:71]
 ds_read_b128 a[152:155],v20 offset:35968
 s_waitcnt lgkmcnt(3)
 v_mfma_f32_16x16x32_bf16 v[128:131],a[160:163],v[96:99],v[128:131]
 v_exp_f32 v66,v66
 v_mfma_f32_16x16x32_bf16 v[132:135],a[160:163],v[104:107],v[132:135]
 ds_read_b64_tr_b16 a[174:175],v24 offset:35424
 v_cvt_pk_bf16_f32 v100,v64,v65
 v_mfma_f32_16x16x32_bf16 v[136:139],a[160:163],v[112:115],v[136:139]
 v_exp_f32 v67,v67
 v_mfma_f32_16x16x32_bf16 v[140:143],a[160:163],v[120:123],v[140:143]
 buffer_load_dwordx4 v17,s[24:27],s59 offen offset:1088 lds
 v_mfma_f32_16x16x32_bf16 v[72:75],a[128:131],a[8:11],v[88:91]
 v_exp_f32 v68,v68
 v_mfma_f32_16x16x32_bf16 v[72:75],a[132:135],a[40:43],v[72:75]
 ds_read_b64_tr_b16 a[160:161],v24 offset:35200
 v_cvt_pk_bf16_f32 v101,v66,v67
 v_mfma_f32_16x16x32_bf16 v[72:75],a[136:139],a[72:75],v[72:75]
 v_exp_f32 v69,v69
 v_mfma_f32_16x16x32_bf16 v[72:75],a[140:143],a[104:107],v[72:75]
 ds_read_b128 a[156:159],v20 offset:36032
 v_sub_u32 v20,v25,v20
 v_mfma_f32_16x16x32_bf16 v[144:147],a[164:167],v[96:99],v[144:147]
 v_exp_f32 v70,v70
 v_mfma_f32_16x16x32_bf16 v[148:151],a[164:167],v[104:107],v[148:151]
 ds_read_b64_tr_b16 a[162:163],v24 offset:35456
 v_cvt_pk_bf16_f32 v108,v68,v69
 v_mfma_f32_16x16x32_bf16 v[152:155],a[164:167],v[112:115],v[152:155]
 v_exp_f32 v71,v71
 v_mfma_f32_16x16x32_bf16 v[156:159],a[164:167],v[120:123],v[156:159]
 buffer_load_dwordx4 v18,s[24:27],s59 offen offset:2176 lds
 v_mfma_f32_16x16x32_bf16 v[76:79],a[128:131],a[12:15],v[92:95]
 v_exp_f32 v72,v72
 v_mfma_f32_16x16x32_bf16 v[76:79],a[132:135],a[44:47],v[76:79]
 ds_read_b64_tr_b16 a[164:165],v24 offset:35232
 v_cvt_pk_bf16_f32 v109,v70,v71
 v_mfma_f32_16x16x32_bf16 v[76:79],a[136:139],a[76:79],v[76:79]
 v_exp_f32 v73,v73
 v_mfma_f32_16x16x32_bf16 v[76:79],a[140:143],a[108:111],v[76:79]
 ds_read_b128 a[128:131],v20 offset:0
 s_waitcnt lgkmcnt(3)
 v_mfma_f32_16x16x32_bf16 v[160:163],a[168:171],v[96:99],v[160:163]
 v_exp_f32 v74,v74
 v_mfma_f32_16x16x32_bf16 v[164:167],a[168:171],v[104:107],v[164:167]
 ds_read_b64_tr_b16 a[166:167],v24 offset:35488
 v_cvt_pk_bf16_f32 v116,v72,v73
 v_mfma_f32_16x16x32_bf16 v[168:171],a[168:171],v[112:115],v[168:171]
 v_exp_f32 v75,v75
 v_mfma_f32_16x16x32_bf16 v[172:175],a[168:171],v[120:123],v[172:175]
 buffer_load_dwordx4 v19,s[24:27],s59 offen offset:3264 lds
 s_waitcnt vmcnt(9)
 v_mfma_f32_16x16x32_bf16 v[64:67],a[144:147],a[0:3],v[80:83]
 v_exp_f32 v76,v76
 v_mfma_f32_16x16x32_bf16 v[64:67],a[148:151],a[32:35],v[64:67]
 ds_read_b64_tr_b16 a[168:169],v24 offset:35264
 v_cvt_pk_bf16_f32 v117,v74,v75
 v_mfma_f32_16x16x32_bf16 v[64:67],a[152:155],a[64:67],v[64:67]
 v_exp_f32 v77,v77
 v_mfma_f32_16x16x32_bf16 v[64:67],a[156:159],a[96:99],v[64:67]
 ds_read_b128 a[132:135],v20 offset:64
 v_sub_u32_dpp v28,v28,v28 quad_perm:[0,0,0,0] row_mask:0xf bank_mask:0xf
 v_mfma_f32_16x16x32_bf16 v[176:179],a[172:175],v[96:99],v[176:179]
 v_exp_f32 v78,v78
 v_mfma_f32_16x16x32_bf16 v[180:183],a[172:175],v[104:107],v[180:183]
 ds_read_b64_tr_b16 a[170:171],v24 offset:35520
 v_cvt_pk_bf16_f32 v124,v76,v77
 v_mfma_f32_16x16x32_bf16 v[184:187],a[172:175],v[112:115],v[184:187]
 v_exp_f32 v79,v79
 v_mfma_f32_16x16x32_bf16 v[188:191],a[172:175],v[120:123],v[188:191]
 v_readfirstlane_b32 s82,v43
 v_med3_i32 v28,v28,0,10
 v_mfma_f32_16x16x32_bf16 v[68:71],a[144:147],a[4:7],v[84:87]
 v_exp_f32 v64,v64
 v_mfma_f32_16x16x32_bf16 v[68:71],a[148:151],a[36:39],v[68:71]
 ds_read_b64_tr_b16 a[172:173],v24 offset:35296
 v_cvt_pk_bf16_f32 v125,v78,v79
 v_mfma_f32_16x16x32_bf16 v[68:71],a[152:155],a[68:71],v[68:71]
 v_exp_f32 v65,v65
 v_mfma_f32_16x16x32_bf16 v[68:71],a[156:159],a[100:103],v[68:71]
 ds_read_b128 a[136:139],v20 offset:128
 s_waitcnt lgkmcnt(3)
 v_mfma_f32_16x16x32_bf16 v[192:195],a[160:163],v[96:99],v[192:195]
 v_exp_f32 v66,v66
 v_mfma_f32_16x16x32_bf16 v[196:199],a[160:163],v[104:107],v[196:199]
 ds_read_b64_tr_b16 a[174:175],v24 offset:35552
 v_cvt_pk_bf16_f32 v102,v64,v65
 v_mfma_f32_16x16x32_bf16 v[200:203],a[160:163],v[112:115],v[200:203]
 v_exp_f32 v67,v67
 v_mfma_f32_16x16x32_bf16 v[204:207],a[160:163],v[120:123],v[204:207]
 s_add_u32 s57,s57,8192
 v_add_u32 v42,0x30201000,v43
 v_mfma_f32_16x16x32_bf16 v[72:75],a[144:147],a[8:11],v[88:91]
 v_exp_f32 v68,v68
 v_mfma_f32_16x16x32_bf16 v[72:75],a[148:151],a[40:43],v[72:75]
 ds_read_b64_tr_b16 a[160:161],v24 offset:43840
 v_cvt_pk_bf16_f32 v103,v66,v67
 v_mfma_f32_16x16x32_bf16 v[72:75],a[152:155],a[72:75],v[72:75]
 v_exp_f32 v69,v69
 v_mfma_f32_16x16x32_bf16 v[72:75],a[156:159],a[104:107],v[72:75]
 ds_read_b128 a[140:143],v20 offset:192
 s_mov_b32 s57,s71
 v_mfma_f32_16x16x32_bf16 v[208:211],a[164:167],v[96:99],v[208:211]
 v_exp_f32 v70,v70
 v_mfma_f32_16x16x32_bf16 v[212:215],a[164:167],v[104:107],v[212:215]
 ds_read_b64_tr_b16 a[162:163],v24 offset:44096
 v_cvt_pk_bf16_f32 v110,v68,v69
 v_mfma_f32_16x16x32_bf16 v[216:219],a[164:167],v[112:115],v[216:219]
 v_exp_f32 v71,v71
 v_mfma_f32_16x16x32_bf16 v[220:223],a[164:167],v[120:123],v[220:223]
 buffer_load_dwordx4 a[16:19],v4,s[8:11],s57 offen offset:0 sc1
 v_smfmac_f32_16x16x64_bf16 a[176:179],v[60:63],v[96:103],v30
 v_add_u32_dpp v27,v28,v28 quad_perm:[1,0,3,2] row_mask:0xf bank_mask:0xf
 v_mfma_f32_16x16x32_bf16 v[76:79],a[144:147],a[12:15],v[92:95]
 v_exp_f32 v72,v72
 v_mfma_f32_16x16x32_bf16 v[76:79],a[148:151],a[44:47],v[76:79]
 ds_read_b64_tr_b16 a[164:165],v24 offset:43872
 v_cvt_pk_bf16_f32 v111,v70,v71
 v_mfma_f32_16x16x32_bf16 v[76:79],a[152:155],a[76:79],v[76:79]
 v_exp_f32 v73,v73
 v_mfma_f32_16x16x32_bf16 v[76:79],a[156:159],a[108:111],v[76:79]
 ds_read_b128 a[144:147],v20 offset:256
 s_waitcnt lgkmcnt(3)
 v_mfma_f32_16x16x32_bf16 v[224:227],a[168:171],v[96:99],v[224:227]
 v_exp_f32 v74,v74
 v_mfma_f32_16x16x32_bf16 v[228:231],a[168:171],v[104:107],v[228:231]
 ds_read_b64_tr_b16 a[166:167],v24 offset:44128
 v_cvt_pk_bf16_f32 v118,v72,v73
 v_mfma_f32_16x16x32_bf16 v[232:235],a[168:171],v[112:115],v[232:235]
 v_exp_f32 v75,v75
 v_mfma_f32_16x16x32_bf16 v[236:239],a[168:171],v[120:123],v[236:239]
 buffer_load_dwordx4 a[20:23],v4,s[8:11],s57 offen offset:1024 sc1
 v_mfma_f32_16x16x32_bf16 v[64:67],a[128:131],a[0:3],v[80:83]
 v_exp_f32 v76,v76
 v_mfma_f32_16x16x32_bf16 v[64:67],a[132:135],a[32:35],v[64:67]
 ds_read_b64_tr_b16 a[168:169],v24 offset:43904
 v_cvt_pk_bf16_f32 v119,v74,v75
 v_mfma_f32_16x16x32_bf16 v[64:67],a[136:139],a[64:67],v[64:67]
 v_exp_f32 v77,v77
 v_mfma_f32_16x16x32_bf16 v[64:67],a[140:143],a[96:99],v[64:67]
 ds_read_b128 a[148:151],v20 offset:320
 v_add_u32_dpp v27,v27,v27 quad_perm:[2,3,0,1] row_mask:0xf bank_mask:0xf
 v_mfma_f32_16x16x32_bf16 v[240:243],a[172:175],v[96:99],v[240:243]
 v_exp_f32 v78,v78
 v_mfma_f32_16x16x32_bf16 v[244:247],a[172:175],v[104:107],v[244:247]
 ds_read_b64_tr_b16 a[170:171],v24 offset:44160
 v_cvt_pk_bf16_f32 v126,v76,v77
 v_mfma_f32_16x16x32_bf16 v[248:251],a[172:175],v[112:115],v[248:251]
 v_exp_f32 v79,v79
 v_mfma_f32_16x16x32_bf16 v[252:255],a[172:175],v[120:123],v[252:255]
 s_and_b32 s85,s82,0x7e7e7e00
 s_cselect_b32 s85,0x1000,s99
 v_smfmac_f32_16x16x64_bf16 a[180:183],v[60:63],v[104:111],v30
 v_mad_i32_i24 v28,v28,-4,v27
 v_mfma_f32_16x16x32_bf16 v[68:71],a[128:131],a[4:7],v[84:87]
 v_exp_f32 v64,v64
 v_mfma_f32_16x16x32_bf16 v[68:71],a[132:135],a[36:39],v[68:71]
 ds_read_b64_tr_b16 a[172:173],v24 offset:43936
 v_cvt_pk_bf16_f32 v127,v78,v79
 v_mfma_f32_16x16x32_bf16 v[68:71],a[136:139],a[68:71],v[68:71]
 v_exp_f32 v65,v65
 v_mfma_f32_16x16x32_bf16 v[68:71],a[140:143],a[100:103],v[68:71]
 ds_read_b128 a[152:155],v20 offset:384
 s_waitcnt lgkmcnt(3)
 v_mfma_f32_16x16x32_bf16 v[128:131],a[160:163],v[100:103],v[128:131]
 v_exp_f32 v66,v66
 v_mfma_f32_16x16x32_bf16 v[132:135],a[160:163],v[108:111],v[132:135]
 ds_read_b64_tr_b16 a[174:175],v24 offset:44192
 v_cvt_pk_bf16_f32 v96,v64,v65
 v_mfma_f32_16x16x32_bf16 v[136:139],a[160:163],v[116:119],v[136:139]
 v_exp_f32 v67,v67
 v_mfma_f32_16x16x32_bf16 v[140:143],a[160:163],v[124:127],v[140:143]
 v_mad_i32_i24 v28,v28,5,8
 v_mfma_f32_16x16x32_bf16 v[72:75],a[128:131],a[8:11],v[88:91]
 v_exp_f32 v68,v68
 v_mfma_f32_16x16x32_bf16 v[72:75],a[132:135],a[40:43],v[72:75]
 ds_read_b64_tr_b16 a[160:161],v24 offset:43968
 v_cvt_pk_bf16_f32 v97,v66,v67
 v_mfma_f32_16x16x32_bf16 v[72:75],a[136:139],a[72:75],v[72:75]
 v_exp_f32 v69,v69
 v_mfma_f32_16x16x32_bf16 v[72:75],a[140:143],a[104:107],v[72:75]
 ds_read_b128 a[156:159],v20 offset:448
 v_ashrrev_i32 v28,4,v28
 v_mfma_f32_16x16x32_bf16 v[144:147],a[164:167],v[100:103],v[144:147]
 v_exp_f32 v70,v70
 v_mfma_f32_16x16x32_bf16 v[148:151],a[164:167],v[108:111],v[148:151]
 ds_read_b64_tr_b16 a[162:163],v24 offset:44224
 v_cvt_pk_bf16_f32 v104,v68,v69
 v_mfma_f32_16x16x32_bf16 v[152:155],a[164:167],v[116:119],v[152:155]
 v_exp_f32 v71,v71
 v_mfma_f32_16x16x32_bf16 v[156:159],a[164:167],v[124:127],v[156:159]
 buffer_load_dwordx4 a[24:27],v4,s[8:11],s57 offen offset:2048 sc1
 v_smfmac_f32_16x16x64_bf16 a[184:187],v[60:63],v[112:119],v30
 v_med3_i32 v28,v28,-5,9
 v_mfma_f32_16x16x32_bf16 v[76:79],a[128:131],a[12:15],v[92:95]
 v_exp_f32 v72,v72
 v_mfma_f32_16x16x32_bf16 v[76:79],a[132:135],a[44:47],v[76:79]
 ds_read_b64_tr_b16 a[164:165],v24 offset:44000
 v_cvt_pk_bf16_f32 v105,v70,v71
 v_mfma_f32_16x16x32_bf16 v[76:79],a[136:139],a[76:79],v[76:79]
 v_exp_f32 v73,v73
 v_mfma_f32_16x16x32_bf16 v[76:79],a[140:143],a[108:111],v[76:79]
 ds_read_b128 a[128:131],v20 offset:512
 s_waitcnt lgkmcnt(3)
 v_mfma_f32_16x16x32_bf16 v[160:163],a[168:171],v[100:103],v[160:163]
 v_exp_f32 v74,v74
 v_mfma_f32_16x16x32_bf16 v[164:167],a[168:171],v[108:111],v[164:167]
 ds_read_b64_tr_b16 a[166:167],v24 offset:44256
 v_cvt_pk_bf16_f32 v112,v72,v73
 v_mfma_f32_16x16x32_bf16 v[168:171],a[168:171],v[116:119],v[168:171]
 v_exp_f32 v75,v75
 v_mfma_f32_16x16x32_bf16 v[172:175],a[168:171],v[124:127],v[172:175]
L_w16:
 s_cbranch_execz L_w101
 buffer_load_dwordx4 a[28:31],v4,s[8:11],s57 offen offset:3072 sc1
 v_smfmac_f32_16x16x64_bf16 a[188:191],v[60:63],v[120:127],v30
 v_cmp_eq_i32 vcc,-3,v28
 v_mfma_f32_16x16x32_bf16 v[64:67],a[144:147],a[0:3],v[80:83]
 v_exp_f32 v76,v76
 v_mfma_f32_16x16x32_bf16 v[64:67],a[148:151],a[32:35],v[64:67]
 ds_read_b64_tr_b16 a[168:169],v24 offset:44032
 v_cvt_pk_bf16_f32 v113,v74,v75
 v_mfma_f32_16x16x32_bf16 v[64:67],a[152:155],a[64:67],v[64:67]
 v_exp_f32 v77,v77
 v_mfma_f32_16x16x32_bf16 v[64:67],a[156:159],a[96:99],v[64:67]
 ds_read_b128 a[132:135],v20 offset:576
 s_add_u32 s59,s59,16384
 v_mfma_f32_16x16x32_bf16 v[176:179],a[172:175],v[100:103],v[176:179]
 v_exp_f32 v78,v78
 v_mfma_f32_16x16x32_bf16 v[180:183],a[172:175],v[108:111],v[180:183]
 ds_read_b64_tr_b16 a[170:171],v24 offset:44288
 v_cvt_pk_bf16_f32 v120,v76,v77
 v_mfma_f32_16x16x32_bf16 v[184:187],a[172:175],v[116:119],v[184:187]
 v_exp_f32 v79,v79
 v_mfma_f32_16x16x32_bf16 v[188:191],a[172:175],v[124:127],v[188:191]
 s_waitcnt vmcnt(8)
 s_barrier
 v_mfma_f32_16x16x32_bf16 v[68:71],a[144:147],a[4:7],v[84:87]
 v_exp_f32 v64,v64
 v_mfma_f32_16x16x32_bf16 v[68:71],a[148:151],a[36:39],v[68:71]
 ds_read_b64_tr_b16 a[172:173],v24 offset:44064
 v_cvt_pk_bf16_f32 v121,v78,v79
 v_mfma_f32_16x16x32_bf16 v[68:71],a[152:155],a[68:71],v[68:71]
 v_exp_f32 v65,v65
 v_mfma_f32_16x16x32_bf16 v[68:71],a[156:159],a[100:103],v[68:71]
 ds_read_b128 a[136:139],v20 offset:640
 s_waitcnt lgkmcnt(3)
 v_mfma_f32_16x16x32_bf16 v[192:195],a[160:163],v[100:103],v[192:195]
 v_exp_f32 v66,v66
 v_mfma_f32_16x16x32_bf16 v[196:199],a[160:163],v[108:111],v[196:199]
 ds_read_b64_tr_b16 a[174:175],v24 offset:44320
 v_cvt_pk_bf16_f32 v98,v64,v65
 v_mfma_f32_16x16x32_bf16 v[200:203],a[160:163],v[116:119],v[200:203]
 v_exp_f32 v67,v67
 v_mfma_f32_16x16x32_bf16 v[204:207],a[160:163],v[124:127],v[204:207]
 buffer_load_dwordx4 a[48:51],v5,s[8:11],s57 offen offset:0 sc1
 v_sub_u32 v24,v26,v24
 v_mfma_f32_16x16x32_bf16 v[72:75],a[144:147],a[8:11],v[88:91]
 v_exp_f32 v68,v68
 v_mfma_f32_16x16x32_bf16 v[72:75],a[148:151],a[40:43],v[72:75]
 ds_read_b64_tr_b16 a[160:161],v24 offset:0
 v_cvt_pk_bf16_f32 v99,v66,v67
 v_mfma_f32_16x16x32_bf16 v[72:75],a[152:155],a[72:75],v[72:75]
 v_exp_f32 v69,v69
 v_mfma_f32_16x16x32_bf16 v[72:75],a[156:159],a[104:107],v[72:75]
 ds_read_b128 a[140:143],v20 offset:704
 s_add_u32 s58,s58,131072
 v_mfma_f32_16x16x32_bf16 v[208:211],a[164:167],v[100:103],v[208:211]
 v_exp_f32 v70,v70
 v_mfma_f32_16x16x32_bf16 v[212:215],a[164:167],v[108:111],v[212:215]
 ds_read_b64_tr_b16 a[162:163],v24 offset:256
 v_cvt_pk_bf16_f32 v106,v68,v69
 v_mfma_f32_16x16x32_bf16 v[216:219],a[164:167],v[116:119],v[216:219]
 v_exp_f32 v71,v71
 v_cndmask_b32 v28,v28,-4,vcc
 v_mul_lo_u32 v28,v28,v6
 s_nop 1
 v_add_u32_dpp v28,v28,v28 quad_perm:[1,0,3,2] row_mask:0xf bank_mask:0xf
 s_nop 1
 v_add_u32_dpp v28,v28,v28 quad_perm:[2,3,0,1] row_mask:0xf bank_mask:0xf
 v_sub_u32 v42,v42,v28
 s_nop 0
 v_readfirstlane_b32 s83,v42
 v_mfma_f32_16x16x32_bf16 v[220:223],a[164:167],v[124:127],v[220:223]
 buffer_atomic_cmpswap v[42:43],v29,s[44:47],s85 offen sc0 sc1
 v_mfma_f32_16x16x32_bf16 v[76:79],a[144:147],a[12:15],v[92:95]
 v_exp_f32 v72,v72
 v_mfma_f32_16x16x32_bf16 v[76:79],a[148:151],a[44:47],v[76:79]
 ds_read_b64_tr_b16 a[164:165],v24 offset:32
 v_cvt_pk_bf16_f32 v107,v70,v71
 v_mfma_f32_16x16x32_bf16 v[76:79],a[152:155],a[76:79],v[76:79]
 v_exp_f32 v73,v73
 v_mfma_f32_16x16x32_bf16 v[76:79],a[156:159],a[108:111],v[76:79]
 ds_read_b128 a[144:147],v20 offset:768
 s_waitcnt lgkmcnt(3)
 v_mfma_f32_16x16x32_bf16 v[224:227],a[168:171],v[100:103],v[224:227]
 v_exp_f32 v74,v74
 v_mfma_f32_16x16x32_bf16 v[228:231],a[168:171],v[108:111],v[228:231]
 ds_read_b64_tr_b16 a[166:167],v24 offset:288
 v_cvt_pk_bf16_f32 v114,v72,v73
 v_mfma_f32_16x16x32_bf16 v[232:235],a[168:171],v[116:119],v[232:235]
 v_exp_f32 v75,v75
 v_mfma_f32_16x16x32_bf16 v[236:239],a[168:171],v[124:127],v[236:239]
 buffer_load_dwordx4 a[52:55],v5,s[8:11],s57 offen offset:1024 sc1
 v_mfma_f32_16x16x32_bf16 v[64:67],a[128:131],a[0:3],v[80:83]
 v_exp_f32 v76,v76
 v_mfma_f32_16x16x32_bf16 v[64:67],a[132:135],a[32:35],v[64:67]
 ds_read_b64_tr_b16 a[168:169],v24 offset:64
 v_cvt_pk_bf16_f32 v115,v74,v75
 v_mfma_f32_16x16x32_bf16 v[64:67],a[136:139],a[64:67],v[64:67]
 buffer_load_dwordx4 a[56:59],v5,s[8:11],s57 offen offset:2048 sc1
 v_exp_f32 v77,v77
 v_mfma_f32_16x16x32_bf16 v[64:67],a[140:143],a[96:99],v[64:67]
 ds_read_b128 a[148:151],v20 offset:832
 s_add_u32 m0,s51,0
 v_mfma_f32_16x16x32_bf16 v[240:243],a[172:175],v[100:103],v[240:243]
 v_exp_f32 v78,v78
 v_mfma_f32_16x16x32_bf16 v[244:247],a[172:175],v[108:111],v[244:247]
 ds_read_b64_tr_b16 a[170:171],v24 offset:320
 v_cvt_pk_bf16_f32 v122,v76,v77
 v_mfma_f32_16x16x32_bf16 v[248:251],a[172:175],v[116:119],v[248:251]
 v_exp_f32 v79,v79
 v_mfma_f32_16x16x32_bf16 v[252:255],a[172:175],v[124:127],v[252:255]
 v_mfma_f32_16x16x32_bf16 v[68:71],a[128:131],a[4:7],v[84:87]
 v_exp_f32 v64,v64
 v_mfma_f32_16x16x32_bf16 v[68:71],a[132:135],a[36:39],v[68:71]
 ds_read_b64_tr_b16 a[172:173],v24 offset:96
 v_cvt_pk_bf16_f32 v123,v78,v79
 v_mfma_f32_16x16x32_bf16 v[68:71],a[136:139],a[68:71],v[68:71]
 buffer_load_dwordx4 a[60:63],v5,s[8:11],s57 offen offset:3072 sc1
 v_exp_f32 v65,v65
 v_mfma_f32_16x16x32_bf16 v[68:71],a[140:143],a[100:103],v[68:71]
 ds_read_b128 a[152:155],v20 offset:896
 s_waitcnt lgkmcnt(3)
 v_mfma_f32_16x16x32_bf16 v[128:131],a[160:163],v[96:99],v[128:131]
 v_exp_f32 v66,v66
 v_mfma_f32_16x16x32_bf16 v[132:135],a[160:163],v[104:107],v[132:135]
 ds_read_b64_tr_b16 a[174:175],v24 offset:352
 v_cvt_pk_bf16_f32 v100,v64,v65
 v_mfma_f32_16x16x32_bf16 v[136:139],a[160:163],v[112:115],v[136:139]
 v_exp_f32 v67,v67
 v_mfma_f32_16x16x32_bf16 v[140:143],a[160:163],v[120:123],v[140:143]
 buffer_load_dwordx4 v8,s[28:31],s58 offen offset:0 lds
 v_mfma_f32_16x16x32_bf16 v[72:75],a[128:131],a[8:11],v[88:91]
 v_exp_f32 v68,v68
 v_mfma_f32_16x16x32_bf16 v[72:75],a[132:135],a[40:43],v[72:75]
 ds_read_b64_tr_b16 a[160:161],v24 offset:128
 v_cvt_pk_bf16_f32 v101,v66,v67
 v_mfma_f32_16x16x32_bf16 v[72:75],a[136:139],a[72:75],v[72:75]
 buffer_load_dwordx4 v9,s[28:31],s58 offen offset:1088 lds
 v_exp_f32 v69,v69
 v_mfma_f32_16x16x32_bf16 v[72:75],a[140:143],a[104:107],v[72:75]
 ds_read_b128 a[156:159],v20 offset:960
 s_add_u32 s57,s57,8192
 v_mfma_f32_16x16x32_bf16 v[144:147],a[164:167],v[96:99],v[144:147]
 v_exp_f32 v70,v70
 v_mfma_f32_16x16x32_bf16 v[148:151],a[164:167],v[104:107],v[148:151]
 ds_read_b64_tr_b16 a[162:163],v24 offset:384
 v_cvt_pk_bf16_f32 v108,v68,v69
 v_mfma_f32_16x16x32_bf16 v[152:155],a[164:167],v[112:115],v[152:155]
 v_exp_f32 v71,v71
 v_mfma_f32_16x16x32_bf16 v[156:159],a[164:167],v[120:123],v[156:159]
 buffer_load_dwordx4 v10,s[28:31],s58 offen offset:2176 lds
 v_mfma_f32_16x16x32_bf16 v[76:79],a[128:131],a[12:15],v[92:95]
 v_exp_f32 v72,v72
 v_mfma_f32_16x16x32_bf16 v[76:79],a[132:135],a[44:47],v[76:79]
 ds_read_b64_tr_b16 a[164:165],v24 offset:160
 v_cvt_pk_bf16_f32 v109,v70,v71
 v_mfma_f32_16x16x32_bf16 v[76:79],a[136:139],a[76:79],v[76:79]
 buffer_load_dwordx4 v11,s[28:31],s58 offen offset:3264 lds
 v_exp_f32 v73,v73
 v_mfma_f32_16x16x32_bf16 v[76:79],a[140:143],a[108:111],v[76:79]
 ds_read_b128 a[128:131],v20 offset:35072
 s_waitcnt lgkmcnt(3)
 v_mfma_f32_16x16x32_bf16 v[160:163],a[168:171],v[96:99],v[160:163]
 v_exp_f32 v74,v74
 v_mfma_f32_16x16x32_bf16 v[164:167],a[168:171],v[104:107],v[164:167]
 ds_read_b64_tr_b16 a[166:167],v24 offset:416
 v_cvt_pk_bf16_f32 v116,v72,v73
 v_mfma_f32_16x16x32_bf16 v[168:171],a[168:171],v[112:115],v[168:171]
 v_exp_f32 v75,v75
 v_mfma_f32_16x16x32_bf16 v[172:175],a[168:171],v[120:123],v[172:175]
 buffer_load_dwordx4 a[80:83],v4,s[8:11],s57 offen offset:0 sc1
 v_mfma_f32_16x16x32_bf16 v[64:67],a[144:147],a[0:3],v[80:83]
 v_exp_f32 v76,v76
 v_mfma_f32_16x16x32_bf16 v[64:67],a[148:151],a[32:35],v[64:67]
 ds_read_b64_tr_b16 a[168:169],v24 offset:192
 v_cvt_pk_bf16_f32 v117,v74,v75
 v_mfma_f32_16x16x32_bf16 v[64:67],a[152:155],a[64:67],v[64:67]
 v_exp_f32 v77,v77
 v_mfma_f32_16x16x32_bf16 v[64:67],a[156:159],a[96:99],v[64:67]
 ds_read_b128 a[132:135],v20 offset:35136
 v_mfma_f32_16x16x32_bf16 v[176:179],a[172:175],v[96:99],v[176:179]
 v_exp_f32 v78,v78
 v_mfma_f32_16x16x32_bf16 v[180:183],a[172:175],v[104:107],v[180:183]
 ds_read_b64_tr_b16 a[170:171],v24 offset:448
 v_cvt_pk_bf16_f32 v124,v76,v77
 v_mfma_f32_16x16x32_bf16 v[184:187],a[172:175],v[112:115],v[184:187]
 v_exp_f32 v79,v79
 v_mfma_f32_16x16x32_bf16 v[188:191],a[172:175],v[120:123],v[188:191]
 v_mfma_f32_16x16x32_bf16 v[68:71],a[144:147],a[4:7],v[84:87]
 v_exp_f32 v64,v64
 v_mfma_f32_16x16x32_bf16 v[68:71],a[148:151],a[36:39],v[68:71]
 ds_read_b64_tr_b16 a[172:173],v24 offset:224
 v_cvt_pk_bf16_f32 v125,v78,v79
 v_mfma_f32_16x16x32_bf16 v[68:71],a[152:155],a[68:71],v[68:71]
 v_exp_f32 v65,v65
 v_mfma_f32_16x16x32_bf16 v[68:71],a[156:159],a[100:103],v[68:71]
 ds_read_b128 a[136:139],v20 offset:35200
 s_waitcnt lgkmcnt(3)
 v_mfma_f32_16x16x32_bf16 v[192:195],a[160:163],v[96:99],v[192:195]
 v_exp_f32 v66,v66
 v_mfma_f32_16x16x32_bf16 v[196:199],a[160:163],v[104:107],v[196:199]
 ds_read_b64_tr_b16 a[174:175],v24 offset:480
 v_cvt_pk_bf16_f32 v102,v64,v65
 v_mfma_f32_16x16x32_bf16 v[200:203],a[160:163],v[112:115],v[200:203]
 v_exp_f32 v67,v67
 v_mfma_f32_16x16x32_bf16 v[204:207],a[160:163],v[120:123],v[204:207]
 v_mfma_f32_16x16x32_bf16 v[72:75],a[144:147],a[8:11],v[88:91]
 v_exp_f32 v68,v68
 v_mfma_f32_16x16x32_bf16 v[72:75],a[148:151],a[40:43],v[72:75]
 ds_read_b64_tr_b16 a[160:161],v24 offset:8768
 v_cvt_pk_bf16_f32 v103,v66,v67
 v_mfma_f32_16x16x32_bf16 v[72:75],a[152:155],a[72:75],v[72:75]
 v_exp_f32 v69,v69
 v_mfma_f32_16x16x32_bf16 v[72:75],a[156:159],a[104:107],v[72:75]
 ds_read_b128 a[140:143],v20 offset:35264
 v_mfma_f32_16x16x32_bf16 v[208:211],a[164:167],v[96:99],v[208:211]
 v_exp_f32 v70,v70
 v_mfma_f32_16x16x32_bf16 v[212:215],a[164:167],v[104:107],v[212:215]
 ds_read_b64_tr_b16 a[162:163],v24 offset:9024
 v_cvt_pk_bf16_f32 v110,v68,v69
 v_mfma_f32_16x16x32_bf16 v[216:219],a[164:167],v[112:115],v[216:219]
 v_exp_f32 v71,v71
 v_mfma_f32_16x16x32_bf16 v[220:223],a[164:167],v[120:123],v[220:223]
 v_smfmac_f32_16x16x64_bf16 a[176:179],v[60:63],v[96:103],v30
 v_mfma_f32_16x16x32_bf16 v[76:79],a[144:147],a[12:15],v[92:95]
 v_exp_f32 v72,v72
 v_mfma_f32_16x16x32_bf16 v[76:79],a[148:151],a[44:47],v[76:79]
 ds_read_b64_tr_b16 a[164:165],v24 offset:8800
 v_cvt_pk_bf16_f32 v111,v70,v71
 v_mfma_f32_16x16x32_bf16 v[76:79],a[152:155],a[76:79],v[76:79]
 buffer_load_dwordx4 a[84:87],v4,s[8:11],s57 offen offset:1024 sc1
 v_exp_f32 v73,v73
 v_mfma_f32_16x16x32_bf16 v[76:79],a[156:159],a[108:111],v[76:79]
 ds_read_b128 a[144:147],v20 offset:35328
 s_waitcnt lgkmcnt(3)
 v_mfma_f32_16x16x32_bf16 v[224:227],a[168:171],v[96:99],v[224:227]
 v_exp_f32 v74,v74
 v_mfma_f32_16x16x32_bf16 v[228:231],a[168:171],v[104:107],v[228:231]
 ds_read_b64_tr_b16 a[166:167],v24 offset:9056
 v_cvt_pk_bf16_f32 v118,v72,v73
 v_mfma_f32_16x16x32_bf16 v[232:235],a[168:171],v[112:115],v[232:235]
 v_exp_f32 v75,v75
 v_mfma_f32_16x16x32_bf16 v[236:239],a[168:171],v[120:123],v[236:239]
 buffer_load_dwordx4 a[88:91],v4,s[8:11],s57 offen offset:2048 sc1
 v_mfma_f32_16x16x32_bf16 v[64:67],a[128:131],a[0:3],v[80:83]
 v_exp_f32 v76,v76
 v_mfma_f32_16x16x32_bf16 v[64:67],a[132:135],a[32:35],v[64:67]
 ds_read_b64_tr_b16 a[168:169],v24 offset:8832
 v_cvt_pk_bf16_f32 v119,v74,v75
 v_mfma_f32_16x16x32_bf16 v[64:67],a[136:139],a[64:67],v[64:67]
 buffer_load_dwordx4 a[92:95],v4,s[8:11],s57 offen offset:3072 sc1
 v_exp_f32 v77,v77
 v_mfma_f32_16x16x32_bf16 v[64:67],a[140:143],a[96:99],v[64:67]
 ds_read_b128 a[148:151],v20 offset:35392
 v_mfma_f32_16x16x32_bf16 v[240:243],a[172:175],v[96:99],v[240:243]
 v_exp_f32 v78,v78
 v_mfma_f32_16x16x32_bf16 v[244:247],a[172:175],v[104:107],v[244:247]
 ds_read_b64_tr_b16 a[170:171],v24 offset:9088
 v_cvt_pk_bf16_f32 v126,v76,v77
 v_mfma_f32_16x16x32_bf16 v[248:251],a[172:175],v[112:115],v[248:251]
 v_exp_f32 v79,v79
 v_mfma_f32_16x16x32_bf16 v[252:255],a[172:175],v[120:123],v[252:255]
 buffer_load_dwordx4 a[112:115],v5,s[8:11],s57 offen offset:0 sc1
 v_smfmac_f32_16x16x64_bf16 a[180:183],v[60:63],v[104:111],v30
 s_add_u32 s58,s58,131072
 v_mfma_f32_16x16x32_bf16 v[68:71],a[128:131],a[4:7],v[84:87]
 v_exp_f32 v64,v64
 v_mfma_f32_16x16x32_bf16 v[68:71],a[132:135],a[36:39],v[68:71]
 ds_read_b64_tr_b16 a[172:173],v24 offset:8864
 v_cvt_pk_bf16_f32 v127,v78,v79
 v_mfma_f32_16x16x32_bf16 v[68:71],a[136:139],a[68:71],v[68:71]
 buffer_load_dwordx4 a[116:119],v5,s[8:11],s57 offen offset:1024 sc1
 v_exp_f32 v65,v65
 v_mfma_f32_16x16x32_bf16 v[68:71],a[140:143],a[100:103],v[68:71]
 ds_read_b128 a[152:155],v20 offset:35456
 s_waitcnt lgkmcnt(3)
 v_mfma_f32_16x16x32_bf16 v[128:131],a[160:163],v[100:103],v[128:131]
 v_exp_f32 v66,v66
 v_mfma_f32_16x16x32_bf16 v[132:135],a[160:163],v[108:111],v[132:135]
 ds_read_b64_tr_b16 a[174:175],v24 offset:9120
 v_cvt_pk_bf16_f32 v96,v64,v65
 v_mfma_f32_16x16x32_bf16 v[136:139],a[160:163],v[116:119],v[136:139]
 v_exp_f32 v67,v67
 v_mfma_f32_16x16x32_bf16 v[140:143],a[160:163],v[124:127],v[140:143]
 buffer_load_dwordx4 a[120:123],v5,s[8:11],s57 offen offset:2048 sc1
 v_mfma_f32_16x16x32_bf16 v[72:75],a[128:131],a[8:11],v[88:91]
 v_exp_f32 v68,v68
 v_mfma_f32_16x16x32_bf16 v[72:75],a[132:135],a[40:43],v[72:75]
 ds_read_b64_tr_b16 a[160:161],v24 offset:8896
 v_cvt_pk_bf16_f32 v97,v66,v67
 v_mfma_f32_16x16x32_bf16 v[72:75],a[136:139],a[72:75],v[72:75]
 v_exp_f32 v69,v69
 v_mfma_f32_16x16x32_bf16 v[72:75],a[140:143],a[104:107],v[72:75]
 ds_read_b128 a[156:159],v20 offset:35520
 s_add_u32 m0,s51,35072
 v_mfma_f32_16x16x32_bf16 v[144:147],a[164:167],v[100:103],v[144:147]
 v_exp_f32 v70,v70
 v_mfma_f32_16x16x32_bf16 v[148:151],a[164:167],v[108:111],v[148:151]
 ds_read_b64_tr_b16 a[162:163],v24 offset:9152
 v_cvt_pk_bf16_f32 v104,v68,v69
 v_mfma_f32_16x16x32_bf16 v[152:155],a[164:167],v[116:119],v[152:155]
 v_exp_f32 v71,v71
 v_mfma_f32_16x16x32_bf16 v[156:159],a[164:167],v[124:127],v[156:159]
 buffer_load_dwordx4 a[124:127],v5,s[8:11],s57 offen offset:3072 sc1
 v_smfmac_f32_16x16x64_bf16 a[184:187],v[60:63],v[112:119],v30
 buffer_load_dwordx4 v8,s[28:31],s58 offen offset:0 lds
 v_mfma_f32_16x16x32_bf16 v[76:79],a[128:131],a[12:15],v[92:95]
 v_exp_f32 v72,v72
 v_mfma_f32_16x16x32_bf16 v[76:79],a[132:135],a[44:47],v[76:79]
 ds_read_b64_tr_b16 a[164:165],v24 offset:8928
 v_cvt_pk_bf16_f32 v105,v70,v71
 v_mfma_f32_16x16x32_bf16 v[76:79],a[136:139],a[76:79],v[76:79]
 v_exp_f32 v73,v73
 v_mfma_f32_16x16x32_bf16 v[76:79],a[140:143],a[108:111],v[76:79]
 ds_read_b128 a[128:131],v20 offset:35584
 s_waitcnt lgkmcnt(3)
 v_mfma_f32_16x16x32_bf16 v[160:163],a[168:171],v[100:103],v[160:163]
 v_exp_f32 v74,v74
 v_mfma_f32_16x16x32_bf16 v[164:167],a[168:171],v[108:111],v[164:167]
 ds_read_b64_tr_b16 a[166:167],v24 offset:9184
 v_cvt_pk_bf16_f32 v112,v72,v73
 v_mfma_f32_16x16x32_bf16 v[168:171],a[168:171],v[116:119],v[168:171]
 v_exp_f32 v75,v75
 v_mfma_f32_16x16x32_bf16 v[172:175],a[168:171],v[124:127],v[172:175]
 buffer_load_dwordx4 v9,s[28:31],s58 offen offset:1088 lds
 v_smfmac_f32_16x16x64_bf16 a[188:191],v[60:63],v[120:127],v30
 v_mfma_f32_16x16x32_bf16 v[64:67],a[144:147],a[0:3],v[80:83]
 v_exp_f32 v76,v76
 v_mfma_f32_16x16x32_bf16 v[64:67],a[148:151],a[32:35],v[64:67]
 ds_read_b64_tr_b16 a[168:169],v24 offset:8960
 v_cvt_pk_bf16_f32 v113,v74,v75
 v_mfma_f32_16x16x32_bf16 v[64:67],a[152:155],a[64:67],v[64:67]
 buffer_load_dwordx4 v10,s[28:31],s58 offen offset:2176 lds
 v_exp_f32 v77,v77
 v_mfma_f32_16x16x32_bf16 v[64:67],a[156:159],a[96:99],v[64:67]
 ds_read_b128 a[132:135],v20 offset:35648
 s_add_u32 s57,s57,8192
 v_mfma_f32_16x16x32_bf16 v[176:179],a[172:175],v[100:103],v[176:179]
 v_exp_f32 v78,v78
 v_mfma_f32_16x16x32_bf16 v[180:183],a[172:175],v[108:111],v[180:183]
 ds_read_b64_tr_b16 a[170:171],v24 offset:9216
 v_cvt_pk_bf16_f32 v120,v76,v77
 v_mfma_f32_16x16x32_bf16 v[184:187],a[172:175],v[116:119],v[184:187]
 v_exp_f32 v79,v79
 v_mfma_f32_16x16x32_bf16 v[188:191],a[172:175],v[124:127],v[188:191]
 s_waitcnt vmcnt(24)
 s_barrier
 v_mfma_f32_16x16x32_bf16 v[68:71],a[144:147],a[4:7],v[84:87]
 v_exp_f32 v64,v64
 v_mfma_f32_16x16x32_bf16 v[68:71],a[148:151],a[36:39],v[68:71]
 ds_read_b64_tr_b16 a[172:173],v24 offset:8992
 v_cvt_pk_bf16_f32 v121,v78,v79
 v_mfma_f32_16x16x32_bf16 v[68:71],a[152:155],a[68:71],v[68:71]
 buffer_load_dwordx4 v11,s[28:31],s58 offen offset:3264 lds
 v_exp_f32 v65,v65
 v_mfma_f32_16x16x32_bf16 v[68:71],a[156:159],a[100:103],v[68:71]
 ds_read_b128 a[136:139],v20 offset:35712
 s_waitcnt lgkmcnt(3)
 v_mfma_f32_16x16x32_bf16 v[192:195],a[160:163],v[100:103],v[192:195]
 v_exp_f32 v66,v66
 v_mfma_f32_16x16x32_bf16 v[196:199],a[160:163],v[108:111],v[196:199]
 ds_read_b64_tr_b16 a[174:175],v24 offset:9248
 v_cvt_pk_bf16_f32 v98,v64,v65
 v_mfma_f32_16x16x32_bf16 v[200:203],a[160:163],v[116:119],v[200:203]
 v_exp_f32 v67,v67
 v_mfma_f32_16x16x32_bf16 v[204:207],a[160:163],v[124:127],v[204:207]
 buffer_load_dwordx4 a[192:195],v4,s[8:11],s57 offen offset:0 sc1
 v_mfma_f32_16x16x32_bf16 v[72:75],a[144:147],a[8:11],v[88:91]
 v_exp_f32 v68,v68
 v_mfma_f32_16x16x32_bf16 v[72:75],a[148:151],a[40:43],v[72:75]
 ds_read_b64_tr_b16 a[160:161],v24 offset:35072
 v_cvt_pk_bf16_f32 v99,v66,v67
 v_mfma_f32_16x16x32_bf16 v[72:75],a[152:155],a[72:75],v[72:75]
 buffer_load_dwordx4 a[196:199],v4,s[8:11],s57 offen offset:1024 sc1
 v_exp_f32 v69,v69
 v_mfma_f32_16x16x32_bf16 v[72:75],a[156:159],a[104:107],v[72:75]
 ds_read_b128 a[140:143],v20 offset:35776
 v_mfma_f32_16x16x32_bf16 v[208:211],a[164:167],v[100:103],v[208:211]
 v_exp_f32 v70,v70
 v_mfma_f32_16x16x32_bf16 v[212:215],a[164:167],v[108:111],v[212:215]
 ds_read_b64_tr_b16 a[162:163],v24 offset:35328
 v_cvt_pk_bf16_f32 v106,v68,v69
 v_mfma_f32_16x16x32_bf16 v[216:219],a[164:167],v[116:119],v[216:219]
 v_exp_f32 v71,v71
 v_mfma_f32_16x16x32_bf16 v[220:223],a[164:167],v[124:127],v[220:223]
 buffer_load_dwordx4 a[200:203],v4,s[8:11],s57 offen offset:2048 sc1
 v_mfma_f32_16x16x32_bf16 v[76:79],a[144:147],a[12:15],v[92:95]
 v_exp_f32 v72,v72
 v_mfma_f32_16x16x32_bf16 v[76:79],a[148:151],a[44:47],v[76:79]
 ds_read_b64_tr_b16 a[164:165],v24 offset:35104
 v_cvt_pk_bf16_f32 v107,v70,v71
 v_mfma_f32_16x16x32_bf16 v[76:79],a[152:155],a[76:79],v[76:79]
 buffer_load_dwordx4 a[204:207],v4,s[8:11],s57 offen offset:3072 sc1
 v_exp_f32 v73,v73
 v_mfma_f32_16x16x32_bf16 v[76:79],a[156:159],a[108:111],v[76:79]
 ds_read_b128 a[144:147],v20 offset:35840
 s_waitcnt lgkmcnt(3)
 v_mfma_f32_16x16x32_bf16 v[224:227],a[168:171],v[100:103],v[224:227]
 v_exp_f32 v74,v74
 v_mfma_f32_16x16x32_bf16 v[228:231],a[168:171],v[108:111],v[228:231]
 ds_read_b64_tr_b16 a[166:167],v24 offset:35360
 v_cvt_pk_bf16_f32 v114,v72,v73
 v_mfma_f32_16x16x32_bf16 v[232:235],a[168:171],v[116:119],v[232:235]
 v_exp_f32 v75,v75
 v_mfma_f32_16x16x32_bf16 v[236:239],a[168:171],v[124:127],v[236:239]
 buffer_load_dwordx4 a[208:211],v5,s[8:11],s57 offen offset:0 sc1
 v_mfma_f32_16x16x32_bf16 v[64:67],a[128:131],a[0:3],v[80:83]
 v_exp_f32 v76,v76
 v_mfma_f32_16x16x32_bf16 v[64:67],a[132:135],a[32:35],v[64:67]
 ds_read_b64_tr_b16 a[168:169],v24 offset:35136
 v_cvt_pk_bf16_f32 v115,v74,v75
 v_mfma_f32_16x16x32_bf16 v[64:67],a[136:139],a[64:67],v[64:67]
 buffer_load_dwordx4 a[212:215],v5,s[8:11],s57 offen offset:1024 sc1
 v_exp_f32 v77,v77
 v_mfma_f32_16x16x32_bf16 v[64:67],a[140:143],a[96:99],v[64:67]
 ds_read_b128 a[148:151],v20 offset:35904
 s_add_u32 s58,s58,131072
 v_mfma_f32_16x16x32_bf16 v[240:243],a[172:175],v[100:103],v[240:243]
 v_exp_f32 v78,v78
 v_mfma_f32_16x16x32_bf16 v[244:247],a[172:175],v[108:111],v[244:247]
 ds_read_b64_tr_b16 a[170:171],v24 offset:35392
 v_cvt_pk_bf16_f32 v122,v76,v77
 v_mfma_f32_16x16x32_bf16 v[248:251],a[172:175],v[116:119],v[248:251]
 v_exp_f32 v79,v79
 v_mfma_f32_16x16x32_bf16 v[252:255],a[172:175],v[124:127],v[252:255]
 buffer_load_dwordx4 a[216:219],v5,s[8:11],s57 offen offset:2048 sc1
 v_mfma_f32_16x16x32_bf16 v[68:71],a[128:131],a[4:7],v[84:87]
 v_exp_f32 v64,v64
 v_mfma_f32_16x16x32_bf16 v[68:71],a[132:135],a[36:39],v[68:71]
 ds_read_b64_tr_b16 a[172:173],v24 offset:35168
 v_cvt_pk_bf16_f32 v123,v78,v79
 v_mfma_f32_16x16x32_bf16 v[68:71],a[136:139],a[68:71],v[68:71]
 v_exp_f32 v65,v65
 v_mfma_f32_16x16x32_bf16 v[68:71],a[140:143],a[100:103],v[68:71]
 ds_read_b128 a[152:155],v20 offset:35968
 s_waitcnt lgkmcnt(3)
 v_mfma_f32_16x16x32_bf16 v[128:131],a[160:163],v[96:99],v[128:131]
 v_exp_f32 v66,v66
 v_mfma_f32_16x16x32_bf16 v[132:135],a[160:163],v[104:107],v[132:135]
 ds_read_b64_tr_b16 a[174:175],v24 offset:35424
 v_cvt_pk_bf16_f32 v100,v64,v65
 v_mfma_f32_16x16x32_bf16 v[136:139],a[160:163],v[112:115],v[136:139]
 v_exp_f32 v67,v67
 v_mfma_f32_16x16x32_bf16 v[140:143],a[160:163],v[120:123],v[140:143]
 buffer_load_dwordx4 a[220:223],v5,s[8:11],s57 offen offset:3072 sc1
 v_mfma_f32_16x16x32_bf16 v[72:75],a[128:131],a[8:11],v[88:91]
 v_exp_f32 v68,v68
 v_mfma_f32_16x16x32_bf16 v[72:75],a[132:135],a[40:43],v[72:75]
 ds_read_b64_tr_b16 a[160:161],v24 offset:35200
 v_cvt_pk_bf16_f32 v101,v66,v67
 v_mfma_f32_16x16x32_bf16 v[72:75],a[136:139],a[72:75],v[72:75]
 v_exp_f32 v69,v69
 v_mfma_f32_16x16x32_bf16 v[72:75],a[140:143],a[104:107],v[72:75]
 ds_read_b128 a[156:159],v20 offset:36032
 s_add_u32 m0,s51,17536
 v_mfma_f32_16x16x32_bf16 v[144:147],a[164:167],v[96:99],v[144:147]
 v_exp_f32 v70,v70
 v_mfma_f32_16x16x32_bf16 v[148:151],a[164:167],v[104:107],v[148:151]
 ds_read_b64_tr_b16 a[162:163],v24 offset:35456
 v_cvt_pk_bf16_f32 v108,v68,v69
 v_mfma_f32_16x16x32_bf16 v[152:155],a[164:167],v[112:115],v[152:155]
 v_exp_f32 v71,v71
 v_mfma_f32_16x16x32_bf16 v[156:159],a[164:167],v[120:123],v[156:159]
 buffer_load_dwordx4 v8,s[28:31],s58 offen offset:0 lds
 v_mfma_f32_16x16x32_bf16 v[76:79],a[128:131],a[12:15],v[92:95]
 v_exp_f32 v72,v72
 v_mfma_f32_16x16x32_bf16 v[76:79],a[132:135],a[44:47],v[76:79]
 ds_read_b64_tr_b16 a[164:165],v24 offset:35232
 v_cvt_pk_bf16_f32 v109,v70,v71
 v_mfma_f32_16x16x32_bf16 v[76:79],a[136:139],a[76:79],v[76:79]
 buffer_load_dwordx4 v9,s[28:31],s58 offen offset:1088 lds
 v_exp_f32 v73,v73
 v_mfma_f32_16x16x32_bf16 v[76:79],a[140:143],a[108:111],v[76:79]
 s_waitcnt lgkmcnt(2)
 v_mfma_f32_16x16x32_bf16 v[160:163],a[168:171],v[96:99],v[160:163]
 v_exp_f32 v74,v74
 v_mfma_f32_16x16x32_bf16 v[164:167],a[168:171],v[104:107],v[164:167]
 ds_read_b64_tr_b16 a[166:167],v24 offset:35488
 v_cvt_pk_bf16_f32 v116,v72,v73
 v_mfma_f32_16x16x32_bf16 v[168:171],a[168:171],v[112:115],v[168:171]
 v_exp_f32 v75,v75
 v_mfma_f32_16x16x32_bf16 v[172:175],a[168:171],v[120:123],v[172:175]
 buffer_load_dwordx4 v10,s[28:31],s58 offen offset:2176 lds
 v_mfma_f32_16x16x32_bf16 v[64:67],a[144:147],a[0:3],v[80:83]
 v_exp_f32 v76,v76
 v_mfma_f32_16x16x32_bf16 v[64:67],a[148:151],a[32:35],v[64:67]
 ds_read_b64_tr_b16 a[168:169],v24 offset:35264
 v_cvt_pk_bf16_f32 v117,v74,v75
 v_mfma_f32_16x16x32_bf16 v[64:67],a[152:155],a[64:67],v[64:67]
 buffer_load_dwordx4 v11,s[28:31],s58 offen offset:3264 lds
 v_exp_f32 v77,v77
 s_barrier
 v_mfma_f32_16x16x32_bf16 v[64:67],a[156:159],a[96:99],v[64:67]
 ds_read_b64_tr_b16 a[128:129],v23 offset:35072
 v_mfma_f32_16x16x32_bf16 v[176:179],a[172:175],v[96:99],v[176:179]
 v_exp_f32 v78,v78
 v_mfma_f32_16x16x32_bf16 v[180:183],a[172:175],v[104:107],v[180:183]
 ds_read_b64_tr_b16 a[170:171],v24 offset:35520
 v_cvt_pk_bf16_f32 v124,v76,v77
 v_mfma_f32_16x16x32_bf16 v[184:187],a[172:175],v[112:115],v[184:187]
 v_exp_f32 v79,v79
 v_mfma_f32_16x16x32_bf16 v[188:191],a[172:175],v[120:123],v[188:191]
 ds_read_b64_tr_b16 a[130:131],v23 offset:35328
 s_add_u32 s57,s57,8192
 v_mfma_f32_16x16x32_bf16 v[68:71],a[144:147],a[4:7],v[84:87]
 v_exp_f32 v64,v64
 v_mfma_f32_16x16x32_bf16 v[68:71],a[148:151],a[36:39],v[68:71]
 ds_read_b64_tr_b16 a[172:173],v24 offset:35296
 v_cvt_pk_bf16_f32 v125,v78,v79
 v_mfma_f32_16x16x32_bf16 v[68:71],a[152:155],a[68:71],v[68:71]
 buffer_load_dwordx4 a[224:227],v4,s[8:11],s57 offen offset:0 sc1
 v_exp_f32 v65,v65
 v_mfma_f32_16x16x32_bf16 v[68:71],a[156:159],a[100:103],v[68:71]
 ds_read_b64_tr_b16 a[132:133],v23 offset:43840
 s_waitcnt lgkmcnt(6)
 v_mfma_f32_16x16x32_bf16 v[192:195],a[160:163],v[96:99],v[192:195]
 v_exp_f32 v66,v66
 v_mfma_f32_16x16x32_bf16 v[196:199],a[160:163],v[104:107],v[196:199]
 ds_read_b64_tr_b16 a[174:175],v24 offset:35552
 v_cvt_pk_bf16_f32 v102,v64,v65
 v_mfma_f32_16x16x32_bf16 v[200:203],a[160:163],v[112:115],v[200:203]
 v_exp_f32 v67,v67
 v_mfma_f32_16x16x32_bf16 v[204:207],a[160:163],v[120:123],v[204:207]
 ds_read_b64_tr_b16 a[134:135],v23 offset:44096
 v_mfma_f32_16x16x32_bf16 v[72:75],a[144:147],a[8:11],v[88:91]
 v_exp_f32 v68,v68
 v_mfma_f32_16x16x32_bf16 v[72:75],a[148:151],a[40:43],v[72:75]
 ds_read_b64_tr_b16 a[160:161],v24 offset:43840
 v_cvt_pk_bf16_f32 v103,v66,v67
 v_mfma_f32_16x16x32_bf16 v[72:75],a[152:155],a[72:75],v[72:75]
 buffer_load_dwordx4 a[228:231],v4,s[8:11],s57 offen offset:1024 sc1
 v_exp_f32 v69,v69
 v_mfma_f32_16x16x32_bf16 v[72:75],a[156:159],a[104:107],v[72:75]
 ds_read_b64_tr_b16 a[136:137],v23 offset:35104
 v_mfma_f32_16x16x32_bf16 v[208:211],a[164:167],v[96:99],v[208:211]
 v_exp_f32 v70,v70
 v_mfma_f32_16x16x32_bf16 v[212:215],a[164:167],v[104:107],v[212:215]
 ds_read_b64_tr_b16 a[162:163],v24 offset:44096
 v_cvt_pk_bf16_f32 v110,v68,v69
 v_mfma_f32_16x16x32_bf16 v[216:219],a[164:167],v[112:115],v[216:219]
 v_exp_f32 v71,v71
 v_mfma_f32_16x16x32_bf16 v[220:223],a[164:167],v[120:123],v[220:223]
 ds_read_b64_tr_b16 a[138:139],v23 offset:35360
 v_smfmac_f32_16x16x64_bf16 a[176:179],v[60:63],v[96:103],v30
 ds_read_b64_tr_b16 a[140:141],v23 offset:43872
 v_mfma_f32_16x16x32_bf16 v[76:79],a[144:147],a[12:15],v[92:95]
 v_exp_f32 v72,v72
 v_mfma_f32_16x16x32_bf16 v[76:79],a[148:151],a[44:47],v[76:79]
 ds_read_b64_tr_b16 a[164:165],v24 offset:43872
 v_cvt_pk_bf16_f32 v111,v70,v71
 v_mfma_f32_16x16x32_bf16 v[76:79],a[152:155],a[76:79],v[76:79]
 buffer_load_dwordx4 a[232:235],v4,s[8:11],s57 offen offset:2048 sc1
 v_exp_f32 v73,v73
 v_mfma_f32_16x16x32_bf16 v[76:79],a[156:159],a[108:111],v[76:79]
 ds_read_b64_tr_b16 a[142:143],v23 offset:44128
 s_waitcnt lgkmcnt(8)
 v_mfma_f32_16x16x32_bf16 v[224:227],a[168:171],v[96:99],v[224:227]
 v_exp_f32 v74,v74
 v_mfma_f32_16x16x32_bf16 v[228:231],a[168:171],v[104:107],v[228:231]
 ds_read_b64_tr_b16 a[166:167],v24 offset:44128
 v_cvt_pk_bf16_f32 v118,v72,v73
 v_mfma_f32_16x16x32_bf16 v[232:235],a[168:171],v[112:115],v[232:235]
 v_exp_f32 v75,v75
 v_mfma_f32_16x16x32_bf16 v[236:239],a[168:171],v[120:123],v[236:239]
 s_waitcnt vmcnt(31)
 s_waitcnt lgkmcnt(8)
 v_mfma_f32_16x16x32_bf16 a[0:3],a[128:131],a[16:19],0
 v_exp_f32 v76,v76
 v_mfma_f32_16x16x32_bf16 a[0:3],a[132:135],a[20:23],a[0:3]
 ds_read_b64_tr_b16 a[168:169],v24 offset:43904
 v_cvt_pk_bf16_f32 v119,v74,v75
 v_mfma_f32_16x16x32_bf16 a[4:7],a[128:131],a[24:27],0
 v_exp_f32 v77,v77
 v_mfma_f32_16x16x32_bf16 a[4:7],a[132:135],a[28:31],a[4:7]
 ds_read_b64_tr_b16 a[144:145],v23 offset:35136
 v_mov_b32 v37,163328
 v_mfma_f32_16x16x32_bf16 v[240:243],a[172:175],v[96:99],v[240:243]
 v_exp_f32 v78,v78
 v_mfma_f32_16x16x32_bf16 v[244:247],a[172:175],v[104:107],v[244:247]
 ds_read_b64_tr_b16 a[170:171],v24 offset:44160
 v_cvt_pk_bf16_f32 v126,v76,v77
 v_mfma_f32_16x16x32_bf16 v[248:251],a[172:175],v[112:115],v[248:251]
 v_exp_f32 v79,v79
 v_mfma_f32_16x16x32_bf16 v[252:255],a[172:175],v[120:123],v[252:255]
 ds_read_b64_tr_b16 a[146:147],v23 offset:35392
 v_lshl_add_u32 v36,s48,2,v37
L_w17:
 s_cbranch_execz L_w102
 v_smfmac_f32_16x16x64_bf16 a[180:183],v[60:63],v[104:111],v30
 ds_read_b64_tr_b16 a[148:149],v23 offset:43904
 v_mfma_f32_16x16x32_bf16 a[8:11],a[128:131],a[48:51],0
 ds_read_b64_tr_b16 a[150:151],v23 offset:44160
 v_min_u32 v38,2,v1
 v_mfma_f32_16x16x32_bf16 a[8:11],a[132:135],a[52:55],a[8:11]
 ds_read_b64_tr_b16 a[172:173],v24 offset:43936
 v_cvt_pk_bf16_f32 v127,v78,v79
 v_mfma_f32_16x16x32_bf16 a[12:15],a[128:131],a[56:59],0
 ds_read_b64_tr_b16 a[152:153],v23 offset:35168
 v_add_u32 v38,1,v38
 v_mfma_f32_16x16x32_bf16 a[12:15],a[132:135],a[60:63],a[12:15]
 ds_read_b64_tr_b16 a[154:155],v23 offset:35424
 s_waitcnt lgkmcnt(9)
 v_mfma_f32_16x16x32_bf16 v[128:131],a[160:163],v[100:103],v[128:131]
 ds_read_b64_tr_b16 a[156:157],v23 offset:43936
 v_lshlrev_b32 v33,4,v38
 v_mfma_f32_16x16x32_bf16 v[132:135],a[160:163],v[108:111],v[132:135]
 ds_read_b64_tr_b16 a[174:175],v24 offset:44192
 v_xor_b32 v33,s76,v33
 v_mfma_f32_16x16x32_bf16 v[136:139],a[160:163],v[116:119],v[136:139]
 ds_read_b64_tr_b16 a[158:159],v23 offset:44192
 v_add_u32 v38,4096,v33
 v_mfma_f32_16x16x32_bf16 v[140:143],a[160:163],v[124:127],v[140:143]
 buffer_load_dwordx4 a[236:239],v4,s[8:11],s57 offen offset:3072 sc1
 v_mfma_f32_16x16x32_bf16 v[64:67],a[136:139],a[16:19],0
 ds_read_b64_tr_b16 a[128:129],v23 offset:35200
 v_and_b32 v34,3,v1
 v_mfma_f32_16x16x32_bf16 v[64:67],a[140:143],a[20:23],v[64:67]
 ds_read_b64_tr_b16 a[160:161],v24 offset:43968
 s_add_u32 s58,s58,131072
 v_mfma_f32_16x16x32_bf16 v[68:71],a[136:139],a[24:27],0
 ds_read_b64_tr_b16 a[130:131],v23 offset:35456
 s_add_u32 m0,s51,70144
 v_mfma_f32_16x16x32_bf16 v[68:71],a[140:143],a[28:31],v[68:71]
 buffer_load_dwordx4 a[240:243],v5,s[8:11],s57 offen offset:0 sc1
 v_mfma_f32_16x16x32_bf16 v[144:147],a[164:167],v[100:103],v[144:147]
 buffer_load_dwordx4 v8,s[28:31],s58 offen offset:0 lds
 v_mfma_f32_16x16x32_bf16 v[148:151],a[164:167],v[108:111],v[148:151]
 ds_read_b64_tr_b16 a[162:163],v24 offset:44224
 v_readfirstlane_b32 s84,v42
 v_mfma_f32_16x16x32_bf16 v[152:155],a[164:167],v[116:119],v[152:155]
 buffer_load_dwordx4 a[244:247],v5,s[8:11],s57 offen offset:1024 sc1
 v_mfma_f32_16x16x32_bf16 v[156:159],a[164:167],v[124:127],v[156:159]
 buffer_load_dwordx4 v9,s[28:31],s58 offen offset:1088 lds
 v_smfmac_f32_16x16x64_bf16 a[184:187],v[60:63],v[112:119],v30
 buffer_load_dwordx4 a[248:251],v5,s[8:11],s57 offen offset:2048 sc1
 v_mfma_f32_16x16x32_bf16 v[72:75],a[136:139],a[48:51],0
 ds_read_b64_tr_b16 a[132:133],v23 offset:43968
 v_mfma_f32_16x16x32_bf16 v[72:75],a[140:143],a[52:55],v[72:75]
 ds_read_b64_tr_b16 a[164:165],v24 offset:44000
 v_mfma_f32_16x16x32_bf16 v[76:79],a[136:139],a[56:59],0
 ds_read_b64_tr_b16 a[134:135],v23 offset:44224
 v_mfma_f32_16x16x32_bf16 v[76:79],a[140:143],a[60:63],v[76:79]
 buffer_load_dwordx4 a[252:255],v5,s[8:11],s57 offen offset:3072 sc1
 s_waitcnt lgkmcnt(8)
 v_mfma_f32_16x16x32_bf16 v[160:163],a[168:171],v[100:103],v[160:163]
 s_lshr_b32 s4,s74,16
 s_add_u32 s4,s4,s91
 v_lshl_add_u32 v34,v34,2,s4
 v_mfma_f32_16x16x32_bf16 v[164:167],a[168:171],v[108:111],v[164:167]
 ds_read_b64_tr_b16 a[166:167],v24 offset:44256
 v_add_u32 v34,4096,v34
 v_mfma_f32_16x16x32_bf16 v[168:171],a[168:171],v[116:119],v[168:171]
 buffer_load_dwordx4 v10,s[28:31],s58 offen offset:2176 lds
 v_mfma_f32_16x16x32_bf16 v[172:175],a[168:171],v[124:127],v[172:175]
 s_cmp_eq_u32 s84,s82
 s_cselect_b32 s84,s83,s84
 v_smfmac_f32_16x16x64_bf16 a[188:191],v[60:63],v[120:127],v30
 v_mfma_f32_16x16x32_bf16 a[32:35],a[144:147],a[16:19],0
 ds_read_b64_tr_b16 a[136:137],v23 offset:35232
 v_mfma_f32_16x16x32_bf16 a[32:35],a[148:151],a[20:23],a[32:35]
 ds_read_b64_tr_b16 a[168:169],v24 offset:44032
 s_cmp_lt_u32 s85,256
 s_cselect_b32 s82,s84,s82
 s_and_b32 s82,s82,0x7e7e7e00
 v_mfma_f32_16x16x32_bf16 a[36:39],a[144:147],a[24:27],0
 ds_read_b64_tr_b16 a[138:139],v23 offset:35488
 v_accvgpr_read_b32 v40,a176
 v_mfma_f32_16x16x32_bf16 a[36:39],a[148:151],a[28:31],a[36:39]
 v_accvgpr_read_b32 v41,a180
 v_accvgpr_read_b32 v42,a184
 v_mfma_f32_16x16x32_bf16 v[176:179],a[172:175],v[100:103],v[176:179]
 v_accvgpr_read_b32 v43,a188
 v_accvgpr_read_b32 v27,a177
 v_mfma_f32_16x16x32_bf16 v[180:183],a[172:175],v[108:111],v[180:183]
 ds_read_b64_tr_b16 a[170:171],v24 offset:44288
 v_accvgpr_read_b32 v28,a181
 v_mfma_f32_16x16x32_bf16 v[184:187],a[172:175],v[116:119],v[184:187]
 v_accvgpr_read_b32 v29,a185
 v_accvgpr_read_b32 v30,a189
 v_mfma_f32_16x16x32_bf16 v[188:191],a[172:175],v[124:127],v[188:191]
 v_add_f32 v40,v40,v27
 v_add_f32 v41,v41,v28
 v_mfma_f32_16x16x32_bf16 a[40:43],a[144:147],a[48:51],0
 ds_read_b64_tr_b16 a[140:141],v23 offset:44000
 v_add_f32 v42,v42,v29
 v_mfma_f32_16x16x32_bf16 a[40:43],a[148:151],a[52:55],a[40:43]
 ds_read_b64_tr_b16 a[172:173],v24 offset:44064
 v_add_f32 v43,v43,v30
 v_mfma_f32_16x16x32_bf16 a[44:47],a[144:147],a[56:59],0
 ds_read_b64_tr_b16 a[142:143],v23 offset:44256
 v_max3_u32 v39,v40,v41,v42
 v_mfma_f32_16x16x32_bf16 a[44:47],a[148:151],a[60:63],a[44:47]
 v_max_u32 v39,v39,v43
 s_waitcnt lgkmcnt(7)
 v_mfma_f32_16x16x32_bf16 v[192:195],a[160:163],v[100:103],v[192:195]
 v_rcp_f32 v60,v40
 v_mfma_f32_16x16x32_bf16 v[196:199],a[160:163],v[108:111],v[196:199]
 ds_read_b64_tr_b16 a[174:175],v24 offset:44320
 v_cmp_lt_u32 vcc,s50,v39
 v_mfma_f32_16x16x32_bf16 v[200:203],a[160:163],v[116:119],v[200:203]
 v_rcp_f32 v61,v41
 v_mfma_f32_16x16x32_bf16 v[204:207],a[160:163],v[124:127],v[204:207]
 v_rcp_f32 v62,v42
 v_mfma_f32_16x16x32_bf16 v[80:83],a[152:155],a[16:19],0
 ds_read_b64_tr_b16 a[144:145],v23 offset:35264
 v_mfma_f32_16x16x32_bf16 v[80:83],a[156:159],a[20:23],v[80:83]
 v_rcp_f32 v63,v43
 v_mfma_f32_16x16x32_bf16 v[84:87],a[152:155],a[24:27],0
 ds_read_b64_tr_b16 a[146:147],v23 offset:35520
 s_add_u32 s63,s69,0
 v_mfma_f32_16x16x32_bf16 v[84:87],a[156:159],a[28:31],v[84:87]
 buffer_load_dwordx4 v11,s[28:31],s58 offen offset:3264 lds
 v_mfma_f32_16x16x32_bf16 v[208:211],a[164:167],v[100:103],v[208:211]
 s_cmp_lg_u64 vcc,0
 s_addc_u32 s80,s80,0
 v_mfma_f32_16x16x32_bf16 v[212:215],a[164:167],v[108:111],v[212:215]
 s_add_u32 s58,s58,131072
 s_add_u32 m0,s51,87680
 v_mfma_f32_16x16x32_bf16 v[216:219],a[164:167],v[116:119],v[216:219]
 buffer_load_dwordx4 v8,s[28:31],s58 offen offset:0 lds
 v_mfma_f32_16x16x32_bf16 v[220:223],a[164:167],v[124:127],v[220:223]
 s_or_b32 s80,s80,s82
 v_mov_b32 v39,s80
 v_mfma_f32_16x16x32_bf16 v[88:91],a[152:155],a[48:51],0
 ds_read_b64_tr_b16 a[148:149],v23 offset:44032
 v_mul_f32 v128,v128,v60
 v_mfma_f32_16x16x32_bf16 v[88:91],a[156:159],a[52:55],v[88:91]
 ds_write_b32 v36,v39
 v_mul_f32 v129,v129,v60
 v_mfma_f32_16x16x32_bf16 v[92:95],a[152:155],a[56:59],0
 ds_read_b64_tr_b16 a[150:151],v23 offset:44288
 v_mul_f32 v130,v130,v60
 v_mfma_f32_16x16x32_bf16 v[92:95],a[156:159],a[60:63],v[92:95]
 buffer_load_dwordx4 v9,s[28:31],s58 offen offset:1088 lds
 s_waitcnt lgkmcnt(5)
 v_mfma_f32_16x16x32_bf16 v[224:227],a[168:171],v[100:103],v[224:227]
 v_mul_f32 v131,v131,v60
 v_mul_f32 v144,v144,v60
 v_mfma_f32_16x16x32_bf16 v[228:231],a[168:171],v[108:111],v[228:231]
 v_mul_f32 v145,v145,v60
 v_mul_f32 v146,v146,v60
 v_mfma_f32_16x16x32_bf16 v[232:235],a[168:171],v[116:119],v[232:235]
 v_mul_f32 v147,v147,v60
 v_cvt_pk_bf16_f32 v128,v128,v129
 v_mfma_f32_16x16x32_bf16 v[236:239],a[168:171],v[124:127],v[236:239]
 v_cvt_pk_bf16_f32 v129,v130,v131
 v_mfma_f32_16x16x32_bf16 a[64:67],a[128:131],a[16:19],0
 ds_read_b64_tr_b16 a[152:153],v23 offset:35296
 v_cvt_pk_bf16_f32 v130,v144,v145
 v_mfma_f32_16x16x32_bf16 a[64:67],a[132:135],a[20:23],a[64:67]
 buffer_load_dwordx4 v10,s[28:31],s58 offen offset:2176 lds
 v_mfma_f32_16x16x32_bf16 a[68:71],a[128:131],a[24:27],0
 ds_read_b64_tr_b16 a[154:155],v23 offset:35552
 v_cvt_pk_bf16_f32 v131,v146,v147
 v_mfma_f32_16x16x32_bf16 a[68:71],a[132:135],a[28:31],a[68:71]
 buffer_store_dwordx4 v[128:131],v4,s[8:11],s63 offen offset:0 sc0 sc1
 v_mfma_f32_16x16x32_bf16 v[240:243],a[172:175],v[100:103],v[240:243]
 v_mul_f32 v132,v132,v61
 v_mul_f32 v133,v133,v61
 v_mfma_f32_16x16x32_bf16 v[244:247],a[172:175],v[108:111],v[244:247]
 v_mul_f32 v134,v134,v61
 v_mul_f32 v135,v135,v61
 v_mfma_f32_16x16x32_bf16 v[248:251],a[172:175],v[116:119],v[248:251]
 v_mul_f32 v148,v148,v61
 v_mul_f32 v149,v149,v61
 v_mfma_f32_16x16x32_bf16 v[252:255],a[172:175],v[124:127],v[252:255]
 v_mul_f32 v150,v150,v61
 v_mul_f32 v151,v151,v61
 v_mfma_f32_16x16x32_bf16 a[72:75],a[128:131],a[48:51],0
 ds_read_b64_tr_b16 a[156:157],v23 offset:44064
 v_cvt_pk_bf16_f32 v132,v132,v133
 v_mfma_f32_16x16x32_bf16 a[72:75],a[132:135],a[52:55],a[72:75]
 buffer_load_dwordx4 v11,s[28:31],s58 offen offset:3264 lds
 v_mfma_f32_16x16x32_bf16 a[76:79],a[128:131],a[56:59],0
 ds_read_b64_tr_b16 a[158:159],v23 offset:44320
 v_cvt_pk_bf16_f32 v133,v134,v135
 v_mfma_f32_16x16x32_bf16 a[76:79],a[132:135],a[60:63],a[76:79]
 s_waitcnt lgkmcnt(5)
 s_waitcnt vmcnt(41)
 s_barrier
 v_mfma_f32_16x16x32_bf16 v[96:99],a[136:139],a[16:19],0
 ds_read_b64_tr_b16 a[128:129],v21 offset:0
 v_cvt_pk_bf16_f32 v134,v148,v149
 v_mfma_f32_16x16x32_bf16 v[96:99],a[140:143],a[20:23],v[96:99]
 ds_read_b128 v[40:43],v37
 v_cvt_pk_bf16_f32 v135,v150,v151
 v_mfma_f32_16x16x32_bf16 v[100:103],a[136:139],a[24:27],0
 ds_read_b64_tr_b16 a[130:131],v21 offset:256
 v_mul_f32 v136,v136,v62
 v_mfma_f32_16x16x32_bf16 v[100:103],a[140:143],a[28:31],v[100:103]
 buffer_store_dwordx4 v[132:135],v4,s[8:11],s63 offen offset:2048 sc0 sc1
 v_mfma_f32_16x16x32_bf16 v[104:107],a[136:139],a[48:51],0
 ds_read_b64_tr_b16 a[132:133],v21 offset:8768
 v_mul_f32 v137,v137,v62
 v_mfma_f32_16x16x32_bf16 v[104:107],a[140:143],a[52:55],v[104:107]
 v_mul_f32 v138,v138,v62
 v_mul_f32 v139,v139,v62
 v_mfma_f32_16x16x32_bf16 v[108:111],a[136:139],a[56:59],0
 ds_read_b64_tr_b16 a[134:135],v21 offset:9024
 v_mul_f32 v152,v152,v62
 v_mfma_f32_16x16x32_bf16 v[108:111],a[140:143],a[60:63],v[108:111]
 v_mul_f32 v153,v153,v62
 s_waitcnt lgkmcnt(5)
 v_mfma_f32_16x16x32_bf16 a[96:99],a[144:147],a[16:19],0
 ds_read_b64_tr_b16 a[136:137],v21 offset:32
 s_add_u32 s57,s57,8192
 s_waitcnt lgkmcnt(4)
 v_mfma_f32_16x16x32_bf16 a[96:99],a[148:151],a[20:23],a[96:99]
 buffer_load_dwordx4 a[160:163],v4,s[8:11],s57 offen offset:0 sc1
 v_mfma_f32_16x16x32_bf16 a[100:103],a[144:147],a[24:27],0
 ds_read_b64_tr_b16 a[138:139],v21 offset:288
 v_or3_b32 v39,v40,v41,v42
 v_mfma_f32_16x16x32_bf16 a[100:103],a[148:151],a[28:31],a[100:103]
 buffer_load_dwordx4 a[164:167],v4,s[8:11],s57 offen offset:1024 sc1
 v_mfma_f32_16x16x32_bf16 a[104:107],a[144:147],a[48:51],0
 ds_read_b64_tr_b16 a[140:141],v21 offset:8800
 v_or_b32 v39,v39,v43
 v_mfma_f32_16x16x32_bf16 a[104:107],a[148:151],a[52:55],a[104:107]
 v_readfirstlane_b32 s1,v39
 v_mul_f32 v154,v154,v62
 v_mfma_f32_16x16x32_bf16 a[108:111],a[144:147],a[56:59],0
 ds_read_b64_tr_b16 a[142:143],v21 offset:9056
 v_mul_f32 v155,v155,v62
 v_mfma_f32_16x16x32_bf16 a[108:111],a[148:151],a[60:63],a[108:111]
 buffer_load_dwordx4 a[168:171],v4,s[8:11],s57 offen offset:2048 sc1
 v_mfma_f32_16x16x32_bf16 v[112:115],a[152:155],a[16:19],0
 ds_read_b64_tr_b16 a[144:145],v21 offset:64
 s_ff1_i32_b32 s83,s1
 v_mfma_f32_16x16x32_bf16 v[112:115],a[156:159],a[20:23],v[112:115]
 v_cvt_pk_bf16_f32 v136,v136,v137
 v_cvt_pk_bf16_f32 v137,v138,v139
 v_mfma_f32_16x16x32_bf16 v[116:119],a[152:155],a[24:27],0
 ds_read_b64_tr_b16 a[146:147],v21 offset:320
 v_cvt_pk_bf16_f32 v138,v152,v153
 v_mfma_f32_16x16x32_bf16 v[116:119],a[156:159],a[28:31],v[116:119]
 v_cvt_pk_bf16_f32 v139,v154,v155
 v_mul_f32 v140,v140,v63
 v_mfma_f32_16x16x32_bf16 v[120:123],a[152:155],a[48:51],0
 ds_read_b64_tr_b16 a[148:149],v21 offset:8832
 v_mul_f32 v141,v141,v63
 v_mfma_f32_16x16x32_bf16 v[120:123],a[156:159],a[52:55],v[120:123]
 buffer_load_dwordx4 a[172:175],v4,s[8:11],s57 offen offset:3072 sc1
 v_mfma_f32_16x16x32_bf16 v[124:127],a[152:155],a[56:59],0
 ds_read_b64_tr_b16 a[150:151],v21 offset:9088
 v_mul_f32 v142,v142,v63
 v_mfma_f32_16x16x32_bf16 v[124:127],a[156:159],a[60:63],v[124:127]
 s_waitcnt vmcnt(38)
 s_waitcnt lgkmcnt(4)
 v_mfma_f32_16x16x32_bf16 a[0:3],a[128:131],a[80:83],a[0:3]
 ds_read_b64_tr_b16 a[152:153],v21 offset:96
 v_mul_f32 v143,v143,v63
 v_mfma_f32_16x16x32_bf16 a[0:3],a[132:135],a[84:87],a[0:3]
 buffer_load_dwordx4 a[176:179],v5,s[8:11],s57 offen offset:0 sc1
 v_mfma_f32_16x16x32_bf16 a[4:7],a[128:131],a[88:91],a[4:7]
 ds_read_b64_tr_b16 a[154:155],v21 offset:352
 v_mul_f32 v156,v156,v63
 v_mfma_f32_16x16x32_bf16 a[4:7],a[132:135],a[92:95],a[4:7]
 buffer_store_dwordx4 v[136:139],v5,s[8:11],s63 offen offset:0 sc0 sc1
 v_mfma_f32_16x16x32_bf16 a[8:11],a[128:131],a[112:115],a[8:11]
 ds_read_b64_tr_b16 a[156:157],v21 offset:8864
 v_mul_f32 v157,v157,v63
 v_mfma_f32_16x16x32_bf16 a[8:11],a[132:135],a[116:119],a[8:11]
 v_mul_f32 v158,v158,v63
 v_mul_f32 v159,v159,v63
 v_mfma_f32_16x16x32_bf16 a[12:15],a[128:131],a[120:123],a[12:15]
 ds_read_b64_tr_b16 a[158:159],v21 offset:9120
 v_cvt_pk_bf16_f32 v140,v140,v141
 v_mfma_f32_16x16x32_bf16 a[12:15],a[132:135],a[124:127],a[12:15]
 v_cvt_pk_bf16_f32 v141,v142,v143
 v_cvt_pk_bf16_f32 v142,v156,v157
 v_mfma_f32_16x16x32_bf16 v[64:67],a[136:139],a[80:83],v[64:67]
 ds_read_b64_tr_b16 a[128:129],v21 offset:128
 v_cvt_pk_bf16_f32 v143,v158,v159
 v_mfma_f32_16x16x32_bf16 v[64:67],a[140:143],a[84:87],v[64:67]
 buffer_load_dwordx4 a[180:183],v5,s[8:11],s57 offen offset:1024 sc1
 v_mfma_f32_16x16x32_bf16 v[68:71],a[136:139],a[88:91],v[68:71]
 ds_read_b64_tr_b16 a[130:131],v21 offset:384
 v_mul_f32 v160,v160,v60
 v_mfma_f32_16x16x32_bf16 v[68:71],a[140:143],a[92:95],v[68:71]
 buffer_store_dwordx4 v[140:143],v5,s[8:11],s63 offen offset:2048 sc0 sc1
 v_mfma_f32_16x16x32_bf16 v[72:75],a[136:139],a[112:115],v[72:75]
 ds_read_b64_tr_b16 a[132:133],v21 offset:8896
 v_mul_f32 v161,v161,v60
 v_mfma_f32_16x16x32_bf16 v[72:75],a[140:143],a[116:119],v[72:75]
 v_mul_f32 v162,v162,v60
 v_mul_f32 v163,v163,v60
 v_mfma_f32_16x16x32_bf16 v[76:79],a[136:139],a[120:123],v[76:79]
 ds_read_b64_tr_b16 a[134:135],v21 offset:9152
 v_mul_f32 v176,v176,v60
 v_mfma_f32_16x16x32_bf16 v[76:79],a[140:143],a[124:127],v[76:79]
 v_mul_f32 v177,v177,v60
 s_waitcnt lgkmcnt(4)
 v_mfma_f32_16x16x32_bf16 a[32:35],a[144:147],a[80:83],a[32:35]
 ds_read_b64_tr_b16 a[136:137],v21 offset:160
 v_mul_f32 v178,v178,v60
 v_mfma_f32_16x16x32_bf16 a[32:35],a[148:151],a[84:87],a[32:35]
 v_mul_f32 v179,v179,v60
 v_cvt_pk_bf16_f32 v160,v160,v161
 v_mfma_f32_16x16x32_bf16 a[36:39],a[144:147],a[88:91],a[36:39]
 ds_read_b64_tr_b16 a[138:139],v21 offset:416
 v_cvt_pk_bf16_f32 v161,v162,v163
 v_mfma_f32_16x16x32_bf16 a[36:39],a[148:151],a[92:95],a[36:39]
 buffer_load_dwordx4 a[184:187],v5,s[8:11],s57 offen offset:2048 sc1
 v_mfma_f32_16x16x32_bf16 a[40:43],a[144:147],a[112:115],a[40:43]
 ds_read_b64_tr_b16 a[140:141],v21 offset:8928
 v_cvt_pk_bf16_f32 v162,v176,v177
 v_mfma_f32_16x16x32_bf16 a[40:43],a[148:151],a[116:119],a[40:43]
 v_cvt_pk_bf16_f32 v163,v178,v179
 v_mul_f32 v164,v164,v61
 v_mfma_f32_16x16x32_bf16 a[44:47],a[144:147],a[120:123],a[44:47]
 ds_read_b64_tr_b16 a[142:143],v21 offset:9184
 v_mul_f32 v165,v165,v61
 v_mfma_f32_16x16x32_bf16 a[44:47],a[148:151],a[124:127],a[44:47]
 buffer_store_dwordx4 v[160:163],v4,s[8:11],s63 offen offset:1024 sc0 sc1
 v_mfma_f32_16x16x32_bf16 v[80:83],a[152:155],a[80:83],v[80:83]
 ds_read_b64_tr_b16 a[144:145],v21 offset:192
 v_mul_f32 v166,v166,v61
 v_mfma_f32_16x16x32_bf16 v[80:83],a[156:159],a[84:87],v[80:83]
 v_mul_f32 v167,v167,v61
 v_mul_f32 v180,v180,v61
 v_mfma_f32_16x16x32_bf16 v[84:87],a[152:155],a[88:91],v[84:87]
 ds_read_b64_tr_b16 a[146:147],v21 offset:448
 v_mul_f32 v181,v181,v61
 v_mfma_f32_16x16x32_bf16 v[84:87],a[156:159],a[92:95],v[84:87]
 v_mul_f32 v182,v182,v61
 v_mul_f32 v183,v183,v61
 v_mfma_f32_16x16x32_bf16 v[88:91],a[152:155],a[112:115],v[88:91]
 ds_read_b64_tr_b16 a[148:149],v21 offset:8960
 v_cvt_pk_bf16_f32 v164,v164,v165
 v_mfma_f32_16x16x32_bf16 v[88:91],a[156:159],a[116:119],v[88:91]
 buffer_load_dwordx4 a[188:191],v5,s[8:11],s57 offen offset:3072 sc1
 v_mfma_f32_16x16x32_bf16 v[92:95],a[152:155],a[120:123],v[92:95]
 ds_read_b64_tr_b16 a[150:151],v21 offset:9216
 v_cvt_pk_bf16_f32 v165,v166,v167
 v_mfma_f32_16x16x32_bf16 v[92:95],a[156:159],a[124:127],v[92:95]
 v_cvt_pk_bf16_f32 v166,v180,v181
 s_waitcnt lgkmcnt(4)
 v_mfma_f32_16x16x32_bf16 a[64:67],a[128:131],a[80:83],a[64:67]
 ds_read_b64_tr_b16 a[152:153],v21 offset:224
 s_add_u32 s57,s57,8192
 v_mfma_f32_16x16x32_bf16 a[64:67],a[132:135],a[84:87],a[64:67]
 buffer_load_dwordx4 a[16:19],v4,s[8:11],s57 offen offset:0 sc1
 v_mfma_f32_16x16x32_bf16 a[68:71],a[128:131],a[88:91],a[68:71]
 ds_read_b64_tr_b16 a[154:155],v21 offset:480
 v_cvt_pk_bf16_f32 v167,v182,v183
 v_mfma_f32_16x16x32_bf16 a[68:71],a[132:135],a[92:95],a[68:71]
 buffer_store_dwordx4 v[164:167],v4,s[8:11],s63 offen offset:3072 sc0 sc1
 v_mfma_f32_16x16x32_bf16 a[72:75],a[128:131],a[112:115],a[72:75]
 ds_read_b64_tr_b16 a[156:157],v21 offset:8992
 v_mul_f32 v168,v168,v62
 v_mfma_f32_16x16x32_bf16 a[72:75],a[132:135],a[116:119],a[72:75]
 v_mul_f32 v169,v169,v62
 v_mul_f32 v170,v170,v62
 v_mfma_f32_16x16x32_bf16 a[76:79],a[128:131],a[120:123],a[76:79]
 ds_read_b64_tr_b16 a[158:159],v21 offset:9248
 v_mul_f32 v171,v171,v62
 v_mfma_f32_16x16x32_bf16 a[76:79],a[132:135],a[124:127],a[76:79]
 s_waitcnt vmcnt(43)
 s_barrier
 v_mfma_f32_16x16x32_bf16 v[96:99],a[136:139],a[80:83],v[96:99]
 ds_read_b64_tr_b16 a[128:129],v21 offset:35072
 v_mul_f32 v184,v184,v62
 v_mfma_f32_16x16x32_bf16 v[96:99],a[140:143],a[84:87],v[96:99]
 v_mul_f32 v185,v185,v62
 v_mul_f32 v186,v186,v62
 v_mfma_f32_16x16x32_bf16 v[100:103],a[136:139],a[88:91],v[100:103]
 ds_read_b64_tr_b16 a[130:131],v21 offset:35328
 v_mul_f32 v187,v187,v62
 v_mfma_f32_16x16x32_bf16 v[100:103],a[140:143],a[92:95],v[100:103]
 v_cvt_pk_bf16_f32 v168,v168,v169
 v_cvt_pk_bf16_f32 v169,v170,v171
 v_mfma_f32_16x16x32_bf16 v[104:107],a[136:139],a[112:115],v[104:107]
 ds_read_b64_tr_b16 a[132:133],v21 offset:43840
 v_cvt_pk_bf16_f32 v170,v184,v185
 v_mfma_f32_16x16x32_bf16 v[104:107],a[140:143],a[116:119],v[104:107]
 v_cvt_pk_bf16_f32 v171,v186,v187
 v_mul_f32 v172,v172,v63
 v_mfma_f32_16x16x32_bf16 v[108:111],a[136:139],a[120:123],v[108:111]
 ds_read_b64_tr_b16 a[134:135],v21 offset:44096
 v_mul_f32 v173,v173,v63
 v_mfma_f32_16x16x32_bf16 v[108:111],a[140:143],a[124:127],v[108:111]
 v_mul_f32 v174,v174,v63
 s_waitcnt lgkmcnt(4)
 v_mfma_f32_16x16x32_bf16 a[96:99],a[144:147],a[80:83],a[96:99]
 ds_read_b64_tr_b16 a[136:137],v21 offset:35104
 v_mul_f32 v175,v175,v63
 v_mfma_f32_16x16x32_bf16 a[96:99],a[148:151],a[84:87],a[96:99]
 buffer_store_dwordx4 v[168:171],v5,s[8:11],s63 offen offset:1024 sc0 sc1
 v_mfma_f32_16x16x32_bf16 a[100:103],a[144:147],a[88:91],a[100:103]
 ds_read_b64_tr_b16 a[138:139],v21 offset:35360
 v_mul_f32 v188,v188,v63
 v_mfma_f32_16x16x32_bf16 a[100:103],a[148:151],a[92:95],a[100:103]
 v_mul_f32 v189,v189,v63
 v_mul_f32 v190,v190,v63
 v_mfma_f32_16x16x32_bf16 a[104:107],a[144:147],a[112:115],a[104:107]
 ds_read_b64_tr_b16 a[140:141],v21 offset:43872
 v_mul_f32 v191,v191,v63
 v_mfma_f32_16x16x32_bf16 a[104:107],a[148:151],a[116:119],a[104:107]
 v_cvt_pk_bf16_f32 v172,v172,v173
 v_cvt_pk_bf16_f32 v173,v174,v175
 v_mfma_f32_16x16x32_bf16 a[108:111],a[144:147],a[120:123],a[108:111]
 ds_read_b64_tr_b16 a[142:143],v21 offset:44128
 v_cvt_pk_bf16_f32 v174,v188,v189
 v_mfma_f32_16x16x32_bf16 a[108:111],a[148:151],a[124:127],a[108:111]
 buffer_load_dwordx4 a[20:23],v4,s[8:11],s57 offen offset:1024 sc1
 v_mfma_f32_16x16x32_bf16 v[112:115],a[152:155],a[80:83],v[112:115]
 ds_read_b64_tr_b16 a[144:145],v21 offset:35136
 v_cvt_pk_bf16_f32 v175,v190,v191
 v_mfma_f32_16x16x32_bf16 v[112:115],a[156:159],a[84:87],v[112:115]
 buffer_store_dwordx4 v[172:175],v5,s[8:11],s63 offen offset:3072 sc0 sc1
 v_mfma_f32_16x16x32_bf16 v[116:119],a[152:155],a[88:91],v[116:119]
 ds_read_b64_tr_b16 a[146:147],v21 offset:35392
 v_mul_f32 v192,v192,v60
 v_mfma_f32_16x16x32_bf16 v[116:119],a[156:159],a[92:95],v[116:119]
 s_add_u32 s63,s69,8192
 v_mul_f32 v193,v193,v60
 v_mfma_f32_16x16x32_bf16 v[120:123],a[152:155],a[112:115],v[120:123]
 ds_read_b64_tr_b16 a[148:149],v21 offset:43904
 v_mul_f32 v194,v194,v60
 v_mfma_f32_16x16x32_bf16 v[120:123],a[156:159],a[116:119],v[120:123]
 v_mul_f32 v195,v195,v60
 v_mul_f32 v208,v208,v60
 v_mfma_f32_16x16x32_bf16 v[124:127],a[152:155],a[120:123],v[124:127]
 ds_read_b64_tr_b16 a[150:151],v21 offset:44160
 v_mul_f32 v209,v209,v60
 v_mfma_f32_16x16x32_bf16 v[124:127],a[156:159],a[124:127],v[124:127]
 s_waitcnt vmcnt(38)
 s_waitcnt lgkmcnt(4)
 v_mfma_f32_16x16x32_bf16 a[0:3],a[128:131],a[192:195],a[0:3]
 ds_read_b64_tr_b16 a[152:153],v21 offset:35168
 v_mul_f32 v210,v210,v60
 v_mfma_f32_16x16x32_bf16 a[0:3],a[132:135],a[196:199],a[0:3]
 v_mul_f32 v211,v211,v60
 v_cvt_pk_bf16_f32 v192,v192,v193
 v_mfma_f32_16x16x32_bf16 a[4:7],a[128:131],a[200:203],a[4:7]
 ds_read_b64_tr_b16 a[154:155],v21 offset:35424
 v_cvt_pk_bf16_f32 v193,v194,v195
 v_mfma_f32_16x16x32_bf16 a[4:7],a[132:135],a[204:207],a[4:7]
 buffer_load_dwordx4 a[24:27],v4,s[8:11],s57 offen offset:2048 sc1
 v_mfma_f32_16x16x32_bf16 a[8:11],a[128:131],a[208:211],a[8:11]
 ds_read_b64_tr_b16 a[156:157],v21 offset:43936
 v_cvt_pk_bf16_f32 v194,v208,v209
 v_mfma_f32_16x16x32_bf16 a[8:11],a[132:135],a[212:215],a[8:11]
 v_cvt_pk_bf16_f32 v195,v210,v211
 v_mul_f32 v196,v196,v61
 v_mfma_f32_16x16x32_bf16 a[12:15],a[128:131],a[216:219],a[12:15]
 ds_read_b64_tr_b16 a[158:159],v21 offset:44192
 v_mul_f32 v197,v197,v61
 v_mfma_f32_16x16x32_bf16 a[12:15],a[132:135],a[220:223],a[12:15]
 buffer_store_dwordx4 v[192:195],v4,s[8:11],s63 offen offset:0 sc0 sc1
 v_mfma_f32_16x16x32_bf16 v[64:67],a[136:139],a[192:195],v[64:67]
 ds_read_b64_tr_b16 a[128:129],v21 offset:35200
 v_mul_f32 v198,v198,v61
 v_mfma_f32_16x16x32_bf16 v[64:67],a[140:143],a[196:199],v[64:67]
 v_mul_f32 v199,v199,v61
 v_mul_f32 v212,v212,v61
 v_mfma_f32_16x16x32_bf16 v[68:71],a[136:139],a[200:203],v[68:71]
 ds_read_b64_tr_b16 a[130:131],v21 offset:35456
 v_mul_f32 v213,v213,v61
 v_mfma_f32_16x16x32_bf16 v[68:71],a[140:143],a[204:207],v[68:71]
 v_mul_f32 v214,v214,v61
 v_mul_f32 v215,v215,v61
 v_mfma_f32_16x16x32_bf16 v[72:75],a[136:139],a[208:211],v[72:75]
 ds_read_b64_tr_b16 a[132:133],v21 offset:43968
 v_cvt_pk_bf16_f32 v196,v196,v197
 v_mfma_f32_16x16x32_bf16 v[72:75],a[140:143],a[212:215],v[72:75]
 buffer_load_dwordx4 a[28:31],v4,s[8:11],s57 offen offset:3072 sc1
 v_mfma_f32_16x16x32_bf16 v[76:79],a[136:139],a[216:219],v[76:79]
 ds_read_b64_tr_b16 a[134:135],v21 offset:44224
 v_cvt_pk_bf16_f32 v197,v198,v199
 v_mfma_f32_16x16x32_bf16 v[76:79],a[140:143],a[220:223],v[76:79]
 v_cvt_pk_bf16_f32 v198,v212,v213
 s_waitcnt lgkmcnt(4)
 v_mfma_f32_16x16x32_bf16 a[32:35],a[144:147],a[192:195],a[32:35]
 ds_read_b64_tr_b16 a[136:137],v21 offset:35232
 v_cvt_pk_bf16_f32 v199,v214,v215
 v_mfma_f32_16x16x32_bf16 a[32:35],a[148:151],a[196:199],a[32:35]
 buffer_load_dwordx4 a[48:51],v5,s[8:11],s57 offen offset:0 sc1
 v_mfma_f32_16x16x32_bf16 a[36:39],a[144:147],a[200:203],a[36:39]
 ds_read_b64_tr_b16 a[138:139],v21 offset:35488
 v_mul_f32 v200,v200,v62
 v_mfma_f32_16x16x32_bf16 a[36:39],a[148:151],a[204:207],a[36:39]
 buffer_store_dwordx4 v[196:199],v4,s[8:11],s63 offen offset:2048 sc0 sc1
 v_mfma_f32_16x16x32_bf16 a[40:43],a[144:147],a[208:211],a[40:43]
 ds_read_b64_tr_b16 a[140:141],v21 offset:44000
 v_mul_f32 v201,v201,v62
 v_mfma_f32_16x16x32_bf16 a[40:43],a[148:151],a[212:215],a[40:43]
 v_mul_f32 v202,v202,v62
 v_mul_f32 v203,v203,v62
 v_mfma_f32_16x16x32_bf16 a[44:47],a[144:147],a[216:219],a[44:47]
 ds_read_b64_tr_b16 a[142:143],v21 offset:44256
 v_mul_f32 v216,v216,v62
 v_mfma_f32_16x16x32_bf16 a[44:47],a[148:151],a[220:223],a[44:47]
 v_mul_f32 v217,v217,v62
 v_mul_f32 v218,v218,v62
 v_mfma_f32_16x16x32_bf16 v[80:83],a[152:155],a[192:195],v[80:83]
 ds_read_b64_tr_b16 a[144:145],v21 offset:35264
 v_mul_f32 v219,v219,v62
 v_mfma_f32_16x16x32_bf16 v[80:83],a[156:159],a[196:199],v[80:83]
 v_cvt_pk_bf16_f32 v200,v200,v201
 v_cvt_pk_bf16_f32 v201,v202,v203
 v_mfma_f32_16x16x32_bf16 v[84:87],a[152:155],a[200:203],v[84:87]
 ds_read_b64_tr_b16 a[146:147],v21 offset:35520
 v_cvt_pk_bf16_f32 v202,v216,v217
 v_mfma_f32_16x16x32_bf16 v[84:87],a[156:159],a[204:207],v[84:87]
 v_cvt_pk_bf16_f32 v203,v218,v219
 v_mul_f32 v204,v204,v63
 v_mfma_f32_16x16x32_bf16 v[88:91],a[152:155],a[208:211],v[88:91]
 ds_read_b64_tr_b16 a[148:149],v21 offset:44032
 v_mul_f32 v205,v205,v63
 v_mfma_f32_16x16x32_bf16 v[88:91],a[156:159],a[212:215],v[88:91]
 buffer_store_dwordx4 v[200:203],v5,s[8:11],s63 offen offset:0 sc0 sc1
 v_mfma_f32_16x16x32_bf16 v[92:95],a[152:155],a[216:219],v[92:95]
 ds_read_b64_tr_b16 a[150:151],v21 offset:44288
 v_mul_f32 v206,v206,v63
 v_mfma_f32_16x16x32_bf16 v[92:95],a[156:159],a[220:223],v[92:95]
 v_mul_f32 v207,v207,v63
 s_waitcnt lgkmcnt(4)
 v_mfma_f32_16x16x32_bf16 a[64:67],a[128:131],a[192:195],a[64:67]
 ds_read_b64_tr_b16 a[152:153],v21 offset:35296
 v_mul_f32 v220,v220,v63
 v_mfma_f32_16x16x32_bf16 a[64:67],a[132:135],a[196:199],a[64:67]
 v_mul_f32 v221,v221,v63
 v_mul_f32 v222,v222,v63
 v_mfma_f32_16x16x32_bf16 a[68:71],a[128:131],a[200:203],a[68:71]
 ds_read_b64_tr_b16 a[154:155],v21 offset:35552
 v_mul_f32 v223,v223,v63
 v_mfma_f32_16x16x32_bf16 a[68:71],a[132:135],a[204:207],a[68:71]
 v_cvt_pk_bf16_f32 v204,v204,v205
 v_cvt_pk_bf16_f32 v205,v206,v207
 v_mfma_f32_16x16x32_bf16 a[72:75],a[128:131],a[208:211],a[72:75]
 ds_read_b64_tr_b16 a[156:157],v21 offset:44064
 v_cvt_pk_bf16_f32 v206,v220,v221
 v_mfma_f32_16x16x32_bf16 a[72:75],a[132:135],a[212:215],a[72:75]
 v_cvt_pk_bf16_f32 v207,v222,v223
 v_mul_f32 v224,v224,v60
 v_mfma_f32_16x16x32_bf16 a[76:79],a[128:131],a[216:219],a[76:79]
 ds_read_b64_tr_b16 a[158:159],v21 offset:44320
 v_mul_f32 v225,v225,v60
 v_mfma_f32_16x16x32_bf16 a[76:79],a[132:135],a[220:223],a[76:79]
 s_waitcnt vmcnt(40)
 s_barrier
 v_mfma_f32_16x16x32_bf16 v[96:99],a[136:139],a[192:195],v[96:99]
 ds_read_b64_tr_b16 a[128:129],v21 offset:17536
 v_mul_f32 v226,v226,v60
 v_mfma_f32_16x16x32_bf16 v[96:99],a[140:143],a[196:199],v[96:99]
 buffer_store_dwordx4 v[204:207],v5,s[8:11],s63 offen offset:2048 sc0 sc1
 v_mfma_f32_16x16x32_bf16 v[100:103],a[136:139],a[200:203],v[100:103]
 ds_read_b64_tr_b16 a[130:131],v21 offset:17792
 v_mul_f32 v227,v227,v60
 v_mfma_f32_16x16x32_bf16 v[100:103],a[140:143],a[204:207],v[100:103]
 v_mul_f32 v240,v240,v60
 v_mul_f32 v241,v241,v60
 v_mfma_f32_16x16x32_bf16 v[104:107],a[136:139],a[208:211],v[104:107]
 ds_read_b64_tr_b16 a[132:133],v21 offset:26304
 v_mul_f32 v242,v242,v60
 v_mfma_f32_16x16x32_bf16 v[104:107],a[140:143],a[212:215],v[104:107]
 v_mul_f32 v243,v243,v60
 v_cvt_pk_bf16_f32 v224,v224,v225
 v_mfma_f32_16x16x32_bf16 v[108:111],a[136:139],a[216:219],v[108:111]
 ds_read_b64_tr_b16 a[134:135],v21 offset:26560
 v_cvt_pk_bf16_f32 v225,v226,v227
 v_mfma_f32_16x16x32_bf16 v[108:111],a[140:143],a[220:223],v[108:111]
 v_cvt_pk_bf16_f32 v226,v240,v241
 s_waitcnt lgkmcnt(4)
 v_mfma_f32_16x16x32_bf16 a[96:99],a[144:147],a[192:195],a[96:99]
 ds_read_b64_tr_b16 a[136:137],v21 offset:17568
 v_cvt_pk_bf16_f32 v227,v242,v243
 v_mfma_f32_16x16x32_bf16 a[96:99],a[148:151],a[196:199],a[96:99]
 buffer_store_dwordx4 v[224:227],v4,s[8:11],s63 offen offset:1024 sc0 sc1
 v_mfma_f32_16x16x32_bf16 a[100:103],a[144:147],a[200:203],a[100:103]
 ds_read_b64_tr_b16 a[138:139],v21 offset:17824
 v_mul_f32 v228,v228,v61
 v_mfma_f32_16x16x32_bf16 a[100:103],a[148:151],a[204:207],a[100:103]
 v_mul_f32 v229,v229,v61
 v_mul_f32 v230,v230,v61
 v_mfma_f32_16x16x32_bf16 a[104:107],a[144:147],a[208:211],a[104:107]
 ds_read_b64_tr_b16 a[140:141],v21 offset:26336
 v_mul_f32 v231,v231,v61
 v_mfma_f32_16x16x32_bf16 a[104:107],a[148:151],a[212:215],a[104:107]
 v_mul_f32 v244,v244,v61
 v_mul_f32 v245,v245,v61
 v_mfma_f32_16x16x32_bf16 a[108:111],a[144:147],a[216:219],a[108:111]
 ds_read_b64_tr_b16 a[142:143],v21 offset:26592
 v_mul_f32 v246,v246,v61
 v_mfma_f32_16x16x32_bf16 a[108:111],a[148:151],a[220:223],a[108:111]
 v_mul_f32 v247,v247,v61
 v_cvt_pk_bf16_f32 v228,v228,v229
 v_mfma_f32_16x16x32_bf16 v[112:115],a[152:155],a[192:195],v[112:115]
 ds_read_b64_tr_b16 a[144:145],v21 offset:17600
 v_cvt_pk_bf16_f32 v229,v230,v231
 v_mfma_f32_16x16x32_bf16 v[112:115],a[156:159],a[196:199],v[112:115]
 buffer_load_dwordx4 a[52:55],v5,s[8:11],s57 offen offset:1024 sc1
 v_mfma_f32_16x16x32_bf16 v[116:119],a[152:155],a[200:203],v[116:119]
 ds_read_b64_tr_b16 a[146:147],v21 offset:17856
 v_cvt_pk_bf16_f32 v230,v244,v245
 v_mfma_f32_16x16x32_bf16 v[116:119],a[156:159],a[204:207],v[116:119]
 v_cvt_pk_bf16_f32 v231,v246,v247
 v_mul_f32 v232,v232,v62
 v_mfma_f32_16x16x32_bf16 v[120:123],a[152:155],a[208:211],v[120:123]
 ds_read_b64_tr_b16 a[148:149],v21 offset:26368
 v_mul_f32 v233,v233,v62
 v_mfma_f32_16x16x32_bf16 v[120:123],a[156:159],a[212:215],v[120:123]
 buffer_store_dwordx4 v[228:231],v4,s[8:11],s63 offen offset:3072 sc0 sc1
 v_mfma_f32_16x16x32_bf16 v[124:127],a[152:155],a[216:219],v[124:127]
 ds_read_b64_tr_b16 a[150:151],v21 offset:26624
 v_mul_f32 v234,v234,v62
 v_mfma_f32_16x16x32_bf16 v[124:127],a[156:159],a[220:223],v[124:127]
 s_waitcnt vmcnt(34)
 s_waitcnt lgkmcnt(4)
 v_mfma_f32_16x16x32_bf16 a[0:3],a[128:131],a[224:227],a[0:3]
 ds_read_b64_tr_b16 a[152:153],v21 offset:17632
 v_mul_f32 v235,v235,v62
 v_mfma_f32_16x16x32_bf16 a[0:3],a[132:135],a[228:231],a[0:3]
 v_mul_f32 v248,v248,v62
 v_mul_f32 v249,v249,v62
 v_mfma_f32_16x16x32_bf16 a[4:7],a[128:131],a[232:235],a[4:7]
 ds_read_b64_tr_b16 a[154:155],v21 offset:17888
 v_mul_f32 v250,v250,v62
 v_mfma_f32_16x16x32_bf16 a[4:7],a[132:135],a[236:239],a[4:7]
 v_mul_f32 v251,v251,v62
 v_cvt_pk_bf16_f32 v232,v232,v233
 v_mfma_f32_16x16x32_bf16 a[8:11],a[128:131],a[240:243],a[8:11]
 ds_read_b64_tr_b16 a[156:157],v21 offset:26400
 v_cvt_pk_bf16_f32 v233,v234,v235
 v_mfma_f32_16x16x32_bf16 a[8:11],a[132:135],a[244:247],a[8:11]
 v_cvt_pk_bf16_f32 v234,v248,v249
 v_cvt_pk_bf16_f32 v235,v250,v251
 v_mfma_f32_16x16x32_bf16 a[12:15],a[128:131],a[248:251],a[12:15]
 ds_read_b64_tr_b16 a[158:159],v21 offset:26656
 v_mul_f32 v236,v236,v63
 v_mfma_f32_16x16x32_bf16 a[12:15],a[132:135],a[252:255],a[12:15]
 buffer_load_dwordx4 a[56:59],v5,s[8:11],s57 offen offset:2048 sc1
 v_mfma_f32_16x16x32_bf16 v[64:67],a[136:139],a[224:227],v[64:67]
 ds_read_b64_tr_b16 a[128:129],v21 offset:17664
 v_mul_f32 v237,v237,v63
 v_mfma_f32_16x16x32_bf16 v[64:67],a[140:143],a[228:231],v[64:67]
 buffer_store_dwordx4 v[232:235],v5,s[8:11],s63 offen offset:1024 sc0 sc1
 v_mfma_f32_16x16x32_bf16 v[68:71],a[136:139],a[232:235],v[68:71]
 ds_read_b64_tr_b16 a[130:131],v21 offset:17920
 v_mul_f32 v238,v238,v63
 v_mfma_f32_16x16x32_bf16 v[68:71],a[140:143],a[236:239],v[68:71]
 v_mul_f32 v239,v239,v63
 v_mul_f32 v252,v252,v63
 v_mfma_f32_16x16x32_bf16 v[72:75],a[136:139],a[240:243],v[72:75]
 ds_read_b64_tr_b16 a[132:133],v21 offset:26432
 v_mul_f32 v253,v253,v63
 v_mfma_f32_16x16x32_bf16 v[72:75],a[140:143],a[244:247],v[72:75]
 v_mul_f32 v254,v254,v63
 v_mul_f32 v255,v255,v63
 v_mfma_f32_16x16x32_bf16 v[76:79],a[136:139],a[248:251],v[76:79]
 ds_read_b64_tr_b16 a[134:135],v21 offset:26688
 v_cvt_pk_bf16_f32 v236,v236,v237
 v_mfma_f32_16x16x32_bf16 v[76:79],a[140:143],a[252:255],v[76:79]
 v_cvt_pk_bf16_f32 v237,v238,v239
 s_waitcnt lgkmcnt(4)
 v_mfma_f32_16x16x32_bf16 a[32:35],a[144:147],a[224:227],a[32:35]
 ds_read_b64_tr_b16 a[136:137],v21 offset:17696
 v_cvt_pk_bf16_f32 v238,v252,v253
 v_mfma_f32_16x16x32_bf16 a[32:35],a[148:151],a[228:231],a[32:35]
 v_cvt_pk_bf16_f32 v239,v254,v255
 v_mfma_f32_16x16x32_bf16 a[36:39],a[144:147],a[232:235],a[36:39]
 ds_read_b64_tr_b16 a[138:139],v21 offset:17952
 v_mfma_f32_16x16x32_bf16 a[36:39],a[148:151],a[236:239],a[36:39]
 buffer_store_dwordx4 v[236:239],v5,s[8:11],s63 offen offset:3072 sc0 sc1
 v_mfma_f32_16x16x32_bf16 a[40:43],a[144:147],a[240:243],a[40:43]
 ds_read_b64_tr_b16 a[140:141],v21 offset:26464
 v_mfma_f32_16x16x32_bf16 a[40:43],a[148:151],a[244:247],a[40:43]
 v_mfma_f32_16x16x32_bf16 a[44:47],a[144:147],a[248:251],a[44:47]
 ds_read_b64_tr_b16 a[142:143],v21 offset:26720
 v_mfma_f32_16x16x32_bf16 a[44:47],a[148:151],a[252:255],a[44:47]
 v_mfma_f32_16x16x32_bf16 v[80:83],a[152:155],a[224:227],v[80:83]
 ds_read_b64_tr_b16 a[144:145],v21 offset:17728
 v_mfma_f32_16x16x32_bf16 v[80:83],a[156:159],a[228:231],v[80:83]
 v_mfma_f32_16x16x32_bf16 v[84:87],a[152:155],a[232:235],v[84:87]
 ds_read_b64_tr_b16 a[146:147],v21 offset:17984
 v_mfma_f32_16x16x32_bf16 v[84:87],a[156:159],a[236:239],v[84:87]
 v_mfma_f32_16x16x32_bf16 v[88:91],a[152:155],a[240:243],v[88:91]
 ds_read_b64_tr_b16 a[148:149],v21 offset:26496
 v_mfma_f32_16x16x32_bf16 v[88:91],a[156:159],a[244:247],v[88:91]
 v_mfma_f32_16x16x32_bf16 v[92:95],a[152:155],a[248:251],v[92:95]
 ds_read_b64_tr_b16 a[150:151],v21 offset:26752
 v_mfma_f32_16x16x32_bf16 v[92:95],a[156:159],a[252:255],v[92:95]
 s_waitcnt lgkmcnt(4)
 v_mfma_f32_16x16x32_bf16 a[64:67],a[128:131],a[224:227],a[64:67]
 ds_read_b64_tr_b16 a[152:153],v21 offset:17760
 v_mfma_f32_16x16x32_bf16 a[64:67],a[132:135],a[228:231],a[64:67]
 v_mfma_f32_16x16x32_bf16 a[68:71],a[128:131],a[232:235],a[68:71]
 ds_read_b64_tr_b16 a[154:155],v21 offset:18016
 s_lshl3_add_u32 s84,s88,0x60001
 v_mfma_f32_16x16x32_bf16 a[68:71],a[132:135],a[236:239],a[68:71]
 buffer_load_dwordx4 a[60:63],v5,s[8:11],s57 offen offset:3072 sc1
 v_mfma_f32_16x16x32_bf16 a[72:75],a[128:131],a[240:243],a[72:75]
 ds_read_b64_tr_b16 a[156:157],v21 offset:26528
 s_lshr_b32 s67,s1,8
 v_mfma_f32_16x16x32_bf16 a[72:75],a[132:135],a[244:247],a[72:75]
 s_bfe_u32 s85,s1,s84
 s_or_b32 s67,s67,0x40000000
 v_mfma_f32_16x16x32_bf16 a[76:79],a[128:131],a[248:251],a[76:79]
 ds_read_b64_tr_b16 a[158:159],v21 offset:26784
 v_add_u32 v20,70144,v21
 v_mfma_f32_16x16x32_bf16 a[76:79],a[132:135],a[252:255],a[76:79]
 s_waitcnt vmcnt(36)
 s_barrier
 v_mfma_f32_16x16x32_bf16 v[96:99],a[136:139],a[224:227],v[96:99]
 ds_read_b64_tr_b16 a[128:129],v20 offset:0
 s_bfe_u32 s67,s67,s84
 v_mfma_f32_16x16x32_bf16 v[96:99],a[140:143],a[228:231],v[96:99]
 s_sub_u32 s67,s67,s85
 s_lshl_b32 s84,s85,17
 v_mfma_f32_16x16x32_bf16 v[100:103],a[136:139],a[232:235],v[100:103]
 ds_read_b64_tr_b16 a[130:131],v20 offset:256
 s_add_u32 s84,s84,3014656
 v_mfma_f32_16x16x32_bf16 v[100:103],a[140:143],a[236:239],v[100:103]
 s_sub_u32 s85,s84,s73
 s_lshr_b32 s85,s85,4
 v_mfma_f32_16x16x32_bf16 v[104:107],a[136:139],a[240:243],v[104:107]
 ds_read_b64_tr_b16 a[132:133],v20 offset:8768
 s_add_u32 s85,s85,s71
 v_mfma_f32_16x16x32_bf16 v[104:107],a[140:143],a[244:247],v[104:107]
 s_sub_u32 s66,0,s67
 s_and_b32 s66,s66,3
 v_mfma_f32_16x16x32_bf16 v[108:111],a[136:139],a[248:251],v[108:111]
 ds_read_b64_tr_b16 a[134:135],v20 offset:9024
 s_mul_i32 s65,s66,3
 v_mfma_f32_16x16x32_bf16 v[108:111],a[140:143],a[252:255],v[108:111]
 s_sub_u32 s67,s67,s65
 s_waitcnt lgkmcnt(4)
 v_mfma_f32_16x16x32_bf16 a[96:99],a[144:147],a[224:227],a[96:99]
 ds_read_b64_tr_b16 a[136:137],v20 offset:32
 s_bfe_u32 s67,s67,0x30002
 v_mfma_f32_16x16x32_bf16 a[96:99],a[148:151],a[228:231],a[96:99]
 s_cmp_lt_i32 s83,2
 s_cbranch_scc1 L_rare
 v_mfma_f32_16x16x32_bf16 a[100:103],a[144:147],a[232:235],a[100:103]
 ds_read_b64_tr_b16 a[138:139],v20 offset:288
 s_mov_b32 s64,87680
 v_mfma_f32_16x16x32_bf16 a[100:103],a[148:151],a[236:239],a[100:103]
 s_add_u32 s68,s70,4096
 s_mov_b32 s58,s84
 v_mfma_f32_16x16x32_bf16 a[104:107],a[144:147],a[240:243],a[104:107]
 ds_read_b64_tr_b16 a[140:141],v20 offset:8800
 s_mov_b32 s57,s85
 v_mfma_f32_16x16x32_bf16 a[104:107],a[148:151],a[244:247],a[104:107]
 v_mfma_f32_16x16x32_bf16 a[108:111],a[144:147],a[248:251],a[108:111]
 ds_read_b64_tr_b16 a[142:143],v20 offset:9056
 v_mfma_f32_16x16x32_bf16 a[108:111],a[148:151],a[252:255],a[108:111]
 v_mfma_f32_16x16x32_bf16 v[112:115],a[152:155],a[224:227],v[112:115]
 ds_read_b64_tr_b16 a[144:145],v20 offset:64
 v_mfma_f32_16x16x32_bf16 v[112:115],a[156:159],a[228:231],v[112:115]
 v_mfma_f32_16x16x32_bf16 v[116:119],a[152:155],a[232:235],v[116:119]
 ds_read_b64_tr_b16 a[146:147],v20 offset:320
 v_mfma_f32_16x16x32_bf16 v[116:119],a[156:159],a[236:239],v[116:119]
 v_mfma_f32_16x16x32_bf16 v[120:123],a[152:155],a[240:243],v[120:123]
 ds_read_b64_tr_b16 a[148:149],v20 offset:8832
 v_mfma_f32_16x16x32_bf16 v[120:123],a[156:159],a[244:247],v[120:123]
 v_mfma_f32_16x16x32_bf16 v[124:127],a[152:155],a[248:251],v[124:127]
 ds_read_b64_tr_b16 a[150:151],v20 offset:9088
 v_mfma_f32_16x16x32_bf16 v[124:127],a[156:159],a[252:255],v[124:127]
 s_waitcnt vmcnt(19)
 s_sub_u32 s66,s66,1
 s_cbranch_scc1 L_c1
L_b0:
 s_waitcnt lgkmcnt(4)
 v_mfma_f32_16x16x32_bf16 a[0:3],a[128:131],a[160:163],a[0:3]
 ds_read_b64_tr_b16 a[152:153],v20 offset:96
 s_add_u32 s57,s57,8192
 v_mfma_f32_16x16x32_bf16 a[0:3],a[132:135],a[164:167],a[0:3]
 buffer_load_dwordx4 a[80:83],v4,s[8:11],s57 offen offset:0 sc1
 v_mfma_f32_16x16x32_bf16 a[4:7],a[128:131],a[168:171],a[4:7]
 ds_read_b64_tr_b16 a[154:155],v20 offset:352
 s_add_u32 s58,s58,131072
 s_mov_b32 s65,s64
 s_add_u32 s64,s64,17536
 s_cmp_eq_u32 s64,140288
 s_cselect_b32 s64,70144,s64
 s_add_u32 m0,s51,s64
 v_mfma_f32_16x16x32_bf16 a[4:7],a[132:135],a[172:175],a[4:7]
 buffer_load_dwordx4 v8,s[28:31],s58 offen offset:0 lds
 v_mfma_f32_16x16x32_bf16 a[8:11],a[128:131],a[176:179],a[8:11]
 ds_read_b64_tr_b16 a[156:157],v20 offset:8864
 v_mfma_f32_16x16x32_bf16 a[8:11],a[132:135],a[180:183],a[8:11]
 buffer_load_dwordx4 v9,s[28:31],s58 offen offset:1088 lds
 v_mfma_f32_16x16x32_bf16 a[12:15],a[128:131],a[184:187],a[12:15]
 ds_read_b64_tr_b16 a[158:159],v20 offset:9120
 v_mfma_f32_16x16x32_bf16 a[12:15],a[132:135],a[188:191],a[12:15]
 v_mfma_f32_16x16x32_bf16 v[64:67],a[136:139],a[160:163],v[64:67]
 ds_read_b64_tr_b16 a[128:129],v20 offset:128
 v_mfma_f32_16x16x32_bf16 v[64:67],a[140:143],a[164:167],v[64:67]
 v_mfma_f32_16x16x32_bf16 v[68:71],a[136:139],a[168:171],v[68:71]
 ds_read_b64_tr_b16 a[130:131],v20 offset:384
 v_mfma_f32_16x16x32_bf16 v[68:71],a[140:143],a[172:175],v[68:71]
 v_mfma_f32_16x16x32_bf16 v[72:75],a[136:139],a[176:179],v[72:75]
 ds_read_b64_tr_b16 a[132:133],v20 offset:8896
 v_mfma_f32_16x16x32_bf16 v[72:75],a[140:143],a[180:183],v[72:75]
 v_mfma_f32_16x16x32_bf16 v[76:79],a[136:139],a[184:187],v[76:79]
 ds_read_b64_tr_b16 a[134:135],v20 offset:9152
 v_mfma_f32_16x16x32_bf16 v[76:79],a[140:143],a[188:191],v[76:79]
 s_waitcnt lgkmcnt(4)
 v_mfma_f32_16x16x32_bf16 a[32:35],a[144:147],a[160:163],a[32:35]
 ds_read_b64_tr_b16 a[136:137],v20 offset:160
 v_mfma_f32_16x16x32_bf16 a[32:35],a[148:151],a[164:167],a[32:35]
 buffer_load_dwordx4 v10,s[28:31],s58 offen offset:2176 lds
 v_mfma_f32_16x16x32_bf16 a[36:39],a[144:147],a[168:171],a[36:39]
 ds_read_b64_tr_b16 a[138:139],v20 offset:416
 v_mfma_f32_16x16x32_bf16 a[36:39],a[148:151],a[172:175],a[36:39]
 v_mfma_f32_16x16x32_bf16 a[40:43],a[144:147],a[176:179],a[40:43]
 ds_read_b64_tr_b16 a[140:141],v20 offset:8928
 v_mfma_f32_16x16x32_bf16 a[40:43],a[148:151],a[180:183],a[40:43]
 buffer_load_dwordx4 v11,s[28:31],s58 offen offset:3264 lds
 v_mfma_f32_16x16x32_bf16 a[44:47],a[144:147],a[184:187],a[44:47]
 ds_read_b64_tr_b16 a[142:143],v20 offset:9184
 v_mfma_f32_16x16x32_bf16 a[44:47],a[148:151],a[188:191],a[44:47]
 v_mfma_f32_16x16x32_bf16 v[80:83],a[152:155],a[160:163],v[80:83]
 ds_read_b64_tr_b16 a[144:145],v20 offset:192
 s_waitcnt vmcnt(6)
 v_mfma_f32_16x16x32_bf16 v[80:83],a[156:159],a[164:167],v[80:83]
 buffer_store_dword v7,off,s[8:11],s68 sc0 sc1
 v_mfma_f32_16x16x32_bf16 v[84:87],a[152:155],a[168:171],v[84:87]
 ds_read_b64_tr_b16 a[146:147],v20 offset:448
 s_brev_b32 s68,2
 v_mfma_f32_16x16x32_bf16 v[84:87],a[156:159],a[172:175],v[84:87]
 v_mfma_f32_16x16x32_bf16 v[88:91],a[152:155],a[176:179],v[88:91]
 ds_read_b64_tr_b16 a[148:149],v20 offset:8960
 v_mfma_f32_16x16x32_bf16 v[88:91],a[156:159],a[180:183],v[88:91]
 v_mfma_f32_16x16x32_bf16 v[92:95],a[152:155],a[184:187],v[92:95]
 ds_read_b64_tr_b16 a[150:151],v20 offset:9216
 v_mfma_f32_16x16x32_bf16 v[92:95],a[156:159],a[188:191],v[92:95]
 s_waitcnt lgkmcnt(4)
 v_mfma_f32_16x16x32_bf16 a[64:67],a[128:131],a[160:163],a[64:67]
 ds_read_b64_tr_b16 a[152:153],v20 offset:224
 v_mfma_f32_16x16x32_bf16 a[64:67],a[132:135],a[164:167],a[64:67]
 v_mfma_f32_16x16x32_bf16 a[68:71],a[128:131],a[168:171],a[68:71]
 ds_read_b64_tr_b16 a[154:155],v20 offset:480
 v_mfma_f32_16x16x32_bf16 a[68:71],a[132:135],a[172:175],a[68:71]
 buffer_load_dwordx4 a[84:87],v4,s[8:11],s57 offen offset:1024 sc1
 v_mfma_f32_16x16x32_bf16 a[72:75],a[128:131],a[176:179],a[72:75]
 ds_read_b64_tr_b16 a[156:157],v20 offset:8992
 v_mfma_f32_16x16x32_bf16 a[72:75],a[132:135],a[180:183],a[72:75]
 v_mfma_f32_16x16x32_bf16 a[76:79],a[128:131],a[184:187],a[76:79]
 ds_read_b64_tr_b16 a[158:159],v20 offset:9248
 v_add_u32 v20,s65,v21
 v_mfma_f32_16x16x32_bf16 a[76:79],a[132:135],a[188:191],a[76:79]
 s_barrier
 v_mfma_f32_16x16x32_bf16 v[96:99],a[136:139],a[160:163],v[96:99]
 ds_read_b64_tr_b16 a[128:129],v20 offset:0
 v_mfma_f32_16x16x32_bf16 v[96:99],a[140:143],a[164:167],v[96:99]
 v_mfma_f32_16x16x32_bf16 v[100:103],a[136:139],a[168:171],v[100:103]
 ds_read_b64_tr_b16 a[130:131],v20 offset:256
 v_mfma_f32_16x16x32_bf16 v[100:103],a[140:143],a[172:175],v[100:103]
 v_mfma_f32_16x16x32_bf16 v[104:107],a[136:139],a[176:179],v[104:107]
 ds_read_b64_tr_b16 a[132:133],v20 offset:8768
 v_mfma_f32_16x16x32_bf16 v[104:107],a[140:143],a[180:183],v[104:107]
 v_mfma_f32_16x16x32_bf16 v[108:111],a[136:139],a[184:187],v[108:111]
 ds_read_b64_tr_b16 a[134:135],v20 offset:9024
 v_mfma_f32_16x16x32_bf16 v[108:111],a[140:143],a[188:191],v[108:111]
 s_waitcnt lgkmcnt(4)
 v_mfma_f32_16x16x32_bf16 a[96:99],a[144:147],a[160:163],a[96:99]
 ds_read_b64_tr_b16 a[136:137],v20 offset:32
 v_mfma_f32_16x16x32_bf16 a[96:99],a[148:151],a[164:167],a[96:99]
 buffer_load_dwordx4 a[88:91],v4,s[8:11],s57 offen offset:2048 sc1
 v_mfma_f32_16x16x32_bf16 a[100:103],a[144:147],a[168:171],a[100:103]
 ds_read_b64_tr_b16 a[138:139],v20 offset:288
 v_mfma_f32_16x16x32_bf16 a[100:103],a[148:151],a[172:175],a[100:103]
 buffer_load_dwordx4 a[92:95],v4,s[8:11],s57 offen offset:3072 sc1
 v_mfma_f32_16x16x32_bf16 a[104:107],a[144:147],a[176:179],a[104:107]
 ds_read_b64_tr_b16 a[140:141],v20 offset:8800
 v_mfma_f32_16x16x32_bf16 a[104:107],a[148:151],a[180:183],a[104:107]
 buffer_load_dwordx4 a[112:115],v5,s[8:11],s57 offen offset:0 sc1
 v_mfma_f32_16x16x32_bf16 a[108:111],a[144:147],a[184:187],a[108:111]
 ds_read_b64_tr_b16 a[142:143],v20 offset:9056
 v_mfma_f32_16x16x32_bf16 a[108:111],a[148:151],a[188:191],a[108:111]
 buffer_load_dwordx4 a[116:119],v5,s[8:11],s57 offen offset:1024 sc1
 v_mfma_f32_16x16x32_bf16 v[112:115],a[152:155],a[160:163],v[112:115]
 ds_read_b64_tr_b16 a[144:145],v20 offset:64
 s_add_u32 s58,s58,131072
 v_mfma_f32_16x16x32_bf16 v[112:115],a[156:159],a[164:167],v[112:115]
 buffer_load_dwordx4 a[120:123],v5,s[8:11],s57 offen offset:2048 sc1
 v_mfma_f32_16x16x32_bf16 v[116:119],a[152:155],a[168:171],v[116:119]
 ds_read_b64_tr_b16 a[146:147],v20 offset:320
 s_mov_b32 s65,s64
 v_mfma_f32_16x16x32_bf16 v[116:119],a[156:159],a[172:175],v[116:119]
 buffer_load_dwordx4 a[124:127],v5,s[8:11],s57 offen offset:3072 sc1
 v_mfma_f32_16x16x32_bf16 v[120:123],a[152:155],a[176:179],v[120:123]
 ds_read_b64_tr_b16 a[148:149],v20 offset:8832
 s_add_u32 s64,s64,17536
 v_mfma_f32_16x16x32_bf16 v[120:123],a[156:159],a[180:183],v[120:123]
 s_cmp_eq_u32 s64,140288
 s_cselect_b32 s64,70144,s64
 v_mfma_f32_16x16x32_bf16 v[124:127],a[152:155],a[184:187],v[124:127]
 ds_read_b64_tr_b16 a[150:151],v20 offset:9088
 v_mfma_f32_16x16x32_bf16 v[124:127],a[156:159],a[188:191],v[124:127]
 s_waitcnt vmcnt(13)
 s_waitcnt lgkmcnt(4)
 v_mfma_f32_16x16x32_bf16 a[0:3],a[128:131],a[16:19],a[0:3]
 ds_read_b64_tr_b16 a[152:153],v20 offset:96
 s_add_u32 m0,s51,s64
 v_mfma_f32_16x16x32_bf16 a[0:3],a[132:135],a[20:23],a[0:3]
 buffer_load_dwordx4 v8,s[28:31],s58 offen offset:0 lds
 v_mfma_f32_16x16x32_bf16 a[4:7],a[128:131],a[24:27],a[4:7]
 ds_read_b64_tr_b16 a[154:155],v20 offset:352
 v_mfma_f32_16x16x32_bf16 a[4:7],a[132:135],a[28:31],a[4:7]
 v_mfma_f32_16x16x32_bf16 a[8:11],a[128:131],a[48:51],a[8:11]
 ds_read_b64_tr_b16 a[156:157],v20 offset:8864
 v_mfma_f32_16x16x32_bf16 a[8:11],a[132:135],a[52:55],a[8:11]
 v_mfma_f32_16x16x32_bf16 a[12:15],a[128:131],a[56:59],a[12:15]
 ds_read_b64_tr_b16 a[158:159],v20 offset:9120
 v_mfma_f32_16x16x32_bf16 a[12:15],a[132:135],a[60:63],a[12:15]
 v_mfma_f32_16x16x32_bf16 v[64:67],a[136:139],a[16:19],v[64:67]
 ds_read_b64_tr_b16 a[128:129],v20 offset:128
 v_mfma_f32_16x16x32_bf16 v[64:67],a[140:143],a[20:23],v[64:67]
 v_mfma_f32_16x16x32_bf16 v[68:71],a[136:139],a[24:27],v[68:71]
 ds_read_b64_tr_b16 a[130:131],v20 offset:384
 v_mfma_f32_16x16x32_bf16 v[68:71],a[140:143],a[28:31],v[68:71]
 v_mfma_f32_16x16x32_bf16 v[72:75],a[136:139],a[48:51],v[72:75]
 ds_read_b64_tr_b16 a[132:133],v20 offset:8896
 v_mfma_f32_16x16x32_bf16 v[72:75],a[140:143],a[52:55],v[72:75]
 v_mfma_f32_16x16x32_bf16 v[76:79],a[136:139],a[56:59],v[76:79]
 ds_read_b64_tr_b16 a[134:135],v20 offset:9152
 v_mfma_f32_16x16x32_bf16 v[76:79],a[140:143],a[60:63],v[76:79]
 s_waitcnt lgkmcnt(4)
 v_mfma_f32_16x16x32_bf16 a[32:35],a[144:147],a[16:19],a[32:35]
 ds_read_b64_tr_b16 a[136:137],v20 offset:160
 v_mfma_f32_16x16x32_bf16 a[32:35],a[148:151],a[20:23],a[32:35]
 v_mfma_f32_16x16x32_bf16 a[36:39],a[144:147],a[24:27],a[36:39]
 ds_read_b64_tr_b16 a[138:139],v20 offset:416
 v_mfma_f32_16x16x32_bf16 a[36:39],a[148:151],a[28:31],a[36:39]
 buffer_load_dwordx4 v9,s[28:31],s58 offen offset:1088 lds
 v_mfma_f32_16x16x32_bf16 a[40:43],a[144:147],a[48:51],a[40:43]
 ds_read_b64_tr_b16 a[140:141],v20 offset:8928
 v_mfma_f32_16x16x32_bf16 a[40:43],a[148:151],a[52:55],a[40:43]
 v_mfma_f32_16x16x32_bf16 a[44:47],a[144:147],a[56:59],a[44:47]
 ds_read_b64_tr_b16 a[142:143],v20 offset:9184
 v_mfma_f32_16x16x32_bf16 a[44:47],a[148:151],a[60:63],a[44:47]
 buffer_load_dwordx4 v10,s[28:31],s58 offen offset:2176 lds
 v_mfma_f32_16x16x32_bf16 v[80:83],a[152:155],a[16:19],v[80:83]
 ds_read_b64_tr_b16 a[144:145],v20 offset:192
 v_mfma_f32_16x16x32_bf16 v[80:83],a[156:159],a[20:23],v[80:83]
 v_mfma_f32_16x16x32_bf16 v[84:87],a[152:155],a[24:27],v[84:87]
 ds_read_b64_tr_b16 a[146:147],v20 offset:448
 v_mfma_f32_16x16x32_bf16 v[84:87],a[156:159],a[28:31],v[84:87]
 v_mfma_f32_16x16x32_bf16 v[88:91],a[152:155],a[48:51],v[88:91]
 ds_read_b64_tr_b16 a[148:149],v20 offset:8960
 v_mfma_f32_16x16x32_bf16 v[88:91],a[156:159],a[52:55],v[88:91]
 buffer_load_dwordx4 v11,s[28:31],s58 offen offset:3264 lds
 v_mfma_f32_16x16x32_bf16 v[92:95],a[152:155],a[56:59],v[92:95]
 ds_read_b64_tr_b16 a[150:151],v20 offset:9216
 v_mfma_f32_16x16x32_bf16 v[92:95],a[156:159],a[60:63],v[92:95]
 s_waitcnt lgkmcnt(4)
 v_mfma_f32_16x16x32_bf16 a[64:67],a[128:131],a[16:19],a[64:67]
 ds_read_b64_tr_b16 a[152:153],v20 offset:224
 s_add_u32 s57,s57,8192
 v_mfma_f32_16x16x32_bf16 a[64:67],a[132:135],a[20:23],a[64:67]
 buffer_load_dwordx4 a[160:163],v4,s[8:11],s57 offen offset:0 sc1
 v_mfma_f32_16x16x32_bf16 a[68:71],a[128:131],a[24:27],a[68:71]
 ds_read_b64_tr_b16 a[154:155],v20 offset:480
 v_mfma_f32_16x16x32_bf16 a[68:71],a[132:135],a[28:31],a[68:71]
 v_mfma_f32_16x16x32_bf16 a[72:75],a[128:131],a[48:51],a[72:75]
 ds_read_b64_tr_b16 a[156:157],v20 offset:8992
 v_mfma_f32_16x16x32_bf16 a[72:75],a[132:135],a[52:55],a[72:75]
 v_mfma_f32_16x16x32_bf16 a[76:79],a[128:131],a[56:59],a[76:79]
 ds_read_b64_tr_b16 a[158:159],v20 offset:9248
 v_add_u32 v20,s65,v21
 v_mfma_f32_16x16x32_bf16 a[76:79],a[132:135],a[60:63],a[76:79]
 s_waitcnt vmcnt(13)
 s_barrier
 v_mfma_f32_16x16x32_bf16 v[96:99],a[136:139],a[16:19],v[96:99]
 ds_read_b64_tr_b16 a[128:129],v20 offset:0
 v_mfma_f32_16x16x32_bf16 v[96:99],a[140:143],a[20:23],v[96:99]
 buffer_load_dwordx4 a[164:167],v4,s[8:11],s57 offen offset:1024 sc1
 v_mfma_f32_16x16x32_bf16 v[100:103],a[136:139],a[24:27],v[100:103]
 ds_read_b64_tr_b16 a[130:131],v20 offset:256
 v_mfma_f32_16x16x32_bf16 v[100:103],a[140:143],a[28:31],v[100:103]
 buffer_load_dwordx4 a[168:171],v4,s[8:11],s57 offen offset:2048 sc1
 v_mfma_f32_16x16x32_bf16 v[104:107],a[136:139],a[48:51],v[104:107]
 ds_read_b64_tr_b16 a[132:133],v20 offset:8768
 v_mfma_f32_16x16x32_bf16 v[104:107],a[140:143],a[52:55],v[104:107]
 v_mfma_f32_16x16x32_bf16 v[108:111],a[136:139],a[56:59],v[108:111]
 ds_read_b64_tr_b16 a[134:135],v20 offset:9024
 v_mfma_f32_16x16x32_bf16 v[108:111],a[140:143],a[60:63],v[108:111]
 s_waitcnt lgkmcnt(4)
 v_mfma_f32_16x16x32_bf16 a[96:99],a[144:147],a[16:19],a[96:99]
 ds_read_b64_tr_b16 a[136:137],v20 offset:32
 v_mfma_f32_16x16x32_bf16 a[96:99],a[148:151],a[20:23],a[96:99]
 buffer_load_dwordx4 a[172:175],v4,s[8:11],s57 offen offset:3072 sc1
 v_mfma_f32_16x16x32_bf16 a[100:103],a[144:147],a[24:27],a[100:103]
 ds_read_b64_tr_b16 a[138:139],v20 offset:288
 v_mfma_f32_16x16x32_bf16 a[100:103],a[148:151],a[28:31],a[100:103]
 buffer_load_dwordx4 a[176:179],v5,s[8:11],s57 offen offset:0 sc1
 v_mfma_f32_16x16x32_bf16 a[104:107],a[144:147],a[48:51],a[104:107]
 ds_read_b64_tr_b16 a[140:141],v20 offset:8800
 v_mfma_f32_16x16x32_bf16 a[104:107],a[148:151],a[52:55],a[104:107]
 buffer_load_dwordx4 a[180:183],v5,s[8:11],s57 offen offset:1024 sc1
 v_mfma_f32_16x16x32_bf16 a[108:111],a[144:147],a[56:59],a[108:111]
 ds_read_b64_tr_b16 a[142:143],v20 offset:9056
 v_mfma_f32_16x16x32_bf16 a[108:111],a[148:151],a[60:63],a[108:111]
 buffer_load_dwordx4 a[184:187],v5,s[8:11],s57 offen offset:2048 sc1
 v_mfma_f32_16x16x32_bf16 v[112:115],a[152:155],a[16:19],v[112:115]
 ds_read_b64_tr_b16 a[144:145],v20 offset:64
 v_mfma_f32_16x16x32_bf16 v[112:115],a[156:159],a[20:23],v[112:115]
 buffer_load_dwordx4 a[188:191],v5,s[8:11],s57 offen offset:3072 sc1
 v_mfma_f32_16x16x32_bf16 v[116:119],a[152:155],a[24:27],v[116:119]
 ds_read_b64_tr_b16 a[146:147],v20 offset:320
 v_mfma_f32_16x16x32_bf16 v[116:119],a[156:159],a[28:31],v[116:119]
 s_add_u32 s58,s58,131072
 s_mov_b32 s65,s64
 v_mfma_f32_16x16x32_bf16 v[120:123],a[152:155],a[48:51],v[120:123]
 ds_read_b64_tr_b16 a[148:149],v20 offset:8832
 s_add_u32 s64,s64,17536
 v_mfma_f32_16x16x32_bf16 v[120:123],a[156:159],a[52:55],v[120:123]
 s_cmp_eq_u32 s64,140288
 s_cselect_b32 s64,70144,s64
 v_mfma_f32_16x16x32_bf16 v[124:127],a[152:155],a[56:59],v[124:127]
 ds_read_b64_tr_b16 a[150:151],v20 offset:9088
 v_mfma_f32_16x16x32_bf16 v[124:127],a[156:159],a[60:63],v[124:127]
 s_waitcnt vmcnt(12)
 s_waitcnt lgkmcnt(4)
 v_mfma_f32_16x16x32_bf16 a[0:3],a[128:131],a[80:83],a[0:3]
 ds_read_b64_tr_b16 a[152:153],v20 offset:96
 s_add_u32 m0,s51,s64
 v_mfma_f32_16x16x32_bf16 a[0:3],a[132:135],a[84:87],a[0:3]
 buffer_load_dwordx4 v8,s[28:31],s58 offen offset:0 lds
 v_mfma_f32_16x16x32_bf16 a[4:7],a[128:131],a[88:91],a[4:7]
 ds_read_b64_tr_b16 a[154:155],v20 offset:352
 v_mfma_f32_16x16x32_bf16 a[4:7],a[132:135],a[92:95],a[4:7]
 v_mfma_f32_16x16x32_bf16 a[8:11],a[128:131],a[112:115],a[8:11]
 ds_read_b64_tr_b16 a[156:157],v20 offset:8864
 v_mfma_f32_16x16x32_bf16 a[8:11],a[132:135],a[116:119],a[8:11]
 v_mfma_f32_16x16x32_bf16 a[12:15],a[128:131],a[120:123],a[12:15]
 ds_read_b64_tr_b16 a[158:159],v20 offset:9120
 v_mfma_f32_16x16x32_bf16 a[12:15],a[132:135],a[124:127],a[12:15]
 buffer_load_dwordx4 v9,s[28:31],s58 offen offset:1088 lds
 v_mfma_f32_16x16x32_bf16 v[64:67],a[136:139],a[80:83],v[64:67]
 ds_read_b64_tr_b16 a[128:129],v20 offset:128
 v_mfma_f32_16x16x32_bf16 v[64:67],a[140:143],a[84:87],v[64:67]
 v_mfma_f32_16x16x32_bf16 v[68:71],a[136:139],a[88:91],v[68:71]
 ds_read_b64_tr_b16 a[130:131],v20 offset:384
 v_mfma_f32_16x16x32_bf16 v[68:71],a[140:143],a[92:95],v[68:71]
 buffer_load_dwordx4 v10,s[28:31],s58 offen offset:2176 lds
 v_mfma_f32_16x16x32_bf16 v[72:75],a[136:139],a[112:115],v[72:75]
 ds_read_b64_tr_b16 a[132:133],v20 offset:8896
 v_mfma_f32_16x16x32_bf16 v[72:75],a[140:143],a[116:119],v[72:75]
 v_mfma_f32_16x16x32_bf16 v[76:79],a[136:139],a[120:123],v[76:79]
 ds_read_b64_tr_b16 a[134:135],v20 offset:9152
 v_mfma_f32_16x16x32_bf16 v[76:79],a[140:143],a[124:127],v[76:79]
 s_waitcnt lgkmcnt(4)
 v_mfma_f32_16x16x32_bf16 a[32:35],a[144:147],a[80:83],a[32:35]
 ds_read_b64_tr_b16 a[136:137],v20 offset:160
 v_mfma_f32_16x16x32_bf16 a[32:35],a[148:151],a[84:87],a[32:35]
 buffer_load_dwordx4 v11,s[28:31],s58 offen offset:3264 lds
 v_mfma_f32_16x16x32_bf16 a[36:39],a[144:147],a[88:91],a[36:39]
 ds_read_b64_tr_b16 a[138:139],v20 offset:416
 v_mfma_f32_16x16x32_bf16 a[36:39],a[148:151],a[92:95],a[36:39]
 v_mfma_f32_16x16x32_bf16 a[40:43],a[144:147],a[112:115],a[40:43]
 ds_read_b64_tr_b16 a[140:141],v20 offset:8928
 s_add_u32 s57,s57,8192
 v_mfma_f32_16x16x32_bf16 a[40:43],a[148:151],a[116:119],a[40:43]
 buffer_load_dwordx4 a[16:19],v4,s[8:11],s57 offen offset:0 sc1
 v_mfma_f32_16x16x32_bf16 a[44:47],a[144:147],a[120:123],a[44:47]
 ds_read_b64_tr_b16 a[142:143],v20 offset:9184
 v_mfma_f32_16x16x32_bf16 a[44:47],a[148:151],a[124:127],a[44:47]
 v_mfma_f32_16x16x32_bf16 v[80:83],a[152:155],a[80:83],v[80:83]
 ds_read_b64_tr_b16 a[144:145],v20 offset:192
 v_mfma_f32_16x16x32_bf16 v[80:83],a[156:159],a[84:87],v[80:83]
 buffer_load_dwordx4 a[20:23],v4,s[8:11],s57 offen offset:1024 sc1
 v_mfma_f32_16x16x32_bf16 v[84:87],a[152:155],a[88:91],v[84:87]
 ds_read_b64_tr_b16 a[146:147],v20 offset:448
 v_mfma_f32_16x16x32_bf16 v[84:87],a[156:159],a[92:95],v[84:87]
 v_mfma_f32_16x16x32_bf16 v[88:91],a[152:155],a[112:115],v[88:91]
 ds_read_b64_tr_b16 a[148:149],v20 offset:8960
 v_mfma_f32_16x16x32_bf16 v[88:91],a[156:159],a[116:119],v[88:91]
 v_mfma_f32_16x16x32_bf16 v[92:95],a[152:155],a[120:123],v[92:95]
 ds_read_b64_tr_b16 a[150:151],v20 offset:9216
 v_mfma_f32_16x16x32_bf16 v[92:95],a[156:159],a[124:127],v[92:95]
 s_waitcnt lgkmcnt(4)
 v_mfma_f32_16x16x32_bf16 a[64:67],a[128:131],a[80:83],a[64:67]
 ds_read_b64_tr_b16 a[152:153],v20 offset:224
 v_mfma_f32_16x16x32_bf16 a[64:67],a[132:135],a[84:87],a[64:67]
 buffer_load_dwordx4 a[24:27],v4,s[8:11],s57 offen offset:2048 sc1
 v_mfma_f32_16x16x32_bf16 a[68:71],a[128:131],a[88:91],a[68:71]
 ds_read_b64_tr_b16 a[154:155],v20 offset:480
 v_mfma_f32_16x16x32_bf16 a[68:71],a[132:135],a[92:95],a[68:71]
 buffer_load_dwordx4 a[28:31],v4,s[8:11],s57 offen offset:3072 sc1
 v_mfma_f32_16x16x32_bf16 a[72:75],a[128:131],a[112:115],a[72:75]
 ds_read_b64_tr_b16 a[156:157],v20 offset:8992
 v_mfma_f32_16x16x32_bf16 a[72:75],a[132:135],a[116:119],a[72:75]
 v_mfma_f32_16x16x32_bf16 a[76:79],a[128:131],a[120:123],a[76:79]
 ds_read_b64_tr_b16 a[158:159],v20 offset:9248
 v_add_u32 v20,s65,v21
 v_mfma_f32_16x16x32_bf16 a[76:79],a[132:135],a[124:127],a[76:79]
 s_waitcnt vmcnt(16)
 s_barrier
 v_mfma_f32_16x16x32_bf16 v[96:99],a[136:139],a[80:83],v[96:99]
 ds_read_b64_tr_b16 a[128:129],v20 offset:0
 v_mfma_f32_16x16x32_bf16 v[96:99],a[140:143],a[84:87],v[96:99]
 buffer_load_dwordx4 a[48:51],v5,s[8:11],s57 offen offset:0 sc1
 v_mfma_f32_16x16x32_bf16 v[100:103],a[136:139],a[88:91],v[100:103]
 ds_read_b64_tr_b16 a[130:131],v20 offset:256
 v_mfma_f32_16x16x32_bf16 v[100:103],a[140:143],a[92:95],v[100:103]
 v_mfma_f32_16x16x32_bf16 v[104:107],a[136:139],a[112:115],v[104:107]
 ds_read_b64_tr_b16 a[132:133],v20 offset:8768
 v_mfma_f32_16x16x32_bf16 v[104:107],a[140:143],a[116:119],v[104:107]
 buffer_load_dwordx4 a[52:55],v5,s[8:11],s57 offen offset:1024 sc1
 v_mfma_f32_16x16x32_bf16 v[108:111],a[136:139],a[120:123],v[108:111]
 ds_read_b64_tr_b16 a[134:135],v20 offset:9024
 v_mfma_f32_16x16x32_bf16 v[108:111],a[140:143],a[124:127],v[108:111]
 s_waitcnt lgkmcnt(4)
 v_mfma_f32_16x16x32_bf16 a[96:99],a[144:147],a[80:83],a[96:99]
 ds_read_b64_tr_b16 a[136:137],v20 offset:32
 v_mfma_f32_16x16x32_bf16 a[96:99],a[148:151],a[84:87],a[96:99]
 buffer_load_dwordx4 a[56:59],v5,s[8:11],s57 offen offset:2048 sc1
 v_mfma_f32_16x16x32_bf16 a[100:103],a[144:147],a[88:91],a[100:103]
 ds_read_b64_tr_b16 a[138:139],v20 offset:288
 v_mfma_f32_16x16x32_bf16 a[100:103],a[148:151],a[92:95],a[100:103]
 buffer_load_dwordx4 a[60:63],v5,s[8:11],s57 offen offset:3072 sc1
 v_mfma_f32_16x16x32_bf16 a[104:107],a[144:147],a[112:115],a[104:107]
 ds_read_b64_tr_b16 a[140:141],v20 offset:8800
 v_mfma_f32_16x16x32_bf16 a[104:107],a[148:151],a[116:119],a[104:107]
 v_mfma_f32_16x16x32_bf16 a[108:111],a[144:147],a[120:123],a[108:111]
 ds_read_b64_tr_b16 a[142:143],v20 offset:9056
 v_mfma_f32_16x16x32_bf16 a[108:111],a[148:151],a[124:127],a[108:111]
 v_mfma_f32_16x16x32_bf16 v[112:115],a[152:155],a[80:83],v[112:115]
 ds_read_b64_tr_b16 a[144:145],v20 offset:64
 v_mfma_f32_16x16x32_bf16 v[112:115],a[156:159],a[84:87],v[112:115]
 v_mfma_f32_16x16x32_bf16 v[116:119],a[152:155],a[88:91],v[116:119]
 ds_read_b64_tr_b16 a[146:147],v20 offset:320
 v_mfma_f32_16x16x32_bf16 v[116:119],a[156:159],a[92:95],v[116:119]
 v_mfma_f32_16x16x32_bf16 v[120:123],a[152:155],a[112:115],v[120:123]
 ds_read_b64_tr_b16 a[148:149],v20 offset:8832
 v_mfma_f32_16x16x32_bf16 v[120:123],a[156:159],a[116:119],v[120:123]
 v_mfma_f32_16x16x32_bf16 v[124:127],a[152:155],a[120:123],v[124:127]
L_w19:
 s_cbranch_execz L_wret1
 ds_read_b64_tr_b16 a[150:151],v20 offset:9088
 v_mfma_f32_16x16x32_bf16 v[124:127],a[156:159],a[124:127],v[124:127]
 s_waitcnt vmcnt(12)
 s_sub_u32 s66,s66,1
 s_cbranch_scc0 L_b0
L_w101:
 s_cbranch_execz L_wret1
L_c1:
 s_sub_u32 s67,s67,1
 s_cbranch_scc1 L_c2
L_b1:
 s_waitcnt lgkmcnt(4)
 v_mfma_f32_16x16x32_bf16 a[0:3],a[128:131],a[160:163],a[0:3]
 ds_read_b64_tr_b16 a[152:153],v20 offset:96
 s_add_u32 s57,s57,8192
 v_mfma_f32_16x16x32_bf16 a[0:3],a[132:135],a[164:167],a[0:3]
 buffer_load_dwordx4 a[80:83],v4,s[8:11],s57 offen offset:0 sc1
 v_mfma_f32_16x16x32_bf16 a[4:7],a[128:131],a[168:171],a[4:7]
 ds_read_b64_tr_b16 a[154:155],v20 offset:352
 s_add_u32 s58,s58,131072
 s_mov_b32 s65,s64
 s_add_u32 s64,s64,17536
 s_cmp_eq_u32 s64,140288
 s_cselect_b32 s64,70144,s64
 s_add_u32 m0,s51,s64
 v_mfma_f32_16x16x32_bf16 a[4:7],a[132:135],a[172:175],a[4:7]
 buffer_load_dwordx4 v8,s[28:31],s58 offen offset:0 lds
 v_mfma_f32_16x16x32_bf16 a[8:11],a[128:131],a[176:179],a[8:11]
 ds_read_b64_tr_b16 a[156:157],v20 offset:8864
 v_mfma_f32_16x16x32_bf16 a[8:11],a[132:135],a[180:183],a[8:11]
 buffer_load_dwordx4 v9,s[28:31],s58 offen offset:1088 lds
 v_mfma_f32_16x16x32_bf16 a[12:15],a[128:131],a[184:187],a[12:15]
 ds_read_b64_tr_b16 a[158:159],v20 offset:9120
 v_mfma_f32_16x16x32_bf16 a[12:15],a[132:135],a[188:191],a[12:15]
 buffer_load_dwordx4 v10,s[28:31],s58 offen offset:2176 lds
 v_mfma_f32_16x16x32_bf16 v[64:67],a[136:139],a[160:163],v[64:67]
 ds_read_b64_tr_b16 a[128:129],v20 offset:128
 v_mfma_f32_16x16x32_bf16 v[64:67],a[140:143],a[164:167],v[64:67]
 v_mfma_f32_16x16x32_bf16 v[68:71],a[136:139],a[168:171],v[68:71]
 ds_read_b64_tr_b16 a[130:131],v20 offset:384
 v_mfma_f32_16x16x32_bf16 v[68:71],a[140:143],a[172:175],v[68:71]
 v_mfma_f32_16x16x32_bf16 v[72:75],a[136:139],a[176:179],v[72:75]
 ds_read_b64_tr_b16 a[132:133],v20 offset:8896
 v_mfma_f32_16x16x32_bf16 v[72:75],a[140:143],a[180:183],v[72:75]
 buffer_load_dwordx4 v11,s[28:31],s58 offen offset:3264 lds
 v_mfma_f32_16x16x32_bf16 v[76:79],a[136:139],a[184:187],v[76:79]
 ds_read_b64_tr_b16 a[134:135],v20 offset:9152
 v_mfma_f32_16x16x32_bf16 v[76:79],a[140:143],a[188:191],v[76:79]
 s_waitcnt lgkmcnt(4)
 v_mfma_f32_16x16x32_bf16 a[32:35],a[144:147],a[160:163],a[32:35]
 ds_read_b64_tr_b16 a[136:137],v20 offset:160
 v_mfma_f32_16x16x32_bf16 a[32:35],a[148:151],a[164:167],a[32:35]
 buffer_load_dwordx4 a[84:87],v4,s[8:11],s57 offen offset:1024 sc1
 v_mfma_f32_16x16x32_bf16 a[36:39],a[144:147],a[168:171],a[36:39]
 ds_read_b64_tr_b16 a[138:139],v20 offset:416
 v_mfma_f32_16x16x32_bf16 a[36:39],a[148:151],a[172:175],a[36:39]
 v_mfma_f32_16x16x32_bf16 a[40:43],a[144:147],a[176:179],a[40:43]
 ds_read_b64_tr_b16 a[140:141],v20 offset:8928
 v_mfma_f32_16x16x32_bf16 a[40:43],a[148:151],a[180:183],a[40:43]
 buffer_load_dwordx4 a[88:91],v4,s[8:11],s57 offen offset:2048 sc1
 v_mfma_f32_16x16x32_bf16 a[44:47],a[144:147],a[184:187],a[44:47]
 ds_read_b64_tr_b16 a[142:143],v20 offset:9184
 v_mfma_f32_16x16x32_bf16 a[44:47],a[148:151],a[188:191],a[44:47]
 v_mfma_f32_16x16x32_bf16 v[80:83],a[152:155],a[160:163],v[80:83]
 ds_read_b64_tr_b16 a[144:145],v20 offset:192
 s_waitcnt vmcnt(8)
 v_mfma_f32_16x16x32_bf16 v[80:83],a[156:159],a[164:167],v[80:83]
 buffer_store_dword v7,off,s[8:11],s68 sc0 sc1
 v_mfma_f32_16x16x32_bf16 v[84:87],a[152:155],a[168:171],v[84:87]
 ds_read_b64_tr_b16 a[146:147],v20 offset:448
 s_brev_b32 s68,2
 v_mfma_f32_16x16x32_bf16 v[84:87],a[156:159],a[172:175],v[84:87]
 buffer_load_dwordx4 a[92:95],v4,s[8:11],s57 offen offset:3072 sc1
 v_mfma_f32_16x16x32_bf16 v[88:91],a[152:155],a[176:179],v[88:91]
 ds_read_b64_tr_b16 a[148:149],v20 offset:8960
 v_mfma_f32_16x16x32_bf16 v[88:91],a[156:159],a[180:183],v[88:91]
 v_mfma_f32_16x16x32_bf16 v[92:95],a[152:155],a[184:187],v[92:95]
 ds_read_b64_tr_b16 a[150:151],v20 offset:9216
 v_mfma_f32_16x16x32_bf16 v[92:95],a[156:159],a[188:191],v[92:95]
 s_waitcnt lgkmcnt(4)
 v_mfma_f32_16x16x32_bf16 a[64:67],a[128:131],a[160:163],a[64:67]
 ds_read_b64_tr_b16 a[152:153],v20 offset:224
 v_mfma_f32_16x16x32_bf16 a[64:67],a[132:135],a[164:167],a[64:67]
 v_mfma_f32_16x16x32_bf16 a[68:71],a[128:131],a[168:171],a[68:71]
 ds_read_b64_tr_b16 a[154:155],v20 offset:480
 v_mfma_f32_16x16x32_bf16 a[68:71],a[132:135],a[172:175],a[68:71]
 v_mfma_f32_16x16x32_bf16 a[72:75],a[128:131],a[176:179],a[72:75]
 ds_read_b64_tr_b16 a[156:157],v20 offset:8992
 v_mfma_f32_16x16x32_bf16 a[72:75],a[132:135],a[180:183],a[72:75]
 v_mfma_f32_16x16x32_bf16 a[76:79],a[128:131],a[184:187],a[76:79]
 ds_read_b64_tr_b16 a[158:159],v20 offset:9248
 v_add_u32 v20,s65,v21
 v_mfma_f32_16x16x32_bf16 a[76:79],a[132:135],a[188:191],a[76:79]
 s_barrier
 v_mfma_f32_16x16x32_bf16 v[96:99],a[136:139],a[160:163],v[96:99]
 ds_read_b64_tr_b16 a[128:129],v20 offset:0
 v_mfma_f32_16x16x32_bf16 v[96:99],a[140:143],a[164:167],v[96:99]
 buffer_load_dwordx4 a[112:115],v5,s[8:11],s57 offen offset:0 sc1
 v_mfma_f32_16x16x32_bf16 v[100:103],a[136:139],a[168:171],v[100:103]
 ds_read_b64_tr_b16 a[130:131],v20 offset:256
 v_mfma_f32_16x16x32_bf16 v[100:103],a[140:143],a[172:175],v[100:103]
 buffer_load_dwordx4 a[116:119],v5,s[8:11],s57 offen offset:1024 sc1
 v_mfma_f32_16x16x32_bf16 v[104:107],a[136:139],a[176:179],v[104:107]
 ds_read_b64_tr_b16 a[132:133],v20 offset:8768
 v_mfma_f32_16x16x32_bf16 v[104:107],a[140:143],a[180:183],v[104:107]
 v_mfma_f32_16x16x32_bf16 v[108:111],a[136:139],a[184:187],v[108:111]
 ds_read_b64_tr_b16 a[134:135],v20 offset:9024
 v_mfma_f32_16x16x32_bf16 v[108:111],a[140:143],a[188:191],v[108:111]
 s_waitcnt lgkmcnt(4)
 v_mfma_f32_16x16x32_bf16 a[96:99],a[144:147],a[160:163],a[96:99]
 ds_read_b64_tr_b16 a[136:137],v20 offset:32
 v_mfma_f32_16x16x32_bf16 a[96:99],a[148:151],a[164:167],a[96:99]
 buffer_load_dwordx4 a[120:123],v5,s[8:11],s57 offen offset:2048 sc1
 v_mfma_f32_16x16x32_bf16 a[100:103],a[144:147],a[168:171],a[100:103]
 ds_read_b64_tr_b16 a[138:139],v20 offset:288
 v_mfma_f32_16x16x32_bf16 a[100:103],a[148:151],a[172:175],a[100:103]
 s_add_u32 s58,s58,131072
 v_mfma_f32_16x16x32_bf16 a[104:107],a[144:147],a[176:179],a[104:107]
 ds_read_b64_tr_b16 a[140:141],v20 offset:8800
 s_mov_b32 s65,s64
 v_mfma_f32_16x16x32_bf16 a[104:107],a[148:151],a[180:183],a[104:107]
 buffer_load_dwordx4 a[124:127],v5,s[8:11],s57 offen offset:3072 sc1
 v_mfma_f32_16x16x32_bf16 a[108:111],a[144:147],a[184:187],a[108:111]
 ds_read_b64_tr_b16 a[142:143],v20 offset:9056
 s_add_u32 s64,s64,17536
 v_mfma_f32_16x16x32_bf16 a[108:111],a[148:151],a[188:191],a[108:111]
 s_cmp_eq_u32 s64,140288
 s_cselect_b32 s64,70144,s64
 v_mfma_f32_16x16x32_bf16 v[112:115],a[152:155],a[160:163],v[112:115]
 ds_read_b64_tr_b16 a[144:145],v20 offset:64
 s_add_u32 m0,s51,s64
 v_mfma_f32_16x16x32_bf16 v[112:115],a[156:159],a[164:167],v[112:115]
 buffer_load_dwordx4 v8,s[28:31],s58 offen offset:0 lds
 v_mfma_f32_16x16x32_bf16 v[116:119],a[152:155],a[168:171],v[116:119]
 ds_read_b64_tr_b16 a[146:147],v20 offset:320
 v_mfma_f32_16x16x32_bf16 v[116:119],a[156:159],a[172:175],v[116:119]
 v_mfma_f32_16x16x32_bf16 v[120:123],a[152:155],a[176:179],v[120:123]
 ds_read_b64_tr_b16 a[148:149],v20 offset:8832
 v_mfma_f32_16x16x32_bf16 v[120:123],a[156:159],a[180:183],v[120:123]
 buffer_load_dwordx4 v9,s[28:31],s58 offen offset:1088 lds
 v_mfma_f32_16x16x32_bf16 v[124:127],a[152:155],a[184:187],v[124:127]
 ds_read_b64_tr_b16 a[150:151],v20 offset:9088
 v_mfma_f32_16x16x32_bf16 v[124:127],a[156:159],a[188:191],v[124:127]
 s_waitcnt vmcnt(15)
 s_waitcnt lgkmcnt(4)
 v_mfma_f32_16x16x32_bf16 a[0:3],a[128:131],a[16:19],a[0:3]
 ds_read_b64_tr_b16 a[152:153],v20 offset:96
 v_mfma_f32_16x16x32_bf16 a[0:3],a[132:135],a[20:23],a[0:3]
 v_mfma_f32_16x16x32_bf16 a[4:7],a[128:131],a[24:27],a[4:7]
 ds_read_b64_tr_b16 a[154:155],v20 offset:352
 v_mfma_f32_16x16x32_bf16 a[4:7],a[132:135],a[28:31],a[4:7]
 buffer_load_dwordx4 v10,s[28:31],s58 offen offset:2176 lds
 v_mfma_f32_16x16x32_bf16 a[8:11],a[128:131],a[48:51],a[8:11]
 ds_read_b64_tr_b16 a[156:157],v20 offset:8864
 v_mfma_f32_16x16x32_bf16 a[8:11],a[132:135],a[52:55],a[8:11]
 v_mfma_f32_16x16x32_bf16 a[12:15],a[128:131],a[56:59],a[12:15]
 ds_read_b64_tr_b16 a[158:159],v20 offset:9120
 v_mfma_f32_16x16x32_bf16 a[12:15],a[132:135],a[60:63],a[12:15]
 buffer_load_dwordx4 v11,s[28:31],s58 offen offset:3264 lds
 v_mfma_f32_16x16x32_bf16 v[64:67],a[136:139],a[16:19],v[64:67]
 ds_read_b64_tr_b16 a[128:129],v20 offset:128
 v_mfma_f32_16x16x32_bf16 v[64:67],a[140:143],a[20:23],v[64:67]
 v_mfma_f32_16x16x32_bf16 v[68:71],a[136:139],a[24:27],v[68:71]
 ds_read_b64_tr_b16 a[130:131],v20 offset:384
 v_mfma_f32_16x16x32_bf16 v[68:71],a[140:143],a[28:31],v[68:71]
 v_mfma_f32_16x16x32_bf16 v[72:75],a[136:139],a[48:51],v[72:75]
 ds_read_b64_tr_b16 a[132:133],v20 offset:8896
 v_mfma_f32_16x16x32_bf16 v[72:75],a[140:143],a[52:55],v[72:75]
 v_mfma_f32_16x16x32_bf16 v[76:79],a[136:139],a[56:59],v[76:79]
 ds_read_b64_tr_b16 a[134:135],v20 offset:9152
 v_mfma_f32_16x16x32_bf16 v[76:79],a[140:143],a[60:63],v[76:79]
 s_waitcnt lgkmcnt(4)
 v_mfma_f32_16x16x32_bf16 a[32:35],a[144:147],a[16:19],a[32:35]
 ds_read_b64_tr_b16 a[136:137],v20 offset:160
 v_mfma_f32_16x16x32_bf16 a[32:35],a[148:151],a[20:23],a[32:35]
 v_mfma_f32_16x16x32_bf16 a[36:39],a[144:147],a[24:27],a[36:39]
 ds_read_b64_tr_b16 a[138:139],v20 offset:416
 v_mfma_f32_16x16x32_bf16 a[36:39],a[148:151],a[28:31],a[36:39]
 v_mfma_f32_16x16x32_bf16 a[40:43],a[144:147],a[48:51],a[40:43]
 ds_read_b64_tr_b16 a[140:141],v20 offset:8928
 v_mfma_f32_16x16x32_bf16 a[40:43],a[148:151],a[52:55],a[40:43]
 v_mfma_f32_16x16x32_bf16 a[44:47],a[144:147],a[56:59],a[44:47]
 ds_read_b64_tr_b16 a[142:143],v20 offset:9184
 v_mfma_f32_16x16x32_bf16 a[44:47],a[148:151],a[60:63],a[44:47]
 v_mfma_f32_16x16x32_bf16 v[80:83],a[152:155],a[16:19],v[80:83]
 ds_read_b64_tr_b16 a[144:145],v20 offset:192
 v_mfma_f32_16x16x32_bf16 v[80:83],a[156:159],a[20:23],v[80:83]
 v_mfma_f32_16x16x32_bf16 v[84:87],a[152:155],a[24:27],v[84:87]
 ds_read_b64_tr_b16 a[146:147],v20 offset:448
 v_mfma_f32_16x16x32_bf16 v[84:87],a[156:159],a[28:31],v[84:87]
 v_mfma_f32_16x16x32_bf16 v[88:91],a[152:155],a[48:51],v[88:91]
 ds_read_b64_tr_b16 a[148:149],v20 offset:8960
 v_mfma_f32_16x16x32_bf16 v[88:91],a[156:159],a[52:55],v[88:91]
 v_mfma_f32_16x16x32_bf16 v[92:95],a[152:155],a[56:59],v[92:95]
 ds_read_b64_tr_b16 a[150:151],v20 offset:9216
 v_mfma_f32_16x16x32_bf16 v[92:95],a[156:159],a[60:63],v[92:95]
 s_waitcnt lgkmcnt(4)
 v_mfma_f32_16x16x32_bf16 a[64:67],a[128:131],a[16:19],a[64:67]
 ds_read_b64_tr_b16 a[152:153],v20 offset:224
 s_add_u32 s57,s57,8192
 v_mfma_f32_16x16x32_bf16 a[64:67],a[132:135],a[20:23],a[64:67]
 buffer_load_dwordx4 a[192:195],v4,s[8:11],s57 offen offset:0 sc1
 v_mfma_f32_16x16x32_bf16 a[68:71],a[128:131],a[24:27],a[68:71]
 ds_read_b64_tr_b16 a[154:155],v20 offset:480
 v_mfma_f32_16x16x32_bf16 a[68:71],a[132:135],a[28:31],a[68:71]
 v_mfma_f32_16x16x32_bf16 a[72:75],a[128:131],a[48:51],a[72:75]
 ds_read_b64_tr_b16 a[156:157],v20 offset:8992
 v_mfma_f32_16x16x32_bf16 a[72:75],a[132:135],a[52:55],a[72:75]
 buffer_load_dwordx4 a[196:199],v4,s[8:11],s57 offen offset:1024 sc1
 v_mfma_f32_16x16x32_bf16 a[76:79],a[128:131],a[56:59],a[76:79]
 ds_read_b64_tr_b16 a[158:159],v20 offset:9248
 v_add_u32 v20,s65,v21
 v_mfma_f32_16x16x32_bf16 a[76:79],a[132:135],a[60:63],a[76:79]
 s_waitcnt vmcnt(14)
 s_barrier
 v_mfma_f32_16x16x32_bf16 v[96:99],a[136:139],a[16:19],v[96:99]
 ds_read_b64_tr_b16 a[128:129],v20 offset:0
 v_mfma_f32_16x16x32_bf16 v[96:99],a[140:143],a[20:23],v[96:99]
 v_mfma_f32_16x16x32_bf16 v[100:103],a[136:139],a[24:27],v[100:103]
 ds_read_b64_tr_b16 a[130:131],v20 offset:256
 v_mfma_f32_16x16x32_bf16 v[100:103],a[140:143],a[28:31],v[100:103]
 buffer_load_dwordx4 a[200:203],v4,s[8:11],s57 offen offset:2048 sc1
 v_mfma_f32_16x16x32_bf16 v[104:107],a[136:139],a[48:51],v[104:107]
 ds_read_b64_tr_b16 a[132:133],v20 offset:8768
 v_mfma_f32_16x16x32_bf16 v[104:107],a[140:143],a[52:55],v[104:107]
 v_mfma_f32_16x16x32_bf16 v[108:111],a[136:139],a[56:59],v[108:111]
 ds_read_b64_tr_b16 a[134:135],v20 offset:9024
 v_mfma_f32_16x16x32_bf16 v[108:111],a[140:143],a[60:63],v[108:111]
 s_waitcnt lgkmcnt(4)
 v_mfma_f32_16x16x32_bf16 a[96:99],a[144:147],a[16:19],a[96:99]
 ds_read_b64_tr_b16 a[136:137],v20 offset:32
 v_mfma_f32_16x16x32_bf16 a[96:99],a[148:151],a[20:23],a[96:99]
 buffer_load_dwordx4 a[204:207],v4,s[8:11],s57 offen offset:3072 sc1
 v_mfma_f32_16x16x32_bf16 a[100:103],a[144:147],a[24:27],a[100:103]
 ds_read_b64_tr_b16 a[138:139],v20 offset:288
 v_mfma_f32_16x16x32_bf16 a[100:103],a[148:151],a[28:31],a[100:103]
 buffer_load_dwordx4 a[208:211],v5,s[8:11],s57 offen offset:0 sc1
 v_mfma_f32_16x16x32_bf16 a[104:107],a[144:147],a[48:51],a[104:107]
 ds_read_b64_tr_b16 a[140:141],v20 offset:8800
 v_mfma_f32_16x16x32_bf16 a[104:107],a[148:151],a[52:55],a[104:107]
 buffer_load_dwordx4 a[212:215],v5,s[8:11],s57 offen offset:1024 sc1
 v_mfma_f32_16x16x32_bf16 a[108:111],a[144:147],a[56:59],a[108:111]
 ds_read_b64_tr_b16 a[142:143],v20 offset:9056
 v_mfma_f32_16x16x32_bf16 a[108:111],a[148:151],a[60:63],a[108:111]
 buffer_load_dwordx4 a[216:219],v5,s[8:11],s57 offen offset:2048 sc1
 v_mfma_f32_16x16x32_bf16 v[112:115],a[152:155],a[16:19],v[112:115]
 ds_read_b64_tr_b16 a[144:145],v20 offset:64
 v_mfma_f32_16x16x32_bf16 v[112:115],a[156:159],a[20:23],v[112:115]
 buffer_load_dwordx4 a[220:223],v5,s[8:11],s57 offen offset:3072 sc1
 v_mfma_f32_16x16x32_bf16 v[116:119],a[152:155],a[24:27],v[116:119]
 ds_read_b64_tr_b16 a[146:147],v20 offset:320
 v_mfma_f32_16x16x32_bf16 v[116:119],a[156:159],a[28:31],v[116:119]
 s_add_u32 s58,s58,131072
 s_mov_b32 s65,s64
 v_mfma_f32_16x16x32_bf16 v[120:123],a[152:155],a[48:51],v[120:123]
 ds_read_b64_tr_b16 a[148:149],v20 offset:8832
 s_add_u32 s64,s64,17536
 v_mfma_f32_16x16x32_bf16 v[120:123],a[156:159],a[52:55],v[120:123]
 s_cmp_eq_u32 s64,140288
 s_cselect_b32 s64,70144,s64
 v_mfma_f32_16x16x32_bf16 v[124:127],a[152:155],a[56:59],v[124:127]
 ds_read_b64_tr_b16 a[150:151],v20 offset:9088
 v_mfma_f32_16x16x32_bf16 v[124:127],a[156:159],a[60:63],v[124:127]
 s_waitcnt vmcnt(12)
 s_waitcnt lgkmcnt(4)
 v_mfma_f32_16x16x32_bf16 a[0:3],a[128:131],a[80:83],a[0:3]
 ds_read_b64_tr_b16 a[152:153],v20 offset:96
 s_add_u32 m0,s51,s64
 v_mfma_f32_16x16x32_bf16 a[0:3],a[132:135],a[84:87],a[0:3]
 buffer_load_dwordx4 v8,s[28:31],s58 offen offset:0 lds
 v_mfma_f32_16x16x32_bf16 a[4:7],a[128:131],a[88:91],a[4:7]
 ds_read_b64_tr_b16 a[154:155],v20 offset:352
 v_mfma_f32_16x16x32_bf16 a[4:7],a[132:135],a[92:95],a[4:7]
 buffer_load_dwordx4 v9,s[28:31],s58 offen offset:1088 lds
 v_mfma_f32_16x16x32_bf16 a[8:11],a[128:131],a[112:115],a[8:11]
 ds_read_b64_tr_b16 a[156:157],v20 offset:8864
 v_mfma_f32_16x16x32_bf16 a[8:11],a[132:135],a[116:119],a[8:11]
 v_mfma_f32_16x16x32_bf16 a[12:15],a[128:131],a[120:123],a[12:15]
 ds_read_b64_tr_b16 a[158:159],v20 offset:9120
 v_mfma_f32_16x16x32_bf16 a[12:15],a[132:135],a[124:127],a[12:15]
 v_mfma_f32_16x16x32_bf16 v[64:67],a[136:139],a[80:83],v[64:67]
 ds_read_b64_tr_b16 a[128:129],v20 offset:128
 v_mfma_f32_16x16x32_bf16 v[64:67],a[140:143],a[84:87],v[64:67]
 buffer_load_dwordx4 v10,s[28:31],s58 offen offset:2176 lds
 v_mfma_f32_16x16x32_bf16 v[68:71],a[136:139],a[88:91],v[68:71]
 ds_read_b64_tr_b16 a[130:131],v20 offset:384
 v_mfma_f32_16x16x32_bf16 v[68:71],a[140:143],a[92:95],v[68:71]
 v_mfma_f32_16x16x32_bf16 v[72:75],a[136:139],a[112:115],v[72:75]
 ds_read_b64_tr_b16 a[132:133],v20 offset:8896
 v_mfma_f32_16x16x32_bf16 v[72:75],a[140:143],a[116:119],v[72:75]
 v_mfma_f32_16x16x32_bf16 v[76:79],a[136:139],a[120:123],v[76:79]
 ds_read_b64_tr_b16 a[134:135],v20 offset:9152
 v_mfma_f32_16x16x32_bf16 v[76:79],a[140:143],a[124:127],v[76:79]
 s_waitcnt lgkmcnt(4)
 v_mfma_f32_16x16x32_bf16 a[32:35],a[144:147],a[80:83],a[32:35]
 ds_read_b64_tr_b16 a[136:137],v20 offset:160
 v_mfma_f32_16x16x32_bf16 a[32:35],a[148:151],a[84:87],a[32:35]
 buffer_load_dwordx4 v11,s[28:31],s58 offen offset:3264 lds
 v_mfma_f32_16x16x32_bf16 a[36:39],a[144:147],a[88:91],a[36:39]
 ds_read_b64_tr_b16 a[138:139],v20 offset:416
 s_add_u32 s57,s57,8192
 v_mfma_f32_16x16x32_bf16 a[36:39],a[148:151],a[92:95],a[36:39]
 buffer_load_dwordx4 a[160:163],v4,s[8:11],s57 offen offset:0 sc1
 v_mfma_f32_16x16x32_bf16 a[40:43],a[144:147],a[112:115],a[40:43]
 ds_read_b64_tr_b16 a[140:141],v20 offset:8928
 v_mfma_f32_16x16x32_bf16 a[40:43],a[148:151],a[116:119],a[40:43]
 v_mfma_f32_16x16x32_bf16 a[44:47],a[144:147],a[120:123],a[44:47]
 ds_read_b64_tr_b16 a[142:143],v20 offset:9184
 v_mfma_f32_16x16x32_bf16 a[44:47],a[148:151],a[124:127],a[44:47]
 v_mfma_f32_16x16x32_bf16 v[80:83],a[152:155],a[80:83],v[80:83]
 ds_read_b64_tr_b16 a[144:145],v20 offset:192
 v_mfma_f32_16x16x32_bf16 v[80:83],a[156:159],a[84:87],v[80:83]
 buffer_load_dwordx4 a[164:167],v4,s[8:11],s57 offen offset:1024 sc1
 v_mfma_f32_16x16x32_bf16 v[84:87],a[152:155],a[88:91],v[84:87]
 ds_read_b64_tr_b16 a[146:147],v20 offset:448
 v_mfma_f32_16x16x32_bf16 v[84:87],a[156:159],a[92:95],v[84:87]
 v_mfma_f32_16x16x32_bf16 v[88:91],a[152:155],a[112:115],v[88:91]
 ds_read_b64_tr_b16 a[148:149],v20 offset:8960
 v_mfma_f32_16x16x32_bf16 v[88:91],a[156:159],a[116:119],v[88:91]
 buffer_load_dwordx4 a[168:171],v4,s[8:11],s57 offen offset:2048 sc1
 v_mfma_f32_16x16x32_bf16 v[92:95],a[152:155],a[120:123],v[92:95]
 ds_read_b64_tr_b16 a[150:151],v20 offset:9216
 v_mfma_f32_16x16x32_bf16 v[92:95],a[156:159],a[124:127],v[92:95]
 s_waitcnt lgkmcnt(4)
 v_mfma_f32_16x16x32_bf16 a[64:67],a[128:131],a[80:83],a[64:67]
 ds_read_b64_tr_b16 a[152:153],v20 offset:224
 v_mfma_f32_16x16x32_bf16 a[64:67],a[132:135],a[84:87],a[64:67]
 buffer_load_dwordx4 a[172:175],v4,s[8:11],s57 offen offset:3072 sc1
 v_mfma_f32_16x16x32_bf16 a[68:71],a[128:131],a[88:91],a[68:71]
 ds_read_b64_tr_b16 a[154:155],v20 offset:480
 v_mfma_f32_16x16x32_bf16 a[68:71],a[132:135],a[92:95],a[68:71]
 v_mfma_f32_16x16x32_bf16 a[72:75],a[128:131],a[112:115],a[72:75]
 ds_read_b64_tr_b16 a[156:157],v20 offset:8992
 v_mfma_f32_16x16x32_bf16 a[72:75],a[132:135],a[116:119],a[72:75]
 v_mfma_f32_16x16x32_bf16 a[76:79],a[128:131],a[120:123],a[76:79]
 ds_read_b64_tr_b16 a[158:159],v20 offset:9248
 v_add_u32 v20,s65,v21
 v_mfma_f32_16x16x32_bf16 a[76:79],a[132:135],a[124:127],a[76:79]
 s_waitcnt vmcnt(16)
 s_barrier
 v_mfma_f32_16x16x32_bf16 v[96:99],a[136:139],a[80:83],v[96:99]
 ds_read_b64_tr_b16 a[128:129],v20 offset:0
 v_mfma_f32_16x16x32_bf16 v[96:99],a[140:143],a[84:87],v[96:99]
 buffer_load_dwordx4 a[176:179],v5,s[8:11],s57 offen offset:0 sc1
 v_mfma_f32_16x16x32_bf16 v[100:103],a[136:139],a[88:91],v[100:103]
 ds_read_b64_tr_b16 a[130:131],v20 offset:256
 v_mfma_f32_16x16x32_bf16 v[100:103],a[140:143],a[92:95],v[100:103]
 buffer_load_dwordx4 a[180:183],v5,s[8:11],s57 offen offset:1024 sc1
 v_mfma_f32_16x16x32_bf16 v[104:107],a[136:139],a[112:115],v[104:107]
 ds_read_b64_tr_b16 a[132:133],v20 offset:8768
 v_mfma_f32_16x16x32_bf16 v[104:107],a[140:143],a[116:119],v[104:107]
 v_mfma_f32_16x16x32_bf16 v[108:111],a[136:139],a[120:123],v[108:111]
 ds_read_b64_tr_b16 a[134:135],v20 offset:9024
 v_mfma_f32_16x16x32_bf16 v[108:111],a[140:143],a[124:127],v[108:111]
 s_waitcnt lgkmcnt(4)
 v_mfma_f32_16x16x32_bf16 a[96:99],a[144:147],a[80:83],a[96:99]
 ds_read_b64_tr_b16 a[136:137],v20 offset:32
 v_mfma_f32_16x16x32_bf16 a[96:99],a[148:151],a[84:87],a[96:99]
 buffer_load_dwordx4 a[184:187],v5,s[8:11],s57 offen offset:2048 sc1
 v_mfma_f32_16x16x32_bf16 a[100:103],a[144:147],a[88:91],a[100:103]
 ds_read_b64_tr_b16 a[138:139],v20 offset:288
 v_mfma_f32_16x16x32_bf16 a[100:103],a[148:151],a[92:95],a[100:103]
 s_add_u32 s58,s58,131072
 v_mfma_f32_16x16x32_bf16 a[104:107],a[144:147],a[112:115],a[104:107]
 ds_read_b64_tr_b16 a[140:141],v20 offset:8800
 s_mov_b32 s65,s64
 v_mfma_f32_16x16x32_bf16 a[104:107],a[148:151],a[116:119],a[104:107]
 buffer_load_dwordx4 a[188:191],v5,s[8:11],s57 offen offset:3072 sc1
 v_mfma_f32_16x16x32_bf16 a[108:111],a[144:147],a[120:123],a[108:111]
 ds_read_b64_tr_b16 a[142:143],v20 offset:9056
 s_add_u32 s64,s64,17536
 v_mfma_f32_16x16x32_bf16 a[108:111],a[148:151],a[124:127],a[108:111]
 s_cmp_eq_u32 s64,140288
 s_cselect_b32 s64,70144,s64
 v_mfma_f32_16x16x32_bf16 v[112:115],a[152:155],a[80:83],v[112:115]
 ds_read_b64_tr_b16 a[144:145],v20 offset:64
 s_add_u32 m0,s51,s64
 v_mfma_f32_16x16x32_bf16 v[112:115],a[156:159],a[84:87],v[112:115]
 buffer_load_dwordx4 v8,s[28:31],s58 offen offset:0 lds
 v_mfma_f32_16x16x32_bf16 v[116:119],a[152:155],a[88:91],v[116:119]
 ds_read_b64_tr_b16 a[146:147],v20 offset:320
 v_mfma_f32_16x16x32_bf16 v[116:119],a[156:159],a[92:95],v[116:119]
 v_mfma_f32_16x16x32_bf16 v[120:123],a[152:155],a[112:115],v[120:123]
 ds_read_b64_tr_b16 a[148:149],v20 offset:8832
 v_mfma_f32_16x16x32_bf16 v[120:123],a[156:159],a[116:119],v[120:123]
 v_mfma_f32_16x16x32_bf16 v[124:127],a[152:155],a[120:123],v[124:127]
 ds_read_b64_tr_b16 a[150:151],v20 offset:9088
 v_mfma_f32_16x16x32_bf16 v[124:127],a[156:159],a[124:127],v[124:127]
 s_waitcnt vmcnt(13)
 s_waitcnt lgkmcnt(4)
 v_mfma_f32_16x16x32_bf16 a[0:3],a[128:131],a[192:195],a[0:3]
 ds_read_b64_tr_b16 a[152:153],v20 offset:96
 v_mfma_f32_16x16x32_bf16 a[0:3],a[132:135],a[196:199],a[0:3]
 buffer_load_dwordx4 v9,s[28:31],s58 offen offset:1088 lds
 v_mfma_f32_16x16x32_bf16 a[4:7],a[128:131],a[200:203],a[4:7]
 ds_read_b64_tr_b16 a[154:155],v20 offset:352
 v_mfma_f32_16x16x32_bf16 a[4:7],a[132:135],a[204:207],a[4:7]
 v_mfma_f32_16x16x32_bf16 a[8:11],a[128:131],a[208:211],a[8:11]
 ds_read_b64_tr_b16 a[156:157],v20 offset:8864
 v_mfma_f32_16x16x32_bf16 a[8:11],a[132:135],a[212:215],a[8:11]
 buffer_load_dwordx4 v10,s[28:31],s58 offen offset:2176 lds
 v_mfma_f32_16x16x32_bf16 a[12:15],a[128:131],a[216:219],a[12:15]
 ds_read_b64_tr_b16 a[158:159],v20 offset:9120
 v_mfma_f32_16x16x32_bf16 a[12:15],a[132:135],a[220:223],a[12:15]
 v_mfma_f32_16x16x32_bf16 v[64:67],a[136:139],a[192:195],v[64:67]
 ds_read_b64_tr_b16 a[128:129],v20 offset:128
 v_mfma_f32_16x16x32_bf16 v[64:67],a[140:143],a[196:199],v[64:67]
 buffer_load_dwordx4 v11,s[28:31],s58 offen offset:3264 lds
 v_mfma_f32_16x16x32_bf16 v[68:71],a[136:139],a[200:203],v[68:71]
 ds_read_b64_tr_b16 a[130:131],v20 offset:384
 v_mfma_f32_16x16x32_bf16 v[68:71],a[140:143],a[204:207],v[68:71]
 v_mfma_f32_16x16x32_bf16 v[72:75],a[136:139],a[208:211],v[72:75]
 ds_read_b64_tr_b16 a[132:133],v20 offset:8896
 v_mfma_f32_16x16x32_bf16 v[72:75],a[140:143],a[212:215],v[72:75]
 v_mfma_f32_16x16x32_bf16 v[76:79],a[136:139],a[216:219],v[76:79]
 ds_read_b64_tr_b16 a[134:135],v20 offset:9152
 v_mfma_f32_16x16x32_bf16 v[76:79],a[140:143],a[220:223],v[76:79]
 s_waitcnt lgkmcnt(4)
 v_mfma_f32_16x16x32_bf16 a[32:35],a[144:147],a[192:195],a[32:35]
 ds_read_b64_tr_b16 a[136:137],v20 offset:160
 s_add_u32 s57,s57,8192
 v_mfma_f32_16x16x32_bf16 a[32:35],a[148:151],a[196:199],a[32:35]
 buffer_load_dwordx4 a[16:19],v4,s[8:11],s57 offen offset:0 sc1
 v_mfma_f32_16x16x32_bf16 a[36:39],a[144:147],a[200:203],a[36:39]
 ds_read_b64_tr_b16 a[138:139],v20 offset:416
 v_mfma_f32_16x16x32_bf16 a[36:39],a[148:151],a[204:207],a[36:39]
 v_mfma_f32_16x16x32_bf16 a[40:43],a[144:147],a[208:211],a[40:43]
 ds_read_b64_tr_b16 a[140:141],v20 offset:8928
 v_mfma_f32_16x16x32_bf16 a[40:43],a[148:151],a[212:215],a[40:43]
 buffer_load_dwordx4 a[20:23],v4,s[8:11],s57 offen offset:1024 sc1
 v_mfma_f32_16x16x32_bf16 a[44:47],a[144:147],a[216:219],a[44:47]
 ds_read_b64_tr_b16 a[142:143],v20 offset:9184
 v_mfma_f32_16x16x32_bf16 a[44:47],a[148:151],a[220:223],a[44:47]
 v_mfma_f32_16x16x32_bf16 v[80:83],a[152:155],a[192:195],v[80:83]
 ds_read_b64_tr_b16 a[144:145],v20 offset:192
 v_mfma_f32_16x16x32_bf16 v[80:83],a[156:159],a[196:199],v[80:83]
 buffer_load_dwordx4 a[24:27],v4,s[8:11],s57 offen offset:2048 sc1
 v_mfma_f32_16x16x32_bf16 v[84:87],a[152:155],a[200:203],v[84:87]
 ds_read_b64_tr_b16 a[146:147],v20 offset:448
 v_mfma_f32_16x16x32_bf16 v[84:87],a[156:159],a[204:207],v[84:87]
 v_mfma_f32_16x16x32_bf16 v[88:91],a[152:155],a[208:211],v[88:91]
 ds_read_b64_tr_b16 a[148:149],v20 offset:8960
 v_mfma_f32_16x16x32_bf16 v[88:91],a[156:159],a[212:215],v[88:91]
 buffer_load_dwordx4 a[28:31],v4,s[8:11],s57 offen offset:3072 sc1
 v_mfma_f32_16x16x32_bf16 v[92:95],a[152:155],a[216:219],v[92:95]
 ds_read_b64_tr_b16 a[150:151],v20 offset:9216
 v_mfma_f32_16x16x32_bf16 v[92:95],a[156:159],a[220:223],v[92:95]
 s_waitcnt lgkmcnt(4)
 v_mfma_f32_16x16x32_bf16 a[64:67],a[128:131],a[192:195],a[64:67]
 ds_read_b64_tr_b16 a[152:153],v20 offset:224
 v_mfma_f32_16x16x32_bf16 a[64:67],a[132:135],a[196:199],a[64:67]
 v_mfma_f32_16x16x32_bf16 a[68:71],a[128:131],a[200:203],a[68:71]
 ds_read_b64_tr_b16 a[154:155],v20 offset:480
 v_mfma_f32_16x16x32_bf16 a[68:71],a[132:135],a[204:207],a[68:71]
 buffer_load_dwordx4 a[48:51],v5,s[8:11],s57 offen offset:0 sc1
 v_mfma_f32_16x16x32_bf16 a[72:75],a[128:131],a[208:211],a[72:75]
 ds_read_b64_tr_b16 a[156:157],v20 offset:8992
 v_mfma_f32_16x16x32_bf16 a[72:75],a[132:135],a[212:215],a[72:75]
 v_mfma_f32_16x16x32_bf16 a[76:79],a[128:131],a[216:219],a[76:79]
 ds_read_b64_tr_b16 a[158:159],v20 offset:9248
 v_add_u32 v20,s65,v21
 v_mfma_f32_16x16x32_bf16 a[76:79],a[132:135],a[220:223],a[76:79]
 s_waitcnt vmcnt(17)
 s_barrier
 v_mfma_f32_16x16x32_bf16 v[96:99],a[136:139],a[192:195],v[96:99]
 ds_read_b64_tr_b16 a[128:129],v20 offset:0
 v_mfma_f32_16x16x32_bf16 v[96:99],a[140:143],a[196:199],v[96:99]
 buffer_load_dwordx4 a[52:55],v5,s[8:11],s57 offen offset:1024 sc1
 v_mfma_f32_16x16x32_bf16 v[100:103],a[136:139],a[200:203],v[100:103]
 ds_read_b64_tr_b16 a[130:131],v20 offset:256
 v_mfma_f32_16x16x32_bf16 v[100:103],a[140:143],a[204:207],v[100:103]
 buffer_load_dwordx4 a[56:59],v5,s[8:11],s57 offen offset:2048 sc1
 v_mfma_f32_16x16x32_bf16 v[104:107],a[136:139],a[208:211],v[104:107]
 ds_read_b64_tr_b16 a[132:133],v20 offset:8768
 v_mfma_f32_16x16x32_bf16 v[104:107],a[140:143],a[212:215],v[104:107]
 v_mfma_f32_16x16x32_bf16 v[108:111],a[136:139],a[216:219],v[108:111]
 ds_read_b64_tr_b16 a[134:135],v20 offset:9024
 v_mfma_f32_16x16x32_bf16 v[108:111],a[140:143],a[220:223],v[108:111]
 s_waitcnt lgkmcnt(4)
 v_mfma_f32_16x16x32_bf16 a[96:99],a[144:147],a[192:195],a[96:99]
 ds_read_b64_tr_b16 a[136:137],v20 offset:32
 v_mfma_f32_16x16x32_bf16 a[96:99],a[148:151],a[196:199],a[96:99]
 buffer_load_dwordx4 a[60:63],v5,s[8:11],s57 offen offset:3072 sc1
 v_mfma_f32_16x16x32_bf16 a[100:103],a[144:147],a[200:203],a[100:103]
 ds_read_b64_tr_b16 a[138:139],v20 offset:288
 v_mfma_f32_16x16x32_bf16 a[100:103],a[148:151],a[204:207],a[100:103]
 v_mfma_f32_16x16x32_bf16 a[104:107],a[144:147],a[208:211],a[104:107]
 ds_read_b64_tr_b16 a[140:141],v20 offset:8800
 v_mfma_f32_16x16x32_bf16 a[104:107],a[148:151],a[212:215],a[104:107]
 v_mfma_f32_16x16x32_bf16 a[108:111],a[144:147],a[216:219],a[108:111]
 ds_read_b64_tr_b16 a[142:143],v20 offset:9056
 v_mfma_f32_16x16x32_bf16 a[108:111],a[148:151],a[220:223],a[108:111]
 v_mfma_f32_16x16x32_bf16 v[112:115],a[152:155],a[192:195],v[112:115]
 ds_read_b64_tr_b16 a[144:145],v20 offset:64
 v_mfma_f32_16x16x32_bf16 v[112:115],a[156:159],a[196:199],v[112:115]
 v_mfma_f32_16x16x32_bf16 v[116:119],a[152:155],a[200:203],v[116:119]
 ds_read_b64_tr_b16 a[146:147],v20 offset:320
 v_mfma_f32_16x16x32_bf16 v[116:119],a[156:159],a[204:207],v[116:119]
 v_mfma_f32_16x16x32_bf16 v[120:123],a[152:155],a[208:211],v[120:123]
 ds_read_b64_tr_b16 a[148:149],v20 offset:8832
 v_mfma_f32_16x16x32_bf16 v[120:123],a[156:159],a[212:215],v[120:123]
 v_mfma_f32_16x16x32_bf16 v[124:127],a[152:155],a[216:219],v[124:127]
 ds_read_b64_tr_b16 a[150:151],v20 offset:9088
 v_mfma_f32_16x16x32_bf16 v[124:127],a[156:159],a[220:223],v[124:127]
 s_waitcnt vmcnt(12)
 s_sub_u32 s67,s67,1
 s_cbranch_scc0 L_b1
L_w102:
 s_cbranch_execz L_wret1
L_c2:
 s_waitcnt lgkmcnt(4)
 v_mfma_f32_16x16x32_bf16 a[0:3],a[128:131],a[160:163],a[0:3]
 ds_read_b64_tr_b16 a[152:153],v20 offset:96
 s_lshl_b32 s58,s61,18
 s_add_u32 m0,s51,52608
 v_mfma_f32_16x16x32_bf16 a[0:3],a[132:135],a[164:167],a[0:3]
 buffer_load_dwordx4 v8,s[32:35],s58 offen offset:0 lds
 v_mfma_f32_16x16x32_bf16 a[4:7],a[128:131],a[168:171],a[4:7]
 ds_read_b64_tr_b16 a[154:155],v20 offset:352
 v_mfma_f32_16x16x32_bf16 a[4:7],a[132:135],a[172:175],a[4:7]
 buffer_load_dwordx4 v9,s[32:35],s58 offen offset:1088 lds
 v_mfma_f32_16x16x32_bf16 a[8:11],a[128:131],a[176:179],a[8:11]
 ds_read_b64_tr_b16 a[156:157],v20 offset:8864
 v_mfma_f32_16x16x32_bf16 a[8:11],a[132:135],a[180:183],a[8:11]
 buffer_load_dwordx4 v10,s[32:35],s58 offen offset:2176 lds
 v_mfma_f32_16x16x32_bf16 a[12:15],a[128:131],a[184:187],a[12:15]
 ds_read_b64_tr_b16 a[158:159],v20 offset:9120
 v_mfma_f32_16x16x32_bf16 a[12:15],a[132:135],a[188:191],a[12:15]
 buffer_load_dwordx4 v11,s[32:35],s58 offen offset:3264 lds
 v_mfma_f32_16x16x32_bf16 v[64:67],a[136:139],a[160:163],v[64:67]
 ds_read_b64_tr_b16 a[128:129],v20 offset:128
 s_add_u32 s58,s58,131072
 s_add_u32 m0,s51,140288
 v_mfma_f32_16x16x32_bf16 v[64:67],a[140:143],a[164:167],v[64:67]
 buffer_load_dwordx4 v8,s[32:35],s58 offen offset:0 lds
 v_mfma_f32_16x16x32_bf16 v[68:71],a[136:139],a[168:171],v[68:71]
 ds_read_b64_tr_b16 a[130:131],v20 offset:384
 v_mfma_f32_16x16x32_bf16 v[68:71],a[140:143],a[172:175],v[68:71]
 v_permlane16_swap_b32 v44,v46
 v_mfma_f32_16x16x32_bf16 v[72:75],a[136:139],a[176:179],v[72:75]
 ds_read_b64_tr_b16 a[132:133],v20 offset:8896
 v_mfma_f32_16x16x32_bf16 v[72:75],a[140:143],a[180:183],v[72:75]
 buffer_load_dword v35,v34,s[8:11],0 offen sc0 sc1
L_w20:
 s_cbranch_execz L_wret1
 v_mfma_f32_16x16x32_bf16 v[76:79],a[136:139],a[184:187],v[76:79]
 ds_read_b64_tr_b16 a[134:135],v20 offset:9152
 v_mfma_f32_16x16x32_bf16 v[76:79],a[140:143],a[188:191],v[76:79]
 s_waitcnt lgkmcnt(4)
 v_mfma_f32_16x16x32_bf16 a[32:35],a[144:147],a[160:163],a[32:35]
 ds_read_b64_tr_b16 a[136:137],v20 offset:160
 v_mfma_f32_16x16x32_bf16 a[32:35],a[148:151],a[164:167],a[32:35]
 buffer_load_dwordx4 v9,s[32:35],s58 offen offset:1088 lds
 v_mfma_f32_16x16x32_bf16 a[36:39],a[144:147],a[168:171],a[36:39]
 ds_read_b64_tr_b16 a[138:139],v20 offset:416
 v_mfma_f32_16x16x32_bf16 a[36:39],a[148:151],a[172:175],a[36:39]
 v_permlane16_swap_b32 v45,v47
 v_mfma_f32_16x16x32_bf16 a[40:43],a[144:147],a[176:179],a[40:43]
 ds_read_b64_tr_b16 a[140:141],v20 offset:8928
 v_mfma_f32_16x16x32_bf16 a[40:43],a[148:151],a[180:183],a[40:43]
 buffer_load_dwordx4 v10,s[32:35],s58 offen offset:2176 lds
 v_mfma_f32_16x16x32_bf16 a[44:47],a[144:147],a[184:187],a[44:47]
 ds_read_b64_tr_b16 a[142:143],v20 offset:9184
 v_mfma_f32_16x16x32_bf16 a[44:47],a[148:151],a[188:191],a[44:47]
 buffer_load_dwordx4 v11,s[32:35],s58 offen offset:3264 lds
 v_mfma_f32_16x16x32_bf16 v[80:83],a[152:155],a[160:163],v[80:83]
 ds_read_b64_tr_b16 a[144:145],v20 offset:192
 v_mfma_f32_16x16x32_bf16 v[80:83],a[156:159],a[164:167],v[80:83]
 v_permlane16_swap_b32 v48,v50
 v_mfma_f32_16x16x32_bf16 v[84:87],a[152:155],a[168:171],v[84:87]
 ds_read_b64_tr_b16 a[146:147],v20 offset:448
 v_mfma_f32_16x16x32_bf16 v[84:87],a[156:159],a[172:175],v[84:87]
 v_permlane16_swap_b32 v49,v51
 v_mfma_f32_16x16x32_bf16 v[88:91],a[152:155],a[176:179],v[88:91]
 ds_read_b64_tr_b16 a[148:149],v20 offset:8960
 s_xor_b32 s58,s61,1
 v_mfma_f32_16x16x32_bf16 v[88:91],a[156:159],a[180:183],v[88:91]
 s_and_b32 s58,s58,3
 s_cselect_b32 s58,262144,0
 v_mfma_f32_16x16x32_bf16 v[92:95],a[152:155],a[184:187],v[92:95]
 ds_read_b64_tr_b16 a[150:151],v20 offset:9216
 v_mfma_f32_16x16x32_bf16 v[92:95],a[156:159],a[188:191],v[92:95]
 s_add_u32 s58,s58,s74
 s_waitcnt lgkmcnt(4)
 v_mfma_f32_16x16x32_bf16 a[64:67],a[128:131],a[160:163],a[64:67]
 ds_read_b64_tr_b16 a[152:153],v20 offset:224
 s_add_u32 m0,s51,0
 v_mfma_f32_16x16x32_bf16 a[64:67],a[132:135],a[164:167],a[64:67]
 buffer_load_dwordx4 v8,s[32:35],s58 offen offset:0 lds
 v_mfma_f32_16x16x32_bf16 a[68:71],a[128:131],a[168:171],a[68:71]
 ds_read_b64_tr_b16 a[154:155],v20 offset:480
 v_mfma_f32_16x16x32_bf16 a[68:71],a[132:135],a[172:175],a[68:71]
 v_permlane16_swap_b32 v52,v54
 v_mfma_f32_16x16x32_bf16 a[72:75],a[128:131],a[176:179],a[72:75]
 ds_read_b64_tr_b16 a[156:157],v20 offset:8992
 v_mfma_f32_16x16x32_bf16 a[72:75],a[132:135],a[180:183],a[72:75]
 buffer_load_dwordx4 v9,s[32:35],s58 offen offset:1088 lds
 v_mfma_f32_16x16x32_bf16 a[76:79],a[128:131],a[184:187],a[76:79]
 ds_read_b64_tr_b16 a[158:159],v20 offset:9248
 v_add_u32 v20,s64,v21
 v_mfma_f32_16x16x32_bf16 a[76:79],a[132:135],a[188:191],a[76:79]
 s_waitcnt vmcnt(19)
 s_barrier
 v_mfma_f32_16x16x32_bf16 v[96:99],a[136:139],a[160:163],v[96:99]
 ds_read_b64_tr_b16 a[128:129],v20 offset:0
 v_mfma_f32_16x16x32_bf16 v[96:99],a[140:143],a[164:167],v[96:99]
 v_permlane16_swap_b32 v53,v55
 v_mfma_f32_16x16x32_bf16 v[100:103],a[136:139],a[168:171],v[100:103]
 ds_read_b64_tr_b16 a[130:131],v20 offset:256
 v_mfma_f32_16x16x32_bf16 v[100:103],a[140:143],a[172:175],v[100:103]
 buffer_load_dwordx4 v10,s[32:35],s58 offen offset:2176 lds
 v_mfma_f32_16x16x32_bf16 v[104:107],a[136:139],a[176:179],v[104:107]
 ds_read_b64_tr_b16 a[132:133],v20 offset:8768
 v_mfma_f32_16x16x32_bf16 v[104:107],a[140:143],a[180:183],v[104:107]
 v_permlane16_swap_b32 v56,v58
 v_mfma_f32_16x16x32_bf16 v[108:111],a[136:139],a[184:187],v[108:111]
 ds_read_b64_tr_b16 a[134:135],v20 offset:9024
 v_mfma_f32_16x16x32_bf16 v[108:111],a[140:143],a[188:191],v[108:111]
 s_waitcnt lgkmcnt(4)
 v_mfma_f32_16x16x32_bf16 a[96:99],a[144:147],a[160:163],a[96:99]
 ds_read_b64_tr_b16 a[136:137],v20 offset:32
 v_mfma_f32_16x16x32_bf16 a[96:99],a[148:151],a[164:167],a[96:99]
 buffer_load_dwordx4 v11,s[32:35],s58 offen offset:3264 lds
 v_mfma_f32_16x16x32_bf16 a[100:103],a[144:147],a[168:171],a[100:103]
 ds_read_b64_tr_b16 a[138:139],v20 offset:288
 s_add_u32 s58,s58,131072
 s_add_u32 m0,s51,35072
 v_mfma_f32_16x16x32_bf16 a[100:103],a[148:151],a[172:175],a[100:103]
 buffer_load_dwordx4 v8,s[32:35],s58 offen offset:0 lds
 v_mfma_f32_16x16x32_bf16 a[104:107],a[144:147],a[176:179],a[104:107]
 ds_read_b64_tr_b16 a[140:141],v20 offset:8800
 v_mfma_f32_16x16x32_bf16 a[104:107],a[148:151],a[180:183],a[104:107]
 v_permlane16_swap_b32 v57,v59
 v_mfma_f32_16x16x32_bf16 a[108:111],a[144:147],a[184:187],a[108:111]
 ds_read_b64_tr_b16 a[142:143],v20 offset:9056
 v_mfma_f32_16x16x32_bf16 a[108:111],a[148:151],a[188:191],a[108:111]
 v_mfma_f32_16x16x32_bf16 v[112:115],a[152:155],a[160:163],v[112:115]
 ds_read_b64_tr_b16 a[144:145],v20 offset:64
 v_mfma_f32_16x16x32_bf16 v[112:115],a[156:159],a[164:167],v[112:115]
 buffer_load_dwordx4 v9,s[32:35],s58 offen offset:1088 lds
 v_mfma_f32_16x16x32_bf16 v[116:119],a[152:155],a[168:171],v[116:119]
 ds_read_b64_tr_b16 a[146:147],v20 offset:320
 v_mfma_f32_16x16x32_bf16 v[116:119],a[156:159],a[172:175],v[116:119]
 v_mfma_f32_16x16x32_bf16 v[120:123],a[152:155],a[176:179],v[120:123]
 ds_read_b64_tr_b16 a[148:149],v20 offset:8832
 v_mfma_f32_16x16x32_bf16 v[120:123],a[156:159],a[180:183],v[120:123]
 v_mfma_f32_16x16x32_bf16 v[124:127],a[152:155],a[184:187],v[124:127]
 ds_read_b64_tr_b16 a[150:151],v20 offset:9088
 v_mfma_f32_16x16x32_bf16 v[124:127],a[156:159],a[188:191],v[124:127]
 s_waitcnt vmcnt(15)
 s_waitcnt lgkmcnt(4)
 v_mfma_f32_16x16x32_bf16 a[0:3],a[128:131],a[16:19],a[0:3]
 ds_read_b64_tr_b16 a[152:153],v20 offset:96
 v_mfma_f32_16x16x32_bf16 a[0:3],a[132:135],a[20:23],a[0:3]
 v_mfma_f32_16x16x32_bf16 a[4:7],a[128:131],a[24:27],a[4:7]
 ds_read_b64_tr_b16 a[154:155],v20 offset:352
 v_mfma_f32_16x16x32_bf16 a[4:7],a[132:135],a[28:31],a[4:7]
 v_mfma_f32_16x16x32_bf16 a[8:11],a[128:131],a[48:51],a[8:11]
 ds_read_b64_tr_b16 a[156:157],v20 offset:8864
 v_mfma_f32_16x16x32_bf16 a[8:11],a[132:135],a[52:55],a[8:11]
 v_mfma_f32_16x16x32_bf16 a[12:15],a[128:131],a[56:59],a[12:15]
 ds_read_b64_tr_b16 a[158:159],v20 offset:9120
 v_mfma_f32_16x16x32_bf16 a[12:15],a[132:135],a[60:63],a[12:15]
 v_mfma_f32_16x16x32_bf16 v[64:67],a[136:139],a[16:19],v[64:67]
 ds_read_b64_tr_b16 a[128:129],v20 offset:128
 v_mfma_f32_16x16x32_bf16 v[64:67],a[140:143],a[20:23],v[64:67]
 v_mfma_f32_16x16x32_bf16 v[68:71],a[136:139],a[24:27],v[68:71]
 ds_read_b64_tr_b16 a[130:131],v20 offset:384
 v_mfma_f32_16x16x32_bf16 v[68:71],a[140:143],a[28:31],v[68:71]
 v_mfma_f32_16x16x32_bf16 v[72:75],a[136:139],a[48:51],v[72:75]
 ds_read_b64_tr_b16 a[132:133],v20 offset:8896
 v_mfma_f32_16x16x32_bf16 v[72:75],a[140:143],a[52:55],v[72:75]
 v_mfma_f32_16x16x32_bf16 v[76:79],a[136:139],a[56:59],v[76:79]
 ds_read_b64_tr_b16 a[134:135],v20 offset:9152
 v_mfma_f32_16x16x32_bf16 v[76:79],a[140:143],a[60:63],v[76:79]
 s_waitcnt lgkmcnt(4)
 v_mfma_f32_16x16x32_bf16 a[32:35],a[144:147],a[16:19],a[32:35]
 ds_read_b64_tr_b16 a[136:137],v20 offset:160
 v_mfma_f32_16x16x32_bf16 a[32:35],a[148:151],a[20:23],a[32:35]
 v_mfma_f32_16x16x32_bf16 a[36:39],a[144:147],a[24:27],a[36:39]
 ds_read_b64_tr_b16 a[138:139],v20 offset:416
 s_waitcnt vmcnt(9)
 v_cmp_eq_u32 vcc,0,v35
 s_nop 0
 s_cbranch_vccnz L_opoll
L_opoll_ret:
 v_mfma_f32_16x16x32_bf16 a[36:39],a[148:151],a[28:31],a[36:39]
 v_mfma_f32_16x16x32_bf16 a[40:43],a[144:147],a[48:51],a[40:43]
 ds_read_b64_tr_b16 a[140:141],v20 offset:8928
 s_xor_b32 s57,s72,16384
 v_mfma_f32_16x16x32_bf16 a[40:43],a[148:151],a[52:55],a[40:43]
 s_cmp_eq_u32 s57,s69
 s_cselect_b32 s57,s72,s57
 v_mfma_f32_16x16x32_bf16 a[44:47],a[144:147],a[56:59],a[44:47]
 ds_read_b64_tr_b16 a[142:143],v20 offset:9184
 v_mfma_f32_16x16x32_bf16 a[44:47],a[148:151],a[60:63],a[44:47]
 buffer_load_dwordx4 a[80:83],v4,s[8:11],s57 offen offset:0 sc1
 v_mfma_f32_16x16x32_bf16 v[80:83],a[152:155],a[16:19],v[80:83]
 ds_read_b64_tr_b16 a[144:145],v20 offset:192
 v_xor_b32 v34,16,v34
 v_mfma_f32_16x16x32_bf16 v[80:83],a[156:159],a[20:23],v[80:83]
 v_mfma_f32_16x16x32_bf16 v[84:87],a[152:155],a[24:27],v[84:87]
 ds_read_b64_tr_b16 a[146:147],v20 offset:448
 v_mfma_f32_16x16x32_bf16 v[84:87],a[156:159],a[28:31],v[84:87]
 buffer_load_dwordx4 a[84:87],v4,s[8:11],s57 offen offset:1024 sc1
 v_mfma_f32_16x16x32_bf16 v[88:91],a[152:155],a[48:51],v[88:91]
 ds_read_b64_tr_b16 a[148:149],v20 offset:8960
 v_mfma_f32_16x16x32_bf16 v[88:91],a[156:159],a[52:55],v[88:91]
 v_mfma_f32_16x16x32_bf16 v[92:95],a[152:155],a[56:59],v[92:95]
 ds_read_b64_tr_b16 a[150:151],v20 offset:9216
 v_mfma_f32_16x16x32_bf16 v[92:95],a[156:159],a[60:63],v[92:95]
 s_waitcnt lgkmcnt(4)
 v_mfma_f32_16x16x32_bf16 a[64:67],a[128:131],a[16:19],a[64:67]
 ds_read_b64_tr_b16 a[152:153],v20 offset:224
 v_mfma_f32_16x16x32_bf16 a[64:67],a[132:135],a[20:23],a[64:67]
 buffer_load_dwordx4 a[88:91],v4,s[8:11],s57 offen offset:2048 sc1
 v_mfma_f32_16x16x32_bf16 a[68:71],a[128:131],a[24:27],a[68:71]
 ds_read_b64_tr_b16 a[154:155],v20 offset:480
 s_add_u32 s63,s75,4096
 v_mfma_f32_16x16x32_bf16 a[68:71],a[132:135],a[28:31],a[68:71]
 v_accvgpr_read_b32 v12,a32
 v_accvgpr_read_b32 v13,a33
 v_mfma_f32_16x16x32_bf16 a[72:75],a[128:131],a[48:51],a[72:75]
 ds_read_b64_tr_b16 a[156:157],v20 offset:8992
 v_accvgpr_read_b32 v14,a34
 v_mfma_f32_16x16x32_bf16 a[72:75],a[132:135],a[52:55],a[72:75]
 buffer_load_dwordx4 a[92:95],v4,s[8:11],s57 offen offset:3072 sc1
 v_mfma_f32_16x16x32_bf16 a[76:79],a[128:131],a[56:59],a[76:79]
 ds_read_b64_tr_b16 a[158:159],v20 offset:9248
 v_accvgpr_read_b32 v15,a35
 v_mfma_f32_16x16x32_bf16 a[76:79],a[132:135],a[60:63],a[76:79]
 s_barrier
 v_mfma_f32_16x16x32_bf16 v[96:99],a[136:139],a[16:19],v[96:99]
 ds_read_b64_tr_b16 a[128:129],v22 offset:32
 v_cvt_pk_bf16_f32 v12,v12,v13
 v_mfma_f32_16x16x32_bf16 v[96:99],a[140:143],a[20:23],v[96:99]
 buffer_load_dwordx4 a[112:115],v5,s[8:11],s57 offen offset:0 sc1
 v_mfma_f32_16x16x32_bf16 v[100:103],a[136:139],a[24:27],v[100:103]
 ds_read_b64_tr_b16 a[130:131],v22 offset:288
 v_cvt_pk_bf16_f32 v13,v14,v15
 v_mfma_f32_16x16x32_bf16 v[100:103],a[140:143],a[28:31],v[100:103]
 v_cvt_pk_bf16_f32 v14,v80,v81
 v_cvt_pk_bf16_f32 v15,v82,v83
 v_mfma_f32_16x16x32_bf16 v[104:107],a[136:139],a[48:51],v[104:107]
 ds_read_b64_tr_b16 a[132:133],v22 offset:8800
 v_accvgpr_read_b32 v16,a36
 v_mfma_f32_16x16x32_bf16 v[104:107],a[140:143],a[52:55],v[104:107]
 buffer_store_dwordx4 v[12:15],v4,s[8:11],s63 offen offset:0 sc0 sc1
 v_mfma_f32_16x16x32_bf16 v[108:111],a[136:139],a[56:59],v[108:111]
 ds_read_b64_tr_b16 a[134:135],v22 offset:9056
 v_accvgpr_read_b32 v17,a37
 v_mfma_f32_16x16x32_bf16 v[108:111],a[140:143],a[60:63],v[108:111]
 v_accvgpr_read_b32 v18,a38
 s_waitcnt lgkmcnt(4)
 v_mfma_f32_16x16x32_bf16 a[96:99],a[144:147],a[16:19],a[96:99]
 ds_read_b64_tr_b16 a[136:137],v22 offset:96
 v_accvgpr_read_b32 v19,a39
 v_mfma_f32_16x16x32_bf16 a[96:99],a[148:151],a[20:23],a[96:99]
 buffer_load_dwordx4 a[116:119],v5,s[8:11],s57 offen offset:1024 sc1
 v_mfma_f32_16x16x32_bf16 a[100:103],a[144:147],a[24:27],a[100:103]
 ds_read_b64_tr_b16 a[138:139],v22 offset:352
 v_cvt_pk_bf16_f32 v16,v16,v17
 v_mfma_f32_16x16x32_bf16 a[100:103],a[148:151],a[28:31],a[100:103]
 v_cvt_pk_bf16_f32 v17,v18,v19
 v_cvt_pk_bf16_f32 v18,v84,v85
 v_mfma_f32_16x16x32_bf16 a[104:107],a[144:147],a[48:51],a[104:107]
 ds_read_b64_tr_b16 a[140:141],v22 offset:8864
 v_cvt_pk_bf16_f32 v19,v86,v87
 v_mfma_f32_16x16x32_bf16 a[104:107],a[148:151],a[52:55],a[104:107]
 buffer_store_dwordx4 v[16:19],v4,s[8:11],s63 offen offset:1024 sc0 sc1
 v_mfma_f32_16x16x32_bf16 a[108:111],a[144:147],a[56:59],a[108:111]
 ds_read_b64_tr_b16 a[142:143],v22 offset:9120
 v_accvgpr_read_b32 v24,a40
 v_mfma_f32_16x16x32_bf16 a[108:111],a[148:151],a[60:63],a[108:111]
 v_accvgpr_read_b32 v25,a41
 v_accvgpr_read_b32 v26,a42
 v_mfma_f32_16x16x32_bf16 v[112:115],a[152:155],a[16:19],v[112:115]
 ds_read_b64_tr_b16 a[144:145],v22 offset:160
 v_accvgpr_read_b32 v27,a43
 v_mfma_f32_16x16x32_bf16 v[112:115],a[156:159],a[20:23],v[112:115]
 v_cvt_pk_bf16_f32 v24,v24,v25
 v_cvt_pk_bf16_f32 v25,v26,v27
 v_mfma_f32_16x16x32_bf16 v[116:119],a[152:155],a[24:27],v[116:119]
 ds_read_b64_tr_b16 a[146:147],v22 offset:416
 v_cvt_pk_bf16_f32 v26,v88,v89
 v_mfma_f32_16x16x32_bf16 v[116:119],a[156:159],a[28:31],v[116:119]
 v_cvt_pk_bf16_f32 v27,v90,v91
 v_accvgpr_read_b32 v40,a44
 v_mfma_f32_16x16x32_bf16 v[120:123],a[152:155],a[48:51],v[120:123]
 ds_read_b64_tr_b16 a[148:149],v22 offset:8928
 v_accvgpr_read_b32 v41,a45
 v_mfma_f32_16x16x32_bf16 v[120:123],a[156:159],a[52:55],v[120:123]
 buffer_load_dwordx4 a[120:123],v5,s[8:11],s57 offen offset:2048 sc1
 v_mfma_f32_16x16x32_bf16 v[124:127],a[152:155],a[56:59],v[124:127]
 ds_read_b64_tr_b16 a[150:151],v22 offset:9184
 v_accvgpr_read_b32 v42,a46
 v_mfma_f32_16x16x32_bf16 v[124:127],a[156:159],a[60:63],v[124:127]
 v_accvgpr_read_b32 v43,a47
 s_waitcnt lgkmcnt(4)
 v_mfma_f32_16x16x32_bf16 v[144:147],a[128:131],v[128:131],0
 ds_read_b64_tr_b16 a[152:153],v22 offset:224
 v_cvt_pk_bf16_f32 v40,v40,v41
 v_mfma_f32_16x16x32_bf16 v[144:147],a[132:135],v[160:163],v[144:147]
 buffer_store_dwordx4 v[24:27],v4,s[8:11],s63 offen offset:2048 sc0 sc1
 v_mfma_f32_16x16x32_bf16 v[148:151],a[128:131],v[132:135],0
 ds_read_b64_tr_b16 a[154:155],v22 offset:480
 v_cvt_pk_bf16_f32 v41,v42,v43
 v_mfma_f32_16x16x32_bf16 v[148:151],a[132:135],v[164:167],v[148:151]
 v_cvt_pk_bf16_f32 v42,v92,v93
 v_cvt_pk_bf16_f32 v43,v94,v95
 v_mfma_f32_16x16x32_bf16 v[152:155],a[128:131],v[136:139],0
 ds_read_b64_tr_b16 a[156:157],v22 offset:8992
 v_mfma_f32_16x16x32_bf16 v[152:155],a[132:135],v[168:171],v[152:155]
 buffer_store_dwordx4 v[40:43],v4,s[8:11],s63 offen offset:3072 sc0 sc1
 v_mfma_f32_16x16x32_bf16 v[156:159],a[128:131],v[140:143],0
 ds_read_b64_tr_b16 a[158:159],v22 offset:9248
 v_mfma_f32_16x16x32_bf16 v[156:159],a[132:135],v[172:175],v[156:159]
 buffer_load_dwordx4 a[124:127],v5,s[8:11],s57 offen offset:3072 sc1
 v_mfma_f32_16x16x32_bf16 v[176:179],a[136:139],v[128:131],0
 ds_read_b64_tr_b16 a[128:129],v22 offset:0
 s_add_u32 s63,s75,8192
 v_mfma_f32_16x16x32_bf16 v[176:179],a[140:143],v[160:163],v[176:179]
 v_accvgpr_read_b32 v12,a64
 v_accvgpr_read_b32 v13,a65
 v_mfma_f32_16x16x32_bf16 v[180:183],a[136:139],v[132:135],0
 ds_read_b64_tr_b16 a[130:131],v22 offset:256
 v_accvgpr_read_b32 v14,a66
 v_mfma_f32_16x16x32_bf16 v[180:183],a[140:143],v[164:167],v[180:183]
 v_accvgpr_read_b32 v15,a67
 v_cvt_pk_bf16_f32 v12,v12,v13
 v_mfma_f32_16x16x32_bf16 v[184:187],a[136:139],v[136:139],0
 ds_read_b64_tr_b16 a[132:133],v22 offset:8768
 v_cvt_pk_bf16_f32 v13,v14,v15
 v_mfma_f32_16x16x32_bf16 v[184:187],a[140:143],v[168:171],v[184:187]
 v_cvt_pk_bf16_f32 v14,v96,v97
 v_cvt_pk_bf16_f32 v15,v98,v99
 v_mfma_f32_16x16x32_bf16 v[188:191],a[136:139],v[140:143],0
 ds_read_b64_tr_b16 a[134:135],v22 offset:9024
 v_accvgpr_read_b32 v16,a68
 v_mfma_f32_16x16x32_bf16 v[188:191],a[140:143],v[172:175],v[188:191]
 s_waitcnt vmcnt(18)
 s_barrier
 s_waitcnt lgkmcnt(4)
 v_mfma_f32_16x16x32_bf16 v[208:211],a[144:147],v[128:131],0
 ds_read_b64_tr_b16 a[136:137],v23 offset:35072
 v_accvgpr_read_b32 v17,a69
 v_mfma_f32_16x16x32_bf16 v[208:211],a[148:151],v[160:163],v[208:211]
 buffer_load_dwordx4 v10,s[32:35],s58 offen offset:2176 lds
 v_mfma_f32_16x16x32_bf16 v[212:215],a[144:147],v[132:135],0
 ds_read_b64_tr_b16 a[138:139],v23 offset:35328
 v_accvgpr_read_b32 v18,a70
 v_mfma_f32_16x16x32_bf16 v[212:215],a[148:151],v[164:167],v[212:215]
 buffer_store_dwordx4 v[12:15],v4,s[8:11],s63 offen offset:0 sc0 sc1
 v_mfma_f32_16x16x32_bf16 v[216:219],a[144:147],v[136:139],0
 ds_read_b64_tr_b16 a[140:141],v23 offset:43840
 v_accvgpr_read_b32 v19,a71
 v_mfma_f32_16x16x32_bf16 v[216:219],a[148:151],v[168:171],v[216:219]
 buffer_load_dwordx4 v11,s[32:35],s58 offen offset:3264 lds
 v_mfma_f32_16x16x32_bf16 v[220:223],a[144:147],v[140:143],0
 ds_read_b64_tr_b16 a[142:143],v23 offset:44096
 v_cvt_pk_bf16_f32 v16,v16,v17
 v_mfma_f32_16x16x32_bf16 v[220:223],a[148:151],v[172:175],v[220:223]
 v_cvt_pk_bf16_f32 v17,v18,v19
 v_cvt_pk_bf16_f32 v18,v100,v101
 v_mfma_f32_16x16x32_bf16 v[240:243],a[152:155],v[128:131],0
 ds_read_b64_tr_b16 a[144:145],v23 offset:35104
 v_cvt_pk_bf16_f32 v19,v102,v103
 v_mfma_f32_16x16x32_bf16 v[240:243],a[156:159],v[160:163],v[240:243]
 global_load_dword v31,v2,s[6:7]
 v_accvgpr_read_b32 v24,a72
 v_mfma_f32_16x16x32_bf16 v[244:247],a[152:155],v[132:135],0
 ds_read_b64_tr_b16 a[146:147],v23 offset:35360
 v_accvgpr_read_b32 v25,a73
 v_mfma_f32_16x16x32_bf16 v[244:247],a[156:159],v[164:167],v[244:247]
 buffer_store_dwordx4 v[16:19],v4,s[8:11],s63 offen offset:1024 sc0 sc1
 v_mfma_f32_16x16x32_bf16 v[248:251],a[152:155],v[136:139],0
 ds_read_b64_tr_b16 a[148:149],v23 offset:43872
 v_accvgpr_read_b32 v26,a74
 v_mfma_f32_16x16x32_bf16 v[248:251],a[156:159],v[168:171],v[248:251]
 v_accvgpr_read_b32 v27,a75
 v_cvt_pk_bf16_f32 v24,v24,v25
 v_mfma_f32_16x16x32_bf16 v[252:255],a[152:155],v[140:143],0
 ds_read_b64_tr_b16 a[150:151],v23 offset:44128
 v_cvt_pk_bf16_f32 v25,v26,v27
 v_mfma_f32_16x16x32_bf16 v[252:255],a[156:159],v[172:175],v[252:255]
 v_cvt_pk_bf16_f32 v26,v104,v105
 s_waitcnt lgkmcnt(4)
 v_mfma_f32_16x16x32_bf16 a[224:227],a[128:131],v[128:131],0
 ds_read_b64_tr_b16 a[152:153],v23 offset:35168
 v_cvt_pk_bf16_f32 v27,v106,v107
 v_mfma_f32_16x16x32_bf16 a[224:227],a[132:135],v[160:163],a[224:227]
 buffer_store_dwordx4 v[24:27],v4,s[8:11],s63 offen offset:2048 sc0 sc1
 v_mfma_f32_16x16x32_bf16 a[228:231],a[128:131],v[132:135],0
 ds_read_b64_tr_b16 a[154:155],v23 offset:35424
 v_accvgpr_read_b32 v40,a76
 v_mfma_f32_16x16x32_bf16 a[228:231],a[132:135],v[164:167],a[228:231]
 v_accvgpr_read_b32 v41,a77
 v_accvgpr_read_b32 v42,a78
 v_mfma_f32_16x16x32_bf16 a[232:235],a[128:131],v[136:139],0
 ds_read_b64_tr_b16 a[156:157],v23 offset:43936
 v_accvgpr_read_b32 v43,a79
 v_mfma_f32_16x16x32_bf16 a[232:235],a[132:135],v[168:171],a[232:235]
 v_cvt_pk_bf16_f32 v40,v40,v41
 v_cvt_pk_bf16_f32 v41,v42,v43
 v_mfma_f32_16x16x32_bf16 a[236:239],a[128:131],v[140:143],0
 ds_read_b64_tr_b16 a[158:159],v23 offset:44192
 v_cvt_pk_bf16_f32 v42,v108,v109
 v_mfma_f32_16x16x32_bf16 a[236:239],a[132:135],v[172:175],a[236:239]
 v_cvt_pk_bf16_f32 v43,v110,v111
 v_mfma_f32_16x16x32_bf16 a[224:227],a[136:139],v[192:195],a[224:227]
 ds_read_b64_tr_b16 a[128:129],v23 offset:35232
 v_mfma_f32_16x16x32_bf16 a[224:227],a[140:143],v[224:227],a[224:227]
 buffer_store_dwordx4 v[40:43],v4,s[8:11],s63 offen offset:3072 sc0 sc1
 v_mfma_f32_16x16x32_bf16 a[228:231],a[136:139],v[196:199],a[228:231]
 ds_read_b64_tr_b16 a[130:131],v23 offset:35488
 v_mfma_f32_16x16x32_bf16 a[228:231],a[140:143],v[228:231],a[228:231]
 s_add_u32 s63,s75,12288
 v_accvgpr_read_b32 v12,a96
 v_mfma_f32_16x16x32_bf16 a[232:235],a[136:139],v[200:203],a[232:235]
 ds_read_b64_tr_b16 a[132:133],v23 offset:44000
 s_mov_b64 exec,0
 s_cmp_eq_u32 s48,0
 s_cbranch_scc1 L_w22
 s_cmp_eq_u32 s48,1
 s_cbranch_scc1 L_w23
 s_cmp_eq_u32 s48,2
 s_cbranch_scc1 L_w24
 s_branch L_w25
L_wret2:
 s_mov_b64 exec,-1
 v_mfma_f32_16x16x32_bf16 a[232:235],a[140:143],v[232:235],a[232:235]
 v_accvgpr_read_b32 v13,a97
 v_accvgpr_read_b32 v14,a98
 v_mfma_f32_16x16x32_bf16 a[236:239],a[136:139],v[204:207],a[236:239]
 ds_read_b64_tr_b16 a[134:135],v23 offset:44256
 v_accvgpr_read_b32 v15,a99
 v_mfma_f32_16x16x32_bf16 a[236:239],a[140:143],v[236:239],a[236:239]
 v_cvt_pk_bf16_f32 v12,v12,v13
 s_waitcnt lgkmcnt(4)
 v_mfma_f32_16x16x32_bf16 v[144:147],a[144:147],v[192:195],v[144:147]
 ds_read_b64_tr_b16 a[136:137],v23 offset:35296
 v_cvt_pk_bf16_f32 v13,v14,v15
 v_mfma_f32_16x16x32_bf16 v[144:147],a[148:151],v[224:227],v[144:147]
 v_cvt_pk_bf16_f32 v14,v112,v113
 v_cvt_pk_bf16_f32 v15,v114,v115
 v_mfma_f32_16x16x32_bf16 v[148:151],a[144:147],v[196:199],v[148:151]
 ds_read_b64_tr_b16 a[138:139],v23 offset:35552
 v_accvgpr_read_b32 v16,a100
 v_mfma_f32_16x16x32_bf16 v[148:151],a[148:151],v[228:231],v[148:151]
 buffer_store_dwordx4 v[12:15],v4,s[8:11],s63 offen offset:0 sc0 sc1
 v_mfma_f32_16x16x32_bf16 v[152:155],a[144:147],v[200:203],v[152:155]
 ds_read_b64_tr_b16 a[140:141],v23 offset:44064
 v_accvgpr_read_b32 v17,a101
 v_mfma_f32_16x16x32_bf16 v[152:155],a[148:151],v[232:235],v[152:155]
 v_accvgpr_read_b32 v18,a102
 v_accvgpr_read_b32 v19,a103
 v_mfma_f32_16x16x32_bf16 v[156:159],a[144:147],v[204:207],v[156:159]
 ds_read_b64_tr_b16 a[142:143],v23 offset:44320
 s_add_u32 s57,s57,8192
 v_mfma_f32_16x16x32_bf16 v[156:159],a[148:151],v[236:239],v[156:159]
 buffer_load_dwordx4 a[192:195],v4,s[8:11],s57 offen offset:0 sc1
 v_mfma_f32_16x16x32_bf16 v[176:179],a[152:155],v[192:195],v[176:179]
 ds_read_b64_tr_b16 a[144:145],v22 offset:64
 v_cvt_pk_bf16_f32 v16,v16,v17
 v_mfma_f32_16x16x32_bf16 v[176:179],a[156:159],v[224:227],v[176:179]
 v_cvt_pk_bf16_f32 v17,v18,v19
 v_cvt_pk_bf16_f32 v18,v116,v117
 v_mfma_f32_16x16x32_bf16 v[180:183],a[152:155],v[196:199],v[180:183]
 ds_read_b64_tr_b16 a[146:147],v22 offset:320
 v_cvt_pk_bf16_f32 v19,v118,v119
 v_mfma_f32_16x16x32_bf16 v[180:183],a[156:159],v[228:231],v[180:183]
 buffer_store_dwordx4 v[16:19],v4,s[8:11],s63 offen offset:1024 sc0 sc1
 v_mfma_f32_16x16x32_bf16 v[184:187],a[152:155],v[200:203],v[184:187]
 ds_read_b64_tr_b16 a[148:149],v22 offset:8832
 v_accvgpr_read_b32 v24,a104
 v_mfma_f32_16x16x32_bf16 v[184:187],a[156:159],v[232:235],v[184:187]
 v_accvgpr_read_b32 v25,a105
 v_accvgpr_read_b32 v26,a106
 v_mfma_f32_16x16x32_bf16 v[188:191],a[152:155],v[204:207],v[188:191]
 ds_read_b64_tr_b16 a[150:151],v22 offset:9088
 v_accvgpr_read_b32 v27,a107
 v_mfma_f32_16x16x32_bf16 v[188:191],a[156:159],v[236:239],v[188:191]
 v_cvt_pk_bf16_f32 v24,v24,v25
 s_waitcnt lgkmcnt(4)
 v_mfma_f32_16x16x32_bf16 v[208:211],a[128:131],v[192:195],v[208:211]
 ds_read_b64_tr_b16 a[152:153],v23 offset:35136
 v_cvt_pk_bf16_f32 v25,v26,v27
 v_mfma_f32_16x16x32_bf16 v[208:211],a[132:135],v[224:227],v[208:211]
 buffer_load_dwordx4 a[196:199],v4,s[8:11],s57 offen offset:1024 sc1
 v_mfma_f32_16x16x32_bf16 v[212:215],a[128:131],v[196:199],v[212:215]
 ds_read_b64_tr_b16 a[154:155],v23 offset:35392
 v_cvt_pk_bf16_f32 v26,v120,v121
 v_mfma_f32_16x16x32_bf16 v[212:215],a[132:135],v[228:231],v[212:215]
 v_cvt_pk_bf16_f32 v27,v122,v123
 v_accvgpr_read_b32 v40,a108
 v_mfma_f32_16x16x32_bf16 v[216:219],a[128:131],v[200:203],v[216:219]
 ds_read_b64_tr_b16 a[156:157],v23 offset:43904
 v_accvgpr_read_b32 v41,a109
 v_mfma_f32_16x16x32_bf16 v[216:219],a[132:135],v[232:235],v[216:219]
 buffer_store_dwordx4 v[24:27],v4,s[8:11],s63 offen offset:2048 sc0 sc1
 v_mfma_f32_16x16x32_bf16 v[220:223],a[128:131],v[204:207],v[220:223]
 ds_read_b64_tr_b16 a[158:159],v23 offset:44160
 v_accvgpr_read_b32 v42,a110
 v_mfma_f32_16x16x32_bf16 v[220:223],a[132:135],v[236:239],v[220:223]
 v_accvgpr_read_b32 v43,a111
 v_cvt_pk_bf16_f32 v40,v40,v41
 v_mfma_f32_16x16x32_bf16 v[240:243],a[136:139],v[192:195],v[240:243]
 ds_read_b64_tr_b16 a[128:129],v22 offset:128
 v_cvt_pk_bf16_f32 v41,v42,v43
 v_mfma_f32_16x16x32_bf16 v[240:243],a[140:143],v[224:227],v[240:243]
 v_cvt_pk_bf16_f32 v42,v124,v125
 v_cvt_pk_bf16_f32 v43,v126,v127
 v_mfma_f32_16x16x32_bf16 v[244:247],a[136:139],v[196:199],v[244:247]
 ds_read_b64_tr_b16 a[130:131],v22 offset:384
 v_mfma_f32_16x16x32_bf16 v[244:247],a[140:143],v[228:231],v[244:247]
 buffer_store_dwordx4 v[40:43],v4,s[8:11],s63 offen offset:3072 sc0 sc1
 v_mfma_f32_16x16x32_bf16 v[248:251],a[136:139],v[200:203],v[248:251]
 ds_read_b64_tr_b16 a[132:133],v22 offset:8896
 v_mfma_f32_16x16x32_bf16 v[248:251],a[140:143],v[232:235],v[248:251]
 v_mfma_f32_16x16x32_bf16 v[252:255],a[136:139],v[204:207],v[252:255]
 ds_read_b64_tr_b16 a[134:135],v22 offset:9152
 v_mfma_f32_16x16x32_bf16 v[252:255],a[140:143],v[236:239],v[252:255]
 s_waitcnt lgkmcnt(4)
 v_mfma_f32_16x16x32_bf16 v[80:83],a[144:147],v[128:131],0
 ds_read_b64_tr_b16 a[136:137],v23 offset:35200
 v_mfma_f32_16x16x32_bf16 v[80:83],a[148:151],v[160:163],v[80:83]
 v_mfma_f32_16x16x32_bf16 v[84:87],a[144:147],v[132:135],0
 ds_read_b64_tr_b16 a[138:139],v23 offset:35456
 v_mfma_f32_16x16x32_bf16 v[84:87],a[148:151],v[164:167],v[84:87]
 v_mfma_f32_16x16x32_bf16 v[88:91],a[144:147],v[136:139],0
 ds_read_b64_tr_b16 a[140:141],v23 offset:43968
 v_mfma_f32_16x16x32_bf16 v[88:91],a[148:151],v[168:171],v[88:91]
 v_mfma_f32_16x16x32_bf16 v[92:95],a[144:147],v[140:143],0
 ds_read_b64_tr_b16 a[142:143],v23 offset:44224
 v_mfma_f32_16x16x32_bf16 v[92:95],a[148:151],v[172:175],v[92:95]
 v_mfma_f32_16x16x32_bf16 v[80:83],a[152:155],v[192:195],v[80:83]
 ds_read_b64_tr_b16 a[144:145],v22 offset:192
 v_mfma_f32_16x16x32_bf16 v[80:83],a[156:159],v[224:227],v[80:83]
 v_mfma_f32_16x16x32_bf16 v[84:87],a[152:155],v[196:199],v[84:87]
 ds_read_b64_tr_b16 a[146:147],v22 offset:448
 v_mfma_f32_16x16x32_bf16 v[84:87],a[156:159],v[228:231],v[84:87]
 v_mfma_f32_16x16x32_bf16 v[88:91],a[152:155],v[200:203],v[88:91]
 ds_read_b64_tr_b16 a[148:149],v22 offset:8960
 v_mfma_f32_16x16x32_bf16 v[88:91],a[156:159],v[232:235],v[88:91]
 v_mfma_f32_16x16x32_bf16 v[92:95],a[152:155],v[204:207],v[92:95]
 ds_read_b64_tr_b16 a[150:151],v22 offset:9216
 v_mfma_f32_16x16x32_bf16 v[92:95],a[156:159],v[236:239],v[92:95]
 s_waitcnt lgkmcnt(4)
 v_mfma_f32_16x16x32_bf16 v[96:99],a[128:131],v[128:131],0
 ds_read_b64_tr_b16 a[152:153],v23 offset:35264
 v_mfma_f32_16x16x32_bf16 v[96:99],a[132:135],v[160:163],v[96:99]
 buffer_load_dwordx4 a[200:203],v4,s[8:11],s57 offen offset:2048 sc1
 v_mfma_f32_16x16x32_bf16 v[100:103],a[128:131],v[132:135],0
 ds_read_b64_tr_b16 a[154:155],v23 offset:35520
 v_mfma_f32_16x16x32_bf16 v[100:103],a[132:135],v[164:167],v[100:103]
 v_mfma_f32_16x16x32_bf16 v[104:107],a[128:131],v[136:139],0
 ds_read_b64_tr_b16 a[156:157],v23 offset:44032
 v_mfma_f32_16x16x32_bf16 v[104:107],a[132:135],v[168:171],v[104:107]
 v_mfma_f32_16x16x32_bf16 v[108:111],a[128:131],v[140:143],0
 ds_read_b64_tr_b16 a[158:159],v23 offset:44288
 v_mfma_f32_16x16x32_bf16 v[108:111],a[132:135],v[172:175],v[108:111]
 s_waitcnt vmcnt(28)
 s_barrier
 v_mfma_f32_16x16x32_bf16 v[96:99],a[136:139],v[192:195],v[96:99]
 ds_read_b64_tr_b16 a[128:129],v21 offset:0
 v_mfma_f32_16x16x32_bf16 v[96:99],a[140:143],v[224:227],v[96:99]
 v_mfma_f32_16x16x32_bf16 v[100:103],a[136:139],v[196:199],v[100:103]
 ds_read_b64_tr_b16 a[130:131],v21 offset:256
 v_mfma_f32_16x16x32_bf16 v[100:103],a[140:143],v[228:231],v[100:103]
 v_mfma_f32_16x16x32_bf16 v[104:107],a[136:139],v[200:203],v[104:107]
 ds_read_b64_tr_b16 a[132:133],v21 offset:8768
 v_mfma_f32_16x16x32_bf16 v[104:107],a[140:143],v[232:235],v[104:107]
 buffer_load_dwordx4 a[204:207],v4,s[8:11],s57 offen offset:3072 sc1
 v_mfma_f32_16x16x32_bf16 v[108:111],a[136:139],v[204:207],v[108:111]
 ds_read_b64_tr_b16 a[134:135],v21 offset:9024
 v_mfma_f32_16x16x32_bf16 v[108:111],a[140:143],v[236:239],v[108:111]
 s_waitcnt lgkmcnt(4)
 v_mfma_f32_16x16x32_bf16 v[112:115],a[144:147],v[128:131],0
 ds_read_b64_tr_b16 a[136:137],v21 offset:32
 v_mfma_f32_16x16x32_bf16 v[112:115],a[148:151],v[160:163],v[112:115]
 v_mfma_f32_16x16x32_bf16 v[116:119],a[144:147],v[132:135],0
 ds_read_b64_tr_b16 a[138:139],v21 offset:288
 v_mfma_f32_16x16x32_bf16 v[116:119],a[148:151],v[164:167],v[116:119]
 buffer_load_dwordx4 a[208:211],v5,s[8:11],s57 offen offset:0 sc1
 v_mfma_f32_16x16x32_bf16 v[120:123],a[144:147],v[136:139],0
 ds_read_b64_tr_b16 a[140:141],v21 offset:8800
 v_mfma_f32_16x16x32_bf16 v[120:123],a[148:151],v[168:171],v[120:123]
 buffer_load_dwordx4 a[212:215],v5,s[8:11],s57 offen offset:1024 sc1
 v_mfma_f32_16x16x32_bf16 v[124:127],a[144:147],v[140:143],0
 ds_read_b64_tr_b16 a[142:143],v21 offset:9056
 v_mfma_f32_16x16x32_bf16 v[124:127],a[148:151],v[172:175],v[124:127]
 buffer_load_dwordx4 a[216:219],v5,s[8:11],s57 offen offset:2048 sc1
 v_mfma_f32_16x16x32_bf16 v[112:115],a[152:155],v[192:195],v[112:115]
 ds_read_b64_tr_b16 a[144:145],v21 offset:64
 v_mfma_f32_16x16x32_bf16 v[112:115],a[156:159],v[224:227],v[112:115]
 buffer_load_dwordx4 a[220:223],v5,s[8:11],s57 offen offset:3072 sc1
 v_mfma_f32_16x16x32_bf16 v[116:119],a[152:155],v[196:199],v[116:119]
 ds_read_b64_tr_b16 a[146:147],v21 offset:320
 v_mfma_f32_16x16x32_bf16 v[116:119],a[156:159],v[228:231],v[116:119]
 v_mfma_f32_16x16x32_bf16 v[120:123],a[152:155],v[200:203],v[120:123]
 ds_read_b64_tr_b16 a[148:149],v21 offset:8832
 v_mfma_f32_16x16x32_bf16 v[120:123],a[156:159],v[232:235],v[120:123]
 v_mfma_f32_16x16x32_bf16 v[124:127],a[152:155],v[204:207],v[124:127]
 ds_read_b64_tr_b16 a[150:151],v21 offset:9088
 v_mfma_f32_16x16x32_bf16 v[124:127],a[156:159],v[236:239],v[124:127]
 s_waitcnt vmcnt(19)
 s_waitcnt lgkmcnt(4)
 v_mfma_f32_16x16x32_bf16 a[224:227],a[128:131],a[80:83],a[224:227]
 ds_read_b64_tr_b16 a[152:153],v21 offset:96
 v_accvgpr_read_b32 v128,a0
 v_mfma_f32_16x16x32_bf16 a[224:227],a[132:135],a[84:87],a[224:227]
 v_accvgpr_read_b32 v129,a1
 v_accvgpr_read_b32 v130,a2
 v_mfma_f32_16x16x32_bf16 a[228:231],a[128:131],a[88:91],a[228:231]
 ds_read_b64_tr_b16 a[154:155],v21 offset:352
 s_xor_b32 s58,s61,2
 v_mfma_f32_16x16x32_bf16 a[228:231],a[132:135],a[92:95],a[228:231]
 s_and_b32 s58,s58,3
 s_cselect_b32 s58,524288,0
 v_mfma_f32_16x16x32_bf16 a[232:235],a[128:131],a[112:115],a[232:235]
 ds_read_b64_tr_b16 a[156:157],v21 offset:8864
 v_accvgpr_read_b32 v131,a3
 v_mfma_f32_16x16x32_bf16 a[232:235],a[132:135],a[116:119],a[232:235]
 s_add_u32 s58,s58,s74
 v_accvgpr_read_b32 v132,a4
 v_mfma_f32_16x16x32_bf16 a[236:239],a[128:131],a[120:123],a[236:239]
 ds_read_b64_tr_b16 a[158:159],v21 offset:9120
 s_add_u32 m0,s51,17536
 v_mfma_f32_16x16x32_bf16 a[236:239],a[132:135],a[124:127],a[236:239]
 buffer_load_dwordx4 v8,s[32:35],s58 offen offset:0 lds
 v_mfma_f32_16x16x32_bf16 v[144:147],a[136:139],a[80:83],v[144:147]
 ds_read_b64_tr_b16 a[128:129],v21 offset:128
 v_accvgpr_read_b32 v133,a5
 v_mfma_f32_16x16x32_bf16 v[144:147],a[140:143],a[84:87],v[144:147]
 v_accvgpr_read_b32 v134,a6
 v_accvgpr_read_b32 v135,a7
 v_mfma_f32_16x16x32_bf16 v[148:151],a[136:139],a[88:91],v[148:151]
 ds_read_b64_tr_b16 a[130:131],v21 offset:384
 v_accvgpr_read_b32 v136,a8
 v_mfma_f32_16x16x32_bf16 v[148:151],a[140:143],a[92:95],v[148:151]
 v_accvgpr_read_b32 v137,a9
 v_accvgpr_read_b32 v138,a10
 v_mfma_f32_16x16x32_bf16 v[152:155],a[136:139],a[112:115],v[152:155]
 ds_read_b64_tr_b16 a[132:133],v21 offset:8896
 v_accvgpr_read_b32 v139,a11
 v_mfma_f32_16x16x32_bf16 v[152:155],a[140:143],a[116:119],v[152:155]
 v_accvgpr_read_b32 v140,a12
 v_accvgpr_read_b32 v141,a13
 v_mfma_f32_16x16x32_bf16 v[156:159],a[136:139],a[120:123],v[156:159]
 ds_read_b64_tr_b16 a[134:135],v21 offset:9152
 v_accvgpr_read_b32 v142,a14
 v_mfma_f32_16x16x32_bf16 v[156:159],a[140:143],a[124:127],v[156:159]
 v_accvgpr_read_b32 v143,a15
 s_waitcnt lgkmcnt(4)
 v_mfma_f32_16x16x32_bf16 v[80:83],a[144:147],a[80:83],v[80:83]
 ds_read_b64_tr_b16 a[136:137],v21 offset:160
 s_waitcnt vmcnt(7)
 v_mfma_f32_16x16x32_bf16 v[80:83],a[148:151],a[84:87],v[80:83]
 buffer_store_dword v7,off,s[8:11],s76 sc0 sc1
 v_mfma_f32_16x16x32_bf16 v[84:87],a[144:147],a[88:91],v[84:87]
 ds_read_b64_tr_b16 a[138:139],v21 offset:416
 v_mfma_f32_16x16x32_bf16 v[84:87],a[148:151],a[92:95],v[84:87]
 v_mfma_f32_16x16x32_bf16 v[88:91],a[144:147],a[112:115],v[88:91]
 ds_read_b64_tr_b16 a[140:141],v21 offset:8928
 v_mfma_f32_16x16x32_bf16 v[88:91],a[148:151],a[116:119],v[88:91]
 buffer_load_dwordx4 v9,s[32:35],s58 offen offset:1088 lds
 v_mfma_f32_16x16x32_bf16 v[92:95],a[144:147],a[120:123],v[92:95]
 ds_read_b64_tr_b16 a[142:143],v21 offset:9184
 v_mfma_f32_16x16x32_bf16 v[92:95],a[148:151],a[124:127],v[92:95]
 v_mfma_f32_16x16x32_bf16 v[176:179],a[152:155],a[80:83],v[176:179]
 ds_read_b64_tr_b16 a[144:145],v21 offset:192
 v_mfma_f32_16x16x32_bf16 v[176:179],a[156:159],a[84:87],v[176:179]
 v_mfma_f32_16x16x32_bf16 v[180:183],a[152:155],a[88:91],v[180:183]
 ds_read_b64_tr_b16 a[146:147],v21 offset:448
 v_mfma_f32_16x16x32_bf16 v[180:183],a[156:159],a[92:95],v[180:183]
 buffer_load_dwordx4 v10,s[32:35],s58 offen offset:2176 lds
 v_mfma_f32_16x16x32_bf16 v[184:187],a[152:155],a[112:115],v[184:187]
 ds_read_b64_tr_b16 a[148:149],v21 offset:8960
 s_xor_b32 s57,s72,32768
 v_mfma_f32_16x16x32_bf16 v[184:187],a[156:159],a[116:119],v[184:187]
 s_cmp_eq_u32 s57,s69
 s_cselect_b32 s57,s72,s57
 v_mfma_f32_16x16x32_bf16 v[188:191],a[152:155],a[120:123],v[188:191]
 ds_read_b64_tr_b16 a[150:151],v21 offset:9216
 v_mfma_f32_16x16x32_bf16 v[188:191],a[156:159],a[124:127],v[188:191]
 s_waitcnt lgkmcnt(4)
 v_mfma_f32_16x16x32_bf16 v[96:99],a[128:131],a[80:83],v[96:99]
 ds_read_b64_tr_b16 a[152:153],v21 offset:224
 v_mfma_f32_16x16x32_bf16 v[96:99],a[132:135],a[84:87],v[96:99]
 buffer_load_dwordx4 v11,s[32:35],s58 offen offset:3264 lds
 v_mfma_f32_16x16x32_bf16 v[100:103],a[128:131],a[88:91],v[100:103]
 ds_read_b64_tr_b16 a[154:155],v21 offset:480
 v_mfma_f32_16x16x32_bf16 v[100:103],a[132:135],a[92:95],v[100:103]
 buffer_load_dwordx4 a[160:163],v4,s[8:11],s57 offen offset:0 sc1
 v_mfma_f32_16x16x32_bf16 v[104:107],a[128:131],a[112:115],v[104:107]
 ds_read_b64_tr_b16 a[156:157],v21 offset:8992
 v_mfma_f32_16x16x32_bf16 v[104:107],a[132:135],a[116:119],v[104:107]
 v_mfma_f32_16x16x32_bf16 v[108:111],a[128:131],a[120:123],v[108:111]
 ds_read_b64_tr_b16 a[158:159],v21 offset:9248
 v_mfma_f32_16x16x32_bf16 v[108:111],a[132:135],a[124:127],v[108:111]
 s_barrier
 v_mfma_f32_16x16x32_bf16 v[208:211],a[136:139],a[80:83],v[208:211]
 ds_read_b64_tr_b16 a[128:129],v21 offset:35072
 v_mfma_f32_16x16x32_bf16 v[208:211],a[140:143],a[84:87],v[208:211]
 buffer_load_dwordx4 a[164:167],v4,s[8:11],s57 offen offset:1024 sc1
 v_mfma_f32_16x16x32_bf16 v[212:215],a[136:139],a[88:91],v[212:215]
 ds_read_b64_tr_b16 a[130:131],v21 offset:35328
 v_mfma_f32_16x16x32_bf16 v[212:215],a[140:143],a[92:95],v[212:215]
 v_mfma_f32_16x16x32_bf16 v[216:219],a[136:139],a[112:115],v[216:219]
 ds_read_b64_tr_b16 a[132:133],v21 offset:43840
 v_mfma_f32_16x16x32_bf16 v[216:219],a[140:143],a[116:119],v[216:219]
 buffer_load_dwordx4 a[168:171],v4,s[8:11],s57 offen offset:2048 sc1
 v_mfma_f32_16x16x32_bf16 v[220:223],a[136:139],a[120:123],v[220:223]
 ds_read_b64_tr_b16 a[134:135],v21 offset:44096
 v_mfma_f32_16x16x32_bf16 v[220:223],a[140:143],a[124:127],v[220:223]
 s_waitcnt lgkmcnt(4)
 v_mfma_f32_16x16x32_bf16 v[112:115],a[144:147],a[80:83],v[112:115]
 ds_read_b64_tr_b16 a[136:137],v21 offset:35104
 v_mfma_f32_16x16x32_bf16 v[112:115],a[148:151],a[84:87],v[112:115]
 buffer_load_dwordx4 a[172:175],v4,s[8:11],s57 offen offset:3072 sc1
 v_mfma_f32_16x16x32_bf16 v[116:119],a[144:147],a[88:91],v[116:119]
 ds_read_b64_tr_b16 a[138:139],v21 offset:35360
 v_mfma_f32_16x16x32_bf16 v[116:119],a[148:151],a[92:95],v[116:119]
 buffer_load_dwordx4 a[176:179],v5,s[8:11],s57 offen offset:0 sc1
 v_mfma_f32_16x16x32_bf16 v[120:123],a[144:147],a[112:115],v[120:123]
 ds_read_b64_tr_b16 a[140:141],v21 offset:43872
 v_mfma_f32_16x16x32_bf16 v[120:123],a[148:151],a[116:119],v[120:123]
 buffer_load_dwordx4 a[180:183],v5,s[8:11],s57 offen offset:1024 sc1
 v_mfma_f32_16x16x32_bf16 v[124:127],a[144:147],a[120:123],v[124:127]
 ds_read_b64_tr_b16 a[142:143],v21 offset:44128
 v_mfma_f32_16x16x32_bf16 v[124:127],a[148:151],a[124:127],v[124:127]
 buffer_load_dwordx4 a[184:187],v5,s[8:11],s57 offen offset:2048 sc1
 v_mfma_f32_16x16x32_bf16 v[240:243],a[152:155],a[80:83],v[240:243]
 ds_read_b64_tr_b16 a[144:145],v21 offset:35136
 v_mfma_f32_16x16x32_bf16 v[240:243],a[156:159],a[84:87],v[240:243]
 buffer_load_dwordx4 a[188:191],v5,s[8:11],s57 offen offset:3072 sc1
 v_mfma_f32_16x16x32_bf16 v[244:247],a[152:155],a[88:91],v[244:247]
 ds_read_b64_tr_b16 a[146:147],v21 offset:35392
 v_mfma_f32_16x16x32_bf16 v[244:247],a[156:159],a[92:95],v[244:247]
 v_mfma_f32_16x16x32_bf16 v[248:251],a[152:155],a[112:115],v[248:251]
 ds_read_b64_tr_b16 a[148:149],v21 offset:43904
 v_mfma_f32_16x16x32_bf16 v[248:251],a[156:159],a[116:119],v[248:251]
 v_mfma_f32_16x16x32_bf16 v[252:255],a[152:155],a[120:123],v[252:255]
 ds_read_b64_tr_b16 a[150:151],v21 offset:44160
 s_add_u32 s58,s58,131072
 v_mfma_f32_16x16x32_bf16 v[252:255],a[156:159],a[124:127],v[252:255]
 s_waitcnt vmcnt(13)
 s_waitcnt lgkmcnt(4)
 v_mfma_f32_16x16x32_bf16 a[224:227],a[128:131],a[192:195],a[224:227]
 ds_read_b64_tr_b16 a[152:153],v21 offset:35168
 s_add_u32 m0,s51,70144
 v_mfma_f32_16x16x32_bf16 a[224:227],a[132:135],a[196:199],a[224:227]
 buffer_load_dwordx4 v8,s[32:35],s58 offen offset:0 lds
 v_mfma_f32_16x16x32_bf16 a[228:231],a[128:131],a[200:203],a[228:231]
 ds_read_b64_tr_b16 a[154:155],v21 offset:35424
 v_mfma_f32_16x16x32_bf16 a[228:231],a[132:135],a[204:207],a[228:231]
 buffer_load_dwordx4 v9,s[32:35],s58 offen offset:1088 lds
 v_mfma_f32_16x16x32_bf16 a[232:235],a[128:131],a[208:211],a[232:235]
 ds_read_b64_tr_b16 a[156:157],v21 offset:43936
 v_mfma_f32_16x16x32_bf16 a[232:235],a[132:135],a[212:215],a[232:235]
 v_mfma_f32_16x16x32_bf16 a[236:239],a[128:131],a[216:219],a[236:239]
 ds_read_b64_tr_b16 a[158:159],v21 offset:44192
 v_mfma_f32_16x16x32_bf16 a[236:239],a[132:135],a[220:223],a[236:239]
 v_mfma_f32_16x16x32_bf16 v[144:147],a[136:139],a[192:195],v[144:147]
 ds_read_b64_tr_b16 a[128:129],v21 offset:35200
 v_mfma_f32_16x16x32_bf16 v[144:147],a[140:143],a[196:199],v[144:147]
 buffer_load_dwordx4 v10,s[32:35],s58 offen offset:2176 lds
 v_mfma_f32_16x16x32_bf16 v[148:151],a[136:139],a[200:203],v[148:151]
 ds_read_b64_tr_b16 a[130:131],v21 offset:35456
 v_mfma_f32_16x16x32_bf16 v[148:151],a[140:143],a[204:207],v[148:151]
 v_mfma_f32_16x16x32_bf16 v[152:155],a[136:139],a[208:211],v[152:155]
 ds_read_b64_tr_b16 a[132:133],v21 offset:43968
 v_mfma_f32_16x16x32_bf16 v[152:155],a[140:143],a[212:215],v[152:155]
 buffer_load_dwordx4 v11,s[32:35],s58 offen offset:3264 lds
 v_mfma_f32_16x16x32_bf16 v[156:159],a[136:139],a[216:219],v[156:159]
 ds_read_b64_tr_b16 a[134:135],v21 offset:44224
 v_mfma_f32_16x16x32_bf16 v[156:159],a[140:143],a[220:223],v[156:159]
 s_waitcnt lgkmcnt(4)
 v_mfma_f32_16x16x32_bf16 v[80:83],a[144:147],a[192:195],v[80:83]
 ds_read_b64_tr_b16 a[136:137],v21 offset:35232
 s_add_u32 s57,s57,8192
 v_mfma_f32_16x16x32_bf16 v[80:83],a[148:151],a[196:199],v[80:83]
 buffer_load_dwordx4 a[16:19],v4,s[8:11],s57 offen offset:0 sc1
 v_mfma_f32_16x16x32_bf16 v[84:87],a[144:147],a[200:203],v[84:87]
 ds_read_b64_tr_b16 a[138:139],v21 offset:35488
 v_mfma_f32_16x16x32_bf16 v[84:87],a[148:151],a[204:207],v[84:87]
 v_mfma_f32_16x16x32_bf16 v[88:91],a[144:147],a[208:211],v[88:91]
 ds_read_b64_tr_b16 a[140:141],v21 offset:44000
 v_mfma_f32_16x16x32_bf16 v[88:91],a[148:151],a[212:215],v[88:91]
 v_mfma_f32_16x16x32_bf16 v[92:95],a[144:147],a[216:219],v[92:95]
 ds_read_b64_tr_b16 a[142:143],v21 offset:44256
 v_mfma_f32_16x16x32_bf16 v[92:95],a[148:151],a[220:223],v[92:95]
 buffer_load_dwordx4 a[20:23],v4,s[8:11],s57 offen offset:1024 sc1
 v_mfma_f32_16x16x32_bf16 v[176:179],a[152:155],a[192:195],v[176:179]
 ds_read_b64_tr_b16 a[144:145],v21 offset:35264
 v_mfma_f32_16x16x32_bf16 v[176:179],a[156:159],a[196:199],v[176:179]
 v_mfma_f32_16x16x32_bf16 v[180:183],a[152:155],a[200:203],v[180:183]
 ds_read_b64_tr_b16 a[146:147],v21 offset:35520
 v_mfma_f32_16x16x32_bf16 v[180:183],a[156:159],a[204:207],v[180:183]
 buffer_load_dwordx4 a[24:27],v4,s[8:11],s57 offen offset:2048 sc1
 v_mfma_f32_16x16x32_bf16 v[184:187],a[152:155],a[208:211],v[184:187]
 ds_read_b64_tr_b16 a[148:149],v21 offset:44032
 v_mfma_f32_16x16x32_bf16 v[184:187],a[156:159],a[212:215],v[184:187]
 v_mfma_f32_16x16x32_bf16 v[188:191],a[152:155],a[216:219],v[188:191]
 ds_read_b64_tr_b16 a[150:151],v21 offset:44288
 v_mfma_f32_16x16x32_bf16 v[188:191],a[156:159],a[220:223],v[188:191]
 s_waitcnt lgkmcnt(4)
 v_mfma_f32_16x16x32_bf16 v[96:99],a[128:131],a[192:195],v[96:99]
 ds_read_b64_tr_b16 a[152:153],v21 offset:35296
 v_mfma_f32_16x16x32_bf16 v[96:99],a[132:135],a[196:199],v[96:99]
 buffer_load_dwordx4 a[28:31],v4,s[8:11],s57 offen offset:3072 sc1
 v_mfma_f32_16x16x32_bf16 v[100:103],a[128:131],a[200:203],v[100:103]
 ds_read_b64_tr_b16 a[154:155],v21 offset:35552
 v_mfma_f32_16x16x32_bf16 v[100:103],a[132:135],a[204:207],v[100:103]
 buffer_load_dword v35,v33,s[8:11],0 offen sc0 sc1
 v_mfma_f32_16x16x32_bf16 v[104:107],a[128:131],a[208:211],v[104:107]
 ds_read_b64_tr_b16 a[156:157],v21 offset:44064
 v_mfma_f32_16x16x32_bf16 v[104:107],a[132:135],a[212:215],v[104:107]
 buffer_load_dwordx4 a[48:51],v5,s[8:11],s57 offen offset:0 sc1
 v_mfma_f32_16x16x32_bf16 v[108:111],a[128:131],a[216:219],v[108:111]
 ds_read_b64_tr_b16 a[158:159],v21 offset:44320
 v_mfma_f32_16x16x32_bf16 v[108:111],a[132:135],a[220:223],v[108:111]
 s_waitcnt vmcnt(18)
 s_barrier
 v_mfma_f32_16x16x32_bf16 v[208:211],a[136:139],a[192:195],v[208:211]
 ds_read_b64_tr_b16 a[128:129],v21 offset:17536
 v_mfma_f32_16x16x32_bf16 v[208:211],a[140:143],a[196:199],v[208:211]
 buffer_load_dwordx4 a[52:55],v5,s[8:11],s57 offen offset:1024 sc1
 v_mfma_f32_16x16x32_bf16 v[212:215],a[136:139],a[200:203],v[212:215]
 ds_read_b64_tr_b16 a[130:131],v21 offset:17792
 v_mfma_f32_16x16x32_bf16 v[212:215],a[140:143],a[204:207],v[212:215]
 v_mfma_f32_16x16x32_bf16 v[216:219],a[136:139],a[208:211],v[216:219]
 ds_read_b64_tr_b16 a[132:133],v21 offset:26304
 s_xor_b32 s58,s61,3
 v_mfma_f32_16x16x32_bf16 v[216:219],a[140:143],a[212:215],v[216:219]
 s_and_b32 s58,s58,3
 s_cselect_b32 s58,786432,0
 v_mfma_f32_16x16x32_bf16 v[220:223],a[136:139],a[216:219],v[220:223]
 ds_read_b64_tr_b16 a[134:135],v21 offset:26560
 v_mfma_f32_16x16x32_bf16 v[220:223],a[140:143],a[220:223],v[220:223]
 s_waitcnt lgkmcnt(4)
 v_mfma_f32_16x16x32_bf16 v[112:115],a[144:147],a[192:195],v[112:115]
 ds_read_b64_tr_b16 a[136:137],v21 offset:17568
 v_mfma_f32_16x16x32_bf16 v[112:115],a[148:151],a[196:199],v[112:115]
 buffer_load_dwordx4 a[56:59],v5,s[8:11],s57 offen offset:2048 sc1
 v_mfma_f32_16x16x32_bf16 v[116:119],a[144:147],a[200:203],v[116:119]
 ds_read_b64_tr_b16 a[138:139],v21 offset:17824
 v_mfma_f32_16x16x32_bf16 v[116:119],a[148:151],a[204:207],v[116:119]
 buffer_load_dwordx4 a[60:63],v5,s[8:11],s57 offen offset:3072 sc1
 v_mfma_f32_16x16x32_bf16 v[120:123],a[144:147],a[208:211],v[120:123]
 ds_read_b64_tr_b16 a[140:141],v21 offset:26336
 v_mfma_f32_16x16x32_bf16 v[120:123],a[148:151],a[212:215],v[120:123]
 s_add_u32 s58,s58,s74
 v_mfma_f32_16x16x32_bf16 v[124:127],a[144:147],a[216:219],v[124:127]
 ds_read_b64_tr_b16 a[142:143],v21 offset:26592
 s_add_u32 m0,s51,87680
 v_mfma_f32_16x16x32_bf16 v[124:127],a[148:151],a[220:223],v[124:127]
 buffer_load_dwordx4 v8,s[32:35],s58 offen offset:0 lds
 v_mfma_f32_16x16x32_bf16 v[240:243],a[152:155],a[192:195],v[240:243]
 ds_read_b64_tr_b16 a[144:145],v21 offset:17600
 v_mfma_f32_16x16x32_bf16 v[240:243],a[156:159],a[196:199],v[240:243]
 v_mfma_f32_16x16x32_bf16 v[244:247],a[152:155],a[200:203],v[244:247]
 ds_read_b64_tr_b16 a[146:147],v21 offset:17856
 v_mfma_f32_16x16x32_bf16 v[244:247],a[156:159],a[204:207],v[244:247]
 v_mfma_f32_16x16x32_bf16 v[248:251],a[152:155],a[208:211],v[248:251]
 ds_read_b64_tr_b16 a[148:149],v21 offset:26368
 v_mfma_f32_16x16x32_bf16 v[248:251],a[156:159],a[212:215],v[248:251]
 buffer_load_dwordx4 v9,s[32:35],s58 offen offset:1088 lds
 v_mfma_f32_16x16x32_bf16 v[252:255],a[152:155],a[216:219],v[252:255]
 ds_read_b64_tr_b16 a[150:151],v21 offset:26624
 v_mfma_f32_16x16x32_bf16 v[252:255],a[156:159],a[220:223],v[252:255]
 s_waitcnt vmcnt(15)
 s_waitcnt lgkmcnt(4)
 v_mfma_f32_16x16x32_bf16 a[224:227],a[128:131],a[160:163],a[224:227]
 ds_read_b64_tr_b16 a[152:153],v21 offset:17632
 v_mfma_f32_16x16x32_bf16 a[224:227],a[132:135],a[164:167],a[224:227]
 v_mfma_f32_16x16x32_bf16 a[228:231],a[128:131],a[168:171],a[228:231]
 ds_read_b64_tr_b16 a[154:155],v21 offset:17888
 v_mfma_f32_16x16x32_bf16 a[228:231],a[132:135],a[172:175],a[228:231]
 buffer_load_dwordx4 v10,s[32:35],s58 offen offset:2176 lds
 v_mfma_f32_16x16x32_bf16 a[232:235],a[128:131],a[176:179],a[232:235]
 ds_read_b64_tr_b16 a[156:157],v21 offset:26400
 v_mfma_f32_16x16x32_bf16 a[232:235],a[132:135],a[180:183],a[232:235]
 v_mfma_f32_16x16x32_bf16 a[236:239],a[128:131],a[184:187],a[236:239]
 ds_read_b64_tr_b16 a[158:159],v21 offset:26656
 v_mfma_f32_16x16x32_bf16 a[236:239],a[132:135],a[188:191],a[236:239]
 buffer_load_dwordx4 v11,s[32:35],s58 offen offset:3264 lds
 v_mfma_f32_16x16x32_bf16 v[144:147],a[136:139],a[160:163],v[144:147]
 ds_read_b64_tr_b16 a[128:129],v21 offset:17664
 v_mfma_f32_16x16x32_bf16 v[144:147],a[140:143],a[164:167],v[144:147]
 v_mfma_f32_16x16x32_bf16 v[148:151],a[136:139],a[168:171],v[148:151]
 ds_read_b64_tr_b16 a[130:131],v21 offset:17920
 v_mfma_f32_16x16x32_bf16 v[148:151],a[140:143],a[172:175],v[148:151]
 v_mfma_f32_16x16x32_bf16 v[152:155],a[136:139],a[176:179],v[152:155]
 ds_read_b64_tr_b16 a[132:133],v21 offset:26432
 v_mfma_f32_16x16x32_bf16 v[152:155],a[140:143],a[180:183],v[152:155]
 v_mfma_f32_16x16x32_bf16 v[156:159],a[136:139],a[184:187],v[156:159]
 ds_read_b64_tr_b16 a[134:135],v21 offset:26688
 v_mfma_f32_16x16x32_bf16 v[156:159],a[140:143],a[188:191],v[156:159]
 s_waitcnt lgkmcnt(4)
 v_mfma_f32_16x16x32_bf16 v[80:83],a[144:147],a[160:163],v[80:83]
 ds_read_b64_tr_b16 a[136:137],v21 offset:17696
 v_mfma_f32_16x16x32_bf16 v[80:83],a[148:151],a[164:167],v[80:83]
 v_mfma_f32_16x16x32_bf16 v[84:87],a[144:147],a[168:171],v[84:87]
 ds_read_b64_tr_b16 a[138:139],v21 offset:17952
 v_mfma_f32_16x16x32_bf16 v[84:87],a[148:151],a[172:175],v[84:87]
 v_mfma_f32_16x16x32_bf16 v[88:91],a[144:147],a[176:179],v[88:91]
 ds_read_b64_tr_b16 a[140:141],v21 offset:26464
 v_mfma_f32_16x16x32_bf16 v[88:91],a[148:151],a[180:183],v[88:91]
 v_mfma_f32_16x16x32_bf16 v[92:95],a[144:147],a[184:187],v[92:95]
 ds_read_b64_tr_b16 a[142:143],v21 offset:26720
 v_mfma_f32_16x16x32_bf16 v[92:95],a[148:151],a[188:191],v[92:95]
 v_mfma_f32_16x16x32_bf16 v[176:179],a[152:155],a[160:163],v[176:179]
 ds_read_b64_tr_b16 a[144:145],v21 offset:17728
 v_mfma_f32_16x16x32_bf16 v[176:179],a[156:159],a[164:167],v[176:179]
 v_mfma_f32_16x16x32_bf16 v[180:183],a[152:155],a[168:171],v[180:183]
 ds_read_b64_tr_b16 a[146:147],v21 offset:17984
 v_mfma_f32_16x16x32_bf16 v[180:183],a[156:159],a[172:175],v[180:183]
 v_mfma_f32_16x16x32_bf16 v[184:187],a[152:155],a[176:179],v[184:187]
 ds_read_b64_tr_b16 a[148:149],v21 offset:26496
 v_mfma_f32_16x16x32_bf16 v[184:187],a[156:159],a[180:183],v[184:187]
 v_mfma_f32_16x16x32_bf16 v[188:191],a[152:155],a[184:187],v[188:191]
 ds_read_b64_tr_b16 a[150:151],v21 offset:26752
 s_waitcnt vmcnt(8)
 v_cmp_eq_u32 vcc,0,v35
 s_nop 0
 s_cbranch_vccnz L_fpoll
L_fpoll_ret:
 v_mfma_f32_16x16x32_bf16 v[188:191],a[156:159],a[188:191],v[188:191]
 s_waitcnt lgkmcnt(4)
 v_mfma_f32_16x16x32_bf16 v[96:99],a[128:131],a[160:163],v[96:99]
 ds_read_b64_tr_b16 a[152:153],v21 offset:17760
 v_mfma_f32_16x16x32_bf16 v[96:99],a[132:135],a[164:167],v[96:99]
 v_mfma_f32_16x16x32_bf16 v[100:103],a[128:131],a[168:171],v[100:103]
 ds_read_b64_tr_b16 a[154:155],v21 offset:18016
 s_xor_b32 s63,s75,135168
 v_mfma_f32_16x16x32_bf16 v[100:103],a[132:135],a[172:175],v[100:103]
 buffer_load_dwordx4 v[192:195],v4,s[8:11],s63 offen offset:0 sc1
 v_mfma_f32_16x16x32_bf16 v[104:107],a[128:131],a[176:179],v[104:107]
 ds_read_b64_tr_b16 a[156:157],v21 offset:26528
 v_mfma_f32_16x16x32_bf16 v[104:107],a[132:135],a[180:183],v[104:107]
 v_mfma_f32_16x16x32_bf16 v[108:111],a[128:131],a[184:187],v[108:111]
 ds_read_b64_tr_b16 a[158:159],v21 offset:26784
 v_mfma_f32_16x16x32_bf16 v[108:111],a[132:135],a[188:191],v[108:111]
 s_barrier
 v_mfma_f32_16x16x32_bf16 v[208:211],a[136:139],a[160:163],v[208:211]
 ds_read_b64_tr_b16 a[128:129],v22 offset:17536
 s_xor_b32 s57,s72,49152
 v_mfma_f32_16x16x32_bf16 v[208:211],a[140:143],a[164:167],v[208:211]
 s_cmp_eq_u32 s57,s69
 s_cselect_b32 s57,s72,s57
 v_mfma_f32_16x16x32_bf16 v[212:215],a[136:139],a[168:171],v[212:215]
 ds_read_b64_tr_b16 a[130:131],v22 offset:17792
 v_mfma_f32_16x16x32_bf16 v[212:215],a[140:143],a[172:175],v[212:215]
 buffer_load_dwordx4 a[32:35],v4,s[8:11],s57 offen offset:0 sc1
 v_mfma_f32_16x16x32_bf16 v[216:219],a[136:139],a[176:179],v[216:219]
 ds_read_b64_tr_b16 a[132:133],v22 offset:26304
 v_mfma_f32_16x16x32_bf16 v[216:219],a[140:143],a[180:183],v[216:219]
 buffer_load_dwordx4 v[196:199],v4,s[8:11],s63 offen offset:1024 sc1
 v_mfma_f32_16x16x32_bf16 v[220:223],a[136:139],a[184:187],v[220:223]
 ds_read_b64_tr_b16 a[134:135],v22 offset:26560
 v_mfma_f32_16x16x32_bf16 v[220:223],a[140:143],a[188:191],v[220:223]
 s_waitcnt lgkmcnt(4)
 v_mfma_f32_16x16x32_bf16 v[112:115],a[144:147],a[160:163],v[112:115]
 ds_read_b64_tr_b16 a[136:137],v22 offset:17568
 v_mfma_f32_16x16x32_bf16 v[112:115],a[148:151],a[164:167],v[112:115]
 buffer_load_dwordx4 a[36:39],v4,s[8:11],s57 offen offset:1024 sc1
 v_mfma_f32_16x16x32_bf16 v[116:119],a[144:147],a[168:171],v[116:119]
 ds_read_b64_tr_b16 a[138:139],v22 offset:17824
 v_mfma_f32_16x16x32_bf16 v[116:119],a[148:151],a[172:175],v[116:119]
 buffer_load_dwordx4 v[200:203],v4,s[8:11],s63 offen offset:2048 sc1
 v_mfma_f32_16x16x32_bf16 v[120:123],a[144:147],a[176:179],v[120:123]
 ds_read_b64_tr_b16 a[140:141],v22 offset:26336
 v_mfma_f32_16x16x32_bf16 v[120:123],a[148:151],a[180:183],v[120:123]
 buffer_load_dwordx4 a[40:43],v4,s[8:11],s57 offen offset:2048 sc1
 v_mfma_f32_16x16x32_bf16 v[124:127],a[144:147],a[184:187],v[124:127]
 ds_read_b64_tr_b16 a[142:143],v22 offset:26592
 v_mfma_f32_16x16x32_bf16 v[124:127],a[148:151],a[188:191],v[124:127]
 buffer_load_dwordx4 a[44:47],v4,s[8:11],s57 offen offset:3072 sc1
 v_mfma_f32_16x16x32_bf16 v[240:243],a[152:155],a[160:163],v[240:243]
 ds_read_b64_tr_b16 a[144:145],v22 offset:17600
 v_mfma_f32_16x16x32_bf16 v[240:243],a[156:159],a[164:167],v[240:243]
 buffer_load_dwordx4 a[240:243],v5,s[8:11],s57 offen offset:0 sc1
 v_mfma_f32_16x16x32_bf16 v[244:247],a[152:155],a[168:171],v[244:247]
 ds_read_b64_tr_b16 a[146:147],v22 offset:17856
 v_mfma_f32_16x16x32_bf16 v[244:247],a[156:159],a[172:175],v[244:247]
 buffer_load_dwordx4 v[204:207],v4,s[8:11],s63 offen offset:3072 sc1
 v_mfma_f32_16x16x32_bf16 v[248:251],a[152:155],a[176:179],v[248:251]
 ds_read_b64_tr_b16 a[148:149],v22 offset:26368
 v_mfma_f32_16x16x32_bf16 v[248:251],a[156:159],a[180:183],v[248:251]
 buffer_load_dwordx4 a[244:247],v5,s[8:11],s57 offen offset:1024 sc1
 v_mfma_f32_16x16x32_bf16 v[252:255],a[152:155],a[184:187],v[252:255]
 ds_read_b64_tr_b16 a[150:151],v22 offset:26624
 v_mfma_f32_16x16x32_bf16 v[252:255],a[156:159],a[188:191],v[252:255]
 s_waitcnt vmcnt(14)
 s_waitcnt lgkmcnt(4)
 v_mfma_f32_16x16x32_bf16 a[224:227],a[128:131],a[16:19],a[224:227]
 ds_read_b64_tr_b16 a[152:153],v22 offset:17632
 v_mfma_f32_16x16x32_bf16 a[224:227],a[132:135],a[20:23],a[224:227]
 buffer_load_dwordx4 a[248:251],v5,s[8:11],s57 offen offset:2048 sc1
 v_mfma_f32_16x16x32_bf16 a[228:231],a[128:131],a[24:27],a[228:231]
 ds_read_b64_tr_b16 a[154:155],v22 offset:17888
 v_mfma_f32_16x16x32_bf16 a[228:231],a[132:135],a[28:31],a[228:231]
 buffer_load_dword v35,v34,s[8:11],0 offen sc0 sc1
 v_mfma_f32_16x16x32_bf16 a[232:235],a[128:131],a[48:51],a[232:235]
 ds_read_b64_tr_b16 a[156:157],v22 offset:26400
 v_mfma_f32_16x16x32_bf16 a[232:235],a[132:135],a[52:55],a[232:235]
 buffer_load_dwordx4 a[252:255],v5,s[8:11],s57 offen offset:3072 sc1
 v_mfma_f32_16x16x32_bf16 a[236:239],a[128:131],a[56:59],a[236:239]
 ds_read_b64_tr_b16 a[158:159],v22 offset:26656
 s_xor_b32 s63,s75,270336
 v_mfma_f32_16x16x32_bf16 a[236:239],a[132:135],a[60:63],a[236:239]
 buffer_load_dwordx4 v[224:227],v4,s[8:11],s63 offen offset:0 sc1
 v_mfma_f32_16x16x32_bf16 v[144:147],a[136:139],a[16:19],v[144:147]
 ds_read_b64_tr_b16 a[128:129],v22 offset:17664
 v_mfma_f32_16x16x32_bf16 v[144:147],a[140:143],a[20:23],v[144:147]
 v_mfma_f32_16x16x32_bf16 v[148:151],a[136:139],a[24:27],v[148:151]
 ds_read_b64_tr_b16 a[130:131],v22 offset:17920
 v_mfma_f32_16x16x32_bf16 v[148:151],a[140:143],a[28:31],v[148:151]
 buffer_load_dwordx4 v[228:231],v4,s[8:11],s63 offen offset:1024 sc1
 v_mfma_f32_16x16x32_bf16 v[152:155],a[136:139],a[48:51],v[152:155]
 ds_read_b64_tr_b16 a[132:133],v22 offset:26432
 v_mfma_f32_16x16x32_bf16 v[152:155],a[140:143],a[52:55],v[152:155]
 v_mfma_f32_16x16x32_bf16 v[156:159],a[136:139],a[56:59],v[156:159]
 ds_read_b64_tr_b16 a[134:135],v22 offset:26688
 v_mfma_f32_16x16x32_bf16 v[156:159],a[140:143],a[60:63],v[156:159]
 s_waitcnt lgkmcnt(4)
 v_mfma_f32_16x16x32_bf16 v[80:83],a[144:147],a[16:19],v[80:83]
 ds_read_b64_tr_b16 a[136:137],v22 offset:17696
 v_mfma_f32_16x16x32_bf16 v[80:83],a[148:151],a[20:23],v[80:83]
 buffer_load_dwordx4 v[232:235],v4,s[8:11],s63 offen offset:2048 sc1
 v_mfma_f32_16x16x32_bf16 v[84:87],a[144:147],a[24:27],v[84:87]
 ds_read_b64_tr_b16 a[138:139],v22 offset:17952
 v_mfma_f32_16x16x32_bf16 v[84:87],a[148:151],a[28:31],v[84:87]
 v_mfma_f32_16x16x32_bf16 v[88:91],a[144:147],a[48:51],v[88:91]
 ds_read_b64_tr_b16 a[140:141],v22 offset:26464
 v_mfma_f32_16x16x32_bf16 v[88:91],a[148:151],a[52:55],v[88:91]
 buffer_load_dwordx4 v[236:239],v4,s[8:11],s63 offen offset:3072 sc1
 v_mfma_f32_16x16x32_bf16 v[92:95],a[144:147],a[56:59],v[92:95]
 ds_read_b64_tr_b16 a[142:143],v22 offset:26720
 v_mfma_f32_16x16x32_bf16 v[92:95],a[148:151],a[60:63],v[92:95]
 v_mfma_f32_16x16x32_bf16 v[176:179],a[152:155],a[16:19],v[176:179]
 ds_read_b64_tr_b16 a[144:145],v22 offset:17728
 v_mfma_f32_16x16x32_bf16 v[176:179],a[156:159],a[20:23],v[176:179]
 s_add_u32 s58,s58,131072
 v_mfma_f32_16x16x32_bf16 v[180:183],a[152:155],a[24:27],v[180:183]
 ds_read_b64_tr_b16 a[146:147],v22 offset:17984
 s_add_u32 m0,s51,105216
 v_mfma_f32_16x16x32_bf16 v[180:183],a[156:159],a[28:31],v[180:183]
 buffer_load_dwordx4 v8,s[32:35],s58 offen offset:0 lds
 v_mfma_f32_16x16x32_bf16 v[184:187],a[152:155],a[48:51],v[184:187]
 ds_read_b64_tr_b16 a[148:149],v22 offset:26496
 s_xor_b32 s63,s75,405504
 v_mfma_f32_16x16x32_bf16 v[184:187],a[156:159],a[52:55],v[184:187]
 buffer_load_dwordx4 v[12:15],v4,s[8:11],s63 offen offset:0 sc1
 v_mfma_f32_16x16x32_bf16 v[188:191],a[152:155],a[56:59],v[188:191]
 ds_read_b64_tr_b16 a[150:151],v22 offset:26752
 v_mfma_f32_16x16x32_bf16 v[188:191],a[156:159],a[60:63],v[188:191]
 s_waitcnt lgkmcnt(4)
 v_mfma_f32_16x16x32_bf16 v[96:99],a[128:131],a[16:19],v[96:99]
 ds_read_b64_tr_b16 a[152:153],v22 offset:17760
 v_mfma_f32_16x16x32_bf16 v[96:99],a[132:135],a[20:23],v[96:99]
 buffer_load_dwordx4 v[16:19],v4,s[8:11],s63 offen offset:1024 sc1
 v_mfma_f32_16x16x32_bf16 v[100:103],a[128:131],a[24:27],v[100:103]
 ds_read_b64_tr_b16 a[154:155],v22 offset:18016
 v_mfma_f32_16x16x32_bf16 v[100:103],a[132:135],a[28:31],v[100:103]
 buffer_load_dwordx4 v9,s[32:35],s58 offen offset:1088 lds
 v_mfma_f32_16x16x32_bf16 v[104:107],a[128:131],a[48:51],v[104:107]
 ds_read_b64_tr_b16 a[156:157],v22 offset:26528
 v_mfma_f32_16x16x32_bf16 v[104:107],a[132:135],a[52:55],v[104:107]
 buffer_load_dwordx4 v[24:27],v4,s[8:11],s63 offen offset:2048 sc1
 v_mfma_f32_16x16x32_bf16 v[108:111],a[128:131],a[56:59],v[108:111]
 ds_read_b64_tr_b16 a[158:159],v22 offset:26784
 v_mfma_f32_16x16x32_bf16 v[108:111],a[132:135],a[60:63],v[108:111]
 s_waitcnt vmcnt(22)
 s_barrier
 v_mfma_f32_16x16x32_bf16 v[208:211],a[136:139],a[16:19],v[208:211]
 ds_read_b64_tr_b16 a[128:129],v22 offset:35072
 v_mfma_f32_16x16x32_bf16 v[208:211],a[140:143],a[20:23],v[208:211]
 buffer_load_dwordx4 v10,s[32:35],s58 offen offset:2176 lds
 v_mfma_f32_16x16x32_bf16 v[212:215],a[136:139],a[24:27],v[212:215]
 ds_read_b64_tr_b16 a[130:131],v22 offset:35328
 v_mfma_f32_16x16x32_bf16 v[212:215],a[140:143],a[28:31],v[212:215]
 buffer_load_dwordx4 v11,s[32:35],s58 offen offset:3264 lds
 v_mfma_f32_16x16x32_bf16 v[216:219],a[136:139],a[48:51],v[216:219]
 ds_read_b64_tr_b16 a[132:133],v22 offset:43840
 s_add_u32 s57,s57,8192
 v_mfma_f32_16x16x32_bf16 v[216:219],a[140:143],a[52:55],v[216:219]
 buffer_load_dwordx4 a[64:67],v4,s[8:11],s57 offen offset:0 sc1
 v_mfma_f32_16x16x32_bf16 v[220:223],a[136:139],a[56:59],v[220:223]
 ds_read_b64_tr_b16 a[134:135],v22 offset:44096
 v_mfma_f32_16x16x32_bf16 v[220:223],a[140:143],a[60:63],v[220:223]
 s_waitcnt lgkmcnt(4)
 v_mfma_f32_16x16x32_bf16 v[112:115],a[144:147],a[16:19],v[112:115]
 ds_read_b64_tr_b16 a[136:137],v22 offset:35104
 v_mfma_f32_16x16x32_bf16 v[112:115],a[148:151],a[20:23],v[112:115]
 buffer_load_dwordx4 a[68:71],v4,s[8:11],s57 offen offset:1024 sc1
 v_mfma_f32_16x16x32_bf16 v[116:119],a[144:147],a[24:27],v[116:119]
 ds_read_b64_tr_b16 a[138:139],v22 offset:35360
 v_mfma_f32_16x16x32_bf16 v[116:119],a[148:151],a[28:31],v[116:119]
 buffer_load_dwordx4 a[72:75],v4,s[8:11],s57 offen offset:2048 sc1
 v_mfma_f32_16x16x32_bf16 v[120:123],a[144:147],a[48:51],v[120:123]
 ds_read_b64_tr_b16 a[140:141],v22 offset:43872
 v_mfma_f32_16x16x32_bf16 v[120:123],a[148:151],a[52:55],v[120:123]
 buffer_load_dwordx4 a[76:79],v4,s[8:11],s57 offen offset:3072 sc1
 v_mfma_f32_16x16x32_bf16 v[124:127],a[144:147],a[56:59],v[124:127]
 ds_read_b64_tr_b16 a[142:143],v22 offset:44128
 v_mfma_f32_16x16x32_bf16 v[124:127],a[148:151],a[60:63],v[124:127]
 buffer_load_dwordx4 a[96:99],v5,s[8:11],s57 offen offset:0 sc1
 v_mfma_f32_16x16x32_bf16 v[240:243],a[152:155],a[16:19],v[240:243]
 ds_read_b64_tr_b16 a[144:145],v22 offset:35136
 v_mfma_f32_16x16x32_bf16 v[240:243],a[156:159],a[20:23],v[240:243]
 buffer_load_dwordx4 a[100:103],v5,s[8:11],s57 offen offset:1024 sc1
 v_mfma_f32_16x16x32_bf16 v[244:247],a[152:155],a[24:27],v[244:247]
 ds_read_b64_tr_b16 a[146:147],v22 offset:35392
 v_mfma_f32_16x16x32_bf16 v[244:247],a[156:159],a[28:31],v[244:247]
 buffer_load_dwordx4 a[104:107],v5,s[8:11],s57 offen offset:2048 sc1
 v_mfma_f32_16x16x32_bf16 v[248:251],a[152:155],a[48:51],v[248:251]
L_w22:
 s_cbranch_execz L_wret2
 ds_read_b64_tr_b16 a[148:149],v22 offset:43904
 v_mfma_f32_16x16x32_bf16 v[248:251],a[156:159],a[52:55],v[248:251]
 buffer_load_dwordx4 a[108:111],v5,s[8:11],s57 offen offset:3072 sc1
 v_mfma_f32_16x16x32_bf16 v[252:255],a[152:155],a[56:59],v[252:255]
 ds_read_b64_tr_b16 a[150:151],v22 offset:44160
 v_mfma_f32_16x16x32_bf16 v[252:255],a[156:159],a[60:63],v[252:255]
 s_waitcnt vmcnt(19)
 s_waitcnt lgkmcnt(4)
 v_mfma_f32_16x16x32_bf16 a[224:227],a[128:131],a[32:35],a[224:227]
 ds_read_b64_tr_b16 a[152:153],v22 offset:35168
 v_mfma_f32_16x16x32_bf16 a[224:227],a[132:135],a[36:39],a[224:227]
 s_xor_b32 s58,s74,1048576
 v_mfma_f32_16x16x32_bf16 a[228:231],a[128:131],a[40:43],a[228:231]
 ds_read_b64_tr_b16 a[154:155],v22 offset:35424
 s_add_u32 m0,s51,122752
 v_mfma_f32_16x16x32_bf16 a[228:231],a[132:135],a[44:47],a[228:231]
 buffer_load_dwordx4 v8,s[32:35],s58 offen offset:0 lds
 v_mfma_f32_16x16x32_bf16 a[232:235],a[128:131],a[240:243],a[232:235]
 ds_read_b64_tr_b16 a[156:157],v22 offset:43936
 v_mfma_f32_16x16x32_bf16 a[232:235],a[132:135],a[244:247],a[232:235]
 buffer_load_dwordx4 v[40:43],v4,s[8:11],s63 offen offset:3072 sc1
 v_mfma_f32_16x16x32_bf16 a[236:239],a[128:131],a[248:251],a[236:239]
 ds_read_b64_tr_b16 a[158:159],v22 offset:44192
 v_mfma_f32_16x16x32_bf16 a[236:239],a[132:135],a[252:255],a[236:239]
 buffer_load_dwordx4 v9,s[32:35],s58 offen offset:1088 lds
 v_mfma_f32_16x16x32_bf16 v[144:147],a[136:139],a[32:35],v[144:147]
 ds_read_b64_tr_b16 a[128:129],v22 offset:35200
 v_mfma_f32_16x16x32_bf16 v[144:147],a[140:143],a[36:39],v[144:147]
 v_mfma_f32_16x16x32_bf16 v[148:151],a[136:139],a[40:43],v[148:151]
 ds_read_b64_tr_b16 a[130:131],v22 offset:35456
 v_mfma_f32_16x16x32_bf16 v[148:151],a[140:143],a[44:47],v[148:151]
 v_mfma_f32_16x16x32_bf16 v[152:155],a[136:139],a[240:243],v[152:155]
 ds_read_b64_tr_b16 a[132:133],v22 offset:43968
 v_mfma_f32_16x16x32_bf16 v[152:155],a[140:143],a[244:247],v[152:155]
 buffer_load_dwordx4 v10,s[32:35],s58 offen offset:2176 lds
 v_mfma_f32_16x16x32_bf16 v[156:159],a[136:139],a[248:251],v[156:159]
 ds_read_b64_tr_b16 a[134:135],v22 offset:44224
 v_mfma_f32_16x16x32_bf16 v[156:159],a[140:143],a[252:255],v[156:159]
 s_waitcnt lgkmcnt(4)
 v_mfma_f32_16x16x32_bf16 v[80:83],a[144:147],a[32:35],v[80:83]
 ds_read_b64_tr_b16 a[136:137],v22 offset:35232
 v_mfma_f32_16x16x32_bf16 v[80:83],a[148:151],a[36:39],v[80:83]
 buffer_load_dwordx4 v11,s[32:35],s58 offen offset:3264 lds
 v_mfma_f32_16x16x32_bf16 v[84:87],a[144:147],a[40:43],v[84:87]
 ds_read_b64_tr_b16 a[138:139],v22 offset:35488
 v_cmp_eq_u32 vcc,0,v35
 s_nop 0
 s_cbranch_vccnz L_o2poll
L_o2poll_ret:
 v_mfma_f32_16x16x32_bf16 v[84:87],a[148:151],a[44:47],v[84:87]
 v_mfma_f32_16x16x32_bf16 v[88:91],a[144:147],a[240:243],v[88:91]
 ds_read_b64_tr_b16 a[140:141],v22 offset:44000
 s_xor_b32 s57,s72,65536
 v_mfma_f32_16x16x32_bf16 v[88:91],a[148:151],a[244:247],v[88:91]
 buffer_load_dwordx4 a[0:3],v4,s[8:11],s57 offen offset:0 sc1
 v_mfma_f32_16x16x32_bf16 v[92:95],a[144:147],a[248:251],v[92:95]
 ds_read_b64_tr_b16 a[142:143],v22 offset:44256
 v_mfma_f32_16x16x32_bf16 v[92:95],a[148:151],a[252:255],v[92:95]
 v_mfma_f32_16x16x32_bf16 v[176:179],a[152:155],a[32:35],v[176:179]
 ds_read_b64_tr_b16 a[144:145],v22 offset:35264
 v_mfma_f32_16x16x32_bf16 v[176:179],a[156:159],a[36:39],v[176:179]
 buffer_load_dwordx4 a[4:7],v4,s[8:11],s57 offen offset:1024 sc1
 v_mfma_f32_16x16x32_bf16 v[180:183],a[152:155],a[40:43],v[180:183]
 ds_read_b64_tr_b16 a[146:147],v22 offset:35520
 v_mfma_f32_16x16x32_bf16 v[180:183],a[156:159],a[44:47],v[180:183]
 v_mfma_f32_16x16x32_bf16 v[184:187],a[152:155],a[240:243],v[184:187]
 ds_read_b64_tr_b16 a[148:149],v22 offset:44032
 v_mfma_f32_16x16x32_bf16 v[184:187],a[156:159],a[244:247],v[184:187]
 v_mfma_f32_16x16x32_bf16 v[188:191],a[152:155],a[248:251],v[188:191]
 ds_read_b64_tr_b16 a[150:151],v22 offset:44288
 v_mfma_f32_16x16x32_bf16 v[188:191],a[156:159],a[252:255],v[188:191]
 s_waitcnt lgkmcnt(4)
 v_mfma_f32_16x16x32_bf16 v[96:99],a[128:131],a[32:35],v[96:99]
 ds_read_b64_tr_b16 a[152:153],v22 offset:35296
 v_mfma_f32_16x16x32_bf16 v[96:99],a[132:135],a[36:39],v[96:99]
 buffer_load_dwordx4 a[8:11],v4,s[8:11],s57 offen offset:2048 sc1
 v_mfma_f32_16x16x32_bf16 v[100:103],a[128:131],a[40:43],v[100:103]
 ds_read_b64_tr_b16 a[154:155],v22 offset:35552
 v_mfma_f32_16x16x32_bf16 v[100:103],a[132:135],a[44:47],v[100:103]
 buffer_load_dwordx4 a[12:15],v4,s[8:11],s57 offen offset:3072 sc1
 v_mfma_f32_16x16x32_bf16 v[104:107],a[128:131],a[240:243],v[104:107]
 ds_read_b64_tr_b16 a[156:157],v22 offset:44064
 v_mfma_f32_16x16x32_bf16 v[104:107],a[132:135],a[244:247],v[104:107]
 v_mfma_f32_16x16x32_bf16 v[108:111],a[128:131],a[248:251],v[108:111]
 ds_read_b64_tr_b16 a[158:159],v22 offset:44320
 v_mfma_f32_16x16x32_bf16 v[108:111],a[132:135],a[252:255],v[108:111]
 s_waitcnt vmcnt(17)
 s_barrier
 v_mfma_f32_16x16x32_bf16 v[208:211],a[136:139],a[32:35],v[208:211]
 ds_read_b64_tr_b16 a[128:129],v23 offset:0
 v_mfma_f32_16x16x32_bf16 v[208:211],a[140:143],a[36:39],v[208:211]
 buffer_load_dwordx4 v[160:163],v5,s[8:11],s57 offen offset:0 sc1
 v_mfma_f32_16x16x32_bf16 v[212:215],a[136:139],a[40:43],v[212:215]
 ds_read_b64_tr_b16 a[130:131],v23 offset:256
 v_mfma_f32_16x16x32_bf16 v[212:215],a[140:143],a[44:47],v[212:215]
 global_load_dword v31,v2,s[6:7]
 v_mfma_f32_16x16x32_bf16 v[216:219],a[136:139],a[240:243],v[216:219]
 ds_read_b64_tr_b16 a[132:133],v23 offset:8768
 v_mfma_f32_16x16x32_bf16 v[216:219],a[140:143],a[244:247],v[216:219]
 buffer_load_dwordx4 v[164:167],v5,s[8:11],s57 offen offset:1024 sc1
 v_mfma_f32_16x16x32_bf16 v[220:223],a[136:139],a[248:251],v[220:223]
 ds_read_b64_tr_b16 a[134:135],v23 offset:9024
 v_mfma_f32_16x16x32_bf16 v[220:223],a[140:143],a[252:255],v[220:223]
 s_waitcnt lgkmcnt(4)
 v_mfma_f32_16x16x32_bf16 v[112:115],a[144:147],a[32:35],v[112:115]
 ds_read_b64_tr_b16 a[136:137],v23 offset:32
 v_mfma_f32_16x16x32_bf16 v[112:115],a[148:151],a[36:39],v[112:115]
 buffer_load_dwordx4 v[168:171],v5,s[8:11],s57 offen offset:2048 sc1
 v_mfma_f32_16x16x32_bf16 v[116:119],a[144:147],a[40:43],v[116:119]
 ds_read_b64_tr_b16 a[138:139],v23 offset:288
 v_mfma_f32_16x16x32_bf16 v[116:119],a[148:151],a[44:47],v[116:119]
 v_mfma_f32_16x16x32_bf16 v[120:123],a[144:147],a[240:243],v[120:123]
 ds_read_b64_tr_b16 a[140:141],v23 offset:8800
 v_mfma_f32_16x16x32_bf16 v[120:123],a[148:151],a[244:247],v[120:123]
 v_mfma_f32_16x16x32_bf16 v[124:127],a[144:147],a[248:251],v[124:127]
 ds_read_b64_tr_b16 a[142:143],v23 offset:9056
 v_mfma_f32_16x16x32_bf16 v[124:127],a[148:151],a[252:255],v[124:127]
 buffer_load_dwordx4 v[172:175],v5,s[8:11],s57 offen offset:3072 sc1
 v_mfma_f32_16x16x32_bf16 v[240:243],a[152:155],a[32:35],v[240:243]
 ds_read_b64_tr_b16 a[144:145],v23 offset:64
 v_mfma_f32_16x16x32_bf16 v[240:243],a[156:159],a[36:39],v[240:243]
 s_add_u32 s58,s58,131072
 v_mfma_f32_16x16x32_bf16 v[244:247],a[152:155],a[40:43],v[244:247]
 ds_read_b64_tr_b16 a[146:147],v23 offset:320
 s_add_u32 m0,s51,52608
 v_mfma_f32_16x16x32_bf16 v[244:247],a[156:159],a[44:47],v[244:247]
 buffer_load_dwordx4 v8,s[32:35],s58 offen offset:0 lds
 v_mfma_f32_16x16x32_bf16 v[248:251],a[152:155],a[240:243],v[248:251]
 ds_read_b64_tr_b16 a[148:149],v23 offset:8832
 v_mfma_f32_16x16x32_bf16 v[248:251],a[156:159],a[244:247],v[248:251]
 v_mfma_f32_16x16x32_bf16 v[252:255],a[152:155],a[248:251],v[252:255]
 ds_read_b64_tr_b16 a[150:151],v23 offset:9088
 v_mfma_f32_16x16x32_bf16 v[252:255],a[156:159],a[252:255],v[252:255]
 s_waitcnt vmcnt(15)
 s_waitcnt lgkmcnt(4)
 v_mfma_f32_16x16x32_bf16 a[224:227],a[128:131],a[64:67],a[224:227]
 ds_read_b64_tr_b16 a[152:153],v23 offset:96
 s_waitcnt vmcnt(13)
 v_mfma_f32_16x16x32_bf16 a[224:227],a[132:135],a[68:71],a[224:227]
 buffer_load_dwordx4 v9,s[32:35],s58 offen offset:1088 lds
 v_mfma_f32_16x16x32_bf16 a[228:231],a[128:131],a[72:75],a[228:231]
 ds_read_b64_tr_b16 a[154:155],v23 offset:352
 v_lshlrev_b32 v28,16,v192
 v_mfma_f32_16x16x32_bf16 a[228:231],a[132:135],a[76:79],a[228:231]
 v_lshlrev_b32 v29,16,v193
 v_lshlrev_b32 v30,16,v194
 v_mfma_f32_16x16x32_bf16 a[232:235],a[128:131],a[96:99],a[232:235]
 ds_read_b64_tr_b16 a[156:157],v23 offset:8864
 v_lshlrev_b32 v60,16,v195
 v_mfma_f32_16x16x32_bf16 a[232:235],a[132:135],a[100:103],a[232:235]
 v_and_b32 v192,0xffff0000,v192
 v_and_b32 v193,0xffff0000,v193
 v_mfma_f32_16x16x32_bf16 a[236:239],a[128:131],a[104:107],a[236:239]
 ds_read_b64_tr_b16 a[158:159],v23 offset:9120
 v_and_b32 v194,0xffff0000,v194
 v_mfma_f32_16x16x32_bf16 a[236:239],a[132:135],a[108:111],a[236:239]
 buffer_load_dwordx4 v10,s[32:35],s58 offen offset:2176 lds
 v_mfma_f32_16x16x32_bf16 v[144:147],a[136:139],a[64:67],v[144:147]
 ds_read_b64_tr_b16 a[128:129],v23 offset:128
 v_and_b32 v195,0xffff0000,v195
 v_mfma_f32_16x16x32_bf16 v[144:147],a[140:143],a[68:71],v[144:147]
 v_add_f32 v128,v128,v28
 v_add_f32 v129,v129,v192
 v_mfma_f32_16x16x32_bf16 v[148:151],a[136:139],a[72:75],v[148:151]
 ds_read_b64_tr_b16 a[130:131],v23 offset:384
 v_add_f32 v130,v130,v29
 v_mfma_f32_16x16x32_bf16 v[148:151],a[140:143],a[76:79],v[148:151]
 v_add_f32 v131,v131,v193
 v_add_f32 v64,v64,v30
 v_mfma_f32_16x16x32_bf16 v[152:155],a[136:139],a[96:99],v[152:155]
 ds_read_b64_tr_b16 a[132:133],v23 offset:8896
 v_add_f32 v65,v65,v194
 v_mfma_f32_16x16x32_bf16 v[152:155],a[140:143],a[100:103],v[152:155]
 buffer_load_dwordx4 v11,s[32:35],s58 offen offset:3264 lds
 v_mfma_f32_16x16x32_bf16 v[156:159],a[136:139],a[104:107],v[156:159]
 ds_read_b64_tr_b16 a[134:135],v23 offset:9152
 v_add_f32 v66,v66,v60
 v_mfma_f32_16x16x32_bf16 v[156:159],a[140:143],a[108:111],v[156:159]
 v_add_f32 v67,v67,v195
 s_waitcnt lgkmcnt(4)
 v_mfma_f32_16x16x32_bf16 v[80:83],a[144:147],a[64:67],v[80:83]
 ds_read_b64_tr_b16 a[136:137],v23 offset:160
 s_add_u32 s57,s57,8192
 v_mfma_f32_16x16x32_bf16 v[80:83],a[148:151],a[68:71],v[80:83]
 buffer_load_dwordx4 a[80:83],v4,s[8:11],s57 offen offset:0 sc1
 v_mfma_f32_16x16x32_bf16 v[84:87],a[144:147],a[72:75],v[84:87]
 ds_read_b64_tr_b16 a[138:139],v23 offset:416
 v_lshlrev_b32 v61,16,v224
 v_mfma_f32_16x16x32_bf16 v[84:87],a[148:151],a[76:79],v[84:87]
 v_lshlrev_b32 v62,16,v225
 v_lshlrev_b32 v63,16,v226
 v_mfma_f32_16x16x32_bf16 v[88:91],a[144:147],a[96:99],v[88:91]
 ds_read_b64_tr_b16 a[140:141],v23 offset:8928
 v_lshlrev_b32 v28,16,v227
 v_mfma_f32_16x16x32_bf16 v[88:91],a[148:151],a[100:103],v[88:91]
 v_and_b32 v224,0xffff0000,v224
 v_and_b32 v225,0xffff0000,v225
 v_mfma_f32_16x16x32_bf16 v[92:95],a[144:147],a[104:107],v[92:95]
 ds_read_b64_tr_b16 a[142:143],v23 offset:9184
 v_and_b32 v226,0xffff0000,v226
 v_mfma_f32_16x16x32_bf16 v[92:95],a[148:151],a[108:111],v[92:95]
 v_and_b32 v227,0xffff0000,v227
 v_add_f32 v128,v128,v61
 v_mfma_f32_16x16x32_bf16 v[176:179],a[152:155],a[64:67],v[176:179]
 ds_read_b64_tr_b16 a[144:145],v23 offset:192
 v_add_f32 v129,v129,v224
 v_mfma_f32_16x16x32_bf16 v[176:179],a[156:159],a[68:71],v[176:179]
 v_add_f32 v130,v130,v62
 v_add_f32 v131,v131,v225
 v_mfma_f32_16x16x32_bf16 v[180:183],a[152:155],a[72:75],v[180:183]
 ds_read_b64_tr_b16 a[146:147],v23 offset:448
 v_add_f32 v64,v64,v63
 v_mfma_f32_16x16x32_bf16 v[180:183],a[156:159],a[76:79],v[180:183]
 v_add_f32 v65,v65,v226
 v_add_f32 v66,v66,v28
 v_mfma_f32_16x16x32_bf16 v[184:187],a[152:155],a[96:99],v[184:187]
 ds_read_b64_tr_b16 a[148:149],v23 offset:8960
 v_add_f32 v67,v67,v227
 v_mfma_f32_16x16x32_bf16 v[184:187],a[156:159],a[100:103],v[184:187]
 v_lshlrev_b32 v29,16,v12
 v_lshlrev_b32 v30,16,v13
 v_mfma_f32_16x16x32_bf16 v[188:191],a[152:155],a[104:107],v[188:191]
 ds_read_b64_tr_b16 a[150:151],v23 offset:9216
 v_lshlrev_b32 v60,16,v14
 v_mfma_f32_16x16x32_bf16 v[188:191],a[156:159],a[108:111],v[188:191]
 v_lshlrev_b32 v61,16,v15
 s_waitcnt lgkmcnt(4)
 v_mfma_f32_16x16x32_bf16 v[96:99],a[128:131],a[64:67],v[96:99]
 ds_read_b64_tr_b16 a[152:153],v23 offset:224
 v_and_b32 v12,0xffff0000,v12
 v_mfma_f32_16x16x32_bf16 v[96:99],a[132:135],a[68:71],v[96:99]
 v_and_b32 v13,0xffff0000,v13
 v_and_b32 v14,0xffff0000,v14
 v_mfma_f32_16x16x32_bf16 v[100:103],a[128:131],a[72:75],v[100:103]
 ds_read_b64_tr_b16 a[154:155],v23 offset:480
 v_and_b32 v15,0xffff0000,v15
 v_mfma_f32_16x16x32_bf16 v[100:103],a[132:135],a[76:79],v[100:103]
 v_add_f32 v128,v128,v29
 v_add_f32 v129,v129,v12
 v_mfma_f32_16x16x32_bf16 v[104:107],a[128:131],a[96:99],v[104:107]
 ds_read_b64_tr_b16 a[156:157],v23 offset:8992
 v_add_f32 v130,v130,v30
 v_mfma_f32_16x16x32_bf16 v[104:107],a[132:135],a[100:103],v[104:107]
 v_add_f32 v131,v131,v13
 v_add_f32 v64,v64,v60
 v_mfma_f32_16x16x32_bf16 v[108:111],a[128:131],a[104:107],v[108:111]
 ds_read_b64_tr_b16 a[158:159],v23 offset:9248
 v_add_f32 v65,v65,v14
 v_mfma_f32_16x16x32_bf16 v[108:111],a[132:135],a[108:111],v[108:111]
 s_waitcnt vmcnt(14)
 s_barrier
 v_mfma_f32_16x16x32_bf16 v[208:211],a[136:139],a[64:67],v[208:211]
 ds_read_b64_tr_b16 a[128:129],v23 offset:17536
 v_add_f32 v66,v66,v61
 v_mfma_f32_16x16x32_bf16 v[208:211],a[140:143],a[68:71],v[208:211]
 v_add_f32 v67,v67,v15
 v_cvt_pk_bf16_f32 v12,v128,v129
 v_mfma_f32_16x16x32_bf16 v[212:215],a[136:139],a[72:75],v[212:215]
 ds_read_b64_tr_b16 a[130:131],v23 offset:17792
 v_cvt_pk_bf16_f32 v13,v130,v131
 v_mfma_f32_16x16x32_bf16 v[212:215],a[140:143],a[76:79],v[212:215]
 v_cvt_pk_bf16_f32 v14,v64,v65
 v_cvt_pk_bf16_f32 v15,v66,v67
 v_mfma_f32_16x16x32_bf16 v[216:219],a[136:139],a[96:99],v[216:219]
 ds_read_b64_tr_b16 a[132:133],v23 offset:26304
 v_lshlrev_b32 v128,16,v12
 v_mfma_f32_16x16x32_bf16 v[216:219],a[140:143],a[100:103],v[216:219]
 buffer_load_dwordx4 a[84:87],v4,s[8:11],s57 offen offset:1024 sc1
 v_mfma_f32_16x16x32_bf16 v[220:223],a[136:139],a[104:107],v[220:223]
 ds_read_b64_tr_b16 a[134:135],v23 offset:26560
 v_and_b32 v129,0xffff0000,v12
 v_mfma_f32_16x16x32_bf16 v[220:223],a[140:143],a[108:111],v[220:223]
 v_lshlrev_b32 v130,16,v13
 s_waitcnt lgkmcnt(4)
 v_mfma_f32_16x16x32_bf16 v[112:115],a[144:147],a[64:67],v[112:115]
 ds_read_b64_tr_b16 a[136:137],v23 offset:17568
 v_and_b32 v131,0xffff0000,v13
 v_mfma_f32_16x16x32_bf16 v[112:115],a[148:151],a[68:71],v[112:115]
 buffer_load_dwordx4 a[88:91],v4,s[8:11],s57 offen offset:2048 sc1
 v_mfma_f32_16x16x32_bf16 v[116:119],a[144:147],a[72:75],v[116:119]
 ds_read_b64_tr_b16 a[138:139],v23 offset:17824
 v_lshlrev_b32 v64,16,v14
 v_mfma_f32_16x16x32_bf16 v[116:119],a[148:151],a[76:79],v[116:119]
 buffer_load_dwordx4 a[92:95],v4,s[8:11],s57 offen offset:3072 sc1
 v_mfma_f32_16x16x32_bf16 v[120:123],a[144:147],a[96:99],v[120:123]
 ds_read_b64_tr_b16 a[140:141],v23 offset:26336
 v_and_b32 v65,0xffff0000,v14
 v_mfma_f32_16x16x32_bf16 v[120:123],a[148:151],a[100:103],v[120:123]
 buffer_load_dwordx4 a[112:115],v5,s[8:11],s57 offen offset:0 sc1
 v_mfma_f32_16x16x32_bf16 v[124:127],a[144:147],a[104:107],v[124:127]
 ds_read_b64_tr_b16 a[142:143],v23 offset:26592
 v_lshlrev_b32 v66,16,v15
 v_mfma_f32_16x16x32_bf16 v[124:127],a[148:151],a[108:111],v[124:127]
 buffer_load_dwordx4 a[116:119],v5,s[8:11],s57 offen offset:1024 sc1
 v_mfma_f32_16x16x32_bf16 v[240:243],a[152:155],a[64:67],v[240:243]
 ds_read_b64_tr_b16 a[144:145],v23 offset:17600
 v_and_b32 v67,0xffff0000,v15
 v_mfma_f32_16x16x32_bf16 v[240:243],a[156:159],a[68:71],v[240:243]
 buffer_load_dwordx4 a[120:123],v5,s[8:11],s57 offen offset:2048 sc1
 v_mfma_f32_16x16x32_bf16 v[244:247],a[152:155],a[72:75],v[244:247]
 ds_read_b64_tr_b16 a[146:147],v23 offset:17856
 v_mul_f32 v192,0xbfb8aa3b,v128
 v_mfma_f32_16x16x32_bf16 v[244:247],a[156:159],a[76:79],v[244:247]
 buffer_load_dwordx4 a[124:127],v5,s[8:11],s57 offen offset:3072 sc1
 v_mfma_f32_16x16x32_bf16 v[248:251],a[152:155],a[96:99],v[248:251]
 ds_read_b64_tr_b16 a[148:149],v23 offset:26368
 v_mul_f32 v193,0xbfb8aa3b,v129
 v_mfma_f32_16x16x32_bf16 v[248:251],a[156:159],a[100:103],v[248:251]
 v_mul_f32 v194,0xbfb8aa3b,v130
 v_mul_f32 v195,0xbfb8aa3b,v131
 v_mfma_f32_16x16x32_bf16 v[252:255],a[152:155],a[104:107],v[252:255]
 ds_read_b64_tr_b16 a[150:151],v23 offset:26624
 s_add_u32 s58,s58,131072
 v_mfma_f32_16x16x32_bf16 v[252:255],a[156:159],a[108:111],v[252:255]
 s_waitcnt vmcnt(12)
 s_waitcnt lgkmcnt(4)
 v_mfma_f32_16x16x32_bf16 a[224:227],a[128:131],a[0:3],a[224:227]
 ds_read_b64_tr_b16 a[152:153],v23 offset:17632
 s_add_u32 m0,s51,140288
 v_mfma_f32_16x16x32_bf16 a[224:227],a[132:135],a[4:7],a[224:227]
 buffer_load_dwordx4 v8,s[32:35],s58 offen offset:0 lds
 v_mfma_f32_16x16x32_bf16 a[228:231],a[128:131],a[8:11],a[228:231]
 ds_read_b64_tr_b16 a[154:155],v23 offset:17888
 v_mul_f32 v224,0xbfb8aa3b,v64
 v_mfma_f32_16x16x32_bf16 a[228:231],a[132:135],a[12:15],a[228:231]
 v_mul_f32 v225,0xbfb8aa3b,v65
 v_mul_f32 v226,0xbfb8aa3b,v66
 v_mfma_f32_16x16x32_bf16 a[232:235],a[128:131],v[160:163],a[232:235]
 ds_read_b64_tr_b16 a[156:157],v23 offset:26400
 v_mul_f32 v227,0xbfb8aa3b,v67
 v_mfma_f32_16x16x32_bf16 a[232:235],a[132:135],v[164:167],a[232:235]
 buffer_load_dwordx4 v9,s[32:35],s58 offen offset:1088 lds
 v_mfma_f32_16x16x32_bf16 a[236:239],a[128:131],v[168:171],a[236:239]
 ds_read_b64_tr_b16 a[158:159],v23 offset:26656
 v_lshlrev_b32 v62,16,v196
 v_mfma_f32_16x16x32_bf16 a[236:239],a[132:135],v[172:175],a[236:239]
 v_exp_f32 v192,v192
 v_mfma_f32_16x16x32_bf16 v[144:147],a[136:139],a[0:3],v[144:147]
 ds_read_b64_tr_b16 a[128:129],v23 offset:17664
 v_add_f32 v192,1.0,v192
 v_mfma_f32_16x16x32_bf16 v[144:147],a[140:143],a[4:7],v[144:147]
 v_exp_f32 v193,v193
 v_mfma_f32_16x16x32_bf16 v[148:151],a[136:139],a[8:11],v[148:151]
 ds_read_b64_tr_b16 a[130:131],v23 offset:17920
 v_add_f32 v193,1.0,v193
 v_mfma_f32_16x16x32_bf16 v[148:151],a[140:143],a[12:15],v[148:151]
 buffer_load_dwordx4 v10,s[32:35],s58 offen offset:2176 lds
 v_mfma_f32_16x16x32_bf16 v[152:155],a[136:139],v[160:163],v[152:155]
 ds_read_b64_tr_b16 a[132:133],v23 offset:26432
 v_lshlrev_b32 v63,16,v197
 v_mfma_f32_16x16x32_bf16 v[152:155],a[140:143],v[164:167],v[152:155]
 v_exp_f32 v194,v194
 v_mfma_f32_16x16x32_bf16 v[156:159],a[136:139],v[168:171],v[156:159]
 ds_read_b64_tr_b16 a[134:135],v23 offset:26688
 v_add_f32 v194,1.0,v194
 v_mfma_f32_16x16x32_bf16 v[156:159],a[140:143],v[172:175],v[156:159]
 v_lshlrev_b32 v28,16,v198
 s_waitcnt lgkmcnt(4)
 v_mfma_f32_16x16x32_bf16 v[80:83],a[144:147],a[0:3],v[80:83]
 ds_read_b64_tr_b16 a[136:137],v23 offset:17696
 v_lshlrev_b32 v29,16,v199
 v_mfma_f32_16x16x32_bf16 v[80:83],a[148:151],a[4:7],v[80:83]
 buffer_load_dwordx4 v11,s[32:35],s58 offen offset:3264 lds
 v_mfma_f32_16x16x32_bf16 v[84:87],a[144:147],a[8:11],v[84:87]
 ds_read_b64_tr_b16 a[138:139],v23 offset:17952
 s_add_u32 s57,s57,8192
 v_mfma_f32_16x16x32_bf16 v[84:87],a[148:151],a[12:15],v[84:87]
 buffer_load_dwordx4 a[192:195],v4,s[8:11],s57 offen offset:0 sc1
 v_mfma_f32_16x16x32_bf16 v[88:91],a[144:147],v[160:163],v[88:91]
 ds_read_b64_tr_b16 a[140:141],v23 offset:26464
 v_and_b32 v196,0xffff0000,v196
 v_mfma_f32_16x16x32_bf16 v[88:91],a[148:151],v[164:167],v[88:91]
 v_exp_f32 v195,v195
 v_mfma_f32_16x16x32_bf16 v[92:95],a[144:147],v[168:171],v[92:95]
 ds_read_b64_tr_b16 a[142:143],v23 offset:26720
 v_add_f32 v195,1.0,v195
 v_mfma_f32_16x16x32_bf16 v[92:95],a[148:151],v[172:175],v[92:95]
 v_exp_f32 v224,v224
 v_mfma_f32_16x16x32_bf16 v[176:179],a[152:155],a[0:3],v[176:179]
 ds_read_b64_tr_b16 a[144:145],v23 offset:17728
 v_add_f32 v224,1.0,v224
 v_mfma_f32_16x16x32_bf16 v[176:179],a[156:159],a[4:7],v[176:179]
 buffer_load_dwordx4 a[196:199],v4,s[8:11],s57 offen offset:1024 sc1
 v_mfma_f32_16x16x32_bf16 v[180:183],a[152:155],a[8:11],v[180:183]
 ds_read_b64_tr_b16 a[146:147],v23 offset:17984
 v_and_b32 v197,0xffff0000,v197
 v_mfma_f32_16x16x32_bf16 v[180:183],a[156:159],a[12:15],v[180:183]
 v_exp_f32 v225,v225
 v_mfma_f32_16x16x32_bf16 v[184:187],a[152:155],v[160:163],v[184:187]
 ds_read_b64_tr_b16 a[148:149],v23 offset:26496
 v_add_f32 v225,1.0,v225
 v_mfma_f32_16x16x32_bf16 v[184:187],a[156:159],v[164:167],v[184:187]
 buffer_load_dwordx4 a[200:203],v4,s[8:11],s57 offen offset:2048 sc1
 v_mfma_f32_16x16x32_bf16 v[188:191],a[152:155],v[168:171],v[188:191]
 ds_read_b64_tr_b16 a[150:151],v23 offset:26752
 v_and_b32 v198,0xffff0000,v198
 v_mfma_f32_16x16x32_bf16 v[188:191],a[156:159],v[172:175],v[188:191]
 v_and_b32 v199,0xffff0000,v199
 s_waitcnt lgkmcnt(4)
 v_mfma_f32_16x16x32_bf16 v[96:99],a[128:131],a[0:3],v[96:99]
 ds_read_b64_tr_b16 a[152:153],v23 offset:17760
 v_add_f32 v132,v132,v62
 v_mfma_f32_16x16x32_bf16 v[96:99],a[132:135],a[4:7],v[96:99]
 buffer_load_dwordx4 a[204:207],v4,s[8:11],s57 offen offset:3072 sc1
 v_mfma_f32_16x16x32_bf16 v[100:103],a[128:131],a[8:11],v[100:103]
 ds_read_b64_tr_b16 a[154:155],v23 offset:18016
 v_add_f32 v133,v133,v196
 v_mfma_f32_16x16x32_bf16 v[100:103],a[132:135],a[12:15],v[100:103]
 buffer_load_dwordx4 a[208:211],v5,s[8:11],s57 offen offset:0 sc1
 v_mfma_f32_16x16x32_bf16 v[104:107],a[128:131],v[160:163],v[104:107]
 ds_read_b64_tr_b16 a[156:157],v23 offset:26528
 v_mfma_f32_16x16x32_bf16 v[104:107],a[132:135],v[164:167],v[104:107]
 buffer_load_dwordx4 a[212:215],v5,s[8:11],s57 offen offset:1024 sc1
 v_mfma_f32_16x16x32_bf16 v[108:111],a[128:131],v[168:171],v[108:111]
 ds_read_b64_tr_b16 a[158:159],v23 offset:26784
 v_mfma_f32_16x16x32_bf16 v[108:111],a[132:135],v[172:175],v[108:111]
 s_waitcnt vmcnt(18)
 s_barrier
 v_mfma_f32_16x16x32_bf16 v[208:211],a[136:139],a[0:3],v[208:211]
 ds_read_b64_tr_b16 a[128:129],v22 offset:64
 v_mfma_f32_16x16x32_bf16 v[208:211],a[140:143],a[4:7],v[208:211]
 buffer_load_dwordx4 a[216:219],v5,s[8:11],s57 offen offset:2048 sc1
 v_mfma_f32_16x16x32_bf16 v[212:215],a[136:139],a[8:11],v[212:215]
 ds_read_b64_tr_b16 a[130:131],v22 offset:320
 v_mfma_f32_16x16x32_bf16 v[212:215],a[140:143],a[12:15],v[212:215]
 buffer_load_dwordx4 a[220:223],v5,s[8:11],s57 offen offset:3072 sc1
 v_mfma_f32_16x16x32_bf16 v[216:219],a[136:139],v[160:163],v[216:219]
 ds_read_b64_tr_b16 a[132:133],v22 offset:8832
 v_mfma_f32_16x16x32_bf16 v[216:219],a[140:143],v[164:167],v[216:219]
 v_exp_f32 v226,v226
 v_mfma_f32_16x16x32_bf16 v[220:223],a[136:139],v[168:171],v[220:223]
 ds_read_b64_tr_b16 a[134:135],v22 offset:9088
 v_add_f32 v226,1.0,v226
 v_mfma_f32_16x16x32_bf16 v[220:223],a[140:143],v[172:175],v[220:223]
 s_add_u32 s58,s58,131072
 s_waitcnt lgkmcnt(4)
 v_mfma_f32_16x16x32_bf16 v[112:115],a[144:147],a[0:3],v[112:115]
 ds_read_b64_tr_b16 a[136:137],v22 offset:96
 s_add_u32 m0,s51,0
 v_mfma_f32_16x16x32_bf16 v[112:115],a[148:151],a[4:7],v[112:115]
 buffer_load_dwordx4 v8,s[32:35],s58 offen offset:0 lds
 v_mfma_f32_16x16x32_bf16 v[116:119],a[144:147],a[8:11],v[116:119]
 ds_read_b64_tr_b16 a[138:139],v22 offset:352
 v_add_f32 v134,v134,v63
 v_mfma_f32_16x16x32_bf16 v[116:119],a[148:151],a[12:15],v[116:119]
 v_exp_f32 v227,v227
 v_mfma_f32_16x16x32_bf16 v[120:123],a[144:147],v[160:163],v[120:123]
 ds_read_b64_tr_b16 a[140:141],v22 offset:8864
 v_add_f32 v227,1.0,v227
 v_mfma_f32_16x16x32_bf16 v[120:123],a[148:151],v[164:167],v[120:123]
 v_rcp_f32 v192,v192
 v_mfma_f32_16x16x32_bf16 v[124:127],a[144:147],v[168:171],v[124:127]
 ds_read_b64_tr_b16 a[142:143],v22 offset:9120
 v_mul_f32 v128,v128,v192
 v_mfma_f32_16x16x32_bf16 v[124:127],a[148:151],v[172:175],v[124:127]
 buffer_load_dwordx4 v9,s[32:35],s58 offen offset:1088 lds
 v_mfma_f32_16x16x32_bf16 v[240:243],a[152:155],a[0:3],v[240:243]
 ds_read_b64_tr_b16 a[144:145],v22 offset:128
 v_add_f32 v135,v135,v197
 v_mfma_f32_16x16x32_bf16 v[240:243],a[156:159],a[4:7],v[240:243]
 v_rcp_f32 v193,v193
 v_mfma_f32_16x16x32_bf16 v[244:247],a[152:155],a[8:11],v[244:247]
 ds_read_b64_tr_b16 a[146:147],v22 offset:384
 v_mul_f32 v129,v129,v193
 v_mfma_f32_16x16x32_bf16 v[244:247],a[156:159],a[12:15],v[244:247]
 buffer_load_dwordx4 v10,s[32:35],s58 offen offset:2176 lds
 v_mfma_f32_16x16x32_bf16 v[248:251],a[152:155],v[160:163],v[248:251]
 ds_read_b64_tr_b16 a[148:149],v22 offset:8896
 v_cvt_pk_bf16_f32 v12,v128,v129
 v_mfma_f32_16x16x32_bf16 v[248:251],a[156:159],v[164:167],v[248:251]
 v_rcp_f32 v194,v194
 v_mfma_f32_16x16x32_bf16 v[252:255],a[152:155],v[168:171],v[252:255]
 ds_read_b64_tr_b16 a[150:151],v22 offset:9152
 v_mul_f32 v130,v130,v194
 v_mfma_f32_16x16x32_bf16 v[252:255],a[156:159],v[172:175],v[252:255]
 s_waitcnt vmcnt(15)
 s_waitcnt lgkmcnt(4)
 v_mfma_f32_16x16x32_bf16 v[80:83],a[128:131],a[80:83],v[80:83]
 ds_read_b64_tr_b16 a[152:153],v22 offset:160
 v_lshlrev_b32 v128,16,v12
 v_mfma_f32_16x16x32_bf16 v[80:83],a[132:135],a[84:87],v[80:83]
 buffer_load_dwordx4 v11,s[32:35],s58 offen offset:3264 lds
 v_mfma_f32_16x16x32_bf16 v[84:87],a[128:131],a[88:91],v[84:87]
 ds_read_b64_tr_b16 a[154:155],v22 offset:416
 v_and_b32 v129,0xffff0000,v12
 v_mfma_f32_16x16x32_bf16 v[84:87],a[132:135],a[92:95],v[84:87]
 v_rcp_f32 v195,v195
 v_mfma_f32_16x16x32_bf16 v[88:91],a[128:131],a[112:115],v[88:91]
 ds_read_b64_tr_b16 a[156:157],v22 offset:8928
 s_add_u32 s57,s57,8192
 v_mfma_f32_16x16x32_bf16 v[88:91],a[132:135],a[116:119],v[88:91]
 buffer_load_dwordx4 a[160:163],v4,s[8:11],s57 offen offset:0 sc1
 v_mfma_f32_16x16x32_bf16 v[92:95],a[128:131],a[120:123],v[92:95]
 ds_read_b64_tr_b16 a[158:159],v22 offset:9184
 v_mul_f32 v131,v131,v195
 v_mfma_f32_16x16x32_bf16 v[92:95],a[132:135],a[124:127],v[92:95]
 v_rcp_f32 v224,v224
 v_mfma_f32_16x16x32_bf16 v[176:179],a[136:139],a[80:83],v[176:179]
 ds_read_b64_tr_b16 a[128:129],v22 offset:192
 v_mul_f32 v64,v64,v224
 v_mfma_f32_16x16x32_bf16 v[176:179],a[140:143],a[84:87],v[176:179]
 buffer_load_dwordx4 a[164:167],v4,s[8:11],s57 offen offset:1024 sc1
 v_mfma_f32_16x16x32_bf16 v[180:183],a[136:139],a[88:91],v[180:183]
 ds_read_b64_tr_b16 a[130:131],v22 offset:448
 v_cvt_pk_bf16_f32 v13,v130,v131
 v_mfma_f32_16x16x32_bf16 v[180:183],a[140:143],a[92:95],v[180:183]
 v_rcp_f32 v225,v225
 v_mfma_f32_16x16x32_bf16 v[184:187],a[136:139],a[112:115],v[184:187]
 ds_read_b64_tr_b16 a[132:133],v22 offset:8960
 v_mul_f32 v65,v65,v225
 v_mfma_f32_16x16x32_bf16 v[184:187],a[140:143],a[116:119],v[184:187]
 v_rcp_f32 v226,v226
 v_mfma_f32_16x16x32_bf16 v[188:191],a[136:139],a[120:123],v[188:191]
 ds_read_b64_tr_b16 a[134:135],v22 offset:9216
 v_mul_f32 v66,v66,v226
 v_mfma_f32_16x16x32_bf16 v[188:191],a[140:143],a[124:127],v[188:191]
 v_cvt_pk_bf16_f32 v14,v64,v65
 s_waitcnt lgkmcnt(4)
 v_mfma_f32_16x16x32_bf16 v[96:99],a[144:147],a[80:83],v[96:99]
 ds_read_b64_tr_b16 a[136:137],v22 offset:224
 v_lshlrev_b32 v130,16,v13
 v_mfma_f32_16x16x32_bf16 v[96:99],a[148:151],a[84:87],v[96:99]
 buffer_load_dwordx4 a[168:171],v4,s[8:11],s57 offen offset:2048 sc1
 v_mfma_f32_16x16x32_bf16 v[100:103],a[144:147],a[88:91],v[100:103]
 ds_read_b64_tr_b16 a[138:139],v22 offset:480
 v_and_b32 v131,0xffff0000,v13
 v_mfma_f32_16x16x32_bf16 v[100:103],a[148:151],a[92:95],v[100:103]
 buffer_load_dwordx4 a[172:175],v4,s[8:11],s57 offen offset:3072 sc1
 v_mfma_f32_16x16x32_bf16 v[104:107],a[144:147],a[112:115],v[104:107]
 ds_read_b64_tr_b16 a[140:141],v22 offset:8992
 v_lshlrev_b32 v64,16,v14
 v_mfma_f32_16x16x32_bf16 v[104:107],a[148:151],a[116:119],v[104:107]
 buffer_load_dwordx4 a[176:179],v5,s[8:11],s57 offen offset:0 sc1
 v_mfma_f32_16x16x32_bf16 v[108:111],a[144:147],a[120:123],v[108:111]
 ds_read_b64_tr_b16 a[142:143],v22 offset:9248
 v_and_b32 v65,0xffff0000,v14
 v_mfma_f32_16x16x32_bf16 v[108:111],a[148:151],a[124:127],v[108:111]
 s_waitcnt vmcnt(17)
 s_barrier
 v_mfma_f32_16x16x32_bf16 v[208:211],a[152:155],a[80:83],v[208:211]
 ds_read_b64_tr_b16 a[144:145],v23 offset:35136
 v_add_f32 v68,v68,v28
 v_mfma_f32_16x16x32_bf16 v[208:211],a[156:159],a[84:87],v[208:211]
 buffer_load_dwordx4 a[180:183],v5,s[8:11],s57 offen offset:1024 sc1
 v_mfma_f32_16x16x32_bf16 v[212:215],a[152:155],a[88:91],v[212:215]
 ds_read_b64_tr_b16 a[146:147],v23 offset:35392
 v_add_f32 v69,v69,v198
 v_mfma_f32_16x16x32_bf16 v[212:215],a[156:159],a[92:95],v[212:215]
 buffer_load_dwordx4 a[184:187],v5,s[8:11],s57 offen offset:2048 sc1
 v_mfma_f32_16x16x32_bf16 v[216:219],a[152:155],a[112:115],v[216:219]
 ds_read_b64_tr_b16 a[148:149],v23 offset:43904
 v_add_f32 v70,v70,v29
 v_mfma_f32_16x16x32_bf16 v[216:219],a[156:159],a[116:119],v[216:219]
 buffer_load_dwordx4 a[188:191],v5,s[8:11],s57 offen offset:3072 sc1
 v_mfma_f32_16x16x32_bf16 v[220:223],a[152:155],a[120:123],v[220:223]
 ds_read_b64_tr_b16 a[150:151],v23 offset:44160
 v_add_f32 v71,v71,v199
 v_mfma_f32_16x16x32_bf16 v[220:223],a[156:159],a[124:127],v[220:223]
 v_lshlrev_b32 v30,16,v228
 s_waitcnt lgkmcnt(4)
 v_mfma_f32_16x16x32_bf16 v[112:115],a[128:131],a[80:83],v[112:115]
 ds_read_b64_tr_b16 a[152:153],v23 offset:35168
 v_lshlrev_b32 v60,16,v229
 v_mfma_f32_16x16x32_bf16 v[112:115],a[132:135],a[84:87],v[112:115]
 s_add_u32 s58,s58,131072
 v_lshlrev_b32 v61,16,v230
 v_mfma_f32_16x16x32_bf16 v[116:119],a[128:131],a[88:91],v[116:119]
 ds_read_b64_tr_b16 a[154:155],v23 offset:35424
 s_add_u32 m0,s51,35072
 v_mfma_f32_16x16x32_bf16 v[116:119],a[132:135],a[92:95],v[116:119]
 buffer_load_dwordx4 v8,s[32:35],s58 offen offset:0 lds
 v_mfma_f32_16x16x32_bf16 v[120:123],a[128:131],a[112:115],v[120:123]
L_w23:
 s_cbranch_execz L_wret2
 ds_read_b64_tr_b16 a[156:157],v23 offset:43936
 v_lshlrev_b32 v62,16,v231
 v_mfma_f32_16x16x32_bf16 v[120:123],a[132:135],a[116:119],v[120:123]
 v_rcp_f32 v227,v227
 v_mfma_f32_16x16x32_bf16 v[124:127],a[128:131],a[120:123],v[124:127]
 ds_read_b64_tr_b16 a[158:159],v23 offset:44192
 v_mul_f32 v67,v67,v227
 v_mfma_f32_16x16x32_bf16 v[124:127],a[132:135],a[124:127],v[124:127]
 v_cvt_pk_bf16_f32 v15,v66,v67
 v_and_b32 v228,0xffff0000,v228
 v_mfma_f32_16x16x32_bf16 v[240:243],a[136:139],a[80:83],v[240:243]
 ds_read_b64_tr_b16 a[128:129],v23 offset:35200
 v_lshlrev_b32 v66,16,v15
 v_mfma_f32_16x16x32_bf16 v[240:243],a[140:143],a[84:87],v[240:243]
 buffer_load_dwordx4 v9,s[32:35],s58 offen offset:1088 lds
 v_mfma_f32_16x16x32_bf16 v[244:247],a[136:139],a[88:91],v[244:247]
 ds_read_b64_tr_b16 a[130:131],v23 offset:35456
 v_and_b32 v67,0xffff0000,v15
 v_mfma_f32_16x16x32_bf16 v[244:247],a[140:143],a[92:95],v[244:247]
 v_and_b32 v229,0xffff0000,v229
 v_and_b32 v230,0xffff0000,v230
 v_mfma_f32_16x16x32_bf16 v[248:251],a[136:139],a[112:115],v[248:251]
 ds_read_b64_tr_b16 a[132:133],v23 offset:43968
 v_and_b32 v231,0xffff0000,v231
 v_mfma_f32_16x16x32_bf16 v[248:251],a[140:143],a[116:119],v[248:251]
 v_add_f32 v132,v132,v30
 v_add_f32 v133,v133,v228
 v_mfma_f32_16x16x32_bf16 v[252:255],a[136:139],a[120:123],v[252:255]
 ds_read_b64_tr_b16 a[134:135],v23 offset:44224
 v_add_f32 v134,v134,v60
 v_mfma_f32_16x16x32_bf16 v[252:255],a[140:143],a[124:127],v[252:255]
 s_waitcnt vmcnt(14)
 s_waitcnt lgkmcnt(4)
 v_mfma_f32_16x16x32_bf16 v[80:83],a[144:147],a[192:195],v[80:83]
 ds_read_b64_tr_b16 a[136:137],v23 offset:35232
 v_add_f32 v135,v135,v229
 v_mfma_f32_16x16x32_bf16 v[80:83],a[148:151],a[196:199],v[80:83]
 buffer_load_dwordx4 v10,s[32:35],s58 offen offset:2176 lds
 v_mfma_f32_16x16x32_bf16 v[84:87],a[144:147],a[200:203],v[84:87]
 ds_read_b64_tr_b16 a[138:139],v23 offset:35488
 v_add_f32 v68,v68,v61
 v_mfma_f32_16x16x32_bf16 v[84:87],a[148:151],a[204:207],v[84:87]
 buffer_load_dwordx4 v11,s[32:35],s58 offen offset:3264 lds
 v_mfma_f32_16x16x32_bf16 v[88:91],a[144:147],a[208:211],v[88:91]
 ds_read_b64_tr_b16 a[140:141],v23 offset:44000
 v_add_f32 v69,v69,v230
 v_mfma_f32_16x16x32_bf16 v[88:91],a[148:151],a[212:215],v[88:91]
 v_add_f32 v70,v70,v62
 v_add_f32 v71,v71,v231
 v_mfma_f32_16x16x32_bf16 v[92:95],a[144:147],a[216:219],v[92:95]
 ds_read_b64_tr_b16 a[142:143],v23 offset:44256
 v_lshlrev_b32 v63,16,v16
 v_mfma_f32_16x16x32_bf16 v[92:95],a[148:151],a[220:223],v[92:95]
 s_add_u32 s58,s58,131072
 v_lshlrev_b32 v28,16,v17
 v_mfma_f32_16x16x32_bf16 v[176:179],a[152:155],a[192:195],v[176:179]
 ds_read_b64_tr_b16 a[144:145],v23 offset:35264
 s_add_u32 m0,s51,17536
 v_mfma_f32_16x16x32_bf16 v[176:179],a[156:159],a[196:199],v[176:179]
 buffer_load_dwordx4 v8,s[32:35],s58 offen offset:0 lds
 v_mfma_f32_16x16x32_bf16 v[180:183],a[152:155],a[200:203],v[180:183]
 ds_read_b64_tr_b16 a[146:147],v23 offset:35520
 v_lshlrev_b32 v29,16,v18
 v_mfma_f32_16x16x32_bf16 v[180:183],a[156:159],a[204:207],v[180:183]
 v_lshlrev_b32 v30,16,v19
 v_and_b32 v16,0xffff0000,v16
 v_mfma_f32_16x16x32_bf16 v[184:187],a[152:155],a[208:211],v[184:187]
 ds_read_b64_tr_b16 a[148:149],v23 offset:44032
 v_and_b32 v17,0xffff0000,v17
 v_mfma_f32_16x16x32_bf16 v[184:187],a[156:159],a[212:215],v[184:187]
 buffer_load_dwordx4 v9,s[32:35],s58 offen offset:1088 lds
 v_mfma_f32_16x16x32_bf16 v[188:191],a[152:155],a[216:219],v[188:191]
 ds_read_b64_tr_b16 a[150:151],v23 offset:44288
 v_and_b32 v18,0xffff0000,v18
 v_mfma_f32_16x16x32_bf16 v[188:191],a[156:159],a[220:223],v[188:191]
 v_and_b32 v19,0xffff0000,v19
 s_waitcnt lgkmcnt(4)
 v_mfma_f32_16x16x32_bf16 v[96:99],a[128:131],a[192:195],v[96:99]
 ds_read_b64_tr_b16 a[152:153],v23 offset:35296
 v_add_f32 v132,v132,v63
 v_mfma_f32_16x16x32_bf16 v[96:99],a[132:135],a[196:199],v[96:99]
 buffer_load_dwordx4 v10,s[32:35],s58 offen offset:2176 lds
 v_mfma_f32_16x16x32_bf16 v[100:103],a[128:131],a[200:203],v[100:103]
 ds_read_b64_tr_b16 a[154:155],v23 offset:35552
 v_add_f32 v133,v133,v16
 v_mfma_f32_16x16x32_bf16 v[100:103],a[132:135],a[204:207],v[100:103]
 buffer_load_dwordx4 v11,s[32:35],s58 offen offset:3264 lds
 v_mfma_f32_16x16x32_bf16 v[104:107],a[128:131],a[208:211],v[104:107]
 ds_read_b64_tr_b16 a[156:157],v23 offset:44064
 s_add_u32 s57,s57,8192
 v_mfma_f32_16x16x32_bf16 v[104:107],a[132:135],a[212:215],v[104:107]
 buffer_load_dwordx4 a[16:19],v4,s[8:11],s57 offen offset:0 sc1
 v_mfma_f32_16x16x32_bf16 v[108:111],a[128:131],a[216:219],v[108:111]
 ds_read_b64_tr_b16 a[158:159],v23 offset:44320
 v_add_f32 v134,v134,v28
 v_mfma_f32_16x16x32_bf16 v[108:111],a[132:135],a[220:223],v[108:111]
 s_waitcnt vmcnt(17)
 s_barrier
 v_mfma_f32_16x16x32_bf16 v[208:211],a[136:139],a[192:195],v[208:211]
 ds_read_b64_tr_b16 a[128:129],v21 offset:64
 v_add_f32 v135,v135,v17
 v_mfma_f32_16x16x32_bf16 v[208:211],a[140:143],a[196:199],v[208:211]
 buffer_load_dwordx4 a[20:23],v4,s[8:11],s57 offen offset:1024 sc1
 v_mfma_f32_16x16x32_bf16 v[212:215],a[136:139],a[200:203],v[212:215]
 ds_read_b64_tr_b16 a[130:131],v21 offset:320
 v_add_f32 v68,v68,v29
 v_mfma_f32_16x16x32_bf16 v[212:215],a[140:143],a[204:207],v[212:215]
 buffer_load_dwordx4 a[24:27],v4,s[8:11],s57 offen offset:2048 sc1
 v_mfma_f32_16x16x32_bf16 v[216:219],a[136:139],a[208:211],v[216:219]
 ds_read_b64_tr_b16 a[132:133],v21 offset:8832
 v_add_f32 v69,v69,v18
 v_mfma_f32_16x16x32_bf16 v[216:219],a[140:143],a[212:215],v[216:219]
 buffer_load_dwordx4 a[28:31],v4,s[8:11],s57 offen offset:3072 sc1
 v_mfma_f32_16x16x32_bf16 v[220:223],a[136:139],a[216:219],v[220:223]
 ds_read_b64_tr_b16 a[134:135],v21 offset:9088
 v_add_f32 v70,v70,v30
 v_mfma_f32_16x16x32_bf16 v[220:223],a[140:143],a[220:223],v[220:223]
 v_add_f32 v71,v71,v19
 s_waitcnt lgkmcnt(4)
 v_mfma_f32_16x16x32_bf16 v[112:115],a[144:147],a[192:195],v[112:115]
 ds_read_b64_tr_b16 a[136:137],v21 offset:96
 v_cvt_pk_bf16_f32 v16,v132,v133
 v_mfma_f32_16x16x32_bf16 v[112:115],a[148:151],a[196:199],v[112:115]
 buffer_load_dwordx4 a[48:51],v5,s[8:11],s57 offen offset:0 sc1
 v_mfma_f32_16x16x32_bf16 v[116:119],a[144:147],a[200:203],v[116:119]
 ds_read_b64_tr_b16 a[138:139],v21 offset:352
 v_cvt_pk_bf16_f32 v17,v134,v135
 v_mfma_f32_16x16x32_bf16 v[116:119],a[148:151],a[204:207],v[116:119]
 buffer_load_dwordx4 a[52:55],v5,s[8:11],s57 offen offset:1024 sc1
 v_mfma_f32_16x16x32_bf16 v[120:123],a[144:147],a[208:211],v[120:123]
 ds_read_b64_tr_b16 a[140:141],v21 offset:8864
 v_cvt_pk_bf16_f32 v18,v68,v69
 v_mfma_f32_16x16x32_bf16 v[120:123],a[148:151],a[212:215],v[120:123]
 buffer_load_dwordx4 a[56:59],v5,s[8:11],s57 offen offset:2048 sc1
 v_mfma_f32_16x16x32_bf16 v[124:127],a[144:147],a[216:219],v[124:127]
 ds_read_b64_tr_b16 a[142:143],v21 offset:9120
 s_add_u32 s58,s58,131072
 v_mfma_f32_16x16x32_bf16 v[124:127],a[148:151],a[220:223],v[124:127]
 buffer_load_dwordx4 a[60:63],v5,s[8:11],s57 offen offset:3072 sc1
 v_mfma_f32_16x16x32_bf16 v[240:243],a[152:155],a[192:195],v[240:243]
 ds_read_b64_tr_b16 a[144:145],v21 offset:128
 s_add_u32 m0,s51,70144
 v_mfma_f32_16x16x32_bf16 v[240:243],a[156:159],a[196:199],v[240:243]
 buffer_load_dwordx4 v8,s[32:35],s58 offen offset:0 lds
 v_mfma_f32_16x16x32_bf16 v[244:247],a[152:155],a[200:203],v[244:247]
 ds_read_b64_tr_b16 a[146:147],v21 offset:384
 v_cvt_pk_bf16_f32 v19,v70,v71
 v_mfma_f32_16x16x32_bf16 v[244:247],a[156:159],a[204:207],v[244:247]
 buffer_load_dwordx4 v9,s[32:35],s58 offen offset:1088 lds
 v_mfma_f32_16x16x32_bf16 v[248:251],a[152:155],a[208:211],v[248:251]
 ds_read_b64_tr_b16 a[148:149],v21 offset:8896
 v_lshlrev_b32 v132,16,v16
 v_mfma_f32_16x16x32_bf16 v[248:251],a[156:159],a[212:215],v[248:251]
 buffer_load_dwordx4 v10,s[32:35],s58 offen offset:2176 lds
 v_mfma_f32_16x16x32_bf16 v[252:255],a[152:155],a[216:219],v[252:255]
 ds_read_b64_tr_b16 a[150:151],v21 offset:9152
 v_and_b32 v133,0xffff0000,v16
 v_mfma_f32_16x16x32_bf16 v[252:255],a[156:159],a[220:223],v[252:255]
 s_waitcnt vmcnt(19)
 s_waitcnt lgkmcnt(4)
 v_mfma_f32_16x16x32_bf16 v[80:83],a[128:131],a[160:163],v[80:83]
 ds_read_b64_tr_b16 a[152:153],v21 offset:160
 v_lshlrev_b32 v134,16,v17
 v_mfma_f32_16x16x32_bf16 v[80:83],a[132:135],a[164:167],v[80:83]
 buffer_load_dwordx4 v11,s[32:35],s58 offen offset:3264 lds
 v_mfma_f32_16x16x32_bf16 v[84:87],a[128:131],a[168:171],v[84:87]
 ds_read_b64_tr_b16 a[154:155],v21 offset:416
 s_add_u32 s57,s57,8192
 v_mfma_f32_16x16x32_bf16 v[84:87],a[132:135],a[172:175],v[84:87]
 buffer_load_dwordx4 a[32:35],v4,s[8:11],s57 offen offset:0 sc1
 v_mfma_f32_16x16x32_bf16 v[88:91],a[128:131],a[176:179],v[88:91]
 ds_read_b64_tr_b16 a[156:157],v21 offset:8928
 v_and_b32 v135,0xffff0000,v17
 v_mfma_f32_16x16x32_bf16 v[88:91],a[132:135],a[180:183],v[88:91]
 buffer_load_dwordx4 a[36:39],v4,s[8:11],s57 offen offset:1024 sc1
 v_mfma_f32_16x16x32_bf16 v[92:95],a[128:131],a[184:187],v[92:95]
 ds_read_b64_tr_b16 a[158:159],v21 offset:9184
 v_lshlrev_b32 v68,16,v18
 v_mfma_f32_16x16x32_bf16 v[92:95],a[132:135],a[188:191],v[92:95]
 buffer_load_dwordx4 a[40:43],v4,s[8:11],s57 offen offset:2048 sc1
 v_mfma_f32_16x16x32_bf16 v[176:179],a[136:139],a[160:163],v[176:179]
 ds_read_b64_tr_b16 a[128:129],v21 offset:192
 v_and_b32 v69,0xffff0000,v18
 v_mfma_f32_16x16x32_bf16 v[176:179],a[140:143],a[164:167],v[176:179]
 buffer_load_dwordx4 a[44:47],v4,s[8:11],s57 offen offset:3072 sc1
 v_mfma_f32_16x16x32_bf16 v[180:183],a[136:139],a[168:171],v[180:183]
 ds_read_b64_tr_b16 a[130:131],v21 offset:448
 v_lshlrev_b32 v70,16,v19
 v_mfma_f32_16x16x32_bf16 v[180:183],a[140:143],a[172:175],v[180:183]
 buffer_load_dwordx4 a[240:243],v5,s[8:11],s57 offen offset:0 sc1
 v_mfma_f32_16x16x32_bf16 v[184:187],a[136:139],a[176:179],v[184:187]
 ds_read_b64_tr_b16 a[132:133],v21 offset:8960
 v_and_b32 v71,0xffff0000,v19
 v_mfma_f32_16x16x32_bf16 v[184:187],a[140:143],a[180:183],v[184:187]
 buffer_load_dwordx4 a[244:247],v5,s[8:11],s57 offen offset:1024 sc1
 v_mfma_f32_16x16x32_bf16 v[188:191],a[136:139],a[184:187],v[188:191]
 ds_read_b64_tr_b16 a[134:135],v21 offset:9216
 v_mul_f32 v196,0xbfb8aa3b,v132
 v_mfma_f32_16x16x32_bf16 v[188:191],a[140:143],a[188:191],v[188:191]
 v_mul_f32 v197,0xbfb8aa3b,v133
 s_waitcnt lgkmcnt(4)
 v_mfma_f32_16x16x32_bf16 v[96:99],a[144:147],a[160:163],v[96:99]
 ds_read_b64_tr_b16 a[136:137],v21 offset:224
 v_mul_f32 v198,0xbfb8aa3b,v134
 v_mfma_f32_16x16x32_bf16 v[96:99],a[148:151],a[164:167],v[96:99]
 buffer_load_dwordx4 a[248:251],v5,s[8:11],s57 offen offset:2048 sc1
 v_mfma_f32_16x16x32_bf16 v[100:103],a[144:147],a[168:171],v[100:103]
 ds_read_b64_tr_b16 a[138:139],v21 offset:480
 s_add_u32 s58,s58,131072
 v_mfma_f32_16x16x32_bf16 v[100:103],a[148:151],a[172:175],v[100:103]
 buffer_load_dwordx4 a[252:255],v5,s[8:11],s57 offen offset:3072 sc1
 v_mfma_f32_16x16x32_bf16 v[104:107],a[144:147],a[176:179],v[104:107]
 ds_read_b64_tr_b16 a[140:141],v21 offset:8992
 s_add_u32 m0,s51,87680
 v_mfma_f32_16x16x32_bf16 v[104:107],a[148:151],a[180:183],v[104:107]
 buffer_load_dwordx4 v8,s[32:35],s58 offen offset:0 lds
 v_mfma_f32_16x16x32_bf16 v[108:111],a[144:147],a[184:187],v[108:111]
 ds_read_b64_tr_b16 a[142:143],v21 offset:9248
 v_mul_f32 v199,0xbfb8aa3b,v135
 v_mfma_f32_16x16x32_bf16 v[108:111],a[148:151],a[188:191],v[108:111]
 s_waitcnt vmcnt(25)
 s_barrier
 v_mfma_f32_16x16x32_bf16 v[208:211],a[152:155],a[160:163],v[208:211]
 ds_read_b64_tr_b16 a[144:145],v21 offset:35136
 v_mul_f32 v228,0xbfb8aa3b,v68
 v_mfma_f32_16x16x32_bf16 v[208:211],a[156:159],a[164:167],v[208:211]
 buffer_load_dwordx4 v9,s[32:35],s58 offen offset:1088 lds
 v_mfma_f32_16x16x32_bf16 v[212:215],a[152:155],a[168:171],v[212:215]
 ds_read_b64_tr_b16 a[146:147],v21 offset:35392
 v_mul_f32 v229,0xbfb8aa3b,v69
 v_mfma_f32_16x16x32_bf16 v[212:215],a[156:159],a[172:175],v[212:215]
 buffer_load_dwordx4 v10,s[32:35],s58 offen offset:2176 lds
 v_mfma_f32_16x16x32_bf16 v[216:219],a[152:155],a[176:179],v[216:219]
 ds_read_b64_tr_b16 a[148:149],v21 offset:43904
 v_mul_f32 v230,0xbfb8aa3b,v70
 v_mfma_f32_16x16x32_bf16 v[216:219],a[156:159],a[180:183],v[216:219]
 buffer_load_dwordx4 v11,s[32:35],s58 offen offset:3264 lds
 v_mfma_f32_16x16x32_bf16 v[220:223],a[152:155],a[184:187],v[220:223]
 ds_read_b64_tr_b16 a[150:151],v21 offset:44160
 v_mul_f32 v231,0xbfb8aa3b,v71
 v_mfma_f32_16x16x32_bf16 v[220:223],a[156:159],a[188:191],v[220:223]
 v_lshlrev_b32 v60,16,v200
 s_waitcnt lgkmcnt(4)
 v_mfma_f32_16x16x32_bf16 v[112:115],a[128:131],a[160:163],v[112:115]
 ds_read_b64_tr_b16 a[152:153],v21 offset:35168
 s_add_u32 s57,s57,8192
 v_mfma_f32_16x16x32_bf16 v[112:115],a[132:135],a[164:167],v[112:115]
 buffer_load_dwordx4 a[64:67],v4,s[8:11],s57 offen offset:0 sc1
 v_mfma_f32_16x16x32_bf16 v[116:119],a[128:131],a[168:171],v[116:119]
 ds_read_b64_tr_b16 a[154:155],v21 offset:35424
 v_lshlrev_b32 v61,16,v201
 v_mfma_f32_16x16x32_bf16 v[116:119],a[132:135],a[172:175],v[116:119]
 buffer_load_dwordx4 a[68:71],v4,s[8:11],s57 offen offset:1024 sc1
 v_mfma_f32_16x16x32_bf16 v[120:123],a[128:131],a[176:179],v[120:123]
 ds_read_b64_tr_b16 a[156:157],v21 offset:43936
 v_lshlrev_b32 v62,16,v202
 v_mfma_f32_16x16x32_bf16 v[120:123],a[132:135],a[180:183],v[120:123]
 buffer_load_dwordx4 a[72:75],v4,s[8:11],s57 offen offset:2048 sc1
 v_mfma_f32_16x16x32_bf16 v[124:127],a[128:131],a[184:187],v[124:127]
 ds_read_b64_tr_b16 a[158:159],v21 offset:44192
 v_lshlrev_b32 v63,16,v203
 v_mfma_f32_16x16x32_bf16 v[124:127],a[132:135],a[188:191],v[124:127]
 s_waitcnt vmcnt(27)
 s_barrier
 v_mfma_f32_16x16x32_bf16 v[240:243],a[136:139],a[160:163],v[240:243]
 ds_read_b64_tr_b16 a[128:129],v21 offset:17600
 v_mfma_f32_16x16x32_bf16 v[240:243],a[140:143],a[164:167],v[240:243]
 buffer_load_dwordx4 a[76:79],v4,s[8:11],s57 offen offset:3072 sc1
 v_mfma_f32_16x16x32_bf16 v[244:247],a[136:139],a[168:171],v[244:247]
 ds_read_b64_tr_b16 a[130:131],v21 offset:17856
 v_mfma_f32_16x16x32_bf16 v[244:247],a[140:143],a[172:175],v[244:247]
 buffer_load_dwordx4 a[96:99],v5,s[8:11],s57 offen offset:0 sc1
 v_mfma_f32_16x16x32_bf16 v[248:251],a[136:139],a[176:179],v[248:251]
 ds_read_b64_tr_b16 a[132:133],v21 offset:26368
 v_mfma_f32_16x16x32_bf16 v[248:251],a[140:143],a[180:183],v[248:251]
 buffer_load_dwordx4 a[100:103],v5,s[8:11],s57 offen offset:1024 sc1
 v_mfma_f32_16x16x32_bf16 v[252:255],a[136:139],a[184:187],v[252:255]
 ds_read_b64_tr_b16 a[134:135],v21 offset:26624
 v_mfma_f32_16x16x32_bf16 v[252:255],a[140:143],a[188:191],v[252:255]
 s_waitcnt vmcnt(22)
 s_waitcnt lgkmcnt(4)
 v_mfma_f32_16x16x32_bf16 v[80:83],a[144:147],a[16:19],v[80:83]
 ds_read_b64_tr_b16 a[136:137],v21 offset:17632
 v_mfma_f32_16x16x32_bf16 v[80:83],a[148:151],a[20:23],v[80:83]
 buffer_load_dwordx4 a[104:107],v5,s[8:11],s57 offen offset:2048 sc1
 v_mfma_f32_16x16x32_bf16 v[84:87],a[144:147],a[24:27],v[84:87]
 ds_read_b64_tr_b16 a[138:139],v21 offset:17888
 v_mfma_f32_16x16x32_bf16 v[84:87],a[148:151],a[28:31],v[84:87]
 buffer_load_dwordx4 a[108:111],v5,s[8:11],s57 offen offset:3072 sc1
 v_mfma_f32_16x16x32_bf16 v[88:91],a[144:147],a[48:51],v[88:91]
 ds_read_b64_tr_b16 a[140:141],v21 offset:26400
 s_add_u32 s57,s57,8192
 v_mfma_f32_16x16x32_bf16 v[88:91],a[148:151],a[52:55],v[88:91]
 buffer_load_dwordx4 a[0:3],v4,s[8:11],s57 offen offset:0 sc1
 v_mfma_f32_16x16x32_bf16 v[92:95],a[144:147],a[56:59],v[92:95]
 ds_read_b64_tr_b16 a[142:143],v21 offset:26656
 v_mfma_f32_16x16x32_bf16 v[92:95],a[148:151],a[60:63],v[92:95]
 s_waitcnt vmcnt(21)
 s_barrier
 v_mfma_f32_16x16x32_bf16 v[176:179],a[152:155],a[16:19],v[176:179]
 ds_read_b64_tr_b16 a[144:145],v22 offset:17600
 v_mfma_f32_16x16x32_bf16 v[176:179],a[156:159],a[20:23],v[176:179]
 buffer_load_dwordx4 a[4:7],v4,s[8:11],s57 offen offset:1024 sc1
 v_mfma_f32_16x16x32_bf16 v[180:183],a[152:155],a[24:27],v[180:183]
 ds_read_b64_tr_b16 a[146:147],v22 offset:17856
 v_mfma_f32_16x16x32_bf16 v[180:183],a[156:159],a[28:31],v[180:183]
 buffer_load_dwordx4 a[8:11],v4,s[8:11],s57 offen offset:2048 sc1
 v_mfma_f32_16x16x32_bf16 v[184:187],a[152:155],a[48:51],v[184:187]
 ds_read_b64_tr_b16 a[148:149],v22 offset:26368
 v_mfma_f32_16x16x32_bf16 v[184:187],a[156:159],a[52:55],v[184:187]
 buffer_load_dwordx4 a[12:15],v4,s[8:11],s57 offen offset:3072 sc1
 v_mfma_f32_16x16x32_bf16 v[188:191],a[152:155],a[56:59],v[188:191]
 ds_read_b64_tr_b16 a[150:151],v22 offset:26624
 v_mfma_f32_16x16x32_bf16 v[188:191],a[156:159],a[60:63],v[188:191]
 s_waitcnt vmcnt(16)
 s_waitcnt lgkmcnt(4)
 v_mfma_f32_16x16x32_bf16 v[80:83],a[128:131],a[32:35],v[80:83]
 ds_read_b64_tr_b16 a[152:153],v22 offset:17632
 v_mfma_f32_16x16x32_bf16 v[80:83],a[132:135],a[36:39],v[80:83]
 buffer_load_dwordx4 v[160:163],v5,s[8:11],s57 offen offset:0 sc1
 v_mfma_f32_16x16x32_bf16 v[84:87],a[128:131],a[40:43],v[84:87]
 ds_read_b64_tr_b16 a[154:155],v22 offset:17888
 v_mfma_f32_16x16x32_bf16 v[84:87],a[132:135],a[44:47],v[84:87]
 buffer_load_dwordx4 v[164:167],v5,s[8:11],s57 offen offset:1024 sc1
 v_mfma_f32_16x16x32_bf16 v[88:91],a[128:131],a[240:243],v[88:91]
 ds_read_b64_tr_b16 a[156:157],v22 offset:26400
 v_mfma_f32_16x16x32_bf16 v[88:91],a[132:135],a[244:247],v[88:91]
 buffer_load_dwordx4 v[168:171],v5,s[8:11],s57 offen offset:2048 sc1
 v_mfma_f32_16x16x32_bf16 v[92:95],a[128:131],a[248:251],v[92:95]
 ds_read_b64_tr_b16 a[158:159],v22 offset:26656
 v_mfma_f32_16x16x32_bf16 v[92:95],a[132:135],a[252:255],v[92:95]
 s_waitcnt vmcnt(15)
 s_barrier
 v_mfma_f32_16x16x32_bf16 v[176:179],a[136:139],a[32:35],v[176:179]
 ds_read_b64_tr_b16 a[128:129],v22 offset:35136
 v_mfma_f32_16x16x32_bf16 v[176:179],a[140:143],a[36:39],v[176:179]
 buffer_load_dwordx4 v[172:175],v5,s[8:11],s57 offen offset:3072 sc1
 v_mfma_f32_16x16x32_bf16 v[180:183],a[136:139],a[40:43],v[180:183]
 ds_read_b64_tr_b16 a[130:131],v22 offset:35392
 v_mfma_f32_16x16x32_bf16 v[180:183],a[140:143],a[44:47],v[180:183]
 v_exp_f32 v196,v196
 v_mfma_f32_16x16x32_bf16 v[184:187],a[136:139],a[240:243],v[184:187]
 ds_read_b64_tr_b16 a[132:133],v22 offset:43904
 v_add_f32 v196,1.0,v196
 v_mfma_f32_16x16x32_bf16 v[184:187],a[140:143],a[244:247],v[184:187]
 v_exp_f32 v197,v197
 v_mfma_f32_16x16x32_bf16 v[188:191],a[136:139],a[248:251],v[188:191]
 ds_read_b64_tr_b16 a[134:135],v22 offset:44160
 v_add_f32 v197,1.0,v197
 v_mfma_f32_16x16x32_bf16 v[188:191],a[140:143],a[252:255],v[188:191]
 s_waitcnt vmcnt(8)
 s_waitcnt lgkmcnt(4)
 v_mfma_f32_16x16x32_bf16 v[80:83],a[144:147],a[64:67],v[80:83]
 ds_read_b64_tr_b16 a[136:137],v22 offset:35168
 v_and_b32 v200,0xffff0000,v200
 v_mfma_f32_16x16x32_bf16 v[80:83],a[148:151],a[68:71],v[80:83]
 v_exp_f32 v198,v198
 v_mfma_f32_16x16x32_bf16 v[84:87],a[144:147],a[72:75],v[84:87]
 ds_read_b64_tr_b16 a[138:139],v22 offset:35424
 v_add_f32 v198,1.0,v198
 v_mfma_f32_16x16x32_bf16 v[84:87],a[148:151],a[76:79],v[84:87]
 v_exp_f32 v199,v199
 v_mfma_f32_16x16x32_bf16 v[88:91],a[144:147],a[96:99],v[88:91]
 ds_read_b64_tr_b16 a[140:141],v22 offset:43936
 v_add_f32 v199,1.0,v199
 v_mfma_f32_16x16x32_bf16 v[88:91],a[148:151],a[100:103],v[88:91]
 v_exp_f32 v228,v228
 v_mfma_f32_16x16x32_bf16 v[92:95],a[144:147],a[104:107],v[92:95]
 ds_read_b64_tr_b16 a[142:143],v22 offset:44192
 v_add_f32 v228,1.0,v228
 v_mfma_f32_16x16x32_bf16 v[92:95],a[148:151],a[108:111],v[92:95]
 v_exp_f32 v229,v229
 v_mfma_f32_16x16x32_bf16 v[176:179],a[152:155],a[64:67],v[176:179]
 ds_read_b64_tr_b16 a[144:145],v21 offset:35200
 v_add_f32 v229,1.0,v229
 v_mfma_f32_16x16x32_bf16 v[176:179],a[156:159],a[68:71],v[176:179]
 v_exp_f32 v230,v230
 v_mfma_f32_16x16x32_bf16 v[180:183],a[152:155],a[72:75],v[180:183]
 ds_read_b64_tr_b16 a[146:147],v21 offset:35456
 v_add_f32 v230,1.0,v230
 v_mfma_f32_16x16x32_bf16 v[180:183],a[156:159],a[76:79],v[180:183]
 v_exp_f32 v231,v231
 v_mfma_f32_16x16x32_bf16 v[184:187],a[152:155],a[96:99],v[184:187]
 ds_read_b64_tr_b16 a[148:149],v21 offset:43968
 v_add_f32 v231,1.0,v231
 v_mfma_f32_16x16x32_bf16 v[184:187],a[156:159],a[100:103],v[184:187]
 v_rcp_f32 v196,v196
 v_mfma_f32_16x16x32_bf16 v[188:191],a[152:155],a[104:107],v[188:191]
 ds_read_b64_tr_b16 a[150:151],v21 offset:44224
 v_mul_f32 v132,v132,v196
 v_mfma_f32_16x16x32_bf16 v[188:191],a[156:159],a[108:111],v[188:191]
 s_waitcnt vmcnt(0)
 s_waitcnt lgkmcnt(4)
 v_mfma_f32_16x16x32_bf16 v[80:83],a[128:131],a[0:3],v[80:83]
 ds_read_b64_tr_b16 a[152:153],v21 offset:35232
 s_add_u32 s63,s75,69632
 v_mfma_f32_16x16x32_bf16 v[80:83],a[132:135],a[4:7],v[80:83]
 v_rcp_f32 v197,v197
 v_mfma_f32_16x16x32_bf16 v[84:87],a[128:131],a[8:11],v[84:87]
 ds_read_b64_tr_b16 a[154:155],v21 offset:35488
 v_mul_f32 v133,v133,v197
 v_mfma_f32_16x16x32_bf16 v[84:87],a[132:135],a[12:15],v[84:87]
 v_rcp_f32 v198,v198
 v_mfma_f32_16x16x32_bf16 v[88:91],a[128:131],v[160:163],v[88:91]
 ds_read_b64_tr_b16 a[156:157],v21 offset:44000
 v_cvt_pk_bf16_f32 v80,v80,v81
 v_mfma_f32_16x16x32_bf16 v[88:91],a[132:135],v[164:167],v[88:91]
 v_cvt_pk_bf16_f32 v81,v82,v83
 v_mul_f32 v134,v134,v198
 v_mfma_f32_16x16x32_bf16 v[92:95],a[128:131],v[168:171],v[92:95]
 ds_read_b64_tr_b16 a[158:159],v21 offset:44256
 v_cvt_pk_bf16_f32 v84,v84,v85
 v_mfma_f32_16x16x32_bf16 v[92:95],a[132:135],v[172:175],v[92:95]
 v_cvt_pk_bf16_f32 v85,v86,v87
 v_cvt_pk_bf16_f32 v16,v132,v133
 v_mfma_f32_16x16x32_bf16 v[176:179],a[136:139],a[0:3],v[176:179]
 ds_read_b64_tr_b16 a[128:129],v21 offset:17664
 v_cvt_pk_bf16_f32 v88,v88,v89
 v_mfma_f32_16x16x32_bf16 v[176:179],a[140:143],a[4:7],v[176:179]
 v_cvt_pk_bf16_f32 v89,v90,v91
 v_lshlrev_b32 v132,16,v16
 v_mfma_f32_16x16x32_bf16 v[180:183],a[136:139],a[8:11],v[180:183]
 ds_read_b64_tr_b16 a[130:131],v21 offset:17920
 v_cvt_pk_bf16_f32 v92,v92,v93
 v_mfma_f32_16x16x32_bf16 v[180:183],a[140:143],a[12:15],v[180:183]
 v_cvt_pk_bf16_f32 v93,v94,v95
 v_and_b32 v133,0xffff0000,v16
 v_mfma_f32_16x16x32_bf16 v[184:187],a[136:139],v[160:163],v[184:187]
 ds_read_b64_tr_b16 a[132:133],v21 offset:26432
 v_cvt_pk_bf16_f32 v82,v176,v177
 v_mfma_f32_16x16x32_bf16 v[184:187],a[140:143],v[164:167],v[184:187]
 v_cvt_pk_bf16_f32 v83,v178,v179
 v_and_b32 v201,0xffff0000,v201
 v_mfma_f32_16x16x32_bf16 v[188:191],a[136:139],v[168:171],v[188:191]
 ds_read_b64_tr_b16 a[134:135],v21 offset:26688
 v_cvt_pk_bf16_f32 v86,v180,v181
 v_mfma_f32_16x16x32_bf16 v[188:191],a[140:143],v[172:175],v[188:191]
 v_cvt_pk_bf16_f32 v87,v182,v183
 s_waitcnt lgkmcnt(4)
 v_mfma_f32_16x16x32_bf16 v[96:99],a[144:147],a[16:19],v[96:99]
 ds_read_b64_tr_b16 a[136:137],v21 offset:17696
 v_cvt_pk_bf16_f32 v90,v184,v185
 v_mfma_f32_16x16x32_bf16 v[96:99],a[148:151],a[20:23],v[96:99]
 buffer_store_dwordx4 v[80:83],v4,s[8:11],s63 offen offset:0 sc0 sc1
 v_mfma_f32_16x16x32_bf16 v[100:103],a[144:147],a[24:27],v[100:103]
 ds_read_b64_tr_b16 a[138:139],v21 offset:17952
 v_cvt_pk_bf16_f32 v91,v186,v187
 v_mfma_f32_16x16x32_bf16 v[100:103],a[148:151],a[28:31],v[100:103]
 buffer_store_dwordx4 v[84:87],v4,s[8:11],s63 offen offset:1024 sc0 sc1
 v_mfma_f32_16x16x32_bf16 v[104:107],a[144:147],a[48:51],v[104:107]
 ds_read_b64_tr_b16 a[140:141],v21 offset:26464
 v_cvt_pk_bf16_f32 v94,v188,v189
 v_mfma_f32_16x16x32_bf16 v[104:107],a[148:151],a[52:55],v[104:107]
 buffer_store_dwordx4 v[88:91],v4,s[8:11],s63 offen offset:2048 sc0 sc1
 v_mfma_f32_16x16x32_bf16 v[108:111],a[144:147],a[56:59],v[108:111]
 ds_read_b64_tr_b16 a[142:143],v21 offset:26720
 v_cvt_pk_bf16_f32 v95,v190,v191
 v_mfma_f32_16x16x32_bf16 v[108:111],a[148:151],a[60:63],v[108:111]
 buffer_store_dwordx4 v[92:95],v4,s[8:11],s63 offen offset:3072 sc0 sc1
 v_mfma_f32_16x16x32_bf16 v[208:211],a[152:155],a[16:19],v[208:211]
 ds_read_b64_tr_b16 a[144:145],v22 offset:17664
 v_and_b32 v202,0xffff0000,v202
 v_mfma_f32_16x16x32_bf16 v[208:211],a[156:159],a[20:23],v[208:211]
 v_rcp_f32 v199,v199
 v_mfma_f32_16x16x32_bf16 v[212:215],a[152:155],a[24:27],v[212:215]
 ds_read_b64_tr_b16 a[146:147],v22 offset:17920
 v_mul_f32 v135,v135,v199
 v_mfma_f32_16x16x32_bf16 v[212:215],a[156:159],a[28:31],v[212:215]
 v_rcp_f32 v228,v228
 v_mfma_f32_16x16x32_bf16 v[216:219],a[152:155],a[48:51],v[216:219]
 ds_read_b64_tr_b16 a[148:149],v22 offset:26432
 v_mul_f32 v68,v68,v228
 v_mfma_f32_16x16x32_bf16 v[216:219],a[156:159],a[52:55],v[216:219]
 v_rcp_f32 v229,v229
 v_mfma_f32_16x16x32_bf16 v[220:223],a[152:155],a[56:59],v[220:223]
 ds_read_b64_tr_b16 a[150:151],v22 offset:26688
 v_mul_f32 v69,v69,v229
 v_mfma_f32_16x16x32_bf16 v[220:223],a[156:159],a[60:63],v[220:223]
 v_cvt_pk_bf16_f32 v17,v134,v135
 s_waitcnt lgkmcnt(4)
 v_mfma_f32_16x16x32_bf16 v[96:99],a[128:131],a[32:35],v[96:99]
 ds_read_b64_tr_b16 a[152:153],v22 offset:17696
 v_cvt_pk_bf16_f32 v18,v68,v69
 v_mfma_f32_16x16x32_bf16 v[96:99],a[132:135],a[36:39],v[96:99]
 v_rcp_f32 v230,v230
 v_mfma_f32_16x16x32_bf16 v[100:103],a[128:131],a[40:43],v[100:103]
 ds_read_b64_tr_b16 a[154:155],v22 offset:17952
 v_mul_f32 v70,v70,v230
 v_mfma_f32_16x16x32_bf16 v[100:103],a[132:135],a[44:47],v[100:103]
 v_rcp_f32 v231,v231
 v_mfma_f32_16x16x32_bf16 v[104:107],a[128:131],a[240:243],v[104:107]
 ds_read_b64_tr_b16 a[156:157],v22 offset:26464
 v_mul_f32 v71,v71,v231
 v_mfma_f32_16x16x32_bf16 v[104:107],a[132:135],a[244:247],v[104:107]
 v_cvt_pk_bf16_f32 v19,v70,v71
 v_lshlrev_b32 v134,16,v17
 v_mfma_f32_16x16x32_bf16 v[108:111],a[128:131],a[248:251],v[108:111]
 ds_read_b64_tr_b16 a[158:159],v22 offset:26720
 v_and_b32 v135,0xffff0000,v17
 v_mfma_f32_16x16x32_bf16 v[108:111],a[132:135],a[252:255],v[108:111]
 v_lshlrev_b32 v68,16,v18
 v_and_b32 v69,0xffff0000,v18
 v_mfma_f32_16x16x32_bf16 v[208:211],a[136:139],a[32:35],v[208:211]
 ds_read_b64_tr_b16 a[128:129],v22 offset:35200
 v_lshlrev_b32 v70,16,v19
 v_mfma_f32_16x16x32_bf16 v[208:211],a[140:143],a[36:39],v[208:211]
 v_and_b32 v71,0xffff0000,v19
 v_and_b32 v203,0xffff0000,v203
 v_mfma_f32_16x16x32_bf16 v[212:215],a[136:139],a[40:43],v[212:215]
 ds_read_b64_tr_b16 a[130:131],v22 offset:35456
 v_add_f32 v136,v136,v60
 v_mfma_f32_16x16x32_bf16 v[212:215],a[140:143],a[44:47],v[212:215]
 v_add_f32 v137,v137,v200
 v_add_f32 v138,v138,v61
 v_mfma_f32_16x16x32_bf16 v[216:219],a[136:139],a[240:243],v[216:219]
 ds_read_b64_tr_b16 a[132:133],v22 offset:43968
 v_add_f32 v139,v139,v201
 v_mfma_f32_16x16x32_bf16 v[216:219],a[140:143],a[244:247],v[216:219]
 v_add_f32 v72,v72,v62
 v_add_f32 v73,v73,v202
 v_mfma_f32_16x16x32_bf16 v[220:223],a[136:139],a[248:251],v[220:223]
 ds_read_b64_tr_b16 a[134:135],v22 offset:44224
 v_add_f32 v74,v74,v63
 v_mfma_f32_16x16x32_bf16 v[220:223],a[140:143],a[252:255],v[220:223]
 v_add_f32 v75,v75,v203
 s_waitcnt lgkmcnt(4)
 v_mfma_f32_16x16x32_bf16 v[96:99],a[144:147],a[64:67],v[96:99]
 ds_read_b64_tr_b16 a[136:137],v22 offset:35232
 v_lshlrev_b32 v28,16,v232
 v_mfma_f32_16x16x32_bf16 v[96:99],a[148:151],a[68:71],v[96:99]
 v_lshlrev_b32 v29,16,v233
 v_lshlrev_b32 v30,16,v234
 v_mfma_f32_16x16x32_bf16 v[100:103],a[144:147],a[72:75],v[100:103]
 ds_read_b64_tr_b16 a[138:139],v22 offset:35488
 v_lshlrev_b32 v60,16,v235
 v_mfma_f32_16x16x32_bf16 v[100:103],a[148:151],a[76:79],v[100:103]
 v_and_b32 v232,0xffff0000,v232
 v_and_b32 v233,0xffff0000,v233
 v_mfma_f32_16x16x32_bf16 v[104:107],a[144:147],a[96:99],v[104:107]
 ds_read_b64_tr_b16 a[140:141],v22 offset:44000
 v_and_b32 v234,0xffff0000,v234
 v_mfma_f32_16x16x32_bf16 v[104:107],a[148:151],a[100:103],v[104:107]
 v_and_b32 v235,0xffff0000,v235
 v_add_f32 v136,v136,v28
 v_mfma_f32_16x16x32_bf16 v[108:111],a[144:147],a[104:107],v[108:111]
 ds_read_b64_tr_b16 a[142:143],v22 offset:44256
 v_add_f32 v137,v137,v232
 v_mfma_f32_16x16x32_bf16 v[108:111],a[148:151],a[108:111],v[108:111]
 v_add_f32 v138,v138,v29
 v_add_f32 v139,v139,v233
 v_mfma_f32_16x16x32_bf16 v[208:211],a[152:155],a[64:67],v[208:211]
 ds_read_b64_tr_b16 a[144:145],v21 offset:35264
 v_add_f32 v72,v72,v30
 v_mfma_f32_16x16x32_bf16 v[208:211],a[156:159],a[68:71],v[208:211]
 v_add_f32 v73,v73,v234
 v_add_f32 v74,v74,v60
 v_mfma_f32_16x16x32_bf16 v[212:215],a[152:155],a[72:75],v[212:215]
 ds_read_b64_tr_b16 a[146:147],v21 offset:35520
 v_add_f32 v75,v75,v235
 v_mfma_f32_16x16x32_bf16 v[212:215],a[156:159],a[76:79],v[212:215]
 v_lshlrev_b32 v61,16,v24
 v_lshlrev_b32 v62,16,v25
 v_mfma_f32_16x16x32_bf16 v[216:219],a[152:155],a[96:99],v[216:219]
 ds_read_b64_tr_b16 a[148:149],v21 offset:44032
 v_lshlrev_b32 v63,16,v26
 v_mfma_f32_16x16x32_bf16 v[216:219],a[156:159],a[100:103],v[216:219]
 v_lshlrev_b32 v28,16,v27
 v_and_b32 v24,0xffff0000,v24
 v_mfma_f32_16x16x32_bf16 v[220:223],a[152:155],a[104:107],v[220:223]
 ds_read_b64_tr_b16 a[150:151],v21 offset:44288
 v_and_b32 v25,0xffff0000,v25
 v_mfma_f32_16x16x32_bf16 v[220:223],a[156:159],a[108:111],v[220:223]
L_w24:
 s_cbranch_execz L_wret2
 v_and_b32 v26,0xffff0000,v26
 s_waitcnt lgkmcnt(4)
 v_mfma_f32_16x16x32_bf16 v[96:99],a[128:131],a[0:3],v[96:99]
 ds_read_b64_tr_b16 a[152:153],v21 offset:35296
 s_add_u32 s63,s75,73728
 v_mfma_f32_16x16x32_bf16 v[96:99],a[132:135],a[4:7],v[96:99]
 v_and_b32 v27,0xffff0000,v27
 v_add_f32 v136,v136,v61
 v_mfma_f32_16x16x32_bf16 v[100:103],a[128:131],a[8:11],v[100:103]
 ds_read_b64_tr_b16 a[154:155],v21 offset:35552
 v_add_f32 v137,v137,v24
 v_mfma_f32_16x16x32_bf16 v[100:103],a[132:135],a[12:15],v[100:103]
 v_add_f32 v138,v138,v62
 v_add_f32 v139,v139,v25
 v_mfma_f32_16x16x32_bf16 v[104:107],a[128:131],v[160:163],v[104:107]
 ds_read_b64_tr_b16 a[156:157],v21 offset:44064
 v_cvt_pk_bf16_f32 v96,v96,v97
 v_mfma_f32_16x16x32_bf16 v[104:107],a[132:135],v[164:167],v[104:107]
 v_cvt_pk_bf16_f32 v97,v98,v99
 v_add_f32 v72,v72,v63
 v_mfma_f32_16x16x32_bf16 v[108:111],a[128:131],v[168:171],v[108:111]
 ds_read_b64_tr_b16 a[158:159],v21 offset:44320
 v_cvt_pk_bf16_f32 v100,v100,v101
 v_mfma_f32_16x16x32_bf16 v[108:111],a[132:135],v[172:175],v[108:111]
 v_cvt_pk_bf16_f32 v101,v102,v103
 v_add_f32 v73,v73,v26
 v_mfma_f32_16x16x32_bf16 v[208:211],a[136:139],a[0:3],v[208:211]
 ds_read_b64_tr_b16 a[128:129],v21 offset:17728
 v_cvt_pk_bf16_f32 v104,v104,v105
 v_mfma_f32_16x16x32_bf16 v[208:211],a[140:143],a[4:7],v[208:211]
 v_cvt_pk_bf16_f32 v105,v106,v107
 v_add_f32 v74,v74,v28
 v_mfma_f32_16x16x32_bf16 v[212:215],a[136:139],a[8:11],v[212:215]
 ds_read_b64_tr_b16 a[130:131],v21 offset:17984
 v_cvt_pk_bf16_f32 v108,v108,v109
 v_mfma_f32_16x16x32_bf16 v[212:215],a[140:143],a[12:15],v[212:215]
 v_cvt_pk_bf16_f32 v109,v110,v111
 v_add_f32 v75,v75,v27
 v_mfma_f32_16x16x32_bf16 v[216:219],a[136:139],v[160:163],v[216:219]
 ds_read_b64_tr_b16 a[132:133],v21 offset:26496
 v_cvt_pk_bf16_f32 v98,v208,v209
 v_mfma_f32_16x16x32_bf16 v[216:219],a[140:143],v[164:167],v[216:219]
 v_cvt_pk_bf16_f32 v99,v210,v211
 v_cvt_pk_bf16_f32 v24,v136,v137
 v_mfma_f32_16x16x32_bf16 v[220:223],a[136:139],v[168:171],v[220:223]
 ds_read_b64_tr_b16 a[134:135],v21 offset:26752
 v_cvt_pk_bf16_f32 v102,v212,v213
 v_mfma_f32_16x16x32_bf16 v[220:223],a[140:143],v[172:175],v[220:223]
 v_cvt_pk_bf16_f32 v103,v214,v215
 s_waitcnt lgkmcnt(4)
 v_mfma_f32_16x16x32_bf16 v[112:115],a[144:147],a[16:19],v[112:115]
 ds_read_b64_tr_b16 a[136:137],v21 offset:17760
 v_cvt_pk_bf16_f32 v106,v216,v217
 v_mfma_f32_16x16x32_bf16 v[112:115],a[148:151],a[20:23],v[112:115]
 buffer_store_dwordx4 v[96:99],v4,s[8:11],s63 offen offset:0 sc0 sc1
 v_mfma_f32_16x16x32_bf16 v[116:119],a[144:147],a[24:27],v[116:119]
 ds_read_b64_tr_b16 a[138:139],v21 offset:18016
 v_cvt_pk_bf16_f32 v107,v218,v219
 v_mfma_f32_16x16x32_bf16 v[116:119],a[148:151],a[28:31],v[116:119]
 buffer_store_dwordx4 v[100:103],v4,s[8:11],s63 offen offset:1024 sc0 sc1
 v_mfma_f32_16x16x32_bf16 v[120:123],a[144:147],a[48:51],v[120:123]
 ds_read_b64_tr_b16 a[140:141],v21 offset:26528
 v_cvt_pk_bf16_f32 v110,v220,v221
 v_mfma_f32_16x16x32_bf16 v[120:123],a[148:151],a[52:55],v[120:123]
 buffer_store_dwordx4 v[104:107],v4,s[8:11],s63 offen offset:2048 sc0 sc1
 v_mfma_f32_16x16x32_bf16 v[124:127],a[144:147],a[56:59],v[124:127]
 ds_read_b64_tr_b16 a[142:143],v21 offset:26784
 v_cvt_pk_bf16_f32 v111,v222,v223
 v_mfma_f32_16x16x32_bf16 v[124:127],a[148:151],a[60:63],v[124:127]
 buffer_store_dwordx4 v[108:111],v4,s[8:11],s63 offen offset:3072 sc0 sc1
 v_mfma_f32_16x16x32_bf16 v[240:243],a[152:155],a[16:19],v[240:243]
 ds_read_b64_tr_b16 a[144:145],v22 offset:17728
 v_cvt_pk_bf16_f32 v25,v138,v139
 v_mfma_f32_16x16x32_bf16 v[240:243],a[156:159],a[20:23],v[240:243]
 v_cvt_pk_bf16_f32 v26,v72,v73
 v_cvt_pk_bf16_f32 v27,v74,v75
 v_mfma_f32_16x16x32_bf16 v[244:247],a[152:155],a[24:27],v[244:247]
 ds_read_b64_tr_b16 a[146:147],v22 offset:17984
 v_lshlrev_b32 v136,16,v24
 v_mfma_f32_16x16x32_bf16 v[244:247],a[156:159],a[28:31],v[244:247]
 v_and_b32 v137,0xffff0000,v24
 v_lshlrev_b32 v138,16,v25
 v_mfma_f32_16x16x32_bf16 v[248:251],a[152:155],a[48:51],v[248:251]
 ds_read_b64_tr_b16 a[148:149],v22 offset:26496
 v_and_b32 v139,0xffff0000,v25
 v_mfma_f32_16x16x32_bf16 v[248:251],a[156:159],a[52:55],v[248:251]
 v_lshlrev_b32 v72,16,v26
 v_and_b32 v73,0xffff0000,v26
 v_mfma_f32_16x16x32_bf16 v[252:255],a[152:155],a[56:59],v[252:255]
 ds_read_b64_tr_b16 a[150:151],v22 offset:26752
 v_lshlrev_b32 v74,16,v27
 v_mfma_f32_16x16x32_bf16 v[252:255],a[156:159],a[60:63],v[252:255]
 v_and_b32 v75,0xffff0000,v27
 s_waitcnt lgkmcnt(4)
 v_mfma_f32_16x16x32_bf16 v[112:115],a[128:131],a[32:35],v[112:115]
 ds_read_b64_tr_b16 a[152:153],v22 offset:17760
 v_mul_f32 v200,0xbfb8aa3b,v136
 v_mfma_f32_16x16x32_bf16 v[112:115],a[132:135],a[36:39],v[112:115]
 v_mul_f32 v201,0xbfb8aa3b,v137
 v_mul_f32 v202,0xbfb8aa3b,v138
 v_mfma_f32_16x16x32_bf16 v[116:119],a[128:131],a[40:43],v[116:119]
 ds_read_b64_tr_b16 a[154:155],v22 offset:18016
 v_mul_f32 v203,0xbfb8aa3b,v139
 v_mfma_f32_16x16x32_bf16 v[116:119],a[132:135],a[44:47],v[116:119]
 v_mul_f32 v232,0xbfb8aa3b,v72
 v_mul_f32 v233,0xbfb8aa3b,v73
 v_mfma_f32_16x16x32_bf16 v[120:123],a[128:131],a[240:243],v[120:123]
 ds_read_b64_tr_b16 a[156:157],v22 offset:26528
 v_mul_f32 v234,0xbfb8aa3b,v74
 v_mfma_f32_16x16x32_bf16 v[120:123],a[132:135],a[244:247],v[120:123]
 v_mul_f32 v235,0xbfb8aa3b,v75
 v_lshlrev_b32 v29,16,v204
 v_mfma_f32_16x16x32_bf16 v[124:127],a[128:131],a[248:251],v[124:127]
 ds_read_b64_tr_b16 a[158:159],v22 offset:26784
 v_lshlrev_b32 v30,16,v205
 v_mfma_f32_16x16x32_bf16 v[124:127],a[132:135],a[252:255],v[124:127]
 v_exp_f32 v200,v200
 v_mfma_f32_16x16x32_bf16 v[240:243],a[136:139],a[32:35],v[240:243]
 ds_read_b64_tr_b16 a[128:129],v22 offset:35264
 v_add_f32 v200,1.0,v200
 v_mfma_f32_16x16x32_bf16 v[240:243],a[140:143],a[36:39],v[240:243]
 v_exp_f32 v201,v201
 v_mfma_f32_16x16x32_bf16 v[244:247],a[136:139],a[40:43],v[244:247]
 ds_read_b64_tr_b16 a[130:131],v22 offset:35520
 v_add_f32 v201,1.0,v201
 v_mfma_f32_16x16x32_bf16 v[244:247],a[140:143],a[44:47],v[244:247]
 v_exp_f32 v202,v202
 v_mfma_f32_16x16x32_bf16 v[248:251],a[136:139],a[240:243],v[248:251]
 ds_read_b64_tr_b16 a[132:133],v22 offset:44032
 v_add_f32 v202,1.0,v202
 v_mfma_f32_16x16x32_bf16 v[248:251],a[140:143],a[244:247],v[248:251]
 v_exp_f32 v203,v203
 v_mfma_f32_16x16x32_bf16 v[252:255],a[136:139],a[248:251],v[252:255]
 ds_read_b64_tr_b16 a[134:135],v22 offset:44288
 v_add_f32 v203,1.0,v203
 v_mfma_f32_16x16x32_bf16 v[252:255],a[140:143],a[252:255],v[252:255]
 v_lshlrev_b32 v60,16,v206
 s_waitcnt lgkmcnt(4)
 v_mfma_f32_16x16x32_bf16 v[112:115],a[144:147],a[64:67],v[112:115]
 ds_read_b64_tr_b16 a[136:137],v22 offset:35296
 v_lshlrev_b32 v61,16,v207
 v_mfma_f32_16x16x32_bf16 v[112:115],a[148:151],a[68:71],v[112:115]
 v_exp_f32 v232,v232
 v_mfma_f32_16x16x32_bf16 v[116:119],a[144:147],a[72:75],v[116:119]
 ds_read_b64_tr_b16 a[138:139],v22 offset:35552
 v_add_f32 v232,1.0,v232
 v_mfma_f32_16x16x32_bf16 v[116:119],a[148:151],a[76:79],v[116:119]
 v_exp_f32 v233,v233
 v_mfma_f32_16x16x32_bf16 v[120:123],a[144:147],a[96:99],v[120:123]
 ds_read_b64_tr_b16 a[140:141],v22 offset:44064
 v_add_f32 v233,1.0,v233
 v_mfma_f32_16x16x32_bf16 v[120:123],a[148:151],a[100:103],v[120:123]
 v_exp_f32 v234,v234
 v_mfma_f32_16x16x32_bf16 v[124:127],a[144:147],a[104:107],v[124:127]
 ds_read_b64_tr_b16 a[142:143],v22 offset:44320
 v_add_f32 v234,1.0,v234
 v_mfma_f32_16x16x32_bf16 v[124:127],a[148:151],a[108:111],v[124:127]
 v_exp_f32 v235,v235
 v_mfma_f32_16x16x32_bf16 v[240:243],a[152:155],a[64:67],v[240:243]
 ds_read_b64_tr_b16 a[144:145],v22 offset:0
 v_add_f32 v235,1.0,v235
 v_mfma_f32_16x16x32_bf16 v[240:243],a[156:159],a[68:71],v[240:243]
 v_rcp_f32 v200,v200
 v_mfma_f32_16x16x32_bf16 v[244:247],a[152:155],a[72:75],v[244:247]
 ds_read_b64_tr_b16 a[146:147],v22 offset:256
 v_mul_f32 v136,v136,v200
 v_mfma_f32_16x16x32_bf16 v[244:247],a[156:159],a[76:79],v[244:247]
 v_rcp_f32 v201,v201
 v_mfma_f32_16x16x32_bf16 v[248:251],a[152:155],a[96:99],v[248:251]
 ds_read_b64_tr_b16 a[148:149],v22 offset:8768
 v_mul_f32 v137,v137,v201
 v_mfma_f32_16x16x32_bf16 v[248:251],a[156:159],a[100:103],v[248:251]
 v_rcp_f32 v202,v202
 v_mfma_f32_16x16x32_bf16 v[252:255],a[152:155],a[104:107],v[252:255]
 ds_read_b64_tr_b16 a[150:151],v22 offset:9024
 v_mul_f32 v138,v138,v202
 v_mfma_f32_16x16x32_bf16 v[252:255],a[156:159],a[108:111],v[252:255]
 v_cvt_pk_bf16_f32 v24,v136,v137
 s_waitcnt lgkmcnt(4)
 v_mfma_f32_16x16x32_bf16 v[112:115],a[128:131],a[0:3],v[112:115]
 ds_read_b64_tr_b16 a[152:153],v22 offset:32
 s_add_u32 s63,s75,77824
 v_mfma_f32_16x16x32_bf16 v[112:115],a[132:135],a[4:7],v[112:115]
 v_rcp_f32 v203,v203
 v_mfma_f32_16x16x32_bf16 v[116:119],a[128:131],a[8:11],v[116:119]
 ds_read_b64_tr_b16 a[154:155],v22 offset:288
 v_mul_f32 v139,v139,v203
 v_mfma_f32_16x16x32_bf16 v[116:119],a[132:135],a[12:15],v[116:119]
 v_rcp_f32 v232,v232
 v_mfma_f32_16x16x32_bf16 v[120:123],a[128:131],v[160:163],v[120:123]
 ds_read_b64_tr_b16 a[156:157],v22 offset:8800
 v_cvt_pk_bf16_f32 v112,v112,v113
 v_mfma_f32_16x16x32_bf16 v[120:123],a[132:135],v[164:167],v[120:123]
 v_cvt_pk_bf16_f32 v113,v114,v115
 v_mul_f32 v72,v72,v232
 v_mfma_f32_16x16x32_bf16 v[124:127],a[128:131],v[168:171],v[124:127]
 ds_read_b64_tr_b16 a[158:159],v22 offset:9056
 v_cvt_pk_bf16_f32 v116,v116,v117
 v_mfma_f32_16x16x32_bf16 v[124:127],a[132:135],v[172:175],v[124:127]
 v_cvt_pk_bf16_f32 v117,v118,v119
 v_cvt_pk_bf16_f32 v25,v138,v139
 v_mfma_f32_16x16x32_bf16 v[240:243],a[136:139],a[0:3],v[240:243]
 ds_read_b64_tr_b16 a[128:129],v23 offset:35072
 v_cvt_pk_bf16_f32 v120,v120,v121
 v_mfma_f32_16x16x32_bf16 v[240:243],a[140:143],a[4:7],v[240:243]
 v_cvt_pk_bf16_f32 v121,v122,v123
 v_lshlrev_b32 v136,16,v24
 v_mfma_f32_16x16x32_bf16 v[244:247],a[136:139],a[8:11],v[244:247]
 ds_read_b64_tr_b16 a[130:131],v23 offset:35328
 v_cvt_pk_bf16_f32 v124,v124,v125
 v_mfma_f32_16x16x32_bf16 v[244:247],a[140:143],a[12:15],v[244:247]
 v_cvt_pk_bf16_f32 v125,v126,v127
 v_and_b32 v137,0xffff0000,v24
 v_mfma_f32_16x16x32_bf16 v[248:251],a[136:139],v[160:163],v[248:251]
 ds_read_b64_tr_b16 a[132:133],v23 offset:43840
 v_cvt_pk_bf16_f32 v114,v240,v241
 v_mfma_f32_16x16x32_bf16 v[248:251],a[140:143],v[164:167],v[248:251]
 v_cvt_pk_bf16_f32 v115,v242,v243
 v_lshlrev_b32 v138,16,v25
 v_mfma_f32_16x16x32_bf16 v[252:255],a[136:139],v[168:171],v[252:255]
 ds_read_b64_tr_b16 a[134:135],v23 offset:44096
 v_cvt_pk_bf16_f32 v118,v244,v245
 v_mfma_f32_16x16x32_bf16 v[252:255],a[140:143],v[172:175],v[252:255]
 v_cvt_pk_bf16_f32 v119,v246,v247
 s_waitcnt lgkmcnt(4)
 v_mfma_f32_16x16x32_bf16 a[224:227],a[144:147],a[80:83],a[224:227]
 ds_read_b64_tr_b16 a[136:137],v23 offset:35104
 v_cvt_pk_bf16_f32 v122,v248,v249
 v_mfma_f32_16x16x32_bf16 a[224:227],a[148:151],a[84:87],a[224:227]
 buffer_store_dwordx4 v[112:115],v4,s[8:11],s63 offen offset:0 sc0 sc1
 v_mfma_f32_16x16x32_bf16 a[228:231],a[144:147],a[88:91],a[228:231]
 ds_read_b64_tr_b16 a[138:139],v23 offset:35360
 v_cvt_pk_bf16_f32 v123,v250,v251
 v_mfma_f32_16x16x32_bf16 a[228:231],a[148:151],a[92:95],a[228:231]
 buffer_store_dwordx4 v[116:119],v4,s[8:11],s63 offen offset:1024 sc0 sc1
 v_mfma_f32_16x16x32_bf16 a[232:235],a[144:147],a[112:115],a[232:235]
 ds_read_b64_tr_b16 a[140:141],v23 offset:43872
 v_cvt_pk_bf16_f32 v126,v252,v253
 v_mfma_f32_16x16x32_bf16 a[232:235],a[148:151],a[116:119],a[232:235]
 buffer_store_dwordx4 v[120:123],v4,s[8:11],s63 offen offset:2048 sc0 sc1
 v_mfma_f32_16x16x32_bf16 a[236:239],a[144:147],a[120:123],a[236:239]
 ds_read_b64_tr_b16 a[142:143],v23 offset:44128
 v_cvt_pk_bf16_f32 v127,v254,v255
 v_mfma_f32_16x16x32_bf16 a[236:239],a[148:151],a[124:127],a[236:239]
 buffer_store_dwordx4 v[124:127],v4,s[8:11],s63 offen offset:3072 sc0 sc1
 v_mfma_f32_16x16x32_bf16 v[144:147],a[152:155],a[80:83],v[144:147]
 ds_read_b64_tr_b16 a[144:145],v21 offset:0
 v_and_b32 v139,0xffff0000,v25
 v_mfma_f32_16x16x32_bf16 v[144:147],a[156:159],a[84:87],v[144:147]
 v_rcp_f32 v233,v233
 v_mfma_f32_16x16x32_bf16 v[148:151],a[152:155],a[88:91],v[148:151]
 ds_read_b64_tr_b16 a[146:147],v21 offset:256
 v_mul_f32 v73,v73,v233
 v_mfma_f32_16x16x32_bf16 v[148:151],a[156:159],a[92:95],v[148:151]
 v_rcp_f32 v234,v234
 v_mfma_f32_16x16x32_bf16 v[152:155],a[152:155],a[112:115],v[152:155]
 ds_read_b64_tr_b16 a[148:149],v21 offset:8768
 v_mul_f32 v74,v74,v234
 v_mfma_f32_16x16x32_bf16 v[152:155],a[156:159],a[116:119],v[152:155]
 v_rcp_f32 v235,v235
 v_mfma_f32_16x16x32_bf16 v[156:159],a[152:155],a[120:123],v[156:159]
 ds_read_b64_tr_b16 a[150:151],v21 offset:9024
 v_mul_f32 v75,v75,v235
 v_mfma_f32_16x16x32_bf16 v[156:159],a[156:159],a[124:127],v[156:159]
 v_cvt_pk_bf16_f32 v26,v72,v73
 s_waitcnt lgkmcnt(4)
 v_mfma_f32_16x16x32_bf16 a[224:227],a[128:131],a[192:195],a[224:227]
 ds_read_b64_tr_b16 a[152:153],v21 offset:32
 v_cvt_pk_bf16_f32 v27,v74,v75
 v_mfma_f32_16x16x32_bf16 a[224:227],a[132:135],a[196:199],a[224:227]
 v_lshlrev_b32 v72,16,v26
 v_and_b32 v73,0xffff0000,v26
 v_mfma_f32_16x16x32_bf16 a[228:231],a[128:131],a[200:203],a[228:231]
 ds_read_b64_tr_b16 a[154:155],v21 offset:288
 v_lshlrev_b32 v74,16,v27
 v_mfma_f32_16x16x32_bf16 a[228:231],a[132:135],a[204:207],a[228:231]
 v_and_b32 v75,0xffff0000,v27
 v_and_b32 v204,0xffff0000,v204
 v_mfma_f32_16x16x32_bf16 a[232:235],a[128:131],a[208:211],a[232:235]
 ds_read_b64_tr_b16 a[156:157],v21 offset:8800
 v_and_b32 v205,0xffff0000,v205
 v_mfma_f32_16x16x32_bf16 a[232:235],a[132:135],a[212:215],a[232:235]
 v_and_b32 v206,0xffff0000,v206
 v_and_b32 v207,0xffff0000,v207
 v_mfma_f32_16x16x32_bf16 a[236:239],a[128:131],a[216:219],a[236:239]
 ds_read_b64_tr_b16 a[158:159],v21 offset:9056
 s_xor_b32 s4,s75,200704
 v_mfma_f32_16x16x32_bf16 a[236:239],a[132:135],a[220:223],a[236:239]
 buffer_load_dwordx4 v[176:179],v4,s[8:11],s4 offen offset:0 sc0 sc1
 v_mfma_f32_16x16x32_bf16 v[144:147],a[136:139],a[192:195],v[144:147]
 ds_read_b64_tr_b16 a[128:129],v21 offset:35072
 v_add_f32 v140,v140,v29
 v_mfma_f32_16x16x32_bf16 v[144:147],a[140:143],a[196:199],v[144:147]
 buffer_load_dwordx4 v[180:183],v4,s[8:11],s4 offen offset:1024 sc0 sc1
 v_mfma_f32_16x16x32_bf16 v[148:151],a[136:139],a[200:203],v[148:151]
 ds_read_b64_tr_b16 a[130:131],v21 offset:35328
 v_add_f32 v141,v141,v204
 v_mfma_f32_16x16x32_bf16 v[148:151],a[140:143],a[204:207],v[148:151]
 buffer_load_dwordx4 v[184:187],v4,s[8:11],s4 offen offset:2048 sc0 sc1
 v_mfma_f32_16x16x32_bf16 v[152:155],a[136:139],a[208:211],v[152:155]
 ds_read_b64_tr_b16 a[132:133],v21 offset:43840
 v_add_f32 v142,v142,v30
 v_mfma_f32_16x16x32_bf16 v[152:155],a[140:143],a[212:215],v[152:155]
 buffer_load_dwordx4 v[188:191],v4,s[8:11],s4 offen offset:3072 sc0 sc1
 v_mfma_f32_16x16x32_bf16 v[156:159],a[136:139],a[216:219],v[156:159]
 ds_read_b64_tr_b16 a[134:135],v21 offset:44096
 v_add_f32 v143,v143,v205
 v_mfma_f32_16x16x32_bf16 v[156:159],a[140:143],a[220:223],v[156:159]
 v_add_f32 v76,v76,v60
 s_waitcnt lgkmcnt(4)
 v_mfma_f32_16x16x32_bf16 a[224:227],a[144:147],a[160:163],a[224:227]
 ds_read_b64_tr_b16 a[136:137],v21 offset:35104
 v_add_f32 v77,v77,v206
 v_mfma_f32_16x16x32_bf16 a[224:227],a[148:151],a[164:167],a[224:227]
 v_add_f32 v78,v78,v61
 v_add_f32 v79,v79,v207
 v_mfma_f32_16x16x32_bf16 a[228:231],a[144:147],a[168:171],a[228:231]
 ds_read_b64_tr_b16 a[138:139],v21 offset:35360
 v_lshlrev_b32 v62,16,v236
 v_mfma_f32_16x16x32_bf16 a[228:231],a[148:151],a[172:175],a[228:231]
 v_lshlrev_b32 v63,16,v237
 v_lshlrev_b32 v28,16,v238
 v_mfma_f32_16x16x32_bf16 a[232:235],a[144:147],a[176:179],a[232:235]
 ds_read_b64_tr_b16 a[140:141],v21 offset:43872
 v_lshlrev_b32 v29,16,v239
 v_mfma_f32_16x16x32_bf16 a[232:235],a[148:151],a[180:183],a[232:235]
 v_and_b32 v236,0xffff0000,v236
 v_and_b32 v237,0xffff0000,v237
 v_mfma_f32_16x16x32_bf16 a[236:239],a[144:147],a[184:187],a[236:239]
 ds_read_b64_tr_b16 a[142:143],v21 offset:44128
 v_and_b32 v238,0xffff0000,v238
 v_mfma_f32_16x16x32_bf16 a[236:239],a[148:151],a[188:191],a[236:239]
 v_and_b32 v239,0xffff0000,v239
 v_add_f32 v140,v140,v62
 v_mfma_f32_16x16x32_bf16 v[144:147],a[152:155],a[160:163],v[144:147]
 ds_read_b64_tr_b16 a[144:145],v21 offset:17536
 v_add_f32 v141,v141,v236
 v_mfma_f32_16x16x32_bf16 v[144:147],a[156:159],a[164:167],v[144:147]
 v_add_f32 v142,v142,v63
 v_add_f32 v143,v143,v237
 v_mfma_f32_16x16x32_bf16 v[148:151],a[152:155],a[168:171],v[148:151]
 ds_read_b64_tr_b16 a[146:147],v21 offset:17792
 v_add_f32 v76,v76,v28
 v_mfma_f32_16x16x32_bf16 v[148:151],a[156:159],a[172:175],v[148:151]
 v_add_f32 v77,v77,v238
 v_add_f32 v78,v78,v29
 v_mfma_f32_16x16x32_bf16 v[152:155],a[152:155],a[176:179],v[152:155]
 ds_read_b64_tr_b16 a[148:149],v21 offset:26304
 v_add_f32 v79,v79,v239
 v_mfma_f32_16x16x32_bf16 v[152:155],a[156:159],a[180:183],v[152:155]
 v_lshlrev_b32 v30,16,v40
 v_lshlrev_b32 v60,16,v41
 v_mfma_f32_16x16x32_bf16 v[156:159],a[152:155],a[184:187],v[156:159]
 ds_read_b64_tr_b16 a[150:151],v21 offset:26560
 v_lshlrev_b32 v61,16,v42
 v_mfma_f32_16x16x32_bf16 v[156:159],a[156:159],a[188:191],v[156:159]
 v_lshlrev_b32 v62,16,v43
 s_waitcnt lgkmcnt(4)
 v_mfma_f32_16x16x32_bf16 a[224:227],a[128:131],a[16:19],a[224:227]
 ds_read_b64_tr_b16 a[152:153],v21 offset:17568
 v_and_b32 v40,0xffff0000,v40
 v_mfma_f32_16x16x32_bf16 a[224:227],a[132:135],a[20:23],a[224:227]
 v_and_b32 v41,0xffff0000,v41
 v_and_b32 v42,0xffff0000,v42
 v_mfma_f32_16x16x32_bf16 a[228:231],a[128:131],a[24:27],a[228:231]
 ds_read_b64_tr_b16 a[154:155],v21 offset:17824
 v_and_b32 v43,0xffff0000,v43
 v_mfma_f32_16x16x32_bf16 a[228:231],a[132:135],a[28:31],a[228:231]
 v_add_f32 v140,v140,v30
 v_add_f32 v141,v141,v40
 v_mfma_f32_16x16x32_bf16 a[232:235],a[128:131],a[48:51],a[232:235]
 ds_read_b64_tr_b16 a[156:157],v21 offset:26336
 v_add_f32 v142,v142,v60
 v_mfma_f32_16x16x32_bf16 a[232:235],a[132:135],a[52:55],a[232:235]
 v_add_f32 v143,v143,v41
 v_add_f32 v76,v76,v61
 v_mfma_f32_16x16x32_bf16 a[236:239],a[128:131],a[56:59],a[236:239]
 ds_read_b64_tr_b16 a[158:159],v21 offset:26592
 v_add_f32 v77,v77,v42
 v_mfma_f32_16x16x32_bf16 a[236:239],a[132:135],a[60:63],a[236:239]
 v_add_f32 v78,v78,v62
 v_add_f32 v79,v79,v43
 v_mfma_f32_16x16x32_bf16 v[144:147],a[136:139],a[16:19],v[144:147]
 ds_read_b64_tr_b16 a[128:129],v22 offset:17536
 v_cvt_pk_bf16_f32 v40,v140,v141
 v_mfma_f32_16x16x32_bf16 v[144:147],a[140:143],a[20:23],v[144:147]
 v_cvt_pk_bf16_f32 v41,v142,v143
 v_cvt_pk_bf16_f32 v42,v76,v77
 v_mfma_f32_16x16x32_bf16 v[148:151],a[136:139],a[24:27],v[148:151]
 ds_read_b64_tr_b16 a[130:131],v22 offset:17792
 v_cvt_pk_bf16_f32 v43,v78,v79
 v_mfma_f32_16x16x32_bf16 v[148:151],a[140:143],a[28:31],v[148:151]
 v_lshlrev_b32 v140,16,v40
 v_and_b32 v141,0xffff0000,v40
 v_mfma_f32_16x16x32_bf16 v[152:155],a[136:139],a[48:51],v[152:155]
 ds_read_b64_tr_b16 a[132:133],v22 offset:26304
 v_lshlrev_b32 v142,16,v41
 v_mfma_f32_16x16x32_bf16 v[152:155],a[140:143],a[52:55],v[152:155]
 v_and_b32 v143,0xffff0000,v41
 v_lshlrev_b32 v76,16,v42
 v_mfma_f32_16x16x32_bf16 v[156:159],a[136:139],a[56:59],v[156:159]
 ds_read_b64_tr_b16 a[134:135],v22 offset:26560
 v_and_b32 v77,0xffff0000,v42
 v_mfma_f32_16x16x32_bf16 v[156:159],a[140:143],a[60:63],v[156:159]
 v_lshlrev_b32 v78,16,v43
 s_waitcnt lgkmcnt(4)
 v_mfma_f32_16x16x32_bf16 a[224:227],a[144:147],a[32:35],a[224:227]
 ds_read_b64_tr_b16 a[136:137],v22 offset:17568
 v_and_b32 v79,0xffff0000,v43
 v_mfma_f32_16x16x32_bf16 a[224:227],a[148:151],a[36:39],a[224:227]
 v_mul_f32 v204,0xbfb8aa3b,v140
 v_mul_f32 v205,0xbfb8aa3b,v141
 v_mfma_f32_16x16x32_bf16 a[228:231],a[144:147],a[40:43],a[228:231]
 ds_read_b64_tr_b16 a[138:139],v22 offset:17824
 v_mul_f32 v206,0xbfb8aa3b,v142
 v_mfma_f32_16x16x32_bf16 a[228:231],a[148:151],a[44:47],a[228:231]
 v_mul_f32 v207,0xbfb8aa3b,v143
 v_mul_f32 v236,0xbfb8aa3b,v76
 v_mfma_f32_16x16x32_bf16 a[232:235],a[144:147],a[240:243],a[232:235]
 ds_read_b64_tr_b16 a[140:141],v22 offset:26336
 v_mul_f32 v237,0xbfb8aa3b,v77
 v_mfma_f32_16x16x32_bf16 a[232:235],a[148:151],a[244:247],a[232:235]
 v_mul_f32 v238,0xbfb8aa3b,v78
 v_mul_f32 v239,0xbfb8aa3b,v79
 v_mfma_f32_16x16x32_bf16 a[236:239],a[144:147],a[248:251],a[236:239]
 ds_read_b64_tr_b16 a[142:143],v22 offset:26592
 v_mfma_f32_16x16x32_bf16 a[236:239],a[148:151],a[252:255],a[236:239]
 v_exp_f32 v204,v204
 v_mfma_f32_16x16x32_bf16 v[144:147],a[152:155],a[32:35],v[144:147]
 ds_read_b64_tr_b16 a[144:145],v22 offset:35072
 v_add_f32 v204,1.0,v204
 v_mfma_f32_16x16x32_bf16 v[144:147],a[156:159],a[36:39],v[144:147]
 v_exp_f32 v205,v205
 v_mfma_f32_16x16x32_bf16 v[148:151],a[152:155],a[40:43],v[148:151]
 ds_read_b64_tr_b16 a[146:147],v22 offset:35328
 v_add_f32 v205,1.0,v205
 v_mfma_f32_16x16x32_bf16 v[148:151],a[156:159],a[44:47],v[148:151]
 v_exp_f32 v206,v206
 v_mfma_f32_16x16x32_bf16 v[152:155],a[152:155],a[240:243],v[152:155]
 ds_read_b64_tr_b16 a[148:149],v22 offset:43840
 v_add_f32 v206,1.0,v206
 v_mfma_f32_16x16x32_bf16 v[152:155],a[156:159],a[244:247],v[152:155]
 v_exp_f32 v207,v207
 v_mfma_f32_16x16x32_bf16 v[156:159],a[152:155],a[248:251],v[156:159]
 ds_read_b64_tr_b16 a[150:151],v22 offset:44096
 v_add_f32 v207,1.0,v207
 v_mfma_f32_16x16x32_bf16 v[156:159],a[156:159],a[252:255],v[156:159]
 s_waitcnt lgkmcnt(4)
 v_mfma_f32_16x16x32_bf16 a[224:227],a[128:131],a[64:67],a[224:227]
 ds_read_b64_tr_b16 a[152:153],v22 offset:35104
 v_mfma_f32_16x16x32_bf16 a[224:227],a[132:135],a[68:71],a[224:227]
 v_exp_f32 v236,v236
 v_mfma_f32_16x16x32_bf16 a[228:231],a[128:131],a[72:75],a[228:231]
 ds_read_b64_tr_b16 a[154:155],v22 offset:35360
 v_add_f32 v236,1.0,v236
 v_mfma_f32_16x16x32_bf16 a[228:231],a[132:135],a[76:79],a[228:231]
 v_exp_f32 v237,v237
 v_mfma_f32_16x16x32_bf16 a[232:235],a[128:131],a[96:99],a[232:235]
 ds_read_b64_tr_b16 a[156:157],v22 offset:43872
 v_add_f32 v237,1.0,v237
 v_mfma_f32_16x16x32_bf16 a[232:235],a[132:135],a[100:103],a[232:235]
 v_exp_f32 v238,v238
 v_mfma_f32_16x16x32_bf16 a[236:239],a[128:131],a[104:107],a[236:239]
 ds_read_b64_tr_b16 a[158:159],v22 offset:44128
 s_xor_b32 s5,s75,335872
 v_mfma_f32_16x16x32_bf16 a[236:239],a[132:135],a[108:111],a[236:239]
 buffer_load_dwordx4 v[208:211],v4,s[8:11],s5 offen offset:0 sc0 sc1
 v_mfma_f32_16x16x32_bf16 v[144:147],a[136:139],a[64:67],v[144:147]
 buffer_load_dwordx4 v[212:215],v4,s[8:11],s5 offen offset:1024 sc0 sc1
 v_mfma_f32_16x16x32_bf16 v[144:147],a[140:143],a[68:71],v[144:147]
 buffer_load_dwordx4 v[216:219],v4,s[8:11],s5 offen offset:2048 sc0 sc1
 v_mfma_f32_16x16x32_bf16 v[148:151],a[136:139],a[72:75],v[148:151]
 buffer_load_dwordx4 v[220:223],v4,s[8:11],s5 offen offset:3072 sc0 sc1
 v_mfma_f32_16x16x32_bf16 v[148:151],a[140:143],a[76:79],v[148:151]
 v_exp_f32 v239,v239
 v_mfma_f32_16x16x32_bf16 v[152:155],a[136:139],a[96:99],v[152:155]
 v_add_f32 v238,1.0,v238
 v_add_f32 v239,1.0,v239
 v_mfma_f32_16x16x32_bf16 v[152:155],a[140:143],a[100:103],v[152:155]
 v_rcp_f32 v204,v204
 v_mfma_f32_16x16x32_bf16 v[156:159],a[136:139],a[104:107],v[156:159]
 v_rcp_f32 v205,v205
 v_mfma_f32_16x16x32_bf16 v[156:159],a[140:143],a[108:111],v[156:159]
 v_mul_f32 v140,v140,v204
 s_waitcnt lgkmcnt(0)
 v_mfma_f32_16x16x32_bf16 a[224:227],a[144:147],a[0:3],a[224:227]
 v_rcp_f32 v206,v206
 v_mfma_f32_16x16x32_bf16 a[224:227],a[148:151],a[4:7],a[224:227]
 v_rcp_f32 v207,v207
 v_mfma_f32_16x16x32_bf16 a[228:231],a[144:147],a[8:11],a[228:231]
 v_rcp_f32 v236,v236
 v_mfma_f32_16x16x32_bf16 a[228:231],a[148:151],a[12:15],a[228:231]
 v_rcp_f32 v237,v237
 v_mfma_f32_16x16x32_bf16 a[232:235],a[144:147],v[160:163],a[232:235]
 v_rcp_f32 v238,v238
 v_mfma_f32_16x16x32_bf16 a[232:235],a[148:151],v[164:167],a[232:235]
 v_rcp_f32 v239,v239
 v_mfma_f32_16x16x32_bf16 a[236:239],a[144:147],v[168:171],a[236:239]
 v_mul_f32 v141,v141,v205
 v_mul_f32 v142,v142,v206
 v_mfma_f32_16x16x32_bf16 a[236:239],a[148:151],v[172:175],a[236:239]
 v_mul_f32 v143,v143,v207
 v_mul_f32 v76,v76,v236
 v_mfma_f32_16x16x32_bf16 v[144:147],a[152:155],a[0:3],v[144:147]
 v_mul_f32 v77,v77,v237
 v_mul_f32 v78,v78,v238
 v_mfma_f32_16x16x32_bf16 v[144:147],a[156:159],a[4:7],v[144:147]
 v_mul_f32 v79,v79,v239
 v_cvt_pk_bf16_f32 v40,v140,v141
 v_mfma_f32_16x16x32_bf16 v[148:151],a[152:155],a[8:11],v[148:151]
 v_cvt_pk_bf16_f32 v41,v142,v143
 v_cvt_pk_bf16_f32 v42,v76,v77
 v_mfma_f32_16x16x32_bf16 v[148:151],a[156:159],a[12:15],v[148:151]
 v_cvt_pk_bf16_f32 v43,v78,v79
 v_lshlrev_b32 v140,16,v40
 v_mfma_f32_16x16x32_bf16 v[152:155],a[152:155],v[160:163],v[152:155]
 v_and_b32 v141,0xffff0000,v40
 v_lshlrev_b32 v142,16,v41
 v_mfma_f32_16x16x32_bf16 v[152:155],a[156:159],v[164:167],v[152:155]
 v_and_b32 v143,0xffff0000,v41
 v_lshlrev_b32 v76,16,v42
 v_mfma_f32_16x16x32_bf16 v[156:159],a[152:155],v[168:171],v[156:159]
 v_and_b32 v77,0xffff0000,v42
 v_lshlrev_b32 v78,16,v43
 v_mfma_f32_16x16x32_bf16 v[156:159],a[156:159],v[172:175],v[156:159]
 v_and_b32 v79,0xffff0000,v43
L_final:
 s_xor_b32 s6,s75,471040
 buffer_load_dwordx4 v[240:243],v4,s[8:11],s6 offen offset:0 sc0 sc1
 buffer_load_dwordx4 v[244:247],v4,s[8:11],s6 offen offset:1024 sc0 sc1
 buffer_load_dwordx4 v[248:251],v4,s[8:11],s6 offen offset:2048 sc0 sc1
 buffer_load_dwordx4 v[252:255],v4,s[8:11],s6 offen offset:3072 sc0 sc1
 s_add_u32 s3,s76,4096
 v_lshlrev_b32 v192,16,v44
 v_and_b32 v193,0xffff0000,v44
 v_lshlrev_b32 v194,16,v45
 v_and_b32 v195,0xffff0000,v45
 v_lshlrev_b32 v196,16,v46
 v_and_b32 v197,0xffff0000,v46
 v_lshlrev_b32 v198,16,v47
 v_and_b32 v199,0xffff0000,v47
 v_lshlrev_b32 v200,16,v48
 v_and_b32 v201,0xffff0000,v48
 v_lshlrev_b32 v202,16,v49
 v_and_b32 v203,0xffff0000,v49
 v_lshlrev_b32 v204,16,v50
 v_and_b32 v205,0xffff0000,v50
 v_lshlrev_b32 v206,16,v51
 v_and_b32 v207,0xffff0000,v51
 v_lshlrev_b32 v224,16,v52
 v_and_b32 v225,0xffff0000,v52
 v_lshlrev_b32 v226,16,v53
 v_and_b32 v227,0xffff0000,v53
 v_lshlrev_b32 v228,16,v54
 v_and_b32 v229,0xffff0000,v54
 v_lshlrev_b32 v230,16,v55
 v_and_b32 v231,0xffff0000,v55
 v_lshlrev_b32 v232,16,v56
 v_and_b32 v233,0xffff0000,v56
 v_lshlrev_b32 v234,16,v57
 v_and_b32 v235,0xffff0000,v57
 v_lshlrev_b32 v236,16,v58
 v_and_b32 v237,0xffff0000,v58
 v_lshlrev_b32 v238,16,v59
 v_and_b32 v239,0xffff0000,v59
 v_accvgpr_read_b32 v80,a224
 v_accvgpr_read_b32 v81,a225
 v_accvgpr_read_b32 v82,a226
 v_accvgpr_read_b32 v83,a227
 v_accvgpr_read_b32 v84,a228
 v_accvgpr_read_b32 v85,a229
 v_accvgpr_read_b32 v86,a230
 v_accvgpr_read_b32 v87,a231
 v_accvgpr_read_b32 v88,a232
 v_accvgpr_read_b32 v89,a233
 v_accvgpr_read_b32 v90,a234
 v_accvgpr_read_b32 v91,a235
 v_accvgpr_read_b32 v92,a236
 v_accvgpr_read_b32 v93,a237
 v_accvgpr_read_b32 v94,a238
 v_accvgpr_read_b32 v95,a239
 s_waitcnt vmcnt(8)
 v_max3_u32 v40,v176,v177,v178
 v_max3_u32 v41,v180,v181,v182
 v_max3_u32 v42,v184,v185,v186
 v_max3_u32 v43,v188,v189,v190
 v_max3_u32 v40,v40,v179,v183
 v_max3_u32 v41,v41,v187,v191
 v_max3_u32 v40,v40,v42,v43
L_w25:
 s_cbranch_execz L_wret2
 v_max_u32 v40,v40,v41
 v_cmp_eq_u32 vcc,-1,v40
 s_nop 0
 s_cbranch_vccnz L_rt1
L_rt1_ret:
 v_lshlrev_b32 v44,16,v176
 v_and_b32 v45,0xffff0000,v176
 v_lshlrev_b32 v46,16,v177
 v_and_b32 v47,0xffff0000,v177
 v_lshlrev_b32 v48,16,v178
 v_and_b32 v49,0xffff0000,v178
 v_lshlrev_b32 v50,16,v179
 v_and_b32 v51,0xffff0000,v179
 v_pk_add_f32 v[80:81],v[80:81],v[44:45]
 v_pk_add_f32 v[82:83],v[82:83],v[46:47]
 v_pk_add_f32 v[144:145],v[144:145],v[48:49]
 v_pk_add_f32 v[146:147],v[146:147],v[50:51]
 v_lshlrev_b32 v52,16,v180
 v_and_b32 v53,0xffff0000,v180
 v_lshlrev_b32 v54,16,v181
 v_and_b32 v55,0xffff0000,v181
 v_lshlrev_b32 v56,16,v182
 v_and_b32 v57,0xffff0000,v182
 v_lshlrev_b32 v58,16,v183
 v_and_b32 v59,0xffff0000,v183
 v_pk_add_f32 v[84:85],v[84:85],v[52:53]
 v_pk_add_f32 v[86:87],v[86:87],v[54:55]
 v_pk_add_f32 v[148:149],v[148:149],v[56:57]
 v_pk_add_f32 v[150:151],v[150:151],v[58:59]
 v_lshlrev_b32 v44,16,v184
 v_and_b32 v45,0xffff0000,v184
 v_lshlrev_b32 v46,16,v185
 v_and_b32 v47,0xffff0000,v185
 v_lshlrev_b32 v48,16,v186
 v_and_b32 v49,0xffff0000,v186
 v_lshlrev_b32 v50,16,v187
 v_and_b32 v51,0xffff0000,v187
 v_pk_add_f32 v[88:89],v[88:89],v[44:45]
 v_pk_add_f32 v[90:91],v[90:91],v[46:47]
 v_pk_add_f32 v[152:153],v[152:153],v[48:49]
 v_pk_add_f32 v[154:155],v[154:155],v[50:51]
 v_lshlrev_b32 v52,16,v188
 v_and_b32 v53,0xffff0000,v188
 v_lshlrev_b32 v54,16,v189
 v_and_b32 v55,0xffff0000,v189
 v_lshlrev_b32 v56,16,v190
 v_and_b32 v57,0xffff0000,v190
 v_lshlrev_b32 v58,16,v191
 v_and_b32 v59,0xffff0000,v191
 v_pk_add_f32 v[92:93],v[92:93],v[52:53]
 v_pk_add_f32 v[94:95],v[94:95],v[54:55]
 v_pk_add_f32 v[156:157],v[156:157],v[56:57]
 v_pk_add_f32 v[158:159],v[158:159],v[58:59]
 s_waitcnt vmcnt(4)
 buffer_store_dword v7,off,s[8:11],s3 sc0 sc1
 v_max3_u32 v40,v208,v209,v210
 v_max3_u32 v41,v212,v213,v214
 v_max3_u32 v42,v216,v217,v218
 v_max3_u32 v43,v220,v221,v222
 v_max3_u32 v40,v40,v211,v215
 v_max3_u32 v41,v41,v219,v223
 v_max3_u32 v40,v40,v42,v43
 v_max_u32 v40,v40,v41
 v_cmp_eq_u32 vcc,-1,v40
 s_nop 0
 s_cbranch_vccnz L_rt2
L_rt2_ret:
 v_lshlrev_b32 v44,16,v208
 v_and_b32 v45,0xffff0000,v208
 v_lshlrev_b32 v46,16,v209
 v_and_b32 v47,0xffff0000,v209
 v_lshlrev_b32 v48,16,v210
 v_and_b32 v49,0xffff0000,v210
 v_lshlrev_b32 v50,16,v211
 v_and_b32 v51,0xffff0000,v211
 v_pk_add_f32 v[80:81],v[80:81],v[44:45]
 v_pk_add_f32 v[82:83],v[82:83],v[46:47]
 v_pk_add_f32 v[144:145],v[144:145],v[48:49]
 v_pk_add_f32 v[146:147],v[146:147],v[50:51]
 v_pk_fma_f32 v[80:81],v[80:81],v[128:129],v[192:193]
 v_pk_fma_f32 v[82:83],v[82:83],v[130:131],v[194:195]
 v_pk_fma_f32 v[144:145],v[144:145],v[64:65],v[196:197]
 v_pk_fma_f32 v[146:147],v[146:147],v[66:67],v[198:199]
 v_lshlrev_b32 v52,16,v212
 v_and_b32 v53,0xffff0000,v212
 v_lshlrev_b32 v54,16,v213
 v_and_b32 v55,0xffff0000,v213
 v_lshlrev_b32 v56,16,v214
 v_and_b32 v57,0xffff0000,v214
 v_lshlrev_b32 v58,16,v215
 v_and_b32 v59,0xffff0000,v215
 v_pk_add_f32 v[84:85],v[84:85],v[52:53]
 v_pk_add_f32 v[86:87],v[86:87],v[54:55]
 v_pk_add_f32 v[148:149],v[148:149],v[56:57]
 v_pk_add_f32 v[150:151],v[150:151],v[58:59]
 v_pk_fma_f32 v[84:85],v[84:85],v[132:133],v[200:201]
 v_pk_fma_f32 v[86:87],v[86:87],v[134:135],v[202:203]
 v_pk_fma_f32 v[148:149],v[148:149],v[68:69],v[204:205]
 v_pk_fma_f32 v[150:151],v[150:151],v[70:71],v[206:207]
 v_lshlrev_b32 v44,16,v216
 v_and_b32 v45,0xffff0000,v216
 v_lshlrev_b32 v46,16,v217
 v_and_b32 v47,0xffff0000,v217
 v_lshlrev_b32 v48,16,v218
 v_and_b32 v49,0xffff0000,v218
 v_lshlrev_b32 v50,16,v219
 v_and_b32 v51,0xffff0000,v219
 v_pk_add_f32 v[88:89],v[88:89],v[44:45]
 v_pk_add_f32 v[90:91],v[90:91],v[46:47]
 v_pk_add_f32 v[152:153],v[152:153],v[48:49]
 v_pk_add_f32 v[154:155],v[154:155],v[50:51]
 v_pk_fma_f32 v[88:89],v[88:89],v[136:137],v[224:225]
 v_pk_fma_f32 v[90:91],v[90:91],v[138:139],v[226:227]
 v_pk_fma_f32 v[152:153],v[152:153],v[72:73],v[228:229]
 v_pk_fma_f32 v[154:155],v[154:155],v[74:75],v[230:231]
 v_lshlrev_b32 v52,16,v220
 v_and_b32 v53,0xffff0000,v220
 v_lshlrev_b32 v54,16,v221
 v_and_b32 v55,0xffff0000,v221
 v_lshlrev_b32 v56,16,v222
 v_and_b32 v57,0xffff0000,v222
 v_lshlrev_b32 v58,16,v223
 v_and_b32 v59,0xffff0000,v223
 v_pk_add_f32 v[92:93],v[92:93],v[52:53]
 v_pk_add_f32 v[94:95],v[94:95],v[54:55]
 v_pk_add_f32 v[156:157],v[156:157],v[56:57]
 v_pk_add_f32 v[158:159],v[158:159],v[58:59]
 v_pk_fma_f32 v[92:93],v[92:93],v[140:141],v[232:233]
 v_pk_fma_f32 v[94:95],v[94:95],v[142:143],v[234:235]
 v_pk_fma_f32 v[156:157],v[156:157],v[76:77],v[236:237]
 v_pk_fma_f32 v[158:159],v[158:159],v[78:79],v[238:239]
 s_waitcnt vmcnt(1)
 v_max3_u32 v40,v240,v241,v242
 v_max3_u32 v41,v244,v245,v246
 v_max3_u32 v42,v248,v249,v250
 v_max3_u32 v43,v252,v253,v254
 v_max3_u32 v40,v40,v243,v247
 v_max3_u32 v41,v41,v251,v255
 v_max3_u32 v40,v40,v42,v43
 v_max_u32 v40,v40,v41
 v_cmp_eq_u32 vcc,-1,v40
 s_nop 0
 s_cbranch_vccnz L_rt3
L_rt3_ret:
 v_lshlrev_b32 v44,16,v240
 v_and_b32 v45,0xffff0000,v240
 v_lshlrev_b32 v46,16,v241
 v_and_b32 v47,0xffff0000,v241
 v_lshlrev_b32 v48,16,v242
 v_and_b32 v49,0xffff0000,v242
 v_lshlrev_b32 v50,16,v243
 v_and_b32 v51,0xffff0000,v243
 v_pk_fma_f32 v[80:81],v[44:45],v[128:129],v[80:81]
 v_pk_fma_f32 v[82:83],v[46:47],v[130:131],v[82:83]
 v_pk_fma_f32 v[144:145],v[48:49],v[64:65],v[144:145]
 v_pk_fma_f32 v[146:147],v[50:51],v[66:67],v[146:147]
 v_cvt_pk_bf16_f32 v80,v80,v81
 v_cvt_pk_bf16_f32 v81,v82,v83
 v_cvt_pk_bf16_f32 v82,v144,v145
 v_cvt_pk_bf16_f32 v83,v146,v147
 s_mov_b32 s3,0
 v_permlane16_swap_b32 v80,v82
 v_permlane16_swap_b32 v81,v83
 buffer_store_dwordx4 v[80:83],v32,s[40:43],s3 offen sc0 sc1
 v_lshlrev_b32 v52,16,v244
 v_and_b32 v53,0xffff0000,v244
 v_lshlrev_b32 v54,16,v245
 v_and_b32 v55,0xffff0000,v245
 v_lshlrev_b32 v56,16,v246
 v_and_b32 v57,0xffff0000,v246
 v_lshlrev_b32 v58,16,v247
 v_and_b32 v59,0xffff0000,v247
 v_pk_fma_f32 v[84:85],v[52:53],v[132:133],v[84:85]
 v_pk_fma_f32 v[86:87],v[54:55],v[134:135],v[86:87]
 v_pk_fma_f32 v[148:149],v[56:57],v[68:69],v[148:149]
 v_pk_fma_f32 v[150:151],v[58:59],v[70:71],v[150:151]
 v_cvt_pk_bf16_f32 v84,v84,v85
 v_cvt_pk_bf16_f32 v85,v86,v87
 v_cvt_pk_bf16_f32 v86,v148,v149
 v_cvt_pk_bf16_f32 v87,v150,v151
 s_mov_b32 s3,32768
 v_permlane16_swap_b32 v84,v86
 v_permlane16_swap_b32 v85,v87
 buffer_store_dwordx4 v[84:87],v32,s[40:43],s3 offen sc0 sc1
 v_lshlrev_b32 v44,16,v248
 v_and_b32 v45,0xffff0000,v248
 v_lshlrev_b32 v46,16,v249
 v_and_b32 v47,0xffff0000,v249
 v_lshlrev_b32 v48,16,v250
 v_and_b32 v49,0xffff0000,v250
 v_lshlrev_b32 v50,16,v251
 v_and_b32 v51,0xffff0000,v251
 v_pk_fma_f32 v[88:89],v[44:45],v[136:137],v[88:89]
 v_pk_fma_f32 v[90:91],v[46:47],v[138:139],v[90:91]
 v_pk_fma_f32 v[152:153],v[48:49],v[72:73],v[152:153]
 v_pk_fma_f32 v[154:155],v[50:51],v[74:75],v[154:155]
 v_cvt_pk_bf16_f32 v88,v88,v89
 v_cvt_pk_bf16_f32 v89,v90,v91
 v_cvt_pk_bf16_f32 v90,v152,v153
 v_cvt_pk_bf16_f32 v91,v154,v155
 s_mov_b32 s3,65536
 v_permlane16_swap_b32 v88,v90
 v_permlane16_swap_b32 v89,v91
 buffer_store_dwordx4 v[88:91],v32,s[40:43],s3 offen sc0 sc1
 v_lshlrev_b32 v52,16,v252
 v_and_b32 v53,0xffff0000,v252
 v_lshlrev_b32 v54,16,v253
 v_and_b32 v55,0xffff0000,v253
 v_lshlrev_b32 v56,16,v254
 v_and_b32 v57,0xffff0000,v254
 v_lshlrev_b32 v58,16,v255
 v_and_b32 v59,0xffff0000,v255
 v_pk_fma_f32 v[92:93],v[52:53],v[140:141],v[92:93]
 v_pk_fma_f32 v[94:95],v[54:55],v[142:143],v[94:95]
 v_pk_fma_f32 v[156:157],v[56:57],v[76:77],v[156:157]
 v_pk_fma_f32 v[158:159],v[58:59],v[78:79],v[158:159]
 v_cvt_pk_bf16_f32 v92,v92,v93
 v_cvt_pk_bf16_f32 v93,v94,v95
 v_cvt_pk_bf16_f32 v94,v156,v157
 v_cvt_pk_bf16_f32 v95,v158,v159
 s_mov_b32 s3,98304
 v_permlane16_swap_b32 v92,v94
 v_permlane16_swap_b32 v93,v95
 buffer_store_dwordx4 v[92:95],v32,s[40:43],s3 offen sc0 sc1
 s_cmp_lg_u32 s0,0
 s_cbranch_scc1 L_thief_fnext
L_done:
L_end:
 s_endpgm
L_lnself:
 s_mov_b32 s60,s77
 s_mov_b32 s6,31
 v_lshrrev_b32 v200,3,v1
 v_lshlrev_b32 v200,13,v200
 v_and_b32 v201,7,v1
 v_lshl_add_u32 v200,v201,8,v200
 v_xor_b32 v201,0x10000,v200
L_lnself_loop:
 buffer_load_dwordx4 v[32:35],v4,s[36:39],s60 offen offset:0
 buffer_load_dwordx4 v[36:39],v4,s[36:39],s60 offen offset:1024
 buffer_load_dwordx4 v[96:99],v4,s[36:39],s60 offen offset:2048
 buffer_load_dwordx4 v[100:103],v4,s[36:39],s60 offen offset:3072
 s_and_b32 s4,s60,0xfffe0000
 s_bfe_u32 s3,s60,0x2000f
 s_lshl_b32 s3,s3,11
 s_add_u32 s4,s4,s3
 s_bfe_u32 s3,s60,0x4000b
 s_lshl_b32 s3,s3,4
 s_add_u32 s4,s4,s3
 s_waitcnt vmcnt(0)
 v_lshlrev_b32 v40,16,v32
 v_lshlrev_b32 v104,16,v96
 v_and_b32 v41,0xffff0000,v32
 v_and_b32 v105,0xffff0000,v96
 v_lshlrev_b32 v42,16,v33
 v_lshlrev_b32 v106,16,v97
 v_and_b32 v43,0xffff0000,v33
 v_and_b32 v107,0xffff0000,v97
 v_lshlrev_b32 v44,16,v34
 v_lshlrev_b32 v108,16,v98
 v_and_b32 v45,0xffff0000,v34
 v_and_b32 v109,0xffff0000,v98
 v_lshlrev_b32 v46,16,v35
 v_lshlrev_b32 v110,16,v99
 v_and_b32 v47,0xffff0000,v35
 v_and_b32 v111,0xffff0000,v99
 v_lshlrev_b32 v48,16,v36
 v_lshlrev_b32 v112,16,v100
 v_and_b32 v49,0xffff0000,v36
 v_and_b32 v113,0xffff0000,v100
 v_lshlrev_b32 v50,16,v37
 v_lshlrev_b32 v114,16,v101
 v_and_b32 v51,0xffff0000,v37
 v_and_b32 v115,0xffff0000,v101
 v_lshlrev_b32 v52,16,v38
 v_lshlrev_b32 v116,16,v102
 v_and_b32 v53,0xffff0000,v38
 v_and_b32 v117,0xffff0000,v102
 v_lshlrev_b32 v54,16,v39
 v_lshlrev_b32 v118,16,v103
 v_and_b32 v55,0xffff0000,v39
 v_and_b32 v119,0xffff0000,v103
 v_pk_add_f32 v[72:73],v[40:41],v[42:43]
 v_pk_add_f32 v[136:137],v[104:105],v[106:107]
 v_pk_add_f32 v[74:75],v[44:45],v[46:47]
 v_pk_add_f32 v[138:139],v[108:109],v[110:111]
 v_pk_add_f32 v[76:77],v[48:49],v[50:51]
 v_pk_add_f32 v[140:141],v[112:113],v[114:115]
 v_pk_add_f32 v[78:79],v[52:53],v[54:55]
 v_pk_add_f32 v[142:143],v[116:117],v[118:119]
 v_pk_add_f32 v[72:73],v[72:73],v[76:77]
 v_pk_add_f32 v[136:137],v[136:137],v[140:141]
 v_pk_add_f32 v[74:75],v[74:75],v[78:79]
 v_pk_add_f32 v[138:139],v[138:139],v[142:143]
 v_pk_add_f32 v[72:73],v[72:73],v[74:75]
 v_pk_add_f32 v[136:137],v[136:137],v[138:139]
 v_add_f32 v80,v72,v73
 v_add_f32 v144,v136,v137
 s_nop 0
 v_add_f32_dpp v81,v80,v80 quad_perm:[1,0,3,2] row_mask:0xf bank_mask:0xf
 v_add_f32_dpp v145,v144,v144 quad_perm:[1,0,3,2] row_mask:0xf bank_mask:0xf
 s_nop 0
 v_add_f32_dpp v80,v81,v81 quad_perm:[2,3,0,1] row_mask:0xf bank_mask:0xf
 v_add_f32_dpp v144,v145,v145 quad_perm:[2,3,0,1] row_mask:0xf bank_mask:0xf
 s_nop 0
 v_add_f32_dpp v81,v80,v80 row_half_mirror row_mask:0xf bank_mask:0xf
 v_add_f32_dpp v145,v144,v144 row_half_mirror row_mask:0xf bank_mask:0xf
 s_nop 0
 v_add_f32_dpp v80,v81,v81 row_mirror row_mask:0xf bank_mask:0xf
 v_add_f32_dpp v144,v145,v145 row_mirror row_mask:0xf bank_mask:0xf
 v_mov_b32 v81,v80
 v_mov_b32 v145,v144
 s_nop 0
 v_permlane16_swap_b32 v80,v81
 v_permlane16_swap_b32 v144,v145
 v_add_f32 v80,v80,v81
 v_add_f32 v144,v144,v145
 v_mov_b32 v81,v80
 v_mov_b32 v145,v144
 s_nop 0
 v_permlane32_swap_b32 v80,v81
 v_permlane32_swap_b32 v144,v145
 v_add_f32 v80,v80,v81
 v_add_f32 v144,v144,v145
 v_mul_f32 v80,0xba800000,v80
 v_mul_f32 v144,0xba800000,v144
 v_pk_add_f32 v[56:57],v[40:41],v[80:81] op_sel_hi:[1,0]
 v_pk_add_f32 v[120:121],v[104:105],v[144:145] op_sel_hi:[1,0]
 v_pk_add_f32 v[58:59],v[42:43],v[80:81] op_sel_hi:[1,0]
 v_pk_add_f32 v[122:123],v[106:107],v[144:145] op_sel_hi:[1,0]
 v_pk_add_f32 v[60:61],v[44:45],v[80:81] op_sel_hi:[1,0]
 v_pk_add_f32 v[124:125],v[108:109],v[144:145] op_sel_hi:[1,0]
 v_pk_add_f32 v[62:63],v[46:47],v[80:81] op_sel_hi:[1,0]
 v_pk_add_f32 v[126:127],v[110:111],v[144:145] op_sel_hi:[1,0]
 v_pk_add_f32 v[64:65],v[48:49],v[80:81] op_sel_hi:[1,0]
 v_pk_add_f32 v[128:129],v[112:113],v[144:145] op_sel_hi:[1,0]
 v_pk_add_f32 v[66:67],v[50:51],v[80:81] op_sel_hi:[1,0]
 v_pk_add_f32 v[130:131],v[114:115],v[144:145] op_sel_hi:[1,0]
 v_pk_add_f32 v[68:69],v[52:53],v[80:81] op_sel_hi:[1,0]
 v_pk_add_f32 v[132:133],v[116:117],v[144:145] op_sel_hi:[1,0]
 v_pk_add_f32 v[70:71],v[54:55],v[80:81] op_sel_hi:[1,0]
 v_pk_add_f32 v[134:135],v[118:119],v[144:145] op_sel_hi:[1,0]
 v_pk_mul_f32 v[72:73],v[56:57],v[56:57]
 v_pk_mul_f32 v[136:137],v[120:121],v[120:121]
 v_pk_mul_f32 v[74:75],v[58:59],v[58:59]
 v_pk_mul_f32 v[138:139],v[122:123],v[122:123]
 v_pk_fma_f32 v[72:73],v[60:61],v[60:61],v[72:73]
 v_pk_fma_f32 v[136:137],v[124:125],v[124:125],v[136:137]
 v_pk_fma_f32 v[74:75],v[62:63],v[62:63],v[74:75]
 v_pk_fma_f32 v[138:139],v[126:127],v[126:127],v[138:139]
 v_pk_fma_f32 v[72:73],v[64:65],v[64:65],v[72:73]
 v_pk_fma_f32 v[136:137],v[128:129],v[128:129],v[136:137]
 v_pk_fma_f32 v[74:75],v[66:67],v[66:67],v[74:75]
 v_pk_fma_f32 v[138:139],v[130:131],v[130:131],v[138:139]
 v_pk_fma_f32 v[72:73],v[68:69],v[68:69],v[72:73]
 v_pk_fma_f32 v[136:137],v[132:133],v[132:133],v[136:137]
 v_pk_fma_f32 v[74:75],v[70:71],v[70:71],v[74:75]
 v_pk_fma_f32 v[138:139],v[134:135],v[134:135],v[138:139]
 v_pk_add_f32 v[72:73],v[72:73],v[74:75]
 v_pk_add_f32 v[136:137],v[136:137],v[138:139]
 v_add_f32 v82,v72,v73
 v_add_f32 v146,v136,v137
 v_cvt_pk_bf16_f32 v80,v80,v80
 v_cvt_pk_bf16_f32 v144,v144,v144
 v_and_b32 v80,0xffff0000,v80
 v_and_b32 v144,0xffff0000,v144
 v_add_f32_dpp v81,v82,v82 quad_perm:[1,0,3,2] row_mask:0xf bank_mask:0xf
 v_add_f32_dpp v145,v146,v146 quad_perm:[1,0,3,2] row_mask:0xf bank_mask:0xf
 s_nop 0
 v_add_f32_dpp v82,v81,v81 quad_perm:[2,3,0,1] row_mask:0xf bank_mask:0xf
 v_add_f32_dpp v146,v145,v145 quad_perm:[2,3,0,1] row_mask:0xf bank_mask:0xf
 s_nop 0
 v_add_f32_dpp v81,v82,v82 row_half_mirror row_mask:0xf bank_mask:0xf
 v_add_f32_dpp v145,v146,v146 row_half_mirror row_mask:0xf bank_mask:0xf
 s_nop 0
 v_add_f32_dpp v82,v81,v81 row_mirror row_mask:0xf bank_mask:0xf
 v_add_f32_dpp v146,v145,v145 row_mirror row_mask:0xf bank_mask:0xf
 v_mov_b32 v81,v82
 v_mov_b32 v145,v146
 s_nop 0
 v_permlane16_swap_b32 v82,v81
 v_permlane16_swap_b32 v146,v145
 v_add_f32 v82,v82,v81
 v_add_f32 v146,v146,v145
 v_mov_b32 v81,v82
 v_mov_b32 v145,v146
 s_nop 0
 v_permlane32_swap_b32 v82,v81
 v_permlane32_swap_b32 v146,v145
 v_add_f32 v82,v82,v81
 v_add_f32 v146,v146,v145
 v_mul_f32 v82,0x3a800000,v82
 v_mul_f32 v146,0x3a800000,v146
 v_cvt_pk_bf16_f32 v82,v82,v82
 v_cvt_pk_bf16_f32 v146,v146,v146
 v_and_b32 v82,0xffff0000,v82
 v_and_b32 v146,0xffff0000,v146
 v_add_f32 v82,0x3727c5ac,v82
 v_add_f32 v146,0x3727c5ac,v146
 v_cvt_pk_bf16_f32 v82,v82,v82
 v_cvt_pk_bf16_f32 v146,v146,v146
 v_and_b32 v82,0xffff0000,v82
 v_and_b32 v146,0xffff0000,v146
 v_sqrt_f32 v82,v82
 v_sqrt_f32 v146,v146
 v_pk_add_f32 v[56:57],v[40:41],v[80:81] op_sel_hi:[1,0]
 v_pk_add_f32 v[120:121],v[104:105],v[144:145] op_sel_hi:[1,0]
 v_pk_add_f32 v[58:59],v[42:43],v[80:81] op_sel_hi:[1,0]
 v_pk_add_f32 v[122:123],v[106:107],v[144:145] op_sel_hi:[1,0]
 v_pk_add_f32 v[60:61],v[44:45],v[80:81] op_sel_hi:[1,0]
 v_pk_add_f32 v[124:125],v[108:109],v[144:145] op_sel_hi:[1,0]
 v_pk_add_f32 v[62:63],v[46:47],v[80:81] op_sel_hi:[1,0]
 v_pk_add_f32 v[126:127],v[110:111],v[144:145] op_sel_hi:[1,0]
 v_pk_add_f32 v[64:65],v[48:49],v[80:81] op_sel_hi:[1,0]
 v_pk_add_f32 v[128:129],v[112:113],v[144:145] op_sel_hi:[1,0]
 v_pk_add_f32 v[66:67],v[50:51],v[80:81] op_sel_hi:[1,0]
 v_pk_add_f32 v[130:131],v[114:115],v[144:145] op_sel_hi:[1,0]
 v_pk_add_f32 v[68:69],v[52:53],v[80:81] op_sel_hi:[1,0]
 v_pk_add_f32 v[132:133],v[116:117],v[144:145] op_sel_hi:[1,0]
 v_pk_add_f32 v[70:71],v[54:55],v[80:81] op_sel_hi:[1,0]
 v_pk_add_f32 v[134:135],v[118:119],v[144:145] op_sel_hi:[1,0]
 v_cvt_pk_bf16_f32 v82,v82,v82
 v_cvt_pk_bf16_f32 v146,v146,v146
 v_and_b32 v82,0xffff0000,v82
 v_and_b32 v146,0xffff0000,v146
 v_rcp_f32 v72,v82
 v_rcp_f32 v136,v146
 v_cvt_pk_bf16_f32 v32,v56,v57
 v_cvt_pk_bf16_f32 v96,v120,v121
 v_cvt_pk_bf16_f32 v33,v58,v59
 v_cvt_pk_bf16_f32 v97,v122,v123
 v_cvt_pk_bf16_f32 v34,v60,v61
 v_cvt_pk_bf16_f32 v98,v124,v125
 v_cvt_pk_bf16_f32 v35,v62,v63
 v_cvt_pk_bf16_f32 v99,v126,v127
 v_cvt_pk_bf16_f32 v36,v64,v65
 v_cvt_pk_bf16_f32 v100,v128,v129
 v_cvt_pk_bf16_f32 v37,v66,v67
 v_cvt_pk_bf16_f32 v101,v130,v131
 v_cvt_pk_bf16_f32 v38,v68,v69
 v_cvt_pk_bf16_f32 v102,v132,v133
 v_cvt_pk_bf16_f32 v39,v70,v71
 v_cvt_pk_bf16_f32 v103,v134,v135
 v_lshlrev_b32 v40,16,v32
 v_lshlrev_b32 v104,16,v96
 v_and_b32 v41,0xffff0000,v32
 v_and_b32 v105,0xffff0000,v96
 v_lshlrev_b32 v42,16,v33
 v_lshlrev_b32 v106,16,v97
 v_and_b32 v43,0xffff0000,v33
 v_and_b32 v107,0xffff0000,v97
 v_lshlrev_b32 v44,16,v34
 v_lshlrev_b32 v108,16,v98
 v_and_b32 v45,0xffff0000,v34
 v_and_b32 v109,0xffff0000,v98
 v_lshlrev_b32 v46,16,v35
 v_lshlrev_b32 v110,16,v99
 v_and_b32 v47,0xffff0000,v35
 v_and_b32 v111,0xffff0000,v99
 v_lshlrev_b32 v48,16,v36
 v_lshlrev_b32 v112,16,v100
 v_and_b32 v49,0xffff0000,v36
 v_and_b32 v113,0xffff0000,v100
 v_lshlrev_b32 v50,16,v37
 v_lshlrev_b32 v114,16,v101
 v_and_b32 v51,0xffff0000,v37
 v_and_b32 v115,0xffff0000,v101
 v_lshlrev_b32 v52,16,v38
 v_lshlrev_b32 v116,16,v102
 v_and_b32 v53,0xffff0000,v38
 v_and_b32 v117,0xffff0000,v102
 v_lshlrev_b32 v54,16,v39
 v_lshlrev_b32 v118,16,v103
 v_and_b32 v55,0xffff0000,v39
 v_and_b32 v119,0xffff0000,v103
 v_pk_mul_f32 v[56:57],v[40:41],v[72:73] op_sel_hi:[1,0]
 v_pk_mul_f32 v[120:121],v[104:105],v[136:137] op_sel_hi:[1,0]
 v_pk_mul_f32 v[58:59],v[42:43],v[72:73] op_sel_hi:[1,0]
 v_pk_mul_f32 v[122:123],v[106:107],v[136:137] op_sel_hi:[1,0]
 v_pk_mul_f32 v[60:61],v[44:45],v[72:73] op_sel_hi:[1,0]
 v_pk_mul_f32 v[124:125],v[108:109],v[136:137] op_sel_hi:[1,0]
 v_pk_mul_f32 v[62:63],v[46:47],v[72:73] op_sel_hi:[1,0]
 v_pk_mul_f32 v[126:127],v[110:111],v[136:137] op_sel_hi:[1,0]
 v_pk_mul_f32 v[64:65],v[48:49],v[72:73] op_sel_hi:[1,0]
 v_pk_mul_f32 v[128:129],v[112:113],v[136:137] op_sel_hi:[1,0]
 v_pk_mul_f32 v[66:67],v[50:51],v[72:73] op_sel_hi:[1,0]
 v_pk_mul_f32 v[130:131],v[114:115],v[136:137] op_sel_hi:[1,0]
 v_pk_mul_f32 v[68:69],v[52:53],v[72:73] op_sel_hi:[1,0]
 v_pk_mul_f32 v[132:133],v[116:117],v[136:137] op_sel_hi:[1,0]
 v_pk_mul_f32 v[70:71],v[54:55],v[72:73] op_sel_hi:[1,0]
 v_pk_mul_f32 v[134:135],v[118:119],v[136:137] op_sel_hi:[1,0]
 v_cvt_pk_bf16_f32 v32,v56,v57
 v_cvt_pk_bf16_f32 v96,v120,v121
 v_cvt_pk_bf16_f32 v33,v58,v59
 v_cvt_pk_bf16_f32 v97,v122,v123
 v_cvt_pk_bf16_f32 v34,v60,v61
 v_cvt_pk_bf16_f32 v98,v124,v125
 v_cvt_pk_bf16_f32 v35,v62,v63
 v_cvt_pk_bf16_f32 v99,v126,v127
 v_cvt_pk_bf16_f32 v36,v64,v65
 v_cvt_pk_bf16_f32 v100,v128,v129
 v_cvt_pk_bf16_f32 v37,v66,v67
 v_cvt_pk_bf16_f32 v101,v130,v131
 v_cvt_pk_bf16_f32 v38,v68,v69
 v_cvt_pk_bf16_f32 v102,v132,v133
 v_cvt_pk_bf16_f32 v39,v70,v71
 v_cvt_pk_bf16_f32 v103,v134,v135
 buffer_store_dwordx4 v[32:35],v200,s[8:11],s4 offen offset:0 sc0 sc1
 buffer_store_dwordx4 v[36:39],v201,s[8:11],s4 offen offset:0 sc0 sc1
 buffer_store_dwordx4 v[96:99],v200,s[8:11],s4 offen offset:16 sc0 sc1
 buffer_store_dwordx4 v[100:103],v201,s[8:11],s4 offen offset:16 sc0 sc1
 s_add_u32 s60,s60,4096
 s_sub_u32 s6,s6,1
 s_cbranch_scc0 L_lnself_loop
 s_waitcnt vmcnt(0)
 s_branch L_lnok
L_safe:
 v_and_b32 v2,15,v1
 v_lshlrev_b32 v2,8,v2
 v_lshrrev_b32 v3,4,v1
 v_lshl_add_u32 v2,v3,4,v2
 s_lshl_b32 s3,s61,19
 s_mov_b32 s4,127
 v_mov_b32 v48,0xff800000
 v_mov_b32 v49,0xff800000
 v_mov_b32 v50,0xff800000
 v_mov_b32 v51,0xff800000
L_safe_loop:
 buffer_load_dwordx4 a[176:179],v2,s[20:23],s3 offen offset:0
 buffer_load_dwordx4 a[180:183],v2,s[20:23],s3 offen offset:64
 buffer_load_dwordx4 a[184:187],v2,s[20:23],s3 offen offset:128
 buffer_load_dwordx4 a[188:191],v2,s[20:23],s3 offen offset:192
 s_waitcnt vmcnt(0)
 v_mfma_f32_16x16x32_bf16 v[64:67],a[176:179],a[0:3],0
 v_mfma_f32_16x16x32_bf16 v[64:67],a[180:183],a[32:35],v[64:67]
 v_mfma_f32_16x16x32_bf16 v[64:67],a[184:187],a[64:67],v[64:67]
 v_mfma_f32_16x16x32_bf16 v[64:67],a[188:191],a[96:99],v[64:67]
 v_mfma_f32_16x16x32_bf16 v[68:71],a[176:179],a[4:7],0
 v_mfma_f32_16x16x32_bf16 v[68:71],a[180:183],a[36:39],v[68:71]
 v_mfma_f32_16x16x32_bf16 v[68:71],a[184:187],a[68:71],v[68:71]
 v_mfma_f32_16x16x32_bf16 v[68:71],a[188:191],a[100:103],v[68:71]
 v_mfma_f32_16x16x32_bf16 v[72:75],a[176:179],a[8:11],0
 v_mfma_f32_16x16x32_bf16 v[72:75],a[180:183],a[40:43],v[72:75]
 v_mfma_f32_16x16x32_bf16 v[72:75],a[184:187],a[72:75],v[72:75]
 v_mfma_f32_16x16x32_bf16 v[72:75],a[188:191],a[104:107],v[72:75]
 v_mfma_f32_16x16x32_bf16 v[76:79],a[176:179],a[12:15],0
 v_mfma_f32_16x16x32_bf16 v[76:79],a[180:183],a[44:47],v[76:79]
 v_mfma_f32_16x16x32_bf16 v[76:79],a[184:187],a[76:79],v[76:79]
 v_mfma_f32_16x16x32_bf16 v[76:79],a[188:191],a[108:111],v[76:79]
 v_max3_f32 v48,v48,v64,v65
 v_max3_f32 v48,v48,v66,v67
 v_max3_f32 v49,v49,v68,v69
 v_max3_f32 v49,v49,v70,v71
 v_max3_f32 v50,v50,v72,v73
 v_max3_f32 v50,v50,v74,v75
 s_nop 1
 v_max3_f32 v51,v51,v76,v77
 v_max3_f32 v51,v51,v78,v79
 s_add_u32 s3,s3,4096
 s_sub_u32 s4,s4,1
 s_cbranch_scc0 L_safe_loop
 v_permlane16_swap_b32 v48,v49
 v_permlane16_swap_b32 v50,v51
 v_max_f32 v48,v48,v49
 v_max_f32 v50,v50,v51
 s_nop 1
 v_permlane32_swap_b32 v48,v50
 v_max_f32 v48,v48,v50
 v_mov_b32 v50,v48
 s_nop 1
 v_permlane32_swap_b32 v48,v50
 v_mov_b32 v49,v48
 v_mov_b32 v51,v50
 s_nop 0
 v_permlane16_swap_b32 v48,v49
 v_permlane16_swap_b32 v50,v51
 v_sub_f32 v80,0,v48
 v_sub_f32 v81,0,v48
 v_sub_f32 v82,0,v48
 v_sub_f32 v83,0,v48
 v_sub_f32 v84,0,v49
 v_sub_f32 v85,0,v49
 v_sub_f32 v86,0,v49
 v_sub_f32 v87,0,v49
 v_sub_f32 v88,0,v50
 v_sub_f32 v89,0,v50
 v_sub_f32 v90,0,v50
 v_sub_f32 v91,0,v50
 v_sub_f32 v92,0,v51
 v_sub_f32 v93,0,v51
 v_sub_f32 v94,0,v51
 v_sub_f32 v95,0,v51
 s_nop 1
 s_branch L_safe_ret
L_opoll:
 s_waitcnt vmcnt(0)
 buffer_store_dword v7,off,s[8:11],s68 sc0 sc1
 s_mov_b32 s3,0
L_pl_o:
 buffer_load_dword v35,v34,s[8:11],s3 offen sc0 sc1
 s_waitcnt vmcnt(0)
 v_cmp_eq_u32 vcc,0,v35
 s_nop 0
 s_cbranch_vccnz L_pl_o
 s_branch L_opoll_ret
L_fpoll:
 s_mov_b32 s3,0
L_pl_f:
 buffer_load_dword v35,v33,s[8:11],s3 offen sc0 sc1
 s_waitcnt vmcnt(0)
 v_cmp_eq_u32 vcc,0,v35
 s_nop 0
 s_cbranch_vccnz L_pl_f
 s_branch L_fpoll_ret
L_o2poll:
 s_mov_b32 s3,0
L_pl_o2:
 buffer_load_dword v35,v34,s[8:11],s3 offen sc0 sc1
 s_waitcnt vmcnt(0)
 v_cmp_eq_u32 vcc,0,v35
 s_nop 0
 s_cbranch_vccnz L_pl_o2
 s_branch L_o2poll_ret
L_final_all:
 s_xor_b32 s4,s75,200704
 buffer_load_dwordx4 v[176:179],v4,s[8:11],s4 offen offset:0 sc0 sc1
 buffer_load_dwordx4 v[180:183],v4,s[8:11],s4 offen offset:1024 sc0 sc1
 buffer_load_dwordx4 v[184:187],v4,s[8:11],s4 offen offset:2048 sc0 sc1
 buffer_load_dwordx4 v[188:191],v4,s[8:11],s4 offen offset:3072 sc0 sc1
 s_xor_b32 s5,s75,335872
 buffer_load_dwordx4 v[208:211],v4,s[8:11],s5 offen offset:0 sc0 sc1
 buffer_load_dwordx4 v[212:215],v4,s[8:11],s5 offen offset:1024 sc0 sc1
 buffer_load_dwordx4 v[216:219],v4,s[8:11],s5 offen offset:2048 sc0 sc1
 buffer_load_dwordx4 v[220:223],v4,s[8:11],s5 offen offset:3072 sc0 sc1
 s_waitcnt vmcnt(4)
 s_branch L_final
L_rt1:
 s_waitcnt vmcnt(0)
 buffer_store_dword v7,off,s[8:11],s3 sc0 sc1
 s_mov_b32 s7,0
L_rt1_l:
 buffer_load_dwordx4 v[176:179],v4,s[8:11],s4 offen offset:0 sc0 sc1
 buffer_load_dwordx4 v[180:183],v4,s[8:11],s4 offen offset:1024 sc0 sc1
 buffer_load_dwordx4 v[184:187],v4,s[8:11],s4 offen offset:2048 sc0 sc1
 buffer_load_dwordx4 v[188:191],v4,s[8:11],s4 offen offset:3072 sc0 sc1
 buffer_load_dword v35,v38,s[8:11],0 offen sc0 sc1
 s_waitcnt vmcnt(1)
 v_max3_u32 v40,v176,v177,v178
 v_max3_u32 v41,v180,v181,v182
 v_max3_u32 v42,v184,v185,v186
 v_max3_u32 v43,v188,v189,v190
 v_max3_u32 v40,v40,v179,v183
 v_max3_u32 v41,v41,v187,v191
 v_max3_u32 v40,v40,v42,v43
 v_max_u32 v40,v40,v41
 v_cmp_eq_u32 vcc,-1,v40
 s_nop 0
 s_cbranch_vccz L_rt1_ret
 s_cmp_lg_u32 s7,0
 s_cbranch_scc1 L_rt1_ret
 s_waitcnt vmcnt(0)
 v_readlane_b32 s7,v35,0
 s_branch L_rt1_l
L_rt2:
 s_mov_b32 s7,0
L_rt2_l:
 buffer_load_dwordx4 v[208:211],v4,s[8:11],s5 offen offset:0 sc0 sc1
 buffer_load_dwordx4 v[212:215],v4,s[8:11],s5 offen offset:1024 sc0 sc1
 buffer_load_dwordx4 v[216:219],v4,s[8:11],s5 offen offset:2048 sc0 sc1
 buffer_load_dwordx4 v[220:223],v4,s[8:11],s5 offen offset:3072 sc0 sc1
 buffer_load_dword v35,v38,s[8:11],0 offen sc0 sc1
 s_waitcnt vmcnt(1)
 v_max3_u32 v40,v208,v209,v210
 v_max3_u32 v41,v212,v213,v214
 v_max3_u32 v42,v216,v217,v218
 v_max3_u32 v43,v220,v221,v222
 v_max3_u32 v40,v40,v211,v215
 v_max3_u32 v41,v41,v219,v223
 v_max3_u32 v40,v40,v42,v43
 v_max_u32 v40,v40,v41
 v_cmp_eq_u32 vcc,-1,v40
 s_nop 0
 s_cbranch_vccz L_rt2_ret
 s_cmp_lg_u32 s7,0
 s_cbranch_scc1 L_rt2_ret
 s_waitcnt vmcnt(0)
 v_readlane_b32 s7,v35,1
 s_branch L_rt2_l
L_rt3:
 s_mov_b32 s7,0
L_rt3_l:
 buffer_load_dwordx4 v[240:243],v4,s[8:11],s6 offen offset:0 sc0 sc1
 buffer_load_dwordx4 v[244:247],v4,s[8:11],s6 offen offset:1024 sc0 sc1
 buffer_load_dwordx4 v[248:251],v4,s[8:11],s6 offen offset:2048 sc0 sc1
 buffer_load_dwordx4 v[252:255],v4,s[8:11],s6 offen offset:3072 sc0 sc1
 buffer_load_dword v35,v38,s[8:11],0 offen sc0 sc1
 s_waitcnt vmcnt(1)
 v_max3_u32 v40,v240,v241,v242
 v_max3_u32 v41,v244,v245,v246
 v_max3_u32 v42,v248,v249,v250
 v_max3_u32 v43,v252,v253,v254
 v_max3_u32 v40,v40,v243,v247
 v_max3_u32 v41,v41,v251,v255
 v_max3_u32 v40,v40,v42,v43
 v_max_u32 v40,v40,v41
 v_cmp_eq_u32 vcc,-1,v40
 s_nop 0
 s_cbranch_vccz L_rt3_ret
 s_cmp_lg_u32 s7,0
 s_cbranch_scc1 L_rt3_ret
 s_waitcnt vmcnt(0)
 v_readlane_b32 s7,v35,2
 s_branch L_rt3_l
L_rare:
 s_waitcnt vmcnt(0) lgkmcnt(0)
 s_nop 7
 s_bitcmp1_b32 s1,0
 s_cbranch_scc1 L_redo
 s_add_u32 s63,s70,4096
 buffer_store_dword v7,off,s[8:11],s63 sc0 sc1
 s_waitcnt vmcnt(0)
 s_barrier
 v_mov_b32 v37,163344
 s_cmp_lg_u32 s48,0
 s_cbranch_scc1 L_thief_w
 s_cmp_lg_u32 s0,0
 s_cbranch_scc1 L_thief_scan
 v_mov_b32 v32,0
 v_mov_b32 v33,0
 v_mov_b32 v34,0
 v_mov_b32 v35,0
 v_add_u32 v2,160896,v4
 ds_write_b128 v2,v[32:35]
 s_lshl_b32 s3,s49,2
 s_add_u32 s3,s3,160896
 v_mov_b32 v2,s3
 ds_write_b32 v2,v7
L_thief_scan:
 v_lshlrev_b32 v2,2,v1
 buffer_load_dword v40,v2,s[44:47],0 offen sc0 sc1
 s_waitcnt vmcnt(0)
 v_and_b32 v40,0x818181ff,v40
 s_mov_b32 s6,0
 v_mov_b32 v3,-1
 v_bfe_u32 v33,v40,24,8
 v_cmp_eq_u32 vcc,0,v33
 v_add_u32 v32,3,v2
 s_nop 0
 v_cndmask_b32 v3,v3,v32,vcc
 v_bfe_u32 v33,v40,16,8
 v_cmp_eq_u32 vcc,0,v33
 v_add_u32 v32,2,v2
 s_nop 0
 v_cndmask_b32 v3,v3,v32,vcc
 v_bfe_u32 v33,v40,8,8
 v_cmp_eq_u32 vcc,0,v33
 v_add_u32 v32,1,v2
 s_nop 0
 v_cndmask_b32 v3,v3,v32,vcc
 v_bfe_u32 v33,v40,0,8
 v_cmp_eq_u32 vcc,0,v33
 v_add_u32 v32,0,v2
 s_nop 0
 v_cndmask_b32 v3,v3,v32,vcc
 v_cmp_ne_u32 vcc,-1,v3
 s_nop 0
 s_cmp_eq_u64 vcc,0
 s_cbranch_scc1 L_thief_res
 s_ff1_i32_b64 s3,vcc
 s_nop 0
 v_readlane_b32 s6,v3,s3
 s_nop 0
 s_and_b32 s4,s6,3
 s_lshl_b32 s4,s4,3
 s_lshl_b32 s7,1,s4
 v_mov_b32 v32,s7
 s_and_b32 s5,s6,0xfc
 s_mov_b64 exec,1
 buffer_atomic_or v32,off,s[44:47],s5 sc0 sc1
 s_mov_b64 exec,-1
 s_waitcnt vmcnt(0)
 v_readfirstlane_b32 s5,v32
 s_nop 0
 s_andn2_b32 s5,s5,0x7e7e7e00
 s_lshr_b32 s5,s5,s4
 s_and_b32 s5,s5,0xff
 s_cbranch_scc1 L_thief_scan
 s_lshl_b32 s3,s6,2
 s_add_u32 s3,s3,160896
 v_mov_b32 v2,s3
 ds_write_b32 v2,v7
 s_add_u32 s6,s6,1
L_thief_res:
 v_mov_b32 v2,s6
 ds_write_b32 v37,v2
 s_waitcnt lgkmcnt(0)
L_thief_w:
 s_mov_b32 s0,-1
 s_barrier
 ds_read_b32 v2,v37
 s_waitcnt lgkmcnt(0)
 v_readfirstlane_b32 s6,v2
 s_nop 0
 s_cmp_eq_u32 s6,0
 s_cbranch_scc1 L_thief_b
 s_sub_u32 s49,s6,1
 s_mov_b32 s50,1317011456
 s_branch L_reent
L_redo:
 s_barrier
 s_mov_b32 s50,-1
L_reent:
 s_mov_b32 s1,0
 s_branch L_late
L_thief_b:
 v_lshlrev_b32 v2,2,v1
 buffer_load_dword v40,v2,s[44:47],0 offen sc0 sc1
 s_waitcnt vmcnt(0)
 v_or_b32 v40,0x7f7f7f7f,v40
 v_cmp_ne_u32 vcc,-1,v40
 s_nop 0
 s_cbranch_vccnz L_thief_b
 s_mov_b32 s60,-1
L_thief_bnext:
 v_add_u32 v2,160896,v4
 ds_read_b128 v[40:43],v2
 v_mov_b32 v3,-1
 v_lshlrev_b32 v2,2,v1
 s_waitcnt lgkmcnt(0)
 v_add_u32 v32,3,v2
 v_cmp_ne_u32 s[6:7],0,v43
 v_cmp_lt_i32 vcc,s60,v32
 s_nop 0
 s_and_b64 vcc,vcc,s[6:7]
 s_nop 1
 v_cndmask_b32 v3,v3,v32,vcc
 v_add_u32 v32,2,v2
 v_cmp_ne_u32 s[6:7],0,v42
 v_cmp_lt_i32 vcc,s60,v32
 s_nop 0
 s_and_b64 vcc,vcc,s[6:7]
 s_nop 1
 v_cndmask_b32 v3,v3,v32,vcc
 v_add_u32 v32,1,v2
 v_cmp_ne_u32 s[6:7],0,v41
 v_cmp_lt_i32 vcc,s60,v32
 s_nop 0
 s_and_b64 vcc,vcc,s[6:7]
 s_nop 1
 v_cndmask_b32 v3,v3,v32,vcc
 v_add_u32 v32,0,v2
 v_cmp_ne_u32 s[6:7],0,v40
 v_cmp_lt_i32 vcc,s60,v32
 s_nop 0
 s_and_b64 vcc,vcc,s[6:7]
 s_nop 1
 v_cndmask_b32 v3,v3,v32,vcc
 v_cmp_ne_u32 vcc,-1,v3
 s_nop 0
 s_cmp_eq_u64 vcc,0
 s_cbranch_scc1 L_thief_f
 s_ff1_i32_b64 s3,vcc
 s_nop 0
 v_readlane_b32 s88,v3,s3
 s_nop 0
 s_mov_b32 s60,s88
 s_call_b64 s[78:79],L_bsetup
 s_mov_b32 s3,0
L_pl_th:
 buffer_load_dword v35,v34,s[8:11],s3 offen sc0 sc1
 s_waitcnt vmcnt(0)
 v_cmp_eq_u32 vcc,0,v35
 s_nop 0
 s_cbranch_vccnz L_pl_th
 s_mov_b32 s3,4096
L_pl_to:
 buffer_load_dword v35,v34,s[8:11],s3 offen sc0 sc1
 s_waitcnt vmcnt(0)
 v_cmp_eq_u32 vcc,0,v35
 s_nop 0
 s_cbranch_vccnz L_pl_to
 s_and_b32 s5,s88,252
L_part:
 buffer_load_dword v33,off,s[44:47],s5 sc0 sc1
 s_waitcnt vmcnt(0)
 v_readfirstlane_b32 s82,v33
 s_nop 0
 s_and_b32 s82,s82,0x7e7e7e00
 s_cbranch_scc1 L_part_ok
 v_or_b32 v32,0x30201000,v33
 s_mov_b64 exec,1
 buffer_atomic_cmpswap v[32:33],off,s[44:47],s5 sc0 sc1
 s_mov_b64 exec,-1
 s_waitcnt vmcnt(0)
 s_branch L_part
L_part_ok:
 v_mul_u32_u24 v32,0x801,v1
 v_and_b32 v32,0x7830,v32
 v_add_u32 v32,s90,v32
 v_mov_b32 v37,163328
 v_lshl_add_u32 v36,s48,2,v37
 v_min_u32 v2,2,v1
 v_add_u32 v2,1,v2
 v_lshlrev_b32 v33,4,v2
 v_xor_b32 v33,s76,v33
 v_add_u32 v38,4096,v33
 s_lshl3_add_u32 s84,s88,0x60001
 s_lshr_b32 s67,s82,8
 s_bfe_u32 s85,s82,s84
 s_or_b32 s67,s67,0x40000000
 s_bfe_u32 s67,s67,s84
 s_sub_u32 s67,s67,s85
 s_lshl_b32 s84,s85,17
 s_add_u32 s84,s84,3014656
 s_sub_u32 s85,s84,s73
 s_lshr_b32 s85,s85,4
 s_add_u32 s85,s85,s71
 s_mov_b32 s57,s71
 s_mov_b32 s58,s73
 s_mov_b32 s96,s28
 s_mov_b32 s97,s29
 s_mov_b32 s98,s30
 s_mov_b32 s99,0x00020000
 s_add_u32 s6,s67,5
 s_add_u32 s7,s75,0
 s_call_b64 s[78:79],L_bgemm
 s_mov_b32 s57,s72
 s_mov_b32 s58,s74
 s_mov_b32 s96,s32
 s_mov_b32 s97,s33
 s_mov_b32 s98,s34
 s_mov_b32 s99,0x00020000
 s_mov_b32 s6,15
 s_mov_b32 s67,-1
 s_add_u32 s7,s75,65536
 s_call_b64 s[78:79],L_bgemm
 s_waitcnt vmcnt(0)
 buffer_store_dword v7,off,s[8:11],s76 sc0 sc1
 s_add_u32 s4,s76,4096
 buffer_store_dword v7,off,s[8:11],s4 sc0 sc1
 s_branch L_thief_bnext
L_thief_f:
 s_mov_b32 s60,-1
L_thief_fnext:
 v_add_u32 v2,160896,v4
 ds_read_b128 v[40:43],v2
 v_mov_b32 v3,-1
 v_lshlrev_b32 v2,2,v1
 s_waitcnt lgkmcnt(0)
 v_add_u32 v32,3,v2
 v_cmp_ne_u32 s[6:7],0,v43
 v_cmp_lt_i32 vcc,s60,v32
 s_nop 0
 s_and_b64 vcc,vcc,s[6:7]
 s_nop 1
 v_cndmask_b32 v3,v3,v32,vcc
 v_add_u32 v32,2,v2
 v_cmp_ne_u32 s[6:7],0,v42
 v_cmp_lt_i32 vcc,s60,v32
 s_nop 0
 s_and_b64 vcc,vcc,s[6:7]
 s_nop 1
 v_cndmask_b32 v3,v3,v32,vcc
 v_add_u32 v32,1,v2
 v_cmp_ne_u32 s[6:7],0,v41
 v_cmp_lt_i32 vcc,s60,v32
 s_nop 0
 s_and_b64 vcc,vcc,s[6:7]
 s_nop 1
 v_cndmask_b32 v3,v3,v32,vcc
 v_add_u32 v32,0,v2
 v_cmp_ne_u32 s[6:7],0,v40
 v_cmp_lt_i32 vcc,s60,v32
 s_nop 0
 s_and_b64 vcc,vcc,s[6:7]
 s_nop 1
 v_cndmask_b32 v3,v3,v32,vcc
 v_cmp_ne_u32 vcc,-1,v3
 s_nop 0
 s_cmp_eq_u64 vcc,0
 s_cbranch_scc1 L_done
 s_ff1_i32_b64 s3,vcc
 s_nop 0
 v_readlane_b32 s88,v3,s3
 s_nop 0
 s_mov_b32 s60,s88
 s_call_b64 s[78:79],L_bsetup
 s_mov_b32 s3,0
L_pl_tf:
 buffer_load_dword v35,v33,s[8:11],s3 offen sc0 sc1
 s_waitcnt vmcnt(0)
 v_cmp_eq_u32 vcc,0,v35
 s_nop 0
 s_cbranch_vccnz L_pl_tf
 s_xor_b32 s63,s75,0
 buffer_load_dwordx4 v[96:99],v4,s[8:11],s63 offen offset:0 sc1
 buffer_load_dwordx4 v[100:103],v4,s[8:11],s63 offen offset:1024 sc1
 buffer_load_dwordx4 v[104:107],v4,s[8:11],s63 offen offset:2048 sc1
 buffer_load_dwordx4 v[108:111],v4,s[8:11],s63 offen offset:3072 sc1
 s_xor_b32 s63,s75,135168
 buffer_load_dwordx4 v[192:195],v4,s[8:11],s63 offen offset:0 sc1
 buffer_load_dwordx4 v[196:199],v4,s[8:11],s63 offen offset:1024 sc1
 buffer_load_dwordx4 v[200:203],v4,s[8:11],s63 offen offset:2048 sc1
 buffer_load_dwordx4 v[204:207],v4,s[8:11],s63 offen offset:3072 sc1
 s_xor_b32 s63,s75,270336
 buffer_load_dwordx4 v[224:227],v4,s[8:11],s63 offen offset:0 sc1
 buffer_load_dwordx4 v[228:231],v4,s[8:11],s63 offen offset:1024 sc1
 buffer_load_dwordx4 v[232:235],v4,s[8:11],s63 offen offset:2048 sc1
 buffer_load_dwordx4 v[236:239],v4,s[8:11],s63 offen offset:3072 sc1
 s_xor_b32 s63,s75,405504
 buffer_load_dwordx4 v[12:15],v4,s[8:11],s63 offen offset:0 sc1
 buffer_load_dwordx4 v[16:19],v4,s[8:11],s63 offen offset:1024 sc1
 buffer_load_dwordx4 v[24:27],v4,s[8:11],s63 offen offset:2048 sc1
 buffer_load_dwordx4 v[40:43],v4,s[8:11],s63 offen offset:3072 sc1
 s_add_u32 s63,s75,65536
 buffer_load_dwordx4 v[112:115],v4,s[8:11],s63 offen offset:0 sc1
 buffer_load_dwordx4 v[116:119],v4,s[8:11],s63 offen offset:1024 sc1
 buffer_load_dwordx4 v[120:123],v4,s[8:11],s63 offen offset:2048 sc1
 buffer_load_dwordx4 v[124:127],v4,s[8:11],s63 offen offset:3072 sc1
 s_waitcnt vmcnt(0)
 v_lshlrev_b32 v128,16,v96
 v_and_b32 v129,0xffff0000,v96
 v_lshlrev_b32 v130,16,v97
 v_and_b32 v131,0xffff0000,v97
 v_lshlrev_b32 v64,16,v98
 v_and_b32 v65,0xffff0000,v98
 v_lshlrev_b32 v66,16,v99
 v_and_b32 v67,0xffff0000,v99
 v_lshlrev_b32 v132,16,v100
 v_and_b32 v133,0xffff0000,v100
 v_lshlrev_b32 v134,16,v101
 v_and_b32 v135,0xffff0000,v101
 v_lshlrev_b32 v68,16,v102
 v_and_b32 v69,0xffff0000,v102
 v_lshlrev_b32 v70,16,v103
 v_and_b32 v71,0xffff0000,v103
 v_lshlrev_b32 v136,16,v104
 v_and_b32 v137,0xffff0000,v104
 v_lshlrev_b32 v138,16,v105
 v_and_b32 v139,0xffff0000,v105
 v_lshlrev_b32 v72,16,v106
 v_and_b32 v73,0xffff0000,v106
 v_lshlrev_b32 v74,16,v107
 v_and_b32 v75,0xffff0000,v107
 v_lshlrev_b32 v140,16,v108
 v_and_b32 v141,0xffff0000,v108
 v_lshlrev_b32 v142,16,v109
 v_and_b32 v143,0xffff0000,v109
 v_lshlrev_b32 v76,16,v110
 v_and_b32 v77,0xffff0000,v110
 v_lshlrev_b32 v78,16,v111
 v_and_b32 v79,0xffff0000,v111
 v_lshlrev_b32 v28,16,v192
 v_lshlrev_b32 v29,16,v193
 v_lshlrev_b32 v30,16,v194
 v_lshlrev_b32 v60,16,v195
 v_and_b32 v192,0xffff0000,v192
 v_and_b32 v193,0xffff0000,v193
 v_and_b32 v194,0xffff0000,v194
 v_and_b32 v195,0xffff0000,v195
 v_add_f32 v128,v128,v28
 v_add_f32 v129,v129,v192
 v_add_f32 v130,v130,v29
 v_add_f32 v131,v131,v193
 v_add_f32 v64,v64,v30
 v_add_f32 v65,v65,v194
 v_add_f32 v66,v66,v60
 v_add_f32 v67,v67,v195
 v_lshlrev_b32 v61,16,v224
 v_lshlrev_b32 v62,16,v225
 v_lshlrev_b32 v63,16,v226
 v_lshlrev_b32 v28,16,v227
 v_and_b32 v224,0xffff0000,v224
 v_and_b32 v225,0xffff0000,v225
 v_and_b32 v226,0xffff0000,v226
 v_and_b32 v227,0xffff0000,v227
 v_add_f32 v128,v128,v61
 v_add_f32 v129,v129,v224
 v_add_f32 v130,v130,v62
 v_add_f32 v131,v131,v225
 v_add_f32 v64,v64,v63
 v_add_f32 v65,v65,v226
 v_add_f32 v66,v66,v28
 v_add_f32 v67,v67,v227
 v_lshlrev_b32 v29,16,v12
 v_lshlrev_b32 v30,16,v13
 v_lshlrev_b32 v60,16,v14
 v_lshlrev_b32 v61,16,v15
 v_and_b32 v12,0xffff0000,v12
 v_and_b32 v13,0xffff0000,v13
 v_and_b32 v14,0xffff0000,v14
 v_and_b32 v15,0xffff0000,v15
 v_add_f32 v128,v128,v29
 v_add_f32 v129,v129,v12
 v_add_f32 v130,v130,v30
 v_add_f32 v131,v131,v13
 v_add_f32 v64,v64,v60
 v_add_f32 v65,v65,v14
 v_add_f32 v66,v66,v61
 v_add_f32 v67,v67,v15
 v_cvt_pk_bf16_f32 v12,v128,v129
 v_cvt_pk_bf16_f32 v13,v130,v131
 v_cvt_pk_bf16_f32 v14,v64,v65
 v_cvt_pk_bf16_f32 v15,v66,v67
 v_lshlrev_b32 v128,16,v12
 v_and_b32 v129,0xffff0000,v12
 v_lshlrev_b32 v130,16,v13
 v_and_b32 v131,0xffff0000,v13
 v_lshlrev_b32 v64,16,v14
 v_and_b32 v65,0xffff0000,v14
 v_lshlrev_b32 v66,16,v15
 v_and_b32 v67,0xffff0000,v15
 v_mul_f32 v192,0xbfb8aa3b,v128
 v_mul_f32 v193,0xbfb8aa3b,v129
 v_mul_f32 v194,0xbfb8aa3b,v130
 v_mul_f32 v195,0xbfb8aa3b,v131
 v_mul_f32 v224,0xbfb8aa3b,v64
 v_mul_f32 v225,0xbfb8aa3b,v65
 v_mul_f32 v226,0xbfb8aa3b,v66
 v_mul_f32 v227,0xbfb8aa3b,v67
 v_exp_f32 v192,v192
 v_exp_f32 v193,v193
 v_exp_f32 v194,v194
 v_exp_f32 v195,v195
 v_exp_f32 v224,v224
 v_exp_f32 v225,v225
 v_exp_f32 v226,v226
 v_exp_f32 v227,v227
 v_add_f32 v192,1.0,v192
 v_add_f32 v193,1.0,v193
 v_add_f32 v194,1.0,v194
 v_add_f32 v195,1.0,v195
 v_add_f32 v224,1.0,v224
 v_add_f32 v225,1.0,v225
 v_add_f32 v226,1.0,v226
 v_add_f32 v227,1.0,v227
 v_rcp_f32 v192,v192
 v_rcp_f32 v193,v193
 v_rcp_f32 v194,v194
 v_rcp_f32 v195,v195
 v_rcp_f32 v224,v224
 v_rcp_f32 v225,v225
 v_rcp_f32 v226,v226
 v_rcp_f32 v227,v227
 v_mul_f32 v128,v128,v192
 v_mul_f32 v129,v129,v193
 v_mul_f32 v130,v130,v194
 v_mul_f32 v131,v131,v195
 v_mul_f32 v64,v64,v224
 v_mul_f32 v65,v65,v225
 v_mul_f32 v66,v66,v226
 v_mul_f32 v67,v67,v227
 v_cvt_pk_bf16_f32 v12,v128,v129
 v_cvt_pk_bf16_f32 v13,v130,v131
 v_cvt_pk_bf16_f32 v14,v64,v65
 v_cvt_pk_bf16_f32 v15,v66,v67
 v_lshlrev_b32 v128,16,v12
 v_and_b32 v129,0xffff0000,v12
 v_lshlrev_b32 v130,16,v13
 v_and_b32 v131,0xffff0000,v13
 v_lshlrev_b32 v64,16,v14
 v_and_b32 v65,0xffff0000,v14
 v_lshlrev_b32 v66,16,v15
 v_and_b32 v67,0xffff0000,v15
 v_lshlrev_b32 v62,16,v196
 v_lshlrev_b32 v63,16,v197
 v_lshlrev_b32 v28,16,v198
 v_lshlrev_b32 v29,16,v199
 v_and_b32 v196,0xffff0000,v196
 v_and_b32 v197,0xffff0000,v197
 v_and_b32 v198,0xffff0000,v198
 v_and_b32 v199,0xffff0000,v199
 v_add_f32 v132,v132,v62
 v_add_f32 v133,v133,v196
 v_add_f32 v134,v134,v63
 v_add_f32 v135,v135,v197
 v_add_f32 v68,v68,v28
 v_add_f32 v69,v69,v198
 v_add_f32 v70,v70,v29
 v_add_f32 v71,v71,v199
 v_lshlrev_b32 v30,16,v228
 v_lshlrev_b32 v60,16,v229
 v_lshlrev_b32 v61,16,v230
 v_lshlrev_b32 v62,16,v231
 v_and_b32 v228,0xffff0000,v228
 v_and_b32 v229,0xffff0000,v229
 v_and_b32 v230,0xffff0000,v230
 v_and_b32 v231,0xffff0000,v231
 v_add_f32 v132,v132,v30
 v_add_f32 v133,v133,v228
 v_add_f32 v134,v134,v60
 v_add_f32 v135,v135,v229
 v_add_f32 v68,v68,v61
 v_add_f32 v69,v69,v230
 v_add_f32 v70,v70,v62
 v_add_f32 v71,v71,v231
 v_lshlrev_b32 v63,16,v16
 v_lshlrev_b32 v28,16,v17
 v_lshlrev_b32 v29,16,v18
 v_lshlrev_b32 v30,16,v19
 v_and_b32 v16,0xffff0000,v16
 v_and_b32 v17,0xffff0000,v17
 v_and_b32 v18,0xffff0000,v18
 v_and_b32 v19,0xffff0000,v19
 v_add_f32 v132,v132,v63
 v_add_f32 v133,v133,v16
 v_add_f32 v134,v134,v28
 v_add_f32 v135,v135,v17
 v_add_f32 v68,v68,v29
 v_add_f32 v69,v69,v18
 v_add_f32 v70,v70,v30
 v_add_f32 v71,v71,v19
 v_cvt_pk_bf16_f32 v16,v132,v133
 v_cvt_pk_bf16_f32 v17,v134,v135
 v_cvt_pk_bf16_f32 v18,v68,v69
 v_cvt_pk_bf16_f32 v19,v70,v71
 v_lshlrev_b32 v132,16,v16
 v_and_b32 v133,0xffff0000,v16
 v_lshlrev_b32 v134,16,v17
 v_and_b32 v135,0xffff0000,v17
 v_lshlrev_b32 v68,16,v18
 v_and_b32 v69,0xffff0000,v18
 v_lshlrev_b32 v70,16,v19
 v_and_b32 v71,0xffff0000,v19
 v_mul_f32 v196,0xbfb8aa3b,v132
 v_mul_f32 v197,0xbfb8aa3b,v133
 v_mul_f32 v198,0xbfb8aa3b,v134
 v_mul_f32 v199,0xbfb8aa3b,v135
 v_mul_f32 v228,0xbfb8aa3b,v68
 v_mul_f32 v229,0xbfb8aa3b,v69
 v_mul_f32 v230,0xbfb8aa3b,v70
 v_mul_f32 v231,0xbfb8aa3b,v71
 v_exp_f32 v196,v196
 v_exp_f32 v197,v197
 v_exp_f32 v198,v198
 v_exp_f32 v199,v199
 v_exp_f32 v228,v228
 v_exp_f32 v229,v229
 v_exp_f32 v230,v230
 v_exp_f32 v231,v231
 v_add_f32 v196,1.0,v196
 v_add_f32 v197,1.0,v197
 v_add_f32 v198,1.0,v198
 v_add_f32 v199,1.0,v199
 v_add_f32 v228,1.0,v228
 v_add_f32 v229,1.0,v229
 v_add_f32 v230,1.0,v230
 v_add_f32 v231,1.0,v231
 v_rcp_f32 v196,v196
 v_rcp_f32 v197,v197
 v_rcp_f32 v198,v198
 v_rcp_f32 v199,v199
 v_rcp_f32 v228,v228
 v_rcp_f32 v229,v229
 v_rcp_f32 v230,v230
 v_rcp_f32 v231,v231
 v_mul_f32 v132,v132,v196
 v_mul_f32 v133,v133,v197
 v_mul_f32 v134,v134,v198
 v_mul_f32 v135,v135,v199
 v_mul_f32 v68,v68,v228
 v_mul_f32 v69,v69,v229
 v_mul_f32 v70,v70,v230
 v_mul_f32 v71,v71,v231
 v_cvt_pk_bf16_f32 v16,v132,v133
 v_cvt_pk_bf16_f32 v17,v134,v135
 v_cvt_pk_bf16_f32 v18,v68,v69
 v_cvt_pk_bf16_f32 v19,v70,v71
 v_lshlrev_b32 v132,16,v16
 v_and_b32 v133,0xffff0000,v16
 v_lshlrev_b32 v134,16,v17
 v_and_b32 v135,0xffff0000,v17
 v_lshlrev_b32 v68,16,v18
 v_and_b32 v69,0xffff0000,v18
 v_lshlrev_b32 v70,16,v19
 v_and_b32 v71,0xffff0000,v19
 v_lshlrev_b32 v60,16,v200
 v_lshlrev_b32 v61,16,v201
 v_lshlrev_b32 v62,16,v202
 v_lshlrev_b32 v63,16,v203
 v_and_b32 v200,0xffff0000,v200
 v_and_b32 v201,0xffff0000,v201
 v_and_b32 v202,0xffff0000,v202
 v_and_b32 v203,0xffff0000,v203
 v_add_f32 v136,v136,v60
 v_add_f32 v137,v137,v200
 v_add_f32 v138,v138,v61
 v_add_f32 v139,v139,v201
 v_add_f32 v72,v72,v62
 v_add_f32 v73,v73,v202
 v_add_f32 v74,v74,v63
 v_add_f32 v75,v75,v203
 v_lshlrev_b32 v28,16,v232
 v_lshlrev_b32 v29,16,v233
 v_lshlrev_b32 v30,16,v234
 v_lshlrev_b32 v60,16,v235
 v_and_b32 v232,0xffff0000,v232
 v_and_b32 v233,0xffff0000,v233
 v_and_b32 v234,0xffff0000,v234
 v_and_b32 v235,0xffff0000,v235
 v_add_f32 v136,v136,v28
 v_add_f32 v137,v137,v232
 v_add_f32 v138,v138,v29
 v_add_f32 v139,v139,v233
 v_add_f32 v72,v72,v30
 v_add_f32 v73,v73,v234
 v_add_f32 v74,v74,v60
 v_add_f32 v75,v75,v235
 v_lshlrev_b32 v61,16,v24
 v_lshlrev_b32 v62,16,v25
 v_lshlrev_b32 v63,16,v26
 v_lshlrev_b32 v28,16,v27
 v_and_b32 v24,0xffff0000,v24
 v_and_b32 v25,0xffff0000,v25
 v_and_b32 v26,0xffff0000,v26
 v_and_b32 v27,0xffff0000,v27
 v_add_f32 v136,v136,v61
 v_add_f32 v137,v137,v24
 v_add_f32 v138,v138,v62
 v_add_f32 v139,v139,v25
 v_add_f32 v72,v72,v63
 v_add_f32 v73,v73,v26
 v_add_f32 v74,v74,v28
 v_add_f32 v75,v75,v27
 v_cvt_pk_bf16_f32 v24,v136,v137
 v_cvt_pk_bf16_f32 v25,v138,v139
 v_cvt_pk_bf16_f32 v26,v72,v73
 v_cvt_pk_bf16_f32 v27,v74,v75
 v_lshlrev_b32 v136,16,v24
 v_and_b32 v137,0xffff0000,v24
 v_lshlrev_b32 v138,16,v25
 v_and_b32 v139,0xffff0000,v25
 v_lshlrev_b32 v72,16,v26
 v_and_b32 v73,0xffff0000,v26
 v_lshlrev_b32 v74,16,v27
 v_and_b32 v75,0xffff0000,v27
 v_mul_f32 v200,0xbfb8aa3b,v136
 v_mul_f32 v201,0xbfb8aa3b,v137
 v_mul_f32 v202,0xbfb8aa3b,v138
 v_mul_f32 v203,0xbfb8aa3b,v139
 v_mul_f32 v232,0xbfb8aa3b,v72
 v_mul_f32 v233,0xbfb8aa3b,v73
 v_mul_f32 v234,0xbfb8aa3b,v74
 v_mul_f32 v235,0xbfb8aa3b,v75
 v_exp_f32 v200,v200
 v_exp_f32 v201,v201
 v_exp_f32 v202,v202
 v_exp_f32 v203,v203
 v_exp_f32 v232,v232
 v_exp_f32 v233,v233
 v_exp_f32 v234,v234
 v_exp_f32 v235,v235
 v_add_f32 v200,1.0,v200
 v_add_f32 v201,1.0,v201
 v_add_f32 v202,1.0,v202
 v_add_f32 v203,1.0,v203
 v_add_f32 v232,1.0,v232
 v_add_f32 v233,1.0,v233
 v_add_f32 v234,1.0,v234
 v_add_f32 v235,1.0,v235
 v_rcp_f32 v200,v200
 v_rcp_f32 v201,v201
 v_rcp_f32 v202,v202
 v_rcp_f32 v203,v203
 v_rcp_f32 v232,v232
 v_rcp_f32 v233,v233
 v_rcp_f32 v234,v234
 v_rcp_f32 v235,v235
 v_mul_f32 v136,v136,v200
 v_mul_f32 v137,v137,v201
 v_mul_f32 v138,v138,v202
 v_mul_f32 v139,v139,v203
 v_mul_f32 v72,v72,v232
 v_mul_f32 v73,v73,v233
 v_mul_f32 v74,v74,v234
 v_mul_f32 v75,v75,v235
 v_cvt_pk_bf16_f32 v24,v136,v137
 v_cvt_pk_bf16_f32 v25,v138,v139
 v_cvt_pk_bf16_f32 v26,v72,v73
 v_cvt_pk_bf16_f32 v27,v74,v75
 v_lshlrev_b32 v136,16,v24
 v_and_b32 v137,0xffff0000,v24
 v_lshlrev_b32 v138,16,v25
 v_and_b32 v139,0xffff0000,v25
 v_lshlrev_b32 v72,16,v26
 v_and_b32 v73,0xffff0000,v26
 v_lshlrev_b32 v74,16,v27
 v_and_b32 v75,0xffff0000,v27
 v_lshlrev_b32 v29,16,v204
 v_lshlrev_b32 v30,16,v205
 v_lshlrev_b32 v60,16,v206
 v_lshlrev_b32 v61,16,v207
 v_and_b32 v204,0xffff0000,v204
 v_and_b32 v205,0xffff0000,v205
 v_and_b32 v206,0xffff0000,v206
 v_and_b32 v207,0xffff0000,v207
 v_add_f32 v140,v140,v29
 v_add_f32 v141,v141,v204
 v_add_f32 v142,v142,v30
 v_add_f32 v143,v143,v205
 v_add_f32 v76,v76,v60
 v_add_f32 v77,v77,v206
 v_add_f32 v78,v78,v61
 v_add_f32 v79,v79,v207
 v_lshlrev_b32 v62,16,v236
 v_lshlrev_b32 v63,16,v237
 v_lshlrev_b32 v28,16,v238
 v_lshlrev_b32 v29,16,v239
 v_and_b32 v236,0xffff0000,v236
 v_and_b32 v237,0xffff0000,v237
 v_and_b32 v238,0xffff0000,v238
 v_and_b32 v239,0xffff0000,v239
 v_add_f32 v140,v140,v62
 v_add_f32 v141,v141,v236
 v_add_f32 v142,v142,v63
 v_add_f32 v143,v143,v237
 v_add_f32 v76,v76,v28
 v_add_f32 v77,v77,v238
 v_add_f32 v78,v78,v29
 v_add_f32 v79,v79,v239
 v_lshlrev_b32 v30,16,v40
 v_lshlrev_b32 v60,16,v41
 v_lshlrev_b32 v61,16,v42
 v_lshlrev_b32 v62,16,v43
 v_and_b32 v40,0xffff0000,v40
 v_and_b32 v41,0xffff0000,v41
 v_and_b32 v42,0xffff0000,v42
 v_and_b32 v43,0xffff0000,v43
 v_add_f32 v140,v140,v30
 v_add_f32 v141,v141,v40
 v_add_f32 v142,v142,v60
 v_add_f32 v143,v143,v41
 v_add_f32 v76,v76,v61
 v_add_f32 v77,v77,v42
 v_add_f32 v78,v78,v62
 v_add_f32 v79,v79,v43
 v_cvt_pk_bf16_f32 v40,v140,v141
 v_cvt_pk_bf16_f32 v41,v142,v143
 v_cvt_pk_bf16_f32 v42,v76,v77
 v_cvt_pk_bf16_f32 v43,v78,v79
 v_lshlrev_b32 v140,16,v40
 v_and_b32 v141,0xffff0000,v40
 v_lshlrev_b32 v142,16,v41
 v_and_b32 v143,0xffff0000,v41
 v_lshlrev_b32 v76,16,v42
 v_and_b32 v77,0xffff0000,v42
 v_lshlrev_b32 v78,16,v43
 v_and_b32 v79,0xffff0000,v43
 v_mul_f32 v204,0xbfb8aa3b,v140
 v_mul_f32 v205,0xbfb8aa3b,v141
 v_mul_f32 v206,0xbfb8aa3b,v142
 v_mul_f32 v207,0xbfb8aa3b,v143
 v_mul_f32 v236,0xbfb8aa3b,v76
 v_mul_f32 v237,0xbfb8aa3b,v77
 v_mul_f32 v238,0xbfb8aa3b,v78
 v_mul_f32 v239,0xbfb8aa3b,v79
 v_exp_f32 v204,v204
 v_exp_f32 v205,v205
 v_exp_f32 v206,v206
 v_exp_f32 v207,v207
 v_exp_f32 v236,v236
 v_exp_f32 v237,v237
 v_exp_f32 v238,v238
 v_exp_f32 v239,v239
 v_add_f32 v204,1.0,v204
 v_add_f32 v205,1.0,v205
 v_add_f32 v206,1.0,v206
 v_add_f32 v207,1.0,v207
 v_add_f32 v236,1.0,v236
 v_add_f32 v237,1.0,v237
 v_add_f32 v238,1.0,v238
 v_add_f32 v239,1.0,v239
 v_rcp_f32 v204,v204
 v_rcp_f32 v205,v205
 v_rcp_f32 v206,v206
 v_rcp_f32 v207,v207
 v_rcp_f32 v236,v236
 v_rcp_f32 v237,v237
 v_rcp_f32 v238,v238
 v_rcp_f32 v239,v239
 v_mul_f32 v140,v140,v204
 v_mul_f32 v141,v141,v205
 v_mul_f32 v142,v142,v206
 v_mul_f32 v143,v143,v207
 v_mul_f32 v76,v76,v236
 v_mul_f32 v77,v77,v237
 v_mul_f32 v78,v78,v238
 v_mul_f32 v79,v79,v239
 v_cvt_pk_bf16_f32 v40,v140,v141
 v_cvt_pk_bf16_f32 v41,v142,v143
 v_cvt_pk_bf16_f32 v42,v76,v77
 v_cvt_pk_bf16_f32 v43,v78,v79
 v_lshlrev_b32 v140,16,v40
 v_and_b32 v141,0xffff0000,v40
 v_lshlrev_b32 v142,16,v41
 v_and_b32 v143,0xffff0000,v41
 v_lshlrev_b32 v76,16,v42
 v_and_b32 v77,0xffff0000,v42
 v_lshlrev_b32 v78,16,v43
 v_and_b32 v79,0xffff0000,v43
 s_mov_b32 s3,0
 buffer_load_dwordx4 v[44:47],v32,s[36:39],s3 offen
 v_lshlrev_b32 v80,16,v112
 v_and_b32 v81,0xffff0000,v112
 v_lshlrev_b32 v82,16,v113
 v_and_b32 v83,0xffff0000,v113
 v_lshlrev_b32 v144,16,v114
 v_and_b32 v145,0xffff0000,v114
 v_lshlrev_b32 v146,16,v115
 v_and_b32 v147,0xffff0000,v115
 s_mov_b32 s3,32768
 buffer_load_dwordx4 v[48:51],v32,s[36:39],s3 offen
 v_lshlrev_b32 v84,16,v116
 v_and_b32 v85,0xffff0000,v116
 v_lshlrev_b32 v86,16,v117
 v_and_b32 v87,0xffff0000,v117
 v_lshlrev_b32 v148,16,v118
 v_and_b32 v149,0xffff0000,v118
 v_lshlrev_b32 v150,16,v119
 v_and_b32 v151,0xffff0000,v119
 s_mov_b32 s3,65536
 buffer_load_dwordx4 v[52:55],v32,s[36:39],s3 offen
 v_lshlrev_b32 v88,16,v120
 v_and_b32 v89,0xffff0000,v120
 v_lshlrev_b32 v90,16,v121
 v_and_b32 v91,0xffff0000,v121
 v_lshlrev_b32 v152,16,v122
 v_and_b32 v153,0xffff0000,v122
 v_lshlrev_b32 v154,16,v123
 v_and_b32 v155,0xffff0000,v123
 s_mov_b32 s3,98304
 buffer_load_dwordx4 v[56:59],v32,s[36:39],s3 offen
 v_lshlrev_b32 v92,16,v124
 v_and_b32 v93,0xffff0000,v124
 v_lshlrev_b32 v94,16,v125
 v_and_b32 v95,0xffff0000,v125
 v_lshlrev_b32 v156,16,v126
 v_and_b32 v157,0xffff0000,v126
 v_lshlrev_b32 v158,16,v127
 v_and_b32 v159,0xffff0000,v127
 s_waitcnt vmcnt(0)
 v_accvgpr_write_b32 a224,v80
 v_accvgpr_write_b32 a225,v81
 v_accvgpr_write_b32 a226,v82
 v_accvgpr_write_b32 a227,v83
 v_accvgpr_write_b32 a228,v84
 v_accvgpr_write_b32 a229,v85
 v_accvgpr_write_b32 a230,v86
 v_accvgpr_write_b32 a231,v87
 v_accvgpr_write_b32 a232,v88
 v_accvgpr_write_b32 a233,v89
 v_accvgpr_write_b32 a234,v90
 v_accvgpr_write_b32 a235,v91
 v_accvgpr_write_b32 a236,v92
 v_accvgpr_write_b32 a237,v93
 v_accvgpr_write_b32 a238,v94
 v_accvgpr_write_b32 a239,v95
 v_permlane16_swap_b32 v44,v46
 v_permlane16_swap_b32 v45,v47
 v_permlane16_swap_b32 v48,v50
 v_permlane16_swap_b32 v49,v51
 v_permlane16_swap_b32 v52,v54
 v_permlane16_swap_b32 v53,v55
 v_permlane16_swap_b32 v56,v58
 v_permlane16_swap_b32 v57,v59
 s_branch L_final_all
L_bsetup:
 s_and_b32 s3,s88,3
 s_and_b32 s4,s88,4
 s_bfe_u32 s5,s88,0x20003
 s_add_u32 s5,s4,s5
 s_lshr_b32 s4,s88,5
 s_lshl_b32 s4,s4,2
 s_add_u32 s4,s4,s48
 s_mul_i32 s6,s4,458752
 s_mul_i32 s7,s3,49152
 s_add_u32 s6,s6,s7
 s_add_u32 s71,s6,4194304
 s_lshl_b32 s6,s4,19
 s_lshl_b32 s7,s3,17
 s_add_u32 s6,s6,s7
 s_add_u32 s72,s6,20971520
 s_mul_i32 s73,s3,786432
 s_lshl_b32 s74,s3,21
 s_lshl_b32 s89,s3,6
 s_lshr_b32 s6,s48,1
 s_lshl_b32 s6,s6,16
 s_and_b32 s7,s48,1
 s_lshl_b32 s7,s7,13
 s_add_u32 s6,s6,s7
 s_lshl_b32 s7,s5,8
 s_add_u32 s87,s6,s7
 s_lshl_b32 s6,s88,17
 s_lshl_b32 s7,s48,14
 s_add_u32 s6,s6,s7
 s_add_u32 s75,s6,41943040
 s_lshl_b32 s6,s88,4
 s_lshl_b32 s7,s48,2
 s_add_u32 s6,s6,s7
 s_add_u32 s76,s6,83898368
 s_lshl_b32 s6,s4,17
 s_lshl_b32 s7,s5,8
 s_add_u32 s6,s6,s7
 s_add_u32 s90,s6,s89
 s_lshl_b32 s6,s4,7
 s_add_u32 s91,s6,83890176
 v_mul_u32_u24 v32,0x801,v1
 v_and_b32 v32,0x7830,v32
 v_add_u32 v32,s90,v32
 v_and_b32 v8,12,v1
 v_and_b32 v2,1,v1
 v_lshl_or_b32 v8,v2,1,v8
 v_bfe_u32 v2,v1,1,1
 v_or_b32 v8,v8,v2
 v_lshlrev_b32 v8,4,v8
 v_xor_b32 v8,s89,v8
 v_lshrrev_b32 v2,4,v1
 v_lshl_add_u32 v8,v2,14,v8
 v_add_u32 v8,s87,v8
 v_add_u32 v9,960,v8
 v_add_u32 v10,1920,v8
 v_add_u32 v11,2880,v8
 v_and_b32 v34,31,v1
 v_lshlrev_b32 v34,2,v34
 v_add_u32 v34,s91,v34
 v_mov_b32 v37,163328
 v_lshl_add_u32 v36,s48,2,v37
 v_min_u32 v2,2,v1
 v_add_u32 v2,1,v2
 v_lshlrev_b32 v33,4,v2
 v_xor_b32 v33,s76,v33
 v_add_u32 v38,4096,v33
 s_setpc_b64 s[78:79]
L_bgemm:
 v_accvgpr_write_b32 a0,0
 v_accvgpr_write_b32 a1,0
 v_accvgpr_write_b32 a2,0
 v_accvgpr_write_b32 a3,0
 v_accvgpr_write_b32 a4,0
 v_accvgpr_write_b32 a5,0
 v_accvgpr_write_b32 a6,0
 v_accvgpr_write_b32 a7,0
 v_accvgpr_write_b32 a8,0
 v_accvgpr_write_b32 a9,0
 v_accvgpr_write_b32 a10,0
 v_accvgpr_write_b32 a11,0
 v_accvgpr_write_b32 a12,0
 v_accvgpr_write_b32 a13,0
 v_accvgpr_write_b32 a14,0
 v_accvgpr_write_b32 a15,0
 v_accvgpr_write_b32 a16,0
 v_accvgpr_write_b32 a17,0
 v_accvgpr_write_b32 a18,0
 v_accvgpr_write_b32 a19,0
 v_accvgpr_write_b32 a20,0
 v_accvgpr_write_b32 a21,0
 v_accvgpr_write_b32 a22,0
 v_accvgpr_write_b32 a23,0
 v_accvgpr_write_b32 a24,0
 v_accvgpr_write_b32 a25,0
 v_accvgpr_write_b32 a26,0
 v_accvgpr_write_b32 a27,0
 v_accvgpr_write_b32 a28,0
 v_accvgpr_write_b32 a29,0
 v_accvgpr_write_b32 a30,0
 v_accvgpr_write_b32 a31,0
 v_accvgpr_write_b32 a32,0
 v_accvgpr_write_b32 a33,0
 v_accvgpr_write_b32 a34,0
 v_accvgpr_write_b32 a35,0
 v_accvgpr_write_b32 a36,0
 v_accvgpr_write_b32 a37,0
 v_accvgpr_write_b32 a38,0
 v_accvgpr_write_b32 a39,0
 v_accvgpr_write_b32 a40,0
 v_accvgpr_write_b32 a41,0
 v_accvgpr_write_b32 a42,0
 v_accvgpr_write_b32 a43,0
 v_accvgpr_write_b32 a44,0
 v_accvgpr_write_b32 a45,0
 v_accvgpr_write_b32 a46,0
 v_accvgpr_write_b32 a47,0
 v_accvgpr_write_b32 a48,0
 v_accvgpr_write_b32 a49,0
 v_accvgpr_write_b32 a50,0
 v_accvgpr_write_b32 a51,0
 v_accvgpr_write_b32 a52,0
 v_accvgpr_write_b32 a53,0
 v_accvgpr_write_b32 a54,0
 v_accvgpr_write_b32 a55,0
 v_accvgpr_write_b32 a56,0
 v_accvgpr_write_b32 a57,0
 v_accvgpr_write_b32 a58,0
 v_accvgpr_write_b32 a59,0
 v_accvgpr_write_b32 a60,0
 v_accvgpr_write_b32 a61,0
 v_accvgpr_write_b32 a62,0
 v_accvgpr_write_b32 a63,0
 v_accvgpr_write_b32 a64,0
 v_accvgpr_write_b32 a65,0
 v_accvgpr_write_b32 a66,0
 v_accvgpr_write_b32 a67,0
 v_accvgpr_write_b32 a68,0
 v_accvgpr_write_b32 a69,0
 v_accvgpr_write_b32 a70,0
 v_accvgpr_write_b32 a71,0
 v_accvgpr_write_b32 a72,0
 v_accvgpr_write_b32 a73,0
 v_accvgpr_write_b32 a74,0
 v_accvgpr_write_b32 a75,0
 v_accvgpr_write_b32 a76,0
 v_accvgpr_write_b32 a77,0
 v_accvgpr_write_b32 a78,0
 v_accvgpr_write_b32 a79,0
 v_accvgpr_write_b32 a80,0
 v_accvgpr_write_b32 a81,0
 v_accvgpr_write_b32 a82,0
 v_accvgpr_write_b32 a83,0
 v_accvgpr_write_b32 a84,0
 v_accvgpr_write_b32 a85,0
 v_accvgpr_write_b32 a86,0
 v_accvgpr_write_b32 a87,0
 v_accvgpr_write_b32 a88,0
 v_accvgpr_write_b32 a89,0
 v_accvgpr_write_b32 a90,0
 v_accvgpr_write_b32 a91,0
 v_accvgpr_write_b32 a92,0
 v_accvgpr_write_b32 a93,0
 v_accvgpr_write_b32 a94,0
 v_accvgpr_write_b32 a95,0
 v_accvgpr_write_b32 a96,0
 v_accvgpr_write_b32 a97,0
 v_accvgpr_write_b32 a98,0
 v_accvgpr_write_b32 a99,0
 v_accvgpr_write_b32 a100,0
 v_accvgpr_write_b32 a101,0
 v_accvgpr_write_b32 a102,0
 v_accvgpr_write_b32 a103,0
 v_accvgpr_write_b32 a104,0
 v_accvgpr_write_b32 a105,0
 v_accvgpr_write_b32 a106,0
 v_accvgpr_write_b32 a107,0
 v_accvgpr_write_b32 a108,0
 v_accvgpr_write_b32 a109,0
 v_accvgpr_write_b32 a110,0
 v_accvgpr_write_b32 a111,0
 v_accvgpr_write_b32 a112,0
 v_accvgpr_write_b32 a113,0
 v_accvgpr_write_b32 a114,0
 v_accvgpr_write_b32 a115,0
 v_accvgpr_write_b32 a116,0
 v_accvgpr_write_b32 a117,0
 v_accvgpr_write_b32 a118,0
 v_accvgpr_write_b32 a119,0
 v_accvgpr_write_b32 a120,0
 v_accvgpr_write_b32 a121,0
 v_accvgpr_write_b32 a122,0
 v_accvgpr_write_b32 a123,0
 v_accvgpr_write_b32 a124,0
 v_accvgpr_write_b32 a125,0
 v_accvgpr_write_b32 a126,0
 v_accvgpr_write_b32 a127,0
 s_mov_b32 m0,s51
L_bgemm_loop:
 s_nop 0
 buffer_load_dwordx4 v8,s[96:99],s58 offen offset:0 lds
 buffer_load_dwordx4 v9,s[96:99],s58 offen offset:1088 lds
 buffer_load_dwordx4 v10,s[96:99],s58 offen offset:2176 lds
 buffer_load_dwordx4 v11,s[96:99],s58 offen offset:3264 lds
 buffer_load_dwordx4 v[160:163],v4,s[8:11],s57 offen offset:0 sc1
 buffer_load_dwordx4 v[164:167],v4,s[8:11],s57 offen offset:1024 sc1
 buffer_load_dwordx4 v[168:171],v4,s[8:11],s57 offen offset:2048 sc1
 buffer_load_dwordx4 v[172:175],v4,s[8:11],s57 offen offset:3072 sc1
 buffer_load_dwordx4 v[176:179],v5,s[8:11],s57 offen offset:0 sc1
 buffer_load_dwordx4 v[180:183],v5,s[8:11],s57 offen offset:1024 sc1
 buffer_load_dwordx4 v[184:187],v5,s[8:11],s57 offen offset:2048 sc1
 buffer_load_dwordx4 v[188:191],v5,s[8:11],s57 offen offset:3072 sc1
 s_waitcnt vmcnt(0)
 s_barrier
 ds_read_b64_tr_b16 a[128:129],v21 offset:0
 ds_read_b64_tr_b16 a[130:131],v21 offset:256
 ds_read_b64_tr_b16 a[132:133],v21 offset:8768
 ds_read_b64_tr_b16 a[134:135],v21 offset:9024
 ds_read_b64_tr_b16 a[136:137],v21 offset:32
 ds_read_b64_tr_b16 a[138:139],v21 offset:288
 ds_read_b64_tr_b16 a[140:141],v21 offset:8800
 ds_read_b64_tr_b16 a[142:143],v21 offset:9056
 ds_read_b64_tr_b16 a[144:145],v21 offset:64
 ds_read_b64_tr_b16 a[146:147],v21 offset:320
 ds_read_b64_tr_b16 a[148:149],v21 offset:8832
 ds_read_b64_tr_b16 a[150:151],v21 offset:9088
 ds_read_b64_tr_b16 a[152:153],v21 offset:96
 ds_read_b64_tr_b16 a[154:155],v21 offset:352
 ds_read_b64_tr_b16 a[156:157],v21 offset:8864
 ds_read_b64_tr_b16 a[158:159],v21 offset:9120
 s_waitcnt lgkmcnt(0)
 v_mfma_f32_16x16x32_bf16 a[0:3],a[128:131],v[160:163],a[0:3]
 v_mfma_f32_16x16x32_bf16 a[0:3],a[132:135],v[164:167],a[0:3]
 v_mfma_f32_16x16x32_bf16 a[4:7],a[128:131],v[168:171],a[4:7]
 v_mfma_f32_16x16x32_bf16 a[4:7],a[132:135],v[172:175],a[4:7]
 v_mfma_f32_16x16x32_bf16 a[8:11],a[128:131],v[176:179],a[8:11]
 v_mfma_f32_16x16x32_bf16 a[8:11],a[132:135],v[180:183],a[8:11]
 v_mfma_f32_16x16x32_bf16 a[12:15],a[128:131],v[184:187],a[12:15]
 v_mfma_f32_16x16x32_bf16 a[12:15],a[132:135],v[188:191],a[12:15]
 v_mfma_f32_16x16x32_bf16 a[16:19],a[136:139],v[160:163],a[16:19]
 v_mfma_f32_16x16x32_bf16 a[16:19],a[140:143],v[164:167],a[16:19]
 v_mfma_f32_16x16x32_bf16 a[20:23],a[136:139],v[168:171],a[20:23]
 v_mfma_f32_16x16x32_bf16 a[20:23],a[140:143],v[172:175],a[20:23]
 v_mfma_f32_16x16x32_bf16 a[24:27],a[136:139],v[176:179],a[24:27]
 v_mfma_f32_16x16x32_bf16 a[24:27],a[140:143],v[180:183],a[24:27]
 v_mfma_f32_16x16x32_bf16 a[28:31],a[136:139],v[184:187],a[28:31]
 v_mfma_f32_16x16x32_bf16 a[28:31],a[140:143],v[188:191],a[28:31]
 v_mfma_f32_16x16x32_bf16 a[32:35],a[144:147],v[160:163],a[32:35]
 v_mfma_f32_16x16x32_bf16 a[32:35],a[148:151],v[164:167],a[32:35]
 v_mfma_f32_16x16x32_bf16 a[36:39],a[144:147],v[168:171],a[36:39]
 v_mfma_f32_16x16x32_bf16 a[36:39],a[148:151],v[172:175],a[36:39]
 v_mfma_f32_16x16x32_bf16 a[40:43],a[144:147],v[176:179],a[40:43]
 v_mfma_f32_16x16x32_bf16 a[40:43],a[148:151],v[180:183],a[40:43]
 v_mfma_f32_16x16x32_bf16 a[44:47],a[144:147],v[184:187],a[44:47]
 v_mfma_f32_16x16x32_bf16 a[44:47],a[148:151],v[188:191],a[44:47]
 v_mfma_f32_16x16x32_bf16 a[48:51],a[152:155],v[160:163],a[48:51]
 v_mfma_f32_16x16x32_bf16 a[48:51],a[156:159],v[164:167],a[48:51]
 v_mfma_f32_16x16x32_bf16 a[52:55],a[152:155],v[168:171],a[52:55]
 v_mfma_f32_16x16x32_bf16 a[52:55],a[156:159],v[172:175],a[52:55]
 v_mfma_f32_16x16x32_bf16 a[56:59],a[152:155],v[176:179],a[56:59]
 v_mfma_f32_16x16x32_bf16 a[56:59],a[156:159],v[180:183],a[56:59]
 v_mfma_f32_16x16x32_bf16 a[60:63],a[152:155],v[184:187],a[60:63]
 v_mfma_f32_16x16x32_bf16 a[60:63],a[156:159],v[188:191],a[60:63]
 ds_read_b64_tr_b16 a[128:129],v21 offset:128
 ds_read_b64_tr_b16 a[130:131],v21 offset:384
 ds_read_b64_tr_b16 a[132:133],v21 offset:8896
 ds_read_b64_tr_b16 a[134:135],v21 offset:9152
 ds_read_b64_tr_b16 a[136:137],v21 offset:160
 ds_read_b64_tr_b16 a[138:139],v21 offset:416
 ds_read_b64_tr_b16 a[140:141],v21 offset:8928
 ds_read_b64_tr_b16 a[142:143],v21 offset:9184
 ds_read_b64_tr_b16 a[144:145],v21 offset:192
 ds_read_b64_tr_b16 a[146:147],v21 offset:448
 ds_read_b64_tr_b16 a[148:149],v21 offset:8960
 ds_read_b64_tr_b16 a[150:151],v21 offset:9216
 ds_read_b64_tr_b16 a[152:153],v21 offset:224
 ds_read_b64_tr_b16 a[154:155],v21 offset:480
 ds_read_b64_tr_b16 a[156:157],v21 offset:8992
 ds_read_b64_tr_b16 a[158:159],v21 offset:9248
 s_waitcnt lgkmcnt(0)
 v_mfma_f32_16x16x32_bf16 a[64:67],a[128:131],v[160:163],a[64:67]
 v_mfma_f32_16x16x32_bf16 a[64:67],a[132:135],v[164:167],a[64:67]
 v_mfma_f32_16x16x32_bf16 a[68:71],a[128:131],v[168:171],a[68:71]
 v_mfma_f32_16x16x32_bf16 a[68:71],a[132:135],v[172:175],a[68:71]
 v_mfma_f32_16x16x32_bf16 a[72:75],a[128:131],v[176:179],a[72:75]
 v_mfma_f32_16x16x32_bf16 a[72:75],a[132:135],v[180:183],a[72:75]
 v_mfma_f32_16x16x32_bf16 a[76:79],a[128:131],v[184:187],a[76:79]
 v_mfma_f32_16x16x32_bf16 a[76:79],a[132:135],v[188:191],a[76:79]
 v_mfma_f32_16x16x32_bf16 a[80:83],a[136:139],v[160:163],a[80:83]
 v_mfma_f32_16x16x32_bf16 a[80:83],a[140:143],v[164:167],a[80:83]
 v_mfma_f32_16x16x32_bf16 a[84:87],a[136:139],v[168:171],a[84:87]
 v_mfma_f32_16x16x32_bf16 a[84:87],a[140:143],v[172:175],a[84:87]
 v_mfma_f32_16x16x32_bf16 a[88:91],a[136:139],v[176:179],a[88:91]
 v_mfma_f32_16x16x32_bf16 a[88:91],a[140:143],v[180:183],a[88:91]
 v_mfma_f32_16x16x32_bf16 a[92:95],a[136:139],v[184:187],a[92:95]
 v_mfma_f32_16x16x32_bf16 a[92:95],a[140:143],v[188:191],a[92:95]
 v_mfma_f32_16x16x32_bf16 a[96:99],a[144:147],v[160:163],a[96:99]
 v_mfma_f32_16x16x32_bf16 a[96:99],a[148:151],v[164:167],a[96:99]
 v_mfma_f32_16x16x32_bf16 a[100:103],a[144:147],v[168:171],a[100:103]
 v_mfma_f32_16x16x32_bf16 a[100:103],a[148:151],v[172:175],a[100:103]
 v_mfma_f32_16x16x32_bf16 a[104:107],a[144:147],v[176:179],a[104:107]
 v_mfma_f32_16x16x32_bf16 a[104:107],a[148:151],v[180:183],a[104:107]
 v_mfma_f32_16x16x32_bf16 a[108:111],a[144:147],v[184:187],a[108:111]
 v_mfma_f32_16x16x32_bf16 a[108:111],a[148:151],v[188:191],a[108:111]
 v_mfma_f32_16x16x32_bf16 a[112:115],a[152:155],v[160:163],a[112:115]
 v_mfma_f32_16x16x32_bf16 a[112:115],a[156:159],v[164:167],a[112:115]
 v_mfma_f32_16x16x32_bf16 a[116:119],a[152:155],v[168:171],a[116:119]
 v_mfma_f32_16x16x32_bf16 a[116:119],a[156:159],v[172:175],a[116:119]
 v_mfma_f32_16x16x32_bf16 a[120:123],a[152:155],v[176:179],a[120:123]
 v_mfma_f32_16x16x32_bf16 a[120:123],a[156:159],v[180:183],a[120:123]
 v_mfma_f32_16x16x32_bf16 a[124:127],a[152:155],v[184:187],a[124:127]
 v_mfma_f32_16x16x32_bf16 a[124:127],a[156:159],v[188:191],a[124:127]
 s_barrier
 s_cmp_eq_u32 s6,s67
 s_cselect_b32 s57,s85,s57
 s_cselect_b32 s58,s84,s58
 s_add_u32 s57,s57,8192
 s_add_u32 s58,s58,131072
 s_sub_u32 s6,s6,1
 s_cbranch_scc0 L_bgemm_loop
 s_nop 7
 s_add_u32 s63,s7,0
 v_accvgpr_read_b32 v12,a0
 v_accvgpr_read_b32 v13,a1
 v_accvgpr_read_b32 v14,a2
 v_accvgpr_read_b32 v15,a3
 v_accvgpr_read_b32 v16,a16
 v_accvgpr_read_b32 v17,a17
 v_accvgpr_read_b32 v18,a18
 v_accvgpr_read_b32 v19,a19
 v_cvt_pk_bf16_f32 v12,v12,v13
 v_cvt_pk_bf16_f32 v13,v14,v15
 v_cvt_pk_bf16_f32 v14,v16,v17
 v_cvt_pk_bf16_f32 v15,v18,v19
 buffer_store_dwordx4 v[12:15],v4,s[8:11],s63 offen offset:0 sc0 sc1
 v_accvgpr_read_b32 v24,a4
 v_accvgpr_read_b32 v25,a5
 v_accvgpr_read_b32 v26,a6
 v_accvgpr_read_b32 v27,a7
 v_accvgpr_read_b32 v40,a20
 v_accvgpr_read_b32 v41,a21
 v_accvgpr_read_b32 v42,a22
 v_accvgpr_read_b32 v43,a23
 v_cvt_pk_bf16_f32 v24,v24,v25
 v_cvt_pk_bf16_f32 v25,v26,v27
 v_cvt_pk_bf16_f32 v26,v40,v41
 v_cvt_pk_bf16_f32 v27,v42,v43
 buffer_store_dwordx4 v[24:27],v4,s[8:11],s63 offen offset:1024 sc0 sc1
 v_accvgpr_read_b32 v12,a8
 v_accvgpr_read_b32 v13,a9
 v_accvgpr_read_b32 v14,a10
 v_accvgpr_read_b32 v15,a11
 v_accvgpr_read_b32 v16,a24
 v_accvgpr_read_b32 v17,a25
 v_accvgpr_read_b32 v18,a26
 v_accvgpr_read_b32 v19,a27
 v_cvt_pk_bf16_f32 v12,v12,v13
 v_cvt_pk_bf16_f32 v13,v14,v15
 v_cvt_pk_bf16_f32 v14,v16,v17
 v_cvt_pk_bf16_f32 v15,v18,v19
 buffer_store_dwordx4 v[12:15],v4,s[8:11],s63 offen offset:2048 sc0 sc1
 v_accvgpr_read_b32 v24,a12
 v_accvgpr_read_b32 v25,a13
 v_accvgpr_read_b32 v26,a14
 v_accvgpr_read_b32 v27,a15
 v_accvgpr_read_b32 v40,a28
 v_accvgpr_read_b32 v41,a29
 v_accvgpr_read_b32 v42,a30
 v_accvgpr_read_b32 v43,a31
 v_cvt_pk_bf16_f32 v24,v24,v25
 v_cvt_pk_bf16_f32 v25,v26,v27
 v_cvt_pk_bf16_f32 v26,v40,v41
 v_cvt_pk_bf16_f32 v27,v42,v43
 buffer_store_dwordx4 v[24:27],v4,s[8:11],s63 offen offset:3072 sc0 sc1
 s_add_u32 s63,s7,4096
 v_accvgpr_read_b32 v12,a32
 v_accvgpr_read_b32 v13,a33
 v_accvgpr_read_b32 v14,a34
 v_accvgpr_read_b32 v15,a35
 v_accvgpr_read_b32 v16,a48
 v_accvgpr_read_b32 v17,a49
 v_accvgpr_read_b32 v18,a50
 v_accvgpr_read_b32 v19,a51
 v_cvt_pk_bf16_f32 v12,v12,v13
 v_cvt_pk_bf16_f32 v13,v14,v15
 v_cvt_pk_bf16_f32 v14,v16,v17
 v_cvt_pk_bf16_f32 v15,v18,v19
 buffer_store_dwordx4 v[12:15],v4,s[8:11],s63 offen offset:0 sc0 sc1
 v_accvgpr_read_b32 v24,a36
 v_accvgpr_read_b32 v25,a37
 v_accvgpr_read_b32 v26,a38
 v_accvgpr_read_b32 v27,a39
 v_accvgpr_read_b32 v40,a52
 v_accvgpr_read_b32 v41,a53
 v_accvgpr_read_b32 v42,a54
 v_accvgpr_read_b32 v43,a55
 v_cvt_pk_bf16_f32 v24,v24,v25
 v_cvt_pk_bf16_f32 v25,v26,v27
 v_cvt_pk_bf16_f32 v26,v40,v41
 v_cvt_pk_bf16_f32 v27,v42,v43
 buffer_store_dwordx4 v[24:27],v4,s[8:11],s63 offen offset:1024 sc0 sc1
 v_accvgpr_read_b32 v12,a40
 v_accvgpr_read_b32 v13,a41
 v_accvgpr_read_b32 v14,a42
 v_accvgpr_read_b32 v15,a43
 v_accvgpr_read_b32 v16,a56
 v_accvgpr_read_b32 v17,a57
 v_accvgpr_read_b32 v18,a58
 v_accvgpr_read_b32 v19,a59
 v_cvt_pk_bf16_f32 v12,v12,v13
 v_cvt_pk_bf16_f32 v13,v14,v15
 v_cvt_pk_bf16_f32 v14,v16,v17
 v_cvt_pk_bf16_f32 v15,v18,v19
 buffer_store_dwordx4 v[12:15],v4,s[8:11],s63 offen offset:2048 sc0 sc1
 v_accvgpr_read_b32 v24,a44
 v_accvgpr_read_b32 v25,a45
 v_accvgpr_read_b32 v26,a46
 v_accvgpr_read_b32 v27,a47
 v_accvgpr_read_b32 v40,a60
 v_accvgpr_read_b32 v41,a61
 v_accvgpr_read_b32 v42,a62
 v_accvgpr_read_b32 v43,a63
 v_cvt_pk_bf16_f32 v24,v24,v25
 v_cvt_pk_bf16_f32 v25,v26,v27
 v_cvt_pk_bf16_f32 v26,v40,v41
 v_cvt_pk_bf16_f32 v27,v42,v43
 buffer_store_dwordx4 v[24:27],v4,s[8:11],s63 offen offset:3072 sc0 sc1
 s_add_u32 s63,s7,8192
 v_accvgpr_read_b32 v12,a64
 v_accvgpr_read_b32 v13,a65
 v_accvgpr_read_b32 v14,a66
 v_accvgpr_read_b32 v15,a67
 v_accvgpr_read_b32 v16,a80
 v_accvgpr_read_b32 v17,a81
 v_accvgpr_read_b32 v18,a82
 v_accvgpr_read_b32 v19,a83
 v_cvt_pk_bf16_f32 v12,v12,v13
 v_cvt_pk_bf16_f32 v13,v14,v15
 v_cvt_pk_bf16_f32 v14,v16,v17
 v_cvt_pk_bf16_f32 v15,v18,v19
 buffer_store_dwordx4 v[12:15],v4,s[8:11],s63 offen offset:0 sc0 sc1
 v_accvgpr_read_b32 v24,a68
 v_accvgpr_read_b32 v25,a69
 v_accvgpr_read_b32 v26,a70
 v_accvgpr_read_b32 v27,a71
 v_accvgpr_read_b32 v40,a84
 v_accvgpr_read_b32 v41,a85
 v_accvgpr_read_b32 v42,a86
 v_accvgpr_read_b32 v43,a87
 v_cvt_pk_bf16_f32 v24,v24,v25
 v_cvt_pk_bf16_f32 v25,v26,v27
 v_cvt_pk_bf16_f32 v26,v40,v41
 v_cvt_pk_bf16_f32 v27,v42,v43
 buffer_store_dwordx4 v[24:27],v4,s[8:11],s63 offen offset:1024 sc0 sc1
 v_accvgpr_read_b32 v12,a72
 v_accvgpr_read_b32 v13,a73
 v_accvgpr_read_b32 v14,a74
 v_accvgpr_read_b32 v15,a75
 v_accvgpr_read_b32 v16,a88
 v_accvgpr_read_b32 v17,a89
 v_accvgpr_read_b32 v18,a90
 v_accvgpr_read_b32 v19,a91
 v_cvt_pk_bf16_f32 v12,v12,v13
 v_cvt_pk_bf16_f32 v13,v14,v15
 v_cvt_pk_bf16_f32 v14,v16,v17
 v_cvt_pk_bf16_f32 v15,v18,v19
 buffer_store_dwordx4 v[12:15],v4,s[8:11],s63 offen offset:2048 sc0 sc1
 v_accvgpr_read_b32 v24,a76
 v_accvgpr_read_b32 v25,a77
 v_accvgpr_read_b32 v26,a78
 v_accvgpr_read_b32 v27,a79
 v_accvgpr_read_b32 v40,a92
 v_accvgpr_read_b32 v41,a93
 v_accvgpr_read_b32 v42,a94
 v_accvgpr_read_b32 v43,a95
 v_cvt_pk_bf16_f32 v24,v24,v25
 v_cvt_pk_bf16_f32 v25,v26,v27
 v_cvt_pk_bf16_f32 v26,v40,v41
 v_cvt_pk_bf16_f32 v27,v42,v43
 buffer_store_dwordx4 v[24:27],v4,s[8:11],s63 offen offset:3072 sc0 sc1
 s_add_u32 s63,s7,12288
 v_accvgpr_read_b32 v12,a96
 v_accvgpr_read_b32 v13,a97
 v_accvgpr_read_b32 v14,a98
 v_accvgpr_read_b32 v15,a99
 v_accvgpr_read_b32 v16,a112
 v_accvgpr_read_b32 v17,a113
 v_accvgpr_read_b32 v18,a114
 v_accvgpr_read_b32 v19,a115
 v_cvt_pk_bf16_f32 v12,v12,v13
 v_cvt_pk_bf16_f32 v13,v14,v15
 v_cvt_pk_bf16_f32 v14,v16,v17
 v_cvt_pk_bf16_f32 v15,v18,v19
 buffer_store_dwordx4 v[12:15],v4,s[8:11],s63 offen offset:0 sc0 sc1
 v_accvgpr_read_b32 v24,a100
 v_accvgpr_read_b32 v25,a101
 v_accvgpr_read_b32 v26,a102
 v_accvgpr_read_b32 v27,a103
 v_accvgpr_read_b32 v40,a116
 v_accvgpr_read_b32 v41,a117
 v_accvgpr_read_b32 v42,a118
 v_accvgpr_read_b32 v43,a119
 v_cvt_pk_bf16_f32 v24,v24,v25
 v_cvt_pk_bf16_f32 v25,v26,v27
 v_cvt_pk_bf16_f32 v26,v40,v41
 v_cvt_pk_bf16_f32 v27,v42,v43
 buffer_store_dwordx4 v[24:27],v4,s[8:11],s63 offen offset:1024 sc0 sc1
 v_accvgpr_read_b32 v12,a104
 v_accvgpr_read_b32 v13,a105
 v_accvgpr_read_b32 v14,a106
 v_accvgpr_read_b32 v15,a107
 v_accvgpr_read_b32 v16,a120
 v_accvgpr_read_b32 v17,a121
 v_accvgpr_read_b32 v18,a122
 v_accvgpr_read_b32 v19,a123
 v_cvt_pk_bf16_f32 v12,v12,v13
 v_cvt_pk_bf16_f32 v13,v14,v15
 v_cvt_pk_bf16_f32 v14,v16,v17
 v_cvt_pk_bf16_f32 v15,v18,v19
 buffer_store_dwordx4 v[12:15],v4,s[8:11],s63 offen offset:2048 sc0 sc1
 v_accvgpr_read_b32 v24,a108
 v_accvgpr_read_b32 v25,a109
 v_accvgpr_read_b32 v26,a110
 v_accvgpr_read_b32 v27,a111
 v_accvgpr_read_b32 v40,a124
 v_accvgpr_read_b32 v41,a125
 v_accvgpr_read_b32 v42,a126
 v_accvgpr_read_b32 v43,a127
 v_cvt_pk_bf16_f32 v24,v24,v25
 v_cvt_pk_bf16_f32 v25,v26,v27
 v_cvt_pk_bf16_f32 v26,v40,v41
 v_cvt_pk_bf16_f32 v27,v42,v43
 buffer_store_dwordx4 v[24:27],v4,s[8:11],s63 offen offset:3072 sc0 sc1
 s_setpc_b64 s[78:79]
L_codeend:
.section .rodata,"a"
.p2align 6
.amdhsa_kernel recurrent_scan__mha_block_cached__geglu_ffn__prompt_kernel
  .amdhsa_next_free_vgpr 512
  .amdhsa_next_free_sgpr 102
  .amdhsa_accum_offset 256
  .amdhsa_group_segment_fixed_size 0
  .amdhsa_kernarg_size 96
  .amdhsa_user_sgpr_count 2
  .amdhsa_user_sgpr_kernarg_segment_ptr 1
  .amdhsa_system_sgpr_workgroup_id_x 1
.end_amdhsa_kernel
```
